```python
import torch

def _softmax(x, axis=-1):
    return torch.softmax(x, dim=axis)

def _gelu(x):
    return torch.nn.functional.gelu(x, approximate='tanh')

def _silu(x):
    return torch.nn.functional.silu(x)

def _sigmoid(x):
    return torch.sigmoid(x)

def _layernorm(x, axis=-1, eps=1e-05):
    m = x.mean(dim=axis, keepdim=True)
    v = x.var(dim=axis, keepdim=True, unbiased=False)
    return (x - m) / torch.sqrt(v + eps)

def _scatter_add(tgt, idx, src, axis=0):
    return tgt.clone().index_add_(axis, idx, src)

def _segment_sum(src, seg, n):
    out = torch.zeros((n,) + src.shape[1:], dtype=src.dtype)
    return out.index_add_(0, seg, src)

def _pad(x, pw):
    flat = tuple((v for pair in reversed(pw) for v in pair))
    return torch.nn.functional.pad(x, flat)
kernel_name = 'interleave_layers__memory_aug_recurrent_mem_tr__glu_gated_glu__prompt'

def setup_inputs():

    _w = lambda a: (lambda t: t.to(torch.bfloat16) if t.is_floating_point() else t)(torch.as_tensor(a))

    def _A_setup():
        B, S, Dm = (1, 2048, 640)
        H, Dh = (32, 192)
        M, seg = (8, 32)
        seg = min(seg, S)
        S = S // seg * seg
        return {'x': _w((lambda *s: torch.randn(*s, dtype=torch.bfloat16) * 0.05)(B, S, Dm)), 'mem0': _w((lambda *s: torch.randn(*s, dtype=torch.bfloat16) * 0.8)(B, M, Dm)), 'Wq': _w((lambda *s: torch.randn(*s, dtype=torch.bfloat16) * 0.8)(Dm, H, Dh) * Dm ** (-0.5)), 'Wk': _w((lambda *s: torch.randn(*s, dtype=torch.bfloat16) * 0.8)(Dm, H, Dh) * Dm ** (-0.5)), 'Wv': _w((lambda *s: torch.randn(*s, dtype=torch.bfloat16) * 0.8)(Dm, H, Dh) * Dm ** (-0.5)), 'Wo': _w((lambda *s: torch.randn(*s, dtype=torch.bfloat16) * 0.8)(H, Dh, Dm) * (H * Dh) ** (-0.5)), 'seg_len': seg}
    _A_in = _A_setup()

    def _B_setup():
        B, S, D, F = (1, 2048, 640, 1536)
        return {'x': _w((lambda *s: torch.randn(*s, dtype=torch.bfloat16) * 0.05)(B, S, D)), 'w_gate': _w((lambda *s: torch.randn(*s, dtype=torch.bfloat16) * 0.05)(D, F)), 'w_up': _w((lambda *s: torch.randn(*s, dtype=torch.bfloat16) * 0.05)(D, F)), 'w_down': _w((lambda *s: torch.randn(*s, dtype=torch.bfloat16) * 0.05)(F, D))}
    _B_in = _B_setup()
    return {'A_x': _A_in['x'], 'A_mem0': _A_in['mem0'], 'A_Wq': _A_in['Wq'], 'A_Wk': _A_in['Wk'], 'A_Wv': _A_in['Wv'], 'A_Wo': _A_in['Wo'], 'A_seg_len': _A_in['seg_len'], 'B_x': _B_in['x'], 'B_w_gate': _B_in['w_gate'], 'B_w_up': _B_in['w_up'], 'B_w_down': _B_in['w_down']}

def reference(A_x, A_mem0, A_Wq, A_Wk, A_Wv, A_Wo, A_seg_len, B_x, B_w_gate, B_w_up, B_w_down):

    def _A_ref(x, mem0, Wq, Wk, Wv, Wo, seg_len):
        B, S, Dm = x.shape
        H, Dh = (Wq.shape[1], Wq.shape[2])
        M = mem0.shape[1]
        scale = Dh ** (-0.5)
        n_seg = S // seg_len
        L = M + seg_len
        idx = torch.arange(L)
        mask = (idx[:, None] < M) | (idx[:, None] >= idx[None, :])
        mem = mem0
        outs = []
        for s in range(n_seg):
            xs = x[:, s * seg_len:(s + 1) * seg_len, :].clone()
            h = torch.concatenate([mem, xs], axis=1)
            q = torch.einsum('btd,dhe->bhte', h, Wq)
            k = torch.einsum('btd,dhe->bhte', h, Wk)
            v = torch.einsum('btd,dhe->bhte', h, Wv)
            scores = torch.einsum('bhqe,bhke->bhqk', q, k) * scale
            scores = torch.where(mask[None, None], scores, -1000000000.0)
            p = _softmax(scores, axis=-1)
            o = torch.einsum('bhqk,bhke->bhqe', p, v)
            o = torch.einsum('bhte,hed->btd', o, Wo)
            mem = o[:, :M, :].clone()
            outs.append(o[:, M:, :])
        return torch.concatenate(outs, axis=1)

    def _B_ref(x, w_gate, w_up, w_down):
        g = torch.einsum('bsd,df->bsf', x, w_gate)
        u = torch.einsum('bsd,df->bsf', x, w_up)
        h = _sigmoid(g) * u
        return torch.einsum('bsf,fd->bsd', h, w_down)
    x = A_x
    x = x + _A_ref(_layernorm(x, axis=-1), A_mem0, A_Wq, A_Wk, A_Wv, A_Wo, A_seg_len)
    x = x + _B_ref(_layernorm(x, axis=-1), B_w_gate, B_w_up, B_w_down)
    x = x + _A_ref(_layernorm(x, axis=-1), A_mem0, A_Wq, A_Wk, A_Wv, A_Wo, A_seg_len)
    x = x + _B_ref(_layernorm(x, axis=-1), B_w_gate, B_w_up, B_w_down)
    return x
```

```asm
; @launch grid=(256,1,1) block=(256,1,1) lds=163840
.amdgcn_target "amdgcn-amd-amdhsa--gfx950"
.text
.globl interleave_layers__memory_aug_recurrent_mem_tr__glu_gated_glu__prompt_kernel
.p2align 8
.type interleave_layers__memory_aug_recurrent_mem_tr__glu_gated_glu__prompt_kernel,@function
interleave_layers__memory_aug_recurrent_mem_tr__glu_gated_glu__prompt_kernel:
    s_cmp_ge_u32 s2, 256
    s_cbranch_scc1 L_exit
    s_load_dwordx16 s[64:79], s[0:1], 0
    s_load_dwordx8 s[80:87], s[0:1], 64
    s_load_dwordx4 s[88:91], s[0:1], 96
    s_getreg_b32 s14, hwreg(HW_REG_XCC_ID, 0, 4)
    v_lshrrev_b32 v2, 6, v0
    v_and_b32 v0, 63, v0
    v_readfirstlane_b32 s12, v2
    s_and_b32 s14, s14, 7
    s_mov_b32 s18, 0
    s_waitcnt lgkmcnt(0)
    s_mov_b64 s[16:17], s[88:89]

    s_mov_b32 s4, s90
    s_and_b32 s5, s91, 0xffff
    s_mov_b32 s6, 268435456
    s_mov_b32 s7, 0x20000
    s_mov_b32 s8, s90
    s_and_b32 s9, s91, 0xffff
    s_mov_b32 s10, 268435456
    s_mov_b32 s11, 0x20000
    v_mov_b32 v4, 163824
    s_cmp_lg_u32 s12, 0
    s_cbranch_scc1 L_ticket_done
    v_mov_b32 v3, 1
    s_lshl_b32 s15, s14, 2
    v_mov_b32 v2, s15
    s_mov_b64 exec, 1
    global_atomic_add v5, v2, v3, s[16:17] sc0 sc1
    s_waitcnt vmcnt(0)
    ds_write_b32 v4, v5
    s_waitcnt lgkmcnt(0)
    s_mov_b64 exec, -1
L_ticket_done:
    s_barrier
    ds_read_b32 v5, v4
    s_waitcnt lgkmcnt(0)
    v_readfirstlane_b32 s15, v5
    s_lshl_b32 s13, s14, 5
    s_add_u32 s13, s13, s15
    s_cmp_ge_u32 s15, 32
    s_cbranch_scc1 L_surplus

L_dispatch:
    s_cmp_lt_u32 s13, 64
    s_cbranch_scc1 L_roleR
    s_cmp_lt_u32 s13, 160
    s_cbranch_scc1 L_roleP
    s_cmp_lt_u32 s13, 224
    s_cbranch_scc1 L_roleO
    s_cmp_lt_u32 s13, 256
    s_cbranch_scc1 L_roleG
    s_endpgm
L_surplus:
    s_barrier
    s_cmp_lg_u32 s12, 0
    s_cbranch_scc1 L_E_arr_1
    s_lshl_b32 s3, s18, 2
    s_add_u32 s3, s3, 64
    v_mov_b32 v92, s3
    v_mov_b32 v93, 1
    s_mov_b64 exec, 1
    global_atomic_add v92, v93, s[16:17] sc1
    s_waitcnt vmcnt(0)
    s_mov_b64 exec, -1
L_E_arr_1:
    s_lshl_b32 s3, s18, 2
    s_add_u32 s3, s3, 64
    v_mov_b32 v92, s3
    v_lshlrev_b32 v94, 2, v0
    v_and_b32 v94, 28, v94
    s_mov_b32 s19, 0
L_E_warr_2:
    global_load_dword v93, v92, s[16:17] sc1
    s_add_u32 s19, s19, 1
    s_cmp_ge_u32 s19, 524288
    s_cbranch_scc1 L_fail
    s_waitcnt vmcnt(0)
    v_cmp_gt_u32 vcc, 256, v93
    s_nop 0
    s_cbranch_vccnz L_E_warr_2
L_fallback:
    s_barrier
    s_mov_b32 s18, 1
    s_mov_b32 s13, s2
    s_branch L_dispatch

L_fail:
    s_waitcnt vmcnt(0) lgkmcnt(0)
    s_mov_b64 exec, 1
    v_mov_b32 v2, 128
    v_mov_b32 v3, s13
    v_or_b32 v3, 0x10000, v3
    global_store_dword v2, v3, s[16:17]
    s_waitcnt vmcnt(0)
L_exit:
    s_endpgm

L_roleR:
    s_cmp_eq_u32 s12, 0
    s_cbranch_scc1 L_R0_start
    s_cmp_eq_u32 s12, 1
    s_cbranch_scc1 L_R1_start
    s_cmp_eq_u32 s12, 2
    s_cbranch_scc1 L_R2_start
    s_branch L_R3_start
L_R0_start:
    s_lshr_b32 s14, s13, 5
    s_and_b32 s15, s13, 31
    s_mov_b32 s62, 0
    v_lshlrev_b32 v10, 4, v0
    v_mov_b32 v12, 0
    v_mov_b32 v13, 0
    v_mov_b32 v14, 0
    v_mov_b32 v15, 0
    v_mov_b32 v16, -1
    v_mov_b32 v17, -1
    v_mov_b32 v18, -1
    v_mov_b32 v19, -1
    s_lshl_b32 s60, s13, 12
    s_add_u32 s60, s60, 917504
    buffer_store_dwordx4 v[12:15], v10, s[4:7], s60 offen sc1
    s_mul_i32 s60, s13, 20480
    s_add_u32 s60, s60, 1310720
    buffer_store_dwordx4 v[12:15], v10, s[4:7], s60 offen sc1
    s_add_u32 s60, s60, 1024
    buffer_store_dwordx4 v[12:15], v10, s[4:7], s60 offen sc1
    s_add_u32 s60, s60, 1024
    buffer_store_dwordx4 v[12:15], v10, s[4:7], s60 offen sc1
    s_add_u32 s60, s60, 1024
    buffer_store_dwordx4 v[12:15], v10, s[4:7], s60 offen sc1
    s_add_u32 s60, s60, 1024
    buffer_store_dwordx4 v[12:15], v10, s[4:7], s60 offen sc1
    s_add_u32 s60, s60, 1024
    s_mul_i32 s61, s15, 640
    v_add_u32 v11, s61, v10
    s_mov_b32 exec_hi, 0xff
    s_lshl_b32 s60, s14, 15
    s_add_u32 s60, s60, 1179648
    buffer_store_dwordx4 v[12:15], v11, s[4:7], s60 offen sc1
    s_mul_i32 s60, s14, 20480
    s_add_u32 s60, s60, 2621440
    buffer_store_dwordx4 v[12:15], v11, s[4:7], s60 offen sc1
    s_add_u32 s60, s60, 163840
    buffer_store_dwordx4 v[12:15], v11, s[4:7], s60 offen sc1
    s_add_u32 s60, s60, 163840
    buffer_store_dwordx4 v[12:15], v11, s[4:7], s60 offen sc1
    s_add_u32 s60, s60, 163840
    buffer_store_dwordx4 v[12:15], v11, s[4:7], s60 offen sc1
    s_add_u32 s60, s60, 163840
    buffer_store_dwordx4 v[12:15], v11, s[4:7], s60 offen sc1
    s_add_u32 s60, s60, 163840
    buffer_store_dwordx4 v[12:15], v11, s[4:7], s60 offen sc1
    s_add_u32 s60, s60, 163840
    buffer_store_dwordx4 v[12:15], v11, s[4:7], s60 offen sc1
    s_add_u32 s60, s60, 163840
    buffer_store_dwordx4 v[12:15], v11, s[4:7], s60 offen sc1
    s_add_u32 s60, s60, 163840
    buffer_store_dwordx4 v[12:15], v11, s[4:7], s60 offen sc1
    s_add_u32 s60, s60, 163840
    buffer_store_dwordx4 v[12:15], v11, s[4:7], s60 offen sc1
    s_add_u32 s60, s60, 163840
    buffer_store_dwordx4 v[12:15], v11, s[4:7], s60 offen sc1
    s_add_u32 s60, s60, 163840
    buffer_store_dwordx4 v[12:15], v11, s[4:7], s60 offen sc1
    s_add_u32 s60, s60, 163840
    buffer_store_dwordx4 v[12:15], v11, s[4:7], s60 offen sc1
    s_add_u32 s60, s60, 163840
    buffer_store_dwordx4 v[12:15], v11, s[4:7], s60 offen sc1
    s_add_u32 s60, s60, 163840
    buffer_store_dwordx4 v[12:15], v11, s[4:7], s60 offen sc1
    s_add_u32 s60, s60, 163840
    buffer_store_dwordx4 v[12:15], v11, s[4:7], s60 offen sc1
    s_add_u32 s60, s60, 163840
    buffer_store_dwordx4 v[12:15], v11, s[4:7], s60 offen sc1
    s_add_u32 s60, s60, 163840
    buffer_store_dwordx4 v[12:15], v11, s[4:7], s60 offen sc1
    s_add_u32 s60, s60, 163840
    s_mov_b64 exec, 1
    s_lshl_b32 s54, s13, 9
    s_lshr_b32 s55, s13, 1
    s_mul_i32 s55, s55, 1536
    s_add_u32 s55, s55, 32768
    s_add_u32 s54, s54, 0
    buffer_store_dword v12, v10, s[4:7], s54 offen sc1
    s_mov_b64 exec, -1
    v_add_u32 v38, 0, v0
    v_mul_u32_u24 v39, 10923, v38
    v_lshrrev_b32 v39, 16, v39
    v_mul_u32_u24 v20, 6, v39
    v_sub_u32 v20, v38, v20
    v_lshrrev_b32 v20, 0, v20
    v_lshlrev_b32 v20, 4, v20
    v_mul_u32_u24 v39, 12288, v39
    v_add_u32 v20, v20, v39
    v_add_u32 v38, 64, v0
    v_mul_u32_u24 v39, 10923, v38
    v_lshrrev_b32 v39, 16, v39
    v_mul_u32_u24 v21, 6, v39
    v_sub_u32 v21, v38, v21
    v_lshrrev_b32 v21, 0, v21
    v_lshlrev_b32 v21, 4, v21
    v_mul_u32_u24 v39, 12288, v39
    v_add_u32 v21, v21, v39
    v_add_u32 v38, 128, v0
    v_mul_u32_u24 v39, 10923, v38
    v_lshrrev_b32 v39, 16, v39
    v_mul_u32_u24 v22, 6, v39
    v_sub_u32 v22, v38, v22
    v_lshrrev_b32 v22, 0, v22
    v_lshlrev_b32 v22, 4, v22
    v_mul_u32_u24 v39, 12288, v39
    v_add_u32 v22, v22, v39
    v_add_u32 v38, 0, v0
    v_mul_u32_u24 v39, 16385, v38
    v_lshrrev_b32 v39, 16, v39
    v_mul_u32_u24 v23, 4, v39
    v_sub_u32 v23, v38, v23
    v_lshrrev_b32 v23, 0, v23
    v_lshlrev_b32 v23, 4, v23
    v_mul_u32_u24 v39, 12288, v39
    v_add_u32 v23, v23, v39
    v_add_u32 v38, 64, v0
    v_mul_u32_u24 v39, 16385, v38
    v_lshrrev_b32 v39, 16, v39
    v_mul_u32_u24 v24, 4, v39
    v_sub_u32 v24, v38, v24
    v_lshrrev_b32 v24, 0, v24
    v_lshlrev_b32 v24, 4, v24
    v_mul_u32_u24 v39, 12288, v39
    v_add_u32 v24, v24, v39
    v_add_u32 v38, 0, v0
    v_mul_u32_u24 v39, 3277, v38
    v_lshrrev_b32 v39, 16, v39
    v_mul_u32_u24 v25, 20, v39
    v_sub_u32 v25, v38, v25
    v_lshrrev_b32 v25, 0, v25
    v_lshlrev_b32 v25, 4, v25
    v_mul_u32_u24 v39, 1280, v39
    v_add_u32 v25, v25, v39
    v_add_u32 v38, 64, v0
    v_mul_u32_u24 v39, 3277, v38
    v_lshrrev_b32 v39, 16, v39
    v_mul_u32_u24 v26, 20, v39
    v_sub_u32 v26, v38, v26
    v_lshrrev_b32 v26, 0, v26
    v_lshlrev_b32 v26, 4, v26
    v_mul_u32_u24 v39, 1280, v39
    v_add_u32 v26, v26, v39
    v_add_u32 v38, 128, v0
    v_mul_u32_u24 v39, 3277, v38
    v_lshrrev_b32 v39, 16, v39
    v_mul_u32_u24 v27, 20, v39
    v_sub_u32 v27, v38, v27
    v_lshrrev_b32 v27, 0, v27
    v_lshlrev_b32 v27, 4, v27
    v_mul_u32_u24 v39, 1280, v39
    v_add_u32 v27, v27, v39
    v_add_u32 v38, 192, v0
    v_mul_u32_u24 v39, 3277, v38
    v_lshrrev_b32 v39, 16, v39
    v_mul_u32_u24 v28, 20, v39
    v_sub_u32 v28, v38, v28
    v_lshrrev_b32 v28, 0, v28
    v_lshlrev_b32 v28, 4, v28
    v_mul_u32_u24 v39, 1280, v39
    v_add_u32 v28, v28, v39
    v_add_u32 v38, 256, v0
    v_mul_u32_u24 v39, 3277, v38
    v_lshrrev_b32 v39, 16, v39
    v_mul_u32_u24 v29, 20, v39
    v_sub_u32 v29, v38, v29
    v_lshrrev_b32 v29, 0, v29
    v_lshlrev_b32 v29, 4, v29
    v_mul_u32_u24 v39, 1280, v39
    v_add_u32 v29, v29, v39
    v_add_u32 v38, 320, v0
    v_mul_u32_u24 v39, 3277, v38
    v_lshrrev_b32 v39, 16, v39
    v_mul_u32_u24 v30, 20, v39
    v_sub_u32 v30, v38, v30
    v_lshrrev_b32 v30, 0, v30
    v_lshlrev_b32 v30, 4, v30
    v_mul_u32_u24 v39, 1280, v39
    v_add_u32 v30, v30, v39
    v_add_u32 v38, 384, v0
    v_mul_u32_u24 v39, 3277, v38
    v_lshrrev_b32 v39, 16, v39
    v_mul_u32_u24 v31, 20, v39
    v_sub_u32 v31, v38, v31
    v_lshrrev_b32 v31, 0, v31
    v_lshlrev_b32 v31, 4, v31
    v_mul_u32_u24 v39, 1280, v39
    v_add_u32 v31, v31, v39
    v_add_u32 v38, 448, v0
    v_mul_u32_u24 v39, 3277, v38
    v_lshrrev_b32 v39, 16, v39
    v_mul_u32_u24 v32, 20, v39
    v_sub_u32 v32, v38, v32
    v_lshrrev_b32 v32, 0, v32
    v_lshlrev_b32 v32, 4, v32
    v_mul_u32_u24 v39, 1280, v39
    v_add_u32 v32, v32, v39
    v_add_u32 v38, 512, v0
    v_mul_u32_u24 v39, 3277, v38
    v_lshrrev_b32 v39, 16, v39
    v_mul_u32_u24 v33, 20, v39
    v_sub_u32 v33, v38, v33
    v_lshrrev_b32 v33, 0, v33
    v_lshlrev_b32 v33, 4, v33
    v_mul_u32_u24 v39, 1280, v39
    v_add_u32 v33, v33, v39
    v_add_u32 v38, 576, v0
    v_mul_u32_u24 v39, 3277, v38
    v_lshrrev_b32 v39, 16, v39
    v_mul_u32_u24 v34, 20, v39
    v_sub_u32 v34, v38, v34
    v_lshrrev_b32 v34, 0, v34
    v_lshlrev_b32 v34, 4, v34
    v_mul_u32_u24 v39, 1280, v39
    v_add_u32 v34, v34, v39
    v_lshrrev_b32 v35, 2, v0
    v_mul_u32_u24 v35, 96, v35
    v_and_b32 v38, 3, v0
    v_lshl_add_u32 v35, v38, 3, v35
    v_add_u32 v35, s62, v35
    v_lshrrev_b32 v36, 2, v0
    v_mul_u32_u24 v36, 64, v36
    v_and_b32 v38, 3, v0
    v_lshl_add_u32 v36, v38, 3, v36
    v_add_u32 v36, s62, v36
    v_lshrrev_b32 v37, 2, v0
    v_mul_u32_u24 v37, 320, v37
    v_and_b32 v38, 3, v0
    v_lshl_add_u32 v37, v38, 3, v37
    v_add_u32 v37, s62, v37
    v_add_u32 v2, 71680, v10
    s_mov_b32 s8, s68
    s_and_b32 s9, s69, 0xffff
    s_mov_b32 s10, 7864320
    s_mov_b32 s11, 0x20000
    s_mov_b32 s28, s72
    s_and_b32 s29, s73, 0xffff
    s_mov_b32 s30, 7864320
    s_mov_b32 s31, 0x20000
    s_mov_b32 s32, s74
    s_and_b32 s33, s75, 0xffff
    s_mov_b32 s34, 7864320
    s_mov_b32 s35, 0x20000
    s_mul_i32 s60, s13, 192
    s_add_u32 s25, s60, 0
    s_add_u32 s26, s60, 0
    s_mul_i32 s27, s13, 122880
    s_add_u32 s27, s27, 0
    s_add_u32 m0, s62, 0
    s_nop 0
    buffer_load_dwordx4 v20, s[8:11], s25 offen lds
    s_add_u32 m0, s62, 1024
    s_nop 0
    buffer_load_dwordx4 v21, s[8:11], s25 offen lds
    s_add_u32 m0, s62, 2048
    s_nop 0
    buffer_load_dwordx4 v22, s[8:11], s25 offen lds
    s_add_u32 s25, s25, 393216
    s_add_u32 m0, s62, 3072
    s_nop 0
    buffer_load_dwordx4 v20, s[8:11], s25 offen lds
    s_add_u32 m0, s62, 4096
    s_nop 0
    buffer_load_dwordx4 v21, s[8:11], s25 offen lds
    s_add_u32 m0, s62, 5120
    s_nop 0
    buffer_load_dwordx4 v22, s[8:11], s25 offen lds
    s_add_u32 s25, s25, 393216
    s_add_u32 m0, s62, 6144
    s_nop 0
    buffer_load_dwordx4 v20, s[8:11], s25 offen lds
    s_add_u32 m0, s62, 7168
    s_nop 0
    buffer_load_dwordx4 v21, s[8:11], s25 offen lds
    s_add_u32 m0, s62, 8192
    s_nop 0
    buffer_load_dwordx4 v22, s[8:11], s25 offen lds
    s_add_u32 s25, s25, 393216
    s_add_u32 m0, s62, 9216
    s_nop 0
    buffer_load_dwordx4 v20, s[8:11], s25 offen lds
    s_add_u32 m0, s62, 10240
    s_nop 0
    buffer_load_dwordx4 v21, s[8:11], s25 offen lds
    s_add_u32 m0, s62, 11264
    s_nop 0
    buffer_load_dwordx4 v22, s[8:11], s25 offen lds
    s_add_u32 s25, s25, 393216
    s_add_u32 m0, s62, 12288
    s_nop 0
    buffer_load_dwordx4 v20, s[8:11], s25 offen lds
    s_add_u32 m0, s62, 13312
    s_nop 0
    buffer_load_dwordx4 v21, s[8:11], s25 offen lds
    s_add_u32 m0, s62, 14336
    s_nop 0
    buffer_load_dwordx4 v22, s[8:11], s25 offen lds
    s_waitcnt vmcnt(12)
    s_barrier
    s_cmp_lg_u32 s12, 0
    s_cbranch_scc1 L_R0_arr_1
    s_lshl_b32 s3, s18, 2
    s_add_u32 s3, s3, 64
    v_mov_b32 v92, s3
    v_mov_b32 v93, 1
    s_mov_b64 exec, 1
    global_atomic_add v92, v93, s[16:17] sc1
    s_waitcnt vmcnt(0)
    s_mov_b64 exec, -1
L_R0_arr_1:
    ds_read_b64_tr_b16 a[0:1], v35 offset:0
    ds_read_b64_tr_b16 a[2:3], v35 offset:1536
    ds_read_b64_tr_b16 a[80:81], v35 offset:32
    ds_read_b64_tr_b16 a[82:83], v35 offset:1568
    ds_read_b64_tr_b16 a[160:161], v35 offset:64
    ds_read_b64_tr_b16 a[162:163], v35 offset:1600
    s_waitcnt lgkmcnt(0)
    s_add_u32 s25, s25, 393216
    s_add_u32 m0, s62, 0
    s_nop 0
    buffer_load_dwordx4 v20, s[8:11], s25 offen lds
    s_add_u32 m0, s62, 1024
    s_nop 0
    buffer_load_dwordx4 v21, s[8:11], s25 offen lds
    s_add_u32 m0, s62, 2048
    s_nop 0
    buffer_load_dwordx4 v22, s[8:11], s25 offen lds
    s_waitcnt vmcnt(12)
    ds_read_b64_tr_b16 a[4:5], v35 offset:3072
    ds_read_b64_tr_b16 a[6:7], v35 offset:4608
    ds_read_b64_tr_b16 a[84:85], v35 offset:3104
    ds_read_b64_tr_b16 a[86:87], v35 offset:4640
    ds_read_b64_tr_b16 a[164:165], v35 offset:3136
    ds_read_b64_tr_b16 a[166:167], v35 offset:4672
    s_waitcnt lgkmcnt(0)
    s_add_u32 s25, s25, 393216
    s_add_u32 m0, s62, 3072
    s_nop 0
    buffer_load_dwordx4 v20, s[8:11], s25 offen lds
    s_add_u32 m0, s62, 4096
    s_nop 0
    buffer_load_dwordx4 v21, s[8:11], s25 offen lds
    s_add_u32 m0, s62, 5120
    s_nop 0
    buffer_load_dwordx4 v22, s[8:11], s25 offen lds
    s_waitcnt vmcnt(12)
    ds_read_b64_tr_b16 a[8:9], v35 offset:6144
    ds_read_b64_tr_b16 a[10:11], v35 offset:7680
    ds_read_b64_tr_b16 a[88:89], v35 offset:6176
    ds_read_b64_tr_b16 a[90:91], v35 offset:7712
    ds_read_b64_tr_b16 a[168:169], v35 offset:6208
    ds_read_b64_tr_b16 a[170:171], v35 offset:7744
    s_waitcnt lgkmcnt(0)
    s_add_u32 s25, s25, 393216
    s_add_u32 m0, s62, 6144
    s_nop 0
    buffer_load_dwordx4 v20, s[8:11], s25 offen lds
    s_add_u32 m0, s62, 7168
    s_nop 0
    buffer_load_dwordx4 v21, s[8:11], s25 offen lds
    s_add_u32 m0, s62, 8192
    s_nop 0
    buffer_load_dwordx4 v22, s[8:11], s25 offen lds
    s_waitcnt vmcnt(12)
    ds_read_b64_tr_b16 a[12:13], v35 offset:9216
    ds_read_b64_tr_b16 a[14:15], v35 offset:10752
    ds_read_b64_tr_b16 a[92:93], v35 offset:9248
    ds_read_b64_tr_b16 a[94:95], v35 offset:10784
    ds_read_b64_tr_b16 a[172:173], v35 offset:9280
    ds_read_b64_tr_b16 a[174:175], v35 offset:10816
    s_waitcnt lgkmcnt(0)
    s_add_u32 s25, s25, 393216
    s_add_u32 m0, s62, 9216
    s_nop 0
    buffer_load_dwordx4 v20, s[8:11], s25 offen lds
    s_add_u32 m0, s62, 10240
    s_nop 0
    buffer_load_dwordx4 v21, s[8:11], s25 offen lds
    s_add_u32 m0, s62, 11264
    s_nop 0
    buffer_load_dwordx4 v22, s[8:11], s25 offen lds
    s_waitcnt vmcnt(12)
    ds_read_b64_tr_b16 a[16:17], v35 offset:12288
    ds_read_b64_tr_b16 a[18:19], v35 offset:13824
    ds_read_b64_tr_b16 a[96:97], v35 offset:12320
    ds_read_b64_tr_b16 a[98:99], v35 offset:13856
    ds_read_b64_tr_b16 a[176:177], v35 offset:12352
    ds_read_b64_tr_b16 a[178:179], v35 offset:13888
    s_waitcnt lgkmcnt(0)
    s_add_u32 s25, s25, 393216
    s_add_u32 m0, s62, 12288
    s_nop 0
    buffer_load_dwordx4 v20, s[8:11], s25 offen lds
    s_add_u32 m0, s62, 13312
    s_nop 0
    buffer_load_dwordx4 v21, s[8:11], s25 offen lds
    s_add_u32 m0, s62, 14336
    s_nop 0
    buffer_load_dwordx4 v22, s[8:11], s25 offen lds
    s_waitcnt vmcnt(12)
    ds_read_b64_tr_b16 a[20:21], v35 offset:0
    ds_read_b64_tr_b16 a[22:23], v35 offset:1536
    ds_read_b64_tr_b16 a[100:101], v35 offset:32
    ds_read_b64_tr_b16 a[102:103], v35 offset:1568
    ds_read_b64_tr_b16 a[180:181], v35 offset:64
    ds_read_b64_tr_b16 a[182:183], v35 offset:1600
    s_waitcnt lgkmcnt(0)
    s_add_u32 s25, s25, 393216
    s_add_u32 m0, s62, 0
    s_nop 0
    buffer_load_dwordx4 v20, s[8:11], s25 offen lds
    s_add_u32 m0, s62, 1024
    s_nop 0
    buffer_load_dwordx4 v21, s[8:11], s25 offen lds
    s_add_u32 m0, s62, 2048
    s_nop 0
    buffer_load_dwordx4 v22, s[8:11], s25 offen lds
    s_waitcnt vmcnt(12)
    ds_read_b64_tr_b16 a[24:25], v35 offset:3072
    ds_read_b64_tr_b16 a[26:27], v35 offset:4608
    ds_read_b64_tr_b16 a[104:105], v35 offset:3104
    ds_read_b64_tr_b16 a[106:107], v35 offset:4640
    ds_read_b64_tr_b16 a[184:185], v35 offset:3136
    ds_read_b64_tr_b16 a[186:187], v35 offset:4672
    s_waitcnt lgkmcnt(0)
    s_add_u32 s25, s25, 393216
    s_add_u32 m0, s62, 3072
    s_nop 0
    buffer_load_dwordx4 v20, s[8:11], s25 offen lds
    s_add_u32 m0, s62, 4096
    s_nop 0
    buffer_load_dwordx4 v21, s[8:11], s25 offen lds
    s_add_u32 m0, s62, 5120
    s_nop 0
    buffer_load_dwordx4 v22, s[8:11], s25 offen lds
    s_waitcnt vmcnt(12)
    ds_read_b64_tr_b16 a[28:29], v35 offset:6144
    ds_read_b64_tr_b16 a[30:31], v35 offset:7680
    ds_read_b64_tr_b16 a[108:109], v35 offset:6176
    ds_read_b64_tr_b16 a[110:111], v35 offset:7712
    ds_read_b64_tr_b16 a[188:189], v35 offset:6208
    ds_read_b64_tr_b16 a[190:191], v35 offset:7744
    s_waitcnt lgkmcnt(0)
    s_add_u32 s25, s25, 393216
    s_add_u32 m0, s62, 6144
    s_nop 0
    buffer_load_dwordx4 v20, s[8:11], s25 offen lds
    s_add_u32 m0, s62, 7168
    s_nop 0
    buffer_load_dwordx4 v21, s[8:11], s25 offen lds
    s_add_u32 m0, s62, 8192
    s_nop 0
    buffer_load_dwordx4 v22, s[8:11], s25 offen lds
    s_waitcnt vmcnt(12)
    ds_read_b64_tr_b16 a[32:33], v35 offset:9216
    ds_read_b64_tr_b16 a[34:35], v35 offset:10752
    ds_read_b64_tr_b16 a[112:113], v35 offset:9248
    ds_read_b64_tr_b16 a[114:115], v35 offset:10784
    ds_read_b64_tr_b16 a[192:193], v35 offset:9280
    ds_read_b64_tr_b16 a[194:195], v35 offset:10816
    s_waitcnt lgkmcnt(0)
    s_add_u32 s25, s25, 393216
    s_add_u32 m0, s62, 9216
    s_nop 0
    buffer_load_dwordx4 v20, s[8:11], s25 offen lds
    s_add_u32 m0, s62, 10240
    s_nop 0
    buffer_load_dwordx4 v21, s[8:11], s25 offen lds
    s_add_u32 m0, s62, 11264
    s_nop 0
    buffer_load_dwordx4 v22, s[8:11], s25 offen lds
    s_waitcnt vmcnt(12)
    ds_read_b64_tr_b16 a[36:37], v35 offset:12288
    ds_read_b64_tr_b16 a[38:39], v35 offset:13824
    ds_read_b64_tr_b16 a[116:117], v35 offset:12320
    ds_read_b64_tr_b16 a[118:119], v35 offset:13856
    ds_read_b64_tr_b16 a[196:197], v35 offset:12352
    ds_read_b64_tr_b16 a[198:199], v35 offset:13888
    s_waitcnt lgkmcnt(0)
    s_add_u32 s25, s25, 393216
    s_add_u32 m0, s62, 12288
    s_nop 0
    buffer_load_dwordx4 v20, s[8:11], s25 offen lds
    s_add_u32 m0, s62, 13312
    s_nop 0
    buffer_load_dwordx4 v21, s[8:11], s25 offen lds
    s_add_u32 m0, s62, 14336
    s_nop 0
    buffer_load_dwordx4 v22, s[8:11], s25 offen lds
    s_waitcnt vmcnt(12)
    ds_read_b64_tr_b16 a[40:41], v35 offset:0
    ds_read_b64_tr_b16 a[42:43], v35 offset:1536
    ds_read_b64_tr_b16 a[120:121], v35 offset:32
    ds_read_b64_tr_b16 a[122:123], v35 offset:1568
    ds_read_b64_tr_b16 a[200:201], v35 offset:64
    ds_read_b64_tr_b16 a[202:203], v35 offset:1600
    s_waitcnt lgkmcnt(0)
    s_add_u32 s25, s25, 393216
    s_add_u32 m0, s62, 0
    s_nop 0
    buffer_load_dwordx4 v20, s[8:11], s25 offen lds
    s_add_u32 m0, s62, 1024
    s_nop 0
    buffer_load_dwordx4 v21, s[8:11], s25 offen lds
    s_add_u32 m0, s62, 2048
    s_nop 0
    buffer_load_dwordx4 v22, s[8:11], s25 offen lds
    s_waitcnt vmcnt(12)
    ds_read_b64_tr_b16 a[44:45], v35 offset:3072
    ds_read_b64_tr_b16 a[46:47], v35 offset:4608
    ds_read_b64_tr_b16 a[124:125], v35 offset:3104
    ds_read_b64_tr_b16 a[126:127], v35 offset:4640
    ds_read_b64_tr_b16 a[204:205], v35 offset:3136
    ds_read_b64_tr_b16 a[206:207], v35 offset:4672
    s_waitcnt lgkmcnt(0)
    s_add_u32 s25, s25, 393216
    s_add_u32 m0, s62, 3072
    s_nop 0
    buffer_load_dwordx4 v20, s[8:11], s25 offen lds
    s_add_u32 m0, s62, 4096
    s_nop 0
    buffer_load_dwordx4 v21, s[8:11], s25 offen lds
    s_add_u32 m0, s62, 5120
    s_nop 0
    buffer_load_dwordx4 v22, s[8:11], s25 offen lds
    s_waitcnt vmcnt(12)
    ds_read_b64_tr_b16 a[48:49], v35 offset:6144
    ds_read_b64_tr_b16 a[50:51], v35 offset:7680
    ds_read_b64_tr_b16 a[128:129], v35 offset:6176
    ds_read_b64_tr_b16 a[130:131], v35 offset:7712
    ds_read_b64_tr_b16 a[208:209], v35 offset:6208
    ds_read_b64_tr_b16 a[210:211], v35 offset:7744
    s_waitcnt lgkmcnt(0)
    s_add_u32 s25, s25, 393216
    s_add_u32 m0, s62, 6144
    s_nop 0
    buffer_load_dwordx4 v20, s[8:11], s25 offen lds
    s_add_u32 m0, s62, 7168
    s_nop 0
    buffer_load_dwordx4 v21, s[8:11], s25 offen lds
    s_add_u32 m0, s62, 8192
    s_nop 0
    buffer_load_dwordx4 v22, s[8:11], s25 offen lds
    s_waitcnt vmcnt(12)
    ds_read_b64_tr_b16 a[52:53], v35 offset:9216
    ds_read_b64_tr_b16 a[54:55], v35 offset:10752
    ds_read_b64_tr_b16 a[132:133], v35 offset:9248
    ds_read_b64_tr_b16 a[134:135], v35 offset:10784
    ds_read_b64_tr_b16 a[212:213], v35 offset:9280
    ds_read_b64_tr_b16 a[214:215], v35 offset:10816
    s_waitcnt lgkmcnt(0)
    s_add_u32 s25, s25, 393216
    s_add_u32 m0, s62, 9216
    s_nop 0
    buffer_load_dwordx4 v20, s[8:11], s25 offen lds
    s_add_u32 m0, s62, 10240
    s_nop 0
    buffer_load_dwordx4 v21, s[8:11], s25 offen lds
    s_add_u32 m0, s62, 11264
    s_nop 0
    buffer_load_dwordx4 v22, s[8:11], s25 offen lds
    s_waitcnt vmcnt(12)
    ds_read_b64_tr_b16 a[56:57], v35 offset:12288
    ds_read_b64_tr_b16 a[58:59], v35 offset:13824
    ds_read_b64_tr_b16 a[136:137], v35 offset:12320
    ds_read_b64_tr_b16 a[138:139], v35 offset:13856
    ds_read_b64_tr_b16 a[216:217], v35 offset:12352
    ds_read_b64_tr_b16 a[218:219], v35 offset:13888
    s_waitcnt lgkmcnt(0)
    s_add_u32 s25, s25, 393216
    s_add_u32 m0, s62, 12288
    s_nop 0
    buffer_load_dwordx4 v20, s[8:11], s25 offen lds
    s_add_u32 m0, s62, 13312
    s_nop 0
    buffer_load_dwordx4 v21, s[8:11], s25 offen lds
    s_add_u32 m0, s62, 14336
    s_nop 0
    buffer_load_dwordx4 v22, s[8:11], s25 offen lds
    s_add_u32 m0, s62, 15360
    s_nop 0
    buffer_load_dwordx4 v23, s[28:31], s26 offen lds
    s_add_u32 m0, s62, 16384
    s_nop 0
    buffer_load_dwordx4 v24, s[28:31], s26 offen lds
    s_waitcnt vmcnt(14)
    ds_read_b64_tr_b16 a[60:61], v35 offset:0
    ds_read_b64_tr_b16 a[62:63], v35 offset:1536
    ds_read_b64_tr_b16 a[140:141], v35 offset:32
    ds_read_b64_tr_b16 a[142:143], v35 offset:1568
    ds_read_b64_tr_b16 a[220:221], v35 offset:64
    ds_read_b64_tr_b16 a[222:223], v35 offset:1600
    s_waitcnt lgkmcnt(0)
    s_add_u32 s26, s26, 393216
    s_add_u32 m0, s62, 0
    s_nop 0
    buffer_load_dwordx4 v23, s[28:31], s26 offen lds
    s_add_u32 m0, s62, 1024
    s_nop 0
    buffer_load_dwordx4 v24, s[28:31], s26 offen lds
    s_waitcnt vmcnt(13)
    ds_read_b64_tr_b16 a[64:65], v35 offset:3072
    ds_read_b64_tr_b16 a[66:67], v35 offset:4608
    ds_read_b64_tr_b16 a[144:145], v35 offset:3104
    ds_read_b64_tr_b16 a[146:147], v35 offset:4640
    ds_read_b64_tr_b16 a[224:225], v35 offset:3136
    ds_read_b64_tr_b16 a[226:227], v35 offset:4672
    s_waitcnt lgkmcnt(0)
    s_add_u32 s26, s26, 393216
    s_add_u32 m0, s62, 2048
    s_nop 0
    buffer_load_dwordx4 v23, s[28:31], s26 offen lds
    s_add_u32 m0, s62, 3072
    s_nop 0
    buffer_load_dwordx4 v24, s[28:31], s26 offen lds
    s_add_u32 s26, s26, 393216
    s_add_u32 m0, s62, 4096
    s_nop 0
    buffer_load_dwordx4 v23, s[28:31], s26 offen lds
    s_add_u32 m0, s62, 5120
    s_nop 0
    buffer_load_dwordx4 v24, s[28:31], s26 offen lds
    s_waitcnt vmcnt(14)
    ds_read_b64_tr_b16 a[68:69], v35 offset:6144
    ds_read_b64_tr_b16 a[70:71], v35 offset:7680
    ds_read_b64_tr_b16 a[148:149], v35 offset:6176
    ds_read_b64_tr_b16 a[150:151], v35 offset:7712
    ds_read_b64_tr_b16 a[228:229], v35 offset:6208
    ds_read_b64_tr_b16 a[230:231], v35 offset:7744
    s_waitcnt lgkmcnt(0)
    s_add_u32 s26, s26, 393216
    s_add_u32 m0, s62, 6144
    s_nop 0
    buffer_load_dwordx4 v23, s[28:31], s26 offen lds
    s_add_u32 m0, s62, 7168
    s_nop 0
    buffer_load_dwordx4 v24, s[28:31], s26 offen lds
    s_waitcnt vmcnt(13)
    ds_read_b64_tr_b16 a[72:73], v35 offset:9216
    ds_read_b64_tr_b16 a[74:75], v35 offset:10752
    ds_read_b64_tr_b16 a[152:153], v35 offset:9248
    ds_read_b64_tr_b16 a[154:155], v35 offset:10784
    ds_read_b64_tr_b16 a[232:233], v35 offset:9280
    ds_read_b64_tr_b16 a[234:235], v35 offset:10816
    s_waitcnt lgkmcnt(0)
    s_add_u32 s26, s26, 393216
    s_add_u32 m0, s62, 8192
    s_nop 0
    buffer_load_dwordx4 v23, s[28:31], s26 offen lds
    s_add_u32 m0, s62, 9216
    s_nop 0
    buffer_load_dwordx4 v24, s[28:31], s26 offen lds
    s_add_u32 s26, s26, 393216
    s_add_u32 m0, s62, 10240
    s_nop 0
    buffer_load_dwordx4 v23, s[28:31], s26 offen lds
    s_add_u32 m0, s62, 11264
    s_nop 0
    buffer_load_dwordx4 v24, s[28:31], s26 offen lds
    s_waitcnt vmcnt(14)
    ds_read_b64_tr_b16 a[76:77], v35 offset:12288
    ds_read_b64_tr_b16 a[78:79], v35 offset:13824
    ds_read_b64_tr_b16 a[156:157], v35 offset:12320
    ds_read_b64_tr_b16 a[158:159], v35 offset:13856
    ds_read_b64_tr_b16 a[236:237], v35 offset:12352
    ds_read_b64_tr_b16 a[238:239], v35 offset:13888
    s_waitcnt lgkmcnt(0)
    s_add_u32 s26, s26, 393216
    s_add_u32 m0, s62, 12288
    s_nop 0
    buffer_load_dwordx4 v23, s[28:31], s26 offen lds
    s_add_u32 m0, s62, 13312
    s_nop 0
    buffer_load_dwordx4 v24, s[28:31], s26 offen lds
    s_waitcnt vmcnt(14)
    ds_read_b64_tr_b16 v[96:97], v36 offset:15360
    ds_read_b64_tr_b16 v[98:99], v36 offset:16384
    ds_read_b64_tr_b16 v[176:177], v36 offset:15392
    ds_read_b64_tr_b16 v[178:179], v36 offset:16416
    s_waitcnt lgkmcnt(0)
    s_add_u32 s26, s26, 393216
    s_add_u32 m0, s62, 14336
    s_nop 0
    buffer_load_dwordx4 v23, s[28:31], s26 offen lds
    s_add_u32 m0, s62, 15360
    s_nop 0
    buffer_load_dwordx4 v24, s[28:31], s26 offen lds
    s_waitcnt vmcnt(14)
    ds_read_b64_tr_b16 v[100:101], v36 offset:0
    ds_read_b64_tr_b16 v[102:103], v36 offset:1024
    ds_read_b64_tr_b16 v[180:181], v36 offset:32
    ds_read_b64_tr_b16 v[182:183], v36 offset:1056
    s_waitcnt lgkmcnt(0)
    s_add_u32 s26, s26, 393216
    s_add_u32 m0, s62, 0
    s_nop 0
    buffer_load_dwordx4 v23, s[28:31], s26 offen lds
    s_add_u32 m0, s62, 1024
    s_nop 0
    buffer_load_dwordx4 v24, s[28:31], s26 offen lds
    s_waitcnt vmcnt(14)
    ds_read_b64_tr_b16 v[104:105], v36 offset:2048
    ds_read_b64_tr_b16 v[106:107], v36 offset:3072
    ds_read_b64_tr_b16 v[184:185], v36 offset:2080
    ds_read_b64_tr_b16 v[186:187], v36 offset:3104
    s_waitcnt lgkmcnt(0)
    s_add_u32 s26, s26, 393216
    s_add_u32 m0, s62, 2048
    s_nop 0
    buffer_load_dwordx4 v23, s[28:31], s26 offen lds
    s_add_u32 m0, s62, 3072
    s_nop 0
    buffer_load_dwordx4 v24, s[28:31], s26 offen lds
    s_waitcnt vmcnt(14)
    ds_read_b64_tr_b16 v[108:109], v36 offset:4096
    ds_read_b64_tr_b16 v[110:111], v36 offset:5120
    ds_read_b64_tr_b16 v[188:189], v36 offset:4128
    ds_read_b64_tr_b16 v[190:191], v36 offset:5152
    s_waitcnt lgkmcnt(0)
    s_add_u32 s26, s26, 393216
    s_add_u32 m0, s62, 4096
    s_nop 0
    buffer_load_dwordx4 v23, s[28:31], s26 offen lds
    s_add_u32 m0, s62, 5120
    s_nop 0
    buffer_load_dwordx4 v24, s[28:31], s26 offen lds
    s_waitcnt vmcnt(14)
    ds_read_b64_tr_b16 v[112:113], v36 offset:6144
    ds_read_b64_tr_b16 v[114:115], v36 offset:7168
    ds_read_b64_tr_b16 v[192:193], v36 offset:6176
    ds_read_b64_tr_b16 v[194:195], v36 offset:7200
    s_waitcnt lgkmcnt(0)
    s_add_u32 s26, s26, 393216
    s_add_u32 m0, s62, 6144
    s_nop 0
    buffer_load_dwordx4 v23, s[28:31], s26 offen lds
    s_add_u32 m0, s62, 7168
    s_nop 0
    buffer_load_dwordx4 v24, s[28:31], s26 offen lds
    s_waitcnt vmcnt(14)
    ds_read_b64_tr_b16 v[116:117], v36 offset:8192
    ds_read_b64_tr_b16 v[118:119], v36 offset:9216
    ds_read_b64_tr_b16 v[196:197], v36 offset:8224
    ds_read_b64_tr_b16 v[198:199], v36 offset:9248
    s_waitcnt lgkmcnt(0)
    s_add_u32 s26, s26, 393216
    s_add_u32 m0, s62, 8192
    s_nop 0
    buffer_load_dwordx4 v23, s[28:31], s26 offen lds
    s_add_u32 m0, s62, 9216
    s_nop 0
    buffer_load_dwordx4 v24, s[28:31], s26 offen lds
    s_waitcnt vmcnt(14)
    ds_read_b64_tr_b16 v[120:121], v36 offset:10240
    ds_read_b64_tr_b16 v[122:123], v36 offset:11264
    ds_read_b64_tr_b16 v[200:201], v36 offset:10272
    ds_read_b64_tr_b16 v[202:203], v36 offset:11296
    s_waitcnt lgkmcnt(0)
    s_add_u32 s26, s26, 393216
    s_add_u32 m0, s62, 10240
    s_nop 0
    buffer_load_dwordx4 v23, s[28:31], s26 offen lds
    s_add_u32 m0, s62, 11264
    s_nop 0
    buffer_load_dwordx4 v24, s[28:31], s26 offen lds
    s_waitcnt vmcnt(14)
    ds_read_b64_tr_b16 v[124:125], v36 offset:12288
    ds_read_b64_tr_b16 v[126:127], v36 offset:13312
    ds_read_b64_tr_b16 v[204:205], v36 offset:12320
    ds_read_b64_tr_b16 v[206:207], v36 offset:13344
    s_waitcnt lgkmcnt(0)
    s_add_u32 s26, s26, 393216
    s_add_u32 m0, s62, 12288
    s_nop 0
    buffer_load_dwordx4 v23, s[28:31], s26 offen lds
    s_add_u32 m0, s62, 13312
    s_nop 0
    buffer_load_dwordx4 v24, s[28:31], s26 offen lds
    s_waitcnt vmcnt(14)
    ds_read_b64_tr_b16 v[128:129], v36 offset:14336
    ds_read_b64_tr_b16 v[130:131], v36 offset:15360
    ds_read_b64_tr_b16 v[208:209], v36 offset:14368
    ds_read_b64_tr_b16 v[210:211], v36 offset:15392
    s_waitcnt lgkmcnt(0)
    s_add_u32 s26, s26, 393216
    s_add_u32 m0, s62, 14336
    s_nop 0
    buffer_load_dwordx4 v23, s[28:31], s26 offen lds
    s_add_u32 m0, s62, 15360
    s_nop 0
    buffer_load_dwordx4 v24, s[28:31], s26 offen lds
    s_waitcnt vmcnt(14)
    ds_read_b64_tr_b16 v[132:133], v36 offset:0
    ds_read_b64_tr_b16 v[134:135], v36 offset:1024
    ds_read_b64_tr_b16 v[212:213], v36 offset:32
    ds_read_b64_tr_b16 v[214:215], v36 offset:1056
    s_waitcnt lgkmcnt(0)
    s_add_u32 s26, s26, 393216
    s_add_u32 m0, s62, 0
    s_nop 0
    buffer_load_dwordx4 v23, s[28:31], s26 offen lds
    s_add_u32 m0, s62, 1024
    s_nop 0
    buffer_load_dwordx4 v24, s[28:31], s26 offen lds
    s_waitcnt vmcnt(14)
    ds_read_b64_tr_b16 v[136:137], v36 offset:2048
    ds_read_b64_tr_b16 v[138:139], v36 offset:3072
    ds_read_b64_tr_b16 v[216:217], v36 offset:2080
    ds_read_b64_tr_b16 v[218:219], v36 offset:3104
    s_waitcnt lgkmcnt(0)
    s_add_u32 s26, s26, 393216
    s_add_u32 m0, s62, 2048
    s_nop 0
    buffer_load_dwordx4 v23, s[28:31], s26 offen lds
    s_add_u32 m0, s62, 3072
    s_nop 0
    buffer_load_dwordx4 v24, s[28:31], s26 offen lds
    s_waitcnt vmcnt(14)
    ds_read_b64_tr_b16 v[140:141], v36 offset:4096
    ds_read_b64_tr_b16 v[142:143], v36 offset:5120
    ds_read_b64_tr_b16 v[220:221], v36 offset:4128
    ds_read_b64_tr_b16 v[222:223], v36 offset:5152
    s_waitcnt lgkmcnt(0)
    s_add_u32 s26, s26, 393216
    s_add_u32 m0, s62, 4096
    s_nop 0
    buffer_load_dwordx4 v23, s[28:31], s26 offen lds
    s_add_u32 m0, s62, 5120
    s_nop 0
    buffer_load_dwordx4 v24, s[28:31], s26 offen lds
    s_waitcnt vmcnt(14)
    ds_read_b64_tr_b16 v[144:145], v36 offset:6144
    ds_read_b64_tr_b16 v[146:147], v36 offset:7168
    ds_read_b64_tr_b16 v[224:225], v36 offset:6176
    ds_read_b64_tr_b16 v[226:227], v36 offset:7200
    s_waitcnt lgkmcnt(0)
    s_waitcnt vmcnt(12)
    ds_read_b64_tr_b16 v[148:149], v36 offset:8192
    ds_read_b64_tr_b16 v[150:151], v36 offset:9216
    ds_read_b64_tr_b16 v[228:229], v36 offset:8224
    ds_read_b64_tr_b16 v[230:231], v36 offset:9248
    s_waitcnt lgkmcnt(0)
    s_waitcnt vmcnt(10)
    ds_read_b64_tr_b16 v[152:153], v36 offset:10240
    ds_read_b64_tr_b16 v[154:155], v36 offset:11264
    ds_read_b64_tr_b16 v[232:233], v36 offset:10272
    ds_read_b64_tr_b16 v[234:235], v36 offset:11296
    s_waitcnt lgkmcnt(0)
    s_waitcnt vmcnt(8)
    ds_read_b64_tr_b16 v[156:157], v36 offset:12288
    ds_read_b64_tr_b16 v[158:159], v36 offset:13312
    ds_read_b64_tr_b16 v[236:237], v36 offset:12320
    ds_read_b64_tr_b16 v[238:239], v36 offset:13344
    s_waitcnt lgkmcnt(0)
    s_waitcnt vmcnt(6)
    ds_read_b64_tr_b16 v[160:161], v36 offset:14336
    ds_read_b64_tr_b16 v[162:163], v36 offset:15360
    ds_read_b64_tr_b16 v[240:241], v36 offset:14368
    ds_read_b64_tr_b16 v[242:243], v36 offset:15392
    s_waitcnt lgkmcnt(0)
    s_add_u32 m0, s62, 6144
    s_nop 0
    buffer_load_dwordx4 v25, s[32:35], s27 offen lds
    s_add_u32 m0, s62, 7168
    s_nop 0
    buffer_load_dwordx4 v26, s[32:35], s27 offen lds
    s_add_u32 m0, s62, 8192
    s_nop 0
    buffer_load_dwordx4 v27, s[32:35], s27 offen lds
    s_add_u32 m0, s62, 9216
    s_nop 0
    buffer_load_dwordx4 v28, s[32:35], s27 offen lds
    s_add_u32 m0, s62, 10240
    s_nop 0
    buffer_load_dwordx4 v29, s[32:35], s27 offen lds
    s_add_u32 m0, s62, 11264
    s_nop 0
    buffer_load_dwordx4 v30, s[32:35], s27 offen lds
    s_add_u32 m0, s62, 12288
    s_nop 0
    buffer_load_dwordx4 v31, s[32:35], s27 offen lds
    s_add_u32 m0, s62, 13312
    s_nop 0
    buffer_load_dwordx4 v32, s[32:35], s27 offen lds
    s_add_u32 m0, s62, 14336
    s_nop 0
    buffer_load_dwordx4 v33, s[32:35], s27 offen lds
    s_add_u32 m0, s62, 15360
    s_nop 0
    buffer_load_dwordx4 v34, s[32:35], s27 offen lds
    s_waitcnt vmcnt(14)
    ds_read_b64_tr_b16 v[164:165], v36 offset:0
    ds_read_b64_tr_b16 v[166:167], v36 offset:1024
    ds_read_b64_tr_b16 v[244:245], v36 offset:32
    ds_read_b64_tr_b16 v[246:247], v36 offset:1056
    s_waitcnt lgkmcnt(0)
    s_waitcnt vmcnt(12)
    ds_read_b64_tr_b16 v[168:169], v36 offset:2048
    ds_read_b64_tr_b16 v[170:171], v36 offset:3072
    ds_read_b64_tr_b16 v[248:249], v36 offset:2080
    ds_read_b64_tr_b16 v[250:251], v36 offset:3104
    s_waitcnt lgkmcnt(0)
    s_waitcnt vmcnt(10)
    ds_read_b64_tr_b16 v[172:173], v36 offset:4096
    ds_read_b64_tr_b16 v[174:175], v36 offset:5120
    ds_read_b64_tr_b16 v[252:253], v36 offset:4128
    ds_read_b64_tr_b16 v[254:255], v36 offset:5152
    s_waitcnt lgkmcnt(0)
    s_waitcnt vmcnt(0)
    ds_read_b64_tr_b16 v[40:41], v37 offset:6144
    ds_read_b64_tr_b16 v[42:43], v37 offset:11264
    ds_read_b64_tr_b16 v[44:45], v37 offset:6176
    ds_read_b64_tr_b16 v[46:47], v37 offset:11296
    ds_read_b64_tr_b16 v[48:49], v37 offset:6208
    ds_read_b64_tr_b16 v[50:51], v37 offset:11328
    ds_read_b64_tr_b16 v[52:53], v37 offset:6240
    ds_read_b64_tr_b16 v[54:55], v37 offset:11360
    s_waitcnt lgkmcnt(0)
    ds_write_b128 v2, v[40:43] offset:0
    ds_write_b128 v2, v[44:47] offset:3072
    ds_write_b128 v2, v[48:51] offset:6144
    ds_write_b128 v2, v[52:55] offset:9216
    s_waitcnt lgkmcnt(0)
    ds_read_b64_tr_b16 v[40:41], v37 offset:6272
    ds_read_b64_tr_b16 v[42:43], v37 offset:11392
    ds_read_b64_tr_b16 v[44:45], v37 offset:6304
    ds_read_b64_tr_b16 v[46:47], v37 offset:11424
    ds_read_b64_tr_b16 v[48:49], v37 offset:6336
    ds_read_b64_tr_b16 v[50:51], v37 offset:11456
    ds_read_b64_tr_b16 v[52:53], v37 offset:6368
    ds_read_b64_tr_b16 v[54:55], v37 offset:11488
    s_waitcnt lgkmcnt(0)
    ds_write_b128 v2, v[40:43] offset:12288
    ds_write_b128 v2, v[44:47] offset:15360
    ds_write_b128 v2, v[48:51] offset:18432
    ds_write_b128 v2, v[52:55] offset:21504
    s_waitcnt lgkmcnt(0)
    ds_read_b64_tr_b16 v[40:41], v37 offset:6400
    ds_read_b64_tr_b16 v[42:43], v37 offset:11520
    ds_read_b64_tr_b16 v[44:45], v37 offset:6432
    ds_read_b64_tr_b16 v[46:47], v37 offset:11552
    s_waitcnt lgkmcnt(0)
    ds_write_b128 v2, v[40:43] offset:24576
    ds_write_b128 v2, v[44:47] offset:27648
    s_waitcnt lgkmcnt(0)
    s_add_u32 s27, s27, 40960
    s_add_u32 m0, s62, 0
    s_nop 0
    buffer_load_dwordx4 v25, s[32:35], s27 offen lds
    s_add_u32 m0, s62, 1024
    s_nop 0
    buffer_load_dwordx4 v26, s[32:35], s27 offen lds
    s_add_u32 m0, s62, 2048
    s_nop 0
    buffer_load_dwordx4 v27, s[32:35], s27 offen lds
    s_add_u32 m0, s62, 3072
    s_nop 0
    buffer_load_dwordx4 v28, s[32:35], s27 offen lds
    s_add_u32 m0, s62, 4096
    s_nop 0
    buffer_load_dwordx4 v29, s[32:35], s27 offen lds
    s_add_u32 m0, s62, 5120
    s_nop 0
    buffer_load_dwordx4 v30, s[32:35], s27 offen lds
    s_add_u32 m0, s62, 6144
    s_nop 0
    buffer_load_dwordx4 v31, s[32:35], s27 offen lds
    s_add_u32 m0, s62, 7168
    s_nop 0
    buffer_load_dwordx4 v32, s[32:35], s27 offen lds
    s_add_u32 m0, s62, 8192
    s_nop 0
    buffer_load_dwordx4 v33, s[32:35], s27 offen lds
    s_add_u32 m0, s62, 9216
    s_nop 0
    buffer_load_dwordx4 v34, s[32:35], s27 offen lds
    s_waitcnt vmcnt(0)
    ds_read_b64_tr_b16 v[40:41], v37 offset:0
    ds_read_b64_tr_b16 v[42:43], v37 offset:5120
    ds_read_b64_tr_b16 v[44:45], v37 offset:32
    ds_read_b64_tr_b16 v[46:47], v37 offset:5152
    ds_read_b64_tr_b16 v[48:49], v37 offset:64
    ds_read_b64_tr_b16 v[50:51], v37 offset:5184
    ds_read_b64_tr_b16 v[52:53], v37 offset:96
    ds_read_b64_tr_b16 v[54:55], v37 offset:5216
    s_waitcnt lgkmcnt(0)
    ds_write_b128 v2, v[40:43] offset:1024
    ds_write_b128 v2, v[44:47] offset:4096
    ds_write_b128 v2, v[48:51] offset:7168
    ds_write_b128 v2, v[52:55] offset:10240
    s_waitcnt lgkmcnt(0)
    ds_read_b64_tr_b16 v[40:41], v37 offset:128
    ds_read_b64_tr_b16 v[42:43], v37 offset:5248
    ds_read_b64_tr_b16 v[44:45], v37 offset:160
    ds_read_b64_tr_b16 v[46:47], v37 offset:5280
    ds_read_b64_tr_b16 v[48:49], v37 offset:192
    ds_read_b64_tr_b16 v[50:51], v37 offset:5312
    ds_read_b64_tr_b16 v[52:53], v37 offset:224
    ds_read_b64_tr_b16 v[54:55], v37 offset:5344
    s_waitcnt lgkmcnt(0)
    ds_write_b128 v2, v[40:43] offset:13312
    ds_write_b128 v2, v[44:47] offset:16384
    ds_write_b128 v2, v[48:51] offset:19456
    ds_write_b128 v2, v[52:55] offset:22528
    s_waitcnt lgkmcnt(0)
    ds_read_b64_tr_b16 v[40:41], v37 offset:256
    ds_read_b64_tr_b16 v[42:43], v37 offset:5376
    ds_read_b64_tr_b16 v[44:45], v37 offset:288
    ds_read_b64_tr_b16 v[46:47], v37 offset:5408
    s_waitcnt lgkmcnt(0)
    ds_write_b128 v2, v[40:43] offset:25600
    ds_write_b128 v2, v[44:47] offset:28672
    s_waitcnt lgkmcnt(0)
    s_add_u32 s27, s27, 40960
    s_add_u32 m0, s62, 0
    s_nop 0
    buffer_load_dwordx4 v25, s[32:35], s27 offen lds
    s_add_u32 m0, s62, 1024
    s_nop 0
    buffer_load_dwordx4 v26, s[32:35], s27 offen lds
    s_add_u32 m0, s62, 2048
    s_nop 0
    buffer_load_dwordx4 v27, s[32:35], s27 offen lds
    s_add_u32 m0, s62, 3072
    s_nop 0
    buffer_load_dwordx4 v28, s[32:35], s27 offen lds
    s_add_u32 m0, s62, 4096
    s_nop 0
    buffer_load_dwordx4 v29, s[32:35], s27 offen lds
    s_add_u32 m0, s62, 5120
    s_nop 0
    buffer_load_dwordx4 v30, s[32:35], s27 offen lds
    s_add_u32 m0, s62, 6144
    s_nop 0
    buffer_load_dwordx4 v31, s[32:35], s27 offen lds
    s_add_u32 m0, s62, 7168
    s_nop 0
    buffer_load_dwordx4 v32, s[32:35], s27 offen lds
    s_add_u32 m0, s62, 8192
    s_nop 0
    buffer_load_dwordx4 v33, s[32:35], s27 offen lds
    s_add_u32 m0, s62, 9216
    s_nop 0
    buffer_load_dwordx4 v34, s[32:35], s27 offen lds
    s_waitcnt vmcnt(0)
    ds_read_b64_tr_b16 v[40:41], v37 offset:0
    ds_read_b64_tr_b16 v[42:43], v37 offset:5120
    ds_read_b64_tr_b16 v[44:45], v37 offset:32
    ds_read_b64_tr_b16 v[46:47], v37 offset:5152
    ds_read_b64_tr_b16 v[48:49], v37 offset:64
    ds_read_b64_tr_b16 v[50:51], v37 offset:5184
    ds_read_b64_tr_b16 v[52:53], v37 offset:96
    ds_read_b64_tr_b16 v[54:55], v37 offset:5216
    s_waitcnt lgkmcnt(0)
    ds_write_b128 v2, v[40:43] offset:2048
    ds_write_b128 v2, v[44:47] offset:5120
    ds_write_b128 v2, v[48:51] offset:8192
    ds_write_b128 v2, v[52:55] offset:11264
    s_waitcnt lgkmcnt(0)
    ds_read_b64_tr_b16 v[40:41], v37 offset:128
    ds_read_b64_tr_b16 v[42:43], v37 offset:5248
    ds_read_b64_tr_b16 v[44:45], v37 offset:160
    ds_read_b64_tr_b16 v[46:47], v37 offset:5280
    ds_read_b64_tr_b16 v[48:49], v37 offset:192
    ds_read_b64_tr_b16 v[50:51], v37 offset:5312
    ds_read_b64_tr_b16 v[52:53], v37 offset:224
    ds_read_b64_tr_b16 v[54:55], v37 offset:5344
    s_waitcnt lgkmcnt(0)
    ds_write_b128 v2, v[40:43] offset:14336
    ds_write_b128 v2, v[44:47] offset:17408
    ds_write_b128 v2, v[48:51] offset:20480
    ds_write_b128 v2, v[52:55] offset:23552
    s_waitcnt lgkmcnt(0)
    ds_read_b64_tr_b16 v[40:41], v37 offset:256
    ds_read_b64_tr_b16 v[42:43], v37 offset:5376
    ds_read_b64_tr_b16 v[44:45], v37 offset:288
    ds_read_b64_tr_b16 v[46:47], v37 offset:5408
    s_waitcnt lgkmcnt(0)
    ds_write_b128 v2, v[40:43] offset:26624
    ds_write_b128 v2, v[44:47] offset:29696
    s_waitcnt lgkmcnt(0)
    v_and_b32 v10, 15, v0
    v_lshrrev_b32 v11, 4, v0
    v_and_b32 v12, 7, v0
    v_and_b32 v13, 1, v0
    v_mov_b32 v14, 0x3f80
    v_lshlrev_b32 v13, 4, v13
    v_lshlrev_b32 v14, v13, v14
    v_lshrrev_b32 v12, 1, v12
    v_lshrrev_b32 v13, 2, v10
    v_cmp_eq_u32 s[38:39], v13, v11
    v_bfe_u32 v13, v0, 1, 1
    s_nop 0
    v_cndmask_b32 v17, 0, v14, s[38:39]
    v_cmp_eq_u32 vcc, 0, v12
    s_nop 1
    v_cndmask_b32 v15, 0, v14, vcc
    v_accvgpr_write_b32 a248, v15
    v_cmp_eq_u32 vcc, 0, v13
    s_nop 1
    v_cndmask_b32 v16, 0, v17, vcc
    v_accvgpr_write_b32 a240, v16
    v_accvgpr_write_b32 a244, 0
    v_cmp_eq_u32 vcc, 1, v12
    s_nop 1
    v_cndmask_b32 v15, 0, v14, vcc
    v_accvgpr_write_b32 a249, v15
    v_cmp_eq_u32 vcc, 1, v13
    s_nop 1
    v_cndmask_b32 v16, 0, v17, vcc
    v_accvgpr_write_b32 a241, v16
    v_accvgpr_write_b32 a245, 0
    v_cmp_eq_u32 vcc, 2, v12
    s_nop 1
    v_cndmask_b32 v15, 0, v14, vcc
    v_accvgpr_write_b32 a250, v15
    v_cmp_eq_u32 vcc, 0, v13
    s_nop 1
    v_cndmask_b32 v16, 0, v17, vcc
    v_accvgpr_write_b32 a246, v16
    v_accvgpr_write_b32 a242, 0
    v_cmp_eq_u32 vcc, 3, v12
    s_nop 1
    v_cndmask_b32 v15, 0, v14, vcc
    v_accvgpr_write_b32 a251, v15
    v_cmp_eq_u32 vcc, 1, v13
    s_nop 1
    v_cndmask_b32 v16, 0, v17, vcc
    v_accvgpr_write_b32 a247, v16
    v_accvgpr_write_b32 a243, 0
    v_cmp_gt_u32 s[48:49], 8, v10
    v_cmp_gt_u32 vcc, 2, v11
    s_xnor_b64 s[50:51], vcc, s[48:49]
    s_mul_i32 s60, s15, 640
    s_mov_b32 s61, 20480
    v_add_u32 v12, 0, v0
    v_mul_u32_u24 v13, 52429, v12
    v_lshrrev_b32 v13, 21, v13
    v_mul_u32_u24 v14, 40, v13
    v_sub_u32 v14, v12, v14
    v_mul_lo_u32 v13, v13, s61
    v_lshl_add_u32 v13, v14, 4, v13
    v_add_u32 v3, s60, v13
    v_add_u32 v12, 64, v0
    v_mul_u32_u24 v13, 52429, v12
    v_lshrrev_b32 v13, 21, v13
    v_mul_u32_u24 v14, 40, v13
    v_sub_u32 v14, v12, v14
    v_mul_lo_u32 v13, v13, s61
    v_lshl_add_u32 v13, v14, 4, v13
    v_add_u32 v4, s60, v13
    v_add_u32 v12, 128, v0
    v_mul_u32_u24 v13, 52429, v12
    v_lshrrev_b32 v13, 21, v13
    v_mul_u32_u24 v14, 40, v13
    v_sub_u32 v14, v12, v14
    v_mul_lo_u32 v13, v13, s61
    v_lshl_add_u32 v13, v14, 4, v13
    v_add_u32 v5, s60, v13
    v_add_u32 v12, 192, v0
    v_mul_u32_u24 v13, 52429, v12
    v_lshrrev_b32 v13, 21, v13
    v_mul_u32_u24 v14, 40, v13
    v_sub_u32 v14, v12, v14
    v_mul_lo_u32 v13, v13, s61
    v_lshl_add_u32 v13, v14, 4, v13
    v_add_u32 v6, s60, v13
    v_add_u32 v12, 256, v0
    v_mul_u32_u24 v13, 52429, v12
    v_lshrrev_b32 v13, 21, v13
    v_mul_u32_u24 v14, 40, v13
    v_sub_u32 v14, v12, v14
    v_mul_lo_u32 v13, v13, s61
    v_lshl_add_u32 v13, v14, 4, v13
    v_add_u32 v7, s60, v13
    s_mul_i32 s60, s15, 20480
    s_add_u32 s60, s60, 0
    v_lshrrev_b32 v12, 4, v0
    v_mul_u32_u24 v12, 640, v12
    v_and_b32 v13, 15, v0
    v_lshl_add_u32 v12, v13, 4, v12
    v_add_u32 v8, s60, v12
    s_mul_i32 s60, s15, 40
    s_add_u32 s60, s60, 0
    v_add_u32 v12, s60, v10
    v_lshlrev_b32 v9, 4, v12
    s_mul_i32 s32, s14, 655360
    s_add_u32 s32, s32, 1310720
    s_add_u32 s33, s32, 5120
    s_add_u32 s34, s32, 10240
    s_add_u32 s35, s32, 15360
    s_mov_b32 s52, 1037384597
    s_mov_b32 s53, 1037384597
    s_lshl_b32 s29, s13, 12
    s_add_u32 s29, s29, 917504
    s_xor_b32 s30, s29, 4096
    s_mov_b64 s[46:47], 65535
    s_mov_b32 s8, s66
    s_and_b32 s9, s67, 0xffff
    s_mov_b32 s10, 10240
    s_mov_b32 s11, 0x20000
    v_and_b32 v13, 7, v12
    v_mul_u32_u24 v13, 1280, v13
    v_lshrrev_b32 v14, 6, v12
    v_lshl_add_u32 v13, v14, 6, v13
    v_bfe_u32 v14, v12, 4, 2
    v_lshl_add_u32 v13, v14, 3, v13
    v_and_b32 v14, 8, v12
    v_cmp_eq_u32 s[38:39], 0, v14
    v_cmp_ne_u32 s[40:41], 0, v14
    s_cmp_eq_u32 s14, 0
    s_cselect_b32 s10, 10240, 0
    buffer_load_dwordx2 v[16:17], v13, s[8:11], 0 offen
    buffer_load_dwordx2 v[18:19], v13, s[8:11], 0 offen offset:32
    s_waitcnt vmcnt(0)
    v_accvgpr_write_b32 a252, v16
    v_accvgpr_write_b32 a253, v17
    v_accvgpr_write_b32 a254, v18
    v_accvgpr_write_b32 a255, v19
    s_lshl_b32 s3, s18, 2
    s_add_u32 s3, s3, 64
    v_mov_b32 v92, s3
    v_lshlrev_b32 v94, 2, v0
    v_and_b32 v94, 28, v94
    s_mov_b32 s19, 0
L_R0_warr_2:
    global_load_dword v93, v92, s[16:17] sc1
    s_add_u32 s19, s19, 1
    s_cmp_ge_u32 s19, 524288
    s_cbranch_scc1 L_fail
    s_waitcnt vmcnt(0)
    v_cmp_gt_u32 vcc, 256, v93
    s_nop 0
    s_cbranch_vccnz L_R0_warr_2
    s_cmp_lg_u32 s18, 0
    s_cbranch_scc1 L_R0_placed_3
    global_load_dword v93, v94, s[16:17] sc1
    s_waitcnt vmcnt(0)
    v_cmp_ne_u32 vcc, 32, v93
    s_nop 0
    s_cbranch_vccnz L_fallback
L_R0_placed_3:
    v_lshlrev_b32 v0, 4, v0
    s_mov_b32 s20, 0
    s_barrier
    v_or_b32 v16, 1, v16
    s_lshl_b32 s60, s14, 15
    s_add_u32 s60, s60, 1179648
    s_mul_i32 s61, s14, 20480
    s_add_u32 s61, s61, 2621440
    s_mov_b64 exec, s[46:47]
    buffer_store_dwordx4 v[16:19], v9, s[4:7], s60 offen sc1
    buffer_store_dwordx4 v[16:19], v9, s[4:7], s61 offen sc1
    s_mov_b64 exec, -1
    s_waitcnt vmcnt(0)
    s_add_u32 s60, s20, 1
    s_and_b32 s22, s60, 1
    s_lshl_b32 s21, s22, 31
    s_sub_u32 s44, 0, s22
    s_bfe_u32 s23, s20, 0x10001
    s_sub_u32 s23, s23, 1
    s_lshr_b32 s24, s60, 1
    s_andn2_b32 s24, 1, s24
    s_lshl_b32 s61, s14, 15
    s_add_u32 s61, s61, 1179648
    s_and_b32 s25, s20, 1
    s_lshl_b32 s25, s25, 16
    s_add_u32 s25, s25, s61
    s_add_u32 s25, s25, 0
    s_add_u32 s26, s25, 4096
    s_lshl_b32 s36, s22, 16
    s_add_u32 s36, s36, s61
    s_lshl_b32 s27, s20, 1
    s_add_u32 s37, s27, 2
    s_add_u32 s37, s37, s14
    s_mul_i32 s37, s37, 20480
    s_add_u32 s37, s37, 2621440
    s_add_u32 s27, s27, 1
    s_sub_u32 s27, s27, s14
    s_mul_i32 s27, s27, 20480
    s_add_u32 s27, s27, 2621440
    s_add_u32 s28, s27, 4096
    s_lshl_b32 s31, s20, 6
    s_add_u32 s31, s31, s13
    s_mul_i32 s31, s31, 6144
    s_add_u32 s31, s31, 5898240
    s_min_u32 s56, s20, 63
    s_lshl_b32 s56, s56, 6
    s_add_u32 s56, s56, s13
    s_mul_i32 s56, s56, 12288
    s_add_u32 s56, s56, 37361664
    s_max_u32 s57, s20, 5
    s_sub_u32 s57, s57, 5
    s_lshl_b32 s57, s57, 6
    s_add_u32 s57, s57, s13
    s_mul_i32 s57, s57, 12288
    s_add_u32 s57, s57, 87693312
    s_cmp_lt_u32 s20, 5
    s_cselect_b32 s57, s56, s57
    s_cmp_gt_u32 s60, 63
    s_cselect_b64 s[42:43], s[38:39], 0
    s_cmp_le_u32 s60, 5
    s_cselect_b64 vcc, s[40:41], 0
    s_or_b64 s[42:43], s[42:43], vcc
    s_cmp_lg_u32 s18, 0
    s_cbranch_scc1 L_R0_slow
L_Rf0_top:
    s_barrier
    buffer_load_dwordx4 v[10:13], v0, s[4:7], s25 offen offset:0 sc1
    buffer_load_dwordx4 v[14:17], v0, s[4:7], s25 offen offset:1024 sc1
    buffer_load_dwordx4 v[18:21], v0, s[4:7], s25 offen offset:2048 sc1
    buffer_load_dwordx4 v[22:25], v0, s[4:7], s25 offen offset:3072 sc1
    buffer_load_dwordx4 v[26:29], v0, s[4:7], s26 offen offset:0 sc1
    s_barrier
    buffer_load_dwordx4 v[46:49], v0, s[4:7], s27 offen offset:0 sc1
    buffer_load_dwordx4 v[30:33], v0, s[4:7], s27 offen offset:1024 sc1
    buffer_load_dwordx4 v[34:37], v0, s[4:7], s27 offen offset:2048 sc1
    buffer_load_dwordx4 v[38:41], v0, s[4:7], s27 offen offset:3072 sc1
    buffer_load_dwordx4 v[42:45], v0, s[4:7], s28 offen offset:0 sc1
    s_mov_b32 s19, 0
L_Rf0_gl_1:
    s_waitcnt vmcnt(9)
    v_mfma_f32_16x16x32_bf16 v[50:53], a[240:243], v[10:13], 0
    v_mfma_f32_16x16x32_bf16 v[54:57], a[244:247], v[10:13], 0
    v_xor_b32 v1, s23, v10
    s_waitcnt vmcnt(8)
    v_mfma_f32_16x16x32_bf16 v[58:61], a[240:243], v[14:17], 0
    v_mfma_f32_16x16x32_bf16 v[62:65], a[244:247], v[14:17], 0
    v_bitop3_b32 v1, v1, v14, s23 bitop3:0xf6
    s_waitcnt vmcnt(7)
    v_mfma_f32_16x16x32_bf16 v[66:69], a[240:243], v[18:21], 0
    v_mfma_f32_16x16x32_bf16 v[70:73], a[244:247], v[18:21], 0
    v_bitop3_b32 v1, v1, v18, s23 bitop3:0xf6
    s_waitcnt vmcnt(6)
    v_mfma_f32_16x16x32_bf16 v[74:77], a[240:243], v[22:25], 0
    v_mfma_f32_16x16x32_bf16 v[78:81], a[244:247], v[22:25], 0
    v_bitop3_b32 v1, v1, v22, s23 bitop3:0xf6
    s_waitcnt vmcnt(5)
    v_mfma_f32_16x16x32_bf16 v[82:85], a[240:243], v[26:29], 0
    v_mfma_f32_16x16x32_bf16 v[86:89], a[244:247], v[26:29], 0
    v_bitop3_b32 v1, v1, v26, s23 bitop3:0xf6
    v_and_b32 v1, 1, v1
    v_cmp_ne_u32 vcc, 0, v1
    s_nop 0
    s_cbranch_vccnz L_Rf0_glfix_3
L_Rf0_gr_2:
    s_waitcnt vmcnt(4)
    v_mfma_f32_16x16x32_bf16 v[50:53], a[240:243], v[46:49], v[50:53]
    v_xor_b32 v1, s23, v46
    v_mfma_f32_16x16x32_bf16 v[54:57], a[244:247], v[46:49], v[54:57]
    s_waitcnt vmcnt(3)
    v_mfma_f32_16x16x32_bf16 v[58:61], a[240:243], v[30:33], v[58:61]
    v_bitop3_b32 v1, v1, v30, s23 bitop3:0xf6
    v_mfma_f32_16x16x32_bf16 v[62:65], a[244:247], v[30:33], v[62:65]
    s_nop 1
    v_cvt_pk_bf16_f32 v90, v50, v51
    v_cvt_pk_bf16_f32 v91, v52, v53
    v_cvt_pk_bf16_f32 v92, v54, v55
    v_cvt_pk_bf16_f32 v93, v56, v57
    ds_write_b128 v0, v[90:93] offset:0
    s_waitcnt vmcnt(2)
    v_mfma_f32_16x16x32_bf16 v[66:69], a[240:243], v[34:37], v[66:69]
    v_bitop3_b32 v1, v1, v34, s23 bitop3:0xf6
    v_mfma_f32_16x16x32_bf16 v[70:73], a[244:247], v[34:37], v[70:73]
    v_cvt_pk_bf16_f32 v90, v58, v59
    v_cvt_pk_bf16_f32 v91, v60, v61
    v_cvt_pk_bf16_f32 v92, v62, v63
    v_cvt_pk_bf16_f32 v93, v64, v65
    ds_write_b128 v0, v[90:93] offset:1024
    s_waitcnt vmcnt(1)
    v_mfma_f32_16x16x32_bf16 v[74:77], a[240:243], v[38:41], v[74:77]
    v_bitop3_b32 v1, v1, v38, s23 bitop3:0xf6
    v_mfma_f32_16x16x32_bf16 v[78:81], a[244:247], v[38:41], v[78:81]
    v_cvt_pk_bf16_f32 v90, v66, v67
    v_cvt_pk_bf16_f32 v91, v68, v69
    v_cvt_pk_bf16_f32 v92, v70, v71
    v_cvt_pk_bf16_f32 v93, v72, v73
    ds_write_b128 v0, v[90:93] offset:2048
    s_waitcnt vmcnt(0)
    v_mfma_f32_16x16x32_bf16 v[82:85], a[240:243], v[42:45], v[82:85]
    v_bitop3_b32 v1, v1, v42, s23 bitop3:0xf6
    v_mfma_f32_16x16x32_bf16 v[86:89], a[244:247], v[42:45], v[86:89]
    v_cvt_pk_bf16_f32 v90, v74, v75
    v_cvt_pk_bf16_f32 v91, v76, v77
    v_cvt_pk_bf16_f32 v92, v78, v79
    v_cvt_pk_bf16_f32 v93, v80, v81
    ds_write_b128 v0, v[90:93] offset:3072
    s_nop 0
    v_cvt_pk_bf16_f32 v90, v82, v83
    v_cvt_pk_bf16_f32 v91, v84, v85
    v_cvt_pk_bf16_f32 v92, v86, v87
    v_cvt_pk_bf16_f32 v93, v88, v89
    ds_write_b128 v0, v[90:93] offset:4096
    v_and_b32 v1, 1, v1
    v_cmp_ne_u32 vcc, 0, v1
    s_nop 0
    s_cbranch_vccnz L_Rf0_grfix_5
    s_waitcnt lgkmcnt(0)
    s_barrier
    ds_read_b128 v[10:13], v0 offset:0
    ds_read_b128 v[14:17], v0 offset:1024
    ds_read_b128 v[18:21], v0 offset:2048
    ds_read_b128 v[22:25], v0 offset:3072
    ds_read_b128 v[26:29], v0 offset:4096
    s_waitcnt lgkmcnt(4)
    v_mfma_f32_16x16x32_bf16 v[46:49], a[0:3], v[10:13], 0
    s_mov_b32 m0, 35840
    v_mfma_f32_16x16x32_bf16 v[50:53], a[80:83], v[10:13], 0
    v_mfma_f32_16x16x32_bf16 v[54:57], a[160:163], v[10:13], 0
    ds_read_b128 v[10:13], v0 offset:5120
    s_waitcnt lgkmcnt(4)
    v_mfma_f32_16x16x32_bf16 v[46:49], a[4:7], v[14:17], v[46:49]
    buffer_load_dwordx4 v0, s[4:7], s56 offen offset:0 sc1 lds
    v_mfma_f32_16x16x32_bf16 v[50:53], a[84:87], v[14:17], v[50:53]
    v_mfma_f32_16x16x32_bf16 v[54:57], a[164:167], v[14:17], v[54:57]
    ds_read_b128 v[14:17], v0 offset:6144
    s_waitcnt lgkmcnt(4)
    v_mfma_f32_16x16x32_bf16 v[46:49], a[8:11], v[18:21], v[46:49]
    buffer_load_dwordx4 v0, s[4:7], s56 offen offset:1024 sc1 lds
    v_mfma_f32_16x16x32_bf16 v[50:53], a[88:91], v[18:21], v[50:53]
    v_mfma_f32_16x16x32_bf16 v[54:57], a[168:171], v[18:21], v[54:57]
    ds_read_b128 v[18:21], v0 offset:7168
    s_waitcnt lgkmcnt(4)
    v_mfma_f32_16x16x32_bf16 v[46:49], a[12:15], v[22:25], v[46:49]
    buffer_load_dwordx4 v0, s[4:7], s56 offen offset:2048 sc1 lds
    v_mfma_f32_16x16x32_bf16 v[50:53], a[92:95], v[22:25], v[50:53]
    v_mfma_f32_16x16x32_bf16 v[54:57], a[172:175], v[22:25], v[54:57]
    ds_read_b128 v[22:25], v0 offset:8192
    s_waitcnt lgkmcnt(4)
    v_mfma_f32_16x16x32_bf16 v[46:49], a[16:19], v[26:29], v[46:49]
    v_mfma_f32_16x16x32_bf16 v[50:53], a[96:99], v[26:29], v[50:53]
    v_mfma_f32_16x16x32_bf16 v[54:57], a[176:179], v[26:29], v[54:57]
    ds_read_b128 v[26:29], v0 offset:9216
    s_waitcnt lgkmcnt(4)
    v_mfma_f32_16x16x32_bf16 v[46:49], a[20:23], v[10:13], v[46:49]
    v_mfma_f32_16x16x32_bf16 v[50:53], a[100:103], v[10:13], v[50:53]
    v_mfma_f32_16x16x32_bf16 v[54:57], a[180:183], v[10:13], v[54:57]
    ds_read_b128 v[10:13], v0 offset:10240
    s_waitcnt lgkmcnt(4)
    v_mfma_f32_16x16x32_bf16 v[46:49], a[24:27], v[14:17], v[46:49]
    v_mfma_f32_16x16x32_bf16 v[50:53], a[104:107], v[14:17], v[50:53]
    v_mfma_f32_16x16x32_bf16 v[54:57], a[184:187], v[14:17], v[54:57]
    ds_read_b128 v[14:17], v0 offset:11264
    s_waitcnt lgkmcnt(4)
    v_mfma_f32_16x16x32_bf16 v[46:49], a[28:31], v[18:21], v[46:49]
    v_mfma_f32_16x16x32_bf16 v[50:53], a[108:111], v[18:21], v[50:53]
    v_mfma_f32_16x16x32_bf16 v[54:57], a[188:191], v[18:21], v[54:57]
    ds_read_b128 v[18:21], v0 offset:12288
    s_waitcnt lgkmcnt(4)
    v_mfma_f32_16x16x32_bf16 v[46:49], a[32:35], v[22:25], v[46:49]
    v_mfma_f32_16x16x32_bf16 v[50:53], a[112:115], v[22:25], v[50:53]
    v_mfma_f32_16x16x32_bf16 v[54:57], a[192:195], v[22:25], v[54:57]
    ds_read_b128 v[22:25], v0 offset:13312
    s_waitcnt lgkmcnt(4)
    v_mfma_f32_16x16x32_bf16 v[46:49], a[36:39], v[26:29], v[46:49]
    v_mfma_f32_16x16x32_bf16 v[50:53], a[116:119], v[26:29], v[50:53]
    v_mfma_f32_16x16x32_bf16 v[54:57], a[196:199], v[26:29], v[54:57]
    ds_read_b128 v[26:29], v0 offset:14336
    s_waitcnt lgkmcnt(4)
    v_mfma_f32_16x16x32_bf16 v[46:49], a[40:43], v[10:13], v[46:49]
    v_mfma_f32_16x16x32_bf16 v[50:53], a[120:123], v[10:13], v[50:53]
    v_mfma_f32_16x16x32_bf16 v[54:57], a[200:203], v[10:13], v[54:57]
    ds_read_b128 v[10:13], v0 offset:15360
    s_waitcnt lgkmcnt(4)
    v_mfma_f32_16x16x32_bf16 v[46:49], a[44:47], v[14:17], v[46:49]
    v_mfma_f32_16x16x32_bf16 v[50:53], a[124:127], v[14:17], v[50:53]
    v_mfma_f32_16x16x32_bf16 v[54:57], a[204:207], v[14:17], v[54:57]
    ds_read_b128 v[14:17], v0 offset:16384
    s_waitcnt lgkmcnt(4)
    v_mfma_f32_16x16x32_bf16 v[46:49], a[48:51], v[18:21], v[46:49]
    v_mfma_f32_16x16x32_bf16 v[50:53], a[128:131], v[18:21], v[50:53]
    v_mfma_f32_16x16x32_bf16 v[54:57], a[208:211], v[18:21], v[54:57]
    ds_read_b128 v[18:21], v0 offset:17408
    s_waitcnt lgkmcnt(4)
    v_mfma_f32_16x16x32_bf16 v[46:49], a[52:55], v[22:25], v[46:49]
    v_mfma_f32_16x16x32_bf16 v[50:53], a[132:135], v[22:25], v[50:53]
    v_mfma_f32_16x16x32_bf16 v[54:57], a[212:215], v[22:25], v[54:57]
    ds_read_b128 v[22:25], v0 offset:18432
    s_waitcnt lgkmcnt(4)
    v_mfma_f32_16x16x32_bf16 v[46:49], a[56:59], v[26:29], v[46:49]
    v_mfma_f32_16x16x32_bf16 v[50:53], a[136:139], v[26:29], v[50:53]
    v_mfma_f32_16x16x32_bf16 v[54:57], a[216:219], v[26:29], v[54:57]
    ds_read_b128 v[26:29], v0 offset:19456
    s_waitcnt lgkmcnt(4)
    v_mfma_f32_16x16x32_bf16 v[46:49], a[60:63], v[10:13], v[46:49]
    v_mfma_f32_16x16x32_bf16 v[50:53], a[140:143], v[10:13], v[50:53]
    v_mfma_f32_16x16x32_bf16 v[54:57], a[220:223], v[10:13], v[54:57]
    ds_read_b128 v[10:13], v0 offset:0
    s_waitcnt lgkmcnt(4)
    v_mfma_f32_16x16x32_bf16 v[46:49], a[64:67], v[14:17], v[46:49]
    v_mfma_f32_16x16x32_bf16 v[50:53], a[144:147], v[14:17], v[50:53]
    v_mfma_f32_16x16x32_bf16 v[54:57], a[224:227], v[14:17], v[54:57]
    ds_read_b128 v[14:17], v0 offset:1024
    s_waitcnt lgkmcnt(4)
    v_mfma_f32_16x16x32_bf16 v[46:49], a[68:71], v[18:21], v[46:49]
    v_mfma_f32_16x16x32_bf16 v[50:53], a[148:151], v[18:21], v[50:53]
    v_mfma_f32_16x16x32_bf16 v[54:57], a[228:231], v[18:21], v[54:57]
    ds_read_b128 v[18:21], v0 offset:2048
    s_waitcnt lgkmcnt(4)
    v_mfma_f32_16x16x32_bf16 v[46:49], a[72:75], v[22:25], v[46:49]
    v_mfma_f32_16x16x32_bf16 v[50:53], a[152:155], v[22:25], v[50:53]
    v_mfma_f32_16x16x32_bf16 v[54:57], a[232:235], v[22:25], v[54:57]
    ds_read_b128 v[22:25], v0 offset:3072
    s_waitcnt lgkmcnt(4)
    v_mfma_f32_16x16x32_bf16 v[46:49], a[76:79], v[26:29], v[46:49]
    v_mfma_f32_16x16x32_bf16 v[50:53], a[156:159], v[26:29], v[50:53]
    v_mfma_f32_16x16x32_bf16 v[54:57], a[236:239], v[26:29], v[54:57]
    ds_read_b128 v[26:29], v0 offset:4096
    s_waitcnt lgkmcnt(4)
    v_mfma_f32_16x16x32_bf16 v[30:33], v[10:13], v[96:99], 0
    v_mfma_f32_16x16x32_bf16 v[34:37], v[10:13], v[176:179], 0
    ds_read_b128 v[10:13], v0 offset:5120
    s_nop 0
    v_cvt_pk_bf16_f32 v82, v46, v47
    v_cvt_pk_bf16_f32 v83, v48, v49
    ds_write_b64 v0, v[82:83] offset:20480
    v_cvt_pk_bf16_f32 v84, v50, v51
    v_cvt_pk_bf16_f32 v85, v52, v53
    ds_write_b64 v0, v[84:85] offset:20488
    v_cvt_pk_bf16_f32 v86, v54, v55
    v_cvt_pk_bf16_f32 v87, v56, v57
    ds_write_b64 v0, v[86:87] offset:21504
    s_waitcnt lgkmcnt(7)
    v_mfma_f32_16x16x32_bf16 v[30:33], v[14:17], v[100:103], v[30:33]
    v_mfma_f32_16x16x32_bf16 v[34:37], v[14:17], v[180:183], v[34:37]
    ds_read_b128 v[14:17], v0 offset:6144
    s_waitcnt lgkmcnt(1)
    s_barrier
    ds_read_b128 v[58:61], v0 offset:23552
    ds_read_b128 v[46:49], v0 offset:20480
    ds_read_b128 v[62:65], v0 offset:24576
    ds_read_b128 v[50:53], v0 offset:21504
    ds_read_b128 v[66:69], v0 offset:25600
    ds_read_b128 v[54:57], v0 offset:22528
    v_mfma_f32_16x16x32_bf16 v[30:33], v[18:21], v[104:107], v[30:33]
    v_mfma_f32_16x16x32_bf16 v[34:37], v[18:21], v[184:187], v[34:37]
    ds_read_b128 v[18:21], v0 offset:7168
    v_mfma_f32_16x16x32_bf16 v[30:33], v[22:25], v[108:111], v[30:33]
    v_mfma_f32_16x16x32_bf16 v[34:37], v[22:25], v[188:191], v[34:37]
    ds_read_b128 v[22:25], v0 offset:8192
    s_waitcnt lgkmcnt(6)
    v_mfma_f32_16x16x32_bf16 v[38:41], v[58:61], v[46:49], 0
    s_waitcnt lgkmcnt(4)
    v_mfma_f32_16x16x32_bf16 v[38:41], v[62:65], v[50:53], v[38:41]
    s_waitcnt lgkmcnt(2)
    v_mfma_f32_16x16x32_bf16 v[38:41], v[66:69], v[54:57], v[38:41]
    v_mfma_f32_16x16x32_bf16 v[30:33], v[26:29], v[112:115], v[30:33]
    v_mfma_f32_16x16x32_bf16 v[34:37], v[26:29], v[192:195], v[34:37]
    ds_read_b128 v[26:29], v0 offset:9216
    s_nop 4
    v_and_or_b32 v38, v38, -2, s22
    buffer_store_dwordx4 v[38:41], v0, s[4:7], s29 offen
    v_mfma_f32_16x16x32_bf16 v[30:33], v[10:13], v[116:119], v[30:33]
    v_mfma_f32_16x16x32_bf16 v[34:37], v[10:13], v[196:199], v[34:37]
    ds_read_b128 v[10:13], v0 offset:10240
    v_mfma_f32_16x16x32_bf16 v[30:33], v[14:17], v[120:123], v[30:33]
    v_mfma_f32_16x16x32_bf16 v[34:37], v[14:17], v[200:203], v[34:37]
    ds_read_b128 v[14:17], v0 offset:11264
    s_waitcnt lgkmcnt(4)
    v_mfma_f32_16x16x32_bf16 v[30:33], v[18:21], v[124:127], v[30:33]
    v_mfma_f32_16x16x32_bf16 v[34:37], v[18:21], v[204:207], v[34:37]
    ds_read_b128 v[18:21], v0 offset:12288
    s_waitcnt lgkmcnt(4)
    v_mfma_f32_16x16x32_bf16 v[30:33], v[22:25], v[128:131], v[30:33]
    v_mfma_f32_16x16x32_bf16 v[34:37], v[22:25], v[208:211], v[34:37]
    ds_read_b128 v[22:25], v0 offset:13312
    s_waitcnt lgkmcnt(4)
    v_mfma_f32_16x16x32_bf16 v[30:33], v[26:29], v[132:135], v[30:33]
    v_mfma_f32_16x16x32_bf16 v[34:37], v[26:29], v[212:215], v[34:37]
    ds_read_b128 v[26:29], v0 offset:14336
    s_waitcnt lgkmcnt(4)
    v_mfma_f32_16x16x32_bf16 v[30:33], v[10:13], v[136:139], v[30:33]
    v_mfma_f32_16x16x32_bf16 v[34:37], v[10:13], v[216:219], v[34:37]
    ds_read_b128 v[10:13], v0 offset:15360
    s_waitcnt lgkmcnt(4)
    v_mfma_f32_16x16x32_bf16 v[30:33], v[14:17], v[140:143], v[30:33]
    v_mfma_f32_16x16x32_bf16 v[34:37], v[14:17], v[220:223], v[34:37]
    ds_read_b128 v[14:17], v0 offset:16384
    s_waitcnt lgkmcnt(4)
    v_mfma_f32_16x16x32_bf16 v[30:33], v[18:21], v[144:147], v[30:33]
    v_mfma_f32_16x16x32_bf16 v[34:37], v[18:21], v[224:227], v[34:37]
    ds_read_b128 v[18:21], v0 offset:17408
    s_waitcnt lgkmcnt(4)
    v_mfma_f32_16x16x32_bf16 v[30:33], v[22:25], v[148:151], v[30:33]
    v_mfma_f32_16x16x32_bf16 v[34:37], v[22:25], v[228:231], v[34:37]
    ds_read_b128 v[22:25], v0 offset:18432
    v_pk_mul_f32 v[42:43], v[38:39], s[52:53]
    v_pk_mul_f32 v[44:45], v[40:41], s[52:53]
    v_mov_b32 v1, 0xff800000
    v_cndmask_b32 v42, v1, v42, s[50:51]
    v_cndmask_b32 v43, v1, v43, s[50:51]
    v_cndmask_b32 v44, v1, v44, s[50:51]
    v_cndmask_b32 v45, v1, v45, s[50:51]
    s_waitcnt vmcnt(0)
    buffer_load_dwordx4 v[82:85], v0, s[4:7], s30 offen sc1
    s_mov_b32 s19, 0
    s_waitcnt lgkmcnt(4)
    v_mfma_f32_16x16x32_bf16 v[30:33], v[26:29], v[152:155], v[30:33]
    v_mfma_f32_16x16x32_bf16 v[34:37], v[26:29], v[232:235], v[34:37]
    ds_read_b128 v[26:29], v0 offset:19456
    s_waitcnt lgkmcnt(4)
    v_mfma_f32_16x16x32_bf16 v[30:33], v[10:13], v[156:159], v[30:33]
    v_mfma_f32_16x16x32_bf16 v[34:37], v[10:13], v[236:239], v[34:37]
    s_waitcnt lgkmcnt(3)
    v_mfma_f32_16x16x32_bf16 v[30:33], v[14:17], v[160:163], v[30:33]
    v_mfma_f32_16x16x32_bf16 v[34:37], v[14:17], v[240:243], v[34:37]
    s_waitcnt lgkmcnt(2)
    v_mfma_f32_16x16x32_bf16 v[30:33], v[18:21], v[164:167], v[30:33]
    v_mfma_f32_16x16x32_bf16 v[34:37], v[18:21], v[244:247], v[34:37]
    s_waitcnt lgkmcnt(1)
    v_mfma_f32_16x16x32_bf16 v[30:33], v[22:25], v[168:171], v[30:33]
    v_mfma_f32_16x16x32_bf16 v[34:37], v[22:25], v[248:251], v[34:37]
    s_waitcnt lgkmcnt(0)
    v_mfma_f32_16x16x32_bf16 v[30:33], v[26:29], v[172:175], v[30:33]
    v_mfma_f32_16x16x32_bf16 v[34:37], v[26:29], v[252:255], v[34:37]
    s_nop 6
    v_cvt_pk_bf16_f32 v88, v30, v31
    v_cvt_pk_bf16_f32 v89, v32, v33
    v_cvt_pk_bf16_f32 v90, v34, v35
    v_cvt_pk_bf16_f32 v91, v36, v37
    s_add_u32 s60, s31, 3072
    s_cmp_eq_u32 s20, 68
    s_cbranch_scc1 L_Rf0_tail
L_Rf0_ha_6:
    s_waitcnt vmcnt(0)
    v_lshlrev_b32 v1, 31, v82
    v_pk_fma_f32 v[38:39], v[82:83], s[52:53], v[42:43]
    v_pk_fma_f32 v[40:41], v[84:85], s[52:53], v[44:45]
    ds_write_b128 v0, v[38:41] offset:26624
    v_cmp_ne_u32 vcc, s21, v1
    s_nop 0
    s_cbranch_vccnz L_Rf0_hafix_7
    s_waitcnt vmcnt(0) lgkmcnt(0)
    s_barrier
    ds_read_b128 v[10:13], v0 offset:26624
    ds_read_b128 v[14:17], v0 offset:27648
    ds_read_b128 v[18:21], v0 offset:28672
    ds_read_b128 v[58:61], v0 offset:35840
    ds_read_b128 v[62:65], v0 offset:36864
    ds_read_b128 v[66:69], v0 offset:48128
    ds_read_b128 v[70:73], v0 offset:49152
    buffer_store_dwordx4 v[88:91], v0, s[4:7], s60 offen sc1
    s_waitcnt lgkmcnt(5)
    v_max3_f32 v22, v10, v11, v12
    v_max3_f32 v23, v13, v14, v15
    v_max3_f32 v22, v22, v16, v17
    s_waitcnt lgkmcnt(4)
    v_max3_f32 v23, v23, v18, v19
    v_max3_f32 v22, v22, v20, v21
    v_max_f32 v22, v22, v23
    v_mov_b32 v23, v22
    ds_read_b128 v[30:33], v2 offset:0
    ds_read_b128 v[34:37], v2 offset:1024
    v_permlane32_swap_b32 v22, v23
    v_max_f32 v22, v22, v23
    v_mov_b32 v23, v22
    ds_read_b128 v[38:41], v2 offset:2048
    ds_read_b128 v[42:45], v2 offset:3072
    v_permlane16_swap_b32 v22, v23
    v_max_f32 v22, v22, v23
    v_pk_add_f32 v[10:11], v[10:11], v[22:23] op_sel_hi:[1,0] neg_lo:[0,1] neg_hi:[0,1]
    v_pk_add_f32 v[12:13], v[12:13], v[22:23] op_sel_hi:[1,0] neg_lo:[0,1] neg_hi:[0,1]
    v_pk_add_f32 v[14:15], v[14:15], v[22:23] op_sel_hi:[1,0] neg_lo:[0,1] neg_hi:[0,1]
    v_pk_add_f32 v[16:17], v[16:17], v[22:23] op_sel_hi:[1,0] neg_lo:[0,1] neg_hi:[0,1]
    v_pk_add_f32 v[18:19], v[18:19], v[22:23] op_sel_hi:[1,0] neg_lo:[0,1] neg_hi:[0,1]
    v_pk_add_f32 v[20:21], v[20:21], v[22:23] op_sel_hi:[1,0] neg_lo:[0,1] neg_hi:[0,1]
    v_exp_f32 v10, v10
    v_exp_f32 v11, v11
    v_exp_f32 v12, v12
    v_exp_f32 v13, v13
    v_exp_f32 v14, v14
    v_exp_f32 v15, v15
    v_cvt_pk_bf16_f32 v24, v10, v11
    v_cvt_pk_bf16_f32 v25, v12, v13
    v_exp_f32 v16, v16
    v_exp_f32 v17, v17
    v_mfma_f32_16x16x16_bf16 v[46:49], v[88:89], v[24:25], 0
    v_mfma_f32_16x16x16_bf16 v[82:85], v[90:91], v[24:25], 0
    v_exp_f32 v18, v18
    v_exp_f32 v19, v19
    v_exp_f32 v20, v20
    v_exp_f32 v21, v21
    v_cvt_pk_bf16_f32 v26, v14, v15
    v_cvt_pk_bf16_f32 v27, v16, v17
    v_cvt_pk_bf16_f32 v28, v18, v19
    v_cvt_pk_bf16_f32 v29, v20, v21
    v_pk_add_f32 v[22:23], v[10:11], v[12:13]
    v_pk_add_f32 v[14:15], v[14:15], v[16:17]
    s_waitcnt lgkmcnt(4)
    v_mfma_f32_16x16x32_bf16 v[50:53], v[58:61], v[26:29], v[46:49]
    v_pk_add_f32 v[18:19], v[18:19], v[20:21]
    v_mfma_f32_16x16x32_bf16 v[54:57], v[66:69], v[26:29], v[46:49]
    v_pk_add_f32 v[22:23], v[22:23], v[14:15]
    v_pk_add_f32 v[22:23], v[22:23], v[18:19]
    v_mfma_f32_16x16x32_bf16 v[10:13], v[62:65], v[26:29], v[82:85]
    v_add_f32 v22, v22, v23
    v_mfma_f32_16x16x32_bf16 v[14:17], v[70:73], v[26:29], v[82:85]
    v_mov_b32 v23, v22
    ds_read_b128 v[74:77], v2 offset:4096
    ds_read_b128 v[78:81], v2 offset:5120
    v_permlane32_swap_b32 v22, v23
    v_add_f32 v22, v22, v23
    v_mov_b32 v23, v22
    v_cndmask_b32 v50, v54, v50, s[48:49]
    v_cndmask_b32 v51, v55, v51, s[48:49]
    v_permlane16_swap_b32 v22, v23
    v_add_f32 v22, v22, v23
    v_rcp_f32 v22, v22
    v_cndmask_b32 v52, v56, v52, s[48:49]
    v_cndmask_b32 v53, v57, v53, s[48:49]
    v_cndmask_b32 v10, v14, v10, s[48:49]
    v_cndmask_b32 v11, v15, v11, s[48:49]
    v_cndmask_b32 v12, v16, v12, s[48:49]
    v_cndmask_b32 v13, v17, v13, s[48:49]
    v_pk_mul_f32 v[50:51], v[50:51], v[22:23] op_sel_hi:[1,0]
    v_pk_mul_f32 v[52:53], v[52:53], v[22:23] op_sel_hi:[1,0]
    v_cvt_pk_bf16_f32 v24, v50, v51
    v_cvt_pk_bf16_f32 v25, v52, v53
    v_pk_mul_f32 v[10:11], v[10:11], v[22:23] op_sel_hi:[1,0]
    v_pk_mul_f32 v[12:13], v[12:13], v[22:23] op_sel_hi:[1,0]
    v_cvt_pk_bf16_f32 v26, v10, v11
    v_cvt_pk_bf16_f32 v27, v12, v13
    ds_write_b128 v0, v[24:27] offset:0
    s_waitcnt lgkmcnt(0)
    s_barrier
    ds_read_b128 v[10:13], v0 offset:0
    ds_read_b128 v[14:17], v0 offset:1024
    ds_read_b128 v[18:21], v0 offset:2048
    s_add_u32 s20, s20, 1
    s_waitcnt lgkmcnt(2)
    v_mfma_f32_16x16x32_bf16 v[46:49], v[30:33], v[10:13], 0
    ds_read_b128 v[30:33], v2 offset:6144
    s_waitcnt lgkmcnt(2)
    v_mfma_f32_16x16x32_bf16 v[46:49], v[34:37], v[14:17], v[46:49]
    ds_read_b128 v[34:37], v2 offset:7168
    s_waitcnt lgkmcnt(2)
    v_mfma_f32_16x16x32_bf16 v[46:49], v[38:41], v[18:21], v[46:49]
    ds_read_b128 v[38:41], v2 offset:8192
    v_mfma_f32_16x16x32_bf16 v[50:53], v[42:45], v[10:13], 0
    ds_read_b128 v[42:45], v2 offset:9216
    v_mfma_f32_16x16x32_bf16 v[50:53], v[74:77], v[14:17], v[50:53]
    ds_read_b128 v[74:77], v2 offset:10240
    v_mfma_f32_16x16x32_bf16 v[50:53], v[78:81], v[18:21], v[50:53]
    ds_read_b128 v[78:81], v2 offset:11264
    s_waitcnt lgkmcnt(3)
    v_mfma_f32_16x16x32_bf16 v[54:57], v[30:33], v[10:13], 0
    ds_read_b128 v[30:33], v2 offset:12288
    v_cvt_pk_bf16_f32 v62, v46, v47
    v_mfma_f32_16x16x32_bf16 v[54:57], v[34:37], v[14:17], v[54:57]
    ds_read_b128 v[34:37], v2 offset:13312
    v_cvt_pk_bf16_f32 v63, v48, v49
    v_and_or_b32 v62, v62, -2, s22
    v_mfma_f32_16x16x32_bf16 v[54:57], v[38:41], v[18:21], v[54:57]
    ds_read_b128 v[38:41], v2 offset:14336
    v_cvt_pk_bf16_f32 v64, v50, v51
    s_waitcnt lgkmcnt(3)
    v_mfma_f32_16x16x32_bf16 v[58:61], v[42:45], v[10:13], 0
    ds_read_b128 v[42:45], v2 offset:15360
    v_cvt_pk_bf16_f32 v65, v52, v53
    buffer_store_dwordx4 v[62:65], v3, s[4:7], s32 offen
    v_mfma_f32_16x16x32_bf16 v[58:61], v[74:77], v[14:17], v[58:61]
    ds_read_b128 v[74:77], v2 offset:16384
    v_mfma_f32_16x16x32_bf16 v[58:61], v[78:81], v[18:21], v[58:61]
    ds_read_b128 v[78:81], v2 offset:17408
    s_waitcnt lgkmcnt(3)
    v_mfma_f32_16x16x32_bf16 v[46:49], v[30:33], v[10:13], 0
    ds_read_b128 v[30:33], v2 offset:18432
    v_cvt_pk_bf16_f32 v66, v54, v55
    v_mfma_f32_16x16x32_bf16 v[46:49], v[34:37], v[14:17], v[46:49]
    ds_read_b128 v[34:37], v2 offset:19456
    v_cvt_pk_bf16_f32 v67, v56, v57
    v_and_or_b32 v66, v66, -2, s22
    v_mfma_f32_16x16x32_bf16 v[46:49], v[38:41], v[18:21], v[46:49]
    ds_read_b128 v[38:41], v2 offset:20480
    v_cvt_pk_bf16_f32 v68, v58, v59
    s_waitcnt lgkmcnt(3)
    v_mfma_f32_16x16x32_bf16 v[50:53], v[42:45], v[10:13], 0
    ds_read_b128 v[42:45], v2 offset:21504
    v_cvt_pk_bf16_f32 v69, v60, v61
    buffer_store_dwordx4 v[66:69], v4, s[4:7], s32 offen
    v_mfma_f32_16x16x32_bf16 v[50:53], v[74:77], v[14:17], v[50:53]
    ds_read_b128 v[74:77], v2 offset:22528
    v_mfma_f32_16x16x32_bf16 v[50:53], v[78:81], v[18:21], v[50:53]
    ds_read_b128 v[78:81], v2 offset:23552
    s_waitcnt lgkmcnt(3)
    v_mfma_f32_16x16x32_bf16 v[54:57], v[30:33], v[10:13], 0
    ds_read_b128 v[30:33], v2 offset:24576
    v_cvt_pk_bf16_f32 v62, v46, v47
    v_mfma_f32_16x16x32_bf16 v[54:57], v[34:37], v[14:17], v[54:57]
    ds_read_b128 v[34:37], v2 offset:25600
    v_cvt_pk_bf16_f32 v63, v48, v49
    v_and_or_b32 v62, v62, -2, s22
    v_mfma_f32_16x16x32_bf16 v[54:57], v[38:41], v[18:21], v[54:57]
    ds_read_b128 v[38:41], v2 offset:26624
    v_cvt_pk_bf16_f32 v64, v50, v51
    s_waitcnt lgkmcnt(3)
    v_mfma_f32_16x16x32_bf16 v[58:61], v[42:45], v[10:13], 0
    ds_read_b128 v[42:45], v2 offset:27648
    v_cvt_pk_bf16_f32 v65, v52, v53
    buffer_store_dwordx4 v[62:65], v5, s[4:7], s32 offen
    v_mfma_f32_16x16x32_bf16 v[58:61], v[74:77], v[14:17], v[58:61]
    ds_read_b128 v[74:77], v2 offset:28672
    v_mfma_f32_16x16x32_bf16 v[58:61], v[78:81], v[18:21], v[58:61]
    ds_read_b128 v[78:81], v2 offset:29696
    s_waitcnt lgkmcnt(3)
    v_mfma_f32_16x16x32_bf16 v[46:49], v[30:33], v[10:13], 0
    v_cvt_pk_bf16_f32 v66, v54, v55
    v_mfma_f32_16x16x32_bf16 v[46:49], v[34:37], v[14:17], v[46:49]
    v_cvt_pk_bf16_f32 v67, v56, v57
    v_and_or_b32 v66, v66, -2, s22
    v_mfma_f32_16x16x32_bf16 v[46:49], v[38:41], v[18:21], v[46:49]
    v_cvt_pk_bf16_f32 v68, v58, v59
    s_waitcnt lgkmcnt(0)
    v_mfma_f32_16x16x32_bf16 v[50:53], v[42:45], v[10:13], 0
    v_cvt_pk_bf16_f32 v69, v60, v61
    buffer_store_dwordx4 v[66:69], v6, s[4:7], s32 offen
    v_mfma_f32_16x16x32_bf16 v[50:53], v[74:77], v[14:17], v[50:53]
    v_mfma_f32_16x16x32_bf16 v[50:53], v[78:81], v[18:21], v[50:53]
    s_nop 0
    v_cvt_pk_bf16_f32 v62, v46, v47
    v_cvt_pk_bf16_f32 v63, v48, v49
    v_and_or_b32 v62, v62, -2, s22
    s_nop 3
    v_cvt_pk_bf16_f32 v64, v50, v51
    v_cvt_pk_bf16_f32 v65, v52, v53
    buffer_store_dwordx4 v[62:65], v7, s[4:7], s32 offen
    v_accvgpr_read_b32 v78, a252
    v_accvgpr_read_b32 v79, a253
    v_accvgpr_read_b32 v80, a254
    v_accvgpr_read_b32 v81, a255
    s_mov_b32 s19, 0
    s_waitcnt vmcnt(0)
    buffer_load_dwordx4 v[26:29], v8, s[4:7], s32 offen offset:0 sc1
    buffer_load_dwordx4 v[30:33], v8, s[4:7], s32 offen offset:2560 sc1
    buffer_load_dwordx4 v[34:37], v8, s[4:7], s33 offen offset:0 sc1
    buffer_load_dwordx4 v[38:41], v8, s[4:7], s33 offen offset:2560 sc1
    buffer_load_dwordx4 v[42:45], v8, s[4:7], s34 offen offset:0 sc1
    buffer_load_dwordx4 v[46:49], v8, s[4:7], s34 offen offset:2560 sc1
    buffer_load_dwordx4 v[50:53], v8, s[4:7], s35 offen offset:0 sc1
    buffer_load_dwordx4 v[54:57], v8, s[4:7], s35 offen offset:2560 sc1
L_Rf0_hb_8:
    s_waitcnt vmcnt(7)
    v_mfma_f32_16x16x32_bf16 v[70:73], a[248:251], v[26:29], 0
    v_xor_b32 v1, s44, v26
    s_waitcnt vmcnt(6)
    v_mfma_f32_16x16x32_bf16 v[70:73], a[248:251], v[30:33], v[70:73]
    v_bitop3_b32 v1, v1, v30, s44 bitop3:0xf6
    s_waitcnt vmcnt(5)
    v_mfma_f32_16x16x32_bf16 v[70:73], a[248:251], v[34:37], v[70:73]
    v_bitop3_b32 v1, v1, v34, s44 bitop3:0xf6
    s_waitcnt vmcnt(4)
    v_mfma_f32_16x16x32_bf16 v[70:73], a[248:251], v[38:41], v[70:73]
    v_bitop3_b32 v1, v1, v38, s44 bitop3:0xf6
    s_waitcnt vmcnt(3)
    v_mfma_f32_16x16x32_bf16 v[70:73], a[248:251], v[42:45], v[70:73]
    v_bitop3_b32 v1, v1, v42, s44 bitop3:0xf6
    s_waitcnt vmcnt(2)
    v_mfma_f32_16x16x32_bf16 v[70:73], a[248:251], v[46:49], v[70:73]
    v_bitop3_b32 v1, v1, v46, s44 bitop3:0xf6
    s_waitcnt vmcnt(1)
    v_mfma_f32_16x16x32_bf16 v[70:73], a[248:251], v[50:53], v[70:73]
    v_bitop3_b32 v1, v1, v50, s44 bitop3:0xf6
    s_waitcnt vmcnt(0)
    v_mfma_f32_16x16x32_bf16 v[70:73], a[248:251], v[54:57], v[70:73]
    v_bitop3_b32 v1, v1, v54, s44 bitop3:0xf6
    v_and_b32 v1, 1, v1
    v_cmp_ne_u32 vcc, 0, v1
    s_nop 0
    s_cbranch_vccnz L_Rf0_hbfix_9
    s_nop 2
    v_cvt_pk_bf16_f32 v74, v70, v71
    v_cvt_pk_bf16_f32 v75, v72, v73
    v_mov_b32 v76, v74
    v_mov_b32 v77, v75
    s_nop 0
    v_permlane16_swap_b32 v74, v76
    v_permlane16_swap_b32 v75, v77
    v_cndmask_b32 v74, v74, v78, s[42:43]
    v_cndmask_b32 v75, v75, v79, s[42:43]
    v_cndmask_b32 v76, v76, v80, s[42:43]
    v_cndmask_b32 v77, v77, v81, s[42:43]
    v_and_or_b32 v74, v74, -2, s24
    s_mov_b64 exec, s[46:47]
    buffer_store_dwordx4 v[74:77], v9, s[4:7], s36 offen
    buffer_store_dwordx4 v[74:77], v9, s[4:7], s37 offen sc1
    s_mov_b64 exec, -1
    s_add_u32 s60, s20, 1
    s_and_b32 s22, s60, 1
    s_lshl_b32 s21, s22, 31
    s_sub_u32 s44, 0, s22
    s_bfe_u32 s23, s20, 0x10001
    s_sub_u32 s23, s23, 1
    s_lshr_b32 s24, s60, 1
    s_andn2_b32 s24, 1, s24
    s_lshl_b32 s61, s14, 15
    s_add_u32 s61, s61, 1179648
    s_and_b32 s25, s20, 1
    s_lshl_b32 s25, s25, 16
    s_add_u32 s25, s25, s61
    s_add_u32 s25, s25, 0
    s_add_u32 s26, s25, 4096
    s_lshl_b32 s36, s22, 16
    s_add_u32 s36, s36, s61
    s_lshl_b32 s27, s20, 1
    s_add_u32 s37, s27, 2
    s_add_u32 s37, s37, s14
    s_mul_i32 s37, s37, 20480
    s_add_u32 s37, s37, 2621440
    s_add_u32 s27, s27, 1
    s_sub_u32 s27, s27, s14
    s_mul_i32 s27, s27, 20480
    s_add_u32 s27, s27, 2621440
    s_add_u32 s28, s27, 4096
    s_lshl_b32 s31, s20, 6
    s_add_u32 s31, s31, s13
    s_mul_i32 s31, s31, 6144
    s_add_u32 s31, s31, 5898240
    s_min_u32 s56, s20, 63
    s_lshl_b32 s56, s56, 6
    s_add_u32 s56, s56, s13
    s_mul_i32 s56, s56, 12288
    s_add_u32 s56, s56, 37361664
    s_max_u32 s57, s20, 5
    s_sub_u32 s57, s57, 5
    s_lshl_b32 s57, s57, 6
    s_add_u32 s57, s57, s13
    s_mul_i32 s57, s57, 12288
    s_add_u32 s57, s57, 87693312
    s_cmp_lt_u32 s20, 5
    s_cselect_b32 s57, s56, s57
    s_cmp_gt_u32 s60, 63
    s_cselect_b64 s[42:43], s[38:39], 0
    s_cmp_le_u32 s60, 5
    s_cselect_b64 vcc, s[40:41], 0
    s_or_b64 s[42:43], s[42:43], vcc
    s_waitcnt vmcnt(1)
    s_branch L_Rf0_top
L_Rf0_tail:
    s_waitcnt lgkmcnt(0)
    buffer_store_dwordx4 v[88:91], v0, s[4:7], s60 offen sc1
    s_waitcnt vmcnt(0) lgkmcnt(0)
    s_barrier
    v_mov_b32 v22, 69
    s_mov_b64 exec, 1
    s_mov_b64 exec, -1
    s_waitcnt vmcnt(0)
    s_endpgm
L_Rf0_glfix_3:
    buffer_load_dwordx4 v[10:13], v0, s[4:7], s25 offen offset:0 sc1
    buffer_load_dwordx4 v[14:17], v0, s[4:7], s25 offen offset:1024 sc1
    buffer_load_dwordx4 v[18:21], v0, s[4:7], s25 offen offset:2048 sc1
    buffer_load_dwordx4 v[22:25], v0, s[4:7], s25 offen offset:3072 sc1
    buffer_load_dwordx4 v[26:29], v0, s[4:7], s26 offen offset:0 sc1
    buffer_load_dwordx4 v[46:49], v0, s[4:7], s27 offen offset:0 sc1
    buffer_load_dwordx4 v[30:33], v0, s[4:7], s27 offen offset:1024 sc1
    buffer_load_dwordx4 v[34:37], v0, s[4:7], s27 offen offset:2048 sc1
    buffer_load_dwordx4 v[38:41], v0, s[4:7], s27 offen offset:3072 sc1
    buffer_load_dwordx4 v[42:45], v0, s[4:7], s28 offen offset:0 sc1
    s_add_u32 s19, s19, 1
    s_cmp_lt_u32 s19, 524288
    s_cbranch_scc1 L_Rf0_gl_1
    s_branch L_fail
L_Rf0_grfix_5:
    buffer_load_dwordx4 v[46:49], v0, s[4:7], s27 offen offset:0 sc1
    buffer_load_dwordx4 v[30:33], v0, s[4:7], s27 offen offset:1024 sc1
    buffer_load_dwordx4 v[34:37], v0, s[4:7], s27 offen offset:2048 sc1
    buffer_load_dwordx4 v[38:41], v0, s[4:7], s27 offen offset:3072 sc1
    buffer_load_dwordx4 v[42:45], v0, s[4:7], s28 offen offset:0 sc1
    s_add_u32 s19, s19, 1
    s_cmp_lt_u32 s19, 524288
    s_cbranch_scc1 L_Rf0_gr2_4
    s_branch L_fail
L_Rf0_gr2_4:
    v_mfma_f32_16x16x32_bf16 v[50:53], a[240:243], v[10:13], 0
    v_mfma_f32_16x16x32_bf16 v[54:57], a[244:247], v[10:13], 0
    v_mfma_f32_16x16x32_bf16 v[58:61], a[240:243], v[14:17], 0
    v_mfma_f32_16x16x32_bf16 v[62:65], a[244:247], v[14:17], 0
    v_mfma_f32_16x16x32_bf16 v[66:69], a[240:243], v[18:21], 0
    v_mfma_f32_16x16x32_bf16 v[70:73], a[244:247], v[18:21], 0
    v_mfma_f32_16x16x32_bf16 v[74:77], a[240:243], v[22:25], 0
    v_mfma_f32_16x16x32_bf16 v[78:81], a[244:247], v[22:25], 0
    v_mfma_f32_16x16x32_bf16 v[82:85], a[240:243], v[26:29], 0
    v_mfma_f32_16x16x32_bf16 v[86:89], a[244:247], v[26:29], 0
    s_branch L_Rf0_gr_2
L_Rf0_hafix_7:
    buffer_load_dwordx4 v[82:85], v0, s[4:7], s30 offen sc1
    s_add_u32 s19, s19, 1
    s_cmp_lt_u32 s19, 524288
    s_cbranch_scc1 L_Rf0_ha_6
    s_branch L_fail
L_Rf0_hbfix_9:
    buffer_load_dwordx4 v[26:29], v8, s[4:7], s32 offen offset:0 sc1
    buffer_load_dwordx4 v[30:33], v8, s[4:7], s32 offen offset:2560 sc1
    buffer_load_dwordx4 v[34:37], v8, s[4:7], s33 offen offset:0 sc1
    buffer_load_dwordx4 v[38:41], v8, s[4:7], s33 offen offset:2560 sc1
    buffer_load_dwordx4 v[42:45], v8, s[4:7], s34 offen offset:0 sc1
    buffer_load_dwordx4 v[46:49], v8, s[4:7], s34 offen offset:2560 sc1
    buffer_load_dwordx4 v[50:53], v8, s[4:7], s35 offen offset:0 sc1
    buffer_load_dwordx4 v[54:57], v8, s[4:7], s35 offen offset:2560 sc1
    s_add_u32 s19, s19, 1
    s_cmp_lt_u32 s19, 524288
    s_cbranch_scc1 L_Rf0_hb_8
    s_branch L_fail
L_R0_slow:
L_Rs0_top:
    s_barrier
    buffer_load_dwordx4 v[10:13], v0, s[4:7], s25 offen offset:0 sc1
    buffer_load_dwordx4 v[14:17], v0, s[4:7], s25 offen offset:1024 sc1
    buffer_load_dwordx4 v[18:21], v0, s[4:7], s25 offen offset:2048 sc1
    buffer_load_dwordx4 v[22:25], v0, s[4:7], s25 offen offset:3072 sc1
    buffer_load_dwordx4 v[26:29], v0, s[4:7], s26 offen offset:0 sc1
    s_barrier
    buffer_load_dwordx4 v[46:49], v0, s[4:7], s27 offen offset:0 sc1
    buffer_load_dwordx4 v[30:33], v0, s[4:7], s27 offen offset:1024 sc1
    buffer_load_dwordx4 v[34:37], v0, s[4:7], s27 offen offset:2048 sc1
    buffer_load_dwordx4 v[38:41], v0, s[4:7], s27 offen offset:3072 sc1
    buffer_load_dwordx4 v[42:45], v0, s[4:7], s28 offen offset:0 sc1
    s_mov_b32 s19, 0
L_Rs0_gl_1:
    s_waitcnt vmcnt(9)
    v_mfma_f32_16x16x32_bf16 v[50:53], a[240:243], v[10:13], 0
    v_mfma_f32_16x16x32_bf16 v[54:57], a[244:247], v[10:13], 0
    v_xor_b32 v1, s23, v10
    s_waitcnt vmcnt(8)
    v_mfma_f32_16x16x32_bf16 v[58:61], a[240:243], v[14:17], 0
    v_mfma_f32_16x16x32_bf16 v[62:65], a[244:247], v[14:17], 0
    v_bitop3_b32 v1, v1, v14, s23 bitop3:0xf6
    s_waitcnt vmcnt(7)
    v_mfma_f32_16x16x32_bf16 v[66:69], a[240:243], v[18:21], 0
    v_mfma_f32_16x16x32_bf16 v[70:73], a[244:247], v[18:21], 0
    v_bitop3_b32 v1, v1, v18, s23 bitop3:0xf6
    s_waitcnt vmcnt(6)
    v_mfma_f32_16x16x32_bf16 v[74:77], a[240:243], v[22:25], 0
    v_mfma_f32_16x16x32_bf16 v[78:81], a[244:247], v[22:25], 0
    v_bitop3_b32 v1, v1, v22, s23 bitop3:0xf6
    s_waitcnt vmcnt(5)
    v_mfma_f32_16x16x32_bf16 v[82:85], a[240:243], v[26:29], 0
    v_mfma_f32_16x16x32_bf16 v[86:89], a[244:247], v[26:29], 0
    v_bitop3_b32 v1, v1, v26, s23 bitop3:0xf6
    v_and_b32 v1, 1, v1
    v_cmp_ne_u32 vcc, 0, v1
    s_nop 0
    s_cbranch_vccnz L_Rs0_glfix_3
L_Rs0_gr_2:
    s_waitcnt vmcnt(4)
    v_mfma_f32_16x16x32_bf16 v[50:53], a[240:243], v[46:49], v[50:53]
    v_xor_b32 v1, s23, v46
    v_mfma_f32_16x16x32_bf16 v[54:57], a[244:247], v[46:49], v[54:57]
    s_waitcnt vmcnt(3)
    v_mfma_f32_16x16x32_bf16 v[58:61], a[240:243], v[30:33], v[58:61]
    v_bitop3_b32 v1, v1, v30, s23 bitop3:0xf6
    v_mfma_f32_16x16x32_bf16 v[62:65], a[244:247], v[30:33], v[62:65]
    s_nop 1
    v_cvt_pk_bf16_f32 v90, v50, v51
    v_cvt_pk_bf16_f32 v91, v52, v53
    v_cvt_pk_bf16_f32 v92, v54, v55
    v_cvt_pk_bf16_f32 v93, v56, v57
    ds_write_b128 v0, v[90:93] offset:0
    s_waitcnt vmcnt(2)
    v_mfma_f32_16x16x32_bf16 v[66:69], a[240:243], v[34:37], v[66:69]
    v_bitop3_b32 v1, v1, v34, s23 bitop3:0xf6
    v_mfma_f32_16x16x32_bf16 v[70:73], a[244:247], v[34:37], v[70:73]
    v_cvt_pk_bf16_f32 v90, v58, v59
    v_cvt_pk_bf16_f32 v91, v60, v61
    v_cvt_pk_bf16_f32 v92, v62, v63
    v_cvt_pk_bf16_f32 v93, v64, v65
    ds_write_b128 v0, v[90:93] offset:1024
    s_waitcnt vmcnt(1)
    v_mfma_f32_16x16x32_bf16 v[74:77], a[240:243], v[38:41], v[74:77]
    v_bitop3_b32 v1, v1, v38, s23 bitop3:0xf6
    v_mfma_f32_16x16x32_bf16 v[78:81], a[244:247], v[38:41], v[78:81]
    v_cvt_pk_bf16_f32 v90, v66, v67
    v_cvt_pk_bf16_f32 v91, v68, v69
    v_cvt_pk_bf16_f32 v92, v70, v71
    v_cvt_pk_bf16_f32 v93, v72, v73
    ds_write_b128 v0, v[90:93] offset:2048
    s_waitcnt vmcnt(0)
    v_mfma_f32_16x16x32_bf16 v[82:85], a[240:243], v[42:45], v[82:85]
    v_bitop3_b32 v1, v1, v42, s23 bitop3:0xf6
    v_mfma_f32_16x16x32_bf16 v[86:89], a[244:247], v[42:45], v[86:89]
    v_cvt_pk_bf16_f32 v90, v74, v75
    v_cvt_pk_bf16_f32 v91, v76, v77
    v_cvt_pk_bf16_f32 v92, v78, v79
    v_cvt_pk_bf16_f32 v93, v80, v81
    ds_write_b128 v0, v[90:93] offset:3072
    s_nop 0
    v_cvt_pk_bf16_f32 v90, v82, v83
    v_cvt_pk_bf16_f32 v91, v84, v85
    v_cvt_pk_bf16_f32 v92, v86, v87
    v_cvt_pk_bf16_f32 v93, v88, v89
    ds_write_b128 v0, v[90:93] offset:4096
    v_and_b32 v1, 1, v1
    v_cmp_ne_u32 vcc, 0, v1
    s_nop 0
    s_cbranch_vccnz L_Rs0_grfix_5
    s_waitcnt lgkmcnt(0)
    s_barrier
    ds_read_b128 v[10:13], v0 offset:0
    ds_read_b128 v[14:17], v0 offset:1024
    ds_read_b128 v[18:21], v0 offset:2048
    ds_read_b128 v[22:25], v0 offset:3072
    ds_read_b128 v[26:29], v0 offset:4096
    s_waitcnt lgkmcnt(4)
    v_mfma_f32_16x16x32_bf16 v[46:49], a[0:3], v[10:13], 0
    s_mov_b32 m0, 35840
    v_mfma_f32_16x16x32_bf16 v[50:53], a[80:83], v[10:13], 0
    v_mfma_f32_16x16x32_bf16 v[54:57], a[160:163], v[10:13], 0
    ds_read_b128 v[10:13], v0 offset:5120
    s_waitcnt lgkmcnt(4)
    v_mfma_f32_16x16x32_bf16 v[46:49], a[4:7], v[14:17], v[46:49]
    buffer_load_dwordx4 v0, s[4:7], s56 offen offset:0 sc1 lds
    v_mfma_f32_16x16x32_bf16 v[50:53], a[84:87], v[14:17], v[50:53]
    v_mfma_f32_16x16x32_bf16 v[54:57], a[164:167], v[14:17], v[54:57]
    ds_read_b128 v[14:17], v0 offset:6144
    s_waitcnt lgkmcnt(4)
    v_mfma_f32_16x16x32_bf16 v[46:49], a[8:11], v[18:21], v[46:49]
    buffer_load_dwordx4 v0, s[4:7], s56 offen offset:1024 sc1 lds
    v_mfma_f32_16x16x32_bf16 v[50:53], a[88:91], v[18:21], v[50:53]
    v_mfma_f32_16x16x32_bf16 v[54:57], a[168:171], v[18:21], v[54:57]
    ds_read_b128 v[18:21], v0 offset:7168
    s_waitcnt lgkmcnt(4)
    v_mfma_f32_16x16x32_bf16 v[46:49], a[12:15], v[22:25], v[46:49]
    buffer_load_dwordx4 v0, s[4:7], s56 offen offset:2048 sc1 lds
    v_mfma_f32_16x16x32_bf16 v[50:53], a[92:95], v[22:25], v[50:53]
    v_mfma_f32_16x16x32_bf16 v[54:57], a[172:175], v[22:25], v[54:57]
    ds_read_b128 v[22:25], v0 offset:8192
    s_waitcnt lgkmcnt(4)
    v_mfma_f32_16x16x32_bf16 v[46:49], a[16:19], v[26:29], v[46:49]
    v_mfma_f32_16x16x32_bf16 v[50:53], a[96:99], v[26:29], v[50:53]
    v_mfma_f32_16x16x32_bf16 v[54:57], a[176:179], v[26:29], v[54:57]
    ds_read_b128 v[26:29], v0 offset:9216
    s_waitcnt lgkmcnt(4)
    v_mfma_f32_16x16x32_bf16 v[46:49], a[20:23], v[10:13], v[46:49]
    v_mfma_f32_16x16x32_bf16 v[50:53], a[100:103], v[10:13], v[50:53]
    v_mfma_f32_16x16x32_bf16 v[54:57], a[180:183], v[10:13], v[54:57]
    ds_read_b128 v[10:13], v0 offset:10240
    s_waitcnt lgkmcnt(4)
    v_mfma_f32_16x16x32_bf16 v[46:49], a[24:27], v[14:17], v[46:49]
    v_mfma_f32_16x16x32_bf16 v[50:53], a[104:107], v[14:17], v[50:53]
    v_mfma_f32_16x16x32_bf16 v[54:57], a[184:187], v[14:17], v[54:57]
    ds_read_b128 v[14:17], v0 offset:11264
    s_waitcnt lgkmcnt(4)
    v_mfma_f32_16x16x32_bf16 v[46:49], a[28:31], v[18:21], v[46:49]
    v_mfma_f32_16x16x32_bf16 v[50:53], a[108:111], v[18:21], v[50:53]
    v_mfma_f32_16x16x32_bf16 v[54:57], a[188:191], v[18:21], v[54:57]
    ds_read_b128 v[18:21], v0 offset:12288
    s_waitcnt lgkmcnt(4)
    v_mfma_f32_16x16x32_bf16 v[46:49], a[32:35], v[22:25], v[46:49]
    v_mfma_f32_16x16x32_bf16 v[50:53], a[112:115], v[22:25], v[50:53]
    v_mfma_f32_16x16x32_bf16 v[54:57], a[192:195], v[22:25], v[54:57]
    ds_read_b128 v[22:25], v0 offset:13312
    s_waitcnt lgkmcnt(4)
    v_mfma_f32_16x16x32_bf16 v[46:49], a[36:39], v[26:29], v[46:49]
    v_mfma_f32_16x16x32_bf16 v[50:53], a[116:119], v[26:29], v[50:53]
    v_mfma_f32_16x16x32_bf16 v[54:57], a[196:199], v[26:29], v[54:57]
    ds_read_b128 v[26:29], v0 offset:14336
    s_waitcnt lgkmcnt(4)
    v_mfma_f32_16x16x32_bf16 v[46:49], a[40:43], v[10:13], v[46:49]
    v_mfma_f32_16x16x32_bf16 v[50:53], a[120:123], v[10:13], v[50:53]
    v_mfma_f32_16x16x32_bf16 v[54:57], a[200:203], v[10:13], v[54:57]
    ds_read_b128 v[10:13], v0 offset:15360
    s_waitcnt lgkmcnt(4)
    v_mfma_f32_16x16x32_bf16 v[46:49], a[44:47], v[14:17], v[46:49]
    v_mfma_f32_16x16x32_bf16 v[50:53], a[124:127], v[14:17], v[50:53]
    v_mfma_f32_16x16x32_bf16 v[54:57], a[204:207], v[14:17], v[54:57]
    ds_read_b128 v[14:17], v0 offset:16384
    s_waitcnt lgkmcnt(4)
    v_mfma_f32_16x16x32_bf16 v[46:49], a[48:51], v[18:21], v[46:49]
    v_mfma_f32_16x16x32_bf16 v[50:53], a[128:131], v[18:21], v[50:53]
    v_mfma_f32_16x16x32_bf16 v[54:57], a[208:211], v[18:21], v[54:57]
    ds_read_b128 v[18:21], v0 offset:17408
    s_waitcnt lgkmcnt(4)
    v_mfma_f32_16x16x32_bf16 v[46:49], a[52:55], v[22:25], v[46:49]
    v_mfma_f32_16x16x32_bf16 v[50:53], a[132:135], v[22:25], v[50:53]
    v_mfma_f32_16x16x32_bf16 v[54:57], a[212:215], v[22:25], v[54:57]
    ds_read_b128 v[22:25], v0 offset:18432
    s_waitcnt lgkmcnt(4)
    v_mfma_f32_16x16x32_bf16 v[46:49], a[56:59], v[26:29], v[46:49]
    v_mfma_f32_16x16x32_bf16 v[50:53], a[136:139], v[26:29], v[50:53]
    v_mfma_f32_16x16x32_bf16 v[54:57], a[216:219], v[26:29], v[54:57]
    ds_read_b128 v[26:29], v0 offset:19456
    s_waitcnt lgkmcnt(4)
    v_mfma_f32_16x16x32_bf16 v[46:49], a[60:63], v[10:13], v[46:49]
    v_mfma_f32_16x16x32_bf16 v[50:53], a[140:143], v[10:13], v[50:53]
    v_mfma_f32_16x16x32_bf16 v[54:57], a[220:223], v[10:13], v[54:57]
    ds_read_b128 v[10:13], v0 offset:0
    s_waitcnt lgkmcnt(4)
    v_mfma_f32_16x16x32_bf16 v[46:49], a[64:67], v[14:17], v[46:49]
    v_mfma_f32_16x16x32_bf16 v[50:53], a[144:147], v[14:17], v[50:53]
    v_mfma_f32_16x16x32_bf16 v[54:57], a[224:227], v[14:17], v[54:57]
    ds_read_b128 v[14:17], v0 offset:1024
    s_waitcnt lgkmcnt(4)
    v_mfma_f32_16x16x32_bf16 v[46:49], a[68:71], v[18:21], v[46:49]
    v_mfma_f32_16x16x32_bf16 v[50:53], a[148:151], v[18:21], v[50:53]
    v_mfma_f32_16x16x32_bf16 v[54:57], a[228:231], v[18:21], v[54:57]
    ds_read_b128 v[18:21], v0 offset:2048
    s_waitcnt lgkmcnt(4)
    v_mfma_f32_16x16x32_bf16 v[46:49], a[72:75], v[22:25], v[46:49]
    v_mfma_f32_16x16x32_bf16 v[50:53], a[152:155], v[22:25], v[50:53]
    v_mfma_f32_16x16x32_bf16 v[54:57], a[232:235], v[22:25], v[54:57]
    ds_read_b128 v[22:25], v0 offset:3072
    s_waitcnt lgkmcnt(4)
    v_mfma_f32_16x16x32_bf16 v[46:49], a[76:79], v[26:29], v[46:49]
    v_mfma_f32_16x16x32_bf16 v[50:53], a[156:159], v[26:29], v[50:53]
    v_mfma_f32_16x16x32_bf16 v[54:57], a[236:239], v[26:29], v[54:57]
    ds_read_b128 v[26:29], v0 offset:4096
    s_waitcnt lgkmcnt(4)
    v_mfma_f32_16x16x32_bf16 v[30:33], v[10:13], v[96:99], 0
    v_mfma_f32_16x16x32_bf16 v[34:37], v[10:13], v[176:179], 0
    ds_read_b128 v[10:13], v0 offset:5120
    s_nop 0
    v_cvt_pk_bf16_f32 v82, v46, v47
    v_cvt_pk_bf16_f32 v83, v48, v49
    ds_write_b64 v0, v[82:83] offset:20480
    v_cvt_pk_bf16_f32 v84, v50, v51
    v_cvt_pk_bf16_f32 v85, v52, v53
    ds_write_b64 v0, v[84:85] offset:20488
    v_cvt_pk_bf16_f32 v86, v54, v55
    v_cvt_pk_bf16_f32 v87, v56, v57
    ds_write_b64 v0, v[86:87] offset:21504
    s_waitcnt lgkmcnt(7)
    v_mfma_f32_16x16x32_bf16 v[30:33], v[14:17], v[100:103], v[30:33]
    v_mfma_f32_16x16x32_bf16 v[34:37], v[14:17], v[180:183], v[34:37]
    ds_read_b128 v[14:17], v0 offset:6144
    s_waitcnt lgkmcnt(1)
    s_barrier
    ds_read_b128 v[58:61], v0 offset:23552
    ds_read_b128 v[46:49], v0 offset:20480
    ds_read_b128 v[62:65], v0 offset:24576
    ds_read_b128 v[50:53], v0 offset:21504
    ds_read_b128 v[66:69], v0 offset:25600
    ds_read_b128 v[54:57], v0 offset:22528
    v_mfma_f32_16x16x32_bf16 v[30:33], v[18:21], v[104:107], v[30:33]
    v_mfma_f32_16x16x32_bf16 v[34:37], v[18:21], v[184:187], v[34:37]
    ds_read_b128 v[18:21], v0 offset:7168
    v_mfma_f32_16x16x32_bf16 v[30:33], v[22:25], v[108:111], v[30:33]
    v_mfma_f32_16x16x32_bf16 v[34:37], v[22:25], v[188:191], v[34:37]
    ds_read_b128 v[22:25], v0 offset:8192
    s_waitcnt lgkmcnt(6)
    v_mfma_f32_16x16x32_bf16 v[38:41], v[58:61], v[46:49], 0
    s_waitcnt lgkmcnt(4)
    v_mfma_f32_16x16x32_bf16 v[38:41], v[62:65], v[50:53], v[38:41]
    s_waitcnt lgkmcnt(2)
    v_mfma_f32_16x16x32_bf16 v[38:41], v[66:69], v[54:57], v[38:41]
    v_mfma_f32_16x16x32_bf16 v[30:33], v[26:29], v[112:115], v[30:33]
    v_mfma_f32_16x16x32_bf16 v[34:37], v[26:29], v[192:195], v[34:37]
    ds_read_b128 v[26:29], v0 offset:9216
    s_nop 4
    v_and_or_b32 v38, v38, -2, s22
    buffer_store_dwordx4 v[38:41], v0, s[4:7], s29 offen sc1
    v_mfma_f32_16x16x32_bf16 v[30:33], v[10:13], v[116:119], v[30:33]
    v_mfma_f32_16x16x32_bf16 v[34:37], v[10:13], v[196:199], v[34:37]
    ds_read_b128 v[10:13], v0 offset:10240
    v_mfma_f32_16x16x32_bf16 v[30:33], v[14:17], v[120:123], v[30:33]
    v_mfma_f32_16x16x32_bf16 v[34:37], v[14:17], v[200:203], v[34:37]
    ds_read_b128 v[14:17], v0 offset:11264
    s_waitcnt lgkmcnt(4)
    v_mfma_f32_16x16x32_bf16 v[30:33], v[18:21], v[124:127], v[30:33]
    v_mfma_f32_16x16x32_bf16 v[34:37], v[18:21], v[204:207], v[34:37]
    ds_read_b128 v[18:21], v0 offset:12288
    s_waitcnt lgkmcnt(4)
    v_mfma_f32_16x16x32_bf16 v[30:33], v[22:25], v[128:131], v[30:33]
    v_mfma_f32_16x16x32_bf16 v[34:37], v[22:25], v[208:211], v[34:37]
    ds_read_b128 v[22:25], v0 offset:13312
    s_waitcnt lgkmcnt(4)
    v_mfma_f32_16x16x32_bf16 v[30:33], v[26:29], v[132:135], v[30:33]
    v_mfma_f32_16x16x32_bf16 v[34:37], v[26:29], v[212:215], v[34:37]
    ds_read_b128 v[26:29], v0 offset:14336
    s_waitcnt lgkmcnt(4)
    v_mfma_f32_16x16x32_bf16 v[30:33], v[10:13], v[136:139], v[30:33]
    v_mfma_f32_16x16x32_bf16 v[34:37], v[10:13], v[216:219], v[34:37]
    ds_read_b128 v[10:13], v0 offset:15360
    s_waitcnt lgkmcnt(4)
    v_mfma_f32_16x16x32_bf16 v[30:33], v[14:17], v[140:143], v[30:33]
    v_mfma_f32_16x16x32_bf16 v[34:37], v[14:17], v[220:223], v[34:37]
    ds_read_b128 v[14:17], v0 offset:16384
    s_waitcnt lgkmcnt(4)
    v_mfma_f32_16x16x32_bf16 v[30:33], v[18:21], v[144:147], v[30:33]
    v_mfma_f32_16x16x32_bf16 v[34:37], v[18:21], v[224:227], v[34:37]
    ds_read_b128 v[18:21], v0 offset:17408
    s_waitcnt lgkmcnt(4)
    v_mfma_f32_16x16x32_bf16 v[30:33], v[22:25], v[148:151], v[30:33]
    v_mfma_f32_16x16x32_bf16 v[34:37], v[22:25], v[228:231], v[34:37]
    ds_read_b128 v[22:25], v0 offset:18432
    v_pk_mul_f32 v[42:43], v[38:39], s[52:53]
    v_pk_mul_f32 v[44:45], v[40:41], s[52:53]
    v_mov_b32 v1, 0xff800000
    v_cndmask_b32 v42, v1, v42, s[50:51]
    v_cndmask_b32 v43, v1, v43, s[50:51]
    v_cndmask_b32 v44, v1, v44, s[50:51]
    v_cndmask_b32 v45, v1, v45, s[50:51]
    s_waitcnt vmcnt(0)
    buffer_load_dwordx4 v[82:85], v0, s[4:7], s30 offen sc1
    s_mov_b32 s19, 0
    s_waitcnt lgkmcnt(4)
    v_mfma_f32_16x16x32_bf16 v[30:33], v[26:29], v[152:155], v[30:33]
    v_mfma_f32_16x16x32_bf16 v[34:37], v[26:29], v[232:235], v[34:37]
    ds_read_b128 v[26:29], v0 offset:19456
    s_waitcnt lgkmcnt(4)
    v_mfma_f32_16x16x32_bf16 v[30:33], v[10:13], v[156:159], v[30:33]
    v_mfma_f32_16x16x32_bf16 v[34:37], v[10:13], v[236:239], v[34:37]
    s_waitcnt lgkmcnt(3)
    v_mfma_f32_16x16x32_bf16 v[30:33], v[14:17], v[160:163], v[30:33]
    v_mfma_f32_16x16x32_bf16 v[34:37], v[14:17], v[240:243], v[34:37]
    s_waitcnt lgkmcnt(2)
    v_mfma_f32_16x16x32_bf16 v[30:33], v[18:21], v[164:167], v[30:33]
    v_mfma_f32_16x16x32_bf16 v[34:37], v[18:21], v[244:247], v[34:37]
    s_waitcnt lgkmcnt(1)
    v_mfma_f32_16x16x32_bf16 v[30:33], v[22:25], v[168:171], v[30:33]
    v_mfma_f32_16x16x32_bf16 v[34:37], v[22:25], v[248:251], v[34:37]
    s_waitcnt lgkmcnt(0)
    v_mfma_f32_16x16x32_bf16 v[30:33], v[26:29], v[172:175], v[30:33]
    v_mfma_f32_16x16x32_bf16 v[34:37], v[26:29], v[252:255], v[34:37]
    s_nop 6
    v_cvt_pk_bf16_f32 v88, v30, v31
    v_cvt_pk_bf16_f32 v89, v32, v33
    v_cvt_pk_bf16_f32 v90, v34, v35
    v_cvt_pk_bf16_f32 v91, v36, v37
    s_add_u32 s60, s31, 3072
    s_cmp_eq_u32 s20, 68
    s_cbranch_scc1 L_Rs0_tail
L_Rs0_ha_6:
    s_waitcnt vmcnt(0)
    v_lshlrev_b32 v1, 31, v82
    v_pk_fma_f32 v[38:39], v[82:83], s[52:53], v[42:43]
    v_pk_fma_f32 v[40:41], v[84:85], s[52:53], v[44:45]
    ds_write_b128 v0, v[38:41] offset:26624
    v_cmp_ne_u32 vcc, s21, v1
    s_nop 0
    s_cbranch_vccnz L_Rs0_hafix_7
    s_waitcnt vmcnt(0) lgkmcnt(0)
    s_barrier
    ds_read_b128 v[10:13], v0 offset:26624
    ds_read_b128 v[14:17], v0 offset:27648
    ds_read_b128 v[18:21], v0 offset:28672
    ds_read_b128 v[58:61], v0 offset:35840
    ds_read_b128 v[62:65], v0 offset:36864
    ds_read_b128 v[66:69], v0 offset:48128
    ds_read_b128 v[70:73], v0 offset:49152
    buffer_store_dwordx4 v[88:91], v0, s[4:7], s60 offen sc1
    s_waitcnt lgkmcnt(5)
    v_max3_f32 v22, v10, v11, v12
    v_max3_f32 v23, v13, v14, v15
    v_max3_f32 v22, v22, v16, v17
    s_waitcnt lgkmcnt(4)
    v_max3_f32 v23, v23, v18, v19
    v_max3_f32 v22, v22, v20, v21
    v_max_f32 v22, v22, v23
    v_mov_b32 v23, v22
    ds_read_b128 v[30:33], v2 offset:0
    ds_read_b128 v[34:37], v2 offset:1024
    v_permlane32_swap_b32 v22, v23
    v_max_f32 v22, v22, v23
    v_mov_b32 v23, v22
    ds_read_b128 v[38:41], v2 offset:2048
    ds_read_b128 v[42:45], v2 offset:3072
    v_permlane16_swap_b32 v22, v23
    v_max_f32 v22, v22, v23
    v_pk_add_f32 v[10:11], v[10:11], v[22:23] op_sel_hi:[1,0] neg_lo:[0,1] neg_hi:[0,1]
    v_pk_add_f32 v[12:13], v[12:13], v[22:23] op_sel_hi:[1,0] neg_lo:[0,1] neg_hi:[0,1]
    v_pk_add_f32 v[14:15], v[14:15], v[22:23] op_sel_hi:[1,0] neg_lo:[0,1] neg_hi:[0,1]
    v_pk_add_f32 v[16:17], v[16:17], v[22:23] op_sel_hi:[1,0] neg_lo:[0,1] neg_hi:[0,1]
    v_pk_add_f32 v[18:19], v[18:19], v[22:23] op_sel_hi:[1,0] neg_lo:[0,1] neg_hi:[0,1]
    v_pk_add_f32 v[20:21], v[20:21], v[22:23] op_sel_hi:[1,0] neg_lo:[0,1] neg_hi:[0,1]
    v_exp_f32 v10, v10
    v_exp_f32 v11, v11
    v_exp_f32 v12, v12
    v_exp_f32 v13, v13
    v_exp_f32 v14, v14
    v_exp_f32 v15, v15
    v_cvt_pk_bf16_f32 v24, v10, v11
    v_cvt_pk_bf16_f32 v25, v12, v13
    v_exp_f32 v16, v16
    v_exp_f32 v17, v17
    v_mfma_f32_16x16x16_bf16 v[46:49], v[88:89], v[24:25], 0
    v_mfma_f32_16x16x16_bf16 v[82:85], v[90:91], v[24:25], 0
    v_exp_f32 v18, v18
    v_exp_f32 v19, v19
    v_exp_f32 v20, v20
    v_exp_f32 v21, v21
    v_cvt_pk_bf16_f32 v26, v14, v15
    v_cvt_pk_bf16_f32 v27, v16, v17
    v_cvt_pk_bf16_f32 v28, v18, v19
    v_cvt_pk_bf16_f32 v29, v20, v21
    v_pk_add_f32 v[22:23], v[10:11], v[12:13]
    v_pk_add_f32 v[14:15], v[14:15], v[16:17]
    s_waitcnt lgkmcnt(4)
    v_mfma_f32_16x16x32_bf16 v[50:53], v[58:61], v[26:29], v[46:49]
    v_pk_add_f32 v[18:19], v[18:19], v[20:21]
    v_mfma_f32_16x16x32_bf16 v[54:57], v[66:69], v[26:29], v[46:49]
    v_pk_add_f32 v[22:23], v[22:23], v[14:15]
    v_pk_add_f32 v[22:23], v[22:23], v[18:19]
    v_mfma_f32_16x16x32_bf16 v[10:13], v[62:65], v[26:29], v[82:85]
    v_add_f32 v22, v22, v23
    v_mfma_f32_16x16x32_bf16 v[14:17], v[70:73], v[26:29], v[82:85]
    v_mov_b32 v23, v22
    ds_read_b128 v[74:77], v2 offset:4096
    ds_read_b128 v[78:81], v2 offset:5120
    v_permlane32_swap_b32 v22, v23
    v_add_f32 v22, v22, v23
    v_mov_b32 v23, v22
    v_cndmask_b32 v50, v54, v50, s[48:49]
    v_cndmask_b32 v51, v55, v51, s[48:49]
    v_permlane16_swap_b32 v22, v23
    v_add_f32 v22, v22, v23
    v_rcp_f32 v22, v22
    v_cndmask_b32 v52, v56, v52, s[48:49]
    v_cndmask_b32 v53, v57, v53, s[48:49]
    v_cndmask_b32 v10, v14, v10, s[48:49]
    v_cndmask_b32 v11, v15, v11, s[48:49]
    v_cndmask_b32 v12, v16, v12, s[48:49]
    v_cndmask_b32 v13, v17, v13, s[48:49]
    v_pk_mul_f32 v[50:51], v[50:51], v[22:23] op_sel_hi:[1,0]
    v_pk_mul_f32 v[52:53], v[52:53], v[22:23] op_sel_hi:[1,0]
    v_cvt_pk_bf16_f32 v24, v50, v51
    v_cvt_pk_bf16_f32 v25, v52, v53
    v_pk_mul_f32 v[10:11], v[10:11], v[22:23] op_sel_hi:[1,0]
    v_pk_mul_f32 v[12:13], v[12:13], v[22:23] op_sel_hi:[1,0]
    v_cvt_pk_bf16_f32 v26, v10, v11
    v_cvt_pk_bf16_f32 v27, v12, v13
    ds_write_b128 v0, v[24:27] offset:0
    s_waitcnt lgkmcnt(0)
    s_barrier
    ds_read_b128 v[10:13], v0 offset:0
    ds_read_b128 v[14:17], v0 offset:1024
    ds_read_b128 v[18:21], v0 offset:2048
    s_add_u32 s20, s20, 1
    s_waitcnt lgkmcnt(2)
    v_mfma_f32_16x16x32_bf16 v[46:49], v[30:33], v[10:13], 0
    ds_read_b128 v[30:33], v2 offset:6144
    s_waitcnt lgkmcnt(2)
    v_mfma_f32_16x16x32_bf16 v[46:49], v[34:37], v[14:17], v[46:49]
    ds_read_b128 v[34:37], v2 offset:7168
    s_waitcnt lgkmcnt(2)
    v_mfma_f32_16x16x32_bf16 v[46:49], v[38:41], v[18:21], v[46:49]
    ds_read_b128 v[38:41], v2 offset:8192
    v_mfma_f32_16x16x32_bf16 v[50:53], v[42:45], v[10:13], 0
    ds_read_b128 v[42:45], v2 offset:9216
    v_mfma_f32_16x16x32_bf16 v[50:53], v[74:77], v[14:17], v[50:53]
    ds_read_b128 v[74:77], v2 offset:10240
    v_mfma_f32_16x16x32_bf16 v[50:53], v[78:81], v[18:21], v[50:53]
    ds_read_b128 v[78:81], v2 offset:11264
    s_waitcnt lgkmcnt(3)
    v_mfma_f32_16x16x32_bf16 v[54:57], v[30:33], v[10:13], 0
    ds_read_b128 v[30:33], v2 offset:12288
    v_cvt_pk_bf16_f32 v62, v46, v47
    v_mfma_f32_16x16x32_bf16 v[54:57], v[34:37], v[14:17], v[54:57]
    ds_read_b128 v[34:37], v2 offset:13312
    v_cvt_pk_bf16_f32 v63, v48, v49
    v_and_or_b32 v62, v62, -2, s22
    v_mfma_f32_16x16x32_bf16 v[54:57], v[38:41], v[18:21], v[54:57]
    ds_read_b128 v[38:41], v2 offset:14336
    v_cvt_pk_bf16_f32 v64, v50, v51
    s_waitcnt lgkmcnt(3)
    v_mfma_f32_16x16x32_bf16 v[58:61], v[42:45], v[10:13], 0
    ds_read_b128 v[42:45], v2 offset:15360
    v_cvt_pk_bf16_f32 v65, v52, v53
    buffer_store_dwordx4 v[62:65], v3, s[4:7], s32 offen sc1
    v_mfma_f32_16x16x32_bf16 v[58:61], v[74:77], v[14:17], v[58:61]
    ds_read_b128 v[74:77], v2 offset:16384
    v_mfma_f32_16x16x32_bf16 v[58:61], v[78:81], v[18:21], v[58:61]
    ds_read_b128 v[78:81], v2 offset:17408
    s_waitcnt lgkmcnt(3)
    v_mfma_f32_16x16x32_bf16 v[46:49], v[30:33], v[10:13], 0
    ds_read_b128 v[30:33], v2 offset:18432
    v_cvt_pk_bf16_f32 v66, v54, v55
    v_mfma_f32_16x16x32_bf16 v[46:49], v[34:37], v[14:17], v[46:49]
    ds_read_b128 v[34:37], v2 offset:19456
    v_cvt_pk_bf16_f32 v67, v56, v57
    v_and_or_b32 v66, v66, -2, s22
    v_mfma_f32_16x16x32_bf16 v[46:49], v[38:41], v[18:21], v[46:49]
    ds_read_b128 v[38:41], v2 offset:20480
    v_cvt_pk_bf16_f32 v68, v58, v59
    s_waitcnt lgkmcnt(3)
    v_mfma_f32_16x16x32_bf16 v[50:53], v[42:45], v[10:13], 0
    ds_read_b128 v[42:45], v2 offset:21504
    v_cvt_pk_bf16_f32 v69, v60, v61
    buffer_store_dwordx4 v[66:69], v4, s[4:7], s32 offen sc1
    v_mfma_f32_16x16x32_bf16 v[50:53], v[74:77], v[14:17], v[50:53]
    ds_read_b128 v[74:77], v2 offset:22528
    v_mfma_f32_16x16x32_bf16 v[50:53], v[78:81], v[18:21], v[50:53]
    ds_read_b128 v[78:81], v2 offset:23552
    s_waitcnt lgkmcnt(3)
    v_mfma_f32_16x16x32_bf16 v[54:57], v[30:33], v[10:13], 0
    ds_read_b128 v[30:33], v2 offset:24576
    v_cvt_pk_bf16_f32 v62, v46, v47
    v_mfma_f32_16x16x32_bf16 v[54:57], v[34:37], v[14:17], v[54:57]
    ds_read_b128 v[34:37], v2 offset:25600
    v_cvt_pk_bf16_f32 v63, v48, v49
    v_and_or_b32 v62, v62, -2, s22
    v_mfma_f32_16x16x32_bf16 v[54:57], v[38:41], v[18:21], v[54:57]
    ds_read_b128 v[38:41], v2 offset:26624
    v_cvt_pk_bf16_f32 v64, v50, v51
    s_waitcnt lgkmcnt(3)
    v_mfma_f32_16x16x32_bf16 v[58:61], v[42:45], v[10:13], 0
    ds_read_b128 v[42:45], v2 offset:27648
    v_cvt_pk_bf16_f32 v65, v52, v53
    buffer_store_dwordx4 v[62:65], v5, s[4:7], s32 offen sc1
    v_mfma_f32_16x16x32_bf16 v[58:61], v[74:77], v[14:17], v[58:61]
    ds_read_b128 v[74:77], v2 offset:28672
    v_mfma_f32_16x16x32_bf16 v[58:61], v[78:81], v[18:21], v[58:61]
    ds_read_b128 v[78:81], v2 offset:29696
    s_waitcnt lgkmcnt(3)
    v_mfma_f32_16x16x32_bf16 v[46:49], v[30:33], v[10:13], 0
    v_cvt_pk_bf16_f32 v66, v54, v55
    v_mfma_f32_16x16x32_bf16 v[46:49], v[34:37], v[14:17], v[46:49]
    v_cvt_pk_bf16_f32 v67, v56, v57
    v_and_or_b32 v66, v66, -2, s22
    v_mfma_f32_16x16x32_bf16 v[46:49], v[38:41], v[18:21], v[46:49]
    v_cvt_pk_bf16_f32 v68, v58, v59
    s_waitcnt lgkmcnt(0)
    v_mfma_f32_16x16x32_bf16 v[50:53], v[42:45], v[10:13], 0
    v_cvt_pk_bf16_f32 v69, v60, v61
    buffer_store_dwordx4 v[66:69], v6, s[4:7], s32 offen sc1
    v_mfma_f32_16x16x32_bf16 v[50:53], v[74:77], v[14:17], v[50:53]
    v_mfma_f32_16x16x32_bf16 v[50:53], v[78:81], v[18:21], v[50:53]
    s_nop 0
    v_cvt_pk_bf16_f32 v62, v46, v47
    v_cvt_pk_bf16_f32 v63, v48, v49
    v_and_or_b32 v62, v62, -2, s22
    s_nop 3
    v_cvt_pk_bf16_f32 v64, v50, v51
    v_cvt_pk_bf16_f32 v65, v52, v53
    buffer_store_dwordx4 v[62:65], v7, s[4:7], s32 offen sc1
    v_accvgpr_read_b32 v78, a252
    v_accvgpr_read_b32 v79, a253
    v_accvgpr_read_b32 v80, a254
    v_accvgpr_read_b32 v81, a255
    s_mov_b32 s19, 0
    s_waitcnt vmcnt(0)
    buffer_load_dwordx4 v[26:29], v8, s[4:7], s32 offen offset:0 sc1
    buffer_load_dwordx4 v[30:33], v8, s[4:7], s32 offen offset:2560 sc1
    buffer_load_dwordx4 v[34:37], v8, s[4:7], s33 offen offset:0 sc1
    buffer_load_dwordx4 v[38:41], v8, s[4:7], s33 offen offset:2560 sc1
    buffer_load_dwordx4 v[42:45], v8, s[4:7], s34 offen offset:0 sc1
    buffer_load_dwordx4 v[46:49], v8, s[4:7], s34 offen offset:2560 sc1
    buffer_load_dwordx4 v[50:53], v8, s[4:7], s35 offen offset:0 sc1
    buffer_load_dwordx4 v[54:57], v8, s[4:7], s35 offen offset:2560 sc1
L_Rs0_hb_8:
    s_waitcnt vmcnt(7)
    v_mfma_f32_16x16x32_bf16 v[70:73], a[248:251], v[26:29], 0
    v_xor_b32 v1, s44, v26
    s_waitcnt vmcnt(6)
    v_mfma_f32_16x16x32_bf16 v[70:73], a[248:251], v[30:33], v[70:73]
    v_bitop3_b32 v1, v1, v30, s44 bitop3:0xf6
    s_waitcnt vmcnt(5)
    v_mfma_f32_16x16x32_bf16 v[70:73], a[248:251], v[34:37], v[70:73]
    v_bitop3_b32 v1, v1, v34, s44 bitop3:0xf6
    s_waitcnt vmcnt(4)
    v_mfma_f32_16x16x32_bf16 v[70:73], a[248:251], v[38:41], v[70:73]
    v_bitop3_b32 v1, v1, v38, s44 bitop3:0xf6
    s_waitcnt vmcnt(3)
    v_mfma_f32_16x16x32_bf16 v[70:73], a[248:251], v[42:45], v[70:73]
    v_bitop3_b32 v1, v1, v42, s44 bitop3:0xf6
    s_waitcnt vmcnt(2)
    v_mfma_f32_16x16x32_bf16 v[70:73], a[248:251], v[46:49], v[70:73]
    v_bitop3_b32 v1, v1, v46, s44 bitop3:0xf6
    s_waitcnt vmcnt(1)
    v_mfma_f32_16x16x32_bf16 v[70:73], a[248:251], v[50:53], v[70:73]
    v_bitop3_b32 v1, v1, v50, s44 bitop3:0xf6
    s_waitcnt vmcnt(0)
    v_mfma_f32_16x16x32_bf16 v[70:73], a[248:251], v[54:57], v[70:73]
    v_bitop3_b32 v1, v1, v54, s44 bitop3:0xf6
    v_and_b32 v1, 1, v1
    v_cmp_ne_u32 vcc, 0, v1
    s_nop 0
    s_cbranch_vccnz L_Rs0_hbfix_9
    s_nop 2
    v_cvt_pk_bf16_f32 v74, v70, v71
    v_cvt_pk_bf16_f32 v75, v72, v73
    v_mov_b32 v76, v74
    v_mov_b32 v77, v75
    s_nop 0
    v_permlane16_swap_b32 v74, v76
    v_permlane16_swap_b32 v75, v77
    v_cndmask_b32 v74, v74, v78, s[42:43]
    v_cndmask_b32 v75, v75, v79, s[42:43]
    v_cndmask_b32 v76, v76, v80, s[42:43]
    v_cndmask_b32 v77, v77, v81, s[42:43]
    v_and_or_b32 v74, v74, -2, s24
    s_mov_b64 exec, s[46:47]
    buffer_store_dwordx4 v[74:77], v9, s[4:7], s36 offen sc1
    buffer_store_dwordx4 v[74:77], v9, s[4:7], s37 offen sc1
    s_mov_b64 exec, -1
    s_add_u32 s60, s20, 1
    s_and_b32 s22, s60, 1
    s_lshl_b32 s21, s22, 31
    s_sub_u32 s44, 0, s22
    s_bfe_u32 s23, s20, 0x10001
    s_sub_u32 s23, s23, 1
    s_lshr_b32 s24, s60, 1
    s_andn2_b32 s24, 1, s24
    s_lshl_b32 s61, s14, 15
    s_add_u32 s61, s61, 1179648
    s_and_b32 s25, s20, 1
    s_lshl_b32 s25, s25, 16
    s_add_u32 s25, s25, s61
    s_add_u32 s25, s25, 0
    s_add_u32 s26, s25, 4096
    s_lshl_b32 s36, s22, 16
    s_add_u32 s36, s36, s61
    s_lshl_b32 s27, s20, 1
    s_add_u32 s37, s27, 2
    s_add_u32 s37, s37, s14
    s_mul_i32 s37, s37, 20480
    s_add_u32 s37, s37, 2621440
    s_add_u32 s27, s27, 1
    s_sub_u32 s27, s27, s14
    s_mul_i32 s27, s27, 20480
    s_add_u32 s27, s27, 2621440
    s_add_u32 s28, s27, 4096
    s_lshl_b32 s31, s20, 6
    s_add_u32 s31, s31, s13
    s_mul_i32 s31, s31, 6144
    s_add_u32 s31, s31, 5898240
    s_min_u32 s56, s20, 63
    s_lshl_b32 s56, s56, 6
    s_add_u32 s56, s56, s13
    s_mul_i32 s56, s56, 12288
    s_add_u32 s56, s56, 37361664
    s_max_u32 s57, s20, 5
    s_sub_u32 s57, s57, 5
    s_lshl_b32 s57, s57, 6
    s_add_u32 s57, s57, s13
    s_mul_i32 s57, s57, 12288
    s_add_u32 s57, s57, 87693312
    s_cmp_lt_u32 s20, 5
    s_cselect_b32 s57, s56, s57
    s_cmp_gt_u32 s60, 63
    s_cselect_b64 s[42:43], s[38:39], 0
    s_cmp_le_u32 s60, 5
    s_cselect_b64 vcc, s[40:41], 0
    s_or_b64 s[42:43], s[42:43], vcc
    s_waitcnt vmcnt(1)
    s_branch L_Rs0_top
L_Rs0_tail:
    s_waitcnt lgkmcnt(0)
    buffer_store_dwordx4 v[88:91], v0, s[4:7], s60 offen sc1
    s_waitcnt vmcnt(0) lgkmcnt(0)
    s_barrier
    v_mov_b32 v22, 69
    s_mov_b64 exec, 1
    s_mov_b64 exec, -1
    s_waitcnt vmcnt(0)
    s_endpgm
L_Rs0_glfix_3:
    buffer_load_dwordx4 v[10:13], v0, s[4:7], s25 offen offset:0 sc1
    buffer_load_dwordx4 v[14:17], v0, s[4:7], s25 offen offset:1024 sc1
    buffer_load_dwordx4 v[18:21], v0, s[4:7], s25 offen offset:2048 sc1
    buffer_load_dwordx4 v[22:25], v0, s[4:7], s25 offen offset:3072 sc1
    buffer_load_dwordx4 v[26:29], v0, s[4:7], s26 offen offset:0 sc1
    buffer_load_dwordx4 v[46:49], v0, s[4:7], s27 offen offset:0 sc1
    buffer_load_dwordx4 v[30:33], v0, s[4:7], s27 offen offset:1024 sc1
    buffer_load_dwordx4 v[34:37], v0, s[4:7], s27 offen offset:2048 sc1
    buffer_load_dwordx4 v[38:41], v0, s[4:7], s27 offen offset:3072 sc1
    buffer_load_dwordx4 v[42:45], v0, s[4:7], s28 offen offset:0 sc1
    s_add_u32 s19, s19, 1
    s_cmp_lt_u32 s19, 524288
    s_cbranch_scc1 L_Rs0_gl_1
    s_branch L_fail
L_Rs0_grfix_5:
    buffer_load_dwordx4 v[46:49], v0, s[4:7], s27 offen offset:0 sc1
    buffer_load_dwordx4 v[30:33], v0, s[4:7], s27 offen offset:1024 sc1
    buffer_load_dwordx4 v[34:37], v0, s[4:7], s27 offen offset:2048 sc1
    buffer_load_dwordx4 v[38:41], v0, s[4:7], s27 offen offset:3072 sc1
    buffer_load_dwordx4 v[42:45], v0, s[4:7], s28 offen offset:0 sc1
    s_add_u32 s19, s19, 1
    s_cmp_lt_u32 s19, 524288
    s_cbranch_scc1 L_Rs0_gr2_4
    s_branch L_fail
L_Rs0_gr2_4:
    v_mfma_f32_16x16x32_bf16 v[50:53], a[240:243], v[10:13], 0
    v_mfma_f32_16x16x32_bf16 v[54:57], a[244:247], v[10:13], 0
    v_mfma_f32_16x16x32_bf16 v[58:61], a[240:243], v[14:17], 0
    v_mfma_f32_16x16x32_bf16 v[62:65], a[244:247], v[14:17], 0
    v_mfma_f32_16x16x32_bf16 v[66:69], a[240:243], v[18:21], 0
    v_mfma_f32_16x16x32_bf16 v[70:73], a[244:247], v[18:21], 0
    v_mfma_f32_16x16x32_bf16 v[74:77], a[240:243], v[22:25], 0
    v_mfma_f32_16x16x32_bf16 v[78:81], a[244:247], v[22:25], 0
    v_mfma_f32_16x16x32_bf16 v[82:85], a[240:243], v[26:29], 0
    v_mfma_f32_16x16x32_bf16 v[86:89], a[244:247], v[26:29], 0
    s_branch L_Rs0_gr_2
L_Rs0_hafix_7:
    buffer_load_dwordx4 v[82:85], v0, s[4:7], s30 offen sc1
    s_add_u32 s19, s19, 1
    s_cmp_lt_u32 s19, 524288
    s_cbranch_scc1 L_Rs0_ha_6
    s_branch L_fail
L_Rs0_hbfix_9:
    buffer_load_dwordx4 v[26:29], v8, s[4:7], s32 offen offset:0 sc1
    buffer_load_dwordx4 v[30:33], v8, s[4:7], s32 offen offset:2560 sc1
    buffer_load_dwordx4 v[34:37], v8, s[4:7], s33 offen offset:0 sc1
    buffer_load_dwordx4 v[38:41], v8, s[4:7], s33 offen offset:2560 sc1
    buffer_load_dwordx4 v[42:45], v8, s[4:7], s34 offen offset:0 sc1
    buffer_load_dwordx4 v[46:49], v8, s[4:7], s34 offen offset:2560 sc1
    buffer_load_dwordx4 v[50:53], v8, s[4:7], s35 offen offset:0 sc1
    buffer_load_dwordx4 v[54:57], v8, s[4:7], s35 offen offset:2560 sc1
    s_add_u32 s19, s19, 1
    s_cmp_lt_u32 s19, 524288
    s_cbranch_scc1 L_Rs0_hb_8
    s_branch L_fail
L_R1_start:
    s_lshr_b32 s14, s13, 5
    s_and_b32 s15, s13, 31
    s_mov_b32 s62, 17920
    v_lshlrev_b32 v10, 4, v0
    v_mov_b32 v12, 0
    v_mov_b32 v13, 0
    v_mov_b32 v14, 0
    v_mov_b32 v15, 0
    v_mov_b32 v16, -1
    v_mov_b32 v17, -1
    v_mov_b32 v18, -1
    v_mov_b32 v19, -1
    s_lshl_b32 s60, s13, 12
    s_add_u32 s60, s60, 918528
    buffer_store_dwordx4 v[12:15], v10, s[4:7], s60 offen sc1
    s_mul_i32 s60, s13, 20480
    s_add_u32 s60, s60, 1315840
    buffer_store_dwordx4 v[12:15], v10, s[4:7], s60 offen sc1
    s_add_u32 s60, s60, 1024
    buffer_store_dwordx4 v[12:15], v10, s[4:7], s60 offen sc1
    s_add_u32 s60, s60, 1024
    buffer_store_dwordx4 v[12:15], v10, s[4:7], s60 offen sc1
    s_add_u32 s60, s60, 1024
    buffer_store_dwordx4 v[12:15], v10, s[4:7], s60 offen sc1
    s_add_u32 s60, s60, 1024
    buffer_store_dwordx4 v[12:15], v10, s[4:7], s60 offen sc1
    s_add_u32 s60, s60, 1024
    s_mul_i32 s61, s15, 640
    v_add_u32 v11, s61, v10
    s_mov_b32 exec_hi, 0xff
    s_lshl_b32 s60, s14, 15
    s_add_u32 s60, s60, 1245184
    buffer_store_dwordx4 v[12:15], v11, s[4:7], s60 offen sc1
    s_mul_i32 s60, s14, 20480
    s_add_u32 s60, s60, 2662400
    buffer_store_dwordx4 v[12:15], v11, s[4:7], s60 offen sc1
    s_add_u32 s60, s60, 163840
    buffer_store_dwordx4 v[12:15], v11, s[4:7], s60 offen sc1
    s_add_u32 s60, s60, 163840
    buffer_store_dwordx4 v[12:15], v11, s[4:7], s60 offen sc1
    s_add_u32 s60, s60, 163840
    buffer_store_dwordx4 v[12:15], v11, s[4:7], s60 offen sc1
    s_add_u32 s60, s60, 163840
    buffer_store_dwordx4 v[12:15], v11, s[4:7], s60 offen sc1
    s_add_u32 s60, s60, 163840
    buffer_store_dwordx4 v[12:15], v11, s[4:7], s60 offen sc1
    s_add_u32 s60, s60, 163840
    buffer_store_dwordx4 v[12:15], v11, s[4:7], s60 offen sc1
    s_add_u32 s60, s60, 163840
    buffer_store_dwordx4 v[12:15], v11, s[4:7], s60 offen sc1
    s_add_u32 s60, s60, 163840
    buffer_store_dwordx4 v[12:15], v11, s[4:7], s60 offen sc1
    s_add_u32 s60, s60, 163840
    buffer_store_dwordx4 v[12:15], v11, s[4:7], s60 offen sc1
    s_add_u32 s60, s60, 163840
    buffer_store_dwordx4 v[12:15], v11, s[4:7], s60 offen sc1
    s_add_u32 s60, s60, 163840
    buffer_store_dwordx4 v[12:15], v11, s[4:7], s60 offen sc1
    s_add_u32 s60, s60, 163840
    buffer_store_dwordx4 v[12:15], v11, s[4:7], s60 offen sc1
    s_add_u32 s60, s60, 163840
    buffer_store_dwordx4 v[12:15], v11, s[4:7], s60 offen sc1
    s_add_u32 s60, s60, 163840
    buffer_store_dwordx4 v[12:15], v11, s[4:7], s60 offen sc1
    s_add_u32 s60, s60, 163840
    buffer_store_dwordx4 v[12:15], v11, s[4:7], s60 offen sc1
    s_add_u32 s60, s60, 163840
    buffer_store_dwordx4 v[12:15], v11, s[4:7], s60 offen sc1
    s_add_u32 s60, s60, 163840
    s_mov_b64 exec, 1
    s_lshl_b32 s54, s13, 9
    s_lshr_b32 s55, s13, 1
    s_mul_i32 s55, s55, 1536
    s_add_u32 s55, s55, 32768
    s_add_u32 s54, s54, 128
    buffer_store_dword v12, v10, s[4:7], s54 offen sc1
    s_mov_b64 exec, -1
    v_add_u32 v38, 0, v0
    v_mul_u32_u24 v39, 10923, v38
    v_lshrrev_b32 v39, 16, v39
    v_mul_u32_u24 v20, 6, v39
    v_sub_u32 v20, v38, v20
    v_lshrrev_b32 v20, 0, v20
    v_lshlrev_b32 v20, 4, v20
    v_mul_u32_u24 v39, 12288, v39
    v_add_u32 v20, v20, v39
    v_add_u32 v38, 64, v0
    v_mul_u32_u24 v39, 10923, v38
    v_lshrrev_b32 v39, 16, v39
    v_mul_u32_u24 v21, 6, v39
    v_sub_u32 v21, v38, v21
    v_lshrrev_b32 v21, 0, v21
    v_lshlrev_b32 v21, 4, v21
    v_mul_u32_u24 v39, 12288, v39
    v_add_u32 v21, v21, v39
    v_add_u32 v38, 128, v0
    v_mul_u32_u24 v39, 10923, v38
    v_lshrrev_b32 v39, 16, v39
    v_mul_u32_u24 v22, 6, v39
    v_sub_u32 v22, v38, v22
    v_lshrrev_b32 v22, 0, v22
    v_lshlrev_b32 v22, 4, v22
    v_mul_u32_u24 v39, 12288, v39
    v_add_u32 v22, v22, v39
    v_add_u32 v38, 0, v0
    v_mul_u32_u24 v39, 16385, v38
    v_lshrrev_b32 v39, 16, v39
    v_mul_u32_u24 v23, 4, v39
    v_sub_u32 v23, v38, v23
    v_lshrrev_b32 v23, 0, v23
    v_lshlrev_b32 v23, 4, v23
    v_mul_u32_u24 v39, 12288, v39
    v_add_u32 v23, v23, v39
    v_add_u32 v38, 64, v0
    v_mul_u32_u24 v39, 16385, v38
    v_lshrrev_b32 v39, 16, v39
    v_mul_u32_u24 v24, 4, v39
    v_sub_u32 v24, v38, v24
    v_lshrrev_b32 v24, 0, v24
    v_lshlrev_b32 v24, 4, v24
    v_mul_u32_u24 v39, 12288, v39
    v_add_u32 v24, v24, v39
    v_add_u32 v38, 0, v0
    v_mul_u32_u24 v39, 3277, v38
    v_lshrrev_b32 v39, 16, v39
    v_mul_u32_u24 v25, 20, v39
    v_sub_u32 v25, v38, v25
    v_lshrrev_b32 v25, 0, v25
    v_lshlrev_b32 v25, 4, v25
    v_mul_u32_u24 v39, 1280, v39
    v_add_u32 v25, v25, v39
    v_add_u32 v38, 64, v0
    v_mul_u32_u24 v39, 3277, v38
    v_lshrrev_b32 v39, 16, v39
    v_mul_u32_u24 v26, 20, v39
    v_sub_u32 v26, v38, v26
    v_lshrrev_b32 v26, 0, v26
    v_lshlrev_b32 v26, 4, v26
    v_mul_u32_u24 v39, 1280, v39
    v_add_u32 v26, v26, v39
    v_add_u32 v38, 128, v0
    v_mul_u32_u24 v39, 3277, v38
    v_lshrrev_b32 v39, 16, v39
    v_mul_u32_u24 v27, 20, v39
    v_sub_u32 v27, v38, v27
    v_lshrrev_b32 v27, 0, v27
    v_lshlrev_b32 v27, 4, v27
    v_mul_u32_u24 v39, 1280, v39
    v_add_u32 v27, v27, v39
    v_add_u32 v38, 192, v0
    v_mul_u32_u24 v39, 3277, v38
    v_lshrrev_b32 v39, 16, v39
    v_mul_u32_u24 v28, 20, v39
    v_sub_u32 v28, v38, v28
    v_lshrrev_b32 v28, 0, v28
    v_lshlrev_b32 v28, 4, v28
    v_mul_u32_u24 v39, 1280, v39
    v_add_u32 v28, v28, v39
    v_add_u32 v38, 256, v0
    v_mul_u32_u24 v39, 3277, v38
    v_lshrrev_b32 v39, 16, v39
    v_mul_u32_u24 v29, 20, v39
    v_sub_u32 v29, v38, v29
    v_lshrrev_b32 v29, 0, v29
    v_lshlrev_b32 v29, 4, v29
    v_mul_u32_u24 v39, 1280, v39
    v_add_u32 v29, v29, v39
    v_add_u32 v38, 320, v0
    v_mul_u32_u24 v39, 3277, v38
    v_lshrrev_b32 v39, 16, v39
    v_mul_u32_u24 v30, 20, v39
    v_sub_u32 v30, v38, v30
    v_lshrrev_b32 v30, 0, v30
    v_lshlrev_b32 v30, 4, v30
    v_mul_u32_u24 v39, 1280, v39
    v_add_u32 v30, v30, v39
    v_add_u32 v38, 384, v0
    v_mul_u32_u24 v39, 3277, v38
    v_lshrrev_b32 v39, 16, v39
    v_mul_u32_u24 v31, 20, v39
    v_sub_u32 v31, v38, v31
    v_lshrrev_b32 v31, 0, v31
    v_lshlrev_b32 v31, 4, v31
    v_mul_u32_u24 v39, 1280, v39
    v_add_u32 v31, v31, v39
    v_add_u32 v38, 448, v0
    v_mul_u32_u24 v39, 3277, v38
    v_lshrrev_b32 v39, 16, v39
    v_mul_u32_u24 v32, 20, v39
    v_sub_u32 v32, v38, v32
    v_lshrrev_b32 v32, 0, v32
    v_lshlrev_b32 v32, 4, v32
    v_mul_u32_u24 v39, 1280, v39
    v_add_u32 v32, v32, v39
    v_add_u32 v38, 512, v0
    v_mul_u32_u24 v39, 3277, v38
    v_lshrrev_b32 v39, 16, v39
    v_mul_u32_u24 v33, 20, v39
    v_sub_u32 v33, v38, v33
    v_lshrrev_b32 v33, 0, v33
    v_lshlrev_b32 v33, 4, v33
    v_mul_u32_u24 v39, 1280, v39
    v_add_u32 v33, v33, v39
    v_add_u32 v38, 576, v0
    v_mul_u32_u24 v39, 3277, v38
    v_lshrrev_b32 v39, 16, v39
    v_mul_u32_u24 v34, 20, v39
    v_sub_u32 v34, v38, v34
    v_lshrrev_b32 v34, 0, v34
    v_lshlrev_b32 v34, 4, v34
    v_mul_u32_u24 v39, 1280, v39
    v_add_u32 v34, v34, v39
    v_lshrrev_b32 v35, 2, v0
    v_mul_u32_u24 v35, 96, v35
    v_and_b32 v38, 3, v0
    v_lshl_add_u32 v35, v38, 3, v35
    v_add_u32 v35, s62, v35
    v_lshrrev_b32 v36, 2, v0
    v_mul_u32_u24 v36, 64, v36
    v_and_b32 v38, 3, v0
    v_lshl_add_u32 v36, v38, 3, v36
    v_add_u32 v36, s62, v36
    v_lshrrev_b32 v37, 2, v0
    v_mul_u32_u24 v37, 320, v37
    v_and_b32 v38, 3, v0
    v_lshl_add_u32 v37, v38, 3, v37
    v_add_u32 v37, s62, v37
    v_add_u32 v2, 102400, v10
    s_mov_b32 s8, s68
    s_and_b32 s9, s69, 0xffff
    s_mov_b32 s10, 7864320
    s_mov_b32 s11, 0x20000
    s_mov_b32 s28, s72
    s_and_b32 s29, s73, 0xffff
    s_mov_b32 s30, 7864320
    s_mov_b32 s31, 0x20000
    s_mov_b32 s32, s74
    s_and_b32 s33, s75, 0xffff
    s_mov_b32 s34, 7864320
    s_mov_b32 s35, 0x20000
    s_mul_i32 s60, s13, 192
    s_add_u32 s25, s60, 96
    s_add_u32 s26, s60, 64
    s_mul_i32 s27, s13, 122880
    s_add_u32 s27, s27, 320
    s_add_u32 m0, s62, 0
    s_nop 0
    buffer_load_dwordx4 v20, s[8:11], s25 offen lds
    s_add_u32 m0, s62, 1024
    s_nop 0
    buffer_load_dwordx4 v21, s[8:11], s25 offen lds
    s_add_u32 m0, s62, 2048
    s_nop 0
    buffer_load_dwordx4 v22, s[8:11], s25 offen lds
    s_add_u32 s25, s25, 393216
    s_add_u32 m0, s62, 3072
    s_nop 0
    buffer_load_dwordx4 v20, s[8:11], s25 offen lds
    s_add_u32 m0, s62, 4096
    s_nop 0
    buffer_load_dwordx4 v21, s[8:11], s25 offen lds
    s_add_u32 m0, s62, 5120
    s_nop 0
    buffer_load_dwordx4 v22, s[8:11], s25 offen lds
    s_add_u32 s25, s25, 393216
    s_add_u32 m0, s62, 6144
    s_nop 0
    buffer_load_dwordx4 v20, s[8:11], s25 offen lds
    s_add_u32 m0, s62, 7168
    s_nop 0
    buffer_load_dwordx4 v21, s[8:11], s25 offen lds
    s_add_u32 m0, s62, 8192
    s_nop 0
    buffer_load_dwordx4 v22, s[8:11], s25 offen lds
    s_add_u32 s25, s25, 393216
    s_add_u32 m0, s62, 9216
    s_nop 0
    buffer_load_dwordx4 v20, s[8:11], s25 offen lds
    s_add_u32 m0, s62, 10240
    s_nop 0
    buffer_load_dwordx4 v21, s[8:11], s25 offen lds
    s_add_u32 m0, s62, 11264
    s_nop 0
    buffer_load_dwordx4 v22, s[8:11], s25 offen lds
    s_add_u32 s25, s25, 393216
    s_add_u32 m0, s62, 12288
    s_nop 0
    buffer_load_dwordx4 v20, s[8:11], s25 offen lds
    s_add_u32 m0, s62, 13312
    s_nop 0
    buffer_load_dwordx4 v21, s[8:11], s25 offen lds
    s_add_u32 m0, s62, 14336
    s_nop 0
    buffer_load_dwordx4 v22, s[8:11], s25 offen lds
    s_waitcnt vmcnt(12)
    s_barrier
    s_cmp_lg_u32 s12, 0
    s_cbranch_scc1 L_R1_arr_1
    s_lshl_b32 s3, s18, 2
    s_add_u32 s3, s3, 64
    v_mov_b32 v92, s3
    v_mov_b32 v93, 1
    s_mov_b64 exec, 1
    global_atomic_add v92, v93, s[16:17] sc1
    s_waitcnt vmcnt(0)
    s_mov_b64 exec, -1
L_R1_arr_1:
    ds_read_b64_tr_b16 a[0:1], v35 offset:0
    ds_read_b64_tr_b16 a[2:3], v35 offset:1536
    ds_read_b64_tr_b16 a[80:81], v35 offset:32
    ds_read_b64_tr_b16 a[82:83], v35 offset:1568
    ds_read_b64_tr_b16 a[160:161], v35 offset:64
    ds_read_b64_tr_b16 a[162:163], v35 offset:1600
    s_waitcnt lgkmcnt(0)
    s_add_u32 s25, s25, 393216
    s_add_u32 m0, s62, 0
    s_nop 0
    buffer_load_dwordx4 v20, s[8:11], s25 offen lds
    s_add_u32 m0, s62, 1024
    s_nop 0
    buffer_load_dwordx4 v21, s[8:11], s25 offen lds
    s_add_u32 m0, s62, 2048
    s_nop 0
    buffer_load_dwordx4 v22, s[8:11], s25 offen lds
    s_waitcnt vmcnt(12)
    ds_read_b64_tr_b16 a[4:5], v35 offset:3072
    ds_read_b64_tr_b16 a[6:7], v35 offset:4608
    ds_read_b64_tr_b16 a[84:85], v35 offset:3104
    ds_read_b64_tr_b16 a[86:87], v35 offset:4640
    ds_read_b64_tr_b16 a[164:165], v35 offset:3136
    ds_read_b64_tr_b16 a[166:167], v35 offset:4672
    s_waitcnt lgkmcnt(0)
    s_add_u32 s25, s25, 393216
    s_add_u32 m0, s62, 3072
    s_nop 0
    buffer_load_dwordx4 v20, s[8:11], s25 offen lds
    s_add_u32 m0, s62, 4096
    s_nop 0
    buffer_load_dwordx4 v21, s[8:11], s25 offen lds
    s_add_u32 m0, s62, 5120
    s_nop 0
    buffer_load_dwordx4 v22, s[8:11], s25 offen lds
    s_waitcnt vmcnt(12)
    ds_read_b64_tr_b16 a[8:9], v35 offset:6144
    ds_read_b64_tr_b16 a[10:11], v35 offset:7680
    ds_read_b64_tr_b16 a[88:89], v35 offset:6176
    ds_read_b64_tr_b16 a[90:91], v35 offset:7712
    ds_read_b64_tr_b16 a[168:169], v35 offset:6208
    ds_read_b64_tr_b16 a[170:171], v35 offset:7744
    s_waitcnt lgkmcnt(0)
    s_add_u32 s25, s25, 393216
    s_add_u32 m0, s62, 6144
    s_nop 0
    buffer_load_dwordx4 v20, s[8:11], s25 offen lds
    s_add_u32 m0, s62, 7168
    s_nop 0
    buffer_load_dwordx4 v21, s[8:11], s25 offen lds
    s_add_u32 m0, s62, 8192
    s_nop 0
    buffer_load_dwordx4 v22, s[8:11], s25 offen lds
    s_waitcnt vmcnt(12)
    ds_read_b64_tr_b16 a[12:13], v35 offset:9216
    ds_read_b64_tr_b16 a[14:15], v35 offset:10752
    ds_read_b64_tr_b16 a[92:93], v35 offset:9248
    ds_read_b64_tr_b16 a[94:95], v35 offset:10784
    ds_read_b64_tr_b16 a[172:173], v35 offset:9280
    ds_read_b64_tr_b16 a[174:175], v35 offset:10816
    s_waitcnt lgkmcnt(0)
    s_add_u32 s25, s25, 393216
    s_add_u32 m0, s62, 9216
    s_nop 0
    buffer_load_dwordx4 v20, s[8:11], s25 offen lds
    s_add_u32 m0, s62, 10240
    s_nop 0
    buffer_load_dwordx4 v21, s[8:11], s25 offen lds
    s_add_u32 m0, s62, 11264
    s_nop 0
    buffer_load_dwordx4 v22, s[8:11], s25 offen lds
    s_waitcnt vmcnt(12)
    ds_read_b64_tr_b16 a[16:17], v35 offset:12288
    ds_read_b64_tr_b16 a[18:19], v35 offset:13824
    ds_read_b64_tr_b16 a[96:97], v35 offset:12320
    ds_read_b64_tr_b16 a[98:99], v35 offset:13856
    ds_read_b64_tr_b16 a[176:177], v35 offset:12352
    ds_read_b64_tr_b16 a[178:179], v35 offset:13888
    s_waitcnt lgkmcnt(0)
    s_add_u32 s25, s25, 393216
    s_add_u32 m0, s62, 12288
    s_nop 0
    buffer_load_dwordx4 v20, s[8:11], s25 offen lds
    s_add_u32 m0, s62, 13312
    s_nop 0
    buffer_load_dwordx4 v21, s[8:11], s25 offen lds
    s_add_u32 m0, s62, 14336
    s_nop 0
    buffer_load_dwordx4 v22, s[8:11], s25 offen lds
    s_waitcnt vmcnt(12)
    ds_read_b64_tr_b16 a[20:21], v35 offset:0
    ds_read_b64_tr_b16 a[22:23], v35 offset:1536
    ds_read_b64_tr_b16 a[100:101], v35 offset:32
    ds_read_b64_tr_b16 a[102:103], v35 offset:1568
    ds_read_b64_tr_b16 a[180:181], v35 offset:64
    ds_read_b64_tr_b16 a[182:183], v35 offset:1600
    s_waitcnt lgkmcnt(0)
    s_add_u32 s25, s25, 393216
    s_add_u32 m0, s62, 0
    s_nop 0
    buffer_load_dwordx4 v20, s[8:11], s25 offen lds
    s_add_u32 m0, s62, 1024
    s_nop 0
    buffer_load_dwordx4 v21, s[8:11], s25 offen lds
    s_add_u32 m0, s62, 2048
    s_nop 0
    buffer_load_dwordx4 v22, s[8:11], s25 offen lds
    s_waitcnt vmcnt(12)
    ds_read_b64_tr_b16 a[24:25], v35 offset:3072
    ds_read_b64_tr_b16 a[26:27], v35 offset:4608
    ds_read_b64_tr_b16 a[104:105], v35 offset:3104
    ds_read_b64_tr_b16 a[106:107], v35 offset:4640
    ds_read_b64_tr_b16 a[184:185], v35 offset:3136
    ds_read_b64_tr_b16 a[186:187], v35 offset:4672
    s_waitcnt lgkmcnt(0)
    s_add_u32 s25, s25, 393216
    s_add_u32 m0, s62, 3072
    s_nop 0
    buffer_load_dwordx4 v20, s[8:11], s25 offen lds
    s_add_u32 m0, s62, 4096
    s_nop 0
    buffer_load_dwordx4 v21, s[8:11], s25 offen lds
    s_add_u32 m0, s62, 5120
    s_nop 0
    buffer_load_dwordx4 v22, s[8:11], s25 offen lds
    s_waitcnt vmcnt(12)
    ds_read_b64_tr_b16 a[28:29], v35 offset:6144
    ds_read_b64_tr_b16 a[30:31], v35 offset:7680
    ds_read_b64_tr_b16 a[108:109], v35 offset:6176
    ds_read_b64_tr_b16 a[110:111], v35 offset:7712
    ds_read_b64_tr_b16 a[188:189], v35 offset:6208
    ds_read_b64_tr_b16 a[190:191], v35 offset:7744
    s_waitcnt lgkmcnt(0)
    s_add_u32 s25, s25, 393216
    s_add_u32 m0, s62, 6144
    s_nop 0
    buffer_load_dwordx4 v20, s[8:11], s25 offen lds
    s_add_u32 m0, s62, 7168
    s_nop 0
    buffer_load_dwordx4 v21, s[8:11], s25 offen lds
    s_add_u32 m0, s62, 8192
    s_nop 0
    buffer_load_dwordx4 v22, s[8:11], s25 offen lds
    s_waitcnt vmcnt(12)
    ds_read_b64_tr_b16 a[32:33], v35 offset:9216
    ds_read_b64_tr_b16 a[34:35], v35 offset:10752
    ds_read_b64_tr_b16 a[112:113], v35 offset:9248
    ds_read_b64_tr_b16 a[114:115], v35 offset:10784
    ds_read_b64_tr_b16 a[192:193], v35 offset:9280
    ds_read_b64_tr_b16 a[194:195], v35 offset:10816
    s_waitcnt lgkmcnt(0)
    s_add_u32 s25, s25, 393216
    s_add_u32 m0, s62, 9216
    s_nop 0
    buffer_load_dwordx4 v20, s[8:11], s25 offen lds
    s_add_u32 m0, s62, 10240
    s_nop 0
    buffer_load_dwordx4 v21, s[8:11], s25 offen lds
    s_add_u32 m0, s62, 11264
    s_nop 0
    buffer_load_dwordx4 v22, s[8:11], s25 offen lds
    s_waitcnt vmcnt(12)
    ds_read_b64_tr_b16 a[36:37], v35 offset:12288
    ds_read_b64_tr_b16 a[38:39], v35 offset:13824
    ds_read_b64_tr_b16 a[116:117], v35 offset:12320
    ds_read_b64_tr_b16 a[118:119], v35 offset:13856
    ds_read_b64_tr_b16 a[196:197], v35 offset:12352
    ds_read_b64_tr_b16 a[198:199], v35 offset:13888
    s_waitcnt lgkmcnt(0)
    s_add_u32 s25, s25, 393216
    s_add_u32 m0, s62, 12288
    s_nop 0
    buffer_load_dwordx4 v20, s[8:11], s25 offen lds
    s_add_u32 m0, s62, 13312
    s_nop 0
    buffer_load_dwordx4 v21, s[8:11], s25 offen lds
    s_add_u32 m0, s62, 14336
    s_nop 0
    buffer_load_dwordx4 v22, s[8:11], s25 offen lds
    s_waitcnt vmcnt(12)
    ds_read_b64_tr_b16 a[40:41], v35 offset:0
    ds_read_b64_tr_b16 a[42:43], v35 offset:1536
    ds_read_b64_tr_b16 a[120:121], v35 offset:32
    ds_read_b64_tr_b16 a[122:123], v35 offset:1568
    ds_read_b64_tr_b16 a[200:201], v35 offset:64
    ds_read_b64_tr_b16 a[202:203], v35 offset:1600
    s_waitcnt lgkmcnt(0)
    s_add_u32 s25, s25, 393216
    s_add_u32 m0, s62, 0
    s_nop 0
    buffer_load_dwordx4 v20, s[8:11], s25 offen lds
    s_add_u32 m0, s62, 1024
    s_nop 0
    buffer_load_dwordx4 v21, s[8:11], s25 offen lds
    s_add_u32 m0, s62, 2048
    s_nop 0
    buffer_load_dwordx4 v22, s[8:11], s25 offen lds
    s_waitcnt vmcnt(12)
    ds_read_b64_tr_b16 a[44:45], v35 offset:3072
    ds_read_b64_tr_b16 a[46:47], v35 offset:4608
    ds_read_b64_tr_b16 a[124:125], v35 offset:3104
    ds_read_b64_tr_b16 a[126:127], v35 offset:4640
    ds_read_b64_tr_b16 a[204:205], v35 offset:3136
    ds_read_b64_tr_b16 a[206:207], v35 offset:4672
    s_waitcnt lgkmcnt(0)
    s_add_u32 s25, s25, 393216
    s_add_u32 m0, s62, 3072
    s_nop 0
    buffer_load_dwordx4 v20, s[8:11], s25 offen lds
    s_add_u32 m0, s62, 4096
    s_nop 0
    buffer_load_dwordx4 v21, s[8:11], s25 offen lds
    s_add_u32 m0, s62, 5120
    s_nop 0
    buffer_load_dwordx4 v22, s[8:11], s25 offen lds
    s_waitcnt vmcnt(12)
    ds_read_b64_tr_b16 a[48:49], v35 offset:6144
    ds_read_b64_tr_b16 a[50:51], v35 offset:7680
    ds_read_b64_tr_b16 a[128:129], v35 offset:6176
    ds_read_b64_tr_b16 a[130:131], v35 offset:7712
    ds_read_b64_tr_b16 a[208:209], v35 offset:6208
    ds_read_b64_tr_b16 a[210:211], v35 offset:7744
    s_waitcnt lgkmcnt(0)
    s_add_u32 s25, s25, 393216
    s_add_u32 m0, s62, 6144
    s_nop 0
    buffer_load_dwordx4 v20, s[8:11], s25 offen lds
    s_add_u32 m0, s62, 7168
    s_nop 0
    buffer_load_dwordx4 v21, s[8:11], s25 offen lds
    s_add_u32 m0, s62, 8192
    s_nop 0
    buffer_load_dwordx4 v22, s[8:11], s25 offen lds
    s_waitcnt vmcnt(12)
    ds_read_b64_tr_b16 a[52:53], v35 offset:9216
    ds_read_b64_tr_b16 a[54:55], v35 offset:10752
    ds_read_b64_tr_b16 a[132:133], v35 offset:9248
    ds_read_b64_tr_b16 a[134:135], v35 offset:10784
    ds_read_b64_tr_b16 a[212:213], v35 offset:9280
    ds_read_b64_tr_b16 a[214:215], v35 offset:10816
    s_waitcnt lgkmcnt(0)
    s_add_u32 s25, s25, 393216
    s_add_u32 m0, s62, 9216
    s_nop 0
    buffer_load_dwordx4 v20, s[8:11], s25 offen lds
    s_add_u32 m0, s62, 10240
    s_nop 0
    buffer_load_dwordx4 v21, s[8:11], s25 offen lds
    s_add_u32 m0, s62, 11264
    s_nop 0
    buffer_load_dwordx4 v22, s[8:11], s25 offen lds
    s_waitcnt vmcnt(12)
    ds_read_b64_tr_b16 a[56:57], v35 offset:12288
    ds_read_b64_tr_b16 a[58:59], v35 offset:13824
    ds_read_b64_tr_b16 a[136:137], v35 offset:12320
    ds_read_b64_tr_b16 a[138:139], v35 offset:13856
    ds_read_b64_tr_b16 a[216:217], v35 offset:12352
    ds_read_b64_tr_b16 a[218:219], v35 offset:13888
    s_waitcnt lgkmcnt(0)
    s_add_u32 s25, s25, 393216
    s_add_u32 m0, s62, 12288
    s_nop 0
    buffer_load_dwordx4 v20, s[8:11], s25 offen lds
    s_add_u32 m0, s62, 13312
    s_nop 0
    buffer_load_dwordx4 v21, s[8:11], s25 offen lds
    s_add_u32 m0, s62, 14336
    s_nop 0
    buffer_load_dwordx4 v22, s[8:11], s25 offen lds
    s_add_u32 m0, s62, 15360
    s_nop 0
    buffer_load_dwordx4 v23, s[28:31], s26 offen lds
    s_add_u32 m0, s62, 16384
    s_nop 0
    buffer_load_dwordx4 v24, s[28:31], s26 offen lds
    s_waitcnt vmcnt(14)
    ds_read_b64_tr_b16 a[60:61], v35 offset:0
    ds_read_b64_tr_b16 a[62:63], v35 offset:1536
    ds_read_b64_tr_b16 a[140:141], v35 offset:32
    ds_read_b64_tr_b16 a[142:143], v35 offset:1568
    ds_read_b64_tr_b16 a[220:221], v35 offset:64
    ds_read_b64_tr_b16 a[222:223], v35 offset:1600
    s_waitcnt lgkmcnt(0)
    s_add_u32 s26, s26, 393216
    s_add_u32 m0, s62, 0
    s_nop 0
    buffer_load_dwordx4 v23, s[28:31], s26 offen lds
    s_add_u32 m0, s62, 1024
    s_nop 0
    buffer_load_dwordx4 v24, s[28:31], s26 offen lds
    s_waitcnt vmcnt(13)
    ds_read_b64_tr_b16 a[64:65], v35 offset:3072
    ds_read_b64_tr_b16 a[66:67], v35 offset:4608
    ds_read_b64_tr_b16 a[144:145], v35 offset:3104
    ds_read_b64_tr_b16 a[146:147], v35 offset:4640
    ds_read_b64_tr_b16 a[224:225], v35 offset:3136
    ds_read_b64_tr_b16 a[226:227], v35 offset:4672
    s_waitcnt lgkmcnt(0)
    s_add_u32 s26, s26, 393216
    s_add_u32 m0, s62, 2048
    s_nop 0
    buffer_load_dwordx4 v23, s[28:31], s26 offen lds
    s_add_u32 m0, s62, 3072
    s_nop 0
    buffer_load_dwordx4 v24, s[28:31], s26 offen lds
    s_add_u32 s26, s26, 393216
    s_add_u32 m0, s62, 4096
    s_nop 0
    buffer_load_dwordx4 v23, s[28:31], s26 offen lds
    s_add_u32 m0, s62, 5120
    s_nop 0
    buffer_load_dwordx4 v24, s[28:31], s26 offen lds
    s_waitcnt vmcnt(14)
    ds_read_b64_tr_b16 a[68:69], v35 offset:6144
    ds_read_b64_tr_b16 a[70:71], v35 offset:7680
    ds_read_b64_tr_b16 a[148:149], v35 offset:6176
    ds_read_b64_tr_b16 a[150:151], v35 offset:7712
    ds_read_b64_tr_b16 a[228:229], v35 offset:6208
    ds_read_b64_tr_b16 a[230:231], v35 offset:7744
    s_waitcnt lgkmcnt(0)
    s_add_u32 s26, s26, 393216
    s_add_u32 m0, s62, 6144
    s_nop 0
    buffer_load_dwordx4 v23, s[28:31], s26 offen lds
    s_add_u32 m0, s62, 7168
    s_nop 0
    buffer_load_dwordx4 v24, s[28:31], s26 offen lds
    s_waitcnt vmcnt(13)
    ds_read_b64_tr_b16 a[72:73], v35 offset:9216
    ds_read_b64_tr_b16 a[74:75], v35 offset:10752
    ds_read_b64_tr_b16 a[152:153], v35 offset:9248
    ds_read_b64_tr_b16 a[154:155], v35 offset:10784
    ds_read_b64_tr_b16 a[232:233], v35 offset:9280
    ds_read_b64_tr_b16 a[234:235], v35 offset:10816
    s_waitcnt lgkmcnt(0)
    s_add_u32 s26, s26, 393216
    s_add_u32 m0, s62, 8192
    s_nop 0
    buffer_load_dwordx4 v23, s[28:31], s26 offen lds
    s_add_u32 m0, s62, 9216
    s_nop 0
    buffer_load_dwordx4 v24, s[28:31], s26 offen lds
    s_add_u32 s26, s26, 393216
    s_add_u32 m0, s62, 10240
    s_nop 0
    buffer_load_dwordx4 v23, s[28:31], s26 offen lds
    s_add_u32 m0, s62, 11264
    s_nop 0
    buffer_load_dwordx4 v24, s[28:31], s26 offen lds
    s_waitcnt vmcnt(14)
    ds_read_b64_tr_b16 a[76:77], v35 offset:12288
    ds_read_b64_tr_b16 a[78:79], v35 offset:13824
    ds_read_b64_tr_b16 a[156:157], v35 offset:12320
    ds_read_b64_tr_b16 a[158:159], v35 offset:13856
    ds_read_b64_tr_b16 a[236:237], v35 offset:12352
    ds_read_b64_tr_b16 a[238:239], v35 offset:13888
    s_waitcnt lgkmcnt(0)
    s_add_u32 s26, s26, 393216
    s_add_u32 m0, s62, 12288
    s_nop 0
    buffer_load_dwordx4 v23, s[28:31], s26 offen lds
    s_add_u32 m0, s62, 13312
    s_nop 0
    buffer_load_dwordx4 v24, s[28:31], s26 offen lds
    s_waitcnt vmcnt(14)
    ds_read_b64_tr_b16 v[96:97], v36 offset:15360
    ds_read_b64_tr_b16 v[98:99], v36 offset:16384
    ds_read_b64_tr_b16 v[176:177], v36 offset:15392
    ds_read_b64_tr_b16 v[178:179], v36 offset:16416
    s_waitcnt lgkmcnt(0)
    s_add_u32 s26, s26, 393216
    s_add_u32 m0, s62, 14336
    s_nop 0
    buffer_load_dwordx4 v23, s[28:31], s26 offen lds
    s_add_u32 m0, s62, 15360
    s_nop 0
    buffer_load_dwordx4 v24, s[28:31], s26 offen lds
    s_waitcnt vmcnt(14)
    ds_read_b64_tr_b16 v[100:101], v36 offset:0
    ds_read_b64_tr_b16 v[102:103], v36 offset:1024
    ds_read_b64_tr_b16 v[180:181], v36 offset:32
    ds_read_b64_tr_b16 v[182:183], v36 offset:1056
    s_waitcnt lgkmcnt(0)
    s_add_u32 s26, s26, 393216
    s_add_u32 m0, s62, 0
    s_nop 0
    buffer_load_dwordx4 v23, s[28:31], s26 offen lds
    s_add_u32 m0, s62, 1024
    s_nop 0
    buffer_load_dwordx4 v24, s[28:31], s26 offen lds
    s_waitcnt vmcnt(14)
    ds_read_b64_tr_b16 v[104:105], v36 offset:2048
    ds_read_b64_tr_b16 v[106:107], v36 offset:3072
    ds_read_b64_tr_b16 v[184:185], v36 offset:2080
    ds_read_b64_tr_b16 v[186:187], v36 offset:3104
    s_waitcnt lgkmcnt(0)
    s_add_u32 s26, s26, 393216
    s_add_u32 m0, s62, 2048
    s_nop 0
    buffer_load_dwordx4 v23, s[28:31], s26 offen lds
    s_add_u32 m0, s62, 3072
    s_nop 0
    buffer_load_dwordx4 v24, s[28:31], s26 offen lds
    s_waitcnt vmcnt(14)
    ds_read_b64_tr_b16 v[108:109], v36 offset:4096
    ds_read_b64_tr_b16 v[110:111], v36 offset:5120
    ds_read_b64_tr_b16 v[188:189], v36 offset:4128
    ds_read_b64_tr_b16 v[190:191], v36 offset:5152
    s_waitcnt lgkmcnt(0)
    s_add_u32 s26, s26, 393216
    s_add_u32 m0, s62, 4096
    s_nop 0
    buffer_load_dwordx4 v23, s[28:31], s26 offen lds
    s_add_u32 m0, s62, 5120
    s_nop 0
    buffer_load_dwordx4 v24, s[28:31], s26 offen lds
    s_waitcnt vmcnt(14)
    ds_read_b64_tr_b16 v[112:113], v36 offset:6144
    ds_read_b64_tr_b16 v[114:115], v36 offset:7168
    ds_read_b64_tr_b16 v[192:193], v36 offset:6176
    ds_read_b64_tr_b16 v[194:195], v36 offset:7200
    s_waitcnt lgkmcnt(0)
    s_add_u32 s26, s26, 393216
    s_add_u32 m0, s62, 6144
    s_nop 0
    buffer_load_dwordx4 v23, s[28:31], s26 offen lds
    s_add_u32 m0, s62, 7168
    s_nop 0
    buffer_load_dwordx4 v24, s[28:31], s26 offen lds
    s_waitcnt vmcnt(14)
    ds_read_b64_tr_b16 v[116:117], v36 offset:8192
    ds_read_b64_tr_b16 v[118:119], v36 offset:9216
    ds_read_b64_tr_b16 v[196:197], v36 offset:8224
    ds_read_b64_tr_b16 v[198:199], v36 offset:9248
    s_waitcnt lgkmcnt(0)
    s_add_u32 s26, s26, 393216
    s_add_u32 m0, s62, 8192
    s_nop 0
    buffer_load_dwordx4 v23, s[28:31], s26 offen lds
    s_add_u32 m0, s62, 9216
    s_nop 0
    buffer_load_dwordx4 v24, s[28:31], s26 offen lds
    s_waitcnt vmcnt(14)
    ds_read_b64_tr_b16 v[120:121], v36 offset:10240
    ds_read_b64_tr_b16 v[122:123], v36 offset:11264
    ds_read_b64_tr_b16 v[200:201], v36 offset:10272
    ds_read_b64_tr_b16 v[202:203], v36 offset:11296
    s_waitcnt lgkmcnt(0)
    s_add_u32 s26, s26, 393216
    s_add_u32 m0, s62, 10240
    s_nop 0
    buffer_load_dwordx4 v23, s[28:31], s26 offen lds
    s_add_u32 m0, s62, 11264
    s_nop 0
    buffer_load_dwordx4 v24, s[28:31], s26 offen lds
    s_waitcnt vmcnt(14)
    ds_read_b64_tr_b16 v[124:125], v36 offset:12288
    ds_read_b64_tr_b16 v[126:127], v36 offset:13312
    ds_read_b64_tr_b16 v[204:205], v36 offset:12320
    ds_read_b64_tr_b16 v[206:207], v36 offset:13344
    s_waitcnt lgkmcnt(0)
    s_add_u32 s26, s26, 393216
    s_add_u32 m0, s62, 12288
    s_nop 0
    buffer_load_dwordx4 v23, s[28:31], s26 offen lds
    s_add_u32 m0, s62, 13312
    s_nop 0
    buffer_load_dwordx4 v24, s[28:31], s26 offen lds
    s_waitcnt vmcnt(14)
    ds_read_b64_tr_b16 v[128:129], v36 offset:14336
    ds_read_b64_tr_b16 v[130:131], v36 offset:15360
    ds_read_b64_tr_b16 v[208:209], v36 offset:14368
    ds_read_b64_tr_b16 v[210:211], v36 offset:15392
    s_waitcnt lgkmcnt(0)
    s_add_u32 s26, s26, 393216
    s_add_u32 m0, s62, 14336
    s_nop 0
    buffer_load_dwordx4 v23, s[28:31], s26 offen lds
    s_add_u32 m0, s62, 15360
    s_nop 0
    buffer_load_dwordx4 v24, s[28:31], s26 offen lds
    s_waitcnt vmcnt(14)
    ds_read_b64_tr_b16 v[132:133], v36 offset:0
    ds_read_b64_tr_b16 v[134:135], v36 offset:1024
    ds_read_b64_tr_b16 v[212:213], v36 offset:32
    ds_read_b64_tr_b16 v[214:215], v36 offset:1056
    s_waitcnt lgkmcnt(0)
    s_add_u32 s26, s26, 393216
    s_add_u32 m0, s62, 0
    s_nop 0
    buffer_load_dwordx4 v23, s[28:31], s26 offen lds
    s_add_u32 m0, s62, 1024
    s_nop 0
    buffer_load_dwordx4 v24, s[28:31], s26 offen lds
    s_waitcnt vmcnt(14)
    ds_read_b64_tr_b16 v[136:137], v36 offset:2048
    ds_read_b64_tr_b16 v[138:139], v36 offset:3072
    ds_read_b64_tr_b16 v[216:217], v36 offset:2080
    ds_read_b64_tr_b16 v[218:219], v36 offset:3104
    s_waitcnt lgkmcnt(0)
    s_add_u32 s26, s26, 393216
    s_add_u32 m0, s62, 2048
    s_nop 0
    buffer_load_dwordx4 v23, s[28:31], s26 offen lds
    s_add_u32 m0, s62, 3072
    s_nop 0
    buffer_load_dwordx4 v24, s[28:31], s26 offen lds
    s_waitcnt vmcnt(14)
    ds_read_b64_tr_b16 v[140:141], v36 offset:4096
    ds_read_b64_tr_b16 v[142:143], v36 offset:5120
    ds_read_b64_tr_b16 v[220:221], v36 offset:4128
    ds_read_b64_tr_b16 v[222:223], v36 offset:5152
    s_waitcnt lgkmcnt(0)
    s_add_u32 s26, s26, 393216
    s_add_u32 m0, s62, 4096
    s_nop 0
    buffer_load_dwordx4 v23, s[28:31], s26 offen lds
    s_add_u32 m0, s62, 5120
    s_nop 0
    buffer_load_dwordx4 v24, s[28:31], s26 offen lds
    s_waitcnt vmcnt(14)
    ds_read_b64_tr_b16 v[144:145], v36 offset:6144
    ds_read_b64_tr_b16 v[146:147], v36 offset:7168
    ds_read_b64_tr_b16 v[224:225], v36 offset:6176
    ds_read_b64_tr_b16 v[226:227], v36 offset:7200
    s_waitcnt lgkmcnt(0)
    s_waitcnt vmcnt(12)
    ds_read_b64_tr_b16 v[148:149], v36 offset:8192
    ds_read_b64_tr_b16 v[150:151], v36 offset:9216
    ds_read_b64_tr_b16 v[228:229], v36 offset:8224
    ds_read_b64_tr_b16 v[230:231], v36 offset:9248
    s_waitcnt lgkmcnt(0)
    s_waitcnt vmcnt(10)
    ds_read_b64_tr_b16 v[152:153], v36 offset:10240
    ds_read_b64_tr_b16 v[154:155], v36 offset:11264
    ds_read_b64_tr_b16 v[232:233], v36 offset:10272
    ds_read_b64_tr_b16 v[234:235], v36 offset:11296
    s_waitcnt lgkmcnt(0)
    s_waitcnt vmcnt(8)
    ds_read_b64_tr_b16 v[156:157], v36 offset:12288
    ds_read_b64_tr_b16 v[158:159], v36 offset:13312
    ds_read_b64_tr_b16 v[236:237], v36 offset:12320
    ds_read_b64_tr_b16 v[238:239], v36 offset:13344
    s_waitcnt lgkmcnt(0)
    s_waitcnt vmcnt(6)
    ds_read_b64_tr_b16 v[160:161], v36 offset:14336
    ds_read_b64_tr_b16 v[162:163], v36 offset:15360
    ds_read_b64_tr_b16 v[240:241], v36 offset:14368
    ds_read_b64_tr_b16 v[242:243], v36 offset:15392
    s_waitcnt lgkmcnt(0)
    s_add_u32 m0, s62, 6144
    s_nop 0
    buffer_load_dwordx4 v25, s[32:35], s27 offen lds
    s_add_u32 m0, s62, 7168
    s_nop 0
    buffer_load_dwordx4 v26, s[32:35], s27 offen lds
    s_add_u32 m0, s62, 8192
    s_nop 0
    buffer_load_dwordx4 v27, s[32:35], s27 offen lds
    s_add_u32 m0, s62, 9216
    s_nop 0
    buffer_load_dwordx4 v28, s[32:35], s27 offen lds
    s_add_u32 m0, s62, 10240
    s_nop 0
    buffer_load_dwordx4 v29, s[32:35], s27 offen lds
    s_add_u32 m0, s62, 11264
    s_nop 0
    buffer_load_dwordx4 v30, s[32:35], s27 offen lds
    s_add_u32 m0, s62, 12288
    s_nop 0
    buffer_load_dwordx4 v31, s[32:35], s27 offen lds
    s_add_u32 m0, s62, 13312
    s_nop 0
    buffer_load_dwordx4 v32, s[32:35], s27 offen lds
    s_add_u32 m0, s62, 14336
    s_nop 0
    buffer_load_dwordx4 v33, s[32:35], s27 offen lds
    s_add_u32 m0, s62, 15360
    s_nop 0
    buffer_load_dwordx4 v34, s[32:35], s27 offen lds
    s_waitcnt vmcnt(14)
    ds_read_b64_tr_b16 v[164:165], v36 offset:0
    ds_read_b64_tr_b16 v[166:167], v36 offset:1024
    ds_read_b64_tr_b16 v[244:245], v36 offset:32
    ds_read_b64_tr_b16 v[246:247], v36 offset:1056
    s_waitcnt lgkmcnt(0)
    s_waitcnt vmcnt(12)
    ds_read_b64_tr_b16 v[168:169], v36 offset:2048
    ds_read_b64_tr_b16 v[170:171], v36 offset:3072
    ds_read_b64_tr_b16 v[248:249], v36 offset:2080
    ds_read_b64_tr_b16 v[250:251], v36 offset:3104
    s_waitcnt lgkmcnt(0)
    s_waitcnt vmcnt(10)
    ds_read_b64_tr_b16 v[172:173], v36 offset:4096
    ds_read_b64_tr_b16 v[174:175], v36 offset:5120
    ds_read_b64_tr_b16 v[252:253], v36 offset:4128
    ds_read_b64_tr_b16 v[254:255], v36 offset:5152
    s_waitcnt lgkmcnt(0)
    s_waitcnt vmcnt(0)
    ds_read_b64_tr_b16 v[40:41], v37 offset:6144
    ds_read_b64_tr_b16 v[42:43], v37 offset:11264
    ds_read_b64_tr_b16 v[44:45], v37 offset:6176
    ds_read_b64_tr_b16 v[46:47], v37 offset:11296
    ds_read_b64_tr_b16 v[48:49], v37 offset:6208
    ds_read_b64_tr_b16 v[50:51], v37 offset:11328
    ds_read_b64_tr_b16 v[52:53], v37 offset:6240
    ds_read_b64_tr_b16 v[54:55], v37 offset:11360
    s_waitcnt lgkmcnt(0)
    ds_write_b128 v2, v[40:43] offset:0
    ds_write_b128 v2, v[44:47] offset:3072
    ds_write_b128 v2, v[48:51] offset:6144
    ds_write_b128 v2, v[52:55] offset:9216
    s_waitcnt lgkmcnt(0)
    ds_read_b64_tr_b16 v[40:41], v37 offset:6272
    ds_read_b64_tr_b16 v[42:43], v37 offset:11392
    ds_read_b64_tr_b16 v[44:45], v37 offset:6304
    ds_read_b64_tr_b16 v[46:47], v37 offset:11424
    ds_read_b64_tr_b16 v[48:49], v37 offset:6336
    ds_read_b64_tr_b16 v[50:51], v37 offset:11456
    ds_read_b64_tr_b16 v[52:53], v37 offset:6368
    ds_read_b64_tr_b16 v[54:55], v37 offset:11488
    s_waitcnt lgkmcnt(0)
    ds_write_b128 v2, v[40:43] offset:12288
    ds_write_b128 v2, v[44:47] offset:15360
    ds_write_b128 v2, v[48:51] offset:18432
    ds_write_b128 v2, v[52:55] offset:21504
    s_waitcnt lgkmcnt(0)
    ds_read_b64_tr_b16 v[40:41], v37 offset:6400
    ds_read_b64_tr_b16 v[42:43], v37 offset:11520
    ds_read_b64_tr_b16 v[44:45], v37 offset:6432
    ds_read_b64_tr_b16 v[46:47], v37 offset:11552
    s_waitcnt lgkmcnt(0)
    ds_write_b128 v2, v[40:43] offset:24576
    ds_write_b128 v2, v[44:47] offset:27648
    s_waitcnt lgkmcnt(0)
    s_add_u32 s27, s27, 40960
    s_add_u32 m0, s62, 0
    s_nop 0
    buffer_load_dwordx4 v25, s[32:35], s27 offen lds
    s_add_u32 m0, s62, 1024
    s_nop 0
    buffer_load_dwordx4 v26, s[32:35], s27 offen lds
    s_add_u32 m0, s62, 2048
    s_nop 0
    buffer_load_dwordx4 v27, s[32:35], s27 offen lds
    s_add_u32 m0, s62, 3072
    s_nop 0
    buffer_load_dwordx4 v28, s[32:35], s27 offen lds
    s_add_u32 m0, s62, 4096
    s_nop 0
    buffer_load_dwordx4 v29, s[32:35], s27 offen lds
    s_add_u32 m0, s62, 5120
    s_nop 0
    buffer_load_dwordx4 v30, s[32:35], s27 offen lds
    s_add_u32 m0, s62, 6144
    s_nop 0
    buffer_load_dwordx4 v31, s[32:35], s27 offen lds
    s_add_u32 m0, s62, 7168
    s_nop 0
    buffer_load_dwordx4 v32, s[32:35], s27 offen lds
    s_add_u32 m0, s62, 8192
    s_nop 0
    buffer_load_dwordx4 v33, s[32:35], s27 offen lds
    s_add_u32 m0, s62, 9216
    s_nop 0
    buffer_load_dwordx4 v34, s[32:35], s27 offen lds
    s_waitcnt vmcnt(0)
    ds_read_b64_tr_b16 v[40:41], v37 offset:0
    ds_read_b64_tr_b16 v[42:43], v37 offset:5120
    ds_read_b64_tr_b16 v[44:45], v37 offset:32
    ds_read_b64_tr_b16 v[46:47], v37 offset:5152
    ds_read_b64_tr_b16 v[48:49], v37 offset:64
    ds_read_b64_tr_b16 v[50:51], v37 offset:5184
    ds_read_b64_tr_b16 v[52:53], v37 offset:96
    ds_read_b64_tr_b16 v[54:55], v37 offset:5216
    s_waitcnt lgkmcnt(0)
    ds_write_b128 v2, v[40:43] offset:1024
    ds_write_b128 v2, v[44:47] offset:4096
    ds_write_b128 v2, v[48:51] offset:7168
    ds_write_b128 v2, v[52:55] offset:10240
    s_waitcnt lgkmcnt(0)
    ds_read_b64_tr_b16 v[40:41], v37 offset:128
    ds_read_b64_tr_b16 v[42:43], v37 offset:5248
    ds_read_b64_tr_b16 v[44:45], v37 offset:160
    ds_read_b64_tr_b16 v[46:47], v37 offset:5280
    ds_read_b64_tr_b16 v[48:49], v37 offset:192
    ds_read_b64_tr_b16 v[50:51], v37 offset:5312
    ds_read_b64_tr_b16 v[52:53], v37 offset:224
    ds_read_b64_tr_b16 v[54:55], v37 offset:5344
    s_waitcnt lgkmcnt(0)
    ds_write_b128 v2, v[40:43] offset:13312
    ds_write_b128 v2, v[44:47] offset:16384
    ds_write_b128 v2, v[48:51] offset:19456
    ds_write_b128 v2, v[52:55] offset:22528
    s_waitcnt lgkmcnt(0)
    ds_read_b64_tr_b16 v[40:41], v37 offset:256
    ds_read_b64_tr_b16 v[42:43], v37 offset:5376
    ds_read_b64_tr_b16 v[44:45], v37 offset:288
    ds_read_b64_tr_b16 v[46:47], v37 offset:5408
    s_waitcnt lgkmcnt(0)
    ds_write_b128 v2, v[40:43] offset:25600
    ds_write_b128 v2, v[44:47] offset:28672
    s_waitcnt lgkmcnt(0)
    s_add_u32 s27, s27, 40960
    s_add_u32 m0, s62, 0
    s_nop 0
    buffer_load_dwordx4 v25, s[32:35], s27 offen lds
    s_add_u32 m0, s62, 1024
    s_nop 0
    buffer_load_dwordx4 v26, s[32:35], s27 offen lds
    s_add_u32 m0, s62, 2048
    s_nop 0
    buffer_load_dwordx4 v27, s[32:35], s27 offen lds
    s_add_u32 m0, s62, 3072
    s_nop 0
    buffer_load_dwordx4 v28, s[32:35], s27 offen lds
    s_add_u32 m0, s62, 4096
    s_nop 0
    buffer_load_dwordx4 v29, s[32:35], s27 offen lds
    s_add_u32 m0, s62, 5120
    s_nop 0
    buffer_load_dwordx4 v30, s[32:35], s27 offen lds
    s_add_u32 m0, s62, 6144
    s_nop 0
    buffer_load_dwordx4 v31, s[32:35], s27 offen lds
    s_add_u32 m0, s62, 7168
    s_nop 0
    buffer_load_dwordx4 v32, s[32:35], s27 offen lds
    s_add_u32 m0, s62, 8192
    s_nop 0
    buffer_load_dwordx4 v33, s[32:35], s27 offen lds
    s_add_u32 m0, s62, 9216
    s_nop 0
    buffer_load_dwordx4 v34, s[32:35], s27 offen lds
    s_waitcnt vmcnt(0)
    ds_read_b64_tr_b16 v[40:41], v37 offset:0
    ds_read_b64_tr_b16 v[42:43], v37 offset:5120
    ds_read_b64_tr_b16 v[44:45], v37 offset:32
    ds_read_b64_tr_b16 v[46:47], v37 offset:5152
    ds_read_b64_tr_b16 v[48:49], v37 offset:64
    ds_read_b64_tr_b16 v[50:51], v37 offset:5184
    ds_read_b64_tr_b16 v[52:53], v37 offset:96
    ds_read_b64_tr_b16 v[54:55], v37 offset:5216
    s_waitcnt lgkmcnt(0)
    ds_write_b128 v2, v[40:43] offset:2048
    ds_write_b128 v2, v[44:47] offset:5120
    ds_write_b128 v2, v[48:51] offset:8192
    ds_write_b128 v2, v[52:55] offset:11264
    s_waitcnt lgkmcnt(0)
    ds_read_b64_tr_b16 v[40:41], v37 offset:128
    ds_read_b64_tr_b16 v[42:43], v37 offset:5248
    ds_read_b64_tr_b16 v[44:45], v37 offset:160
    ds_read_b64_tr_b16 v[46:47], v37 offset:5280
    ds_read_b64_tr_b16 v[48:49], v37 offset:192
    ds_read_b64_tr_b16 v[50:51], v37 offset:5312
    ds_read_b64_tr_b16 v[52:53], v37 offset:224
    ds_read_b64_tr_b16 v[54:55], v37 offset:5344
    s_waitcnt lgkmcnt(0)
    ds_write_b128 v2, v[40:43] offset:14336
    ds_write_b128 v2, v[44:47] offset:17408
    ds_write_b128 v2, v[48:51] offset:20480
    ds_write_b128 v2, v[52:55] offset:23552
    s_waitcnt lgkmcnt(0)
    ds_read_b64_tr_b16 v[40:41], v37 offset:256
    ds_read_b64_tr_b16 v[42:43], v37 offset:5376
    ds_read_b64_tr_b16 v[44:45], v37 offset:288
    ds_read_b64_tr_b16 v[46:47], v37 offset:5408
    s_waitcnt lgkmcnt(0)
    ds_write_b128 v2, v[40:43] offset:26624
    ds_write_b128 v2, v[44:47] offset:29696
    s_waitcnt lgkmcnt(0)
    v_and_b32 v10, 15, v0
    v_lshrrev_b32 v11, 4, v0
    v_and_b32 v12, 7, v0
    v_and_b32 v13, 1, v0
    v_mov_b32 v14, 0x3f80
    v_lshlrev_b32 v13, 4, v13
    v_lshlrev_b32 v14, v13, v14
    v_lshrrev_b32 v12, 1, v12
    v_lshrrev_b32 v13, 2, v10
    v_cmp_eq_u32 s[38:39], v13, v11
    v_bfe_u32 v13, v0, 1, 1
    s_nop 0
    v_cndmask_b32 v17, 0, v14, s[38:39]
    v_cmp_eq_u32 vcc, 0, v12
    s_nop 1
    v_cndmask_b32 v15, 0, v14, vcc
    v_accvgpr_write_b32 a248, v15
    v_cmp_eq_u32 vcc, 0, v13
    s_nop 1
    v_cndmask_b32 v16, 0, v17, vcc
    v_accvgpr_write_b32 a240, v16
    v_accvgpr_write_b32 a244, 0
    v_cmp_eq_u32 vcc, 1, v12
    s_nop 1
    v_cndmask_b32 v15, 0, v14, vcc
    v_accvgpr_write_b32 a249, v15
    v_cmp_eq_u32 vcc, 1, v13
    s_nop 1
    v_cndmask_b32 v16, 0, v17, vcc
    v_accvgpr_write_b32 a241, v16
    v_accvgpr_write_b32 a245, 0
    v_cmp_eq_u32 vcc, 2, v12
    s_nop 1
    v_cndmask_b32 v15, 0, v14, vcc
    v_accvgpr_write_b32 a250, v15
    v_cmp_eq_u32 vcc, 0, v13
    s_nop 1
    v_cndmask_b32 v16, 0, v17, vcc
    v_accvgpr_write_b32 a246, v16
    v_accvgpr_write_b32 a242, 0
    v_cmp_eq_u32 vcc, 3, v12
    s_nop 1
    v_cndmask_b32 v15, 0, v14, vcc
    v_accvgpr_write_b32 a251, v15
    v_cmp_eq_u32 vcc, 1, v13
    s_nop 1
    v_cndmask_b32 v16, 0, v17, vcc
    v_accvgpr_write_b32 a247, v16
    v_accvgpr_write_b32 a243, 0
    v_cmp_gt_u32 s[48:49], 8, v10
    v_cmp_gt_u32 vcc, 2, v11
    s_xnor_b64 s[50:51], vcc, s[48:49]
    s_mul_i32 s60, s15, 640
    s_mov_b32 s61, 20480
    v_add_u32 v12, 320, v0
    v_mul_u32_u24 v13, 52429, v12
    v_lshrrev_b32 v13, 21, v13
    v_mul_u32_u24 v14, 40, v13
    v_sub_u32 v14, v12, v14
    v_mul_lo_u32 v13, v13, s61
    v_lshl_add_u32 v13, v14, 4, v13
    v_add_u32 v3, s60, v13
    v_add_u32 v12, 384, v0
    v_mul_u32_u24 v13, 52429, v12
    v_lshrrev_b32 v13, 21, v13
    v_mul_u32_u24 v14, 40, v13
    v_sub_u32 v14, v12, v14
    v_mul_lo_u32 v13, v13, s61
    v_lshl_add_u32 v13, v14, 4, v13
    v_add_u32 v4, s60, v13
    v_add_u32 v12, 448, v0
    v_mul_u32_u24 v13, 52429, v12
    v_lshrrev_b32 v13, 21, v13
    v_mul_u32_u24 v14, 40, v13
    v_sub_u32 v14, v12, v14
    v_mul_lo_u32 v13, v13, s61
    v_lshl_add_u32 v13, v14, 4, v13
    v_add_u32 v5, s60, v13
    v_add_u32 v12, 512, v0
    v_mul_u32_u24 v13, 52429, v12
    v_lshrrev_b32 v13, 21, v13
    v_mul_u32_u24 v14, 40, v13
    v_sub_u32 v14, v12, v14
    v_mul_lo_u32 v13, v13, s61
    v_lshl_add_u32 v13, v14, 4, v13
    v_add_u32 v6, s60, v13
    v_add_u32 v12, 576, v0
    v_mul_u32_u24 v13, 52429, v12
    v_lshrrev_b32 v13, 21, v13
    v_mul_u32_u24 v14, 40, v13
    v_sub_u32 v14, v12, v14
    v_mul_lo_u32 v13, v13, s61
    v_lshl_add_u32 v13, v14, 4, v13
    v_add_u32 v7, s60, v13
    s_mul_i32 s60, s15, 20480
    s_add_u32 s60, s60, 256
    v_lshrrev_b32 v12, 4, v0
    v_mul_u32_u24 v12, 640, v12
    v_and_b32 v13, 15, v0
    v_lshl_add_u32 v12, v13, 4, v12
    v_add_u32 v8, s60, v12
    s_mul_i32 s60, s15, 40
    s_add_u32 s60, s60, 16
    v_add_u32 v12, s60, v10
    v_lshlrev_b32 v9, 4, v12
    s_mul_i32 s32, s14, 655360
    s_add_u32 s32, s32, 1310720
    s_add_u32 s33, s32, 5120
    s_add_u32 s34, s32, 10240
    s_add_u32 s35, s32, 15360
    s_mov_b32 s52, 1037384597
    s_mov_b32 s53, 1037384597
    s_lshl_b32 s29, s13, 12
    s_add_u32 s29, s29, 918528
    s_xor_b32 s30, s29, 4096
    s_mov_b64 s[46:47], 65535
    s_mov_b32 s8, s66
    s_and_b32 s9, s67, 0xffff
    s_mov_b32 s10, 10240
    s_mov_b32 s11, 0x20000
    v_and_b32 v13, 7, v12
    v_mul_u32_u24 v13, 1280, v13
    v_lshrrev_b32 v14, 6, v12
    v_lshl_add_u32 v13, v14, 6, v13
    v_bfe_u32 v14, v12, 4, 2
    v_lshl_add_u32 v13, v14, 3, v13
    v_and_b32 v14, 8, v12
    v_cmp_eq_u32 s[38:39], 0, v14
    v_cmp_ne_u32 s[40:41], 0, v14
    s_cmp_eq_u32 s14, 0
    s_cselect_b32 s10, 10240, 0
    buffer_load_dwordx2 v[16:17], v13, s[8:11], 0 offen
    buffer_load_dwordx2 v[18:19], v13, s[8:11], 0 offen offset:32
    s_waitcnt vmcnt(0)
    v_accvgpr_write_b32 a252, v16
    v_accvgpr_write_b32 a253, v17
    v_accvgpr_write_b32 a254, v18
    v_accvgpr_write_b32 a255, v19
    s_lshl_b32 s3, s18, 2
    s_add_u32 s3, s3, 64
    v_mov_b32 v92, s3
    v_lshlrev_b32 v94, 2, v0
    v_and_b32 v94, 28, v94
    s_mov_b32 s19, 0
L_R1_warr_2:
    global_load_dword v93, v92, s[16:17] sc1
    s_add_u32 s19, s19, 1
    s_cmp_ge_u32 s19, 524288
    s_cbranch_scc1 L_fail
    s_waitcnt vmcnt(0)
    v_cmp_gt_u32 vcc, 256, v93
    s_nop 0
    s_cbranch_vccnz L_R1_warr_2
    s_cmp_lg_u32 s18, 0
    s_cbranch_scc1 L_R1_placed_3
    global_load_dword v93, v94, s[16:17] sc1
    s_waitcnt vmcnt(0)
    v_cmp_ne_u32 vcc, 32, v93
    s_nop 0
    s_cbranch_vccnz L_fallback
L_R1_placed_3:
    v_lshlrev_b32 v0, 4, v0
    s_mov_b32 s20, 0
    s_barrier
    v_or_b32 v16, 1, v16
    s_lshl_b32 s60, s14, 15
    s_add_u32 s60, s60, 1179648
    s_mul_i32 s61, s14, 20480
    s_add_u32 s61, s61, 2621440
    s_mov_b64 exec, s[46:47]
    buffer_store_dwordx4 v[16:19], v9, s[4:7], s60 offen sc1
    buffer_store_dwordx4 v[16:19], v9, s[4:7], s61 offen sc1
    s_mov_b64 exec, -1
    s_waitcnt vmcnt(0)
    s_add_u32 s60, s20, 1
    s_and_b32 s22, s60, 1
    s_lshl_b32 s21, s22, 31
    s_sub_u32 s44, 0, s22
    s_bfe_u32 s23, s20, 0x10001
    s_sub_u32 s23, s23, 1
    s_lshr_b32 s24, s60, 1
    s_andn2_b32 s24, 1, s24
    s_lshl_b32 s61, s14, 15
    s_add_u32 s61, s61, 1179648
    s_and_b32 s25, s20, 1
    s_lshl_b32 s25, s25, 16
    s_add_u32 s25, s25, s61
    s_add_u32 s25, s25, 5120
    s_add_u32 s26, s25, 4096
    s_lshl_b32 s36, s22, 16
    s_add_u32 s36, s36, s61
    s_lshl_b32 s27, s20, 1
    s_add_u32 s37, s27, 2
    s_add_u32 s37, s37, s14
    s_mul_i32 s37, s37, 20480
    s_add_u32 s37, s37, 2621440
    s_add_u32 s27, s27, 1
    s_sub_u32 s27, s27, s14
    s_mul_i32 s27, s27, 20480
    s_add_u32 s27, s27, 2626560
    s_add_u32 s28, s27, 4096
    s_lshl_b32 s31, s20, 6
    s_add_u32 s31, s31, s13
    s_mul_i32 s31, s31, 6144
    s_add_u32 s31, s31, 5898240
    s_min_u32 s56, s20, 63
    s_lshl_b32 s56, s56, 6
    s_add_u32 s56, s56, s13
    s_mul_i32 s56, s56, 12288
    s_add_u32 s56, s56, 37364736
    s_max_u32 s57, s20, 5
    s_sub_u32 s57, s57, 5
    s_lshl_b32 s57, s57, 6
    s_add_u32 s57, s57, s13
    s_mul_i32 s57, s57, 12288
    s_add_u32 s57, s57, 87696384
    s_cmp_lt_u32 s20, 5
    s_cselect_b32 s57, s56, s57
    s_cmp_gt_u32 s60, 63
    s_cselect_b64 s[42:43], s[38:39], 0
    s_cmp_le_u32 s60, 5
    s_cselect_b64 vcc, s[40:41], 0
    s_or_b64 s[42:43], s[42:43], vcc
    s_cmp_lg_u32 s18, 0
    s_cbranch_scc1 L_R1_slow
L_Rf1_top:
    s_barrier
    buffer_load_dwordx4 v[10:13], v0, s[4:7], s25 offen offset:0 sc1
    buffer_load_dwordx4 v[14:17], v0, s[4:7], s25 offen offset:1024 sc1
    buffer_load_dwordx4 v[18:21], v0, s[4:7], s25 offen offset:2048 sc1
    buffer_load_dwordx4 v[22:25], v0, s[4:7], s25 offen offset:3072 sc1
    buffer_load_dwordx4 v[26:29], v0, s[4:7], s26 offen offset:0 sc1
    s_barrier
    buffer_load_dwordx4 v[46:49], v0, s[4:7], s27 offen offset:0 sc1
    buffer_load_dwordx4 v[30:33], v0, s[4:7], s27 offen offset:1024 sc1
    buffer_load_dwordx4 v[34:37], v0, s[4:7], s27 offen offset:2048 sc1
    buffer_load_dwordx4 v[38:41], v0, s[4:7], s27 offen offset:3072 sc1
    buffer_load_dwordx4 v[42:45], v0, s[4:7], s28 offen offset:0 sc1
    s_mov_b32 s19, 0
L_Rf1_gl_1:
    s_waitcnt vmcnt(9)
    v_mfma_f32_16x16x32_bf16 v[50:53], a[240:243], v[10:13], 0
    v_mfma_f32_16x16x32_bf16 v[54:57], a[244:247], v[10:13], 0
    v_xor_b32 v1, s23, v10
    s_waitcnt vmcnt(8)
    v_mfma_f32_16x16x32_bf16 v[58:61], a[240:243], v[14:17], 0
    v_mfma_f32_16x16x32_bf16 v[62:65], a[244:247], v[14:17], 0
    v_bitop3_b32 v1, v1, v14, s23 bitop3:0xf6
    s_waitcnt vmcnt(7)
    v_mfma_f32_16x16x32_bf16 v[66:69], a[240:243], v[18:21], 0
    v_mfma_f32_16x16x32_bf16 v[70:73], a[244:247], v[18:21], 0
    v_bitop3_b32 v1, v1, v18, s23 bitop3:0xf6
    s_waitcnt vmcnt(6)
    v_mfma_f32_16x16x32_bf16 v[74:77], a[240:243], v[22:25], 0
    v_mfma_f32_16x16x32_bf16 v[78:81], a[244:247], v[22:25], 0
    v_bitop3_b32 v1, v1, v22, s23 bitop3:0xf6
    s_waitcnt vmcnt(5)
    v_mfma_f32_16x16x32_bf16 v[82:85], a[240:243], v[26:29], 0
    v_mfma_f32_16x16x32_bf16 v[86:89], a[244:247], v[26:29], 0
    v_bitop3_b32 v1, v1, v26, s23 bitop3:0xf6
    v_and_b32 v1, 1, v1
    v_cmp_ne_u32 vcc, 0, v1
    s_nop 0
    s_cbranch_vccnz L_Rf1_glfix_3
L_Rf1_gr_2:
    s_waitcnt vmcnt(4)
    v_mfma_f32_16x16x32_bf16 v[50:53], a[240:243], v[46:49], v[50:53]
    v_xor_b32 v1, s23, v46
    v_mfma_f32_16x16x32_bf16 v[54:57], a[244:247], v[46:49], v[54:57]
    s_waitcnt vmcnt(3)
    v_mfma_f32_16x16x32_bf16 v[58:61], a[240:243], v[30:33], v[58:61]
    v_bitop3_b32 v1, v1, v30, s23 bitop3:0xf6
    v_mfma_f32_16x16x32_bf16 v[62:65], a[244:247], v[30:33], v[62:65]
    s_nop 1
    v_cvt_pk_bf16_f32 v90, v50, v51
    v_cvt_pk_bf16_f32 v91, v52, v53
    v_cvt_pk_bf16_f32 v92, v54, v55
    v_cvt_pk_bf16_f32 v93, v56, v57
    ds_write_b128 v0, v[90:93] offset:5120
    s_waitcnt vmcnt(2)
    v_mfma_f32_16x16x32_bf16 v[66:69], a[240:243], v[34:37], v[66:69]
    v_bitop3_b32 v1, v1, v34, s23 bitop3:0xf6
    v_mfma_f32_16x16x32_bf16 v[70:73], a[244:247], v[34:37], v[70:73]
    v_cvt_pk_bf16_f32 v90, v58, v59
    v_cvt_pk_bf16_f32 v91, v60, v61
    v_cvt_pk_bf16_f32 v92, v62, v63
    v_cvt_pk_bf16_f32 v93, v64, v65
    ds_write_b128 v0, v[90:93] offset:6144
    s_waitcnt vmcnt(1)
    v_mfma_f32_16x16x32_bf16 v[74:77], a[240:243], v[38:41], v[74:77]
    v_bitop3_b32 v1, v1, v38, s23 bitop3:0xf6
    v_mfma_f32_16x16x32_bf16 v[78:81], a[244:247], v[38:41], v[78:81]
    v_cvt_pk_bf16_f32 v90, v66, v67
    v_cvt_pk_bf16_f32 v91, v68, v69
    v_cvt_pk_bf16_f32 v92, v70, v71
    v_cvt_pk_bf16_f32 v93, v72, v73
    ds_write_b128 v0, v[90:93] offset:7168
    s_waitcnt vmcnt(0)
    v_mfma_f32_16x16x32_bf16 v[82:85], a[240:243], v[42:45], v[82:85]
    v_bitop3_b32 v1, v1, v42, s23 bitop3:0xf6
    v_mfma_f32_16x16x32_bf16 v[86:89], a[244:247], v[42:45], v[86:89]
    v_cvt_pk_bf16_f32 v90, v74, v75
    v_cvt_pk_bf16_f32 v91, v76, v77
    v_cvt_pk_bf16_f32 v92, v78, v79
    v_cvt_pk_bf16_f32 v93, v80, v81
    ds_write_b128 v0, v[90:93] offset:8192
    s_nop 0
    v_cvt_pk_bf16_f32 v90, v82, v83
    v_cvt_pk_bf16_f32 v91, v84, v85
    v_cvt_pk_bf16_f32 v92, v86, v87
    v_cvt_pk_bf16_f32 v93, v88, v89
    ds_write_b128 v0, v[90:93] offset:9216
    v_and_b32 v1, 1, v1
    v_cmp_ne_u32 vcc, 0, v1
    s_nop 0
    s_cbranch_vccnz L_Rf1_grfix_5
    s_waitcnt lgkmcnt(0)
    s_barrier
    ds_read_b128 v[10:13], v0 offset:0
    ds_read_b128 v[14:17], v0 offset:1024
    ds_read_b128 v[18:21], v0 offset:2048
    ds_read_b128 v[22:25], v0 offset:3072
    ds_read_b128 v[26:29], v0 offset:4096
    s_waitcnt lgkmcnt(4)
    v_mfma_f32_16x16x32_bf16 v[46:49], a[0:3], v[10:13], 0
    s_mov_b32 m0, 38912
    v_mfma_f32_16x16x32_bf16 v[50:53], a[80:83], v[10:13], 0
    v_mfma_f32_16x16x32_bf16 v[54:57], a[160:163], v[10:13], 0
    ds_read_b128 v[10:13], v0 offset:5120
    s_waitcnt lgkmcnt(4)
    v_mfma_f32_16x16x32_bf16 v[46:49], a[4:7], v[14:17], v[46:49]
    buffer_load_dwordx4 v0, s[4:7], s56 offen offset:0 sc1 lds
    v_mfma_f32_16x16x32_bf16 v[50:53], a[84:87], v[14:17], v[50:53]
    v_mfma_f32_16x16x32_bf16 v[54:57], a[164:167], v[14:17], v[54:57]
    ds_read_b128 v[14:17], v0 offset:6144
    s_waitcnt lgkmcnt(4)
    v_mfma_f32_16x16x32_bf16 v[46:49], a[8:11], v[18:21], v[46:49]
    buffer_load_dwordx4 v0, s[4:7], s56 offen offset:1024 sc1 lds
    v_mfma_f32_16x16x32_bf16 v[50:53], a[88:91], v[18:21], v[50:53]
    v_mfma_f32_16x16x32_bf16 v[54:57], a[168:171], v[18:21], v[54:57]
    ds_read_b128 v[18:21], v0 offset:7168
    s_waitcnt lgkmcnt(4)
    v_mfma_f32_16x16x32_bf16 v[46:49], a[12:15], v[22:25], v[46:49]
    buffer_load_dwordx4 v0, s[4:7], s56 offen offset:2048 sc1 lds
    v_mfma_f32_16x16x32_bf16 v[50:53], a[92:95], v[22:25], v[50:53]
    v_mfma_f32_16x16x32_bf16 v[54:57], a[172:175], v[22:25], v[54:57]
    ds_read_b128 v[22:25], v0 offset:8192
    s_waitcnt lgkmcnt(4)
    v_mfma_f32_16x16x32_bf16 v[46:49], a[16:19], v[26:29], v[46:49]
    v_mfma_f32_16x16x32_bf16 v[50:53], a[96:99], v[26:29], v[50:53]
    v_mfma_f32_16x16x32_bf16 v[54:57], a[176:179], v[26:29], v[54:57]
    ds_read_b128 v[26:29], v0 offset:9216
    s_waitcnt lgkmcnt(4)
    v_mfma_f32_16x16x32_bf16 v[46:49], a[20:23], v[10:13], v[46:49]
    v_mfma_f32_16x16x32_bf16 v[50:53], a[100:103], v[10:13], v[50:53]
    v_mfma_f32_16x16x32_bf16 v[54:57], a[180:183], v[10:13], v[54:57]
    ds_read_b128 v[10:13], v0 offset:10240
    s_waitcnt lgkmcnt(4)
    v_mfma_f32_16x16x32_bf16 v[46:49], a[24:27], v[14:17], v[46:49]
    v_mfma_f32_16x16x32_bf16 v[50:53], a[104:107], v[14:17], v[50:53]
    v_mfma_f32_16x16x32_bf16 v[54:57], a[184:187], v[14:17], v[54:57]
    ds_read_b128 v[14:17], v0 offset:11264
    s_waitcnt lgkmcnt(4)
    v_mfma_f32_16x16x32_bf16 v[46:49], a[28:31], v[18:21], v[46:49]
    v_mfma_f32_16x16x32_bf16 v[50:53], a[108:111], v[18:21], v[50:53]
    v_mfma_f32_16x16x32_bf16 v[54:57], a[188:191], v[18:21], v[54:57]
    ds_read_b128 v[18:21], v0 offset:12288
    s_waitcnt lgkmcnt(4)
    v_mfma_f32_16x16x32_bf16 v[46:49], a[32:35], v[22:25], v[46:49]
    v_mfma_f32_16x16x32_bf16 v[50:53], a[112:115], v[22:25], v[50:53]
    v_mfma_f32_16x16x32_bf16 v[54:57], a[192:195], v[22:25], v[54:57]
    ds_read_b128 v[22:25], v0 offset:13312
    s_waitcnt lgkmcnt(4)
    v_mfma_f32_16x16x32_bf16 v[46:49], a[36:39], v[26:29], v[46:49]
    v_mfma_f32_16x16x32_bf16 v[50:53], a[116:119], v[26:29], v[50:53]
    v_mfma_f32_16x16x32_bf16 v[54:57], a[196:199], v[26:29], v[54:57]
    ds_read_b128 v[26:29], v0 offset:14336
    s_waitcnt lgkmcnt(4)
    v_mfma_f32_16x16x32_bf16 v[46:49], a[40:43], v[10:13], v[46:49]
    v_mfma_f32_16x16x32_bf16 v[50:53], a[120:123], v[10:13], v[50:53]
    v_mfma_f32_16x16x32_bf16 v[54:57], a[200:203], v[10:13], v[54:57]
    ds_read_b128 v[10:13], v0 offset:15360
    s_waitcnt lgkmcnt(4)
    v_mfma_f32_16x16x32_bf16 v[46:49], a[44:47], v[14:17], v[46:49]
    ds_read_b128 v[58:61], v0 offset:29696
    v_mfma_f32_16x16x32_bf16 v[50:53], a[124:127], v[14:17], v[50:53]
    v_mfma_f32_16x16x32_bf16 v[54:57], a[204:207], v[14:17], v[54:57]
    ds_read_b128 v[14:17], v0 offset:16384
    s_waitcnt lgkmcnt(5)
    v_mfma_f32_16x16x32_bf16 v[46:49], a[48:51], v[18:21], v[46:49]
    ds_read_b128 v[62:65], v0 offset:30720
    v_mfma_f32_16x16x32_bf16 v[50:53], a[128:131], v[18:21], v[50:53]
    v_mfma_f32_16x16x32_bf16 v[54:57], a[208:211], v[18:21], v[54:57]
    ds_read_b128 v[18:21], v0 offset:17408
    s_waitcnt lgkmcnt(6)
    v_mfma_f32_16x16x32_bf16 v[46:49], a[52:55], v[22:25], v[46:49]
    ds_read_b128 v[66:69], v0 offset:31744
    v_mfma_f32_16x16x32_bf16 v[50:53], a[132:135], v[22:25], v[50:53]
    v_mfma_f32_16x16x32_bf16 v[54:57], a[212:215], v[22:25], v[54:57]
    ds_read_b128 v[22:25], v0 offset:18432
    s_waitcnt lgkmcnt(7)
    v_mfma_f32_16x16x32_bf16 v[46:49], a[56:59], v[26:29], v[46:49]
    ds_read_b128 v[70:73], v0 offset:41984
    v_mfma_f32_16x16x32_bf16 v[50:53], a[136:139], v[26:29], v[50:53]
    v_mfma_f32_16x16x32_bf16 v[54:57], a[216:219], v[26:29], v[54:57]
    ds_read_b128 v[26:29], v0 offset:19456
    s_waitcnt lgkmcnt(8)
    v_mfma_f32_16x16x32_bf16 v[46:49], a[60:63], v[10:13], v[46:49]
    ds_read_b128 v[74:77], v0 offset:43008
    v_mfma_f32_16x16x32_bf16 v[50:53], a[140:143], v[10:13], v[50:53]
    v_mfma_f32_16x16x32_bf16 v[54:57], a[220:223], v[10:13], v[54:57]
    ds_read_b128 v[10:13], v0 offset:0
    s_waitcnt lgkmcnt(8)
    v_mfma_f32_16x16x32_bf16 v[46:49], a[64:67], v[14:17], v[46:49]
    ds_read_b128 v[78:81], v0 offset:44032
    v_mfma_f32_16x16x32_bf16 v[50:53], a[144:147], v[14:17], v[50:53]
    v_mfma_f32_16x16x32_bf16 v[54:57], a[224:227], v[14:17], v[54:57]
    ds_read_b128 v[14:17], v0 offset:1024
    s_waitcnt lgkmcnt(8)
    v_mfma_f32_16x16x32_bf16 v[46:49], a[68:71], v[18:21], v[46:49]
    v_mfma_f32_16x16x32_bf16 v[50:53], a[148:151], v[18:21], v[50:53]
    v_mfma_f32_16x16x32_bf16 v[54:57], a[228:231], v[18:21], v[54:57]
    ds_read_b128 v[18:21], v0 offset:2048
    s_waitcnt lgkmcnt(7)
    v_mfma_f32_16x16x32_bf16 v[46:49], a[72:75], v[22:25], v[46:49]
    v_mfma_f32_16x16x32_bf16 v[50:53], a[152:155], v[22:25], v[50:53]
    v_mfma_f32_16x16x32_bf16 v[54:57], a[232:235], v[22:25], v[54:57]
    ds_read_b128 v[22:25], v0 offset:3072
    s_waitcnt lgkmcnt(6)
    v_mfma_f32_16x16x32_bf16 v[46:49], a[76:79], v[26:29], v[46:49]
    v_mfma_f32_16x16x32_bf16 v[50:53], a[156:159], v[26:29], v[50:53]
    v_mfma_f32_16x16x32_bf16 v[54:57], a[236:239], v[26:29], v[54:57]
    ds_read_b128 v[26:29], v0 offset:4096
    s_waitcnt lgkmcnt(5)
    v_mfma_f32_16x16x32_bf16 v[30:33], v[10:13], v[96:99], 0
    v_mfma_f32_16x16x32_bf16 v[34:37], v[10:13], v[176:179], 0
    ds_read_b128 v[10:13], v0 offset:5120
    s_nop 0
    v_cvt_pk_bf16_f32 v82, v46, v47
    v_cvt_pk_bf16_f32 v83, v48, v49
    ds_write_b64 v0, v[82:83] offset:21512
    v_cvt_pk_bf16_f32 v84, v50, v51
    v_cvt_pk_bf16_f32 v85, v52, v53
    ds_write_b64 v0, v[84:85] offset:22528
    v_cvt_pk_bf16_f32 v86, v54, v55
    v_cvt_pk_bf16_f32 v87, v56, v57
    ds_write_b64 v0, v[86:87] offset:22536
    s_waitcnt lgkmcnt(7)
    v_mfma_f32_16x16x32_bf16 v[30:33], v[14:17], v[100:103], v[30:33]
    v_mfma_f32_16x16x32_bf16 v[34:37], v[14:17], v[180:183], v[34:37]
    ds_read_b128 v[14:17], v0 offset:6144
    s_waitcnt lgkmcnt(1)
    s_barrier
    ds_read_b128 v[46:49], v0 offset:20480
    ds_read_b128 v[50:53], v0 offset:21504
    ds_read_b128 v[54:57], v0 offset:22528
    v_mfma_f32_16x16x32_bf16 v[30:33], v[18:21], v[104:107], v[30:33]
    v_mfma_f32_16x16x32_bf16 v[34:37], v[18:21], v[184:187], v[34:37]
    ds_read_b128 v[18:21], v0 offset:7168
    v_mfma_f32_16x16x32_bf16 v[30:33], v[22:25], v[108:111], v[30:33]
    v_mfma_f32_16x16x32_bf16 v[34:37], v[22:25], v[188:191], v[34:37]
    ds_read_b128 v[22:25], v0 offset:8192
    s_waitcnt lgkmcnt(4)
    v_mfma_f32_16x16x32_bf16 v[38:41], v[58:61], v[46:49], 0
    v_mfma_f32_16x16x32_bf16 v[42:45], v[70:73], v[46:49], 0
    s_waitcnt lgkmcnt(3)
    v_mfma_f32_16x16x32_bf16 v[38:41], v[62:65], v[50:53], v[38:41]
    v_mfma_f32_16x16x32_bf16 v[42:45], v[74:77], v[50:53], v[42:45]
    s_waitcnt lgkmcnt(2)
    v_mfma_f32_16x16x32_bf16 v[38:41], v[66:69], v[54:57], v[38:41]
    v_mfma_f32_16x16x32_bf16 v[42:45], v[78:81], v[54:57], v[42:45]
    v_mfma_f32_16x16x32_bf16 v[30:33], v[26:29], v[112:115], v[30:33]
    v_mfma_f32_16x16x32_bf16 v[34:37], v[26:29], v[192:195], v[34:37]
    ds_read_b128 v[26:29], v0 offset:9216
    s_nop 4
    v_cndmask_b32 v38, v42, v38, s[48:49]
    v_cndmask_b32 v39, v43, v39, s[48:49]
    v_cndmask_b32 v40, v44, v40, s[48:49]
    v_cndmask_b32 v41, v45, v41, s[48:49]
    v_and_or_b32 v38, v38, -2, s22
    buffer_store_dwordx4 v[38:41], v0, s[4:7], s29 offen
    v_mfma_f32_16x16x32_bf16 v[30:33], v[10:13], v[116:119], v[30:33]
    v_mfma_f32_16x16x32_bf16 v[34:37], v[10:13], v[196:199], v[34:37]
    ds_read_b128 v[10:13], v0 offset:10240
    v_mfma_f32_16x16x32_bf16 v[30:33], v[14:17], v[120:123], v[30:33]
    v_mfma_f32_16x16x32_bf16 v[34:37], v[14:17], v[200:203], v[34:37]
    ds_read_b128 v[14:17], v0 offset:11264
    s_waitcnt lgkmcnt(4)
    v_mfma_f32_16x16x32_bf16 v[30:33], v[18:21], v[124:127], v[30:33]
    v_mfma_f32_16x16x32_bf16 v[34:37], v[18:21], v[204:207], v[34:37]
    ds_read_b128 v[18:21], v0 offset:12288
    s_waitcnt lgkmcnt(4)
    v_mfma_f32_16x16x32_bf16 v[30:33], v[22:25], v[128:131], v[30:33]
    v_mfma_f32_16x16x32_bf16 v[34:37], v[22:25], v[208:211], v[34:37]
    ds_read_b128 v[22:25], v0 offset:13312
    s_waitcnt lgkmcnt(4)
    v_mfma_f32_16x16x32_bf16 v[30:33], v[26:29], v[132:135], v[30:33]
    v_mfma_f32_16x16x32_bf16 v[34:37], v[26:29], v[212:215], v[34:37]
    ds_read_b128 v[26:29], v0 offset:14336
    s_waitcnt lgkmcnt(4)
    v_mfma_f32_16x16x32_bf16 v[30:33], v[10:13], v[136:139], v[30:33]
    v_mfma_f32_16x16x32_bf16 v[34:37], v[10:13], v[216:219], v[34:37]
    ds_read_b128 v[10:13], v0 offset:15360
    s_waitcnt lgkmcnt(4)
    v_mfma_f32_16x16x32_bf16 v[30:33], v[14:17], v[140:143], v[30:33]
    v_mfma_f32_16x16x32_bf16 v[34:37], v[14:17], v[220:223], v[34:37]
    ds_read_b128 v[14:17], v0 offset:16384
    s_waitcnt lgkmcnt(4)
    v_mfma_f32_16x16x32_bf16 v[30:33], v[18:21], v[144:147], v[30:33]
    v_mfma_f32_16x16x32_bf16 v[34:37], v[18:21], v[224:227], v[34:37]
    ds_read_b128 v[18:21], v0 offset:17408
    s_waitcnt lgkmcnt(4)
    v_mfma_f32_16x16x32_bf16 v[30:33], v[22:25], v[148:151], v[30:33]
    v_mfma_f32_16x16x32_bf16 v[34:37], v[22:25], v[228:231], v[34:37]
    ds_read_b128 v[22:25], v0 offset:18432
    v_pk_mul_f32 v[42:43], v[38:39], s[52:53]
    v_pk_mul_f32 v[44:45], v[40:41], s[52:53]
    s_waitcnt vmcnt(0)
    buffer_load_dwordx4 v[82:85], v0, s[4:7], s30 offen sc1
    s_mov_b32 s19, 0
    s_waitcnt lgkmcnt(4)
    v_mfma_f32_16x16x32_bf16 v[30:33], v[26:29], v[152:155], v[30:33]
    v_mfma_f32_16x16x32_bf16 v[34:37], v[26:29], v[232:235], v[34:37]
    ds_read_b128 v[26:29], v0 offset:19456
    s_waitcnt lgkmcnt(4)
    v_mfma_f32_16x16x32_bf16 v[30:33], v[10:13], v[156:159], v[30:33]
    v_mfma_f32_16x16x32_bf16 v[34:37], v[10:13], v[236:239], v[34:37]
    s_waitcnt lgkmcnt(3)
    v_mfma_f32_16x16x32_bf16 v[30:33], v[14:17], v[160:163], v[30:33]
    v_mfma_f32_16x16x32_bf16 v[34:37], v[14:17], v[240:243], v[34:37]
    s_waitcnt lgkmcnt(2)
    v_mfma_f32_16x16x32_bf16 v[30:33], v[18:21], v[164:167], v[30:33]
    v_mfma_f32_16x16x32_bf16 v[34:37], v[18:21], v[244:247], v[34:37]
    s_waitcnt lgkmcnt(1)
    v_mfma_f32_16x16x32_bf16 v[30:33], v[22:25], v[168:171], v[30:33]
    v_mfma_f32_16x16x32_bf16 v[34:37], v[22:25], v[248:251], v[34:37]
    s_waitcnt lgkmcnt(0)
    v_mfma_f32_16x16x32_bf16 v[30:33], v[26:29], v[172:175], v[30:33]
    v_mfma_f32_16x16x32_bf16 v[34:37], v[26:29], v[252:255], v[34:37]
    s_nop 6
    v_cvt_pk_bf16_f32 v88, v30, v31
    v_cvt_pk_bf16_f32 v89, v32, v33
    v_cvt_pk_bf16_f32 v90, v34, v35
    v_cvt_pk_bf16_f32 v91, v36, v37
    s_add_u32 s60, s31, 4096
    s_cmp_eq_u32 s20, 68
    s_cbranch_scc1 L_Rf1_tail
L_Rf1_ha_6:
    s_waitcnt vmcnt(0)
    v_lshlrev_b32 v1, 31, v82
    v_pk_fma_f32 v[38:39], v[82:83], s[52:53], v[42:43]
    v_pk_fma_f32 v[40:41], v[84:85], s[52:53], v[44:45]
    ds_write_b128 v0, v[38:41] offset:27648
    v_cmp_ne_u32 vcc, s21, v1
    s_nop 0
    s_cbranch_vccnz L_Rf1_hafix_7
    s_waitcnt vmcnt(0) lgkmcnt(0)
    s_barrier
    ds_read_b128 v[10:13], v0 offset:26624
    ds_read_b128 v[14:17], v0 offset:27648
    ds_read_b128 v[18:21], v0 offset:28672
    ds_read_b128 v[58:61], v0 offset:37888
    ds_read_b128 v[62:65], v0 offset:38912
    ds_read_b128 v[66:69], v0 offset:50176
    ds_read_b128 v[70:73], v0 offset:51200
    buffer_store_dwordx4 v[88:91], v0, s[4:7], s60 offen sc1
    s_waitcnt lgkmcnt(5)
    v_max3_f32 v22, v10, v11, v12
    v_max3_f32 v23, v13, v14, v15
    v_max3_f32 v22, v22, v16, v17
    s_waitcnt lgkmcnt(4)
    v_max3_f32 v23, v23, v18, v19
    v_max3_f32 v22, v22, v20, v21
    v_max_f32 v22, v22, v23
    v_mov_b32 v23, v22
    ds_read_b128 v[30:33], v2 offset:0
    ds_read_b128 v[34:37], v2 offset:1024
    v_permlane32_swap_b32 v22, v23
    v_max_f32 v22, v22, v23
    v_mov_b32 v23, v22
    ds_read_b128 v[38:41], v2 offset:2048
    ds_read_b128 v[42:45], v2 offset:3072
    v_permlane16_swap_b32 v22, v23
    v_max_f32 v22, v22, v23
    v_pk_add_f32 v[10:11], v[10:11], v[22:23] op_sel_hi:[1,0] neg_lo:[0,1] neg_hi:[0,1]
    v_pk_add_f32 v[12:13], v[12:13], v[22:23] op_sel_hi:[1,0] neg_lo:[0,1] neg_hi:[0,1]
    v_pk_add_f32 v[14:15], v[14:15], v[22:23] op_sel_hi:[1,0] neg_lo:[0,1] neg_hi:[0,1]
    v_pk_add_f32 v[16:17], v[16:17], v[22:23] op_sel_hi:[1,0] neg_lo:[0,1] neg_hi:[0,1]
    v_pk_add_f32 v[18:19], v[18:19], v[22:23] op_sel_hi:[1,0] neg_lo:[0,1] neg_hi:[0,1]
    v_pk_add_f32 v[20:21], v[20:21], v[22:23] op_sel_hi:[1,0] neg_lo:[0,1] neg_hi:[0,1]
    v_exp_f32 v10, v10
    v_exp_f32 v11, v11
    v_exp_f32 v12, v12
    v_exp_f32 v13, v13
    v_exp_f32 v14, v14
    v_exp_f32 v15, v15
    v_cvt_pk_bf16_f32 v24, v10, v11
    v_cvt_pk_bf16_f32 v25, v12, v13
    v_exp_f32 v16, v16
    v_exp_f32 v17, v17
    v_mfma_f32_16x16x16_bf16 v[46:49], v[88:89], v[24:25], 0
    v_mfma_f32_16x16x16_bf16 v[82:85], v[90:91], v[24:25], 0
    v_exp_f32 v18, v18
    v_exp_f32 v19, v19
    v_exp_f32 v20, v20
    v_exp_f32 v21, v21
    v_cvt_pk_bf16_f32 v26, v14, v15
    v_cvt_pk_bf16_f32 v27, v16, v17
    v_cvt_pk_bf16_f32 v28, v18, v19
    v_cvt_pk_bf16_f32 v29, v20, v21
    v_pk_add_f32 v[22:23], v[10:11], v[12:13]
    v_pk_add_f32 v[14:15], v[14:15], v[16:17]
    s_waitcnt lgkmcnt(4)
    v_mfma_f32_16x16x32_bf16 v[50:53], v[58:61], v[26:29], v[46:49]
    v_pk_add_f32 v[18:19], v[18:19], v[20:21]
    v_mfma_f32_16x16x32_bf16 v[54:57], v[66:69], v[26:29], v[46:49]
    v_pk_add_f32 v[22:23], v[22:23], v[14:15]
    v_pk_add_f32 v[22:23], v[22:23], v[18:19]
    v_mfma_f32_16x16x32_bf16 v[10:13], v[62:65], v[26:29], v[82:85]
    v_add_f32 v22, v22, v23
    v_mfma_f32_16x16x32_bf16 v[14:17], v[70:73], v[26:29], v[82:85]
    v_mov_b32 v23, v22
    ds_read_b128 v[74:77], v2 offset:4096
    ds_read_b128 v[78:81], v2 offset:5120
    v_permlane32_swap_b32 v22, v23
    v_add_f32 v22, v22, v23
    v_mov_b32 v23, v22
    v_cndmask_b32 v50, v54, v50, s[48:49]
    v_cndmask_b32 v51, v55, v51, s[48:49]
    v_permlane16_swap_b32 v22, v23
    v_add_f32 v22, v22, v23
    v_rcp_f32 v22, v22
    v_cndmask_b32 v52, v56, v52, s[48:49]
    v_cndmask_b32 v53, v57, v53, s[48:49]
    v_cndmask_b32 v10, v14, v10, s[48:49]
    v_cndmask_b32 v11, v15, v11, s[48:49]
    v_cndmask_b32 v12, v16, v12, s[48:49]
    v_cndmask_b32 v13, v17, v13, s[48:49]
    v_pk_mul_f32 v[50:51], v[50:51], v[22:23] op_sel_hi:[1,0]
    v_pk_mul_f32 v[52:53], v[52:53], v[22:23] op_sel_hi:[1,0]
    v_cvt_pk_bf16_f32 v24, v50, v51
    v_cvt_pk_bf16_f32 v25, v52, v53
    v_pk_mul_f32 v[10:11], v[10:11], v[22:23] op_sel_hi:[1,0]
    v_pk_mul_f32 v[12:13], v[12:13], v[22:23] op_sel_hi:[1,0]
    v_cvt_pk_bf16_f32 v26, v10, v11
    v_cvt_pk_bf16_f32 v27, v12, v13
    ds_write_b128 v0, v[24:27] offset:1024
    s_waitcnt lgkmcnt(0)
    s_barrier
    ds_read_b128 v[10:13], v0 offset:0
    ds_read_b128 v[14:17], v0 offset:1024
    ds_read_b128 v[18:21], v0 offset:2048
    s_add_u32 s20, s20, 1
    s_waitcnt lgkmcnt(2)
    v_mfma_f32_16x16x32_bf16 v[46:49], v[30:33], v[10:13], 0
    ds_read_b128 v[30:33], v2 offset:6144
    s_waitcnt lgkmcnt(2)
    v_mfma_f32_16x16x32_bf16 v[46:49], v[34:37], v[14:17], v[46:49]
    ds_read_b128 v[34:37], v2 offset:7168
    s_waitcnt lgkmcnt(2)
    v_mfma_f32_16x16x32_bf16 v[46:49], v[38:41], v[18:21], v[46:49]
    ds_read_b128 v[38:41], v2 offset:8192
    v_mfma_f32_16x16x32_bf16 v[50:53], v[42:45], v[10:13], 0
    ds_read_b128 v[42:45], v2 offset:9216
    v_mfma_f32_16x16x32_bf16 v[50:53], v[74:77], v[14:17], v[50:53]
    ds_read_b128 v[74:77], v2 offset:10240
    v_mfma_f32_16x16x32_bf16 v[50:53], v[78:81], v[18:21], v[50:53]
    ds_read_b128 v[78:81], v2 offset:11264
    s_waitcnt lgkmcnt(3)
    v_mfma_f32_16x16x32_bf16 v[54:57], v[30:33], v[10:13], 0
    ds_read_b128 v[30:33], v2 offset:12288
    v_cvt_pk_bf16_f32 v62, v46, v47
    v_mfma_f32_16x16x32_bf16 v[54:57], v[34:37], v[14:17], v[54:57]
    ds_read_b128 v[34:37], v2 offset:13312
    v_cvt_pk_bf16_f32 v63, v48, v49
    v_and_or_b32 v62, v62, -2, s22
    v_mfma_f32_16x16x32_bf16 v[54:57], v[38:41], v[18:21], v[54:57]
    ds_read_b128 v[38:41], v2 offset:14336
    v_cvt_pk_bf16_f32 v64, v50, v51
    s_waitcnt lgkmcnt(3)
    v_mfma_f32_16x16x32_bf16 v[58:61], v[42:45], v[10:13], 0
    ds_read_b128 v[42:45], v2 offset:15360
    v_cvt_pk_bf16_f32 v65, v52, v53
    v_mfma_f32_16x16x32_bf16 v[58:61], v[74:77], v[14:17], v[58:61]
    ds_read_b128 v[74:77], v2 offset:16384
    buffer_store_dwordx4 v[62:65], v3, s[4:7], s32 offen
    v_mfma_f32_16x16x32_bf16 v[58:61], v[78:81], v[18:21], v[58:61]
    ds_read_b128 v[78:81], v2 offset:17408
    s_waitcnt lgkmcnt(3)
    v_mfma_f32_16x16x32_bf16 v[46:49], v[30:33], v[10:13], 0
    ds_read_b128 v[30:33], v2 offset:18432
    v_cvt_pk_bf16_f32 v66, v54, v55
    v_mfma_f32_16x16x32_bf16 v[46:49], v[34:37], v[14:17], v[46:49]
    ds_read_b128 v[34:37], v2 offset:19456
    v_cvt_pk_bf16_f32 v67, v56, v57
    v_and_or_b32 v66, v66, -2, s22
    v_mfma_f32_16x16x32_bf16 v[46:49], v[38:41], v[18:21], v[46:49]
    ds_read_b128 v[38:41], v2 offset:20480
    v_cvt_pk_bf16_f32 v68, v58, v59
    s_waitcnt lgkmcnt(3)
    v_mfma_f32_16x16x32_bf16 v[50:53], v[42:45], v[10:13], 0
    ds_read_b128 v[42:45], v2 offset:21504
    v_cvt_pk_bf16_f32 v69, v60, v61
    v_mfma_f32_16x16x32_bf16 v[50:53], v[74:77], v[14:17], v[50:53]
    ds_read_b128 v[74:77], v2 offset:22528
    buffer_store_dwordx4 v[66:69], v4, s[4:7], s32 offen
    v_mfma_f32_16x16x32_bf16 v[50:53], v[78:81], v[18:21], v[50:53]
    ds_read_b128 v[78:81], v2 offset:23552
    s_waitcnt lgkmcnt(3)
    v_mfma_f32_16x16x32_bf16 v[54:57], v[30:33], v[10:13], 0
    ds_read_b128 v[30:33], v2 offset:24576
    v_cvt_pk_bf16_f32 v62, v46, v47
    v_mfma_f32_16x16x32_bf16 v[54:57], v[34:37], v[14:17], v[54:57]
    ds_read_b128 v[34:37], v2 offset:25600
    v_cvt_pk_bf16_f32 v63, v48, v49
    v_and_or_b32 v62, v62, -2, s22
    v_mfma_f32_16x16x32_bf16 v[54:57], v[38:41], v[18:21], v[54:57]
    ds_read_b128 v[38:41], v2 offset:26624
    v_cvt_pk_bf16_f32 v64, v50, v51
    s_waitcnt lgkmcnt(3)
    v_mfma_f32_16x16x32_bf16 v[58:61], v[42:45], v[10:13], 0
    ds_read_b128 v[42:45], v2 offset:27648
    v_cvt_pk_bf16_f32 v65, v52, v53
    v_mfma_f32_16x16x32_bf16 v[58:61], v[74:77], v[14:17], v[58:61]
    ds_read_b128 v[74:77], v2 offset:28672
    buffer_store_dwordx4 v[62:65], v5, s[4:7], s32 offen
    v_mfma_f32_16x16x32_bf16 v[58:61], v[78:81], v[18:21], v[58:61]
    ds_read_b128 v[78:81], v2 offset:29696
    s_waitcnt lgkmcnt(3)
    v_mfma_f32_16x16x32_bf16 v[46:49], v[30:33], v[10:13], 0
    v_cvt_pk_bf16_f32 v66, v54, v55
    v_mfma_f32_16x16x32_bf16 v[46:49], v[34:37], v[14:17], v[46:49]
    v_cvt_pk_bf16_f32 v67, v56, v57
    v_and_or_b32 v66, v66, -2, s22
    v_mfma_f32_16x16x32_bf16 v[46:49], v[38:41], v[18:21], v[46:49]
    v_cvt_pk_bf16_f32 v68, v58, v59
    s_waitcnt lgkmcnt(0)
    v_mfma_f32_16x16x32_bf16 v[50:53], v[42:45], v[10:13], 0
    v_cvt_pk_bf16_f32 v69, v60, v61
    v_mfma_f32_16x16x32_bf16 v[50:53], v[74:77], v[14:17], v[50:53]
    buffer_store_dwordx4 v[66:69], v6, s[4:7], s32 offen
    v_mfma_f32_16x16x32_bf16 v[50:53], v[78:81], v[18:21], v[50:53]
    s_nop 0
    v_cvt_pk_bf16_f32 v62, v46, v47
    v_cvt_pk_bf16_f32 v63, v48, v49
    v_and_or_b32 v62, v62, -2, s22
    s_nop 3
    v_cvt_pk_bf16_f32 v64, v50, v51
    v_cvt_pk_bf16_f32 v65, v52, v53
    buffer_store_dwordx4 v[62:65], v7, s[4:7], s32 offen
    v_accvgpr_read_b32 v78, a252
    v_accvgpr_read_b32 v79, a253
    v_accvgpr_read_b32 v80, a254
    v_accvgpr_read_b32 v81, a255
    s_mov_b32 s19, 0
    s_waitcnt vmcnt(0)
    buffer_load_dwordx4 v[26:29], v8, s[4:7], s32 offen offset:0 sc1
    buffer_load_dwordx4 v[30:33], v8, s[4:7], s32 offen offset:2560 sc1
    buffer_load_dwordx4 v[34:37], v8, s[4:7], s33 offen offset:0 sc1
    buffer_load_dwordx4 v[38:41], v8, s[4:7], s33 offen offset:2560 sc1
    buffer_load_dwordx4 v[42:45], v8, s[4:7], s34 offen offset:0 sc1
    buffer_load_dwordx4 v[46:49], v8, s[4:7], s34 offen offset:2560 sc1
    buffer_load_dwordx4 v[50:53], v8, s[4:7], s35 offen offset:0 sc1
    buffer_load_dwordx4 v[54:57], v8, s[4:7], s35 offen offset:2560 sc1
L_Rf1_hb_8:
    s_waitcnt vmcnt(7)
    v_mfma_f32_16x16x32_bf16 v[70:73], a[248:251], v[26:29], 0
    v_xor_b32 v1, s44, v26
    s_waitcnt vmcnt(6)
    v_mfma_f32_16x16x32_bf16 v[70:73], a[248:251], v[30:33], v[70:73]
    v_bitop3_b32 v1, v1, v30, s44 bitop3:0xf6
    s_waitcnt vmcnt(5)
    v_mfma_f32_16x16x32_bf16 v[70:73], a[248:251], v[34:37], v[70:73]
    v_bitop3_b32 v1, v1, v34, s44 bitop3:0xf6
    s_waitcnt vmcnt(4)
    v_mfma_f32_16x16x32_bf16 v[70:73], a[248:251], v[38:41], v[70:73]
    v_bitop3_b32 v1, v1, v38, s44 bitop3:0xf6
    s_waitcnt vmcnt(3)
    v_mfma_f32_16x16x32_bf16 v[70:73], a[248:251], v[42:45], v[70:73]
    v_bitop3_b32 v1, v1, v42, s44 bitop3:0xf6
    s_waitcnt vmcnt(2)
    v_mfma_f32_16x16x32_bf16 v[70:73], a[248:251], v[46:49], v[70:73]
    v_bitop3_b32 v1, v1, v46, s44 bitop3:0xf6
    s_waitcnt vmcnt(1)
    v_mfma_f32_16x16x32_bf16 v[70:73], a[248:251], v[50:53], v[70:73]
    v_bitop3_b32 v1, v1, v50, s44 bitop3:0xf6
    s_waitcnt vmcnt(0)
    v_mfma_f32_16x16x32_bf16 v[70:73], a[248:251], v[54:57], v[70:73]
    v_bitop3_b32 v1, v1, v54, s44 bitop3:0xf6
    v_and_b32 v1, 1, v1
    v_cmp_ne_u32 vcc, 0, v1
    s_nop 0
    s_cbranch_vccnz L_Rf1_hbfix_9
    s_nop 2
    v_cvt_pk_bf16_f32 v74, v70, v71
    v_cvt_pk_bf16_f32 v75, v72, v73
    v_mov_b32 v76, v74
    v_mov_b32 v77, v75
    s_nop 0
    v_permlane16_swap_b32 v74, v76
    v_permlane16_swap_b32 v75, v77
    v_cndmask_b32 v74, v74, v78, s[42:43]
    v_cndmask_b32 v75, v75, v79, s[42:43]
    v_cndmask_b32 v76, v76, v80, s[42:43]
    v_cndmask_b32 v77, v77, v81, s[42:43]
    v_and_or_b32 v74, v74, -2, s24
    s_mov_b64 exec, s[46:47]
    buffer_store_dwordx4 v[74:77], v9, s[4:7], s36 offen
    buffer_store_dwordx4 v[74:77], v9, s[4:7], s37 offen sc1
    s_mov_b64 exec, -1
    s_add_u32 s60, s20, 1
    s_and_b32 s22, s60, 1
    s_lshl_b32 s21, s22, 31
    s_sub_u32 s44, 0, s22
    s_bfe_u32 s23, s20, 0x10001
    s_sub_u32 s23, s23, 1
    s_lshr_b32 s24, s60, 1
    s_andn2_b32 s24, 1, s24
    s_lshl_b32 s61, s14, 15
    s_add_u32 s61, s61, 1179648
    s_and_b32 s25, s20, 1
    s_lshl_b32 s25, s25, 16
    s_add_u32 s25, s25, s61
    s_add_u32 s25, s25, 5120
    s_add_u32 s26, s25, 4096
    s_lshl_b32 s36, s22, 16
    s_add_u32 s36, s36, s61
    s_lshl_b32 s27, s20, 1
    s_add_u32 s37, s27, 2
    s_add_u32 s37, s37, s14
    s_mul_i32 s37, s37, 20480
    s_add_u32 s37, s37, 2621440
    s_add_u32 s27, s27, 1
    s_sub_u32 s27, s27, s14
    s_mul_i32 s27, s27, 20480
    s_add_u32 s27, s27, 2626560
    s_add_u32 s28, s27, 4096
    s_lshl_b32 s31, s20, 6
    s_add_u32 s31, s31, s13
    s_mul_i32 s31, s31, 6144
    s_add_u32 s31, s31, 5898240
    s_min_u32 s56, s20, 63
    s_lshl_b32 s56, s56, 6
    s_add_u32 s56, s56, s13
    s_mul_i32 s56, s56, 12288
    s_add_u32 s56, s56, 37364736
    s_max_u32 s57, s20, 5
    s_sub_u32 s57, s57, 5
    s_lshl_b32 s57, s57, 6
    s_add_u32 s57, s57, s13
    s_mul_i32 s57, s57, 12288
    s_add_u32 s57, s57, 87696384
    s_cmp_lt_u32 s20, 5
    s_cselect_b32 s57, s56, s57
    s_cmp_gt_u32 s60, 63
    s_cselect_b64 s[42:43], s[38:39], 0
    s_cmp_le_u32 s60, 5
    s_cselect_b64 vcc, s[40:41], 0
    s_or_b64 s[42:43], s[42:43], vcc
    s_waitcnt vmcnt(1)
    s_branch L_Rf1_top
L_Rf1_tail:
    s_waitcnt lgkmcnt(0)
    buffer_store_dwordx4 v[88:91], v0, s[4:7], s60 offen sc1
    s_waitcnt vmcnt(0) lgkmcnt(0)
    s_barrier
    v_mov_b32 v22, 69
    s_mov_b64 exec, 1
    s_mov_b64 exec, -1
    s_waitcnt vmcnt(0)
    s_endpgm
L_Rf1_glfix_3:
    buffer_load_dwordx4 v[10:13], v0, s[4:7], s25 offen offset:0 sc1
    buffer_load_dwordx4 v[14:17], v0, s[4:7], s25 offen offset:1024 sc1
    buffer_load_dwordx4 v[18:21], v0, s[4:7], s25 offen offset:2048 sc1
    buffer_load_dwordx4 v[22:25], v0, s[4:7], s25 offen offset:3072 sc1
    buffer_load_dwordx4 v[26:29], v0, s[4:7], s26 offen offset:0 sc1
    buffer_load_dwordx4 v[46:49], v0, s[4:7], s27 offen offset:0 sc1
    buffer_load_dwordx4 v[30:33], v0, s[4:7], s27 offen offset:1024 sc1
    buffer_load_dwordx4 v[34:37], v0, s[4:7], s27 offen offset:2048 sc1
    buffer_load_dwordx4 v[38:41], v0, s[4:7], s27 offen offset:3072 sc1
    buffer_load_dwordx4 v[42:45], v0, s[4:7], s28 offen offset:0 sc1
    s_add_u32 s19, s19, 1
    s_cmp_lt_u32 s19, 524288
    s_cbranch_scc1 L_Rf1_gl_1
    s_branch L_fail
L_Rf1_grfix_5:
    buffer_load_dwordx4 v[46:49], v0, s[4:7], s27 offen offset:0 sc1
    buffer_load_dwordx4 v[30:33], v0, s[4:7], s27 offen offset:1024 sc1
    buffer_load_dwordx4 v[34:37], v0, s[4:7], s27 offen offset:2048 sc1
    buffer_load_dwordx4 v[38:41], v0, s[4:7], s27 offen offset:3072 sc1
    buffer_load_dwordx4 v[42:45], v0, s[4:7], s28 offen offset:0 sc1
    s_add_u32 s19, s19, 1
    s_cmp_lt_u32 s19, 524288
    s_cbranch_scc1 L_Rf1_gr2_4
    s_branch L_fail
L_Rf1_gr2_4:
    v_mfma_f32_16x16x32_bf16 v[50:53], a[240:243], v[10:13], 0
    v_mfma_f32_16x16x32_bf16 v[54:57], a[244:247], v[10:13], 0
    v_mfma_f32_16x16x32_bf16 v[58:61], a[240:243], v[14:17], 0
    v_mfma_f32_16x16x32_bf16 v[62:65], a[244:247], v[14:17], 0
    v_mfma_f32_16x16x32_bf16 v[66:69], a[240:243], v[18:21], 0
    v_mfma_f32_16x16x32_bf16 v[70:73], a[244:247], v[18:21], 0
    v_mfma_f32_16x16x32_bf16 v[74:77], a[240:243], v[22:25], 0
    v_mfma_f32_16x16x32_bf16 v[78:81], a[244:247], v[22:25], 0
    v_mfma_f32_16x16x32_bf16 v[82:85], a[240:243], v[26:29], 0
    v_mfma_f32_16x16x32_bf16 v[86:89], a[244:247], v[26:29], 0
    s_branch L_Rf1_gr_2
L_Rf1_hafix_7:
    buffer_load_dwordx4 v[82:85], v0, s[4:7], s30 offen sc1
    s_add_u32 s19, s19, 1
    s_cmp_lt_u32 s19, 524288
    s_cbranch_scc1 L_Rf1_ha_6
    s_branch L_fail
L_Rf1_hbfix_9:
    buffer_load_dwordx4 v[26:29], v8, s[4:7], s32 offen offset:0 sc1
    buffer_load_dwordx4 v[30:33], v8, s[4:7], s32 offen offset:2560 sc1
    buffer_load_dwordx4 v[34:37], v8, s[4:7], s33 offen offset:0 sc1
    buffer_load_dwordx4 v[38:41], v8, s[4:7], s33 offen offset:2560 sc1
    buffer_load_dwordx4 v[42:45], v8, s[4:7], s34 offen offset:0 sc1
    buffer_load_dwordx4 v[46:49], v8, s[4:7], s34 offen offset:2560 sc1
    buffer_load_dwordx4 v[50:53], v8, s[4:7], s35 offen offset:0 sc1
    buffer_load_dwordx4 v[54:57], v8, s[4:7], s35 offen offset:2560 sc1
    s_add_u32 s19, s19, 1
    s_cmp_lt_u32 s19, 524288
    s_cbranch_scc1 L_Rf1_hb_8
    s_branch L_fail
L_R1_slow:
L_Rs1_top:
    s_barrier
    buffer_load_dwordx4 v[10:13], v0, s[4:7], s25 offen offset:0 sc1
    buffer_load_dwordx4 v[14:17], v0, s[4:7], s25 offen offset:1024 sc1
    buffer_load_dwordx4 v[18:21], v0, s[4:7], s25 offen offset:2048 sc1
    buffer_load_dwordx4 v[22:25], v0, s[4:7], s25 offen offset:3072 sc1
    buffer_load_dwordx4 v[26:29], v0, s[4:7], s26 offen offset:0 sc1
    s_barrier
    buffer_load_dwordx4 v[46:49], v0, s[4:7], s27 offen offset:0 sc1
    buffer_load_dwordx4 v[30:33], v0, s[4:7], s27 offen offset:1024 sc1
    buffer_load_dwordx4 v[34:37], v0, s[4:7], s27 offen offset:2048 sc1
    buffer_load_dwordx4 v[38:41], v0, s[4:7], s27 offen offset:3072 sc1
    buffer_load_dwordx4 v[42:45], v0, s[4:7], s28 offen offset:0 sc1
    s_mov_b32 s19, 0
L_Rs1_gl_1:
    s_waitcnt vmcnt(9)
    v_mfma_f32_16x16x32_bf16 v[50:53], a[240:243], v[10:13], 0
    v_mfma_f32_16x16x32_bf16 v[54:57], a[244:247], v[10:13], 0
    v_xor_b32 v1, s23, v10
    s_waitcnt vmcnt(8)
    v_mfma_f32_16x16x32_bf16 v[58:61], a[240:243], v[14:17], 0
    v_mfma_f32_16x16x32_bf16 v[62:65], a[244:247], v[14:17], 0
    v_bitop3_b32 v1, v1, v14, s23 bitop3:0xf6
    s_waitcnt vmcnt(7)
    v_mfma_f32_16x16x32_bf16 v[66:69], a[240:243], v[18:21], 0
    v_mfma_f32_16x16x32_bf16 v[70:73], a[244:247], v[18:21], 0
    v_bitop3_b32 v1, v1, v18, s23 bitop3:0xf6
    s_waitcnt vmcnt(6)
    v_mfma_f32_16x16x32_bf16 v[74:77], a[240:243], v[22:25], 0
    v_mfma_f32_16x16x32_bf16 v[78:81], a[244:247], v[22:25], 0
    v_bitop3_b32 v1, v1, v22, s23 bitop3:0xf6
    s_waitcnt vmcnt(5)
    v_mfma_f32_16x16x32_bf16 v[82:85], a[240:243], v[26:29], 0
    v_mfma_f32_16x16x32_bf16 v[86:89], a[244:247], v[26:29], 0
    v_bitop3_b32 v1, v1, v26, s23 bitop3:0xf6
    v_and_b32 v1, 1, v1
    v_cmp_ne_u32 vcc, 0, v1
    s_nop 0
    s_cbranch_vccnz L_Rs1_glfix_3
L_Rs1_gr_2:
    s_waitcnt vmcnt(4)
    v_mfma_f32_16x16x32_bf16 v[50:53], a[240:243], v[46:49], v[50:53]
    v_xor_b32 v1, s23, v46
    v_mfma_f32_16x16x32_bf16 v[54:57], a[244:247], v[46:49], v[54:57]
    s_waitcnt vmcnt(3)
    v_mfma_f32_16x16x32_bf16 v[58:61], a[240:243], v[30:33], v[58:61]
    v_bitop3_b32 v1, v1, v30, s23 bitop3:0xf6
    v_mfma_f32_16x16x32_bf16 v[62:65], a[244:247], v[30:33], v[62:65]
    s_nop 1
    v_cvt_pk_bf16_f32 v90, v50, v51
    v_cvt_pk_bf16_f32 v91, v52, v53
    v_cvt_pk_bf16_f32 v92, v54, v55
    v_cvt_pk_bf16_f32 v93, v56, v57
    ds_write_b128 v0, v[90:93] offset:5120
    s_waitcnt vmcnt(2)
    v_mfma_f32_16x16x32_bf16 v[66:69], a[240:243], v[34:37], v[66:69]
    v_bitop3_b32 v1, v1, v34, s23 bitop3:0xf6
    v_mfma_f32_16x16x32_bf16 v[70:73], a[244:247], v[34:37], v[70:73]
    v_cvt_pk_bf16_f32 v90, v58, v59
    v_cvt_pk_bf16_f32 v91, v60, v61
    v_cvt_pk_bf16_f32 v92, v62, v63
    v_cvt_pk_bf16_f32 v93, v64, v65
    ds_write_b128 v0, v[90:93] offset:6144
    s_waitcnt vmcnt(1)
    v_mfma_f32_16x16x32_bf16 v[74:77], a[240:243], v[38:41], v[74:77]
    v_bitop3_b32 v1, v1, v38, s23 bitop3:0xf6
    v_mfma_f32_16x16x32_bf16 v[78:81], a[244:247], v[38:41], v[78:81]
    v_cvt_pk_bf16_f32 v90, v66, v67
    v_cvt_pk_bf16_f32 v91, v68, v69
    v_cvt_pk_bf16_f32 v92, v70, v71
    v_cvt_pk_bf16_f32 v93, v72, v73
    ds_write_b128 v0, v[90:93] offset:7168
    s_waitcnt vmcnt(0)
    v_mfma_f32_16x16x32_bf16 v[82:85], a[240:243], v[42:45], v[82:85]
    v_bitop3_b32 v1, v1, v42, s23 bitop3:0xf6
    v_mfma_f32_16x16x32_bf16 v[86:89], a[244:247], v[42:45], v[86:89]
    v_cvt_pk_bf16_f32 v90, v74, v75
    v_cvt_pk_bf16_f32 v91, v76, v77
    v_cvt_pk_bf16_f32 v92, v78, v79
    v_cvt_pk_bf16_f32 v93, v80, v81
    ds_write_b128 v0, v[90:93] offset:8192
    s_nop 0
    v_cvt_pk_bf16_f32 v90, v82, v83
    v_cvt_pk_bf16_f32 v91, v84, v85
    v_cvt_pk_bf16_f32 v92, v86, v87
    v_cvt_pk_bf16_f32 v93, v88, v89
    ds_write_b128 v0, v[90:93] offset:9216
    v_and_b32 v1, 1, v1
    v_cmp_ne_u32 vcc, 0, v1
    s_nop 0
    s_cbranch_vccnz L_Rs1_grfix_5
    s_waitcnt lgkmcnt(0)
    s_barrier
    ds_read_b128 v[10:13], v0 offset:0
    ds_read_b128 v[14:17], v0 offset:1024
    ds_read_b128 v[18:21], v0 offset:2048
    ds_read_b128 v[22:25], v0 offset:3072
    ds_read_b128 v[26:29], v0 offset:4096
    s_waitcnt lgkmcnt(4)
    v_mfma_f32_16x16x32_bf16 v[46:49], a[0:3], v[10:13], 0
    s_mov_b32 m0, 38912
    v_mfma_f32_16x16x32_bf16 v[50:53], a[80:83], v[10:13], 0
    v_mfma_f32_16x16x32_bf16 v[54:57], a[160:163], v[10:13], 0
    ds_read_b128 v[10:13], v0 offset:5120
    s_waitcnt lgkmcnt(4)
    v_mfma_f32_16x16x32_bf16 v[46:49], a[4:7], v[14:17], v[46:49]
    buffer_load_dwordx4 v0, s[4:7], s56 offen offset:0 sc1 lds
    v_mfma_f32_16x16x32_bf16 v[50:53], a[84:87], v[14:17], v[50:53]
    v_mfma_f32_16x16x32_bf16 v[54:57], a[164:167], v[14:17], v[54:57]
    ds_read_b128 v[14:17], v0 offset:6144
    s_waitcnt lgkmcnt(4)
    v_mfma_f32_16x16x32_bf16 v[46:49], a[8:11], v[18:21], v[46:49]
    buffer_load_dwordx4 v0, s[4:7], s56 offen offset:1024 sc1 lds
    v_mfma_f32_16x16x32_bf16 v[50:53], a[88:91], v[18:21], v[50:53]
    v_mfma_f32_16x16x32_bf16 v[54:57], a[168:171], v[18:21], v[54:57]
    ds_read_b128 v[18:21], v0 offset:7168
    s_waitcnt lgkmcnt(4)
    v_mfma_f32_16x16x32_bf16 v[46:49], a[12:15], v[22:25], v[46:49]
    buffer_load_dwordx4 v0, s[4:7], s56 offen offset:2048 sc1 lds
    v_mfma_f32_16x16x32_bf16 v[50:53], a[92:95], v[22:25], v[50:53]
    v_mfma_f32_16x16x32_bf16 v[54:57], a[172:175], v[22:25], v[54:57]
    ds_read_b128 v[22:25], v0 offset:8192
    s_waitcnt lgkmcnt(4)
    v_mfma_f32_16x16x32_bf16 v[46:49], a[16:19], v[26:29], v[46:49]
    v_mfma_f32_16x16x32_bf16 v[50:53], a[96:99], v[26:29], v[50:53]
    v_mfma_f32_16x16x32_bf16 v[54:57], a[176:179], v[26:29], v[54:57]
    ds_read_b128 v[26:29], v0 offset:9216
    s_waitcnt lgkmcnt(4)
    v_mfma_f32_16x16x32_bf16 v[46:49], a[20:23], v[10:13], v[46:49]
    v_mfma_f32_16x16x32_bf16 v[50:53], a[100:103], v[10:13], v[50:53]
    v_mfma_f32_16x16x32_bf16 v[54:57], a[180:183], v[10:13], v[54:57]
    ds_read_b128 v[10:13], v0 offset:10240
    s_waitcnt lgkmcnt(4)
    v_mfma_f32_16x16x32_bf16 v[46:49], a[24:27], v[14:17], v[46:49]
    v_mfma_f32_16x16x32_bf16 v[50:53], a[104:107], v[14:17], v[50:53]
    v_mfma_f32_16x16x32_bf16 v[54:57], a[184:187], v[14:17], v[54:57]
    ds_read_b128 v[14:17], v0 offset:11264
    s_waitcnt lgkmcnt(4)
    v_mfma_f32_16x16x32_bf16 v[46:49], a[28:31], v[18:21], v[46:49]
    v_mfma_f32_16x16x32_bf16 v[50:53], a[108:111], v[18:21], v[50:53]
    v_mfma_f32_16x16x32_bf16 v[54:57], a[188:191], v[18:21], v[54:57]
    ds_read_b128 v[18:21], v0 offset:12288
    s_waitcnt lgkmcnt(4)
    v_mfma_f32_16x16x32_bf16 v[46:49], a[32:35], v[22:25], v[46:49]
    v_mfma_f32_16x16x32_bf16 v[50:53], a[112:115], v[22:25], v[50:53]
    v_mfma_f32_16x16x32_bf16 v[54:57], a[192:195], v[22:25], v[54:57]
    ds_read_b128 v[22:25], v0 offset:13312
    s_waitcnt lgkmcnt(4)
    v_mfma_f32_16x16x32_bf16 v[46:49], a[36:39], v[26:29], v[46:49]
    v_mfma_f32_16x16x32_bf16 v[50:53], a[116:119], v[26:29], v[50:53]
    v_mfma_f32_16x16x32_bf16 v[54:57], a[196:199], v[26:29], v[54:57]
    ds_read_b128 v[26:29], v0 offset:14336
    s_waitcnt lgkmcnt(4)
    v_mfma_f32_16x16x32_bf16 v[46:49], a[40:43], v[10:13], v[46:49]
    v_mfma_f32_16x16x32_bf16 v[50:53], a[120:123], v[10:13], v[50:53]
    v_mfma_f32_16x16x32_bf16 v[54:57], a[200:203], v[10:13], v[54:57]
    ds_read_b128 v[10:13], v0 offset:15360
    s_waitcnt lgkmcnt(4)
    v_mfma_f32_16x16x32_bf16 v[46:49], a[44:47], v[14:17], v[46:49]
    ds_read_b128 v[58:61], v0 offset:29696
    v_mfma_f32_16x16x32_bf16 v[50:53], a[124:127], v[14:17], v[50:53]
    v_mfma_f32_16x16x32_bf16 v[54:57], a[204:207], v[14:17], v[54:57]
    ds_read_b128 v[14:17], v0 offset:16384
    s_waitcnt lgkmcnt(5)
    v_mfma_f32_16x16x32_bf16 v[46:49], a[48:51], v[18:21], v[46:49]
    ds_read_b128 v[62:65], v0 offset:30720
    v_mfma_f32_16x16x32_bf16 v[50:53], a[128:131], v[18:21], v[50:53]
    v_mfma_f32_16x16x32_bf16 v[54:57], a[208:211], v[18:21], v[54:57]
    ds_read_b128 v[18:21], v0 offset:17408
    s_waitcnt lgkmcnt(6)
    v_mfma_f32_16x16x32_bf16 v[46:49], a[52:55], v[22:25], v[46:49]
    ds_read_b128 v[66:69], v0 offset:31744
    v_mfma_f32_16x16x32_bf16 v[50:53], a[132:135], v[22:25], v[50:53]
    v_mfma_f32_16x16x32_bf16 v[54:57], a[212:215], v[22:25], v[54:57]
    ds_read_b128 v[22:25], v0 offset:18432
    s_waitcnt lgkmcnt(7)
    v_mfma_f32_16x16x32_bf16 v[46:49], a[56:59], v[26:29], v[46:49]
    ds_read_b128 v[70:73], v0 offset:41984
    v_mfma_f32_16x16x32_bf16 v[50:53], a[136:139], v[26:29], v[50:53]
    v_mfma_f32_16x16x32_bf16 v[54:57], a[216:219], v[26:29], v[54:57]
    ds_read_b128 v[26:29], v0 offset:19456
    s_waitcnt lgkmcnt(8)
    v_mfma_f32_16x16x32_bf16 v[46:49], a[60:63], v[10:13], v[46:49]
    ds_read_b128 v[74:77], v0 offset:43008
    v_mfma_f32_16x16x32_bf16 v[50:53], a[140:143], v[10:13], v[50:53]
    v_mfma_f32_16x16x32_bf16 v[54:57], a[220:223], v[10:13], v[54:57]
    ds_read_b128 v[10:13], v0 offset:0
    s_waitcnt lgkmcnt(8)
    v_mfma_f32_16x16x32_bf16 v[46:49], a[64:67], v[14:17], v[46:49]
    ds_read_b128 v[78:81], v0 offset:44032
    v_mfma_f32_16x16x32_bf16 v[50:53], a[144:147], v[14:17], v[50:53]
    v_mfma_f32_16x16x32_bf16 v[54:57], a[224:227], v[14:17], v[54:57]
    ds_read_b128 v[14:17], v0 offset:1024
    s_waitcnt lgkmcnt(8)
    v_mfma_f32_16x16x32_bf16 v[46:49], a[68:71], v[18:21], v[46:49]
    v_mfma_f32_16x16x32_bf16 v[50:53], a[148:151], v[18:21], v[50:53]
    v_mfma_f32_16x16x32_bf16 v[54:57], a[228:231], v[18:21], v[54:57]
    ds_read_b128 v[18:21], v0 offset:2048
    s_waitcnt lgkmcnt(7)
    v_mfma_f32_16x16x32_bf16 v[46:49], a[72:75], v[22:25], v[46:49]
    v_mfma_f32_16x16x32_bf16 v[50:53], a[152:155], v[22:25], v[50:53]
    v_mfma_f32_16x16x32_bf16 v[54:57], a[232:235], v[22:25], v[54:57]
    ds_read_b128 v[22:25], v0 offset:3072
    s_waitcnt lgkmcnt(6)
    v_mfma_f32_16x16x32_bf16 v[46:49], a[76:79], v[26:29], v[46:49]
    v_mfma_f32_16x16x32_bf16 v[50:53], a[156:159], v[26:29], v[50:53]
    v_mfma_f32_16x16x32_bf16 v[54:57], a[236:239], v[26:29], v[54:57]
    ds_read_b128 v[26:29], v0 offset:4096
    s_waitcnt lgkmcnt(5)
    v_mfma_f32_16x16x32_bf16 v[30:33], v[10:13], v[96:99], 0
    v_mfma_f32_16x16x32_bf16 v[34:37], v[10:13], v[176:179], 0
    ds_read_b128 v[10:13], v0 offset:5120
    s_nop 0
    v_cvt_pk_bf16_f32 v82, v46, v47
    v_cvt_pk_bf16_f32 v83, v48, v49
    ds_write_b64 v0, v[82:83] offset:21512
    v_cvt_pk_bf16_f32 v84, v50, v51
    v_cvt_pk_bf16_f32 v85, v52, v53
    ds_write_b64 v0, v[84:85] offset:22528
    v_cvt_pk_bf16_f32 v86, v54, v55
    v_cvt_pk_bf16_f32 v87, v56, v57
    ds_write_b64 v0, v[86:87] offset:22536
    s_waitcnt lgkmcnt(7)
    v_mfma_f32_16x16x32_bf16 v[30:33], v[14:17], v[100:103], v[30:33]
    v_mfma_f32_16x16x32_bf16 v[34:37], v[14:17], v[180:183], v[34:37]
    ds_read_b128 v[14:17], v0 offset:6144
    s_waitcnt lgkmcnt(1)
    s_barrier
    ds_read_b128 v[46:49], v0 offset:20480
    ds_read_b128 v[50:53], v0 offset:21504
    ds_read_b128 v[54:57], v0 offset:22528
    v_mfma_f32_16x16x32_bf16 v[30:33], v[18:21], v[104:107], v[30:33]
    v_mfma_f32_16x16x32_bf16 v[34:37], v[18:21], v[184:187], v[34:37]
    ds_read_b128 v[18:21], v0 offset:7168
    v_mfma_f32_16x16x32_bf16 v[30:33], v[22:25], v[108:111], v[30:33]
    v_mfma_f32_16x16x32_bf16 v[34:37], v[22:25], v[188:191], v[34:37]
    ds_read_b128 v[22:25], v0 offset:8192
    s_waitcnt lgkmcnt(4)
    v_mfma_f32_16x16x32_bf16 v[38:41], v[58:61], v[46:49], 0
    v_mfma_f32_16x16x32_bf16 v[42:45], v[70:73], v[46:49], 0
    s_waitcnt lgkmcnt(3)
    v_mfma_f32_16x16x32_bf16 v[38:41], v[62:65], v[50:53], v[38:41]
    v_mfma_f32_16x16x32_bf16 v[42:45], v[74:77], v[50:53], v[42:45]
    s_waitcnt lgkmcnt(2)
    v_mfma_f32_16x16x32_bf16 v[38:41], v[66:69], v[54:57], v[38:41]
    v_mfma_f32_16x16x32_bf16 v[42:45], v[78:81], v[54:57], v[42:45]
    v_mfma_f32_16x16x32_bf16 v[30:33], v[26:29], v[112:115], v[30:33]
    v_mfma_f32_16x16x32_bf16 v[34:37], v[26:29], v[192:195], v[34:37]
    ds_read_b128 v[26:29], v0 offset:9216
    s_nop 4
    v_cndmask_b32 v38, v42, v38, s[48:49]
    v_cndmask_b32 v39, v43, v39, s[48:49]
    v_cndmask_b32 v40, v44, v40, s[48:49]
    v_cndmask_b32 v41, v45, v41, s[48:49]
    v_and_or_b32 v38, v38, -2, s22
    buffer_store_dwordx4 v[38:41], v0, s[4:7], s29 offen sc1
    v_mfma_f32_16x16x32_bf16 v[30:33], v[10:13], v[116:119], v[30:33]
    v_mfma_f32_16x16x32_bf16 v[34:37], v[10:13], v[196:199], v[34:37]
    ds_read_b128 v[10:13], v0 offset:10240
    v_mfma_f32_16x16x32_bf16 v[30:33], v[14:17], v[120:123], v[30:33]
    v_mfma_f32_16x16x32_bf16 v[34:37], v[14:17], v[200:203], v[34:37]
    ds_read_b128 v[14:17], v0 offset:11264
    s_waitcnt lgkmcnt(4)
    v_mfma_f32_16x16x32_bf16 v[30:33], v[18:21], v[124:127], v[30:33]
    v_mfma_f32_16x16x32_bf16 v[34:37], v[18:21], v[204:207], v[34:37]
    ds_read_b128 v[18:21], v0 offset:12288
    s_waitcnt lgkmcnt(4)
    v_mfma_f32_16x16x32_bf16 v[30:33], v[22:25], v[128:131], v[30:33]
    v_mfma_f32_16x16x32_bf16 v[34:37], v[22:25], v[208:211], v[34:37]
    ds_read_b128 v[22:25], v0 offset:13312
    s_waitcnt lgkmcnt(4)
    v_mfma_f32_16x16x32_bf16 v[30:33], v[26:29], v[132:135], v[30:33]
    v_mfma_f32_16x16x32_bf16 v[34:37], v[26:29], v[212:215], v[34:37]
    ds_read_b128 v[26:29], v0 offset:14336
    s_waitcnt lgkmcnt(4)
    v_mfma_f32_16x16x32_bf16 v[30:33], v[10:13], v[136:139], v[30:33]
    v_mfma_f32_16x16x32_bf16 v[34:37], v[10:13], v[216:219], v[34:37]
    ds_read_b128 v[10:13], v0 offset:15360
    s_waitcnt lgkmcnt(4)
    v_mfma_f32_16x16x32_bf16 v[30:33], v[14:17], v[140:143], v[30:33]
    v_mfma_f32_16x16x32_bf16 v[34:37], v[14:17], v[220:223], v[34:37]
    ds_read_b128 v[14:17], v0 offset:16384
    s_waitcnt lgkmcnt(4)
    v_mfma_f32_16x16x32_bf16 v[30:33], v[18:21], v[144:147], v[30:33]
    v_mfma_f32_16x16x32_bf16 v[34:37], v[18:21], v[224:227], v[34:37]
    ds_read_b128 v[18:21], v0 offset:17408
    s_waitcnt lgkmcnt(4)
    v_mfma_f32_16x16x32_bf16 v[30:33], v[22:25], v[148:151], v[30:33]
    v_mfma_f32_16x16x32_bf16 v[34:37], v[22:25], v[228:231], v[34:37]
    ds_read_b128 v[22:25], v0 offset:18432
    v_pk_mul_f32 v[42:43], v[38:39], s[52:53]
    v_pk_mul_f32 v[44:45], v[40:41], s[52:53]
    s_waitcnt vmcnt(0)
    buffer_load_dwordx4 v[82:85], v0, s[4:7], s30 offen sc1
    s_mov_b32 s19, 0
    s_waitcnt lgkmcnt(4)
    v_mfma_f32_16x16x32_bf16 v[30:33], v[26:29], v[152:155], v[30:33]
    v_mfma_f32_16x16x32_bf16 v[34:37], v[26:29], v[232:235], v[34:37]
    ds_read_b128 v[26:29], v0 offset:19456
    s_waitcnt lgkmcnt(4)
    v_mfma_f32_16x16x32_bf16 v[30:33], v[10:13], v[156:159], v[30:33]
    v_mfma_f32_16x16x32_bf16 v[34:37], v[10:13], v[236:239], v[34:37]
    s_waitcnt lgkmcnt(3)
    v_mfma_f32_16x16x32_bf16 v[30:33], v[14:17], v[160:163], v[30:33]
    v_mfma_f32_16x16x32_bf16 v[34:37], v[14:17], v[240:243], v[34:37]
    s_waitcnt lgkmcnt(2)
    v_mfma_f32_16x16x32_bf16 v[30:33], v[18:21], v[164:167], v[30:33]
    v_mfma_f32_16x16x32_bf16 v[34:37], v[18:21], v[244:247], v[34:37]
    s_waitcnt lgkmcnt(1)
    v_mfma_f32_16x16x32_bf16 v[30:33], v[22:25], v[168:171], v[30:33]
    v_mfma_f32_16x16x32_bf16 v[34:37], v[22:25], v[248:251], v[34:37]
    s_waitcnt lgkmcnt(0)
    v_mfma_f32_16x16x32_bf16 v[30:33], v[26:29], v[172:175], v[30:33]
    v_mfma_f32_16x16x32_bf16 v[34:37], v[26:29], v[252:255], v[34:37]
    s_nop 6
    v_cvt_pk_bf16_f32 v88, v30, v31
    v_cvt_pk_bf16_f32 v89, v32, v33
    v_cvt_pk_bf16_f32 v90, v34, v35
    v_cvt_pk_bf16_f32 v91, v36, v37
    s_add_u32 s60, s31, 4096
    s_cmp_eq_u32 s20, 68
    s_cbranch_scc1 L_Rs1_tail
L_Rs1_ha_6:
    s_waitcnt vmcnt(0)
    v_lshlrev_b32 v1, 31, v82
    v_pk_fma_f32 v[38:39], v[82:83], s[52:53], v[42:43]
    v_pk_fma_f32 v[40:41], v[84:85], s[52:53], v[44:45]
    ds_write_b128 v0, v[38:41] offset:27648
    v_cmp_ne_u32 vcc, s21, v1
    s_nop 0
    s_cbranch_vccnz L_Rs1_hafix_7
    s_waitcnt vmcnt(0) lgkmcnt(0)
    s_barrier
    ds_read_b128 v[10:13], v0 offset:26624
    ds_read_b128 v[14:17], v0 offset:27648
    ds_read_b128 v[18:21], v0 offset:28672
    ds_read_b128 v[58:61], v0 offset:37888
    ds_read_b128 v[62:65], v0 offset:38912
    ds_read_b128 v[66:69], v0 offset:50176
    ds_read_b128 v[70:73], v0 offset:51200
    buffer_store_dwordx4 v[88:91], v0, s[4:7], s60 offen sc1
    s_waitcnt lgkmcnt(5)
    v_max3_f32 v22, v10, v11, v12
    v_max3_f32 v23, v13, v14, v15
    v_max3_f32 v22, v22, v16, v17
    s_waitcnt lgkmcnt(4)
    v_max3_f32 v23, v23, v18, v19
    v_max3_f32 v22, v22, v20, v21
    v_max_f32 v22, v22, v23
    v_mov_b32 v23, v22
    ds_read_b128 v[30:33], v2 offset:0
    ds_read_b128 v[34:37], v2 offset:1024
    v_permlane32_swap_b32 v22, v23
    v_max_f32 v22, v22, v23
    v_mov_b32 v23, v22
    ds_read_b128 v[38:41], v2 offset:2048
    ds_read_b128 v[42:45], v2 offset:3072
    v_permlane16_swap_b32 v22, v23
    v_max_f32 v22, v22, v23
    v_pk_add_f32 v[10:11], v[10:11], v[22:23] op_sel_hi:[1,0] neg_lo:[0,1] neg_hi:[0,1]
    v_pk_add_f32 v[12:13], v[12:13], v[22:23] op_sel_hi:[1,0] neg_lo:[0,1] neg_hi:[0,1]
    v_pk_add_f32 v[14:15], v[14:15], v[22:23] op_sel_hi:[1,0] neg_lo:[0,1] neg_hi:[0,1]
    v_pk_add_f32 v[16:17], v[16:17], v[22:23] op_sel_hi:[1,0] neg_lo:[0,1] neg_hi:[0,1]
    v_pk_add_f32 v[18:19], v[18:19], v[22:23] op_sel_hi:[1,0] neg_lo:[0,1] neg_hi:[0,1]
    v_pk_add_f32 v[20:21], v[20:21], v[22:23] op_sel_hi:[1,0] neg_lo:[0,1] neg_hi:[0,1]
    v_exp_f32 v10, v10
    v_exp_f32 v11, v11
    v_exp_f32 v12, v12
    v_exp_f32 v13, v13
    v_exp_f32 v14, v14
    v_exp_f32 v15, v15
    v_cvt_pk_bf16_f32 v24, v10, v11
    v_cvt_pk_bf16_f32 v25, v12, v13
    v_exp_f32 v16, v16
    v_exp_f32 v17, v17
    v_mfma_f32_16x16x16_bf16 v[46:49], v[88:89], v[24:25], 0
    v_mfma_f32_16x16x16_bf16 v[82:85], v[90:91], v[24:25], 0
    v_exp_f32 v18, v18
    v_exp_f32 v19, v19
    v_exp_f32 v20, v20
    v_exp_f32 v21, v21
    v_cvt_pk_bf16_f32 v26, v14, v15
    v_cvt_pk_bf16_f32 v27, v16, v17
    v_cvt_pk_bf16_f32 v28, v18, v19
    v_cvt_pk_bf16_f32 v29, v20, v21
    v_pk_add_f32 v[22:23], v[10:11], v[12:13]
    v_pk_add_f32 v[14:15], v[14:15], v[16:17]
    s_waitcnt lgkmcnt(4)
    v_mfma_f32_16x16x32_bf16 v[50:53], v[58:61], v[26:29], v[46:49]
    v_pk_add_f32 v[18:19], v[18:19], v[20:21]
    v_mfma_f32_16x16x32_bf16 v[54:57], v[66:69], v[26:29], v[46:49]
    v_pk_add_f32 v[22:23], v[22:23], v[14:15]
    v_pk_add_f32 v[22:23], v[22:23], v[18:19]
    v_mfma_f32_16x16x32_bf16 v[10:13], v[62:65], v[26:29], v[82:85]
    v_add_f32 v22, v22, v23
    v_mfma_f32_16x16x32_bf16 v[14:17], v[70:73], v[26:29], v[82:85]
    v_mov_b32 v23, v22
    ds_read_b128 v[74:77], v2 offset:4096
    ds_read_b128 v[78:81], v2 offset:5120
    v_permlane32_swap_b32 v22, v23
    v_add_f32 v22, v22, v23
    v_mov_b32 v23, v22
    v_cndmask_b32 v50, v54, v50, s[48:49]
    v_cndmask_b32 v51, v55, v51, s[48:49]
    v_permlane16_swap_b32 v22, v23
    v_add_f32 v22, v22, v23
    v_rcp_f32 v22, v22
    v_cndmask_b32 v52, v56, v52, s[48:49]
    v_cndmask_b32 v53, v57, v53, s[48:49]
    v_cndmask_b32 v10, v14, v10, s[48:49]
    v_cndmask_b32 v11, v15, v11, s[48:49]
    v_cndmask_b32 v12, v16, v12, s[48:49]
    v_cndmask_b32 v13, v17, v13, s[48:49]
    v_pk_mul_f32 v[50:51], v[50:51], v[22:23] op_sel_hi:[1,0]
    v_pk_mul_f32 v[52:53], v[52:53], v[22:23] op_sel_hi:[1,0]
    v_cvt_pk_bf16_f32 v24, v50, v51
    v_cvt_pk_bf16_f32 v25, v52, v53
    v_pk_mul_f32 v[10:11], v[10:11], v[22:23] op_sel_hi:[1,0]
    v_pk_mul_f32 v[12:13], v[12:13], v[22:23] op_sel_hi:[1,0]
    v_cvt_pk_bf16_f32 v26, v10, v11
    v_cvt_pk_bf16_f32 v27, v12, v13
    ds_write_b128 v0, v[24:27] offset:1024
    s_waitcnt lgkmcnt(0)
    s_barrier
    ds_read_b128 v[10:13], v0 offset:0
    ds_read_b128 v[14:17], v0 offset:1024
    ds_read_b128 v[18:21], v0 offset:2048
    s_add_u32 s20, s20, 1
    s_waitcnt lgkmcnt(2)
    v_mfma_f32_16x16x32_bf16 v[46:49], v[30:33], v[10:13], 0
    ds_read_b128 v[30:33], v2 offset:6144
    s_waitcnt lgkmcnt(2)
    v_mfma_f32_16x16x32_bf16 v[46:49], v[34:37], v[14:17], v[46:49]
    ds_read_b128 v[34:37], v2 offset:7168
    s_waitcnt lgkmcnt(2)
    v_mfma_f32_16x16x32_bf16 v[46:49], v[38:41], v[18:21], v[46:49]
    ds_read_b128 v[38:41], v2 offset:8192
    v_mfma_f32_16x16x32_bf16 v[50:53], v[42:45], v[10:13], 0
    ds_read_b128 v[42:45], v2 offset:9216
    v_mfma_f32_16x16x32_bf16 v[50:53], v[74:77], v[14:17], v[50:53]
    ds_read_b128 v[74:77], v2 offset:10240
    v_mfma_f32_16x16x32_bf16 v[50:53], v[78:81], v[18:21], v[50:53]
    ds_read_b128 v[78:81], v2 offset:11264
    s_waitcnt lgkmcnt(3)
    v_mfma_f32_16x16x32_bf16 v[54:57], v[30:33], v[10:13], 0
    ds_read_b128 v[30:33], v2 offset:12288
    v_cvt_pk_bf16_f32 v62, v46, v47
    v_mfma_f32_16x16x32_bf16 v[54:57], v[34:37], v[14:17], v[54:57]
    ds_read_b128 v[34:37], v2 offset:13312
    v_cvt_pk_bf16_f32 v63, v48, v49
    v_and_or_b32 v62, v62, -2, s22
    v_mfma_f32_16x16x32_bf16 v[54:57], v[38:41], v[18:21], v[54:57]
    ds_read_b128 v[38:41], v2 offset:14336
    v_cvt_pk_bf16_f32 v64, v50, v51
    s_waitcnt lgkmcnt(3)
    v_mfma_f32_16x16x32_bf16 v[58:61], v[42:45], v[10:13], 0
    ds_read_b128 v[42:45], v2 offset:15360
    v_cvt_pk_bf16_f32 v65, v52, v53
    v_mfma_f32_16x16x32_bf16 v[58:61], v[74:77], v[14:17], v[58:61]
    ds_read_b128 v[74:77], v2 offset:16384
    buffer_store_dwordx4 v[62:65], v3, s[4:7], s32 offen sc1
    v_mfma_f32_16x16x32_bf16 v[58:61], v[78:81], v[18:21], v[58:61]
    ds_read_b128 v[78:81], v2 offset:17408
    s_waitcnt lgkmcnt(3)
    v_mfma_f32_16x16x32_bf16 v[46:49], v[30:33], v[10:13], 0
    ds_read_b128 v[30:33], v2 offset:18432
    v_cvt_pk_bf16_f32 v66, v54, v55
    v_mfma_f32_16x16x32_bf16 v[46:49], v[34:37], v[14:17], v[46:49]
    ds_read_b128 v[34:37], v2 offset:19456
    v_cvt_pk_bf16_f32 v67, v56, v57
    v_and_or_b32 v66, v66, -2, s22
    v_mfma_f32_16x16x32_bf16 v[46:49], v[38:41], v[18:21], v[46:49]
    ds_read_b128 v[38:41], v2 offset:20480
    v_cvt_pk_bf16_f32 v68, v58, v59
    s_waitcnt lgkmcnt(3)
    v_mfma_f32_16x16x32_bf16 v[50:53], v[42:45], v[10:13], 0
    ds_read_b128 v[42:45], v2 offset:21504
    v_cvt_pk_bf16_f32 v69, v60, v61
    v_mfma_f32_16x16x32_bf16 v[50:53], v[74:77], v[14:17], v[50:53]
    ds_read_b128 v[74:77], v2 offset:22528
    buffer_store_dwordx4 v[66:69], v4, s[4:7], s32 offen sc1
    v_mfma_f32_16x16x32_bf16 v[50:53], v[78:81], v[18:21], v[50:53]
    ds_read_b128 v[78:81], v2 offset:23552
    s_waitcnt lgkmcnt(3)
    v_mfma_f32_16x16x32_bf16 v[54:57], v[30:33], v[10:13], 0
    ds_read_b128 v[30:33], v2 offset:24576
    v_cvt_pk_bf16_f32 v62, v46, v47
    v_mfma_f32_16x16x32_bf16 v[54:57], v[34:37], v[14:17], v[54:57]
    ds_read_b128 v[34:37], v2 offset:25600
    v_cvt_pk_bf16_f32 v63, v48, v49
    v_and_or_b32 v62, v62, -2, s22
    v_mfma_f32_16x16x32_bf16 v[54:57], v[38:41], v[18:21], v[54:57]
    ds_read_b128 v[38:41], v2 offset:26624
    v_cvt_pk_bf16_f32 v64, v50, v51
    s_waitcnt lgkmcnt(3)
    v_mfma_f32_16x16x32_bf16 v[58:61], v[42:45], v[10:13], 0
    ds_read_b128 v[42:45], v2 offset:27648
    v_cvt_pk_bf16_f32 v65, v52, v53
    v_mfma_f32_16x16x32_bf16 v[58:61], v[74:77], v[14:17], v[58:61]
    ds_read_b128 v[74:77], v2 offset:28672
    buffer_store_dwordx4 v[62:65], v5, s[4:7], s32 offen sc1
    v_mfma_f32_16x16x32_bf16 v[58:61], v[78:81], v[18:21], v[58:61]
    ds_read_b128 v[78:81], v2 offset:29696
    s_waitcnt lgkmcnt(3)
    v_mfma_f32_16x16x32_bf16 v[46:49], v[30:33], v[10:13], 0
    v_cvt_pk_bf16_f32 v66, v54, v55
    v_mfma_f32_16x16x32_bf16 v[46:49], v[34:37], v[14:17], v[46:49]
    v_cvt_pk_bf16_f32 v67, v56, v57
    v_and_or_b32 v66, v66, -2, s22
    v_mfma_f32_16x16x32_bf16 v[46:49], v[38:41], v[18:21], v[46:49]
    v_cvt_pk_bf16_f32 v68, v58, v59
    s_waitcnt lgkmcnt(0)
    v_mfma_f32_16x16x32_bf16 v[50:53], v[42:45], v[10:13], 0
    v_cvt_pk_bf16_f32 v69, v60, v61
    v_mfma_f32_16x16x32_bf16 v[50:53], v[74:77], v[14:17], v[50:53]
    buffer_store_dwordx4 v[66:69], v6, s[4:7], s32 offen sc1
    v_mfma_f32_16x16x32_bf16 v[50:53], v[78:81], v[18:21], v[50:53]
    s_nop 0
    v_cvt_pk_bf16_f32 v62, v46, v47
    v_cvt_pk_bf16_f32 v63, v48, v49
    v_and_or_b32 v62, v62, -2, s22
    s_nop 3
    v_cvt_pk_bf16_f32 v64, v50, v51
    v_cvt_pk_bf16_f32 v65, v52, v53
    buffer_store_dwordx4 v[62:65], v7, s[4:7], s32 offen sc1
    v_accvgpr_read_b32 v78, a252
    v_accvgpr_read_b32 v79, a253
    v_accvgpr_read_b32 v80, a254
    v_accvgpr_read_b32 v81, a255
    s_mov_b32 s19, 0
    s_waitcnt vmcnt(0)
    buffer_load_dwordx4 v[26:29], v8, s[4:7], s32 offen offset:0 sc1
    buffer_load_dwordx4 v[30:33], v8, s[4:7], s32 offen offset:2560 sc1
    buffer_load_dwordx4 v[34:37], v8, s[4:7], s33 offen offset:0 sc1
    buffer_load_dwordx4 v[38:41], v8, s[4:7], s33 offen offset:2560 sc1
    buffer_load_dwordx4 v[42:45], v8, s[4:7], s34 offen offset:0 sc1
    buffer_load_dwordx4 v[46:49], v8, s[4:7], s34 offen offset:2560 sc1
    buffer_load_dwordx4 v[50:53], v8, s[4:7], s35 offen offset:0 sc1
    buffer_load_dwordx4 v[54:57], v8, s[4:7], s35 offen offset:2560 sc1
L_Rs1_hb_8:
    s_waitcnt vmcnt(7)
    v_mfma_f32_16x16x32_bf16 v[70:73], a[248:251], v[26:29], 0
    v_xor_b32 v1, s44, v26
    s_waitcnt vmcnt(6)
    v_mfma_f32_16x16x32_bf16 v[70:73], a[248:251], v[30:33], v[70:73]
    v_bitop3_b32 v1, v1, v30, s44 bitop3:0xf6
    s_waitcnt vmcnt(5)
    v_mfma_f32_16x16x32_bf16 v[70:73], a[248:251], v[34:37], v[70:73]
    v_bitop3_b32 v1, v1, v34, s44 bitop3:0xf6
    s_waitcnt vmcnt(4)
    v_mfma_f32_16x16x32_bf16 v[70:73], a[248:251], v[38:41], v[70:73]
    v_bitop3_b32 v1, v1, v38, s44 bitop3:0xf6
    s_waitcnt vmcnt(3)
    v_mfma_f32_16x16x32_bf16 v[70:73], a[248:251], v[42:45], v[70:73]
    v_bitop3_b32 v1, v1, v42, s44 bitop3:0xf6
    s_waitcnt vmcnt(2)
    v_mfma_f32_16x16x32_bf16 v[70:73], a[248:251], v[46:49], v[70:73]
    v_bitop3_b32 v1, v1, v46, s44 bitop3:0xf6
    s_waitcnt vmcnt(1)
    v_mfma_f32_16x16x32_bf16 v[70:73], a[248:251], v[50:53], v[70:73]
    v_bitop3_b32 v1, v1, v50, s44 bitop3:0xf6
    s_waitcnt vmcnt(0)
    v_mfma_f32_16x16x32_bf16 v[70:73], a[248:251], v[54:57], v[70:73]
    v_bitop3_b32 v1, v1, v54, s44 bitop3:0xf6
    v_and_b32 v1, 1, v1
    v_cmp_ne_u32 vcc, 0, v1
    s_nop 0
    s_cbranch_vccnz L_Rs1_hbfix_9
    s_nop 2
    v_cvt_pk_bf16_f32 v74, v70, v71
    v_cvt_pk_bf16_f32 v75, v72, v73
    v_mov_b32 v76, v74
    v_mov_b32 v77, v75
    s_nop 0
    v_permlane16_swap_b32 v74, v76
    v_permlane16_swap_b32 v75, v77
    v_cndmask_b32 v74, v74, v78, s[42:43]
    v_cndmask_b32 v75, v75, v79, s[42:43]
    v_cndmask_b32 v76, v76, v80, s[42:43]
    v_cndmask_b32 v77, v77, v81, s[42:43]
    v_and_or_b32 v74, v74, -2, s24
    s_mov_b64 exec, s[46:47]
    buffer_store_dwordx4 v[74:77], v9, s[4:7], s36 offen sc1
    buffer_store_dwordx4 v[74:77], v9, s[4:7], s37 offen sc1
    s_mov_b64 exec, -1
    s_add_u32 s60, s20, 1
    s_and_b32 s22, s60, 1
    s_lshl_b32 s21, s22, 31
    s_sub_u32 s44, 0, s22
    s_bfe_u32 s23, s20, 0x10001
    s_sub_u32 s23, s23, 1
    s_lshr_b32 s24, s60, 1
    s_andn2_b32 s24, 1, s24
    s_lshl_b32 s61, s14, 15
    s_add_u32 s61, s61, 1179648
    s_and_b32 s25, s20, 1
    s_lshl_b32 s25, s25, 16
    s_add_u32 s25, s25, s61
    s_add_u32 s25, s25, 5120
    s_add_u32 s26, s25, 4096
    s_lshl_b32 s36, s22, 16
    s_add_u32 s36, s36, s61
    s_lshl_b32 s27, s20, 1
    s_add_u32 s37, s27, 2
    s_add_u32 s37, s37, s14
    s_mul_i32 s37, s37, 20480
    s_add_u32 s37, s37, 2621440
    s_add_u32 s27, s27, 1
    s_sub_u32 s27, s27, s14
    s_mul_i32 s27, s27, 20480
    s_add_u32 s27, s27, 2626560
    s_add_u32 s28, s27, 4096
    s_lshl_b32 s31, s20, 6
    s_add_u32 s31, s31, s13
    s_mul_i32 s31, s31, 6144
    s_add_u32 s31, s31, 5898240
    s_min_u32 s56, s20, 63
    s_lshl_b32 s56, s56, 6
    s_add_u32 s56, s56, s13
    s_mul_i32 s56, s56, 12288
    s_add_u32 s56, s56, 37364736
    s_max_u32 s57, s20, 5
    s_sub_u32 s57, s57, 5
    s_lshl_b32 s57, s57, 6
    s_add_u32 s57, s57, s13
    s_mul_i32 s57, s57, 12288
    s_add_u32 s57, s57, 87696384
    s_cmp_lt_u32 s20, 5
    s_cselect_b32 s57, s56, s57
    s_cmp_gt_u32 s60, 63
    s_cselect_b64 s[42:43], s[38:39], 0
    s_cmp_le_u32 s60, 5
    s_cselect_b64 vcc, s[40:41], 0
    s_or_b64 s[42:43], s[42:43], vcc
    s_waitcnt vmcnt(1)
    s_branch L_Rs1_top
L_Rs1_tail:
    s_waitcnt lgkmcnt(0)
    buffer_store_dwordx4 v[88:91], v0, s[4:7], s60 offen sc1
    s_waitcnt vmcnt(0) lgkmcnt(0)
    s_barrier
    v_mov_b32 v22, 69
    s_mov_b64 exec, 1
    s_mov_b64 exec, -1
    s_waitcnt vmcnt(0)
    s_endpgm
L_Rs1_glfix_3:
    buffer_load_dwordx4 v[10:13], v0, s[4:7], s25 offen offset:0 sc1
    buffer_load_dwordx4 v[14:17], v0, s[4:7], s25 offen offset:1024 sc1
    buffer_load_dwordx4 v[18:21], v0, s[4:7], s25 offen offset:2048 sc1
    buffer_load_dwordx4 v[22:25], v0, s[4:7], s25 offen offset:3072 sc1
    buffer_load_dwordx4 v[26:29], v0, s[4:7], s26 offen offset:0 sc1
    buffer_load_dwordx4 v[46:49], v0, s[4:7], s27 offen offset:0 sc1
    buffer_load_dwordx4 v[30:33], v0, s[4:7], s27 offen offset:1024 sc1
    buffer_load_dwordx4 v[34:37], v0, s[4:7], s27 offen offset:2048 sc1
    buffer_load_dwordx4 v[38:41], v0, s[4:7], s27 offen offset:3072 sc1
    buffer_load_dwordx4 v[42:45], v0, s[4:7], s28 offen offset:0 sc1
    s_add_u32 s19, s19, 1
    s_cmp_lt_u32 s19, 524288
    s_cbranch_scc1 L_Rs1_gl_1
    s_branch L_fail
L_Rs1_grfix_5:
    buffer_load_dwordx4 v[46:49], v0, s[4:7], s27 offen offset:0 sc1
    buffer_load_dwordx4 v[30:33], v0, s[4:7], s27 offen offset:1024 sc1
    buffer_load_dwordx4 v[34:37], v0, s[4:7], s27 offen offset:2048 sc1
    buffer_load_dwordx4 v[38:41], v0, s[4:7], s27 offen offset:3072 sc1
    buffer_load_dwordx4 v[42:45], v0, s[4:7], s28 offen offset:0 sc1
    s_add_u32 s19, s19, 1
    s_cmp_lt_u32 s19, 524288
    s_cbranch_scc1 L_Rs1_gr2_4
    s_branch L_fail
L_Rs1_gr2_4:
    v_mfma_f32_16x16x32_bf16 v[50:53], a[240:243], v[10:13], 0
    v_mfma_f32_16x16x32_bf16 v[54:57], a[244:247], v[10:13], 0
    v_mfma_f32_16x16x32_bf16 v[58:61], a[240:243], v[14:17], 0
    v_mfma_f32_16x16x32_bf16 v[62:65], a[244:247], v[14:17], 0
    v_mfma_f32_16x16x32_bf16 v[66:69], a[240:243], v[18:21], 0
    v_mfma_f32_16x16x32_bf16 v[70:73], a[244:247], v[18:21], 0
    v_mfma_f32_16x16x32_bf16 v[74:77], a[240:243], v[22:25], 0
    v_mfma_f32_16x16x32_bf16 v[78:81], a[244:247], v[22:25], 0
    v_mfma_f32_16x16x32_bf16 v[82:85], a[240:243], v[26:29], 0
    v_mfma_f32_16x16x32_bf16 v[86:89], a[244:247], v[26:29], 0
    s_branch L_Rs1_gr_2
L_Rs1_hafix_7:
    buffer_load_dwordx4 v[82:85], v0, s[4:7], s30 offen sc1
    s_add_u32 s19, s19, 1
    s_cmp_lt_u32 s19, 524288
    s_cbranch_scc1 L_Rs1_ha_6
    s_branch L_fail
L_Rs1_hbfix_9:
    buffer_load_dwordx4 v[26:29], v8, s[4:7], s32 offen offset:0 sc1
    buffer_load_dwordx4 v[30:33], v8, s[4:7], s32 offen offset:2560 sc1
    buffer_load_dwordx4 v[34:37], v8, s[4:7], s33 offen offset:0 sc1
    buffer_load_dwordx4 v[38:41], v8, s[4:7], s33 offen offset:2560 sc1
    buffer_load_dwordx4 v[42:45], v8, s[4:7], s34 offen offset:0 sc1
    buffer_load_dwordx4 v[46:49], v8, s[4:7], s34 offen offset:2560 sc1
    buffer_load_dwordx4 v[50:53], v8, s[4:7], s35 offen offset:0 sc1
    buffer_load_dwordx4 v[54:57], v8, s[4:7], s35 offen offset:2560 sc1
    s_add_u32 s19, s19, 1
    s_cmp_lt_u32 s19, 524288
    s_cbranch_scc1 L_Rs1_hb_8
    s_branch L_fail
L_R2_start:
    s_lshr_b32 s14, s13, 5
    s_and_b32 s15, s13, 31
    s_mov_b32 s62, 35840
    v_lshlrev_b32 v10, 4, v0
    v_mov_b32 v12, 0
    v_mov_b32 v13, 0
    v_mov_b32 v14, 0
    v_mov_b32 v15, 0
    v_mov_b32 v16, -1
    v_mov_b32 v17, -1
    v_mov_b32 v18, -1
    v_mov_b32 v19, -1
    s_lshl_b32 s60, s13, 12
    s_add_u32 s60, s60, 919552
    buffer_store_dwordx4 v[12:15], v10, s[4:7], s60 offen sc1
    s_mul_i32 s60, s13, 20480
    s_add_u32 s60, s60, 1320960
    buffer_store_dwordx4 v[12:15], v10, s[4:7], s60 offen sc1
    s_add_u32 s60, s60, 1024
    buffer_store_dwordx4 v[12:15], v10, s[4:7], s60 offen sc1
    s_add_u32 s60, s60, 1024
    buffer_store_dwordx4 v[12:15], v10, s[4:7], s60 offen sc1
    s_add_u32 s60, s60, 1024
    buffer_store_dwordx4 v[12:15], v10, s[4:7], s60 offen sc1
    s_add_u32 s60, s60, 1024
    buffer_store_dwordx4 v[12:15], v10, s[4:7], s60 offen sc1
    s_add_u32 s60, s60, 1024
    s_mul_i32 s61, s15, 640
    v_add_u32 v11, s61, v10
    s_mov_b32 exec_hi, 0xff
    s_lshl_b32 s60, s14, 15
    s_mul_i32 s60, s14, 20480
    s_add_u32 s60, s60, 2703360
    buffer_store_dwordx4 v[16:19], v11, s[4:7], s60 offen sc1
    s_add_u32 s60, s60, 163840
    buffer_store_dwordx4 v[16:19], v11, s[4:7], s60 offen sc1
    s_add_u32 s60, s60, 163840
    buffer_store_dwordx4 v[16:19], v11, s[4:7], s60 offen sc1
    s_add_u32 s60, s60, 163840
    buffer_store_dwordx4 v[16:19], v11, s[4:7], s60 offen sc1
    s_add_u32 s60, s60, 163840
    buffer_store_dwordx4 v[16:19], v11, s[4:7], s60 offen sc1
    s_add_u32 s60, s60, 163840
    buffer_store_dwordx4 v[16:19], v11, s[4:7], s60 offen sc1
    s_add_u32 s60, s60, 163840
    buffer_store_dwordx4 v[16:19], v11, s[4:7], s60 offen sc1
    s_add_u32 s60, s60, 163840
    buffer_store_dwordx4 v[16:19], v11, s[4:7], s60 offen sc1
    s_add_u32 s60, s60, 163840
    buffer_store_dwordx4 v[16:19], v11, s[4:7], s60 offen sc1
    s_add_u32 s60, s60, 163840
    buffer_store_dwordx4 v[16:19], v11, s[4:7], s60 offen sc1
    s_add_u32 s60, s60, 163840
    buffer_store_dwordx4 v[16:19], v11, s[4:7], s60 offen sc1
    s_add_u32 s60, s60, 163840
    buffer_store_dwordx4 v[16:19], v11, s[4:7], s60 offen sc1
    s_add_u32 s60, s60, 163840
    buffer_store_dwordx4 v[16:19], v11, s[4:7], s60 offen sc1
    s_add_u32 s60, s60, 163840
    buffer_store_dwordx4 v[16:19], v11, s[4:7], s60 offen sc1
    s_add_u32 s60, s60, 163840
    buffer_store_dwordx4 v[16:19], v11, s[4:7], s60 offen sc1
    s_add_u32 s60, s60, 163840
    buffer_store_dwordx4 v[16:19], v11, s[4:7], s60 offen sc1
    s_add_u32 s60, s60, 163840
    buffer_store_dwordx4 v[16:19], v11, s[4:7], s60 offen sc1
    s_add_u32 s60, s60, 163840
    s_mov_b64 exec, 1
    s_lshl_b32 s54, s13, 9
    s_lshr_b32 s55, s13, 1
    s_mul_i32 s55, s55, 1536
    s_add_u32 s55, s55, 32768
    s_add_u32 s54, s54, 256
    buffer_store_dword v12, v10, s[4:7], s54 offen sc1
    s_mov_b64 exec, -1
    v_add_u32 v38, 0, v0
    v_mul_u32_u24 v39, 10923, v38
    v_lshrrev_b32 v39, 16, v39
    v_mul_u32_u24 v20, 6, v39
    v_sub_u32 v20, v38, v20
    v_lshrrev_b32 v20, 0, v20
    v_lshlrev_b32 v20, 4, v20
    v_mul_u32_u24 v39, 12288, v39
    v_add_u32 v20, v20, v39
    v_add_u32 v38, 64, v0
    v_mul_u32_u24 v39, 10923, v38
    v_lshrrev_b32 v39, 16, v39
    v_mul_u32_u24 v21, 6, v39
    v_sub_u32 v21, v38, v21
    v_lshrrev_b32 v21, 0, v21
    v_lshlrev_b32 v21, 4, v21
    v_mul_u32_u24 v39, 12288, v39
    v_add_u32 v21, v21, v39
    v_add_u32 v38, 128, v0
    v_mul_u32_u24 v39, 10923, v38
    v_lshrrev_b32 v39, 16, v39
    v_mul_u32_u24 v22, 6, v39
    v_sub_u32 v22, v38, v22
    v_lshrrev_b32 v22, 0, v22
    v_lshlrev_b32 v22, 4, v22
    v_mul_u32_u24 v39, 12288, v39
    v_add_u32 v22, v22, v39
    v_add_u32 v38, 0, v0
    v_mul_u32_u24 v39, 16385, v38
    v_lshrrev_b32 v39, 16, v39
    v_mul_u32_u24 v23, 4, v39
    v_sub_u32 v23, v38, v23
    v_lshrrev_b32 v23, 0, v23
    v_lshlrev_b32 v23, 4, v23
    v_mul_u32_u24 v39, 12288, v39
    v_add_u32 v23, v23, v39
    v_add_u32 v38, 64, v0
    v_mul_u32_u24 v39, 16385, v38
    v_lshrrev_b32 v39, 16, v39
    v_mul_u32_u24 v24, 4, v39
    v_sub_u32 v24, v38, v24
    v_lshrrev_b32 v24, 0, v24
    v_lshlrev_b32 v24, 4, v24
    v_mul_u32_u24 v39, 12288, v39
    v_add_u32 v24, v24, v39
    v_add_u32 v38, 0, v0
    v_mul_u32_u24 v39, 3277, v38
    v_lshrrev_b32 v39, 16, v39
    v_mul_u32_u24 v25, 20, v39
    v_sub_u32 v25, v38, v25
    v_lshrrev_b32 v25, 0, v25
    v_lshlrev_b32 v25, 4, v25
    v_mul_u32_u24 v39, 1280, v39
    v_add_u32 v25, v25, v39
    v_add_u32 v38, 64, v0
    v_mul_u32_u24 v39, 3277, v38
    v_lshrrev_b32 v39, 16, v39
    v_mul_u32_u24 v26, 20, v39
    v_sub_u32 v26, v38, v26
    v_lshrrev_b32 v26, 0, v26
    v_lshlrev_b32 v26, 4, v26
    v_mul_u32_u24 v39, 1280, v39
    v_add_u32 v26, v26, v39
    v_add_u32 v38, 128, v0
    v_mul_u32_u24 v39, 3277, v38
    v_lshrrev_b32 v39, 16, v39
    v_mul_u32_u24 v27, 20, v39
    v_sub_u32 v27, v38, v27
    v_lshrrev_b32 v27, 0, v27
    v_lshlrev_b32 v27, 4, v27
    v_mul_u32_u24 v39, 1280, v39
    v_add_u32 v27, v27, v39
    v_add_u32 v38, 192, v0
    v_mul_u32_u24 v39, 3277, v38
    v_lshrrev_b32 v39, 16, v39
    v_mul_u32_u24 v28, 20, v39
    v_sub_u32 v28, v38, v28
    v_lshrrev_b32 v28, 0, v28
    v_lshlrev_b32 v28, 4, v28
    v_mul_u32_u24 v39, 1280, v39
    v_add_u32 v28, v28, v39
    v_add_u32 v38, 256, v0
    v_mul_u32_u24 v39, 3277, v38
    v_lshrrev_b32 v39, 16, v39
    v_mul_u32_u24 v29, 20, v39
    v_sub_u32 v29, v38, v29
    v_lshrrev_b32 v29, 0, v29
    v_lshlrev_b32 v29, 4, v29
    v_mul_u32_u24 v39, 1280, v39
    v_add_u32 v29, v29, v39
    v_add_u32 v38, 320, v0
    v_mul_u32_u24 v39, 3277, v38
    v_lshrrev_b32 v39, 16, v39
    v_mul_u32_u24 v30, 20, v39
    v_sub_u32 v30, v38, v30
    v_lshrrev_b32 v30, 0, v30
    v_lshlrev_b32 v30, 4, v30
    v_mul_u32_u24 v39, 1280, v39
    v_add_u32 v30, v30, v39
    v_add_u32 v38, 384, v0
    v_mul_u32_u24 v39, 3277, v38
    v_lshrrev_b32 v39, 16, v39
    v_mul_u32_u24 v31, 20, v39
    v_sub_u32 v31, v38, v31
    v_lshrrev_b32 v31, 0, v31
    v_lshlrev_b32 v31, 4, v31
    v_mul_u32_u24 v39, 1280, v39
    v_add_u32 v31, v31, v39
    v_add_u32 v38, 448, v0
    v_mul_u32_u24 v39, 3277, v38
    v_lshrrev_b32 v39, 16, v39
    v_mul_u32_u24 v32, 20, v39
    v_sub_u32 v32, v38, v32
    v_lshrrev_b32 v32, 0, v32
    v_lshlrev_b32 v32, 4, v32
    v_mul_u32_u24 v39, 1280, v39
    v_add_u32 v32, v32, v39
    v_add_u32 v38, 512, v0
    v_mul_u32_u24 v39, 3277, v38
    v_lshrrev_b32 v39, 16, v39
    v_mul_u32_u24 v33, 20, v39
    v_sub_u32 v33, v38, v33
    v_lshrrev_b32 v33, 0, v33
    v_lshlrev_b32 v33, 4, v33
    v_mul_u32_u24 v39, 1280, v39
    v_add_u32 v33, v33, v39
    v_add_u32 v38, 576, v0
    v_mul_u32_u24 v39, 3277, v38
    v_lshrrev_b32 v39, 16, v39
    v_mul_u32_u24 v34, 20, v39
    v_sub_u32 v34, v38, v34
    v_lshrrev_b32 v34, 0, v34
    v_lshlrev_b32 v34, 4, v34
    v_mul_u32_u24 v39, 1280, v39
    v_add_u32 v34, v34, v39
    v_lshrrev_b32 v35, 2, v0
    v_mul_u32_u24 v35, 96, v35
    v_and_b32 v38, 3, v0
    v_lshl_add_u32 v35, v38, 3, v35
    v_add_u32 v35, s62, v35
    v_lshrrev_b32 v36, 2, v0
    v_mul_u32_u24 v36, 64, v36
    v_and_b32 v38, 3, v0
    v_lshl_add_u32 v36, v38, 3, v36
    v_add_u32 v36, s62, v36
    v_lshrrev_b32 v37, 2, v0
    v_mul_u32_u24 v37, 320, v37
    v_and_b32 v38, 3, v0
    v_lshl_add_u32 v37, v38, 3, v37
    v_add_u32 v37, s62, v37
    v_add_u32 v2, 133120, v10
    s_mov_b32 s8, s70
    s_and_b32 s9, s71, 0xffff
    s_mov_b32 s10, 7864320
    s_mov_b32 s11, 0x20000
    s_mov_b32 s28, s72
    s_and_b32 s29, s73, 0xffff
    s_mov_b32 s30, 7864320
    s_mov_b32 s31, 0x20000
    s_mov_b32 s32, s74
    s_and_b32 s33, s75, 0xffff
    s_mov_b32 s34, 7864320
    s_mov_b32 s35, 0x20000
    s_mul_i32 s60, s13, 192
    s_add_u32 s25, s60, 0
    s_add_u32 s26, s60, 128
    s_mul_i32 s27, s13, 122880
    s_add_u32 s27, s27, 640
    s_add_u32 m0, s62, 0
    s_nop 0
    buffer_load_dwordx4 v20, s[8:11], s25 offen lds
    s_add_u32 m0, s62, 1024
    s_nop 0
    buffer_load_dwordx4 v21, s[8:11], s25 offen lds
    s_add_u32 m0, s62, 2048
    s_nop 0
    buffer_load_dwordx4 v22, s[8:11], s25 offen lds
    s_add_u32 s25, s25, 393216
    s_add_u32 m0, s62, 3072
    s_nop 0
    buffer_load_dwordx4 v20, s[8:11], s25 offen lds
    s_add_u32 m0, s62, 4096
    s_nop 0
    buffer_load_dwordx4 v21, s[8:11], s25 offen lds
    s_add_u32 m0, s62, 5120
    s_nop 0
    buffer_load_dwordx4 v22, s[8:11], s25 offen lds
    s_add_u32 s25, s25, 393216
    s_add_u32 m0, s62, 6144
    s_nop 0
    buffer_load_dwordx4 v20, s[8:11], s25 offen lds
    s_add_u32 m0, s62, 7168
    s_nop 0
    buffer_load_dwordx4 v21, s[8:11], s25 offen lds
    s_add_u32 m0, s62, 8192
    s_nop 0
    buffer_load_dwordx4 v22, s[8:11], s25 offen lds
    s_add_u32 s25, s25, 393216
    s_add_u32 m0, s62, 9216
    s_nop 0
    buffer_load_dwordx4 v20, s[8:11], s25 offen lds
    s_add_u32 m0, s62, 10240
    s_nop 0
    buffer_load_dwordx4 v21, s[8:11], s25 offen lds
    s_add_u32 m0, s62, 11264
    s_nop 0
    buffer_load_dwordx4 v22, s[8:11], s25 offen lds
    s_add_u32 s25, s25, 393216
    s_add_u32 m0, s62, 12288
    s_nop 0
    buffer_load_dwordx4 v20, s[8:11], s25 offen lds
    s_add_u32 m0, s62, 13312
    s_nop 0
    buffer_load_dwordx4 v21, s[8:11], s25 offen lds
    s_add_u32 m0, s62, 14336
    s_nop 0
    buffer_load_dwordx4 v22, s[8:11], s25 offen lds
    s_waitcnt vmcnt(12)
    s_barrier
    s_cmp_lg_u32 s12, 0
    s_cbranch_scc1 L_R2_arr_1
    s_lshl_b32 s3, s18, 2
    s_add_u32 s3, s3, 64
    v_mov_b32 v92, s3
    v_mov_b32 v93, 1
    s_mov_b64 exec, 1
    global_atomic_add v92, v93, s[16:17] sc1
    s_waitcnt vmcnt(0)
    s_mov_b64 exec, -1
L_R2_arr_1:
    ds_read_b64_tr_b16 a[0:1], v35 offset:0
    ds_read_b64_tr_b16 a[2:3], v35 offset:1536
    ds_read_b64_tr_b16 a[80:81], v35 offset:32
    ds_read_b64_tr_b16 a[82:83], v35 offset:1568
    ds_read_b64_tr_b16 a[160:161], v35 offset:64
    ds_read_b64_tr_b16 a[162:163], v35 offset:1600
    s_waitcnt lgkmcnt(0)
    s_add_u32 s25, s25, 393216
    s_add_u32 m0, s62, 0
    s_nop 0
    buffer_load_dwordx4 v20, s[8:11], s25 offen lds
    s_add_u32 m0, s62, 1024
    s_nop 0
    buffer_load_dwordx4 v21, s[8:11], s25 offen lds
    s_add_u32 m0, s62, 2048
    s_nop 0
    buffer_load_dwordx4 v22, s[8:11], s25 offen lds
    s_waitcnt vmcnt(12)
    ds_read_b64_tr_b16 a[4:5], v35 offset:3072
    ds_read_b64_tr_b16 a[6:7], v35 offset:4608
    ds_read_b64_tr_b16 a[84:85], v35 offset:3104
    ds_read_b64_tr_b16 a[86:87], v35 offset:4640
    ds_read_b64_tr_b16 a[164:165], v35 offset:3136
    ds_read_b64_tr_b16 a[166:167], v35 offset:4672
    s_waitcnt lgkmcnt(0)
    s_add_u32 s25, s25, 393216
    s_add_u32 m0, s62, 3072
    s_nop 0
    buffer_load_dwordx4 v20, s[8:11], s25 offen lds
    s_add_u32 m0, s62, 4096
    s_nop 0
    buffer_load_dwordx4 v21, s[8:11], s25 offen lds
    s_add_u32 m0, s62, 5120
    s_nop 0
    buffer_load_dwordx4 v22, s[8:11], s25 offen lds
    s_waitcnt vmcnt(12)
    ds_read_b64_tr_b16 a[8:9], v35 offset:6144
    ds_read_b64_tr_b16 a[10:11], v35 offset:7680
    ds_read_b64_tr_b16 a[88:89], v35 offset:6176
    ds_read_b64_tr_b16 a[90:91], v35 offset:7712
    ds_read_b64_tr_b16 a[168:169], v35 offset:6208
    ds_read_b64_tr_b16 a[170:171], v35 offset:7744
    s_waitcnt lgkmcnt(0)
    s_add_u32 s25, s25, 393216
    s_add_u32 m0, s62, 6144
    s_nop 0
    buffer_load_dwordx4 v20, s[8:11], s25 offen lds
    s_add_u32 m0, s62, 7168
    s_nop 0
    buffer_load_dwordx4 v21, s[8:11], s25 offen lds
    s_add_u32 m0, s62, 8192
    s_nop 0
    buffer_load_dwordx4 v22, s[8:11], s25 offen lds
    s_waitcnt vmcnt(12)
    ds_read_b64_tr_b16 a[12:13], v35 offset:9216
    ds_read_b64_tr_b16 a[14:15], v35 offset:10752
    ds_read_b64_tr_b16 a[92:93], v35 offset:9248
    ds_read_b64_tr_b16 a[94:95], v35 offset:10784
    ds_read_b64_tr_b16 a[172:173], v35 offset:9280
    ds_read_b64_tr_b16 a[174:175], v35 offset:10816
    s_waitcnt lgkmcnt(0)
    s_add_u32 s25, s25, 393216
    s_add_u32 m0, s62, 9216
    s_nop 0
    buffer_load_dwordx4 v20, s[8:11], s25 offen lds
    s_add_u32 m0, s62, 10240
    s_nop 0
    buffer_load_dwordx4 v21, s[8:11], s25 offen lds
    s_add_u32 m0, s62, 11264
    s_nop 0
    buffer_load_dwordx4 v22, s[8:11], s25 offen lds
    s_waitcnt vmcnt(12)
    ds_read_b64_tr_b16 a[16:17], v35 offset:12288
    ds_read_b64_tr_b16 a[18:19], v35 offset:13824
    ds_read_b64_tr_b16 a[96:97], v35 offset:12320
    ds_read_b64_tr_b16 a[98:99], v35 offset:13856
    ds_read_b64_tr_b16 a[176:177], v35 offset:12352
    ds_read_b64_tr_b16 a[178:179], v35 offset:13888
    s_waitcnt lgkmcnt(0)
    s_add_u32 s25, s25, 393216
    s_add_u32 m0, s62, 12288
    s_nop 0
    buffer_load_dwordx4 v20, s[8:11], s25 offen lds
    s_add_u32 m0, s62, 13312
    s_nop 0
    buffer_load_dwordx4 v21, s[8:11], s25 offen lds
    s_add_u32 m0, s62, 14336
    s_nop 0
    buffer_load_dwordx4 v22, s[8:11], s25 offen lds
    s_waitcnt vmcnt(12)
    ds_read_b64_tr_b16 a[20:21], v35 offset:0
    ds_read_b64_tr_b16 a[22:23], v35 offset:1536
    ds_read_b64_tr_b16 a[100:101], v35 offset:32
    ds_read_b64_tr_b16 a[102:103], v35 offset:1568
    ds_read_b64_tr_b16 a[180:181], v35 offset:64
    ds_read_b64_tr_b16 a[182:183], v35 offset:1600
    s_waitcnt lgkmcnt(0)
    s_add_u32 s25, s25, 393216
    s_add_u32 m0, s62, 0
    s_nop 0
    buffer_load_dwordx4 v20, s[8:11], s25 offen lds
    s_add_u32 m0, s62, 1024
    s_nop 0
    buffer_load_dwordx4 v21, s[8:11], s25 offen lds
    s_add_u32 m0, s62, 2048
    s_nop 0
    buffer_load_dwordx4 v22, s[8:11], s25 offen lds
    s_waitcnt vmcnt(12)
    ds_read_b64_tr_b16 a[24:25], v35 offset:3072
    ds_read_b64_tr_b16 a[26:27], v35 offset:4608
    ds_read_b64_tr_b16 a[104:105], v35 offset:3104
    ds_read_b64_tr_b16 a[106:107], v35 offset:4640
    ds_read_b64_tr_b16 a[184:185], v35 offset:3136
    ds_read_b64_tr_b16 a[186:187], v35 offset:4672
    s_waitcnt lgkmcnt(0)
    s_add_u32 s25, s25, 393216
    s_add_u32 m0, s62, 3072
    s_nop 0
    buffer_load_dwordx4 v20, s[8:11], s25 offen lds
    s_add_u32 m0, s62, 4096
    s_nop 0
    buffer_load_dwordx4 v21, s[8:11], s25 offen lds
    s_add_u32 m0, s62, 5120
    s_nop 0
    buffer_load_dwordx4 v22, s[8:11], s25 offen lds
    s_waitcnt vmcnt(12)
    ds_read_b64_tr_b16 a[28:29], v35 offset:6144
    ds_read_b64_tr_b16 a[30:31], v35 offset:7680
    ds_read_b64_tr_b16 a[108:109], v35 offset:6176
    ds_read_b64_tr_b16 a[110:111], v35 offset:7712
    ds_read_b64_tr_b16 a[188:189], v35 offset:6208
    ds_read_b64_tr_b16 a[190:191], v35 offset:7744
    s_waitcnt lgkmcnt(0)
    s_add_u32 s25, s25, 393216
    s_add_u32 m0, s62, 6144
    s_nop 0
    buffer_load_dwordx4 v20, s[8:11], s25 offen lds
    s_add_u32 m0, s62, 7168
    s_nop 0
    buffer_load_dwordx4 v21, s[8:11], s25 offen lds
    s_add_u32 m0, s62, 8192
    s_nop 0
    buffer_load_dwordx4 v22, s[8:11], s25 offen lds
    s_waitcnt vmcnt(12)
    ds_read_b64_tr_b16 a[32:33], v35 offset:9216
    ds_read_b64_tr_b16 a[34:35], v35 offset:10752
    ds_read_b64_tr_b16 a[112:113], v35 offset:9248
    ds_read_b64_tr_b16 a[114:115], v35 offset:10784
    ds_read_b64_tr_b16 a[192:193], v35 offset:9280
    ds_read_b64_tr_b16 a[194:195], v35 offset:10816
    s_waitcnt lgkmcnt(0)
    s_add_u32 s25, s25, 393216
    s_add_u32 m0, s62, 9216
    s_nop 0
    buffer_load_dwordx4 v20, s[8:11], s25 offen lds
    s_add_u32 m0, s62, 10240
    s_nop 0
    buffer_load_dwordx4 v21, s[8:11], s25 offen lds
    s_add_u32 m0, s62, 11264
    s_nop 0
    buffer_load_dwordx4 v22, s[8:11], s25 offen lds
    s_waitcnt vmcnt(12)
    ds_read_b64_tr_b16 a[36:37], v35 offset:12288
    ds_read_b64_tr_b16 a[38:39], v35 offset:13824
    ds_read_b64_tr_b16 a[116:117], v35 offset:12320
    ds_read_b64_tr_b16 a[118:119], v35 offset:13856
    ds_read_b64_tr_b16 a[196:197], v35 offset:12352
    ds_read_b64_tr_b16 a[198:199], v35 offset:13888
    s_waitcnt lgkmcnt(0)
    s_add_u32 s25, s25, 393216
    s_add_u32 m0, s62, 12288
    s_nop 0
    buffer_load_dwordx4 v20, s[8:11], s25 offen lds
    s_add_u32 m0, s62, 13312
    s_nop 0
    buffer_load_dwordx4 v21, s[8:11], s25 offen lds
    s_add_u32 m0, s62, 14336
    s_nop 0
    buffer_load_dwordx4 v22, s[8:11], s25 offen lds
    s_waitcnt vmcnt(12)
    ds_read_b64_tr_b16 a[40:41], v35 offset:0
    ds_read_b64_tr_b16 a[42:43], v35 offset:1536
    ds_read_b64_tr_b16 a[120:121], v35 offset:32
    ds_read_b64_tr_b16 a[122:123], v35 offset:1568
    ds_read_b64_tr_b16 a[200:201], v35 offset:64
    ds_read_b64_tr_b16 a[202:203], v35 offset:1600
    s_waitcnt lgkmcnt(0)
    s_add_u32 s25, s25, 393216
    s_add_u32 m0, s62, 0
    s_nop 0
    buffer_load_dwordx4 v20, s[8:11], s25 offen lds
    s_add_u32 m0, s62, 1024
    s_nop 0
    buffer_load_dwordx4 v21, s[8:11], s25 offen lds
    s_add_u32 m0, s62, 2048
    s_nop 0
    buffer_load_dwordx4 v22, s[8:11], s25 offen lds
    s_waitcnt vmcnt(12)
    ds_read_b64_tr_b16 a[44:45], v35 offset:3072
    ds_read_b64_tr_b16 a[46:47], v35 offset:4608
    ds_read_b64_tr_b16 a[124:125], v35 offset:3104
    ds_read_b64_tr_b16 a[126:127], v35 offset:4640
    ds_read_b64_tr_b16 a[204:205], v35 offset:3136
    ds_read_b64_tr_b16 a[206:207], v35 offset:4672
    s_waitcnt lgkmcnt(0)
    s_add_u32 s25, s25, 393216
    s_add_u32 m0, s62, 3072
    s_nop 0
    buffer_load_dwordx4 v20, s[8:11], s25 offen lds
    s_add_u32 m0, s62, 4096
    s_nop 0
    buffer_load_dwordx4 v21, s[8:11], s25 offen lds
    s_add_u32 m0, s62, 5120
    s_nop 0
    buffer_load_dwordx4 v22, s[8:11], s25 offen lds
    s_waitcnt vmcnt(12)
    ds_read_b64_tr_b16 a[48:49], v35 offset:6144
    ds_read_b64_tr_b16 a[50:51], v35 offset:7680
    ds_read_b64_tr_b16 a[128:129], v35 offset:6176
    ds_read_b64_tr_b16 a[130:131], v35 offset:7712
    ds_read_b64_tr_b16 a[208:209], v35 offset:6208
    ds_read_b64_tr_b16 a[210:211], v35 offset:7744
    s_waitcnt lgkmcnt(0)
    s_add_u32 s25, s25, 393216
    s_add_u32 m0, s62, 6144
    s_nop 0
    buffer_load_dwordx4 v20, s[8:11], s25 offen lds
    s_add_u32 m0, s62, 7168
    s_nop 0
    buffer_load_dwordx4 v21, s[8:11], s25 offen lds
    s_add_u32 m0, s62, 8192
    s_nop 0
    buffer_load_dwordx4 v22, s[8:11], s25 offen lds
    s_waitcnt vmcnt(12)
    ds_read_b64_tr_b16 a[52:53], v35 offset:9216
    ds_read_b64_tr_b16 a[54:55], v35 offset:10752
    ds_read_b64_tr_b16 a[132:133], v35 offset:9248
    ds_read_b64_tr_b16 a[134:135], v35 offset:10784
    ds_read_b64_tr_b16 a[212:213], v35 offset:9280
    ds_read_b64_tr_b16 a[214:215], v35 offset:10816
    s_waitcnt lgkmcnt(0)
    s_add_u32 s25, s25, 393216
    s_add_u32 m0, s62, 9216
    s_nop 0
    buffer_load_dwordx4 v20, s[8:11], s25 offen lds
    s_add_u32 m0, s62, 10240
    s_nop 0
    buffer_load_dwordx4 v21, s[8:11], s25 offen lds
    s_add_u32 m0, s62, 11264
    s_nop 0
    buffer_load_dwordx4 v22, s[8:11], s25 offen lds
    s_waitcnt vmcnt(12)
    ds_read_b64_tr_b16 a[56:57], v35 offset:12288
    ds_read_b64_tr_b16 a[58:59], v35 offset:13824
    ds_read_b64_tr_b16 a[136:137], v35 offset:12320
    ds_read_b64_tr_b16 a[138:139], v35 offset:13856
    ds_read_b64_tr_b16 a[216:217], v35 offset:12352
    ds_read_b64_tr_b16 a[218:219], v35 offset:13888
    s_waitcnt lgkmcnt(0)
    s_add_u32 s25, s25, 393216
    s_add_u32 m0, s62, 12288
    s_nop 0
    buffer_load_dwordx4 v20, s[8:11], s25 offen lds
    s_add_u32 m0, s62, 13312
    s_nop 0
    buffer_load_dwordx4 v21, s[8:11], s25 offen lds
    s_add_u32 m0, s62, 14336
    s_nop 0
    buffer_load_dwordx4 v22, s[8:11], s25 offen lds
    s_add_u32 m0, s62, 15360
    s_nop 0
    buffer_load_dwordx4 v23, s[28:31], s26 offen lds
    s_add_u32 m0, s62, 16384
    s_nop 0
    buffer_load_dwordx4 v24, s[28:31], s26 offen lds
    s_waitcnt vmcnt(14)
    ds_read_b64_tr_b16 a[60:61], v35 offset:0
    ds_read_b64_tr_b16 a[62:63], v35 offset:1536
    ds_read_b64_tr_b16 a[140:141], v35 offset:32
    ds_read_b64_tr_b16 a[142:143], v35 offset:1568
    ds_read_b64_tr_b16 a[220:221], v35 offset:64
    ds_read_b64_tr_b16 a[222:223], v35 offset:1600
    s_waitcnt lgkmcnt(0)
    s_add_u32 s26, s26, 393216
    s_add_u32 m0, s62, 0
    s_nop 0
    buffer_load_dwordx4 v23, s[28:31], s26 offen lds
    s_add_u32 m0, s62, 1024
    s_nop 0
    buffer_load_dwordx4 v24, s[28:31], s26 offen lds
    s_waitcnt vmcnt(13)
    ds_read_b64_tr_b16 a[64:65], v35 offset:3072
    ds_read_b64_tr_b16 a[66:67], v35 offset:4608
    ds_read_b64_tr_b16 a[144:145], v35 offset:3104
    ds_read_b64_tr_b16 a[146:147], v35 offset:4640
    ds_read_b64_tr_b16 a[224:225], v35 offset:3136
    ds_read_b64_tr_b16 a[226:227], v35 offset:4672
    s_waitcnt lgkmcnt(0)
    s_add_u32 s26, s26, 393216
    s_add_u32 m0, s62, 2048
    s_nop 0
    buffer_load_dwordx4 v23, s[28:31], s26 offen lds
    s_add_u32 m0, s62, 3072
    s_nop 0
    buffer_load_dwordx4 v24, s[28:31], s26 offen lds
    s_add_u32 s26, s26, 393216
    s_add_u32 m0, s62, 4096
    s_nop 0
    buffer_load_dwordx4 v23, s[28:31], s26 offen lds
    s_add_u32 m0, s62, 5120
    s_nop 0
    buffer_load_dwordx4 v24, s[28:31], s26 offen lds
    s_waitcnt vmcnt(14)
    ds_read_b64_tr_b16 a[68:69], v35 offset:6144
    ds_read_b64_tr_b16 a[70:71], v35 offset:7680
    ds_read_b64_tr_b16 a[148:149], v35 offset:6176
    ds_read_b64_tr_b16 a[150:151], v35 offset:7712
    ds_read_b64_tr_b16 a[228:229], v35 offset:6208
    ds_read_b64_tr_b16 a[230:231], v35 offset:7744
    s_waitcnt lgkmcnt(0)
    s_add_u32 s26, s26, 393216
    s_add_u32 m0, s62, 6144
    s_nop 0
    buffer_load_dwordx4 v23, s[28:31], s26 offen lds
    s_add_u32 m0, s62, 7168
    s_nop 0
    buffer_load_dwordx4 v24, s[28:31], s26 offen lds
    s_waitcnt vmcnt(13)
    ds_read_b64_tr_b16 a[72:73], v35 offset:9216
    ds_read_b64_tr_b16 a[74:75], v35 offset:10752
    ds_read_b64_tr_b16 a[152:153], v35 offset:9248
    ds_read_b64_tr_b16 a[154:155], v35 offset:10784
    ds_read_b64_tr_b16 a[232:233], v35 offset:9280
    ds_read_b64_tr_b16 a[234:235], v35 offset:10816
    s_waitcnt lgkmcnt(0)
    s_add_u32 s26, s26, 393216
    s_add_u32 m0, s62, 8192
    s_nop 0
    buffer_load_dwordx4 v23, s[28:31], s26 offen lds
    s_add_u32 m0, s62, 9216
    s_nop 0
    buffer_load_dwordx4 v24, s[28:31], s26 offen lds
    s_add_u32 s26, s26, 393216
    s_add_u32 m0, s62, 10240
    s_nop 0
    buffer_load_dwordx4 v23, s[28:31], s26 offen lds
    s_add_u32 m0, s62, 11264
    s_nop 0
    buffer_load_dwordx4 v24, s[28:31], s26 offen lds
    s_waitcnt vmcnt(14)
    ds_read_b64_tr_b16 a[76:77], v35 offset:12288
    ds_read_b64_tr_b16 a[78:79], v35 offset:13824
    ds_read_b64_tr_b16 a[156:157], v35 offset:12320
    ds_read_b64_tr_b16 a[158:159], v35 offset:13856
    ds_read_b64_tr_b16 a[236:237], v35 offset:12352
    ds_read_b64_tr_b16 a[238:239], v35 offset:13888
    s_waitcnt lgkmcnt(0)
    s_add_u32 s26, s26, 393216
    s_add_u32 m0, s62, 12288
    s_nop 0
    buffer_load_dwordx4 v23, s[28:31], s26 offen lds
    s_add_u32 m0, s62, 13312
    s_nop 0
    buffer_load_dwordx4 v24, s[28:31], s26 offen lds
    s_waitcnt vmcnt(14)
    ds_read_b64_tr_b16 v[96:97], v36 offset:15360
    ds_read_b64_tr_b16 v[98:99], v36 offset:16384
    ds_read_b64_tr_b16 v[176:177], v36 offset:15392
    ds_read_b64_tr_b16 v[178:179], v36 offset:16416
    s_waitcnt lgkmcnt(0)
    s_add_u32 s26, s26, 393216
    s_add_u32 m0, s62, 14336
    s_nop 0
    buffer_load_dwordx4 v23, s[28:31], s26 offen lds
    s_add_u32 m0, s62, 15360
    s_nop 0
    buffer_load_dwordx4 v24, s[28:31], s26 offen lds
    s_waitcnt vmcnt(14)
    ds_read_b64_tr_b16 v[100:101], v36 offset:0
    ds_read_b64_tr_b16 v[102:103], v36 offset:1024
    ds_read_b64_tr_b16 v[180:181], v36 offset:32
    ds_read_b64_tr_b16 v[182:183], v36 offset:1056
    s_waitcnt lgkmcnt(0)
    s_add_u32 s26, s26, 393216
    s_add_u32 m0, s62, 0
    s_nop 0
    buffer_load_dwordx4 v23, s[28:31], s26 offen lds
    s_add_u32 m0, s62, 1024
    s_nop 0
    buffer_load_dwordx4 v24, s[28:31], s26 offen lds
    s_waitcnt vmcnt(14)
    ds_read_b64_tr_b16 v[104:105], v36 offset:2048
    ds_read_b64_tr_b16 v[106:107], v36 offset:3072
    ds_read_b64_tr_b16 v[184:185], v36 offset:2080
    ds_read_b64_tr_b16 v[186:187], v36 offset:3104
    s_waitcnt lgkmcnt(0)
    s_add_u32 s26, s26, 393216
    s_add_u32 m0, s62, 2048
    s_nop 0
    buffer_load_dwordx4 v23, s[28:31], s26 offen lds
    s_add_u32 m0, s62, 3072
    s_nop 0
    buffer_load_dwordx4 v24, s[28:31], s26 offen lds
    s_waitcnt vmcnt(14)
    ds_read_b64_tr_b16 v[108:109], v36 offset:4096
    ds_read_b64_tr_b16 v[110:111], v36 offset:5120
    ds_read_b64_tr_b16 v[188:189], v36 offset:4128
    ds_read_b64_tr_b16 v[190:191], v36 offset:5152
    s_waitcnt lgkmcnt(0)
    s_add_u32 s26, s26, 393216
    s_add_u32 m0, s62, 4096
    s_nop 0
    buffer_load_dwordx4 v23, s[28:31], s26 offen lds
    s_add_u32 m0, s62, 5120
    s_nop 0
    buffer_load_dwordx4 v24, s[28:31], s26 offen lds
    s_waitcnt vmcnt(14)
    ds_read_b64_tr_b16 v[112:113], v36 offset:6144
    ds_read_b64_tr_b16 v[114:115], v36 offset:7168
    ds_read_b64_tr_b16 v[192:193], v36 offset:6176
    ds_read_b64_tr_b16 v[194:195], v36 offset:7200
    s_waitcnt lgkmcnt(0)
    s_add_u32 s26, s26, 393216
    s_add_u32 m0, s62, 6144
    s_nop 0
    buffer_load_dwordx4 v23, s[28:31], s26 offen lds
    s_add_u32 m0, s62, 7168
    s_nop 0
    buffer_load_dwordx4 v24, s[28:31], s26 offen lds
    s_waitcnt vmcnt(14)
    ds_read_b64_tr_b16 v[116:117], v36 offset:8192
    ds_read_b64_tr_b16 v[118:119], v36 offset:9216
    ds_read_b64_tr_b16 v[196:197], v36 offset:8224
    ds_read_b64_tr_b16 v[198:199], v36 offset:9248
    s_waitcnt lgkmcnt(0)
    s_add_u32 s26, s26, 393216
    s_add_u32 m0, s62, 8192
    s_nop 0
    buffer_load_dwordx4 v23, s[28:31], s26 offen lds
    s_add_u32 m0, s62, 9216
    s_nop 0
    buffer_load_dwordx4 v24, s[28:31], s26 offen lds
    s_waitcnt vmcnt(14)
    ds_read_b64_tr_b16 v[120:121], v36 offset:10240
    ds_read_b64_tr_b16 v[122:123], v36 offset:11264
    ds_read_b64_tr_b16 v[200:201], v36 offset:10272
    ds_read_b64_tr_b16 v[202:203], v36 offset:11296
    s_waitcnt lgkmcnt(0)
    s_add_u32 s26, s26, 393216
    s_add_u32 m0, s62, 10240
    s_nop 0
    buffer_load_dwordx4 v23, s[28:31], s26 offen lds
    s_add_u32 m0, s62, 11264
    s_nop 0
    buffer_load_dwordx4 v24, s[28:31], s26 offen lds
    s_waitcnt vmcnt(14)
    ds_read_b64_tr_b16 v[124:125], v36 offset:12288
    ds_read_b64_tr_b16 v[126:127], v36 offset:13312
    ds_read_b64_tr_b16 v[204:205], v36 offset:12320
    ds_read_b64_tr_b16 v[206:207], v36 offset:13344
    s_waitcnt lgkmcnt(0)
    s_add_u32 s26, s26, 393216
    s_add_u32 m0, s62, 12288
    s_nop 0
    buffer_load_dwordx4 v23, s[28:31], s26 offen lds
    s_add_u32 m0, s62, 13312
    s_nop 0
    buffer_load_dwordx4 v24, s[28:31], s26 offen lds
    s_waitcnt vmcnt(14)
    ds_read_b64_tr_b16 v[128:129], v36 offset:14336
    ds_read_b64_tr_b16 v[130:131], v36 offset:15360
    ds_read_b64_tr_b16 v[208:209], v36 offset:14368
    ds_read_b64_tr_b16 v[210:211], v36 offset:15392
    s_waitcnt lgkmcnt(0)
    s_add_u32 s26, s26, 393216
    s_add_u32 m0, s62, 14336
    s_nop 0
    buffer_load_dwordx4 v23, s[28:31], s26 offen lds
    s_add_u32 m0, s62, 15360
    s_nop 0
    buffer_load_dwordx4 v24, s[28:31], s26 offen lds
    s_waitcnt vmcnt(14)
    ds_read_b64_tr_b16 v[132:133], v36 offset:0
    ds_read_b64_tr_b16 v[134:135], v36 offset:1024
    ds_read_b64_tr_b16 v[212:213], v36 offset:32
    ds_read_b64_tr_b16 v[214:215], v36 offset:1056
    s_waitcnt lgkmcnt(0)
    s_add_u32 s26, s26, 393216
    s_add_u32 m0, s62, 0
    s_nop 0
    buffer_load_dwordx4 v23, s[28:31], s26 offen lds
    s_add_u32 m0, s62, 1024
    s_nop 0
    buffer_load_dwordx4 v24, s[28:31], s26 offen lds
    s_waitcnt vmcnt(14)
    ds_read_b64_tr_b16 v[136:137], v36 offset:2048
    ds_read_b64_tr_b16 v[138:139], v36 offset:3072
    ds_read_b64_tr_b16 v[216:217], v36 offset:2080
    ds_read_b64_tr_b16 v[218:219], v36 offset:3104
    s_waitcnt lgkmcnt(0)
    s_add_u32 s26, s26, 393216
    s_add_u32 m0, s62, 2048
    s_nop 0
    buffer_load_dwordx4 v23, s[28:31], s26 offen lds
    s_add_u32 m0, s62, 3072
    s_nop 0
    buffer_load_dwordx4 v24, s[28:31], s26 offen lds
    s_waitcnt vmcnt(14)
    ds_read_b64_tr_b16 v[140:141], v36 offset:4096
    ds_read_b64_tr_b16 v[142:143], v36 offset:5120
    ds_read_b64_tr_b16 v[220:221], v36 offset:4128
    ds_read_b64_tr_b16 v[222:223], v36 offset:5152
    s_waitcnt lgkmcnt(0)
    s_add_u32 s26, s26, 393216
    s_add_u32 m0, s62, 4096
    s_nop 0
    buffer_load_dwordx4 v23, s[28:31], s26 offen lds
    s_add_u32 m0, s62, 5120
    s_nop 0
    buffer_load_dwordx4 v24, s[28:31], s26 offen lds
    s_waitcnt vmcnt(14)
    ds_read_b64_tr_b16 v[144:145], v36 offset:6144
    ds_read_b64_tr_b16 v[146:147], v36 offset:7168
    ds_read_b64_tr_b16 v[224:225], v36 offset:6176
    ds_read_b64_tr_b16 v[226:227], v36 offset:7200
    s_waitcnt lgkmcnt(0)
    s_waitcnt vmcnt(12)
    ds_read_b64_tr_b16 v[148:149], v36 offset:8192
    ds_read_b64_tr_b16 v[150:151], v36 offset:9216
    ds_read_b64_tr_b16 v[228:229], v36 offset:8224
    ds_read_b64_tr_b16 v[230:231], v36 offset:9248
    s_waitcnt lgkmcnt(0)
    s_waitcnt vmcnt(10)
    ds_read_b64_tr_b16 v[152:153], v36 offset:10240
    ds_read_b64_tr_b16 v[154:155], v36 offset:11264
    ds_read_b64_tr_b16 v[232:233], v36 offset:10272
    ds_read_b64_tr_b16 v[234:235], v36 offset:11296
    s_waitcnt lgkmcnt(0)
    s_waitcnt vmcnt(8)
    ds_read_b64_tr_b16 v[156:157], v36 offset:12288
    ds_read_b64_tr_b16 v[158:159], v36 offset:13312
    ds_read_b64_tr_b16 v[236:237], v36 offset:12320
    ds_read_b64_tr_b16 v[238:239], v36 offset:13344
    s_waitcnt lgkmcnt(0)
    s_waitcnt vmcnt(6)
    ds_read_b64_tr_b16 v[160:161], v36 offset:14336
    ds_read_b64_tr_b16 v[162:163], v36 offset:15360
    ds_read_b64_tr_b16 v[240:241], v36 offset:14368
    ds_read_b64_tr_b16 v[242:243], v36 offset:15392
    s_waitcnt lgkmcnt(0)
    s_add_u32 m0, s62, 6144
    s_nop 0
    buffer_load_dwordx4 v25, s[32:35], s27 offen lds
    s_add_u32 m0, s62, 7168
    s_nop 0
    buffer_load_dwordx4 v26, s[32:35], s27 offen lds
    s_add_u32 m0, s62, 8192
    s_nop 0
    buffer_load_dwordx4 v27, s[32:35], s27 offen lds
    s_add_u32 m0, s62, 9216
    s_nop 0
    buffer_load_dwordx4 v28, s[32:35], s27 offen lds
    s_add_u32 m0, s62, 10240
    s_nop 0
    buffer_load_dwordx4 v29, s[32:35], s27 offen lds
    s_add_u32 m0, s62, 11264
    s_nop 0
    buffer_load_dwordx4 v30, s[32:35], s27 offen lds
    s_add_u32 m0, s62, 12288
    s_nop 0
    buffer_load_dwordx4 v31, s[32:35], s27 offen lds
    s_add_u32 m0, s62, 13312
    s_nop 0
    buffer_load_dwordx4 v32, s[32:35], s27 offen lds
    s_add_u32 m0, s62, 14336
    s_nop 0
    buffer_load_dwordx4 v33, s[32:35], s27 offen lds
    s_add_u32 m0, s62, 15360
    s_nop 0
    buffer_load_dwordx4 v34, s[32:35], s27 offen lds
    s_waitcnt vmcnt(14)
    ds_read_b64_tr_b16 v[164:165], v36 offset:0
    ds_read_b64_tr_b16 v[166:167], v36 offset:1024
    ds_read_b64_tr_b16 v[244:245], v36 offset:32
    ds_read_b64_tr_b16 v[246:247], v36 offset:1056
    s_waitcnt lgkmcnt(0)
    s_waitcnt vmcnt(12)
    ds_read_b64_tr_b16 v[168:169], v36 offset:2048
    ds_read_b64_tr_b16 v[170:171], v36 offset:3072
    ds_read_b64_tr_b16 v[248:249], v36 offset:2080
    ds_read_b64_tr_b16 v[250:251], v36 offset:3104
    s_waitcnt lgkmcnt(0)
    s_waitcnt vmcnt(10)
    ds_read_b64_tr_b16 v[172:173], v36 offset:4096
    ds_read_b64_tr_b16 v[174:175], v36 offset:5120
    ds_read_b64_tr_b16 v[252:253], v36 offset:4128
    ds_read_b64_tr_b16 v[254:255], v36 offset:5152
    s_waitcnt lgkmcnt(0)
    s_waitcnt vmcnt(0)
    ds_read_b64_tr_b16 v[40:41], v37 offset:6144
    ds_read_b64_tr_b16 v[42:43], v37 offset:11264
    ds_read_b64_tr_b16 v[44:45], v37 offset:6176
    ds_read_b64_tr_b16 v[46:47], v37 offset:11296
    ds_read_b64_tr_b16 v[48:49], v37 offset:6208
    ds_read_b64_tr_b16 v[50:51], v37 offset:11328
    ds_read_b64_tr_b16 v[52:53], v37 offset:6240
    ds_read_b64_tr_b16 v[54:55], v37 offset:11360
    s_waitcnt lgkmcnt(0)
    ds_write_b128 v2, v[40:43] offset:0
    ds_write_b128 v2, v[44:47] offset:3072
    ds_write_b128 v2, v[48:51] offset:6144
    ds_write_b128 v2, v[52:55] offset:9216
    s_waitcnt lgkmcnt(0)
    ds_read_b64_tr_b16 v[40:41], v37 offset:6272
    ds_read_b64_tr_b16 v[42:43], v37 offset:11392
    ds_read_b64_tr_b16 v[44:45], v37 offset:6304
    ds_read_b64_tr_b16 v[46:47], v37 offset:11424
    ds_read_b64_tr_b16 v[48:49], v37 offset:6336
    ds_read_b64_tr_b16 v[50:51], v37 offset:11456
    ds_read_b64_tr_b16 v[52:53], v37 offset:6368
    ds_read_b64_tr_b16 v[54:55], v37 offset:11488
    s_waitcnt lgkmcnt(0)
    ds_write_b128 v2, v[40:43] offset:12288
    ds_write_b128 v2, v[44:47] offset:15360
    ds_write_b128 v2, v[48:51] offset:18432
    ds_write_b128 v2, v[52:55] offset:21504
    s_waitcnt lgkmcnt(0)
    ds_read_b64_tr_b16 v[40:41], v37 offset:6400
    ds_read_b64_tr_b16 v[42:43], v37 offset:11520
    ds_read_b64_tr_b16 v[44:45], v37 offset:6432
    ds_read_b64_tr_b16 v[46:47], v37 offset:11552
    s_waitcnt lgkmcnt(0)
    ds_write_b128 v2, v[40:43] offset:24576
    ds_write_b128 v2, v[44:47] offset:27648
    s_waitcnt lgkmcnt(0)
    s_add_u32 s27, s27, 40960
    s_add_u32 m0, s62, 0
    s_nop 0
    buffer_load_dwordx4 v25, s[32:35], s27 offen lds
    s_add_u32 m0, s62, 1024
    s_nop 0
    buffer_load_dwordx4 v26, s[32:35], s27 offen lds
    s_add_u32 m0, s62, 2048
    s_nop 0
    buffer_load_dwordx4 v27, s[32:35], s27 offen lds
    s_add_u32 m0, s62, 3072
    s_nop 0
    buffer_load_dwordx4 v28, s[32:35], s27 offen lds
    s_add_u32 m0, s62, 4096
    s_nop 0
    buffer_load_dwordx4 v29, s[32:35], s27 offen lds
    s_add_u32 m0, s62, 5120
    s_nop 0
    buffer_load_dwordx4 v30, s[32:35], s27 offen lds
    s_add_u32 m0, s62, 6144
    s_nop 0
    buffer_load_dwordx4 v31, s[32:35], s27 offen lds
    s_add_u32 m0, s62, 7168
    s_nop 0
    buffer_load_dwordx4 v32, s[32:35], s27 offen lds
    s_add_u32 m0, s62, 8192
    s_nop 0
    buffer_load_dwordx4 v33, s[32:35], s27 offen lds
    s_add_u32 m0, s62, 9216
    s_nop 0
    buffer_load_dwordx4 v34, s[32:35], s27 offen lds
    s_waitcnt vmcnt(0)
    ds_read_b64_tr_b16 v[40:41], v37 offset:0
    ds_read_b64_tr_b16 v[42:43], v37 offset:5120
    ds_read_b64_tr_b16 v[44:45], v37 offset:32
    ds_read_b64_tr_b16 v[46:47], v37 offset:5152
    ds_read_b64_tr_b16 v[48:49], v37 offset:64
    ds_read_b64_tr_b16 v[50:51], v37 offset:5184
    ds_read_b64_tr_b16 v[52:53], v37 offset:96
    ds_read_b64_tr_b16 v[54:55], v37 offset:5216
    s_waitcnt lgkmcnt(0)
    ds_write_b128 v2, v[40:43] offset:1024
    ds_write_b128 v2, v[44:47] offset:4096
    ds_write_b128 v2, v[48:51] offset:7168
    ds_write_b128 v2, v[52:55] offset:10240
    s_waitcnt lgkmcnt(0)
    ds_read_b64_tr_b16 v[40:41], v37 offset:128
    ds_read_b64_tr_b16 v[42:43], v37 offset:5248
    ds_read_b64_tr_b16 v[44:45], v37 offset:160
    ds_read_b64_tr_b16 v[46:47], v37 offset:5280
    ds_read_b64_tr_b16 v[48:49], v37 offset:192
    ds_read_b64_tr_b16 v[50:51], v37 offset:5312
    ds_read_b64_tr_b16 v[52:53], v37 offset:224
    ds_read_b64_tr_b16 v[54:55], v37 offset:5344
    s_waitcnt lgkmcnt(0)
    ds_write_b128 v2, v[40:43] offset:13312
    ds_write_b128 v2, v[44:47] offset:16384
    ds_write_b128 v2, v[48:51] offset:19456
    ds_write_b128 v2, v[52:55] offset:22528
    s_waitcnt lgkmcnt(0)
    ds_read_b64_tr_b16 v[40:41], v37 offset:256
    ds_read_b64_tr_b16 v[42:43], v37 offset:5376
    ds_read_b64_tr_b16 v[44:45], v37 offset:288
    ds_read_b64_tr_b16 v[46:47], v37 offset:5408
    s_waitcnt lgkmcnt(0)
    ds_write_b128 v2, v[40:43] offset:25600
    ds_write_b128 v2, v[44:47] offset:28672
    s_waitcnt lgkmcnt(0)
    s_add_u32 s27, s27, 40960
    s_add_u32 m0, s62, 0
    s_nop 0
    buffer_load_dwordx4 v25, s[32:35], s27 offen lds
    s_add_u32 m0, s62, 1024
    s_nop 0
    buffer_load_dwordx4 v26, s[32:35], s27 offen lds
    s_add_u32 m0, s62, 2048
    s_nop 0
    buffer_load_dwordx4 v27, s[32:35], s27 offen lds
    s_add_u32 m0, s62, 3072
    s_nop 0
    buffer_load_dwordx4 v28, s[32:35], s27 offen lds
    s_add_u32 m0, s62, 4096
    s_nop 0
    buffer_load_dwordx4 v29, s[32:35], s27 offen lds
    s_add_u32 m0, s62, 5120
    s_nop 0
    buffer_load_dwordx4 v30, s[32:35], s27 offen lds
    s_add_u32 m0, s62, 6144
    s_nop 0
    buffer_load_dwordx4 v31, s[32:35], s27 offen lds
    s_add_u32 m0, s62, 7168
    s_nop 0
    buffer_load_dwordx4 v32, s[32:35], s27 offen lds
    s_add_u32 m0, s62, 8192
    s_nop 0
    buffer_load_dwordx4 v33, s[32:35], s27 offen lds
    s_add_u32 m0, s62, 9216
    s_nop 0
    buffer_load_dwordx4 v34, s[32:35], s27 offen lds
    s_waitcnt vmcnt(0)
    ds_read_b64_tr_b16 v[40:41], v37 offset:0
    ds_read_b64_tr_b16 v[42:43], v37 offset:5120
    ds_read_b64_tr_b16 v[44:45], v37 offset:32
    ds_read_b64_tr_b16 v[46:47], v37 offset:5152
    ds_read_b64_tr_b16 v[48:49], v37 offset:64
    ds_read_b64_tr_b16 v[50:51], v37 offset:5184
    ds_read_b64_tr_b16 v[52:53], v37 offset:96
    ds_read_b64_tr_b16 v[54:55], v37 offset:5216
    s_waitcnt lgkmcnt(0)
    ds_write_b128 v2, v[40:43] offset:2048
    ds_write_b128 v2, v[44:47] offset:5120
    ds_write_b128 v2, v[48:51] offset:8192
    ds_write_b128 v2, v[52:55] offset:11264
    s_waitcnt lgkmcnt(0)
    ds_read_b64_tr_b16 v[40:41], v37 offset:128
    ds_read_b64_tr_b16 v[42:43], v37 offset:5248
    ds_read_b64_tr_b16 v[44:45], v37 offset:160
    ds_read_b64_tr_b16 v[46:47], v37 offset:5280
    ds_read_b64_tr_b16 v[48:49], v37 offset:192
    ds_read_b64_tr_b16 v[50:51], v37 offset:5312
    ds_read_b64_tr_b16 v[52:53], v37 offset:224
    ds_read_b64_tr_b16 v[54:55], v37 offset:5344
    s_waitcnt lgkmcnt(0)
    ds_write_b128 v2, v[40:43] offset:14336
    ds_write_b128 v2, v[44:47] offset:17408
    ds_write_b128 v2, v[48:51] offset:20480
    ds_write_b128 v2, v[52:55] offset:23552
    s_waitcnt lgkmcnt(0)
    ds_read_b64_tr_b16 v[40:41], v37 offset:256
    ds_read_b64_tr_b16 v[42:43], v37 offset:5376
    ds_read_b64_tr_b16 v[44:45], v37 offset:288
    ds_read_b64_tr_b16 v[46:47], v37 offset:5408
    s_waitcnt lgkmcnt(0)
    ds_write_b128 v2, v[40:43] offset:26624
    ds_write_b128 v2, v[44:47] offset:29696
    s_waitcnt lgkmcnt(0)
    v_and_b32 v10, 15, v0
    v_lshrrev_b32 v11, 4, v0
    v_and_b32 v12, 7, v0
    v_and_b32 v13, 1, v0
    v_mov_b32 v14, 0x3f80
    v_lshlrev_b32 v13, 4, v13
    v_lshlrev_b32 v14, v13, v14
    v_lshrrev_b32 v12, 1, v12
    v_lshrrev_b32 v13, 2, v10
    v_cmp_eq_u32 s[38:39], v13, v11
    v_bfe_u32 v13, v0, 1, 1
    s_nop 0
    v_cndmask_b32 v17, 0, v14, s[38:39]
    v_cmp_eq_u32 vcc, 0, v12
    s_nop 1
    v_cndmask_b32 v15, 0, v14, vcc
    v_accvgpr_write_b32 a248, v15
    v_cmp_eq_u32 vcc, 0, v13
    s_nop 1
    v_cndmask_b32 v16, 0, v17, vcc
    v_accvgpr_write_b32 a240, v16
    v_accvgpr_write_b32 a244, 0
    v_cmp_eq_u32 vcc, 1, v12
    s_nop 1
    v_cndmask_b32 v15, 0, v14, vcc
    v_accvgpr_write_b32 a249, v15
    v_cmp_eq_u32 vcc, 1, v13
    s_nop 1
    v_cndmask_b32 v16, 0, v17, vcc
    v_accvgpr_write_b32 a241, v16
    v_accvgpr_write_b32 a245, 0
    v_cmp_eq_u32 vcc, 2, v12
    s_nop 1
    v_cndmask_b32 v15, 0, v14, vcc
    v_accvgpr_write_b32 a250, v15
    v_cmp_eq_u32 vcc, 0, v13
    s_nop 1
    v_cndmask_b32 v16, 0, v17, vcc
    v_accvgpr_write_b32 a246, v16
    v_accvgpr_write_b32 a242, 0
    v_cmp_eq_u32 vcc, 3, v12
    s_nop 1
    v_cndmask_b32 v15, 0, v14, vcc
    v_accvgpr_write_b32 a251, v15
    v_cmp_eq_u32 vcc, 1, v13
    s_nop 1
    v_cndmask_b32 v16, 0, v17, vcc
    v_accvgpr_write_b32 a247, v16
    v_accvgpr_write_b32 a243, 0
    v_cmp_gt_u32 s[48:49], 8, v10
    v_cmp_gt_u32 vcc, 2, v11
    s_xnor_b64 s[50:51], vcc, s[48:49]
    s_mul_i32 s60, s15, 640
    s_mov_b32 s61, 20480
    v_add_u32 v12, 640, v0
    v_mul_u32_u24 v13, 52429, v12
    v_lshrrev_b32 v13, 21, v13
    v_mul_u32_u24 v14, 40, v13
    v_sub_u32 v14, v12, v14
    v_mul_lo_u32 v13, v13, s61
    v_lshl_add_u32 v13, v14, 4, v13
    v_add_u32 v3, s60, v13
    v_add_u32 v12, 704, v0
    v_mul_u32_u24 v13, 52429, v12
    v_lshrrev_b32 v13, 21, v13
    v_mul_u32_u24 v14, 40, v13
    v_sub_u32 v14, v12, v14
    v_mul_lo_u32 v13, v13, s61
    v_lshl_add_u32 v13, v14, 4, v13
    v_add_u32 v4, s60, v13
    v_add_u32 v12, 768, v0
    v_mul_u32_u24 v13, 52429, v12
    v_lshrrev_b32 v13, 21, v13
    v_mul_u32_u24 v14, 40, v13
    v_sub_u32 v14, v12, v14
    v_mul_lo_u32 v13, v13, s61
    v_lshl_add_u32 v13, v14, 4, v13
    v_add_u32 v5, s60, v13
    v_add_u32 v12, 832, v0
    v_mul_u32_u24 v13, 52429, v12
    v_lshrrev_b32 v13, 21, v13
    v_mul_u32_u24 v14, 40, v13
    v_sub_u32 v14, v12, v14
    v_mul_lo_u32 v13, v13, s61
    v_lshl_add_u32 v13, v14, 4, v13
    v_add_u32 v6, s60, v13
    v_add_u32 v12, 896, v0
    v_mul_u32_u24 v13, 52429, v12
    v_lshrrev_b32 v13, 21, v13
    v_mul_u32_u24 v14, 40, v13
    v_sub_u32 v14, v12, v14
    v_mul_lo_u32 v13, v13, s61
    v_lshl_add_u32 v13, v14, 4, v13
    v_add_u32 v7, s60, v13
    s_mul_i32 s60, s15, 20480
    s_add_u32 s60, s60, 512
    v_lshrrev_b32 v12, 3, v0
    v_mul_u32_u24 v12, 640, v12
    v_and_b32 v13, 7, v0
    v_lshl_add_u32 v12, v13, 4, v12
    v_add_u32 v8, s60, v12
    s_mul_i32 s60, s15, 40
    s_add_u32 s60, s60, 32
    v_add_u32 v12, s60, v10
    v_lshlrev_b32 v9, 4, v12
    s_mul_i32 s32, s14, 655360
    s_add_u32 s32, s32, 1310720
    s_add_u32 s33, s32, 5120
    s_add_u32 s34, s32, 10240
    s_add_u32 s35, s32, 15360
    s_mov_b32 s52, 1037384597
    s_mov_b32 s53, 1037384597
    s_lshl_b32 s29, s13, 12
    s_add_u32 s29, s29, 917504
    s_xor_b32 s30, s29, 4096
    s_mov_b64 s[46:47], 255
    s_mov_b32 s8, s66
    s_and_b32 s9, s67, 0xffff
    s_mov_b32 s10, 10240
    s_mov_b32 s11, 0x20000
    v_and_b32 v13, 7, v12
    v_mul_u32_u24 v13, 1280, v13
    v_lshrrev_b32 v14, 6, v12
    v_lshl_add_u32 v13, v14, 6, v13
    v_bfe_u32 v14, v12, 4, 2
    v_lshl_add_u32 v13, v14, 3, v13
    v_and_b32 v14, 8, v12
    v_cmp_eq_u32 s[38:39], 0, v14
    v_cmp_ne_u32 s[40:41], 0, v14
    s_cmp_eq_u32 s14, 0
    s_cselect_b32 s10, 10240, 0
    buffer_load_dwordx2 v[16:17], v13, s[8:11], 0 offen
    buffer_load_dwordx2 v[18:19], v13, s[8:11], 0 offen offset:32
    s_waitcnt vmcnt(0)
    v_accvgpr_write_b32 a252, v16
    v_accvgpr_write_b32 a253, v17
    v_accvgpr_write_b32 a254, v18
    v_accvgpr_write_b32 a255, v19
    s_lshl_b32 s3, s18, 2
    s_add_u32 s3, s3, 64
    v_mov_b32 v92, s3
    v_lshlrev_b32 v94, 2, v0
    v_and_b32 v94, 28, v94
    s_mov_b32 s19, 0
L_R2_warr_2:
    global_load_dword v93, v92, s[16:17] sc1
    s_add_u32 s19, s19, 1
    s_cmp_ge_u32 s19, 524288
    s_cbranch_scc1 L_fail
    s_waitcnt vmcnt(0)
    v_cmp_gt_u32 vcc, 256, v93
    s_nop 0
    s_cbranch_vccnz L_R2_warr_2
    s_cmp_lg_u32 s18, 0
    s_cbranch_scc1 L_R2_placed_3
    global_load_dword v93, v94, s[16:17] sc1
    s_waitcnt vmcnt(0)
    v_cmp_ne_u32 vcc, 32, v93
    s_nop 0
    s_cbranch_vccnz L_fallback
L_R2_placed_3:
    v_lshlrev_b32 v0, 4, v0
    s_mov_b32 s20, 0
    s_barrier
    v_or_b32 v16, 1, v16
    s_lshl_b32 s60, s14, 15
    s_add_u32 s60, s60, 1179648
    s_mul_i32 s61, s14, 20480
    s_add_u32 s61, s61, 2621440
    s_mov_b64 exec, s[46:47]
    buffer_store_dwordx4 v[16:19], v9, s[4:7], s60 offen sc1
    buffer_store_dwordx4 v[16:19], v9, s[4:7], s61 offen sc1
    s_mov_b64 exec, -1
    s_waitcnt vmcnt(0)
    s_add_u32 s60, s20, 1
    s_and_b32 s22, s60, 1
    s_lshl_b32 s21, s22, 31
    s_sub_u32 s44, 0, s22
    s_bfe_u32 s23, s20, 0x10001
    s_sub_u32 s23, s23, 1
    s_lshr_b32 s24, s60, 1
    s_andn2_b32 s24, 1, s24
    s_lshl_b32 s61, s14, 15
    s_add_u32 s61, s61, 1179648
    s_and_b32 s25, s20, 1
    s_lshl_b32 s25, s25, 16
    s_add_u32 s25, s25, s61
    s_add_u32 s25, s25, 10240
    s_add_u32 s26, s25, 4096
    s_lshl_b32 s36, s22, 16
    s_add_u32 s36, s36, s61
    s_lshl_b32 s27, s20, 1
    s_add_u32 s37, s27, 2
    s_add_u32 s37, s37, s14
    s_mul_i32 s37, s37, 20480
    s_add_u32 s37, s37, 2621440
    s_add_u32 s27, s27, 1
    s_sub_u32 s27, s27, s14
    s_mul_i32 s27, s27, 20480
    s_add_u32 s27, s27, 2631680
    s_add_u32 s28, s27, 4096
    s_lshl_b32 s31, s20, 6
    s_add_u32 s31, s31, s13
    s_mul_i32 s31, s31, 6144
    s_add_u32 s31, s31, 5898240
    s_min_u32 s56, s20, 63
    s_lshl_b32 s56, s56, 6
    s_add_u32 s56, s56, s13
    s_mul_i32 s56, s56, 12288
    s_add_u32 s56, s56, 37361664
    s_max_u32 s57, s20, 5
    s_sub_u32 s57, s57, 5
    s_lshl_b32 s57, s57, 6
    s_add_u32 s57, s57, s13
    s_mul_i32 s57, s57, 12288
    s_add_u32 s57, s57, 87693312
    s_cmp_lt_u32 s20, 5
    s_cselect_b32 s57, s56, s57
    s_cmp_gt_u32 s60, 63
    s_cselect_b64 s[42:43], s[38:39], 0
    s_cmp_le_u32 s60, 5
    s_cselect_b64 vcc, s[40:41], 0
    s_or_b64 s[42:43], s[42:43], vcc
    s_cmp_lg_u32 s18, 0
    s_cbranch_scc1 L_R2_slow
L_Rf2_top:
    s_barrier
    buffer_load_dwordx4 v[10:13], v0, s[4:7], s25 offen offset:0 sc1
    buffer_load_dwordx4 v[14:17], v0, s[4:7], s25 offen offset:1024 sc1
    buffer_load_dwordx4 v[18:21], v0, s[4:7], s25 offen offset:2048 sc1
    buffer_load_dwordx4 v[22:25], v0, s[4:7], s25 offen offset:3072 sc1
    buffer_load_dwordx4 v[26:29], v0, s[4:7], s26 offen offset:0 sc1
    s_barrier
    buffer_load_dwordx4 v[46:49], v0, s[4:7], s27 offen offset:0 sc1
    buffer_load_dwordx4 v[30:33], v0, s[4:7], s27 offen offset:1024 sc1
    buffer_load_dwordx4 v[34:37], v0, s[4:7], s27 offen offset:2048 sc1
    buffer_load_dwordx4 v[38:41], v0, s[4:7], s27 offen offset:3072 sc1
    buffer_load_dwordx4 v[42:45], v0, s[4:7], s28 offen offset:0 sc1
    s_mov_b32 s19, 0
L_Rf2_gl_1:
    s_waitcnt vmcnt(9)
    v_mfma_f32_16x16x32_bf16 v[50:53], a[240:243], v[10:13], 0
    v_mfma_f32_16x16x32_bf16 v[54:57], a[244:247], v[10:13], 0
    v_xor_b32 v1, s23, v10
    s_waitcnt vmcnt(8)
    v_mfma_f32_16x16x32_bf16 v[58:61], a[240:243], v[14:17], 0
    v_mfma_f32_16x16x32_bf16 v[62:65], a[244:247], v[14:17], 0
    v_bitop3_b32 v1, v1, v14, s23 bitop3:0xf6
    s_waitcnt vmcnt(7)
    v_mfma_f32_16x16x32_bf16 v[66:69], a[240:243], v[18:21], 0
    v_mfma_f32_16x16x32_bf16 v[70:73], a[244:247], v[18:21], 0
    v_bitop3_b32 v1, v1, v18, s23 bitop3:0xf6
    s_waitcnt vmcnt(6)
    v_mfma_f32_16x16x32_bf16 v[74:77], a[240:243], v[22:25], 0
    v_mfma_f32_16x16x32_bf16 v[78:81], a[244:247], v[22:25], 0
    v_bitop3_b32 v1, v1, v22, s23 bitop3:0xf6
    s_waitcnt vmcnt(5)
    v_mfma_f32_16x16x32_bf16 v[82:85], a[240:243], v[26:29], 0
    v_mfma_f32_16x16x32_bf16 v[86:89], a[244:247], v[26:29], 0
    v_bitop3_b32 v1, v1, v26, s23 bitop3:0xf6
    v_and_b32 v1, 1, v1
    v_cmp_ne_u32 vcc, 0, v1
    s_nop 0
    s_cbranch_vccnz L_Rf2_glfix_3
L_Rf2_gr_2:
    s_waitcnt vmcnt(4)
    v_mfma_f32_16x16x32_bf16 v[50:53], a[240:243], v[46:49], v[50:53]
    v_xor_b32 v1, s23, v46
    v_mfma_f32_16x16x32_bf16 v[54:57], a[244:247], v[46:49], v[54:57]
    s_waitcnt vmcnt(3)
    v_mfma_f32_16x16x32_bf16 v[58:61], a[240:243], v[30:33], v[58:61]
    v_bitop3_b32 v1, v1, v30, s23 bitop3:0xf6
    v_mfma_f32_16x16x32_bf16 v[62:65], a[244:247], v[30:33], v[62:65]
    s_nop 1
    v_cvt_pk_bf16_f32 v90, v50, v51
    v_cvt_pk_bf16_f32 v91, v52, v53
    v_cvt_pk_bf16_f32 v92, v54, v55
    v_cvt_pk_bf16_f32 v93, v56, v57
    ds_write_b128 v0, v[90:93] offset:10240
    s_waitcnt vmcnt(2)
    v_mfma_f32_16x16x32_bf16 v[66:69], a[240:243], v[34:37], v[66:69]
    v_bitop3_b32 v1, v1, v34, s23 bitop3:0xf6
    v_mfma_f32_16x16x32_bf16 v[70:73], a[244:247], v[34:37], v[70:73]
    v_cvt_pk_bf16_f32 v90, v58, v59
    v_cvt_pk_bf16_f32 v91, v60, v61
    v_cvt_pk_bf16_f32 v92, v62, v63
    v_cvt_pk_bf16_f32 v93, v64, v65
    ds_write_b128 v0, v[90:93] offset:11264
    s_waitcnt vmcnt(1)
    v_mfma_f32_16x16x32_bf16 v[74:77], a[240:243], v[38:41], v[74:77]
    v_bitop3_b32 v1, v1, v38, s23 bitop3:0xf6
    v_mfma_f32_16x16x32_bf16 v[78:81], a[244:247], v[38:41], v[78:81]
    v_cvt_pk_bf16_f32 v90, v66, v67
    v_cvt_pk_bf16_f32 v91, v68, v69
    v_cvt_pk_bf16_f32 v92, v70, v71
    v_cvt_pk_bf16_f32 v93, v72, v73
    ds_write_b128 v0, v[90:93] offset:12288
    s_waitcnt vmcnt(0)
    v_mfma_f32_16x16x32_bf16 v[82:85], a[240:243], v[42:45], v[82:85]
    v_bitop3_b32 v1, v1, v42, s23 bitop3:0xf6
    v_mfma_f32_16x16x32_bf16 v[86:89], a[244:247], v[42:45], v[86:89]
    v_cvt_pk_bf16_f32 v90, v74, v75
    v_cvt_pk_bf16_f32 v91, v76, v77
    v_cvt_pk_bf16_f32 v92, v78, v79
    v_cvt_pk_bf16_f32 v93, v80, v81
    ds_write_b128 v0, v[90:93] offset:13312
    s_nop 0
    v_cvt_pk_bf16_f32 v90, v82, v83
    v_cvt_pk_bf16_f32 v91, v84, v85
    v_cvt_pk_bf16_f32 v92, v86, v87
    v_cvt_pk_bf16_f32 v93, v88, v89
    ds_write_b128 v0, v[90:93] offset:14336
    v_and_b32 v1, 1, v1
    v_cmp_ne_u32 vcc, 0, v1
    s_nop 0
    s_cbranch_vccnz L_Rf2_grfix_5
    s_waitcnt lgkmcnt(0)
    s_barrier
    ds_read_b128 v[10:13], v0 offset:0
    ds_read_b128 v[14:17], v0 offset:1024
    ds_read_b128 v[18:21], v0 offset:2048
    ds_read_b128 v[22:25], v0 offset:3072
    ds_read_b128 v[26:29], v0 offset:4096
    s_waitcnt lgkmcnt(4)
    v_mfma_f32_16x16x32_bf16 v[46:49], a[0:3], v[10:13], 0
    s_mov_b32 m0, 48128
    v_mfma_f32_16x16x32_bf16 v[50:53], a[80:83], v[10:13], 0
    v_mfma_f32_16x16x32_bf16 v[54:57], a[160:163], v[10:13], 0
    ds_read_b128 v[10:13], v0 offset:5120
    s_waitcnt lgkmcnt(4)
    v_mfma_f32_16x16x32_bf16 v[46:49], a[4:7], v[14:17], v[46:49]
    buffer_load_dwordx4 v0, s[4:7], s57 offen offset:0 sc1 lds
    v_mfma_f32_16x16x32_bf16 v[50:53], a[84:87], v[14:17], v[50:53]
    v_mfma_f32_16x16x32_bf16 v[54:57], a[164:167], v[14:17], v[54:57]
    ds_read_b128 v[14:17], v0 offset:6144
    s_waitcnt lgkmcnt(4)
    v_mfma_f32_16x16x32_bf16 v[46:49], a[8:11], v[18:21], v[46:49]
    buffer_load_dwordx4 v0, s[4:7], s57 offen offset:1024 sc1 lds
    v_mfma_f32_16x16x32_bf16 v[50:53], a[88:91], v[18:21], v[50:53]
    v_mfma_f32_16x16x32_bf16 v[54:57], a[168:171], v[18:21], v[54:57]
    ds_read_b128 v[18:21], v0 offset:7168
    s_waitcnt lgkmcnt(4)
    v_mfma_f32_16x16x32_bf16 v[46:49], a[12:15], v[22:25], v[46:49]
    buffer_load_dwordx4 v0, s[4:7], s57 offen offset:2048 sc1 lds
    v_mfma_f32_16x16x32_bf16 v[50:53], a[92:95], v[22:25], v[50:53]
    v_mfma_f32_16x16x32_bf16 v[54:57], a[172:175], v[22:25], v[54:57]
    ds_read_b128 v[22:25], v0 offset:8192
    s_waitcnt lgkmcnt(4)
    v_mfma_f32_16x16x32_bf16 v[46:49], a[16:19], v[26:29], v[46:49]
    v_mfma_f32_16x16x32_bf16 v[50:53], a[96:99], v[26:29], v[50:53]
    v_mfma_f32_16x16x32_bf16 v[54:57], a[176:179], v[26:29], v[54:57]
    ds_read_b128 v[26:29], v0 offset:9216
    s_waitcnt lgkmcnt(4)
    v_mfma_f32_16x16x32_bf16 v[46:49], a[20:23], v[10:13], v[46:49]
    v_mfma_f32_16x16x32_bf16 v[50:53], a[100:103], v[10:13], v[50:53]
    v_mfma_f32_16x16x32_bf16 v[54:57], a[180:183], v[10:13], v[54:57]
    ds_read_b128 v[10:13], v0 offset:10240
    s_waitcnt lgkmcnt(4)
    v_mfma_f32_16x16x32_bf16 v[46:49], a[24:27], v[14:17], v[46:49]
    v_mfma_f32_16x16x32_bf16 v[50:53], a[104:107], v[14:17], v[50:53]
    v_mfma_f32_16x16x32_bf16 v[54:57], a[184:187], v[14:17], v[54:57]
    ds_read_b128 v[14:17], v0 offset:11264
    s_waitcnt lgkmcnt(4)
    v_mfma_f32_16x16x32_bf16 v[46:49], a[28:31], v[18:21], v[46:49]
    v_mfma_f32_16x16x32_bf16 v[50:53], a[108:111], v[18:21], v[50:53]
    v_mfma_f32_16x16x32_bf16 v[54:57], a[188:191], v[18:21], v[54:57]
    ds_read_b128 v[18:21], v0 offset:12288
    s_waitcnt lgkmcnt(4)
    v_mfma_f32_16x16x32_bf16 v[46:49], a[32:35], v[22:25], v[46:49]
    v_mfma_f32_16x16x32_bf16 v[50:53], a[112:115], v[22:25], v[50:53]
    v_mfma_f32_16x16x32_bf16 v[54:57], a[192:195], v[22:25], v[54:57]
    ds_read_b128 v[22:25], v0 offset:13312
    s_waitcnt lgkmcnt(4)
    v_mfma_f32_16x16x32_bf16 v[46:49], a[36:39], v[26:29], v[46:49]
    v_mfma_f32_16x16x32_bf16 v[50:53], a[116:119], v[26:29], v[50:53]
    v_mfma_f32_16x16x32_bf16 v[54:57], a[196:199], v[26:29], v[54:57]
    ds_read_b128 v[26:29], v0 offset:14336
    s_waitcnt lgkmcnt(4)
    v_mfma_f32_16x16x32_bf16 v[46:49], a[40:43], v[10:13], v[46:49]
    v_mfma_f32_16x16x32_bf16 v[50:53], a[120:123], v[10:13], v[50:53]
    v_mfma_f32_16x16x32_bf16 v[54:57], a[200:203], v[10:13], v[54:57]
    ds_read_b128 v[10:13], v0 offset:15360
    s_waitcnt lgkmcnt(4)
    v_mfma_f32_16x16x32_bf16 v[46:49], a[44:47], v[14:17], v[46:49]
    v_mfma_f32_16x16x32_bf16 v[50:53], a[124:127], v[14:17], v[50:53]
    v_mfma_f32_16x16x32_bf16 v[54:57], a[204:207], v[14:17], v[54:57]
    ds_read_b128 v[14:17], v0 offset:16384
    s_waitcnt lgkmcnt(4)
    v_mfma_f32_16x16x32_bf16 v[46:49], a[48:51], v[18:21], v[46:49]
    v_mfma_f32_16x16x32_bf16 v[50:53], a[128:131], v[18:21], v[50:53]
    v_mfma_f32_16x16x32_bf16 v[54:57], a[208:211], v[18:21], v[54:57]
    ds_read_b128 v[18:21], v0 offset:17408
    s_waitcnt lgkmcnt(4)
    v_mfma_f32_16x16x32_bf16 v[46:49], a[52:55], v[22:25], v[46:49]
    v_mfma_f32_16x16x32_bf16 v[50:53], a[132:135], v[22:25], v[50:53]
    v_mfma_f32_16x16x32_bf16 v[54:57], a[212:215], v[22:25], v[54:57]
    ds_read_b128 v[22:25], v0 offset:18432
    s_waitcnt lgkmcnt(4)
    v_mfma_f32_16x16x32_bf16 v[46:49], a[56:59], v[26:29], v[46:49]
    v_mfma_f32_16x16x32_bf16 v[50:53], a[136:139], v[26:29], v[50:53]
    v_mfma_f32_16x16x32_bf16 v[54:57], a[216:219], v[26:29], v[54:57]
    ds_read_b128 v[26:29], v0 offset:19456
    s_waitcnt lgkmcnt(4)
    v_mfma_f32_16x16x32_bf16 v[46:49], a[60:63], v[10:13], v[46:49]
    v_mfma_f32_16x16x32_bf16 v[50:53], a[140:143], v[10:13], v[50:53]
    v_mfma_f32_16x16x32_bf16 v[54:57], a[220:223], v[10:13], v[54:57]
    ds_read_b128 v[10:13], v0 offset:0
    s_waitcnt lgkmcnt(4)
    v_mfma_f32_16x16x32_bf16 v[46:49], a[64:67], v[14:17], v[46:49]
    v_mfma_f32_16x16x32_bf16 v[50:53], a[144:147], v[14:17], v[50:53]
    v_mfma_f32_16x16x32_bf16 v[54:57], a[224:227], v[14:17], v[54:57]
    ds_read_b128 v[14:17], v0 offset:1024
    s_waitcnt lgkmcnt(4)
    v_mfma_f32_16x16x32_bf16 v[46:49], a[68:71], v[18:21], v[46:49]
    v_mfma_f32_16x16x32_bf16 v[50:53], a[148:151], v[18:21], v[50:53]
    v_mfma_f32_16x16x32_bf16 v[54:57], a[228:231], v[18:21], v[54:57]
    ds_read_b128 v[18:21], v0 offset:2048
    s_waitcnt lgkmcnt(4)
    v_mfma_f32_16x16x32_bf16 v[46:49], a[72:75], v[22:25], v[46:49]
    v_mfma_f32_16x16x32_bf16 v[50:53], a[152:155], v[22:25], v[50:53]
    v_mfma_f32_16x16x32_bf16 v[54:57], a[232:235], v[22:25], v[54:57]
    ds_read_b128 v[22:25], v0 offset:3072
    s_waitcnt lgkmcnt(4)
    v_mfma_f32_16x16x32_bf16 v[46:49], a[76:79], v[26:29], v[46:49]
    v_mfma_f32_16x16x32_bf16 v[50:53], a[156:159], v[26:29], v[50:53]
    v_mfma_f32_16x16x32_bf16 v[54:57], a[236:239], v[26:29], v[54:57]
    ds_read_b128 v[26:29], v0 offset:4096
    s_waitcnt lgkmcnt(4)
    v_mfma_f32_16x16x32_bf16 v[30:33], v[10:13], v[96:99], 0
    v_mfma_f32_16x16x32_bf16 v[34:37], v[10:13], v[176:179], 0
    ds_read_b128 v[10:13], v0 offset:5120
    s_nop 0
    v_cvt_pk_bf16_f32 v82, v46, v47
    v_cvt_pk_bf16_f32 v83, v48, v49
    ds_write_b64 v0, v[82:83] offset:23552
    v_cvt_pk_bf16_f32 v84, v50, v51
    v_cvt_pk_bf16_f32 v85, v52, v53
    ds_write_b64 v0, v[84:85] offset:23560
    v_cvt_pk_bf16_f32 v86, v54, v55
    v_cvt_pk_bf16_f32 v87, v56, v57
    ds_write_b64 v0, v[86:87] offset:24576
    s_waitcnt lgkmcnt(7)
    v_mfma_f32_16x16x32_bf16 v[30:33], v[14:17], v[100:103], v[30:33]
    v_mfma_f32_16x16x32_bf16 v[34:37], v[14:17], v[180:183], v[34:37]
    ds_read_b128 v[14:17], v0 offset:6144
    s_waitcnt lgkmcnt(1)
    s_barrier
    v_mfma_f32_16x16x32_bf16 v[30:33], v[18:21], v[104:107], v[30:33]
    v_mfma_f32_16x16x32_bf16 v[34:37], v[18:21], v[184:187], v[34:37]
    ds_read_b128 v[18:21], v0 offset:7168
    v_mfma_f32_16x16x32_bf16 v[30:33], v[22:25], v[108:111], v[30:33]
    v_mfma_f32_16x16x32_bf16 v[34:37], v[22:25], v[188:191], v[34:37]
    ds_read_b128 v[22:25], v0 offset:8192
    v_mfma_f32_16x16x32_bf16 v[30:33], v[26:29], v[112:115], v[30:33]
    v_mfma_f32_16x16x32_bf16 v[34:37], v[26:29], v[192:195], v[34:37]
    ds_read_b128 v[26:29], v0 offset:9216
    v_mfma_f32_16x16x32_bf16 v[30:33], v[10:13], v[116:119], v[30:33]
    v_mfma_f32_16x16x32_bf16 v[34:37], v[10:13], v[196:199], v[34:37]
    ds_read_b128 v[10:13], v0 offset:10240
    s_waitcnt lgkmcnt(4)
    v_mfma_f32_16x16x32_bf16 v[30:33], v[14:17], v[120:123], v[30:33]
    v_mfma_f32_16x16x32_bf16 v[34:37], v[14:17], v[200:203], v[34:37]
    ds_read_b128 v[14:17], v0 offset:11264
    s_waitcnt lgkmcnt(4)
    v_mfma_f32_16x16x32_bf16 v[30:33], v[18:21], v[124:127], v[30:33]
    v_mfma_f32_16x16x32_bf16 v[34:37], v[18:21], v[204:207], v[34:37]
    ds_read_b128 v[18:21], v0 offset:12288
    s_waitcnt lgkmcnt(4)
    v_mfma_f32_16x16x32_bf16 v[30:33], v[22:25], v[128:131], v[30:33]
    v_mfma_f32_16x16x32_bf16 v[34:37], v[22:25], v[208:211], v[34:37]
    ds_read_b128 v[22:25], v0 offset:13312
    s_waitcnt lgkmcnt(4)
    v_mfma_f32_16x16x32_bf16 v[30:33], v[26:29], v[132:135], v[30:33]
    v_mfma_f32_16x16x32_bf16 v[34:37], v[26:29], v[212:215], v[34:37]
    ds_read_b128 v[26:29], v0 offset:14336
    s_waitcnt lgkmcnt(4)
    v_mfma_f32_16x16x32_bf16 v[30:33], v[10:13], v[136:139], v[30:33]
    v_mfma_f32_16x16x32_bf16 v[34:37], v[10:13], v[216:219], v[34:37]
    ds_read_b128 v[10:13], v0 offset:15360
    s_waitcnt lgkmcnt(4)
    v_mfma_f32_16x16x32_bf16 v[30:33], v[14:17], v[140:143], v[30:33]
    v_mfma_f32_16x16x32_bf16 v[34:37], v[14:17], v[220:223], v[34:37]
    ds_read_b128 v[14:17], v0 offset:16384
    s_waitcnt lgkmcnt(4)
    v_mfma_f32_16x16x32_bf16 v[30:33], v[18:21], v[144:147], v[30:33]
    v_mfma_f32_16x16x32_bf16 v[34:37], v[18:21], v[224:227], v[34:37]
    ds_read_b128 v[18:21], v0 offset:17408
    s_waitcnt lgkmcnt(4)
    v_mfma_f32_16x16x32_bf16 v[30:33], v[22:25], v[148:151], v[30:33]
    v_mfma_f32_16x16x32_bf16 v[34:37], v[22:25], v[228:231], v[34:37]
    ds_read_b128 v[22:25], v0 offset:18432
    s_waitcnt lgkmcnt(4)
    v_mfma_f32_16x16x32_bf16 v[30:33], v[26:29], v[152:155], v[30:33]
    v_mfma_f32_16x16x32_bf16 v[34:37], v[26:29], v[232:235], v[34:37]
    ds_read_b128 v[26:29], v0 offset:19456
    s_waitcnt lgkmcnt(4)
    v_mfma_f32_16x16x32_bf16 v[30:33], v[10:13], v[156:159], v[30:33]
    v_mfma_f32_16x16x32_bf16 v[34:37], v[10:13], v[236:239], v[34:37]
    s_waitcnt lgkmcnt(3)
    v_mfma_f32_16x16x32_bf16 v[30:33], v[14:17], v[160:163], v[30:33]
    v_mfma_f32_16x16x32_bf16 v[34:37], v[14:17], v[240:243], v[34:37]
    s_waitcnt lgkmcnt(2)
    v_mfma_f32_16x16x32_bf16 v[30:33], v[18:21], v[164:167], v[30:33]
    v_mfma_f32_16x16x32_bf16 v[34:37], v[18:21], v[244:247], v[34:37]
    s_waitcnt lgkmcnt(1)
    v_mfma_f32_16x16x32_bf16 v[30:33], v[22:25], v[168:171], v[30:33]
    v_mfma_f32_16x16x32_bf16 v[34:37], v[22:25], v[248:251], v[34:37]
    s_waitcnt lgkmcnt(0)
    v_mfma_f32_16x16x32_bf16 v[30:33], v[26:29], v[172:175], v[30:33]
    v_mfma_f32_16x16x32_bf16 v[34:37], v[26:29], v[252:255], v[34:37]
    s_nop 6
    v_cvt_pk_bf16_f32 v88, v30, v31
    v_cvt_pk_bf16_f32 v89, v32, v33
    v_cvt_pk_bf16_f32 v90, v34, v35
    v_cvt_pk_bf16_f32 v91, v36, v37
    s_add_u32 s60, s31, 5120
    s_cmp_eq_u32 s20, 68
    s_cbranch_scc1 L_Rf2_tail
    s_waitcnt vmcnt(0) lgkmcnt(0)
    s_barrier
    ds_read_b128 v[10:13], v0 offset:26624
    ds_read_b128 v[14:17], v0 offset:27648
    ds_read_b128 v[18:21], v0 offset:28672
    ds_read_b128 v[58:61], v0 offset:39936
    ds_read_b128 v[62:65], v0 offset:40960
    ds_read_b128 v[66:69], v0 offset:52224
    ds_read_b128 v[70:73], v0 offset:53248
    buffer_store_dwordx4 v[88:91], v0, s[4:7], s60 offen sc1
    s_waitcnt lgkmcnt(5)
    v_max3_f32 v22, v10, v11, v12
    v_max3_f32 v23, v13, v14, v15
    v_max3_f32 v22, v22, v16, v17
    s_waitcnt lgkmcnt(4)
    v_max3_f32 v23, v23, v18, v19
    v_max3_f32 v22, v22, v20, v21
    v_max_f32 v22, v22, v23
    v_mov_b32 v23, v22
    ds_read_b128 v[30:33], v2 offset:0
    ds_read_b128 v[34:37], v2 offset:1024
    v_permlane32_swap_b32 v22, v23
    v_max_f32 v22, v22, v23
    v_mov_b32 v23, v22
    ds_read_b128 v[38:41], v2 offset:2048
    ds_read_b128 v[42:45], v2 offset:3072
    v_permlane16_swap_b32 v22, v23
    v_max_f32 v22, v22, v23
    v_pk_add_f32 v[10:11], v[10:11], v[22:23] op_sel_hi:[1,0] neg_lo:[0,1] neg_hi:[0,1]
    v_pk_add_f32 v[12:13], v[12:13], v[22:23] op_sel_hi:[1,0] neg_lo:[0,1] neg_hi:[0,1]
    v_pk_add_f32 v[14:15], v[14:15], v[22:23] op_sel_hi:[1,0] neg_lo:[0,1] neg_hi:[0,1]
    v_pk_add_f32 v[16:17], v[16:17], v[22:23] op_sel_hi:[1,0] neg_lo:[0,1] neg_hi:[0,1]
    v_pk_add_f32 v[18:19], v[18:19], v[22:23] op_sel_hi:[1,0] neg_lo:[0,1] neg_hi:[0,1]
    v_pk_add_f32 v[20:21], v[20:21], v[22:23] op_sel_hi:[1,0] neg_lo:[0,1] neg_hi:[0,1]
    v_exp_f32 v10, v10
    v_exp_f32 v11, v11
    v_exp_f32 v12, v12
    v_exp_f32 v13, v13
    v_exp_f32 v14, v14
    v_exp_f32 v15, v15
    v_cvt_pk_bf16_f32 v24, v10, v11
    v_cvt_pk_bf16_f32 v25, v12, v13
    v_exp_f32 v16, v16
    v_exp_f32 v17, v17
    v_mfma_f32_16x16x16_bf16 v[46:49], v[88:89], v[24:25], 0
    v_mfma_f32_16x16x16_bf16 v[82:85], v[90:91], v[24:25], 0
    v_exp_f32 v18, v18
    v_exp_f32 v19, v19
    v_exp_f32 v20, v20
    v_exp_f32 v21, v21
    v_cvt_pk_bf16_f32 v26, v14, v15
    v_cvt_pk_bf16_f32 v27, v16, v17
    v_cvt_pk_bf16_f32 v28, v18, v19
    v_cvt_pk_bf16_f32 v29, v20, v21
    v_pk_add_f32 v[22:23], v[10:11], v[12:13]
    v_pk_add_f32 v[14:15], v[14:15], v[16:17]
    s_waitcnt lgkmcnt(4)
    v_mfma_f32_16x16x32_bf16 v[50:53], v[58:61], v[26:29], v[46:49]
    v_pk_add_f32 v[18:19], v[18:19], v[20:21]
    v_mfma_f32_16x16x32_bf16 v[54:57], v[66:69], v[26:29], v[46:49]
    v_pk_add_f32 v[22:23], v[22:23], v[14:15]
    v_pk_add_f32 v[22:23], v[22:23], v[18:19]
    v_mfma_f32_16x16x32_bf16 v[10:13], v[62:65], v[26:29], v[82:85]
    v_add_f32 v22, v22, v23
    v_mfma_f32_16x16x32_bf16 v[14:17], v[70:73], v[26:29], v[82:85]
    v_mov_b32 v23, v22
    ds_read_b128 v[74:77], v2 offset:4096
    ds_read_b128 v[78:81], v2 offset:5120
    v_permlane32_swap_b32 v22, v23
    v_add_f32 v22, v22, v23
    v_mov_b32 v23, v22
    v_cndmask_b32 v50, v54, v50, s[48:49]
    v_cndmask_b32 v51, v55, v51, s[48:49]
    v_permlane16_swap_b32 v22, v23
    v_add_f32 v22, v22, v23
    v_rcp_f32 v22, v22
    v_cndmask_b32 v52, v56, v52, s[48:49]
    v_cndmask_b32 v53, v57, v53, s[48:49]
    v_cndmask_b32 v10, v14, v10, s[48:49]
    v_cndmask_b32 v11, v15, v11, s[48:49]
    v_cndmask_b32 v12, v16, v12, s[48:49]
    v_cndmask_b32 v13, v17, v13, s[48:49]
    v_pk_mul_f32 v[50:51], v[50:51], v[22:23] op_sel_hi:[1,0]
    v_pk_mul_f32 v[52:53], v[52:53], v[22:23] op_sel_hi:[1,0]
    v_cvt_pk_bf16_f32 v24, v50, v51
    v_cvt_pk_bf16_f32 v25, v52, v53
    v_pk_mul_f32 v[10:11], v[10:11], v[22:23] op_sel_hi:[1,0]
    v_pk_mul_f32 v[12:13], v[12:13], v[22:23] op_sel_hi:[1,0]
    v_cvt_pk_bf16_f32 v26, v10, v11
    v_cvt_pk_bf16_f32 v27, v12, v13
    ds_write_b128 v0, v[24:27] offset:2048
    s_waitcnt lgkmcnt(0)
    s_barrier
    ds_read_b128 v[10:13], v0 offset:0
    ds_read_b128 v[14:17], v0 offset:1024
    ds_read_b128 v[18:21], v0 offset:2048
    s_add_u32 s20, s20, 1
    s_waitcnt lgkmcnt(2)
    v_mfma_f32_16x16x32_bf16 v[46:49], v[30:33], v[10:13], 0
    ds_read_b128 v[30:33], v2 offset:6144
    s_waitcnt lgkmcnt(2)
    v_mfma_f32_16x16x32_bf16 v[46:49], v[34:37], v[14:17], v[46:49]
    ds_read_b128 v[34:37], v2 offset:7168
    s_waitcnt lgkmcnt(2)
    v_mfma_f32_16x16x32_bf16 v[46:49], v[38:41], v[18:21], v[46:49]
    ds_read_b128 v[38:41], v2 offset:8192
    v_mfma_f32_16x16x32_bf16 v[50:53], v[42:45], v[10:13], 0
    ds_read_b128 v[42:45], v2 offset:9216
    v_mfma_f32_16x16x32_bf16 v[50:53], v[74:77], v[14:17], v[50:53]
    ds_read_b128 v[74:77], v2 offset:10240
    v_mfma_f32_16x16x32_bf16 v[50:53], v[78:81], v[18:21], v[50:53]
    ds_read_b128 v[78:81], v2 offset:11264
    s_waitcnt lgkmcnt(3)
    v_mfma_f32_16x16x32_bf16 v[54:57], v[30:33], v[10:13], 0
    ds_read_b128 v[30:33], v2 offset:12288
    v_cvt_pk_bf16_f32 v62, v46, v47
    v_mfma_f32_16x16x32_bf16 v[54:57], v[34:37], v[14:17], v[54:57]
    ds_read_b128 v[34:37], v2 offset:13312
    v_cvt_pk_bf16_f32 v63, v48, v49
    v_and_or_b32 v62, v62, -2, s22
    v_mfma_f32_16x16x32_bf16 v[54:57], v[38:41], v[18:21], v[54:57]
    ds_read_b128 v[38:41], v2 offset:14336
    v_cvt_pk_bf16_f32 v64, v50, v51
    s_waitcnt lgkmcnt(3)
    v_mfma_f32_16x16x32_bf16 v[58:61], v[42:45], v[10:13], 0
    ds_read_b128 v[42:45], v2 offset:15360
    v_cvt_pk_bf16_f32 v65, v52, v53
    v_mfma_f32_16x16x32_bf16 v[58:61], v[74:77], v[14:17], v[58:61]
    ds_read_b128 v[74:77], v2 offset:16384
    v_mfma_f32_16x16x32_bf16 v[58:61], v[78:81], v[18:21], v[58:61]
    ds_read_b128 v[78:81], v2 offset:17408
    buffer_store_dwordx4 v[62:65], v3, s[4:7], s32 offen
    s_waitcnt lgkmcnt(3)
    v_mfma_f32_16x16x32_bf16 v[46:49], v[30:33], v[10:13], 0
    ds_read_b128 v[30:33], v2 offset:18432
    v_cvt_pk_bf16_f32 v66, v54, v55
    v_mfma_f32_16x16x32_bf16 v[46:49], v[34:37], v[14:17], v[46:49]
    ds_read_b128 v[34:37], v2 offset:19456
    v_cvt_pk_bf16_f32 v67, v56, v57
    v_and_or_b32 v66, v66, -2, s22
    v_mfma_f32_16x16x32_bf16 v[46:49], v[38:41], v[18:21], v[46:49]
    ds_read_b128 v[38:41], v2 offset:20480
    v_cvt_pk_bf16_f32 v68, v58, v59
    s_waitcnt lgkmcnt(3)
    v_mfma_f32_16x16x32_bf16 v[50:53], v[42:45], v[10:13], 0
    ds_read_b128 v[42:45], v2 offset:21504
    v_cvt_pk_bf16_f32 v69, v60, v61
    v_mfma_f32_16x16x32_bf16 v[50:53], v[74:77], v[14:17], v[50:53]
    ds_read_b128 v[74:77], v2 offset:22528
    v_mfma_f32_16x16x32_bf16 v[50:53], v[78:81], v[18:21], v[50:53]
    ds_read_b128 v[78:81], v2 offset:23552
    buffer_store_dwordx4 v[66:69], v4, s[4:7], s32 offen
    s_waitcnt lgkmcnt(3)
    v_mfma_f32_16x16x32_bf16 v[54:57], v[30:33], v[10:13], 0
    ds_read_b128 v[30:33], v2 offset:24576
    v_cvt_pk_bf16_f32 v62, v46, v47
    v_mfma_f32_16x16x32_bf16 v[54:57], v[34:37], v[14:17], v[54:57]
    ds_read_b128 v[34:37], v2 offset:25600
    v_cvt_pk_bf16_f32 v63, v48, v49
    v_and_or_b32 v62, v62, -2, s22
    v_mfma_f32_16x16x32_bf16 v[54:57], v[38:41], v[18:21], v[54:57]
    ds_read_b128 v[38:41], v2 offset:26624
    v_cvt_pk_bf16_f32 v64, v50, v51
    s_waitcnt lgkmcnt(3)
    v_mfma_f32_16x16x32_bf16 v[58:61], v[42:45], v[10:13], 0
    ds_read_b128 v[42:45], v2 offset:27648
    v_cvt_pk_bf16_f32 v65, v52, v53
    v_mfma_f32_16x16x32_bf16 v[58:61], v[74:77], v[14:17], v[58:61]
    ds_read_b128 v[74:77], v2 offset:28672
    v_mfma_f32_16x16x32_bf16 v[58:61], v[78:81], v[18:21], v[58:61]
    ds_read_b128 v[78:81], v2 offset:29696
    buffer_store_dwordx4 v[62:65], v5, s[4:7], s32 offen
    s_waitcnt lgkmcnt(3)
    v_mfma_f32_16x16x32_bf16 v[46:49], v[30:33], v[10:13], 0
    v_cvt_pk_bf16_f32 v66, v54, v55
    v_mfma_f32_16x16x32_bf16 v[46:49], v[34:37], v[14:17], v[46:49]
    v_cvt_pk_bf16_f32 v67, v56, v57
    v_and_or_b32 v66, v66, -2, s22
    v_mfma_f32_16x16x32_bf16 v[46:49], v[38:41], v[18:21], v[46:49]
    v_cvt_pk_bf16_f32 v68, v58, v59
    s_waitcnt lgkmcnt(0)
    v_mfma_f32_16x16x32_bf16 v[50:53], v[42:45], v[10:13], 0
    v_cvt_pk_bf16_f32 v69, v60, v61
    v_mfma_f32_16x16x32_bf16 v[50:53], v[74:77], v[14:17], v[50:53]
    v_mfma_f32_16x16x32_bf16 v[50:53], v[78:81], v[18:21], v[50:53]
    buffer_store_dwordx4 v[66:69], v6, s[4:7], s32 offen
    s_nop 0
    v_cvt_pk_bf16_f32 v62, v46, v47
    v_cvt_pk_bf16_f32 v63, v48, v49
    v_and_or_b32 v62, v62, -2, s22
    s_nop 2
    v_cvt_pk_bf16_f32 v64, v50, v51
    v_cvt_pk_bf16_f32 v65, v52, v53
    buffer_store_dwordx4 v[62:65], v7, s[4:7], s32 offen
    v_accvgpr_read_b32 v78, a252
    v_accvgpr_read_b32 v79, a253
    v_accvgpr_read_b32 v80, a254
    v_accvgpr_read_b32 v81, a255
    s_mov_b32 s19, 0
    s_waitcnt vmcnt(0)
    buffer_load_dwordx4 v[26:29], v8, s[4:7], s32 offen sc1
    buffer_load_dwordx4 v[30:33], v8, s[4:7], s33 offen sc1
    buffer_load_dwordx4 v[34:37], v8, s[4:7], s34 offen sc1
    buffer_load_dwordx4 v[38:41], v8, s[4:7], s35 offen sc1
L_Rf2_hb_6:
    s_waitcnt vmcnt(3)
    v_mfma_f32_16x16x32_bf16 v[70:73], a[248:251], v[26:29], 0
    v_xor_b32 v1, s44, v26
    s_waitcnt vmcnt(2)
    v_mfma_f32_16x16x32_bf16 v[70:73], a[248:251], v[30:33], v[70:73]
    v_bitop3_b32 v1, v1, v30, s44 bitop3:0xf6
    s_waitcnt vmcnt(1)
    v_mfma_f32_16x16x32_bf16 v[70:73], a[248:251], v[34:37], v[70:73]
    v_bitop3_b32 v1, v1, v34, s44 bitop3:0xf6
    s_waitcnt vmcnt(0)
    v_mfma_f32_16x16x32_bf16 v[70:73], a[248:251], v[38:41], v[70:73]
    v_bitop3_b32 v1, v1, v38, s44 bitop3:0xf6
    v_and_b32 v1, 1, v1
    v_cmp_ne_u32 vcc, 0, v1
    s_nop 0
    s_cbranch_vccnz L_Rf2_hbfix_7
    s_nop 2
    v_add_f32_dpp v70, v70, v70 row_ror:8 row_mask:0xf bank_mask:0xf
    v_add_f32_dpp v71, v71, v71 row_ror:8 row_mask:0xf bank_mask:0xf
    v_add_f32_dpp v72, v72, v72 row_ror:8 row_mask:0xf bank_mask:0xf
    v_add_f32_dpp v73, v73, v73 row_ror:8 row_mask:0xf bank_mask:0xf
    v_cvt_pk_bf16_f32 v74, v70, v71
    v_cvt_pk_bf16_f32 v75, v72, v73
    v_mov_b32 v76, v74
    v_mov_b32 v77, v75
    s_nop 0
    v_permlane16_swap_b32 v74, v76
    v_permlane16_swap_b32 v75, v77
    v_cndmask_b32 v74, v74, v78, s[42:43]
    v_cndmask_b32 v75, v75, v79, s[42:43]
    v_cndmask_b32 v76, v76, v80, s[42:43]
    v_cndmask_b32 v77, v77, v81, s[42:43]
    v_and_or_b32 v74, v74, -2, s24
    s_mov_b64 exec, s[46:47]
    buffer_store_dwordx4 v[74:77], v9, s[4:7], s36 offen
    buffer_store_dwordx4 v[74:77], v9, s[4:7], s37 offen sc1
    s_mov_b64 exec, -1
    s_add_u32 s60, s20, 1
    s_and_b32 s22, s60, 1
    s_lshl_b32 s21, s22, 31
    s_sub_u32 s44, 0, s22
    s_bfe_u32 s23, s20, 0x10001
    s_sub_u32 s23, s23, 1
    s_lshr_b32 s24, s60, 1
    s_andn2_b32 s24, 1, s24
    s_lshl_b32 s61, s14, 15
    s_add_u32 s61, s61, 1179648
    s_and_b32 s25, s20, 1
    s_lshl_b32 s25, s25, 16
    s_add_u32 s25, s25, s61
    s_add_u32 s25, s25, 10240
    s_add_u32 s26, s25, 4096
    s_lshl_b32 s36, s22, 16
    s_add_u32 s36, s36, s61
    s_lshl_b32 s27, s20, 1
    s_add_u32 s37, s27, 2
    s_add_u32 s37, s37, s14
    s_mul_i32 s37, s37, 20480
    s_add_u32 s37, s37, 2621440
    s_add_u32 s27, s27, 1
    s_sub_u32 s27, s27, s14
    s_mul_i32 s27, s27, 20480
    s_add_u32 s27, s27, 2631680
    s_add_u32 s28, s27, 4096
    s_lshl_b32 s31, s20, 6
    s_add_u32 s31, s31, s13
    s_mul_i32 s31, s31, 6144
    s_add_u32 s31, s31, 5898240
    s_min_u32 s56, s20, 63
    s_lshl_b32 s56, s56, 6
    s_add_u32 s56, s56, s13
    s_mul_i32 s56, s56, 12288
    s_add_u32 s56, s56, 37361664
    s_max_u32 s57, s20, 5
    s_sub_u32 s57, s57, 5
    s_lshl_b32 s57, s57, 6
    s_add_u32 s57, s57, s13
    s_mul_i32 s57, s57, 12288
    s_add_u32 s57, s57, 87693312
    s_cmp_lt_u32 s20, 5
    s_cselect_b32 s57, s56, s57
    s_cmp_gt_u32 s60, 63
    s_cselect_b64 s[42:43], s[38:39], 0
    s_cmp_le_u32 s60, 5
    s_cselect_b64 vcc, s[40:41], 0
    s_or_b64 s[42:43], s[42:43], vcc
    s_waitcnt vmcnt(1)
    s_branch L_Rf2_top
L_Rf2_tail:
    s_waitcnt lgkmcnt(0)
    buffer_store_dwordx4 v[88:91], v0, s[4:7], s60 offen sc1
    s_waitcnt vmcnt(0) lgkmcnt(0)
    s_barrier
    v_mov_b32 v22, 69
    s_mov_b64 exec, 1
    s_mov_b64 exec, -1
    s_waitcnt vmcnt(0)
    s_endpgm
L_Rf2_glfix_3:
    buffer_load_dwordx4 v[10:13], v0, s[4:7], s25 offen offset:0 sc1
    buffer_load_dwordx4 v[14:17], v0, s[4:7], s25 offen offset:1024 sc1
    buffer_load_dwordx4 v[18:21], v0, s[4:7], s25 offen offset:2048 sc1
    buffer_load_dwordx4 v[22:25], v0, s[4:7], s25 offen offset:3072 sc1
    buffer_load_dwordx4 v[26:29], v0, s[4:7], s26 offen offset:0 sc1
    buffer_load_dwordx4 v[46:49], v0, s[4:7], s27 offen offset:0 sc1
    buffer_load_dwordx4 v[30:33], v0, s[4:7], s27 offen offset:1024 sc1
    buffer_load_dwordx4 v[34:37], v0, s[4:7], s27 offen offset:2048 sc1
    buffer_load_dwordx4 v[38:41], v0, s[4:7], s27 offen offset:3072 sc1
    buffer_load_dwordx4 v[42:45], v0, s[4:7], s28 offen offset:0 sc1
    s_add_u32 s19, s19, 1
    s_cmp_lt_u32 s19, 524288
    s_cbranch_scc1 L_Rf2_gl_1
    s_branch L_fail
L_Rf2_grfix_5:
    buffer_load_dwordx4 v[46:49], v0, s[4:7], s27 offen offset:0 sc1
    buffer_load_dwordx4 v[30:33], v0, s[4:7], s27 offen offset:1024 sc1
    buffer_load_dwordx4 v[34:37], v0, s[4:7], s27 offen offset:2048 sc1
    buffer_load_dwordx4 v[38:41], v0, s[4:7], s27 offen offset:3072 sc1
    buffer_load_dwordx4 v[42:45], v0, s[4:7], s28 offen offset:0 sc1
    s_add_u32 s19, s19, 1
    s_cmp_lt_u32 s19, 524288
    s_cbranch_scc1 L_Rf2_gr2_4
    s_branch L_fail
L_Rf2_gr2_4:
    v_mfma_f32_16x16x32_bf16 v[50:53], a[240:243], v[10:13], 0
    v_mfma_f32_16x16x32_bf16 v[54:57], a[244:247], v[10:13], 0
    v_mfma_f32_16x16x32_bf16 v[58:61], a[240:243], v[14:17], 0
    v_mfma_f32_16x16x32_bf16 v[62:65], a[244:247], v[14:17], 0
    v_mfma_f32_16x16x32_bf16 v[66:69], a[240:243], v[18:21], 0
    v_mfma_f32_16x16x32_bf16 v[70:73], a[244:247], v[18:21], 0
    v_mfma_f32_16x16x32_bf16 v[74:77], a[240:243], v[22:25], 0
    v_mfma_f32_16x16x32_bf16 v[78:81], a[244:247], v[22:25], 0
    v_mfma_f32_16x16x32_bf16 v[82:85], a[240:243], v[26:29], 0
    v_mfma_f32_16x16x32_bf16 v[86:89], a[244:247], v[26:29], 0
    s_branch L_Rf2_gr_2
L_Rf2_hbfix_7:
    buffer_load_dwordx4 v[26:29], v8, s[4:7], s32 offen sc1
    buffer_load_dwordx4 v[30:33], v8, s[4:7], s33 offen sc1
    buffer_load_dwordx4 v[34:37], v8, s[4:7], s34 offen sc1
    buffer_load_dwordx4 v[38:41], v8, s[4:7], s35 offen sc1
    s_add_u32 s19, s19, 1
    s_cmp_lt_u32 s19, 524288
    s_cbranch_scc1 L_Rf2_hb_6
    s_branch L_fail
L_R2_slow:
L_Rs2_top:
    s_barrier
    buffer_load_dwordx4 v[10:13], v0, s[4:7], s25 offen offset:0 sc1
    buffer_load_dwordx4 v[14:17], v0, s[4:7], s25 offen offset:1024 sc1
    buffer_load_dwordx4 v[18:21], v0, s[4:7], s25 offen offset:2048 sc1
    buffer_load_dwordx4 v[22:25], v0, s[4:7], s25 offen offset:3072 sc1
    buffer_load_dwordx4 v[26:29], v0, s[4:7], s26 offen offset:0 sc1
    s_barrier
    buffer_load_dwordx4 v[46:49], v0, s[4:7], s27 offen offset:0 sc1
    buffer_load_dwordx4 v[30:33], v0, s[4:7], s27 offen offset:1024 sc1
    buffer_load_dwordx4 v[34:37], v0, s[4:7], s27 offen offset:2048 sc1
    buffer_load_dwordx4 v[38:41], v0, s[4:7], s27 offen offset:3072 sc1
    buffer_load_dwordx4 v[42:45], v0, s[4:7], s28 offen offset:0 sc1
    s_mov_b32 s19, 0
L_Rs2_gl_1:
    s_waitcnt vmcnt(9)
    v_mfma_f32_16x16x32_bf16 v[50:53], a[240:243], v[10:13], 0
    v_mfma_f32_16x16x32_bf16 v[54:57], a[244:247], v[10:13], 0
    v_xor_b32 v1, s23, v10
    s_waitcnt vmcnt(8)
    v_mfma_f32_16x16x32_bf16 v[58:61], a[240:243], v[14:17], 0
    v_mfma_f32_16x16x32_bf16 v[62:65], a[244:247], v[14:17], 0
    v_bitop3_b32 v1, v1, v14, s23 bitop3:0xf6
    s_waitcnt vmcnt(7)
    v_mfma_f32_16x16x32_bf16 v[66:69], a[240:243], v[18:21], 0
    v_mfma_f32_16x16x32_bf16 v[70:73], a[244:247], v[18:21], 0
    v_bitop3_b32 v1, v1, v18, s23 bitop3:0xf6
    s_waitcnt vmcnt(6)
    v_mfma_f32_16x16x32_bf16 v[74:77], a[240:243], v[22:25], 0
    v_mfma_f32_16x16x32_bf16 v[78:81], a[244:247], v[22:25], 0
    v_bitop3_b32 v1, v1, v22, s23 bitop3:0xf6
    s_waitcnt vmcnt(5)
    v_mfma_f32_16x16x32_bf16 v[82:85], a[240:243], v[26:29], 0
    v_mfma_f32_16x16x32_bf16 v[86:89], a[244:247], v[26:29], 0
    v_bitop3_b32 v1, v1, v26, s23 bitop3:0xf6
    v_and_b32 v1, 1, v1
    v_cmp_ne_u32 vcc, 0, v1
    s_nop 0
    s_cbranch_vccnz L_Rs2_glfix_3
L_Rs2_gr_2:
    s_waitcnt vmcnt(4)
    v_mfma_f32_16x16x32_bf16 v[50:53], a[240:243], v[46:49], v[50:53]
    v_xor_b32 v1, s23, v46
    v_mfma_f32_16x16x32_bf16 v[54:57], a[244:247], v[46:49], v[54:57]
    s_waitcnt vmcnt(3)
    v_mfma_f32_16x16x32_bf16 v[58:61], a[240:243], v[30:33], v[58:61]
    v_bitop3_b32 v1, v1, v30, s23 bitop3:0xf6
    v_mfma_f32_16x16x32_bf16 v[62:65], a[244:247], v[30:33], v[62:65]
    s_nop 1
    v_cvt_pk_bf16_f32 v90, v50, v51
    v_cvt_pk_bf16_f32 v91, v52, v53
    v_cvt_pk_bf16_f32 v92, v54, v55
    v_cvt_pk_bf16_f32 v93, v56, v57
    ds_write_b128 v0, v[90:93] offset:10240
    s_waitcnt vmcnt(2)
    v_mfma_f32_16x16x32_bf16 v[66:69], a[240:243], v[34:37], v[66:69]
    v_bitop3_b32 v1, v1, v34, s23 bitop3:0xf6
    v_mfma_f32_16x16x32_bf16 v[70:73], a[244:247], v[34:37], v[70:73]
    v_cvt_pk_bf16_f32 v90, v58, v59
    v_cvt_pk_bf16_f32 v91, v60, v61
    v_cvt_pk_bf16_f32 v92, v62, v63
    v_cvt_pk_bf16_f32 v93, v64, v65
    ds_write_b128 v0, v[90:93] offset:11264
    s_waitcnt vmcnt(1)
    v_mfma_f32_16x16x32_bf16 v[74:77], a[240:243], v[38:41], v[74:77]
    v_bitop3_b32 v1, v1, v38, s23 bitop3:0xf6
    v_mfma_f32_16x16x32_bf16 v[78:81], a[244:247], v[38:41], v[78:81]
    v_cvt_pk_bf16_f32 v90, v66, v67
    v_cvt_pk_bf16_f32 v91, v68, v69
    v_cvt_pk_bf16_f32 v92, v70, v71
    v_cvt_pk_bf16_f32 v93, v72, v73
    ds_write_b128 v0, v[90:93] offset:12288
    s_waitcnt vmcnt(0)
    v_mfma_f32_16x16x32_bf16 v[82:85], a[240:243], v[42:45], v[82:85]
    v_bitop3_b32 v1, v1, v42, s23 bitop3:0xf6
    v_mfma_f32_16x16x32_bf16 v[86:89], a[244:247], v[42:45], v[86:89]
    v_cvt_pk_bf16_f32 v90, v74, v75
    v_cvt_pk_bf16_f32 v91, v76, v77
    v_cvt_pk_bf16_f32 v92, v78, v79
    v_cvt_pk_bf16_f32 v93, v80, v81
    ds_write_b128 v0, v[90:93] offset:13312
    s_nop 0
    v_cvt_pk_bf16_f32 v90, v82, v83
    v_cvt_pk_bf16_f32 v91, v84, v85
    v_cvt_pk_bf16_f32 v92, v86, v87
    v_cvt_pk_bf16_f32 v93, v88, v89
    ds_write_b128 v0, v[90:93] offset:14336
    v_and_b32 v1, 1, v1
    v_cmp_ne_u32 vcc, 0, v1
    s_nop 0
    s_cbranch_vccnz L_Rs2_grfix_5
    s_waitcnt lgkmcnt(0)
    s_barrier
    ds_read_b128 v[10:13], v0 offset:0
    ds_read_b128 v[14:17], v0 offset:1024
    ds_read_b128 v[18:21], v0 offset:2048
    ds_read_b128 v[22:25], v0 offset:3072
    ds_read_b128 v[26:29], v0 offset:4096
    s_waitcnt lgkmcnt(4)
    v_mfma_f32_16x16x32_bf16 v[46:49], a[0:3], v[10:13], 0
    s_mov_b32 m0, 48128
    v_mfma_f32_16x16x32_bf16 v[50:53], a[80:83], v[10:13], 0
    v_mfma_f32_16x16x32_bf16 v[54:57], a[160:163], v[10:13], 0
    ds_read_b128 v[10:13], v0 offset:5120
    s_waitcnt lgkmcnt(4)
    v_mfma_f32_16x16x32_bf16 v[46:49], a[4:7], v[14:17], v[46:49]
    buffer_load_dwordx4 v0, s[4:7], s57 offen offset:0 sc1 lds
    v_mfma_f32_16x16x32_bf16 v[50:53], a[84:87], v[14:17], v[50:53]
    v_mfma_f32_16x16x32_bf16 v[54:57], a[164:167], v[14:17], v[54:57]
    ds_read_b128 v[14:17], v0 offset:6144
    s_waitcnt lgkmcnt(4)
    v_mfma_f32_16x16x32_bf16 v[46:49], a[8:11], v[18:21], v[46:49]
    buffer_load_dwordx4 v0, s[4:7], s57 offen offset:1024 sc1 lds
    v_mfma_f32_16x16x32_bf16 v[50:53], a[88:91], v[18:21], v[50:53]
    v_mfma_f32_16x16x32_bf16 v[54:57], a[168:171], v[18:21], v[54:57]
    ds_read_b128 v[18:21], v0 offset:7168
    s_waitcnt lgkmcnt(4)
    v_mfma_f32_16x16x32_bf16 v[46:49], a[12:15], v[22:25], v[46:49]
    buffer_load_dwordx4 v0, s[4:7], s57 offen offset:2048 sc1 lds
    v_mfma_f32_16x16x32_bf16 v[50:53], a[92:95], v[22:25], v[50:53]
    v_mfma_f32_16x16x32_bf16 v[54:57], a[172:175], v[22:25], v[54:57]
    ds_read_b128 v[22:25], v0 offset:8192
    s_waitcnt lgkmcnt(4)
    v_mfma_f32_16x16x32_bf16 v[46:49], a[16:19], v[26:29], v[46:49]
    v_mfma_f32_16x16x32_bf16 v[50:53], a[96:99], v[26:29], v[50:53]
    v_mfma_f32_16x16x32_bf16 v[54:57], a[176:179], v[26:29], v[54:57]
    ds_read_b128 v[26:29], v0 offset:9216
    s_waitcnt lgkmcnt(4)
    v_mfma_f32_16x16x32_bf16 v[46:49], a[20:23], v[10:13], v[46:49]
    v_mfma_f32_16x16x32_bf16 v[50:53], a[100:103], v[10:13], v[50:53]
    v_mfma_f32_16x16x32_bf16 v[54:57], a[180:183], v[10:13], v[54:57]
    ds_read_b128 v[10:13], v0 offset:10240
    s_waitcnt lgkmcnt(4)
    v_mfma_f32_16x16x32_bf16 v[46:49], a[24:27], v[14:17], v[46:49]
    v_mfma_f32_16x16x32_bf16 v[50:53], a[104:107], v[14:17], v[50:53]
    v_mfma_f32_16x16x32_bf16 v[54:57], a[184:187], v[14:17], v[54:57]
    ds_read_b128 v[14:17], v0 offset:11264
    s_waitcnt lgkmcnt(4)
    v_mfma_f32_16x16x32_bf16 v[46:49], a[28:31], v[18:21], v[46:49]
    v_mfma_f32_16x16x32_bf16 v[50:53], a[108:111], v[18:21], v[50:53]
    v_mfma_f32_16x16x32_bf16 v[54:57], a[188:191], v[18:21], v[54:57]
    ds_read_b128 v[18:21], v0 offset:12288
    s_waitcnt lgkmcnt(4)
    v_mfma_f32_16x16x32_bf16 v[46:49], a[32:35], v[22:25], v[46:49]
    v_mfma_f32_16x16x32_bf16 v[50:53], a[112:115], v[22:25], v[50:53]
    v_mfma_f32_16x16x32_bf16 v[54:57], a[192:195], v[22:25], v[54:57]
    ds_read_b128 v[22:25], v0 offset:13312
    s_waitcnt lgkmcnt(4)
    v_mfma_f32_16x16x32_bf16 v[46:49], a[36:39], v[26:29], v[46:49]
    v_mfma_f32_16x16x32_bf16 v[50:53], a[116:119], v[26:29], v[50:53]
    v_mfma_f32_16x16x32_bf16 v[54:57], a[196:199], v[26:29], v[54:57]
    ds_read_b128 v[26:29], v0 offset:14336
    s_waitcnt lgkmcnt(4)
    v_mfma_f32_16x16x32_bf16 v[46:49], a[40:43], v[10:13], v[46:49]
    v_mfma_f32_16x16x32_bf16 v[50:53], a[120:123], v[10:13], v[50:53]
    v_mfma_f32_16x16x32_bf16 v[54:57], a[200:203], v[10:13], v[54:57]
    ds_read_b128 v[10:13], v0 offset:15360
    s_waitcnt lgkmcnt(4)
    v_mfma_f32_16x16x32_bf16 v[46:49], a[44:47], v[14:17], v[46:49]
    v_mfma_f32_16x16x32_bf16 v[50:53], a[124:127], v[14:17], v[50:53]
    v_mfma_f32_16x16x32_bf16 v[54:57], a[204:207], v[14:17], v[54:57]
    ds_read_b128 v[14:17], v0 offset:16384
    s_waitcnt lgkmcnt(4)
    v_mfma_f32_16x16x32_bf16 v[46:49], a[48:51], v[18:21], v[46:49]
    v_mfma_f32_16x16x32_bf16 v[50:53], a[128:131], v[18:21], v[50:53]
    v_mfma_f32_16x16x32_bf16 v[54:57], a[208:211], v[18:21], v[54:57]
    ds_read_b128 v[18:21], v0 offset:17408
    s_waitcnt lgkmcnt(4)
    v_mfma_f32_16x16x32_bf16 v[46:49], a[52:55], v[22:25], v[46:49]
    v_mfma_f32_16x16x32_bf16 v[50:53], a[132:135], v[22:25], v[50:53]
    v_mfma_f32_16x16x32_bf16 v[54:57], a[212:215], v[22:25], v[54:57]
    ds_read_b128 v[22:25], v0 offset:18432
    s_waitcnt lgkmcnt(4)
    v_mfma_f32_16x16x32_bf16 v[46:49], a[56:59], v[26:29], v[46:49]
    v_mfma_f32_16x16x32_bf16 v[50:53], a[136:139], v[26:29], v[50:53]
    v_mfma_f32_16x16x32_bf16 v[54:57], a[216:219], v[26:29], v[54:57]
    ds_read_b128 v[26:29], v0 offset:19456
    s_waitcnt lgkmcnt(4)
    v_mfma_f32_16x16x32_bf16 v[46:49], a[60:63], v[10:13], v[46:49]
    v_mfma_f32_16x16x32_bf16 v[50:53], a[140:143], v[10:13], v[50:53]
    v_mfma_f32_16x16x32_bf16 v[54:57], a[220:223], v[10:13], v[54:57]
    ds_read_b128 v[10:13], v0 offset:0
    s_waitcnt lgkmcnt(4)
    v_mfma_f32_16x16x32_bf16 v[46:49], a[64:67], v[14:17], v[46:49]
    v_mfma_f32_16x16x32_bf16 v[50:53], a[144:147], v[14:17], v[50:53]
    v_mfma_f32_16x16x32_bf16 v[54:57], a[224:227], v[14:17], v[54:57]
    ds_read_b128 v[14:17], v0 offset:1024
    s_waitcnt lgkmcnt(4)
    v_mfma_f32_16x16x32_bf16 v[46:49], a[68:71], v[18:21], v[46:49]
    v_mfma_f32_16x16x32_bf16 v[50:53], a[148:151], v[18:21], v[50:53]
    v_mfma_f32_16x16x32_bf16 v[54:57], a[228:231], v[18:21], v[54:57]
    ds_read_b128 v[18:21], v0 offset:2048
    s_waitcnt lgkmcnt(4)
    v_mfma_f32_16x16x32_bf16 v[46:49], a[72:75], v[22:25], v[46:49]
    v_mfma_f32_16x16x32_bf16 v[50:53], a[152:155], v[22:25], v[50:53]
    v_mfma_f32_16x16x32_bf16 v[54:57], a[232:235], v[22:25], v[54:57]
    ds_read_b128 v[22:25], v0 offset:3072
    s_waitcnt lgkmcnt(4)
    v_mfma_f32_16x16x32_bf16 v[46:49], a[76:79], v[26:29], v[46:49]
    v_mfma_f32_16x16x32_bf16 v[50:53], a[156:159], v[26:29], v[50:53]
    v_mfma_f32_16x16x32_bf16 v[54:57], a[236:239], v[26:29], v[54:57]
    ds_read_b128 v[26:29], v0 offset:4096
    s_waitcnt lgkmcnt(4)
    v_mfma_f32_16x16x32_bf16 v[30:33], v[10:13], v[96:99], 0
    v_mfma_f32_16x16x32_bf16 v[34:37], v[10:13], v[176:179], 0
    ds_read_b128 v[10:13], v0 offset:5120
    s_nop 0
    v_cvt_pk_bf16_f32 v82, v46, v47
    v_cvt_pk_bf16_f32 v83, v48, v49
    ds_write_b64 v0, v[82:83] offset:23552
    v_cvt_pk_bf16_f32 v84, v50, v51
    v_cvt_pk_bf16_f32 v85, v52, v53
    ds_write_b64 v0, v[84:85] offset:23560
    v_cvt_pk_bf16_f32 v86, v54, v55
    v_cvt_pk_bf16_f32 v87, v56, v57
    ds_write_b64 v0, v[86:87] offset:24576
    s_waitcnt lgkmcnt(7)
    v_mfma_f32_16x16x32_bf16 v[30:33], v[14:17], v[100:103], v[30:33]
    v_mfma_f32_16x16x32_bf16 v[34:37], v[14:17], v[180:183], v[34:37]
    ds_read_b128 v[14:17], v0 offset:6144
    s_waitcnt lgkmcnt(1)
    s_barrier
    v_mfma_f32_16x16x32_bf16 v[30:33], v[18:21], v[104:107], v[30:33]
    v_mfma_f32_16x16x32_bf16 v[34:37], v[18:21], v[184:187], v[34:37]
    ds_read_b128 v[18:21], v0 offset:7168
    v_mfma_f32_16x16x32_bf16 v[30:33], v[22:25], v[108:111], v[30:33]
    v_mfma_f32_16x16x32_bf16 v[34:37], v[22:25], v[188:191], v[34:37]
    ds_read_b128 v[22:25], v0 offset:8192
    v_mfma_f32_16x16x32_bf16 v[30:33], v[26:29], v[112:115], v[30:33]
    v_mfma_f32_16x16x32_bf16 v[34:37], v[26:29], v[192:195], v[34:37]
    ds_read_b128 v[26:29], v0 offset:9216
    v_mfma_f32_16x16x32_bf16 v[30:33], v[10:13], v[116:119], v[30:33]
    v_mfma_f32_16x16x32_bf16 v[34:37], v[10:13], v[196:199], v[34:37]
    ds_read_b128 v[10:13], v0 offset:10240
    s_waitcnt lgkmcnt(4)
    v_mfma_f32_16x16x32_bf16 v[30:33], v[14:17], v[120:123], v[30:33]
    v_mfma_f32_16x16x32_bf16 v[34:37], v[14:17], v[200:203], v[34:37]
    ds_read_b128 v[14:17], v0 offset:11264
    s_waitcnt lgkmcnt(4)
    v_mfma_f32_16x16x32_bf16 v[30:33], v[18:21], v[124:127], v[30:33]
    v_mfma_f32_16x16x32_bf16 v[34:37], v[18:21], v[204:207], v[34:37]
    ds_read_b128 v[18:21], v0 offset:12288
    s_waitcnt lgkmcnt(4)
    v_mfma_f32_16x16x32_bf16 v[30:33], v[22:25], v[128:131], v[30:33]
    v_mfma_f32_16x16x32_bf16 v[34:37], v[22:25], v[208:211], v[34:37]
    ds_read_b128 v[22:25], v0 offset:13312
    s_waitcnt lgkmcnt(4)
    v_mfma_f32_16x16x32_bf16 v[30:33], v[26:29], v[132:135], v[30:33]
    v_mfma_f32_16x16x32_bf16 v[34:37], v[26:29], v[212:215], v[34:37]
    ds_read_b128 v[26:29], v0 offset:14336
    s_waitcnt lgkmcnt(4)
    v_mfma_f32_16x16x32_bf16 v[30:33], v[10:13], v[136:139], v[30:33]
    v_mfma_f32_16x16x32_bf16 v[34:37], v[10:13], v[216:219], v[34:37]
    ds_read_b128 v[10:13], v0 offset:15360
    s_waitcnt lgkmcnt(4)
    v_mfma_f32_16x16x32_bf16 v[30:33], v[14:17], v[140:143], v[30:33]
    v_mfma_f32_16x16x32_bf16 v[34:37], v[14:17], v[220:223], v[34:37]
    ds_read_b128 v[14:17], v0 offset:16384
    s_waitcnt lgkmcnt(4)
    v_mfma_f32_16x16x32_bf16 v[30:33], v[18:21], v[144:147], v[30:33]
    v_mfma_f32_16x16x32_bf16 v[34:37], v[18:21], v[224:227], v[34:37]
    ds_read_b128 v[18:21], v0 offset:17408
    s_waitcnt lgkmcnt(4)
    v_mfma_f32_16x16x32_bf16 v[30:33], v[22:25], v[148:151], v[30:33]
    v_mfma_f32_16x16x32_bf16 v[34:37], v[22:25], v[228:231], v[34:37]
    ds_read_b128 v[22:25], v0 offset:18432
    s_waitcnt lgkmcnt(4)
    v_mfma_f32_16x16x32_bf16 v[30:33], v[26:29], v[152:155], v[30:33]
    v_mfma_f32_16x16x32_bf16 v[34:37], v[26:29], v[232:235], v[34:37]
    ds_read_b128 v[26:29], v0 offset:19456
    s_waitcnt lgkmcnt(4)
    v_mfma_f32_16x16x32_bf16 v[30:33], v[10:13], v[156:159], v[30:33]
    v_mfma_f32_16x16x32_bf16 v[34:37], v[10:13], v[236:239], v[34:37]
    s_waitcnt lgkmcnt(3)
    v_mfma_f32_16x16x32_bf16 v[30:33], v[14:17], v[160:163], v[30:33]
    v_mfma_f32_16x16x32_bf16 v[34:37], v[14:17], v[240:243], v[34:37]
    s_waitcnt lgkmcnt(2)
    v_mfma_f32_16x16x32_bf16 v[30:33], v[18:21], v[164:167], v[30:33]
    v_mfma_f32_16x16x32_bf16 v[34:37], v[18:21], v[244:247], v[34:37]
    s_waitcnt lgkmcnt(1)
    v_mfma_f32_16x16x32_bf16 v[30:33], v[22:25], v[168:171], v[30:33]
    v_mfma_f32_16x16x32_bf16 v[34:37], v[22:25], v[248:251], v[34:37]
    s_waitcnt lgkmcnt(0)
    v_mfma_f32_16x16x32_bf16 v[30:33], v[26:29], v[172:175], v[30:33]
    v_mfma_f32_16x16x32_bf16 v[34:37], v[26:29], v[252:255], v[34:37]
    s_nop 6
    v_cvt_pk_bf16_f32 v88, v30, v31
    v_cvt_pk_bf16_f32 v89, v32, v33
    v_cvt_pk_bf16_f32 v90, v34, v35
    v_cvt_pk_bf16_f32 v91, v36, v37
    s_add_u32 s60, s31, 5120
    s_cmp_eq_u32 s20, 68
    s_cbranch_scc1 L_Rs2_tail
    s_waitcnt vmcnt(0) lgkmcnt(0)
    s_barrier
    ds_read_b128 v[10:13], v0 offset:26624
    ds_read_b128 v[14:17], v0 offset:27648
    ds_read_b128 v[18:21], v0 offset:28672
    ds_read_b128 v[58:61], v0 offset:39936
    ds_read_b128 v[62:65], v0 offset:40960
    ds_read_b128 v[66:69], v0 offset:52224
    ds_read_b128 v[70:73], v0 offset:53248
    buffer_store_dwordx4 v[88:91], v0, s[4:7], s60 offen sc1
    s_waitcnt lgkmcnt(5)
    v_max3_f32 v22, v10, v11, v12
    v_max3_f32 v23, v13, v14, v15
    v_max3_f32 v22, v22, v16, v17
    s_waitcnt lgkmcnt(4)
    v_max3_f32 v23, v23, v18, v19
    v_max3_f32 v22, v22, v20, v21
    v_max_f32 v22, v22, v23
    v_mov_b32 v23, v22
    ds_read_b128 v[30:33], v2 offset:0
    ds_read_b128 v[34:37], v2 offset:1024
    v_permlane32_swap_b32 v22, v23
    v_max_f32 v22, v22, v23
    v_mov_b32 v23, v22
    ds_read_b128 v[38:41], v2 offset:2048
    ds_read_b128 v[42:45], v2 offset:3072
    v_permlane16_swap_b32 v22, v23
    v_max_f32 v22, v22, v23
    v_pk_add_f32 v[10:11], v[10:11], v[22:23] op_sel_hi:[1,0] neg_lo:[0,1] neg_hi:[0,1]
    v_pk_add_f32 v[12:13], v[12:13], v[22:23] op_sel_hi:[1,0] neg_lo:[0,1] neg_hi:[0,1]
    v_pk_add_f32 v[14:15], v[14:15], v[22:23] op_sel_hi:[1,0] neg_lo:[0,1] neg_hi:[0,1]
    v_pk_add_f32 v[16:17], v[16:17], v[22:23] op_sel_hi:[1,0] neg_lo:[0,1] neg_hi:[0,1]
    v_pk_add_f32 v[18:19], v[18:19], v[22:23] op_sel_hi:[1,0] neg_lo:[0,1] neg_hi:[0,1]
    v_pk_add_f32 v[20:21], v[20:21], v[22:23] op_sel_hi:[1,0] neg_lo:[0,1] neg_hi:[0,1]
    v_exp_f32 v10, v10
    v_exp_f32 v11, v11
    v_exp_f32 v12, v12
    v_exp_f32 v13, v13
    v_exp_f32 v14, v14
    v_exp_f32 v15, v15
    v_cvt_pk_bf16_f32 v24, v10, v11
    v_cvt_pk_bf16_f32 v25, v12, v13
    v_exp_f32 v16, v16
    v_exp_f32 v17, v17
    v_mfma_f32_16x16x16_bf16 v[46:49], v[88:89], v[24:25], 0
    v_mfma_f32_16x16x16_bf16 v[82:85], v[90:91], v[24:25], 0
    v_exp_f32 v18, v18
    v_exp_f32 v19, v19
    v_exp_f32 v20, v20
    v_exp_f32 v21, v21
    v_cvt_pk_bf16_f32 v26, v14, v15
    v_cvt_pk_bf16_f32 v27, v16, v17
    v_cvt_pk_bf16_f32 v28, v18, v19
    v_cvt_pk_bf16_f32 v29, v20, v21
    v_pk_add_f32 v[22:23], v[10:11], v[12:13]
    v_pk_add_f32 v[14:15], v[14:15], v[16:17]
    s_waitcnt lgkmcnt(4)
    v_mfma_f32_16x16x32_bf16 v[50:53], v[58:61], v[26:29], v[46:49]
    v_pk_add_f32 v[18:19], v[18:19], v[20:21]
    v_mfma_f32_16x16x32_bf16 v[54:57], v[66:69], v[26:29], v[46:49]
    v_pk_add_f32 v[22:23], v[22:23], v[14:15]
    v_pk_add_f32 v[22:23], v[22:23], v[18:19]
    v_mfma_f32_16x16x32_bf16 v[10:13], v[62:65], v[26:29], v[82:85]
    v_add_f32 v22, v22, v23
    v_mfma_f32_16x16x32_bf16 v[14:17], v[70:73], v[26:29], v[82:85]
    v_mov_b32 v23, v22
    ds_read_b128 v[74:77], v2 offset:4096
    ds_read_b128 v[78:81], v2 offset:5120
    v_permlane32_swap_b32 v22, v23
    v_add_f32 v22, v22, v23
    v_mov_b32 v23, v22
    v_cndmask_b32 v50, v54, v50, s[48:49]
    v_cndmask_b32 v51, v55, v51, s[48:49]
    v_permlane16_swap_b32 v22, v23
    v_add_f32 v22, v22, v23
    v_rcp_f32 v22, v22
    v_cndmask_b32 v52, v56, v52, s[48:49]
    v_cndmask_b32 v53, v57, v53, s[48:49]
    v_cndmask_b32 v10, v14, v10, s[48:49]
    v_cndmask_b32 v11, v15, v11, s[48:49]
    v_cndmask_b32 v12, v16, v12, s[48:49]
    v_cndmask_b32 v13, v17, v13, s[48:49]
    v_pk_mul_f32 v[50:51], v[50:51], v[22:23] op_sel_hi:[1,0]
    v_pk_mul_f32 v[52:53], v[52:53], v[22:23] op_sel_hi:[1,0]
    v_cvt_pk_bf16_f32 v24, v50, v51
    v_cvt_pk_bf16_f32 v25, v52, v53
    v_pk_mul_f32 v[10:11], v[10:11], v[22:23] op_sel_hi:[1,0]
    v_pk_mul_f32 v[12:13], v[12:13], v[22:23] op_sel_hi:[1,0]
    v_cvt_pk_bf16_f32 v26, v10, v11
    v_cvt_pk_bf16_f32 v27, v12, v13
    ds_write_b128 v0, v[24:27] offset:2048
    s_waitcnt lgkmcnt(0)
    s_barrier
    ds_read_b128 v[10:13], v0 offset:0
    ds_read_b128 v[14:17], v0 offset:1024
    ds_read_b128 v[18:21], v0 offset:2048
    s_add_u32 s20, s20, 1
    s_waitcnt lgkmcnt(2)
    v_mfma_f32_16x16x32_bf16 v[46:49], v[30:33], v[10:13], 0
    ds_read_b128 v[30:33], v2 offset:6144
    s_waitcnt lgkmcnt(2)
    v_mfma_f32_16x16x32_bf16 v[46:49], v[34:37], v[14:17], v[46:49]
    ds_read_b128 v[34:37], v2 offset:7168
    s_waitcnt lgkmcnt(2)
    v_mfma_f32_16x16x32_bf16 v[46:49], v[38:41], v[18:21], v[46:49]
    ds_read_b128 v[38:41], v2 offset:8192
    v_mfma_f32_16x16x32_bf16 v[50:53], v[42:45], v[10:13], 0
    ds_read_b128 v[42:45], v2 offset:9216
    v_mfma_f32_16x16x32_bf16 v[50:53], v[74:77], v[14:17], v[50:53]
    ds_read_b128 v[74:77], v2 offset:10240
    v_mfma_f32_16x16x32_bf16 v[50:53], v[78:81], v[18:21], v[50:53]
    ds_read_b128 v[78:81], v2 offset:11264
    s_waitcnt lgkmcnt(3)
    v_mfma_f32_16x16x32_bf16 v[54:57], v[30:33], v[10:13], 0
    ds_read_b128 v[30:33], v2 offset:12288
    v_cvt_pk_bf16_f32 v62, v46, v47
    v_mfma_f32_16x16x32_bf16 v[54:57], v[34:37], v[14:17], v[54:57]
    ds_read_b128 v[34:37], v2 offset:13312
    v_cvt_pk_bf16_f32 v63, v48, v49
    v_and_or_b32 v62, v62, -2, s22
    v_mfma_f32_16x16x32_bf16 v[54:57], v[38:41], v[18:21], v[54:57]
    ds_read_b128 v[38:41], v2 offset:14336
    v_cvt_pk_bf16_f32 v64, v50, v51
    s_waitcnt lgkmcnt(3)
    v_mfma_f32_16x16x32_bf16 v[58:61], v[42:45], v[10:13], 0
    ds_read_b128 v[42:45], v2 offset:15360
    v_cvt_pk_bf16_f32 v65, v52, v53
    v_mfma_f32_16x16x32_bf16 v[58:61], v[74:77], v[14:17], v[58:61]
    ds_read_b128 v[74:77], v2 offset:16384
    v_mfma_f32_16x16x32_bf16 v[58:61], v[78:81], v[18:21], v[58:61]
    ds_read_b128 v[78:81], v2 offset:17408
    buffer_store_dwordx4 v[62:65], v3, s[4:7], s32 offen sc1
    s_waitcnt lgkmcnt(3)
    v_mfma_f32_16x16x32_bf16 v[46:49], v[30:33], v[10:13], 0
    ds_read_b128 v[30:33], v2 offset:18432
    v_cvt_pk_bf16_f32 v66, v54, v55
    v_mfma_f32_16x16x32_bf16 v[46:49], v[34:37], v[14:17], v[46:49]
    ds_read_b128 v[34:37], v2 offset:19456
    v_cvt_pk_bf16_f32 v67, v56, v57
    v_and_or_b32 v66, v66, -2, s22
    v_mfma_f32_16x16x32_bf16 v[46:49], v[38:41], v[18:21], v[46:49]
    ds_read_b128 v[38:41], v2 offset:20480
    v_cvt_pk_bf16_f32 v68, v58, v59
    s_waitcnt lgkmcnt(3)
    v_mfma_f32_16x16x32_bf16 v[50:53], v[42:45], v[10:13], 0
    ds_read_b128 v[42:45], v2 offset:21504
    v_cvt_pk_bf16_f32 v69, v60, v61
    v_mfma_f32_16x16x32_bf16 v[50:53], v[74:77], v[14:17], v[50:53]
    ds_read_b128 v[74:77], v2 offset:22528
    v_mfma_f32_16x16x32_bf16 v[50:53], v[78:81], v[18:21], v[50:53]
    ds_read_b128 v[78:81], v2 offset:23552
    buffer_store_dwordx4 v[66:69], v4, s[4:7], s32 offen sc1
    s_waitcnt lgkmcnt(3)
    v_mfma_f32_16x16x32_bf16 v[54:57], v[30:33], v[10:13], 0
    ds_read_b128 v[30:33], v2 offset:24576
    v_cvt_pk_bf16_f32 v62, v46, v47
    v_mfma_f32_16x16x32_bf16 v[54:57], v[34:37], v[14:17], v[54:57]
    ds_read_b128 v[34:37], v2 offset:25600
    v_cvt_pk_bf16_f32 v63, v48, v49
    v_and_or_b32 v62, v62, -2, s22
    v_mfma_f32_16x16x32_bf16 v[54:57], v[38:41], v[18:21], v[54:57]
    ds_read_b128 v[38:41], v2 offset:26624
    v_cvt_pk_bf16_f32 v64, v50, v51
    s_waitcnt lgkmcnt(3)
    v_mfma_f32_16x16x32_bf16 v[58:61], v[42:45], v[10:13], 0
    ds_read_b128 v[42:45], v2 offset:27648
    v_cvt_pk_bf16_f32 v65, v52, v53
    v_mfma_f32_16x16x32_bf16 v[58:61], v[74:77], v[14:17], v[58:61]
    ds_read_b128 v[74:77], v2 offset:28672
    v_mfma_f32_16x16x32_bf16 v[58:61], v[78:81], v[18:21], v[58:61]
    ds_read_b128 v[78:81], v2 offset:29696
    buffer_store_dwordx4 v[62:65], v5, s[4:7], s32 offen sc1
    s_waitcnt lgkmcnt(3)
    v_mfma_f32_16x16x32_bf16 v[46:49], v[30:33], v[10:13], 0
    v_cvt_pk_bf16_f32 v66, v54, v55
    v_mfma_f32_16x16x32_bf16 v[46:49], v[34:37], v[14:17], v[46:49]
    v_cvt_pk_bf16_f32 v67, v56, v57
    v_and_or_b32 v66, v66, -2, s22
    v_mfma_f32_16x16x32_bf16 v[46:49], v[38:41], v[18:21], v[46:49]
    v_cvt_pk_bf16_f32 v68, v58, v59
    s_waitcnt lgkmcnt(0)
    v_mfma_f32_16x16x32_bf16 v[50:53], v[42:45], v[10:13], 0
    v_cvt_pk_bf16_f32 v69, v60, v61
    v_mfma_f32_16x16x32_bf16 v[50:53], v[74:77], v[14:17], v[50:53]
    v_mfma_f32_16x16x32_bf16 v[50:53], v[78:81], v[18:21], v[50:53]
    buffer_store_dwordx4 v[66:69], v6, s[4:7], s32 offen sc1
    s_nop 0
    v_cvt_pk_bf16_f32 v62, v46, v47
    v_cvt_pk_bf16_f32 v63, v48, v49
    v_and_or_b32 v62, v62, -2, s22
    s_nop 2
    v_cvt_pk_bf16_f32 v64, v50, v51
    v_cvt_pk_bf16_f32 v65, v52, v53
    buffer_store_dwordx4 v[62:65], v7, s[4:7], s32 offen sc1
    v_accvgpr_read_b32 v78, a252
    v_accvgpr_read_b32 v79, a253
    v_accvgpr_read_b32 v80, a254
    v_accvgpr_read_b32 v81, a255
    s_mov_b32 s19, 0
    s_waitcnt vmcnt(0)
    buffer_load_dwordx4 v[26:29], v8, s[4:7], s32 offen sc1
    buffer_load_dwordx4 v[30:33], v8, s[4:7], s33 offen sc1
    buffer_load_dwordx4 v[34:37], v8, s[4:7], s34 offen sc1
    buffer_load_dwordx4 v[38:41], v8, s[4:7], s35 offen sc1
L_Rs2_hb_6:
    s_waitcnt vmcnt(3)
    v_mfma_f32_16x16x32_bf16 v[70:73], a[248:251], v[26:29], 0
    v_xor_b32 v1, s44, v26
    s_waitcnt vmcnt(2)
    v_mfma_f32_16x16x32_bf16 v[70:73], a[248:251], v[30:33], v[70:73]
    v_bitop3_b32 v1, v1, v30, s44 bitop3:0xf6
    s_waitcnt vmcnt(1)
    v_mfma_f32_16x16x32_bf16 v[70:73], a[248:251], v[34:37], v[70:73]
    v_bitop3_b32 v1, v1, v34, s44 bitop3:0xf6
    s_waitcnt vmcnt(0)
    v_mfma_f32_16x16x32_bf16 v[70:73], a[248:251], v[38:41], v[70:73]
    v_bitop3_b32 v1, v1, v38, s44 bitop3:0xf6
    v_and_b32 v1, 1, v1
    v_cmp_ne_u32 vcc, 0, v1
    s_nop 0
    s_cbranch_vccnz L_Rs2_hbfix_7
    s_nop 2
    v_add_f32_dpp v70, v70, v70 row_ror:8 row_mask:0xf bank_mask:0xf
    v_add_f32_dpp v71, v71, v71 row_ror:8 row_mask:0xf bank_mask:0xf
    v_add_f32_dpp v72, v72, v72 row_ror:8 row_mask:0xf bank_mask:0xf
    v_add_f32_dpp v73, v73, v73 row_ror:8 row_mask:0xf bank_mask:0xf
    v_cvt_pk_bf16_f32 v74, v70, v71
    v_cvt_pk_bf16_f32 v75, v72, v73
    v_mov_b32 v76, v74
    v_mov_b32 v77, v75
    s_nop 0
    v_permlane16_swap_b32 v74, v76
    v_permlane16_swap_b32 v75, v77
    v_cndmask_b32 v74, v74, v78, s[42:43]
    v_cndmask_b32 v75, v75, v79, s[42:43]
    v_cndmask_b32 v76, v76, v80, s[42:43]
    v_cndmask_b32 v77, v77, v81, s[42:43]
    v_and_or_b32 v74, v74, -2, s24
    s_mov_b64 exec, s[46:47]
    buffer_store_dwordx4 v[74:77], v9, s[4:7], s36 offen sc1
    buffer_store_dwordx4 v[74:77], v9, s[4:7], s37 offen sc1
    s_mov_b64 exec, -1
    s_add_u32 s60, s20, 1
    s_and_b32 s22, s60, 1
    s_lshl_b32 s21, s22, 31
    s_sub_u32 s44, 0, s22
    s_bfe_u32 s23, s20, 0x10001
    s_sub_u32 s23, s23, 1
    s_lshr_b32 s24, s60, 1
    s_andn2_b32 s24, 1, s24
    s_lshl_b32 s61, s14, 15
    s_add_u32 s61, s61, 1179648
    s_and_b32 s25, s20, 1
    s_lshl_b32 s25, s25, 16
    s_add_u32 s25, s25, s61
    s_add_u32 s25, s25, 10240
    s_add_u32 s26, s25, 4096
    s_lshl_b32 s36, s22, 16
    s_add_u32 s36, s36, s61
    s_lshl_b32 s27, s20, 1
    s_add_u32 s37, s27, 2
    s_add_u32 s37, s37, s14
    s_mul_i32 s37, s37, 20480
    s_add_u32 s37, s37, 2621440
    s_add_u32 s27, s27, 1
    s_sub_u32 s27, s27, s14
    s_mul_i32 s27, s27, 20480
    s_add_u32 s27, s27, 2631680
    s_add_u32 s28, s27, 4096
    s_lshl_b32 s31, s20, 6
    s_add_u32 s31, s31, s13
    s_mul_i32 s31, s31, 6144
    s_add_u32 s31, s31, 5898240
    s_min_u32 s56, s20, 63
    s_lshl_b32 s56, s56, 6
    s_add_u32 s56, s56, s13
    s_mul_i32 s56, s56, 12288
    s_add_u32 s56, s56, 37361664
    s_max_u32 s57, s20, 5
    s_sub_u32 s57, s57, 5
    s_lshl_b32 s57, s57, 6
    s_add_u32 s57, s57, s13
    s_mul_i32 s57, s57, 12288
    s_add_u32 s57, s57, 87693312
    s_cmp_lt_u32 s20, 5
    s_cselect_b32 s57, s56, s57
    s_cmp_gt_u32 s60, 63
    s_cselect_b64 s[42:43], s[38:39], 0
    s_cmp_le_u32 s60, 5
    s_cselect_b64 vcc, s[40:41], 0
    s_or_b64 s[42:43], s[42:43], vcc
    s_waitcnt vmcnt(1)
    s_branch L_Rs2_top
L_Rs2_tail:
    s_waitcnt lgkmcnt(0)
    buffer_store_dwordx4 v[88:91], v0, s[4:7], s60 offen sc1
    s_waitcnt vmcnt(0) lgkmcnt(0)
    s_barrier
    v_mov_b32 v22, 69
    s_mov_b64 exec, 1
    s_mov_b64 exec, -1
    s_waitcnt vmcnt(0)
    s_endpgm
L_Rs2_glfix_3:
    buffer_load_dwordx4 v[10:13], v0, s[4:7], s25 offen offset:0 sc1
    buffer_load_dwordx4 v[14:17], v0, s[4:7], s25 offen offset:1024 sc1
    buffer_load_dwordx4 v[18:21], v0, s[4:7], s25 offen offset:2048 sc1
    buffer_load_dwordx4 v[22:25], v0, s[4:7], s25 offen offset:3072 sc1
    buffer_load_dwordx4 v[26:29], v0, s[4:7], s26 offen offset:0 sc1
    buffer_load_dwordx4 v[46:49], v0, s[4:7], s27 offen offset:0 sc1
    buffer_load_dwordx4 v[30:33], v0, s[4:7], s27 offen offset:1024 sc1
    buffer_load_dwordx4 v[34:37], v0, s[4:7], s27 offen offset:2048 sc1
    buffer_load_dwordx4 v[38:41], v0, s[4:7], s27 offen offset:3072 sc1
    buffer_load_dwordx4 v[42:45], v0, s[4:7], s28 offen offset:0 sc1
    s_add_u32 s19, s19, 1
    s_cmp_lt_u32 s19, 524288
    s_cbranch_scc1 L_Rs2_gl_1
    s_branch L_fail
L_Rs2_grfix_5:
    buffer_load_dwordx4 v[46:49], v0, s[4:7], s27 offen offset:0 sc1
    buffer_load_dwordx4 v[30:33], v0, s[4:7], s27 offen offset:1024 sc1
    buffer_load_dwordx4 v[34:37], v0, s[4:7], s27 offen offset:2048 sc1
    buffer_load_dwordx4 v[38:41], v0, s[4:7], s27 offen offset:3072 sc1
    buffer_load_dwordx4 v[42:45], v0, s[4:7], s28 offen offset:0 sc1
    s_add_u32 s19, s19, 1
    s_cmp_lt_u32 s19, 524288
    s_cbranch_scc1 L_Rs2_gr2_4
    s_branch L_fail
L_Rs2_gr2_4:
    v_mfma_f32_16x16x32_bf16 v[50:53], a[240:243], v[10:13], 0
    v_mfma_f32_16x16x32_bf16 v[54:57], a[244:247], v[10:13], 0
    v_mfma_f32_16x16x32_bf16 v[58:61], a[240:243], v[14:17], 0
    v_mfma_f32_16x16x32_bf16 v[62:65], a[244:247], v[14:17], 0
    v_mfma_f32_16x16x32_bf16 v[66:69], a[240:243], v[18:21], 0
    v_mfma_f32_16x16x32_bf16 v[70:73], a[244:247], v[18:21], 0
    v_mfma_f32_16x16x32_bf16 v[74:77], a[240:243], v[22:25], 0
    v_mfma_f32_16x16x32_bf16 v[78:81], a[244:247], v[22:25], 0
    v_mfma_f32_16x16x32_bf16 v[82:85], a[240:243], v[26:29], 0
    v_mfma_f32_16x16x32_bf16 v[86:89], a[244:247], v[26:29], 0
    s_branch L_Rs2_gr_2
L_Rs2_hbfix_7:
    buffer_load_dwordx4 v[26:29], v8, s[4:7], s32 offen sc1
    buffer_load_dwordx4 v[30:33], v8, s[4:7], s33 offen sc1
    buffer_load_dwordx4 v[34:37], v8, s[4:7], s34 offen sc1
    buffer_load_dwordx4 v[38:41], v8, s[4:7], s35 offen sc1
    s_add_u32 s19, s19, 1
    s_cmp_lt_u32 s19, 524288
    s_cbranch_scc1 L_Rs2_hb_6
    s_branch L_fail
L_R3_start:
    s_lshr_b32 s14, s13, 5
    s_and_b32 s15, s13, 31
    s_mov_b32 s62, 53760
    v_lshlrev_b32 v10, 4, v0
    v_mov_b32 v12, 0
    v_mov_b32 v13, 0
    v_mov_b32 v14, 0
    v_mov_b32 v15, 0
    v_mov_b32 v16, -1
    v_mov_b32 v17, -1
    v_mov_b32 v18, -1
    v_mov_b32 v19, -1
    s_lshl_b32 s60, s13, 12
    s_add_u32 s60, s60, 920576
    buffer_store_dwordx4 v[12:15], v10, s[4:7], s60 offen sc1
    s_mul_i32 s60, s13, 20480
    s_add_u32 s60, s60, 1326080
    buffer_store_dwordx4 v[12:15], v10, s[4:7], s60 offen sc1
    s_add_u32 s60, s60, 1024
    buffer_store_dwordx4 v[12:15], v10, s[4:7], s60 offen sc1
    s_add_u32 s60, s60, 1024
    buffer_store_dwordx4 v[12:15], v10, s[4:7], s60 offen sc1
    s_add_u32 s60, s60, 1024
    buffer_store_dwordx4 v[12:15], v10, s[4:7], s60 offen sc1
    s_add_u32 s60, s60, 1024
    buffer_store_dwordx4 v[12:15], v10, s[4:7], s60 offen sc1
    s_add_u32 s60, s60, 1024
    s_mul_i32 s61, s15, 640
    v_add_u32 v11, s61, v10
    s_mov_b32 exec_hi, 0xff
    s_lshl_b32 s60, s14, 15
    s_mul_i32 s60, s14, 20480
    s_add_u32 s60, s60, 2744320
    buffer_store_dwordx4 v[16:19], v11, s[4:7], s60 offen sc1
    s_add_u32 s60, s60, 163840
    buffer_store_dwordx4 v[16:19], v11, s[4:7], s60 offen sc1
    s_add_u32 s60, s60, 163840
    buffer_store_dwordx4 v[16:19], v11, s[4:7], s60 offen sc1
    s_add_u32 s60, s60, 163840
    buffer_store_dwordx4 v[16:19], v11, s[4:7], s60 offen sc1
    s_add_u32 s60, s60, 163840
    buffer_store_dwordx4 v[16:19], v11, s[4:7], s60 offen sc1
    s_add_u32 s60, s60, 163840
    buffer_store_dwordx4 v[16:19], v11, s[4:7], s60 offen sc1
    s_add_u32 s60, s60, 163840
    buffer_store_dwordx4 v[16:19], v11, s[4:7], s60 offen sc1
    s_add_u32 s60, s60, 163840
    buffer_store_dwordx4 v[16:19], v11, s[4:7], s60 offen sc1
    s_add_u32 s60, s60, 163840
    buffer_store_dwordx4 v[16:19], v11, s[4:7], s60 offen sc1
    s_add_u32 s60, s60, 163840
    buffer_store_dwordx4 v[16:19], v11, s[4:7], s60 offen sc1
    s_add_u32 s60, s60, 163840
    buffer_store_dwordx4 v[16:19], v11, s[4:7], s60 offen sc1
    s_add_u32 s60, s60, 163840
    buffer_store_dwordx4 v[16:19], v11, s[4:7], s60 offen sc1
    s_add_u32 s60, s60, 163840
    buffer_store_dwordx4 v[16:19], v11, s[4:7], s60 offen sc1
    s_add_u32 s60, s60, 163840
    buffer_store_dwordx4 v[16:19], v11, s[4:7], s60 offen sc1
    s_add_u32 s60, s60, 163840
    buffer_store_dwordx4 v[16:19], v11, s[4:7], s60 offen sc1
    s_add_u32 s60, s60, 163840
    buffer_store_dwordx4 v[16:19], v11, s[4:7], s60 offen sc1
    s_add_u32 s60, s60, 163840
    buffer_store_dwordx4 v[16:19], v11, s[4:7], s60 offen sc1
    s_add_u32 s60, s60, 163840
    s_mov_b64 exec, 1
    s_lshl_b32 s54, s13, 9
    s_lshr_b32 s55, s13, 1
    s_mul_i32 s55, s55, 1536
    s_add_u32 s55, s55, 32768
    s_add_u32 s54, s54, 384
    buffer_store_dword v12, v10, s[4:7], s54 offen sc1
    s_mov_b64 exec, -1
    v_add_u32 v38, 0, v0
    v_mul_u32_u24 v39, 10923, v38
    v_lshrrev_b32 v39, 16, v39
    v_mul_u32_u24 v20, 6, v39
    v_sub_u32 v20, v38, v20
    v_lshrrev_b32 v20, 0, v20
    v_lshlrev_b32 v20, 4, v20
    v_mul_u32_u24 v39, 12288, v39
    v_add_u32 v20, v20, v39
    v_add_u32 v38, 64, v0
    v_mul_u32_u24 v39, 10923, v38
    v_lshrrev_b32 v39, 16, v39
    v_mul_u32_u24 v21, 6, v39
    v_sub_u32 v21, v38, v21
    v_lshrrev_b32 v21, 0, v21
    v_lshlrev_b32 v21, 4, v21
    v_mul_u32_u24 v39, 12288, v39
    v_add_u32 v21, v21, v39
    v_add_u32 v38, 128, v0
    v_mul_u32_u24 v39, 10923, v38
    v_lshrrev_b32 v39, 16, v39
    v_mul_u32_u24 v22, 6, v39
    v_sub_u32 v22, v38, v22
    v_lshrrev_b32 v22, 0, v22
    v_lshlrev_b32 v22, 4, v22
    v_mul_u32_u24 v39, 12288, v39
    v_add_u32 v22, v22, v39
    v_add_u32 v38, 0, v0
    v_mul_u32_u24 v39, 16385, v38
    v_lshrrev_b32 v39, 16, v39
    v_mul_u32_u24 v23, 4, v39
    v_sub_u32 v23, v38, v23
    v_lshrrev_b32 v23, 0, v23
    v_lshlrev_b32 v23, 4, v23
    v_mul_u32_u24 v39, 12288, v39
    v_add_u32 v23, v23, v39
    v_add_u32 v38, 64, v0
    v_mul_u32_u24 v39, 16385, v38
    v_lshrrev_b32 v39, 16, v39
    v_mul_u32_u24 v24, 4, v39
    v_sub_u32 v24, v38, v24
    v_lshrrev_b32 v24, 0, v24
    v_lshlrev_b32 v24, 4, v24
    v_mul_u32_u24 v39, 12288, v39
    v_add_u32 v24, v24, v39
    v_add_u32 v38, 0, v0
    v_mul_u32_u24 v39, 3277, v38
    v_lshrrev_b32 v39, 16, v39
    v_mul_u32_u24 v25, 20, v39
    v_sub_u32 v25, v38, v25
    v_lshrrev_b32 v25, 0, v25
    v_lshlrev_b32 v25, 4, v25
    v_mul_u32_u24 v39, 1280, v39
    v_add_u32 v25, v25, v39
    v_add_u32 v38, 64, v0
    v_mul_u32_u24 v39, 3277, v38
    v_lshrrev_b32 v39, 16, v39
    v_mul_u32_u24 v26, 20, v39
    v_sub_u32 v26, v38, v26
    v_lshrrev_b32 v26, 0, v26
    v_lshlrev_b32 v26, 4, v26
    v_mul_u32_u24 v39, 1280, v39
    v_add_u32 v26, v26, v39
    v_add_u32 v38, 128, v0
    v_mul_u32_u24 v39, 3277, v38
    v_lshrrev_b32 v39, 16, v39
    v_mul_u32_u24 v27, 20, v39
    v_sub_u32 v27, v38, v27
    v_lshrrev_b32 v27, 0, v27
    v_lshlrev_b32 v27, 4, v27
    v_mul_u32_u24 v39, 1280, v39
    v_add_u32 v27, v27, v39
    v_add_u32 v38, 192, v0
    v_mul_u32_u24 v39, 3277, v38
    v_lshrrev_b32 v39, 16, v39
    v_mul_u32_u24 v28, 20, v39
    v_sub_u32 v28, v38, v28
    v_lshrrev_b32 v28, 0, v28
    v_lshlrev_b32 v28, 4, v28
    v_mul_u32_u24 v39, 1280, v39
    v_add_u32 v28, v28, v39
    v_add_u32 v38, 256, v0
    v_mul_u32_u24 v39, 3277, v38
    v_lshrrev_b32 v39, 16, v39
    v_mul_u32_u24 v29, 20, v39
    v_sub_u32 v29, v38, v29
    v_lshrrev_b32 v29, 0, v29
    v_lshlrev_b32 v29, 4, v29
    v_mul_u32_u24 v39, 1280, v39
    v_add_u32 v29, v29, v39
    v_add_u32 v38, 320, v0
    v_mul_u32_u24 v39, 3277, v38
    v_lshrrev_b32 v39, 16, v39
    v_mul_u32_u24 v30, 20, v39
    v_sub_u32 v30, v38, v30
    v_lshrrev_b32 v30, 0, v30
    v_lshlrev_b32 v30, 4, v30
    v_mul_u32_u24 v39, 1280, v39
    v_add_u32 v30, v30, v39
    v_add_u32 v38, 384, v0
    v_mul_u32_u24 v39, 3277, v38
    v_lshrrev_b32 v39, 16, v39
    v_mul_u32_u24 v31, 20, v39
    v_sub_u32 v31, v38, v31
    v_lshrrev_b32 v31, 0, v31
    v_lshlrev_b32 v31, 4, v31
    v_mul_u32_u24 v39, 1280, v39
    v_add_u32 v31, v31, v39
    v_add_u32 v38, 448, v0
    v_mul_u32_u24 v39, 3277, v38
    v_lshrrev_b32 v39, 16, v39
    v_mul_u32_u24 v32, 20, v39
    v_sub_u32 v32, v38, v32
    v_lshrrev_b32 v32, 0, v32
    v_lshlrev_b32 v32, 4, v32
    v_mul_u32_u24 v39, 1280, v39
    v_add_u32 v32, v32, v39
    v_add_u32 v38, 512, v0
    v_mul_u32_u24 v39, 3277, v38
    v_lshrrev_b32 v39, 16, v39
    v_mul_u32_u24 v33, 20, v39
    v_sub_u32 v33, v38, v33
    v_lshrrev_b32 v33, 0, v33
    v_lshlrev_b32 v33, 4, v33
    v_mul_u32_u24 v39, 1280, v39
    v_add_u32 v33, v33, v39
    v_add_u32 v38, 576, v0
    v_mul_u32_u24 v39, 3277, v38
    v_lshrrev_b32 v39, 16, v39
    v_mul_u32_u24 v34, 20, v39
    v_sub_u32 v34, v38, v34
    v_lshrrev_b32 v34, 0, v34
    v_lshlrev_b32 v34, 4, v34
    v_mul_u32_u24 v39, 1280, v39
    v_add_u32 v34, v34, v39
    v_lshrrev_b32 v35, 2, v0
    v_mul_u32_u24 v35, 96, v35
    v_and_b32 v38, 3, v0
    v_lshl_add_u32 v35, v38, 3, v35
    v_add_u32 v35, s62, v35
    v_lshrrev_b32 v36, 2, v0
    v_mul_u32_u24 v36, 64, v36
    v_and_b32 v38, 3, v0
    v_lshl_add_u32 v36, v38, 3, v36
    v_add_u32 v36, s62, v36
    v_lshrrev_b32 v37, 2, v0
    v_mul_u32_u24 v37, 320, v37
    v_and_b32 v38, 3, v0
    v_lshl_add_u32 v37, v38, 3, v37
    v_add_u32 v37, s62, v37
    v_add_u32 v2, 133120, v10
    s_mov_b32 s8, s70
    s_and_b32 s9, s71, 0xffff
    s_mov_b32 s10, 7864320
    s_mov_b32 s11, 0x20000
    s_mov_b32 s28, s72
    s_and_b32 s29, s73, 0xffff
    s_mov_b32 s30, 7864320
    s_mov_b32 s31, 0x20000
    s_mov_b32 s32, s74
    s_and_b32 s33, s75, 0xffff
    s_mov_b32 s34, 7864320
    s_mov_b32 s35, 0x20000
    s_mul_i32 s60, s13, 192
    s_add_u32 s25, s60, 96
    s_add_u32 s26, s60, 192
    s_mul_i32 s27, s13, 122880
    s_add_u32 s27, s27, 960
    s_add_u32 m0, s62, 0
    s_nop 0
    buffer_load_dwordx4 v20, s[8:11], s25 offen lds
    s_add_u32 m0, s62, 1024
    s_nop 0
    buffer_load_dwordx4 v21, s[8:11], s25 offen lds
    s_add_u32 m0, s62, 2048
    s_nop 0
    buffer_load_dwordx4 v22, s[8:11], s25 offen lds
    s_add_u32 s25, s25, 393216
    s_add_u32 m0, s62, 3072
    s_nop 0
    buffer_load_dwordx4 v20, s[8:11], s25 offen lds
    s_add_u32 m0, s62, 4096
    s_nop 0
    buffer_load_dwordx4 v21, s[8:11], s25 offen lds
    s_add_u32 m0, s62, 5120
    s_nop 0
    buffer_load_dwordx4 v22, s[8:11], s25 offen lds
    s_add_u32 s25, s25, 393216
    s_add_u32 m0, s62, 6144
    s_nop 0
    buffer_load_dwordx4 v20, s[8:11], s25 offen lds
    s_add_u32 m0, s62, 7168
    s_nop 0
    buffer_load_dwordx4 v21, s[8:11], s25 offen lds
    s_add_u32 m0, s62, 8192
    s_nop 0
    buffer_load_dwordx4 v22, s[8:11], s25 offen lds
    s_add_u32 s25, s25, 393216
    s_add_u32 m0, s62, 9216
    s_nop 0
    buffer_load_dwordx4 v20, s[8:11], s25 offen lds
    s_add_u32 m0, s62, 10240
    s_nop 0
    buffer_load_dwordx4 v21, s[8:11], s25 offen lds
    s_add_u32 m0, s62, 11264
    s_nop 0
    buffer_load_dwordx4 v22, s[8:11], s25 offen lds
    s_add_u32 s25, s25, 393216
    s_add_u32 m0, s62, 12288
    s_nop 0
    buffer_load_dwordx4 v20, s[8:11], s25 offen lds
    s_add_u32 m0, s62, 13312
    s_nop 0
    buffer_load_dwordx4 v21, s[8:11], s25 offen lds
    s_add_u32 m0, s62, 14336
    s_nop 0
    buffer_load_dwordx4 v22, s[8:11], s25 offen lds
    s_waitcnt vmcnt(12)
    s_barrier
    s_cmp_lg_u32 s12, 0
    s_cbranch_scc1 L_R3_arr_1
    s_lshl_b32 s3, s18, 2
    s_add_u32 s3, s3, 64
    v_mov_b32 v92, s3
    v_mov_b32 v93, 1
    s_mov_b64 exec, 1
    global_atomic_add v92, v93, s[16:17] sc1
    s_waitcnt vmcnt(0)
    s_mov_b64 exec, -1
L_R3_arr_1:
    ds_read_b64_tr_b16 a[0:1], v35 offset:0
    ds_read_b64_tr_b16 a[2:3], v35 offset:1536
    ds_read_b64_tr_b16 a[80:81], v35 offset:32
    ds_read_b64_tr_b16 a[82:83], v35 offset:1568
    ds_read_b64_tr_b16 a[160:161], v35 offset:64
    ds_read_b64_tr_b16 a[162:163], v35 offset:1600
    s_waitcnt lgkmcnt(0)
    s_add_u32 s25, s25, 393216
    s_add_u32 m0, s62, 0
    s_nop 0
    buffer_load_dwordx4 v20, s[8:11], s25 offen lds
    s_add_u32 m0, s62, 1024
    s_nop 0
    buffer_load_dwordx4 v21, s[8:11], s25 offen lds
    s_add_u32 m0, s62, 2048
    s_nop 0
    buffer_load_dwordx4 v22, s[8:11], s25 offen lds
    s_waitcnt vmcnt(12)
    ds_read_b64_tr_b16 a[4:5], v35 offset:3072
    ds_read_b64_tr_b16 a[6:7], v35 offset:4608
    ds_read_b64_tr_b16 a[84:85], v35 offset:3104
    ds_read_b64_tr_b16 a[86:87], v35 offset:4640
    ds_read_b64_tr_b16 a[164:165], v35 offset:3136
    ds_read_b64_tr_b16 a[166:167], v35 offset:4672
    s_waitcnt lgkmcnt(0)
    s_add_u32 s25, s25, 393216
    s_add_u32 m0, s62, 3072
    s_nop 0
    buffer_load_dwordx4 v20, s[8:11], s25 offen lds
    s_add_u32 m0, s62, 4096
    s_nop 0
    buffer_load_dwordx4 v21, s[8:11], s25 offen lds
    s_add_u32 m0, s62, 5120
    s_nop 0
    buffer_load_dwordx4 v22, s[8:11], s25 offen lds
    s_waitcnt vmcnt(12)
    ds_read_b64_tr_b16 a[8:9], v35 offset:6144
    ds_read_b64_tr_b16 a[10:11], v35 offset:7680
    ds_read_b64_tr_b16 a[88:89], v35 offset:6176
    ds_read_b64_tr_b16 a[90:91], v35 offset:7712
    ds_read_b64_tr_b16 a[168:169], v35 offset:6208
    ds_read_b64_tr_b16 a[170:171], v35 offset:7744
    s_waitcnt lgkmcnt(0)
    s_add_u32 s25, s25, 393216
    s_add_u32 m0, s62, 6144
    s_nop 0
    buffer_load_dwordx4 v20, s[8:11], s25 offen lds
    s_add_u32 m0, s62, 7168
    s_nop 0
    buffer_load_dwordx4 v21, s[8:11], s25 offen lds
    s_add_u32 m0, s62, 8192
    s_nop 0
    buffer_load_dwordx4 v22, s[8:11], s25 offen lds
    s_waitcnt vmcnt(12)
    ds_read_b64_tr_b16 a[12:13], v35 offset:9216
    ds_read_b64_tr_b16 a[14:15], v35 offset:10752
    ds_read_b64_tr_b16 a[92:93], v35 offset:9248
    ds_read_b64_tr_b16 a[94:95], v35 offset:10784
    ds_read_b64_tr_b16 a[172:173], v35 offset:9280
    ds_read_b64_tr_b16 a[174:175], v35 offset:10816
    s_waitcnt lgkmcnt(0)
    s_add_u32 s25, s25, 393216
    s_add_u32 m0, s62, 9216
    s_nop 0
    buffer_load_dwordx4 v20, s[8:11], s25 offen lds
    s_add_u32 m0, s62, 10240
    s_nop 0
    buffer_load_dwordx4 v21, s[8:11], s25 offen lds
    s_add_u32 m0, s62, 11264
    s_nop 0
    buffer_load_dwordx4 v22, s[8:11], s25 offen lds
    s_waitcnt vmcnt(12)
    ds_read_b64_tr_b16 a[16:17], v35 offset:12288
    ds_read_b64_tr_b16 a[18:19], v35 offset:13824
    ds_read_b64_tr_b16 a[96:97], v35 offset:12320
    ds_read_b64_tr_b16 a[98:99], v35 offset:13856
    ds_read_b64_tr_b16 a[176:177], v35 offset:12352
    ds_read_b64_tr_b16 a[178:179], v35 offset:13888
    s_waitcnt lgkmcnt(0)
    s_add_u32 s25, s25, 393216
    s_add_u32 m0, s62, 12288
    s_nop 0
    buffer_load_dwordx4 v20, s[8:11], s25 offen lds
    s_add_u32 m0, s62, 13312
    s_nop 0
    buffer_load_dwordx4 v21, s[8:11], s25 offen lds
    s_add_u32 m0, s62, 14336
    s_nop 0
    buffer_load_dwordx4 v22, s[8:11], s25 offen lds
    s_waitcnt vmcnt(12)
    ds_read_b64_tr_b16 a[20:21], v35 offset:0
    ds_read_b64_tr_b16 a[22:23], v35 offset:1536
    ds_read_b64_tr_b16 a[100:101], v35 offset:32
    ds_read_b64_tr_b16 a[102:103], v35 offset:1568
    ds_read_b64_tr_b16 a[180:181], v35 offset:64
    ds_read_b64_tr_b16 a[182:183], v35 offset:1600
    s_waitcnt lgkmcnt(0)
    s_add_u32 s25, s25, 393216
    s_add_u32 m0, s62, 0
    s_nop 0
    buffer_load_dwordx4 v20, s[8:11], s25 offen lds
    s_add_u32 m0, s62, 1024
    s_nop 0
    buffer_load_dwordx4 v21, s[8:11], s25 offen lds
    s_add_u32 m0, s62, 2048
    s_nop 0
    buffer_load_dwordx4 v22, s[8:11], s25 offen lds
    s_waitcnt vmcnt(12)
    ds_read_b64_tr_b16 a[24:25], v35 offset:3072
    ds_read_b64_tr_b16 a[26:27], v35 offset:4608
    ds_read_b64_tr_b16 a[104:105], v35 offset:3104
    ds_read_b64_tr_b16 a[106:107], v35 offset:4640
    ds_read_b64_tr_b16 a[184:185], v35 offset:3136
    ds_read_b64_tr_b16 a[186:187], v35 offset:4672
    s_waitcnt lgkmcnt(0)
    s_add_u32 s25, s25, 393216
    s_add_u32 m0, s62, 3072
    s_nop 0
    buffer_load_dwordx4 v20, s[8:11], s25 offen lds
    s_add_u32 m0, s62, 4096
    s_nop 0
    buffer_load_dwordx4 v21, s[8:11], s25 offen lds
    s_add_u32 m0, s62, 5120
    s_nop 0
    buffer_load_dwordx4 v22, s[8:11], s25 offen lds
    s_waitcnt vmcnt(12)
    ds_read_b64_tr_b16 a[28:29], v35 offset:6144
    ds_read_b64_tr_b16 a[30:31], v35 offset:7680
    ds_read_b64_tr_b16 a[108:109], v35 offset:6176
    ds_read_b64_tr_b16 a[110:111], v35 offset:7712
    ds_read_b64_tr_b16 a[188:189], v35 offset:6208
    ds_read_b64_tr_b16 a[190:191], v35 offset:7744
    s_waitcnt lgkmcnt(0)
    s_add_u32 s25, s25, 393216
    s_add_u32 m0, s62, 6144
    s_nop 0
    buffer_load_dwordx4 v20, s[8:11], s25 offen lds
    s_add_u32 m0, s62, 7168
    s_nop 0
    buffer_load_dwordx4 v21, s[8:11], s25 offen lds
    s_add_u32 m0, s62, 8192
    s_nop 0
    buffer_load_dwordx4 v22, s[8:11], s25 offen lds
    s_waitcnt vmcnt(12)
    ds_read_b64_tr_b16 a[32:33], v35 offset:9216
    ds_read_b64_tr_b16 a[34:35], v35 offset:10752
    ds_read_b64_tr_b16 a[112:113], v35 offset:9248
    ds_read_b64_tr_b16 a[114:115], v35 offset:10784
    ds_read_b64_tr_b16 a[192:193], v35 offset:9280
    ds_read_b64_tr_b16 a[194:195], v35 offset:10816
    s_waitcnt lgkmcnt(0)
    s_add_u32 s25, s25, 393216
    s_add_u32 m0, s62, 9216
    s_nop 0
    buffer_load_dwordx4 v20, s[8:11], s25 offen lds
    s_add_u32 m0, s62, 10240
    s_nop 0
    buffer_load_dwordx4 v21, s[8:11], s25 offen lds
    s_add_u32 m0, s62, 11264
    s_nop 0
    buffer_load_dwordx4 v22, s[8:11], s25 offen lds
    s_waitcnt vmcnt(12)
    ds_read_b64_tr_b16 a[36:37], v35 offset:12288
    ds_read_b64_tr_b16 a[38:39], v35 offset:13824
    ds_read_b64_tr_b16 a[116:117], v35 offset:12320
    ds_read_b64_tr_b16 a[118:119], v35 offset:13856
    ds_read_b64_tr_b16 a[196:197], v35 offset:12352
    ds_read_b64_tr_b16 a[198:199], v35 offset:13888
    s_waitcnt lgkmcnt(0)
    s_add_u32 s25, s25, 393216
    s_add_u32 m0, s62, 12288
    s_nop 0
    buffer_load_dwordx4 v20, s[8:11], s25 offen lds
    s_add_u32 m0, s62, 13312
    s_nop 0
    buffer_load_dwordx4 v21, s[8:11], s25 offen lds
    s_add_u32 m0, s62, 14336
    s_nop 0
    buffer_load_dwordx4 v22, s[8:11], s25 offen lds
    s_waitcnt vmcnt(12)
    ds_read_b64_tr_b16 a[40:41], v35 offset:0
    ds_read_b64_tr_b16 a[42:43], v35 offset:1536
    ds_read_b64_tr_b16 a[120:121], v35 offset:32
    ds_read_b64_tr_b16 a[122:123], v35 offset:1568
    ds_read_b64_tr_b16 a[200:201], v35 offset:64
    ds_read_b64_tr_b16 a[202:203], v35 offset:1600
    s_waitcnt lgkmcnt(0)
    s_add_u32 s25, s25, 393216
    s_add_u32 m0, s62, 0
    s_nop 0
    buffer_load_dwordx4 v20, s[8:11], s25 offen lds
    s_add_u32 m0, s62, 1024
    s_nop 0
    buffer_load_dwordx4 v21, s[8:11], s25 offen lds
    s_add_u32 m0, s62, 2048
    s_nop 0
    buffer_load_dwordx4 v22, s[8:11], s25 offen lds
    s_waitcnt vmcnt(12)
    ds_read_b64_tr_b16 a[44:45], v35 offset:3072
    ds_read_b64_tr_b16 a[46:47], v35 offset:4608
    ds_read_b64_tr_b16 a[124:125], v35 offset:3104
    ds_read_b64_tr_b16 a[126:127], v35 offset:4640
    ds_read_b64_tr_b16 a[204:205], v35 offset:3136
    ds_read_b64_tr_b16 a[206:207], v35 offset:4672
    s_waitcnt lgkmcnt(0)
    s_add_u32 s25, s25, 393216
    s_add_u32 m0, s62, 3072
    s_nop 0
    buffer_load_dwordx4 v20, s[8:11], s25 offen lds
    s_add_u32 m0, s62, 4096
    s_nop 0
    buffer_load_dwordx4 v21, s[8:11], s25 offen lds
    s_add_u32 m0, s62, 5120
    s_nop 0
    buffer_load_dwordx4 v22, s[8:11], s25 offen lds
    s_waitcnt vmcnt(12)
    ds_read_b64_tr_b16 a[48:49], v35 offset:6144
    ds_read_b64_tr_b16 a[50:51], v35 offset:7680
    ds_read_b64_tr_b16 a[128:129], v35 offset:6176
    ds_read_b64_tr_b16 a[130:131], v35 offset:7712
    ds_read_b64_tr_b16 a[208:209], v35 offset:6208
    ds_read_b64_tr_b16 a[210:211], v35 offset:7744
    s_waitcnt lgkmcnt(0)
    s_add_u32 s25, s25, 393216
    s_add_u32 m0, s62, 6144
    s_nop 0
    buffer_load_dwordx4 v20, s[8:11], s25 offen lds
    s_add_u32 m0, s62, 7168
    s_nop 0
    buffer_load_dwordx4 v21, s[8:11], s25 offen lds
    s_add_u32 m0, s62, 8192
    s_nop 0
    buffer_load_dwordx4 v22, s[8:11], s25 offen lds
    s_waitcnt vmcnt(12)
    ds_read_b64_tr_b16 a[52:53], v35 offset:9216
    ds_read_b64_tr_b16 a[54:55], v35 offset:10752
    ds_read_b64_tr_b16 a[132:133], v35 offset:9248
    ds_read_b64_tr_b16 a[134:135], v35 offset:10784
    ds_read_b64_tr_b16 a[212:213], v35 offset:9280
    ds_read_b64_tr_b16 a[214:215], v35 offset:10816
    s_waitcnt lgkmcnt(0)
    s_add_u32 s25, s25, 393216
    s_add_u32 m0, s62, 9216
    s_nop 0
    buffer_load_dwordx4 v20, s[8:11], s25 offen lds
    s_add_u32 m0, s62, 10240
    s_nop 0
    buffer_load_dwordx4 v21, s[8:11], s25 offen lds
    s_add_u32 m0, s62, 11264
    s_nop 0
    buffer_load_dwordx4 v22, s[8:11], s25 offen lds
    s_waitcnt vmcnt(12)
    ds_read_b64_tr_b16 a[56:57], v35 offset:12288
    ds_read_b64_tr_b16 a[58:59], v35 offset:13824
    ds_read_b64_tr_b16 a[136:137], v35 offset:12320
    ds_read_b64_tr_b16 a[138:139], v35 offset:13856
    ds_read_b64_tr_b16 a[216:217], v35 offset:12352
    ds_read_b64_tr_b16 a[218:219], v35 offset:13888
    s_waitcnt lgkmcnt(0)
    s_add_u32 s25, s25, 393216
    s_add_u32 m0, s62, 12288
    s_nop 0
    buffer_load_dwordx4 v20, s[8:11], s25 offen lds
    s_add_u32 m0, s62, 13312
    s_nop 0
    buffer_load_dwordx4 v21, s[8:11], s25 offen lds
    s_add_u32 m0, s62, 14336
    s_nop 0
    buffer_load_dwordx4 v22, s[8:11], s25 offen lds
    s_waitcnt vmcnt(12)
    ds_read_b64_tr_b16 a[60:61], v35 offset:0
    ds_read_b64_tr_b16 a[62:63], v35 offset:1536
    ds_read_b64_tr_b16 a[140:141], v35 offset:32
    ds_read_b64_tr_b16 a[142:143], v35 offset:1568
    ds_read_b64_tr_b16 a[220:221], v35 offset:64
    ds_read_b64_tr_b16 a[222:223], v35 offset:1600
    s_waitcnt lgkmcnt(0)
    s_waitcnt vmcnt(9)
    ds_read_b64_tr_b16 a[64:65], v35 offset:3072
    ds_read_b64_tr_b16 a[66:67], v35 offset:4608
    ds_read_b64_tr_b16 a[144:145], v35 offset:3104
    ds_read_b64_tr_b16 a[146:147], v35 offset:4640
    ds_read_b64_tr_b16 a[224:225], v35 offset:3136
    ds_read_b64_tr_b16 a[226:227], v35 offset:4672
    s_waitcnt lgkmcnt(0)
    s_waitcnt vmcnt(6)
    ds_read_b64_tr_b16 a[68:69], v35 offset:6144
    ds_read_b64_tr_b16 a[70:71], v35 offset:7680
    ds_read_b64_tr_b16 a[148:149], v35 offset:6176
    ds_read_b64_tr_b16 a[150:151], v35 offset:7712
    ds_read_b64_tr_b16 a[228:229], v35 offset:6208
    ds_read_b64_tr_b16 a[230:231], v35 offset:7744
    s_waitcnt lgkmcnt(0)
    s_waitcnt vmcnt(3)
    ds_read_b64_tr_b16 a[72:73], v35 offset:9216
    ds_read_b64_tr_b16 a[74:75], v35 offset:10752
    ds_read_b64_tr_b16 a[152:153], v35 offset:9248
    ds_read_b64_tr_b16 a[154:155], v35 offset:10784
    ds_read_b64_tr_b16 a[232:233], v35 offset:9280
    ds_read_b64_tr_b16 a[234:235], v35 offset:10816
    s_waitcnt lgkmcnt(0)
    s_add_u32 m0, s62, 0
    s_nop 0
    buffer_load_dwordx4 v25, s[32:35], s27 offen lds
    s_add_u32 m0, s62, 1024
    s_nop 0
    buffer_load_dwordx4 v26, s[32:35], s27 offen lds
    s_add_u32 m0, s62, 2048
    s_nop 0
    buffer_load_dwordx4 v27, s[32:35], s27 offen lds
    s_add_u32 m0, s62, 3072
    s_nop 0
    buffer_load_dwordx4 v28, s[32:35], s27 offen lds
    s_add_u32 m0, s62, 4096
    s_nop 0
    buffer_load_dwordx4 v29, s[32:35], s27 offen lds
    s_add_u32 m0, s62, 5120
    s_nop 0
    buffer_load_dwordx4 v30, s[32:35], s27 offen lds
    s_add_u32 m0, s62, 6144
    s_nop 0
    buffer_load_dwordx4 v31, s[32:35], s27 offen lds
    s_add_u32 m0, s62, 7168
    s_nop 0
    buffer_load_dwordx4 v32, s[32:35], s27 offen lds
    s_add_u32 m0, s62, 8192
    s_nop 0
    buffer_load_dwordx4 v33, s[32:35], s27 offen lds
    s_add_u32 m0, s62, 9216
    s_nop 0
    buffer_load_dwordx4 v34, s[32:35], s27 offen lds
    s_waitcnt vmcnt(10)
    ds_read_b64_tr_b16 a[76:77], v35 offset:12288
    ds_read_b64_tr_b16 a[78:79], v35 offset:13824
    ds_read_b64_tr_b16 a[156:157], v35 offset:12320
    ds_read_b64_tr_b16 a[158:159], v35 offset:13856
    ds_read_b64_tr_b16 a[236:237], v35 offset:12352
    ds_read_b64_tr_b16 a[238:239], v35 offset:13888
    s_waitcnt lgkmcnt(0)
    s_waitcnt vmcnt(0)
    ds_read_b64_tr_b16 v[96:97], v37 offset:0
    ds_read_b64_tr_b16 v[98:99], v37 offset:5120
    ds_read_b64_tr_b16 v[108:109], v37 offset:32
    ds_read_b64_tr_b16 v[110:111], v37 offset:5152
    ds_read_b64_tr_b16 v[120:121], v37 offset:64
    ds_read_b64_tr_b16 v[122:123], v37 offset:5184
    ds_read_b64_tr_b16 v[132:133], v37 offset:96
    ds_read_b64_tr_b16 v[134:135], v37 offset:5216
    ds_read_b64_tr_b16 v[144:145], v37 offset:128
    ds_read_b64_tr_b16 v[146:147], v37 offset:5248
    ds_read_b64_tr_b16 v[156:157], v37 offset:160
    ds_read_b64_tr_b16 v[158:159], v37 offset:5280
    ds_read_b64_tr_b16 v[168:169], v37 offset:192
    ds_read_b64_tr_b16 v[170:171], v37 offset:5312
    ds_read_b64_tr_b16 v[180:181], v37 offset:224
    ds_read_b64_tr_b16 v[182:183], v37 offset:5344
    ds_read_b64_tr_b16 v[192:193], v37 offset:256
    ds_read_b64_tr_b16 v[194:195], v37 offset:5376
    ds_read_b64_tr_b16 v[204:205], v37 offset:288
    ds_read_b64_tr_b16 v[206:207], v37 offset:5408
    s_waitcnt lgkmcnt(0)
    s_add_u32 s27, s27, 40960
    s_add_u32 m0, s62, 0
    s_nop 0
    buffer_load_dwordx4 v25, s[32:35], s27 offen lds
    s_add_u32 m0, s62, 1024
    s_nop 0
    buffer_load_dwordx4 v26, s[32:35], s27 offen lds
    s_add_u32 m0, s62, 2048
    s_nop 0
    buffer_load_dwordx4 v27, s[32:35], s27 offen lds
    s_add_u32 m0, s62, 3072
    s_nop 0
    buffer_load_dwordx4 v28, s[32:35], s27 offen lds
    s_add_u32 m0, s62, 4096
    s_nop 0
    buffer_load_dwordx4 v29, s[32:35], s27 offen lds
    s_add_u32 m0, s62, 5120
    s_nop 0
    buffer_load_dwordx4 v30, s[32:35], s27 offen lds
    s_add_u32 m0, s62, 6144
    s_nop 0
    buffer_load_dwordx4 v31, s[32:35], s27 offen lds
    s_add_u32 m0, s62, 7168
    s_nop 0
    buffer_load_dwordx4 v32, s[32:35], s27 offen lds
    s_add_u32 m0, s62, 8192
    s_nop 0
    buffer_load_dwordx4 v33, s[32:35], s27 offen lds
    s_add_u32 m0, s62, 9216
    s_nop 0
    buffer_load_dwordx4 v34, s[32:35], s27 offen lds
    s_waitcnt vmcnt(0)
    ds_read_b64_tr_b16 v[100:101], v37 offset:0
    ds_read_b64_tr_b16 v[102:103], v37 offset:5120
    ds_read_b64_tr_b16 v[112:113], v37 offset:32
    ds_read_b64_tr_b16 v[114:115], v37 offset:5152
    ds_read_b64_tr_b16 v[124:125], v37 offset:64
    ds_read_b64_tr_b16 v[126:127], v37 offset:5184
    ds_read_b64_tr_b16 v[136:137], v37 offset:96
    ds_read_b64_tr_b16 v[138:139], v37 offset:5216
    ds_read_b64_tr_b16 v[148:149], v37 offset:128
    ds_read_b64_tr_b16 v[150:151], v37 offset:5248
    ds_read_b64_tr_b16 v[160:161], v37 offset:160
    ds_read_b64_tr_b16 v[162:163], v37 offset:5280
    ds_read_b64_tr_b16 v[172:173], v37 offset:192
    ds_read_b64_tr_b16 v[174:175], v37 offset:5312
    ds_read_b64_tr_b16 v[184:185], v37 offset:224
    ds_read_b64_tr_b16 v[186:187], v37 offset:5344
    ds_read_b64_tr_b16 v[196:197], v37 offset:256
    ds_read_b64_tr_b16 v[198:199], v37 offset:5376
    ds_read_b64_tr_b16 v[208:209], v37 offset:288
    ds_read_b64_tr_b16 v[210:211], v37 offset:5408
    s_waitcnt lgkmcnt(0)
    s_add_u32 s27, s27, 40960
    s_add_u32 m0, s62, 0
    s_nop 0
    buffer_load_dwordx4 v25, s[32:35], s27 offen lds
    s_add_u32 m0, s62, 1024
    s_nop 0
    buffer_load_dwordx4 v26, s[32:35], s27 offen lds
    s_add_u32 m0, s62, 2048
    s_nop 0
    buffer_load_dwordx4 v27, s[32:35], s27 offen lds
    s_add_u32 m0, s62, 3072
    s_nop 0
    buffer_load_dwordx4 v28, s[32:35], s27 offen lds
    s_add_u32 m0, s62, 4096
    s_nop 0
    buffer_load_dwordx4 v29, s[32:35], s27 offen lds
    s_add_u32 m0, s62, 5120
    s_nop 0
    buffer_load_dwordx4 v30, s[32:35], s27 offen lds
    s_add_u32 m0, s62, 6144
    s_nop 0
    buffer_load_dwordx4 v31, s[32:35], s27 offen lds
    s_add_u32 m0, s62, 7168
    s_nop 0
    buffer_load_dwordx4 v32, s[32:35], s27 offen lds
    s_add_u32 m0, s62, 8192
    s_nop 0
    buffer_load_dwordx4 v33, s[32:35], s27 offen lds
    s_add_u32 m0, s62, 9216
    s_nop 0
    buffer_load_dwordx4 v34, s[32:35], s27 offen lds
    s_waitcnt vmcnt(0)
    ds_read_b64_tr_b16 v[104:105], v37 offset:0
    ds_read_b64_tr_b16 v[106:107], v37 offset:5120
    ds_read_b64_tr_b16 v[116:117], v37 offset:32
    ds_read_b64_tr_b16 v[118:119], v37 offset:5152
    ds_read_b64_tr_b16 v[128:129], v37 offset:64
    ds_read_b64_tr_b16 v[130:131], v37 offset:5184
    ds_read_b64_tr_b16 v[140:141], v37 offset:96
    ds_read_b64_tr_b16 v[142:143], v37 offset:5216
    ds_read_b64_tr_b16 v[152:153], v37 offset:128
    ds_read_b64_tr_b16 v[154:155], v37 offset:5248
    ds_read_b64_tr_b16 v[164:165], v37 offset:160
    ds_read_b64_tr_b16 v[166:167], v37 offset:5280
    ds_read_b64_tr_b16 v[176:177], v37 offset:192
    ds_read_b64_tr_b16 v[178:179], v37 offset:5312
    ds_read_b64_tr_b16 v[188:189], v37 offset:224
    ds_read_b64_tr_b16 v[190:191], v37 offset:5344
    ds_read_b64_tr_b16 v[200:201], v37 offset:256
    ds_read_b64_tr_b16 v[202:203], v37 offset:5376
    ds_read_b64_tr_b16 v[212:213], v37 offset:288
    ds_read_b64_tr_b16 v[214:215], v37 offset:5408
    s_waitcnt lgkmcnt(0)
    v_and_b32 v10, 15, v0
    v_lshrrev_b32 v11, 4, v0
    v_and_b32 v12, 7, v0
    v_and_b32 v13, 1, v0
    v_mov_b32 v14, 0x3f80
    v_lshlrev_b32 v13, 4, v13
    v_lshlrev_b32 v14, v13, v14
    v_lshrrev_b32 v12, 1, v12
    v_lshrrev_b32 v13, 2, v10
    v_cmp_eq_u32 s[38:39], v13, v11
    v_bfe_u32 v13, v0, 1, 1
    s_nop 0
    v_cndmask_b32 v17, 0, v14, s[38:39]
    v_cmp_eq_u32 vcc, 0, v12
    s_nop 1
    v_cndmask_b32 v15, 0, v14, vcc
    v_accvgpr_write_b32 a248, v15
    v_cmp_eq_u32 vcc, 0, v13
    s_nop 1
    v_cndmask_b32 v16, 0, v17, vcc
    v_accvgpr_write_b32 a240, v16
    v_accvgpr_write_b32 a244, 0
    v_cmp_eq_u32 vcc, 1, v12
    s_nop 1
    v_cndmask_b32 v15, 0, v14, vcc
    v_accvgpr_write_b32 a249, v15
    v_cmp_eq_u32 vcc, 1, v13
    s_nop 1
    v_cndmask_b32 v16, 0, v17, vcc
    v_accvgpr_write_b32 a241, v16
    v_accvgpr_write_b32 a245, 0
    v_cmp_eq_u32 vcc, 2, v12
    s_nop 1
    v_cndmask_b32 v15, 0, v14, vcc
    v_accvgpr_write_b32 a250, v15
    v_cmp_eq_u32 vcc, 0, v13
    s_nop 1
    v_cndmask_b32 v16, 0, v17, vcc
    v_accvgpr_write_b32 a246, v16
    v_accvgpr_write_b32 a242, 0
    v_cmp_eq_u32 vcc, 3, v12
    s_nop 1
    v_cndmask_b32 v15, 0, v14, vcc
    v_accvgpr_write_b32 a251, v15
    v_cmp_eq_u32 vcc, 1, v13
    s_nop 1
    v_cndmask_b32 v16, 0, v17, vcc
    v_accvgpr_write_b32 a247, v16
    v_accvgpr_write_b32 a243, 0
    v_cmp_gt_u32 s[48:49], 8, v10
    v_cmp_gt_u32 vcc, 2, v11
    s_xnor_b64 s[50:51], vcc, s[48:49]
    s_mul_i32 s60, s15, 640
    s_mov_b32 s61, 20480
    v_add_u32 v12, 960, v0
    v_mul_u32_u24 v13, 52429, v12
    v_lshrrev_b32 v13, 21, v13
    v_mul_u32_u24 v14, 40, v13
    v_sub_u32 v14, v12, v14
    v_mul_lo_u32 v13, v13, s61
    v_lshl_add_u32 v13, v14, 4, v13
    v_add_u32 v3, s60, v13
    v_add_u32 v12, 1024, v0
    v_mul_u32_u24 v13, 52429, v12
    v_lshrrev_b32 v13, 21, v13
    v_mul_u32_u24 v14, 40, v13
    v_sub_u32 v14, v12, v14
    v_mul_lo_u32 v13, v13, s61
    v_lshl_add_u32 v13, v14, 4, v13
    v_add_u32 v4, s60, v13
    v_add_u32 v12, 1088, v0
    v_mul_u32_u24 v13, 52429, v12
    v_lshrrev_b32 v13, 21, v13
    v_mul_u32_u24 v14, 40, v13
    v_sub_u32 v14, v12, v14
    v_mul_lo_u32 v13, v13, s61
    v_lshl_add_u32 v13, v14, 4, v13
    v_add_u32 v5, s60, v13
    v_add_u32 v12, 1152, v0
    v_mul_u32_u24 v13, 52429, v12
    v_lshrrev_b32 v13, 21, v13
    v_mul_u32_u24 v14, 40, v13
    v_sub_u32 v14, v12, v14
    v_mul_lo_u32 v13, v13, s61
    v_lshl_add_u32 v13, v14, 4, v13
    v_add_u32 v6, s60, v13
    v_add_u32 v12, 1216, v0
    v_mul_u32_u24 v13, 52429, v12
    v_lshrrev_b32 v13, 21, v13
    v_mul_u32_u24 v14, 40, v13
    v_sub_u32 v14, v12, v14
    v_mul_lo_u32 v13, v13, s61
    v_lshl_add_u32 v13, v14, 4, v13
    v_add_u32 v7, s60, v13
    s_mul_i32 s60, s15, 20480
    s_add_u32 s60, s60, 512
    v_lshrrev_b32 v12, 4, v0
    v_mul_u32_u24 v12, 640, v12
    v_and_b32 v13, 15, v0
    v_lshl_add_u32 v12, v13, 4, v12
    v_add_u32 v8, s60, v12
    s_mul_i32 s60, s15, 40
    s_add_u32 s60, s60, 32
    v_add_u32 v12, s60, v10
    v_lshlrev_b32 v9, 4, v12
    s_mul_i32 s32, s14, 655360
    s_add_u32 s32, s32, 1310720
    s_add_u32 s33, s32, 5120
    s_add_u32 s34, s32, 10240
    s_add_u32 s35, s32, 15360
    s_mov_b32 s52, 1037384597
    s_mov_b32 s53, 1037384597
    s_lshl_b32 s29, s13, 12
    s_add_u32 s29, s29, 919552
    s_xor_b32 s30, s29, 4096
    s_mov_b64 s[46:47], 65535
    s_mov_b32 s8, s66
    s_and_b32 s9, s67, 0xffff
    s_mov_b32 s10, 10240
    s_mov_b32 s11, 0x20000
    v_and_b32 v13, 7, v12
    v_mul_u32_u24 v13, 1280, v13
    v_lshrrev_b32 v14, 6, v12
    v_lshl_add_u32 v13, v14, 6, v13
    v_bfe_u32 v14, v12, 4, 2
    v_lshl_add_u32 v13, v14, 3, v13
    v_and_b32 v14, 8, v12
    v_cmp_eq_u32 s[38:39], 0, v14
    v_cmp_ne_u32 s[40:41], 0, v14
    s_cmp_eq_u32 s14, 0
    s_cselect_b32 s10, 10240, 0
    buffer_load_dwordx2 v[16:17], v13, s[8:11], 0 offen
    buffer_load_dwordx2 v[18:19], v13, s[8:11], 0 offen offset:32
    s_waitcnt vmcnt(0)
    v_accvgpr_write_b32 a252, v16
    v_accvgpr_write_b32 a253, v17
    v_accvgpr_write_b32 a254, v18
    v_accvgpr_write_b32 a255, v19
    s_lshl_b32 s3, s18, 2
    s_add_u32 s3, s3, 64
    v_mov_b32 v92, s3
    v_lshlrev_b32 v94, 2, v0
    v_and_b32 v94, 28, v94
    s_mov_b32 s19, 0
L_R3_warr_2:
    global_load_dword v93, v92, s[16:17] sc1
    s_add_u32 s19, s19, 1
    s_cmp_ge_u32 s19, 524288
    s_cbranch_scc1 L_fail
    s_waitcnt vmcnt(0)
    v_cmp_gt_u32 vcc, 256, v93
    s_nop 0
    s_cbranch_vccnz L_R3_warr_2
    s_cmp_lg_u32 s18, 0
    s_cbranch_scc1 L_R3_placed_3
    global_load_dword v93, v94, s[16:17] sc1
    s_waitcnt vmcnt(0)
    v_cmp_ne_u32 vcc, 32, v93
    s_nop 0
    s_cbranch_vccnz L_fallback
L_R3_placed_3:
    v_lshlrev_b32 v0, 4, v0
    s_mov_b32 s20, 0
    s_barrier
    v_lshlrev_b32 v217, 3, v0
    v_and_b32 v217, 0x780, v217
    v_bfe_u32 v218, v0, 8, 1
    v_lshl_add_u32 v217, v218, 2, v217
    s_add_u32 s60, s20, 0
    s_add_u32 s58, s60, 1
    s_cmp_gt_u32 s60, 63
    s_cselect_b32 s58, 0, s58
    s_sub_u32 s59, s60, 4
    s_cmp_lt_u32 s60, 5
    s_cselect_b32 s59, 0, s59
    v_mov_b32 v216, s58
    v_mov_b32 v218, s59
    v_cmp_gt_u32 vcc, 256, v0
    s_nop 1
    v_cndmask_b32 v216, v218, v216, vcc
    buffer_load_dword v218, v217, s[4:7], s55 offen sc1
    s_waitcnt vmcnt(0)
    s_mov_b32 s19, 0
L_R3_kvchk_4:
    v_cmp_lt_u32 vcc, v218, v216
    s_and_b64 vcc, vcc, 0x0fff0fff
    s_cbranch_vccnz L_R3_kvretry_5
    s_cmp_eq_u32 s58, 0
    s_cbranch_scc1 L_R3_kv1_6
    s_sub_u32 s60, s58, 1
    s_lshl_b32 s60, s60, 6
    s_add_u32 s60, s60, s13
    s_mul_i32 s60, s60, 12288
    s_add_u32 s60, s60, 37355520
    s_mov_b32 m0, 29696
    s_nop 0
    buffer_load_dwordx4 v0, s[4:7], s60 offen offset:0 sc1 lds
    buffer_load_dwordx4 v0, s[4:7], s60 offen offset:1024 sc1 lds
    buffer_load_dwordx4 v0, s[4:7], s60 offen offset:2048 sc1 lds
    s_add_u32 s60, s60, 3072
    s_mov_b32 m0, 32768
    s_nop 0
    buffer_load_dwordx4 v0, s[4:7], s60 offen offset:0 sc1 lds
    buffer_load_dwordx4 v0, s[4:7], s60 offen offset:1024 sc1 lds
    buffer_load_dwordx4 v0, s[4:7], s60 offen offset:2048 sc1 lds
L_R3_kv1_6:
    s_cmp_eq_u32 s59, 0
    s_cbranch_scc1 L_R3_kv2_7
    s_sub_u32 s60, s59, 1
    s_lshl_b32 s60, s60, 6
    s_add_u32 s60, s60, s13
    s_mul_i32 s60, s60, 12288
    s_add_u32 s60, s60, 87687168
    s_mov_b32 m0, 41984
    s_nop 0
    buffer_load_dwordx4 v0, s[4:7], s60 offen offset:0 sc1 lds
    buffer_load_dwordx4 v0, s[4:7], s60 offen offset:1024 sc1 lds
    buffer_load_dwordx4 v0, s[4:7], s60 offen offset:2048 sc1 lds
    s_add_u32 s60, s60, 3072
    s_mov_b32 m0, 45056
    s_nop 0
    buffer_load_dwordx4 v0, s[4:7], s60 offen offset:0 sc1 lds
    buffer_load_dwordx4 v0, s[4:7], s60 offen offset:1024 sc1 lds
    buffer_load_dwordx4 v0, s[4:7], s60 offen offset:2048 sc1 lds
L_R3_kv2_7:
    s_branch L_R3_go_8
L_R3_kvretry_5:
    s_add_u32 s19, s19, 1
    s_cmp_ge_u32 s19, 524288
    s_cbranch_scc1 L_fail
    s_waitcnt vmcnt(0) lgkmcnt(0)
    buffer_load_dword v218, v217, s[4:7], s55 offen sc1
    s_waitcnt vmcnt(0)
    s_branch L_R3_kvchk_4
L_R3_go_8:
    s_add_u32 s60, s20, 1
    s_add_u32 s58, s60, 1
    s_cmp_gt_u32 s60, 63
    s_cselect_b32 s58, 0, s58
    s_sub_u32 s59, s60, 4
    s_cmp_lt_u32 s60, 5
    s_cselect_b32 s59, 0, s59
    v_mov_b32 v216, s58
    v_mov_b32 v218, s59
    v_cmp_gt_u32 vcc, 256, v0
    s_nop 1
    v_cndmask_b32 v216, v218, v216, vcc
    s_add_u32 s60, s20, 1
    s_and_b32 s22, s60, 1
    s_lshl_b32 s21, s22, 31
    s_sub_u32 s44, 0, s22
    s_bfe_u32 s23, s20, 0x10001
    s_sub_u32 s23, s23, 1
    s_lshr_b32 s24, s60, 1
    s_andn2_b32 s24, 1, s24
    s_lshl_b32 s61, s14, 15
    s_add_u32 s61, s61, 1179648
    s_and_b32 s25, s20, 1
    s_lshl_b32 s25, s25, 16
    s_add_u32 s25, s25, s61
    s_add_u32 s25, s25, 15360
    s_add_u32 s26, s25, 4096
    s_lshl_b32 s36, s22, 16
    s_add_u32 s36, s36, s61
    s_lshl_b32 s27, s20, 1
    s_add_u32 s37, s27, 2
    s_add_u32 s37, s37, s14
    s_mul_i32 s37, s37, 20480
    s_add_u32 s37, s37, 2621440
    s_add_u32 s27, s27, 1
    s_sub_u32 s27, s27, s14
    s_mul_i32 s27, s27, 20480
    s_add_u32 s27, s27, 2636800
    s_add_u32 s28, s27, 4096
    s_lshl_b32 s31, s20, 6
    s_add_u32 s31, s31, s13
    s_mul_i32 s31, s31, 6144
    s_add_u32 s31, s31, 5898240
    s_min_u32 s56, s20, 63
    s_lshl_b32 s56, s56, 6
    s_add_u32 s56, s56, s13
    s_mul_i32 s56, s56, 12288
    s_add_u32 s56, s56, 37364736
    s_max_u32 s57, s20, 5
    s_sub_u32 s57, s57, 5
    s_lshl_b32 s57, s57, 6
    s_add_u32 s57, s57, s13
    s_mul_i32 s57, s57, 12288
    s_add_u32 s57, s57, 87696384
    s_cmp_lt_u32 s20, 5
    s_cselect_b32 s57, s56, s57
    s_cmp_gt_u32 s60, 63
    s_cselect_b64 s[42:43], s[38:39], 0
    s_cmp_le_u32 s60, 5
    s_cselect_b64 vcc, s[40:41], 0
    s_or_b64 s[42:43], s[42:43], vcc
    s_cmp_lg_u32 s18, 0
    s_cbranch_scc1 L_R3_slow
L_Rf3_top:
    s_barrier
    buffer_load_dwordx4 v[10:13], v0, s[4:7], s25 offen offset:0 sc1
    buffer_load_dwordx4 v[14:17], v0, s[4:7], s25 offen offset:1024 sc1
    buffer_load_dwordx4 v[18:21], v0, s[4:7], s25 offen offset:2048 sc1
    buffer_load_dwordx4 v[22:25], v0, s[4:7], s25 offen offset:3072 sc1
    buffer_load_dwordx4 v[26:29], v0, s[4:7], s26 offen offset:0 sc1
    s_barrier
    buffer_load_dwordx4 v[46:49], v0, s[4:7], s27 offen offset:0 sc1
    buffer_load_dwordx4 v[30:33], v0, s[4:7], s27 offen offset:1024 sc1
    buffer_load_dwordx4 v[34:37], v0, s[4:7], s27 offen offset:2048 sc1
    buffer_load_dwordx4 v[38:41], v0, s[4:7], s27 offen offset:3072 sc1
    buffer_load_dwordx4 v[42:45], v0, s[4:7], s28 offen offset:0 sc1
    s_mov_b32 s19, 0
L_Rf3_gl_1:
    s_waitcnt vmcnt(9)
    v_mfma_f32_16x16x32_bf16 v[50:53], a[240:243], v[10:13], 0
    v_mfma_f32_16x16x32_bf16 v[54:57], a[244:247], v[10:13], 0
    v_xor_b32 v1, s23, v10
    s_waitcnt vmcnt(8)
    v_mfma_f32_16x16x32_bf16 v[58:61], a[240:243], v[14:17], 0
    v_mfma_f32_16x16x32_bf16 v[62:65], a[244:247], v[14:17], 0
    v_bitop3_b32 v1, v1, v14, s23 bitop3:0xf6
    s_waitcnt vmcnt(7)
    v_mfma_f32_16x16x32_bf16 v[66:69], a[240:243], v[18:21], 0
    v_mfma_f32_16x16x32_bf16 v[70:73], a[244:247], v[18:21], 0
    v_bitop3_b32 v1, v1, v18, s23 bitop3:0xf6
    s_waitcnt vmcnt(6)
    v_mfma_f32_16x16x32_bf16 v[74:77], a[240:243], v[22:25], 0
    v_mfma_f32_16x16x32_bf16 v[78:81], a[244:247], v[22:25], 0
    v_bitop3_b32 v1, v1, v22, s23 bitop3:0xf6
    s_waitcnt vmcnt(5)
    v_mfma_f32_16x16x32_bf16 v[82:85], a[240:243], v[26:29], 0
    v_mfma_f32_16x16x32_bf16 v[86:89], a[244:247], v[26:29], 0
    v_bitop3_b32 v1, v1, v26, s23 bitop3:0xf6
    v_and_b32 v1, 1, v1
    v_cmp_ne_u32 vcc, 0, v1
    s_nop 0
    s_cbranch_vccnz L_Rf3_glfix_3
L_Rf3_gr_2:
    s_waitcnt vmcnt(4)
    v_mfma_f32_16x16x32_bf16 v[50:53], a[240:243], v[46:49], v[50:53]
    v_xor_b32 v1, s23, v46
    v_mfma_f32_16x16x32_bf16 v[54:57], a[244:247], v[46:49], v[54:57]
    s_waitcnt vmcnt(3)
    v_mfma_f32_16x16x32_bf16 v[58:61], a[240:243], v[30:33], v[58:61]
    v_bitop3_b32 v1, v1, v30, s23 bitop3:0xf6
    v_mfma_f32_16x16x32_bf16 v[62:65], a[244:247], v[30:33], v[62:65]
    s_nop 1
    v_cvt_pk_bf16_f32 v90, v50, v51
    v_cvt_pk_bf16_f32 v91, v52, v53
    v_cvt_pk_bf16_f32 v92, v54, v55
    v_cvt_pk_bf16_f32 v93, v56, v57
    ds_write_b128 v0, v[90:93] offset:15360
    s_waitcnt vmcnt(2)
    v_mfma_f32_16x16x32_bf16 v[66:69], a[240:243], v[34:37], v[66:69]
    v_bitop3_b32 v1, v1, v34, s23 bitop3:0xf6
    v_mfma_f32_16x16x32_bf16 v[70:73], a[244:247], v[34:37], v[70:73]
    v_cvt_pk_bf16_f32 v90, v58, v59
    v_cvt_pk_bf16_f32 v91, v60, v61
    v_cvt_pk_bf16_f32 v92, v62, v63
    v_cvt_pk_bf16_f32 v93, v64, v65
    ds_write_b128 v0, v[90:93] offset:16384
    s_waitcnt vmcnt(1)
    v_mfma_f32_16x16x32_bf16 v[74:77], a[240:243], v[38:41], v[74:77]
    v_bitop3_b32 v1, v1, v38, s23 bitop3:0xf6
    v_mfma_f32_16x16x32_bf16 v[78:81], a[244:247], v[38:41], v[78:81]
    v_cvt_pk_bf16_f32 v90, v66, v67
    v_cvt_pk_bf16_f32 v91, v68, v69
    v_cvt_pk_bf16_f32 v92, v70, v71
    v_cvt_pk_bf16_f32 v93, v72, v73
    ds_write_b128 v0, v[90:93] offset:17408
    s_waitcnt vmcnt(0)
    v_mfma_f32_16x16x32_bf16 v[82:85], a[240:243], v[42:45], v[82:85]
    v_bitop3_b32 v1, v1, v42, s23 bitop3:0xf6
    v_mfma_f32_16x16x32_bf16 v[86:89], a[244:247], v[42:45], v[86:89]
    v_cvt_pk_bf16_f32 v90, v74, v75
    v_cvt_pk_bf16_f32 v91, v76, v77
    v_cvt_pk_bf16_f32 v92, v78, v79
    v_cvt_pk_bf16_f32 v93, v80, v81
    ds_write_b128 v0, v[90:93] offset:18432
    s_nop 0
    v_cvt_pk_bf16_f32 v90, v82, v83
    v_cvt_pk_bf16_f32 v91, v84, v85
    v_cvt_pk_bf16_f32 v92, v86, v87
    v_cvt_pk_bf16_f32 v93, v88, v89
    ds_write_b128 v0, v[90:93] offset:19456
    v_and_b32 v1, 1, v1
    v_cmp_ne_u32 vcc, 0, v1
    s_nop 0
    s_cbranch_vccnz L_Rf3_grfix_5
    s_waitcnt lgkmcnt(0)
    s_barrier
    ds_read_b128 v[10:13], v0 offset:0
    ds_read_b128 v[14:17], v0 offset:1024
    ds_read_b128 v[18:21], v0 offset:2048
    ds_read_b128 v[22:25], v0 offset:3072
    ds_read_b128 v[26:29], v0 offset:4096
    s_waitcnt lgkmcnt(4)
    v_mfma_f32_16x16x32_bf16 v[46:49], a[0:3], v[10:13], 0
    s_mov_b32 m0, 51200
    v_mfma_f32_16x16x32_bf16 v[50:53], a[80:83], v[10:13], 0
    buffer_load_dword v218, v217, s[4:7], s55 offen sc1
    v_mfma_f32_16x16x32_bf16 v[54:57], a[160:163], v[10:13], 0
    v_mov_b32 v1, s20
    s_mov_b64 exec, 1
    buffer_store_dword v1, v0, s[4:7], s54 offen sc1
    s_mov_b64 exec, -1
    ds_read_b128 v[10:13], v0 offset:5120
    s_waitcnt lgkmcnt(4)
    v_mfma_f32_16x16x32_bf16 v[46:49], a[4:7], v[14:17], v[46:49]
    buffer_load_dwordx4 v0, s[4:7], s57 offen offset:0 sc1 lds
    v_mfma_f32_16x16x32_bf16 v[50:53], a[84:87], v[14:17], v[50:53]
    v_mfma_f32_16x16x32_bf16 v[54:57], a[164:167], v[14:17], v[54:57]
    ds_read_b128 v[14:17], v0 offset:6144
    s_waitcnt lgkmcnt(4)
    v_mfma_f32_16x16x32_bf16 v[46:49], a[8:11], v[18:21], v[46:49]
    buffer_load_dwordx4 v0, s[4:7], s57 offen offset:1024 sc1 lds
    v_mfma_f32_16x16x32_bf16 v[50:53], a[88:91], v[18:21], v[50:53]
    v_mfma_f32_16x16x32_bf16 v[54:57], a[168:171], v[18:21], v[54:57]
    ds_read_b128 v[18:21], v0 offset:7168
    s_waitcnt lgkmcnt(4)
    v_mfma_f32_16x16x32_bf16 v[46:49], a[12:15], v[22:25], v[46:49]
    buffer_load_dwordx4 v0, s[4:7], s57 offen offset:2048 sc1 lds
    v_mfma_f32_16x16x32_bf16 v[50:53], a[92:95], v[22:25], v[50:53]
    v_mfma_f32_16x16x32_bf16 v[54:57], a[172:175], v[22:25], v[54:57]
    ds_read_b128 v[22:25], v0 offset:8192
    s_waitcnt lgkmcnt(4)
    v_mfma_f32_16x16x32_bf16 v[46:49], a[16:19], v[26:29], v[46:49]
    v_mfma_f32_16x16x32_bf16 v[50:53], a[96:99], v[26:29], v[50:53]
    v_mfma_f32_16x16x32_bf16 v[54:57], a[176:179], v[26:29], v[54:57]
    ds_read_b128 v[26:29], v0 offset:9216
    s_waitcnt lgkmcnt(4)
    v_mfma_f32_16x16x32_bf16 v[46:49], a[20:23], v[10:13], v[46:49]
    v_mfma_f32_16x16x32_bf16 v[50:53], a[100:103], v[10:13], v[50:53]
    v_mfma_f32_16x16x32_bf16 v[54:57], a[180:183], v[10:13], v[54:57]
    ds_read_b128 v[10:13], v0 offset:10240
    s_waitcnt lgkmcnt(4)
    v_mfma_f32_16x16x32_bf16 v[46:49], a[24:27], v[14:17], v[46:49]
    v_mfma_f32_16x16x32_bf16 v[50:53], a[104:107], v[14:17], v[50:53]
    v_mfma_f32_16x16x32_bf16 v[54:57], a[184:187], v[14:17], v[54:57]
    ds_read_b128 v[14:17], v0 offset:11264
    s_waitcnt lgkmcnt(4)
    v_mfma_f32_16x16x32_bf16 v[46:49], a[28:31], v[18:21], v[46:49]
    v_mfma_f32_16x16x32_bf16 v[50:53], a[108:111], v[18:21], v[50:53]
    v_mfma_f32_16x16x32_bf16 v[54:57], a[188:191], v[18:21], v[54:57]
    ds_read_b128 v[18:21], v0 offset:12288
    s_waitcnt lgkmcnt(4)
    v_mfma_f32_16x16x32_bf16 v[46:49], a[32:35], v[22:25], v[46:49]
    v_mfma_f32_16x16x32_bf16 v[50:53], a[112:115], v[22:25], v[50:53]
    v_mfma_f32_16x16x32_bf16 v[54:57], a[192:195], v[22:25], v[54:57]
    ds_read_b128 v[22:25], v0 offset:13312
    s_waitcnt lgkmcnt(4)
    v_mfma_f32_16x16x32_bf16 v[46:49], a[36:39], v[26:29], v[46:49]
    v_mfma_f32_16x16x32_bf16 v[50:53], a[116:119], v[26:29], v[50:53]
    v_mfma_f32_16x16x32_bf16 v[54:57], a[196:199], v[26:29], v[54:57]
    ds_read_b128 v[26:29], v0 offset:14336
    s_waitcnt lgkmcnt(4)
    v_mfma_f32_16x16x32_bf16 v[46:49], a[40:43], v[10:13], v[46:49]
    v_mfma_f32_16x16x32_bf16 v[50:53], a[120:123], v[10:13], v[50:53]
    v_mfma_f32_16x16x32_bf16 v[54:57], a[200:203], v[10:13], v[54:57]
    ds_read_b128 v[10:13], v0 offset:15360
    s_waitcnt lgkmcnt(4)
    v_mfma_f32_16x16x32_bf16 v[46:49], a[44:47], v[14:17], v[46:49]
    ds_read_b128 v[58:61], v0 offset:32768
    v_mfma_f32_16x16x32_bf16 v[50:53], a[124:127], v[14:17], v[50:53]
    v_mfma_f32_16x16x32_bf16 v[54:57], a[204:207], v[14:17], v[54:57]
    ds_read_b128 v[14:17], v0 offset:16384
    s_waitcnt lgkmcnt(5)
    v_mfma_f32_16x16x32_bf16 v[46:49], a[48:51], v[18:21], v[46:49]
    ds_read_b128 v[62:65], v0 offset:33792
    v_mfma_f32_16x16x32_bf16 v[50:53], a[128:131], v[18:21], v[50:53]
    v_mfma_f32_16x16x32_bf16 v[54:57], a[208:211], v[18:21], v[54:57]
    ds_read_b128 v[18:21], v0 offset:17408
    s_waitcnt lgkmcnt(6)
    v_mfma_f32_16x16x32_bf16 v[46:49], a[52:55], v[22:25], v[46:49]
    ds_read_b128 v[66:69], v0 offset:34816
    v_mfma_f32_16x16x32_bf16 v[50:53], a[132:135], v[22:25], v[50:53]
    v_mfma_f32_16x16x32_bf16 v[54:57], a[212:215], v[22:25], v[54:57]
    ds_read_b128 v[22:25], v0 offset:18432
    s_waitcnt lgkmcnt(7)
    v_mfma_f32_16x16x32_bf16 v[46:49], a[56:59], v[26:29], v[46:49]
    ds_read_b128 v[70:73], v0 offset:45056
    v_mfma_f32_16x16x32_bf16 v[50:53], a[136:139], v[26:29], v[50:53]
    v_mfma_f32_16x16x32_bf16 v[54:57], a[216:219], v[26:29], v[54:57]
    ds_read_b128 v[26:29], v0 offset:19456
    s_waitcnt lgkmcnt(8)
    v_mfma_f32_16x16x32_bf16 v[46:49], a[60:63], v[10:13], v[46:49]
    ds_read_b128 v[74:77], v0 offset:46080
    v_mfma_f32_16x16x32_bf16 v[50:53], a[140:143], v[10:13], v[50:53]
    v_mfma_f32_16x16x32_bf16 v[54:57], a[220:223], v[10:13], v[54:57]
    s_waitcnt lgkmcnt(7)
    v_mfma_f32_16x16x32_bf16 v[46:49], a[64:67], v[14:17], v[46:49]
    ds_read_b128 v[78:81], v0 offset:47104
    v_mfma_f32_16x16x32_bf16 v[50:53], a[144:147], v[14:17], v[50:53]
    v_mfma_f32_16x16x32_bf16 v[54:57], a[224:227], v[14:17], v[54:57]
    s_waitcnt lgkmcnt(6)
    v_mfma_f32_16x16x32_bf16 v[46:49], a[68:71], v[18:21], v[46:49]
    v_mfma_f32_16x16x32_bf16 v[50:53], a[148:151], v[18:21], v[50:53]
    v_mfma_f32_16x16x32_bf16 v[54:57], a[228:231], v[18:21], v[54:57]
    s_waitcnt lgkmcnt(4)
    v_mfma_f32_16x16x32_bf16 v[46:49], a[72:75], v[22:25], v[46:49]
    v_mfma_f32_16x16x32_bf16 v[50:53], a[152:155], v[22:25], v[50:53]
    v_mfma_f32_16x16x32_bf16 v[54:57], a[232:235], v[22:25], v[54:57]
    s_waitcnt lgkmcnt(2)
    v_mfma_f32_16x16x32_bf16 v[46:49], a[76:79], v[26:29], v[46:49]
    v_mfma_f32_16x16x32_bf16 v[50:53], a[156:159], v[26:29], v[50:53]
    v_mfma_f32_16x16x32_bf16 v[54:57], a[236:239], v[26:29], v[54:57]
    s_nop 5
    v_cvt_pk_bf16_f32 v82, v46, v47
    v_cvt_pk_bf16_f32 v83, v48, v49
    ds_write_b64 v0, v[82:83] offset:24584
    v_cvt_pk_bf16_f32 v84, v50, v51
    v_cvt_pk_bf16_f32 v85, v52, v53
    ds_write_b64 v0, v[84:85] offset:25600
    v_cvt_pk_bf16_f32 v86, v54, v55
    v_cvt_pk_bf16_f32 v87, v56, v57
    ds_write_b64 v0, v[86:87] offset:25608
    s_waitcnt lgkmcnt(0)
    s_barrier
    ds_read_b128 v[46:49], v0 offset:20480
    ds_read_b128 v[50:53], v0 offset:21504
    ds_read_b128 v[54:57], v0 offset:22528
    s_waitcnt lgkmcnt(2)
    v_mfma_f32_16x16x32_bf16 v[38:41], v[58:61], v[46:49], 0
    v_mfma_f32_16x16x32_bf16 v[42:45], v[70:73], v[46:49], 0
    s_waitcnt lgkmcnt(1)
    v_mfma_f32_16x16x32_bf16 v[38:41], v[62:65], v[50:53], v[38:41]
    v_mfma_f32_16x16x32_bf16 v[42:45], v[74:77], v[50:53], v[42:45]
    s_waitcnt lgkmcnt(0)
    v_mfma_f32_16x16x32_bf16 v[38:41], v[66:69], v[54:57], v[38:41]
    v_mfma_f32_16x16x32_bf16 v[42:45], v[78:81], v[54:57], v[42:45]
    s_nop 7
    v_cndmask_b32 v38, v42, v38, s[48:49]
    v_cndmask_b32 v39, v43, v39, s[48:49]
    v_cndmask_b32 v40, v44, v40, s[48:49]
    v_cndmask_b32 v41, v45, v41, s[48:49]
    v_and_or_b32 v38, v38, -2, s22
    buffer_store_dwordx4 v[38:41], v0, s[4:7], s29 offen
    v_pk_mul_f32 v[42:43], v[38:39], s[52:53]
    v_pk_mul_f32 v[44:45], v[40:41], s[52:53]
    s_waitcnt vmcnt(0)
    buffer_load_dwordx4 v[82:85], v0, s[4:7], s30 offen sc1
    s_mov_b32 s19, 0
    ds_read_b128 v[58:61], v0 offset:23552
    ds_read_b128 v[62:65], v0 offset:24576
    ds_read_b128 v[66:69], v0 offset:25600
    s_add_u32 s60, s31, 5120
    s_cmp_eq_u32 s20, 68
    s_cbranch_scc1 L_Rf3_tail
L_Rf3_ha_6:
    s_waitcnt vmcnt(0)
    v_lshlrev_b32 v1, 31, v82
    v_pk_fma_f32 v[38:39], v[82:83], s[52:53], v[42:43]
    v_pk_fma_f32 v[40:41], v[84:85], s[52:53], v[44:45]
    ds_write_b128 v0, v[38:41] offset:28672
    v_cmp_ne_u32 vcc, s21, v1
    s_nop 0
    s_cbranch_vccnz L_Rf3_hafix_7
    s_waitcnt vmcnt(0) lgkmcnt(0)
    s_barrier
    buffer_store_dwordx4 v[58:61], v0, s[4:7], s31 offen offset:0 sc1
    buffer_store_dwordx4 v[62:65], v0, s[4:7], s31 offen offset:1024 sc1
    buffer_store_dwordx4 v[66:69], v0, s[4:7], s31 offen offset:2048 sc1
    s_mov_b32 s19, 0
L_Rf3_kvchk_8:
    v_cmp_lt_u32 vcc, v218, v216
    s_and_b64 vcc, vcc, 0x0fff0fff
    s_cbranch_vccnz L_Rf3_kvretry_9
    s_cmp_eq_u32 s58, 0
    s_cbranch_scc1 L_Rf3_kv1_10
    s_sub_u32 s60, s58, 1
    s_lshl_b32 s60, s60, 6
    s_add_u32 s60, s60, s13
    s_mul_i32 s60, s60, 12288
    s_add_u32 s60, s60, 37355520
    s_mov_b32 m0, 29696
    s_nop 0
    buffer_load_dwordx4 v0, s[4:7], s60 offen offset:0 sc1 lds
    buffer_load_dwordx4 v0, s[4:7], s60 offen offset:1024 sc1 lds
    buffer_load_dwordx4 v0, s[4:7], s60 offen offset:2048 sc1 lds
    s_add_u32 s60, s60, 3072
    s_mov_b32 m0, 32768
    s_nop 0
    buffer_load_dwordx4 v0, s[4:7], s60 offen offset:0 sc1 lds
    buffer_load_dwordx4 v0, s[4:7], s60 offen offset:1024 sc1 lds
    buffer_load_dwordx4 v0, s[4:7], s60 offen offset:2048 sc1 lds
L_Rf3_kv1_10:
    s_cmp_eq_u32 s59, 0
    s_cbranch_scc1 L_Rf3_kv2_11
    s_sub_u32 s60, s59, 1
    s_lshl_b32 s60, s60, 6
    s_add_u32 s60, s60, s13
    s_mul_i32 s60, s60, 12288
    s_add_u32 s60, s60, 87687168
    s_mov_b32 m0, 41984
    s_nop 0
    buffer_load_dwordx4 v0, s[4:7], s60 offen offset:0 sc1 lds
    buffer_load_dwordx4 v0, s[4:7], s60 offen offset:1024 sc1 lds
    buffer_load_dwordx4 v0, s[4:7], s60 offen offset:2048 sc1 lds
    s_add_u32 s60, s60, 3072
    s_mov_b32 m0, 45056
    s_nop 0
    buffer_load_dwordx4 v0, s[4:7], s60 offen offset:0 sc1 lds
    buffer_load_dwordx4 v0, s[4:7], s60 offen offset:1024 sc1 lds
    buffer_load_dwordx4 v0, s[4:7], s60 offen offset:2048 sc1 lds
L_Rf3_kv2_11:
    s_barrier
    ds_read_b128 v[10:13], v0 offset:0
    ds_read_b128 v[14:17], v0 offset:1024
    ds_read_b128 v[18:21], v0 offset:2048
    s_add_u32 s20, s20, 1
    s_waitcnt lgkmcnt(2)
    v_mfma_f32_16x16x32_bf16 v[46:49], v[96:99], v[10:13], 0
    s_waitcnt lgkmcnt(1)
    v_mfma_f32_16x16x32_bf16 v[46:49], v[100:103], v[14:17], v[46:49]
    s_waitcnt lgkmcnt(0)
    v_mfma_f32_16x16x32_bf16 v[46:49], v[104:107], v[18:21], v[46:49]
    v_mfma_f32_16x16x32_bf16 v[50:53], v[108:111], v[10:13], 0
    v_mfma_f32_16x16x32_bf16 v[50:53], v[112:115], v[14:17], v[50:53]
    v_mfma_f32_16x16x32_bf16 v[50:53], v[116:119], v[18:21], v[50:53]
    v_mfma_f32_16x16x32_bf16 v[54:57], v[120:123], v[10:13], 0
    s_nop 3
    v_cvt_pk_bf16_f32 v62, v46, v47
    v_mfma_f32_16x16x32_bf16 v[54:57], v[124:127], v[14:17], v[54:57]
    v_cvt_pk_bf16_f32 v63, v48, v49
    v_and_or_b32 v62, v62, -2, s22
    v_mfma_f32_16x16x32_bf16 v[54:57], v[128:131], v[18:21], v[54:57]
    v_cvt_pk_bf16_f32 v64, v50, v51
    v_mfma_f32_16x16x32_bf16 v[58:61], v[132:135], v[10:13], 0
    v_cvt_pk_bf16_f32 v65, v52, v53
    v_mfma_f32_16x16x32_bf16 v[58:61], v[136:139], v[14:17], v[58:61]
    v_mfma_f32_16x16x32_bf16 v[58:61], v[140:143], v[18:21], v[58:61]
    v_mfma_f32_16x16x32_bf16 v[46:49], v[144:147], v[10:13], 0
    buffer_store_dwordx4 v[62:65], v3, s[4:7], s32 offen
    s_nop 0
    v_cvt_pk_bf16_f32 v66, v54, v55
    v_mfma_f32_16x16x32_bf16 v[46:49], v[148:151], v[14:17], v[46:49]
    v_cvt_pk_bf16_f32 v67, v56, v57
    v_and_or_b32 v66, v66, -2, s22
    v_mfma_f32_16x16x32_bf16 v[46:49], v[152:155], v[18:21], v[46:49]
    v_cvt_pk_bf16_f32 v68, v58, v59
    v_mfma_f32_16x16x32_bf16 v[50:53], v[156:159], v[10:13], 0
    v_cvt_pk_bf16_f32 v69, v60, v61
    v_mfma_f32_16x16x32_bf16 v[50:53], v[160:163], v[14:17], v[50:53]
    v_mfma_f32_16x16x32_bf16 v[50:53], v[164:167], v[18:21], v[50:53]
    v_mfma_f32_16x16x32_bf16 v[54:57], v[168:171], v[10:13], 0
    buffer_store_dwordx4 v[66:69], v4, s[4:7], s32 offen
    s_nop 0
    v_cvt_pk_bf16_f32 v62, v46, v47
    v_mfma_f32_16x16x32_bf16 v[54:57], v[172:175], v[14:17], v[54:57]
    v_cvt_pk_bf16_f32 v63, v48, v49
    v_and_or_b32 v62, v62, -2, s22
    v_mfma_f32_16x16x32_bf16 v[54:57], v[176:179], v[18:21], v[54:57]
    v_cvt_pk_bf16_f32 v64, v50, v51
    v_mfma_f32_16x16x32_bf16 v[58:61], v[180:183], v[10:13], 0
    v_cvt_pk_bf16_f32 v65, v52, v53
    v_mfma_f32_16x16x32_bf16 v[58:61], v[184:187], v[14:17], v[58:61]
    v_mfma_f32_16x16x32_bf16 v[58:61], v[188:191], v[18:21], v[58:61]
    v_mfma_f32_16x16x32_bf16 v[46:49], v[192:195], v[10:13], 0
    buffer_store_dwordx4 v[62:65], v5, s[4:7], s32 offen
    s_nop 0
    v_cvt_pk_bf16_f32 v66, v54, v55
    v_mfma_f32_16x16x32_bf16 v[46:49], v[196:199], v[14:17], v[46:49]
    v_cvt_pk_bf16_f32 v67, v56, v57
    v_and_or_b32 v66, v66, -2, s22
    v_mfma_f32_16x16x32_bf16 v[46:49], v[200:203], v[18:21], v[46:49]
    v_cvt_pk_bf16_f32 v68, v58, v59
    v_mfma_f32_16x16x32_bf16 v[50:53], v[204:207], v[10:13], 0
    v_cvt_pk_bf16_f32 v69, v60, v61
    v_mfma_f32_16x16x32_bf16 v[50:53], v[208:211], v[14:17], v[50:53]
    v_mfma_f32_16x16x32_bf16 v[50:53], v[212:215], v[18:21], v[50:53]
    buffer_store_dwordx4 v[66:69], v6, s[4:7], s32 offen
    s_nop 1
    v_cvt_pk_bf16_f32 v62, v46, v47
    v_cvt_pk_bf16_f32 v63, v48, v49
    v_and_or_b32 v62, v62, -2, s22
    s_nop 1
    v_cvt_pk_bf16_f32 v64, v50, v51
    v_cvt_pk_bf16_f32 v65, v52, v53
    buffer_store_dwordx4 v[62:65], v7, s[4:7], s32 offen
    s_add_u32 s60, s20, 1
    s_and_b32 s22, s60, 1
    s_lshl_b32 s21, s22, 31
    s_sub_u32 s44, 0, s22
    s_bfe_u32 s23, s20, 0x10001
    s_sub_u32 s23, s23, 1
    s_lshr_b32 s24, s60, 1
    s_andn2_b32 s24, 1, s24
    s_lshl_b32 s61, s14, 15
    s_add_u32 s61, s61, 1179648
    s_and_b32 s25, s20, 1
    s_lshl_b32 s25, s25, 16
    s_add_u32 s25, s25, s61
    s_add_u32 s25, s25, 15360
    s_add_u32 s26, s25, 4096
    s_lshl_b32 s36, s22, 16
    s_add_u32 s36, s36, s61
    s_lshl_b32 s27, s20, 1
    s_add_u32 s37, s27, 2
    s_add_u32 s37, s37, s14
    s_mul_i32 s37, s37, 20480
    s_add_u32 s37, s37, 2621440
    s_add_u32 s27, s27, 1
    s_sub_u32 s27, s27, s14
    s_mul_i32 s27, s27, 20480
    s_add_u32 s27, s27, 2636800
    s_add_u32 s28, s27, 4096
    s_lshl_b32 s31, s20, 6
    s_add_u32 s31, s31, s13
    s_mul_i32 s31, s31, 6144
    s_add_u32 s31, s31, 5898240
    s_min_u32 s56, s20, 63
    s_lshl_b32 s56, s56, 6
    s_add_u32 s56, s56, s13
    s_mul_i32 s56, s56, 12288
    s_add_u32 s56, s56, 37364736
    s_max_u32 s57, s20, 5
    s_sub_u32 s57, s57, 5
    s_lshl_b32 s57, s57, 6
    s_add_u32 s57, s57, s13
    s_mul_i32 s57, s57, 12288
    s_add_u32 s57, s57, 87696384
    s_cmp_lt_u32 s20, 5
    s_cselect_b32 s57, s56, s57
    s_cmp_gt_u32 s60, 63
    s_cselect_b64 s[42:43], s[38:39], 0
    s_cmp_le_u32 s60, 5
    s_cselect_b64 vcc, s[40:41], 0
    s_or_b64 s[42:43], s[42:43], vcc
    s_add_u32 s60, s20, 1
    s_add_u32 s58, s60, 1
    s_cmp_gt_u32 s60, 63
    s_cselect_b32 s58, 0, s58
    s_sub_u32 s59, s60, 4
    s_cmp_lt_u32 s60, 5
    s_cselect_b32 s59, 0, s59
    v_mov_b32 v216, s58
    v_mov_b32 v218, s59
    v_cmp_gt_u32 vcc, 256, v0
    s_nop 1
    v_cndmask_b32 v216, v218, v216, vcc
    s_branch L_Rf3_top
L_Rf3_tail:
    s_waitcnt lgkmcnt(0)
    buffer_store_dwordx4 v[58:61], v0, s[4:7], s31 offen offset:0 sc1
    buffer_store_dwordx4 v[62:65], v0, s[4:7], s31 offen offset:1024 sc1
    buffer_store_dwordx4 v[66:69], v0, s[4:7], s31 offen offset:2048 sc1
    s_waitcnt vmcnt(0) lgkmcnt(0)
    s_barrier
    v_mov_b32 v22, 69
    s_mov_b64 exec, 1
    buffer_store_dword v22, v0, s[4:7], s54 offen sc1
    s_mov_b64 exec, -1
    s_waitcnt vmcnt(0)
    s_endpgm
L_Rf3_glfix_3:
    buffer_load_dwordx4 v[10:13], v0, s[4:7], s25 offen offset:0 sc1
    buffer_load_dwordx4 v[14:17], v0, s[4:7], s25 offen offset:1024 sc1
    buffer_load_dwordx4 v[18:21], v0, s[4:7], s25 offen offset:2048 sc1
    buffer_load_dwordx4 v[22:25], v0, s[4:7], s25 offen offset:3072 sc1
    buffer_load_dwordx4 v[26:29], v0, s[4:7], s26 offen offset:0 sc1
    buffer_load_dwordx4 v[46:49], v0, s[4:7], s27 offen offset:0 sc1
    buffer_load_dwordx4 v[30:33], v0, s[4:7], s27 offen offset:1024 sc1
    buffer_load_dwordx4 v[34:37], v0, s[4:7], s27 offen offset:2048 sc1
    buffer_load_dwordx4 v[38:41], v0, s[4:7], s27 offen offset:3072 sc1
    buffer_load_dwordx4 v[42:45], v0, s[4:7], s28 offen offset:0 sc1
    s_add_u32 s19, s19, 1
    s_cmp_lt_u32 s19, 524288
    s_cbranch_scc1 L_Rf3_gl_1
    s_branch L_fail
L_Rf3_grfix_5:
    buffer_load_dwordx4 v[46:49], v0, s[4:7], s27 offen offset:0 sc1
    buffer_load_dwordx4 v[30:33], v0, s[4:7], s27 offen offset:1024 sc1
    buffer_load_dwordx4 v[34:37], v0, s[4:7], s27 offen offset:2048 sc1
    buffer_load_dwordx4 v[38:41], v0, s[4:7], s27 offen offset:3072 sc1
    buffer_load_dwordx4 v[42:45], v0, s[4:7], s28 offen offset:0 sc1
    s_add_u32 s19, s19, 1
    s_cmp_lt_u32 s19, 524288
    s_cbranch_scc1 L_Rf3_gr2_4
    s_branch L_fail
L_Rf3_gr2_4:
    v_mfma_f32_16x16x32_bf16 v[50:53], a[240:243], v[10:13], 0
    v_mfma_f32_16x16x32_bf16 v[54:57], a[244:247], v[10:13], 0
    v_mfma_f32_16x16x32_bf16 v[58:61], a[240:243], v[14:17], 0
    v_mfma_f32_16x16x32_bf16 v[62:65], a[244:247], v[14:17], 0
    v_mfma_f32_16x16x32_bf16 v[66:69], a[240:243], v[18:21], 0
    v_mfma_f32_16x16x32_bf16 v[70:73], a[244:247], v[18:21], 0
    v_mfma_f32_16x16x32_bf16 v[74:77], a[240:243], v[22:25], 0
    v_mfma_f32_16x16x32_bf16 v[78:81], a[244:247], v[22:25], 0
    v_mfma_f32_16x16x32_bf16 v[82:85], a[240:243], v[26:29], 0
    v_mfma_f32_16x16x32_bf16 v[86:89], a[244:247], v[26:29], 0
    s_branch L_Rf3_gr_2
L_Rf3_hafix_7:
    buffer_load_dwordx4 v[82:85], v0, s[4:7], s30 offen sc1
    s_add_u32 s19, s19, 1
    s_cmp_lt_u32 s19, 524288
    s_cbranch_scc1 L_Rf3_ha_6
    s_branch L_fail
L_Rf3_kvretry_9:
    s_add_u32 s19, s19, 1
    s_cmp_ge_u32 s19, 524288
    s_cbranch_scc1 L_fail
    s_waitcnt vmcnt(0) lgkmcnt(0)
    buffer_load_dword v218, v217, s[4:7], s55 offen sc1
    s_waitcnt vmcnt(0)
    s_branch L_Rf3_kvchk_8
L_R3_slow:
L_Rs3_top:
    s_barrier
    buffer_load_dwordx4 v[10:13], v0, s[4:7], s25 offen offset:0 sc1
    buffer_load_dwordx4 v[14:17], v0, s[4:7], s25 offen offset:1024 sc1
    buffer_load_dwordx4 v[18:21], v0, s[4:7], s25 offen offset:2048 sc1
    buffer_load_dwordx4 v[22:25], v0, s[4:7], s25 offen offset:3072 sc1
    buffer_load_dwordx4 v[26:29], v0, s[4:7], s26 offen offset:0 sc1
    s_barrier
    buffer_load_dwordx4 v[46:49], v0, s[4:7], s27 offen offset:0 sc1
    buffer_load_dwordx4 v[30:33], v0, s[4:7], s27 offen offset:1024 sc1
    buffer_load_dwordx4 v[34:37], v0, s[4:7], s27 offen offset:2048 sc1
    buffer_load_dwordx4 v[38:41], v0, s[4:7], s27 offen offset:3072 sc1
    buffer_load_dwordx4 v[42:45], v0, s[4:7], s28 offen offset:0 sc1
    s_mov_b32 s19, 0
L_Rs3_gl_1:
    s_waitcnt vmcnt(9)
    v_mfma_f32_16x16x32_bf16 v[50:53], a[240:243], v[10:13], 0
    v_mfma_f32_16x16x32_bf16 v[54:57], a[244:247], v[10:13], 0
    v_xor_b32 v1, s23, v10
    s_waitcnt vmcnt(8)
    v_mfma_f32_16x16x32_bf16 v[58:61], a[240:243], v[14:17], 0
    v_mfma_f32_16x16x32_bf16 v[62:65], a[244:247], v[14:17], 0
    v_bitop3_b32 v1, v1, v14, s23 bitop3:0xf6
    s_waitcnt vmcnt(7)
    v_mfma_f32_16x16x32_bf16 v[66:69], a[240:243], v[18:21], 0
    v_mfma_f32_16x16x32_bf16 v[70:73], a[244:247], v[18:21], 0
    v_bitop3_b32 v1, v1, v18, s23 bitop3:0xf6
    s_waitcnt vmcnt(6)
    v_mfma_f32_16x16x32_bf16 v[74:77], a[240:243], v[22:25], 0
    v_mfma_f32_16x16x32_bf16 v[78:81], a[244:247], v[22:25], 0
    v_bitop3_b32 v1, v1, v22, s23 bitop3:0xf6
    s_waitcnt vmcnt(5)
    v_mfma_f32_16x16x32_bf16 v[82:85], a[240:243], v[26:29], 0
    v_mfma_f32_16x16x32_bf16 v[86:89], a[244:247], v[26:29], 0
    v_bitop3_b32 v1, v1, v26, s23 bitop3:0xf6
    v_and_b32 v1, 1, v1
    v_cmp_ne_u32 vcc, 0, v1
    s_nop 0
    s_cbranch_vccnz L_Rs3_glfix_3
L_Rs3_gr_2:
    s_waitcnt vmcnt(4)
    v_mfma_f32_16x16x32_bf16 v[50:53], a[240:243], v[46:49], v[50:53]
    v_xor_b32 v1, s23, v46
    v_mfma_f32_16x16x32_bf16 v[54:57], a[244:247], v[46:49], v[54:57]
    s_waitcnt vmcnt(3)
    v_mfma_f32_16x16x32_bf16 v[58:61], a[240:243], v[30:33], v[58:61]
    v_bitop3_b32 v1, v1, v30, s23 bitop3:0xf6
    v_mfma_f32_16x16x32_bf16 v[62:65], a[244:247], v[30:33], v[62:65]
    s_nop 1
    v_cvt_pk_bf16_f32 v90, v50, v51
    v_cvt_pk_bf16_f32 v91, v52, v53
    v_cvt_pk_bf16_f32 v92, v54, v55
    v_cvt_pk_bf16_f32 v93, v56, v57
    ds_write_b128 v0, v[90:93] offset:15360
    s_waitcnt vmcnt(2)
    v_mfma_f32_16x16x32_bf16 v[66:69], a[240:243], v[34:37], v[66:69]
    v_bitop3_b32 v1, v1, v34, s23 bitop3:0xf6
    v_mfma_f32_16x16x32_bf16 v[70:73], a[244:247], v[34:37], v[70:73]
    v_cvt_pk_bf16_f32 v90, v58, v59
    v_cvt_pk_bf16_f32 v91, v60, v61
    v_cvt_pk_bf16_f32 v92, v62, v63
    v_cvt_pk_bf16_f32 v93, v64, v65
    ds_write_b128 v0, v[90:93] offset:16384
    s_waitcnt vmcnt(1)
    v_mfma_f32_16x16x32_bf16 v[74:77], a[240:243], v[38:41], v[74:77]
    v_bitop3_b32 v1, v1, v38, s23 bitop3:0xf6
    v_mfma_f32_16x16x32_bf16 v[78:81], a[244:247], v[38:41], v[78:81]
    v_cvt_pk_bf16_f32 v90, v66, v67
    v_cvt_pk_bf16_f32 v91, v68, v69
    v_cvt_pk_bf16_f32 v92, v70, v71
    v_cvt_pk_bf16_f32 v93, v72, v73
    ds_write_b128 v0, v[90:93] offset:17408
    s_waitcnt vmcnt(0)
    v_mfma_f32_16x16x32_bf16 v[82:85], a[240:243], v[42:45], v[82:85]
    v_bitop3_b32 v1, v1, v42, s23 bitop3:0xf6
    v_mfma_f32_16x16x32_bf16 v[86:89], a[244:247], v[42:45], v[86:89]
    v_cvt_pk_bf16_f32 v90, v74, v75
    v_cvt_pk_bf16_f32 v91, v76, v77
    v_cvt_pk_bf16_f32 v92, v78, v79
    v_cvt_pk_bf16_f32 v93, v80, v81
    ds_write_b128 v0, v[90:93] offset:18432
    s_nop 0
    v_cvt_pk_bf16_f32 v90, v82, v83
    v_cvt_pk_bf16_f32 v91, v84, v85
    v_cvt_pk_bf16_f32 v92, v86, v87
    v_cvt_pk_bf16_f32 v93, v88, v89
    ds_write_b128 v0, v[90:93] offset:19456
    v_and_b32 v1, 1, v1
    v_cmp_ne_u32 vcc, 0, v1
    s_nop 0
    s_cbranch_vccnz L_Rs3_grfix_5
    s_waitcnt lgkmcnt(0)
    s_barrier
    ds_read_b128 v[10:13], v0 offset:0
    ds_read_b128 v[14:17], v0 offset:1024
    ds_read_b128 v[18:21], v0 offset:2048
    ds_read_b128 v[22:25], v0 offset:3072
    ds_read_b128 v[26:29], v0 offset:4096
    s_waitcnt lgkmcnt(4)
    v_mfma_f32_16x16x32_bf16 v[46:49], a[0:3], v[10:13], 0
    s_mov_b32 m0, 51200
    v_mfma_f32_16x16x32_bf16 v[50:53], a[80:83], v[10:13], 0
    buffer_load_dword v218, v217, s[4:7], s55 offen sc1
    v_mfma_f32_16x16x32_bf16 v[54:57], a[160:163], v[10:13], 0
    v_mov_b32 v1, s20
    s_mov_b64 exec, 1
    buffer_store_dword v1, v0, s[4:7], s54 offen sc1
    s_mov_b64 exec, -1
    ds_read_b128 v[10:13], v0 offset:5120
    s_waitcnt lgkmcnt(4)
    v_mfma_f32_16x16x32_bf16 v[46:49], a[4:7], v[14:17], v[46:49]
    buffer_load_dwordx4 v0, s[4:7], s57 offen offset:0 sc1 lds
    v_mfma_f32_16x16x32_bf16 v[50:53], a[84:87], v[14:17], v[50:53]
    v_mfma_f32_16x16x32_bf16 v[54:57], a[164:167], v[14:17], v[54:57]
    ds_read_b128 v[14:17], v0 offset:6144
    s_waitcnt lgkmcnt(4)
    v_mfma_f32_16x16x32_bf16 v[46:49], a[8:11], v[18:21], v[46:49]
    buffer_load_dwordx4 v0, s[4:7], s57 offen offset:1024 sc1 lds
    v_mfma_f32_16x16x32_bf16 v[50:53], a[88:91], v[18:21], v[50:53]
    v_mfma_f32_16x16x32_bf16 v[54:57], a[168:171], v[18:21], v[54:57]
    ds_read_b128 v[18:21], v0 offset:7168
    s_waitcnt lgkmcnt(4)
    v_mfma_f32_16x16x32_bf16 v[46:49], a[12:15], v[22:25], v[46:49]
    buffer_load_dwordx4 v0, s[4:7], s57 offen offset:2048 sc1 lds
    v_mfma_f32_16x16x32_bf16 v[50:53], a[92:95], v[22:25], v[50:53]
    v_mfma_f32_16x16x32_bf16 v[54:57], a[172:175], v[22:25], v[54:57]
    ds_read_b128 v[22:25], v0 offset:8192
    s_waitcnt lgkmcnt(4)
    v_mfma_f32_16x16x32_bf16 v[46:49], a[16:19], v[26:29], v[46:49]
    v_mfma_f32_16x16x32_bf16 v[50:53], a[96:99], v[26:29], v[50:53]
    v_mfma_f32_16x16x32_bf16 v[54:57], a[176:179], v[26:29], v[54:57]
    ds_read_b128 v[26:29], v0 offset:9216
    s_waitcnt lgkmcnt(4)
    v_mfma_f32_16x16x32_bf16 v[46:49], a[20:23], v[10:13], v[46:49]
    v_mfma_f32_16x16x32_bf16 v[50:53], a[100:103], v[10:13], v[50:53]
    v_mfma_f32_16x16x32_bf16 v[54:57], a[180:183], v[10:13], v[54:57]
    ds_read_b128 v[10:13], v0 offset:10240
    s_waitcnt lgkmcnt(4)
    v_mfma_f32_16x16x32_bf16 v[46:49], a[24:27], v[14:17], v[46:49]
    v_mfma_f32_16x16x32_bf16 v[50:53], a[104:107], v[14:17], v[50:53]
    v_mfma_f32_16x16x32_bf16 v[54:57], a[184:187], v[14:17], v[54:57]
    ds_read_b128 v[14:17], v0 offset:11264
    s_waitcnt lgkmcnt(4)
    v_mfma_f32_16x16x32_bf16 v[46:49], a[28:31], v[18:21], v[46:49]
    v_mfma_f32_16x16x32_bf16 v[50:53], a[108:111], v[18:21], v[50:53]
    v_mfma_f32_16x16x32_bf16 v[54:57], a[188:191], v[18:21], v[54:57]
    ds_read_b128 v[18:21], v0 offset:12288
    s_waitcnt lgkmcnt(4)
    v_mfma_f32_16x16x32_bf16 v[46:49], a[32:35], v[22:25], v[46:49]
    v_mfma_f32_16x16x32_bf16 v[50:53], a[112:115], v[22:25], v[50:53]
    v_mfma_f32_16x16x32_bf16 v[54:57], a[192:195], v[22:25], v[54:57]
    ds_read_b128 v[22:25], v0 offset:13312
    s_waitcnt lgkmcnt(4)
    v_mfma_f32_16x16x32_bf16 v[46:49], a[36:39], v[26:29], v[46:49]
    v_mfma_f32_16x16x32_bf16 v[50:53], a[116:119], v[26:29], v[50:53]
    v_mfma_f32_16x16x32_bf16 v[54:57], a[196:199], v[26:29], v[54:57]
    ds_read_b128 v[26:29], v0 offset:14336
    s_waitcnt lgkmcnt(4)
    v_mfma_f32_16x16x32_bf16 v[46:49], a[40:43], v[10:13], v[46:49]
    v_mfma_f32_16x16x32_bf16 v[50:53], a[120:123], v[10:13], v[50:53]
    v_mfma_f32_16x16x32_bf16 v[54:57], a[200:203], v[10:13], v[54:57]
    ds_read_b128 v[10:13], v0 offset:15360
    s_waitcnt lgkmcnt(4)
    v_mfma_f32_16x16x32_bf16 v[46:49], a[44:47], v[14:17], v[46:49]
    ds_read_b128 v[58:61], v0 offset:32768
    v_mfma_f32_16x16x32_bf16 v[50:53], a[124:127], v[14:17], v[50:53]
    v_mfma_f32_16x16x32_bf16 v[54:57], a[204:207], v[14:17], v[54:57]
    ds_read_b128 v[14:17], v0 offset:16384
    s_waitcnt lgkmcnt(5)
    v_mfma_f32_16x16x32_bf16 v[46:49], a[48:51], v[18:21], v[46:49]
    ds_read_b128 v[62:65], v0 offset:33792
    v_mfma_f32_16x16x32_bf16 v[50:53], a[128:131], v[18:21], v[50:53]
    v_mfma_f32_16x16x32_bf16 v[54:57], a[208:211], v[18:21], v[54:57]
    ds_read_b128 v[18:21], v0 offset:17408
    s_waitcnt lgkmcnt(6)
    v_mfma_f32_16x16x32_bf16 v[46:49], a[52:55], v[22:25], v[46:49]
    ds_read_b128 v[66:69], v0 offset:34816
    v_mfma_f32_16x16x32_bf16 v[50:53], a[132:135], v[22:25], v[50:53]
    v_mfma_f32_16x16x32_bf16 v[54:57], a[212:215], v[22:25], v[54:57]
    ds_read_b128 v[22:25], v0 offset:18432
    s_waitcnt lgkmcnt(7)
    v_mfma_f32_16x16x32_bf16 v[46:49], a[56:59], v[26:29], v[46:49]
    ds_read_b128 v[70:73], v0 offset:45056
    v_mfma_f32_16x16x32_bf16 v[50:53], a[136:139], v[26:29], v[50:53]
    v_mfma_f32_16x16x32_bf16 v[54:57], a[216:219], v[26:29], v[54:57]
    ds_read_b128 v[26:29], v0 offset:19456
    s_waitcnt lgkmcnt(8)
    v_mfma_f32_16x16x32_bf16 v[46:49], a[60:63], v[10:13], v[46:49]
    ds_read_b128 v[74:77], v0 offset:46080
    v_mfma_f32_16x16x32_bf16 v[50:53], a[140:143], v[10:13], v[50:53]
    v_mfma_f32_16x16x32_bf16 v[54:57], a[220:223], v[10:13], v[54:57]
    s_waitcnt lgkmcnt(7)
    v_mfma_f32_16x16x32_bf16 v[46:49], a[64:67], v[14:17], v[46:49]
    ds_read_b128 v[78:81], v0 offset:47104
    v_mfma_f32_16x16x32_bf16 v[50:53], a[144:147], v[14:17], v[50:53]
    v_mfma_f32_16x16x32_bf16 v[54:57], a[224:227], v[14:17], v[54:57]
    s_waitcnt lgkmcnt(6)
    v_mfma_f32_16x16x32_bf16 v[46:49], a[68:71], v[18:21], v[46:49]
    v_mfma_f32_16x16x32_bf16 v[50:53], a[148:151], v[18:21], v[50:53]
    v_mfma_f32_16x16x32_bf16 v[54:57], a[228:231], v[18:21], v[54:57]
    s_waitcnt lgkmcnt(4)
    v_mfma_f32_16x16x32_bf16 v[46:49], a[72:75], v[22:25], v[46:49]
    v_mfma_f32_16x16x32_bf16 v[50:53], a[152:155], v[22:25], v[50:53]
    v_mfma_f32_16x16x32_bf16 v[54:57], a[232:235], v[22:25], v[54:57]
    s_waitcnt lgkmcnt(2)
    v_mfma_f32_16x16x32_bf16 v[46:49], a[76:79], v[26:29], v[46:49]
    v_mfma_f32_16x16x32_bf16 v[50:53], a[156:159], v[26:29], v[50:53]
    v_mfma_f32_16x16x32_bf16 v[54:57], a[236:239], v[26:29], v[54:57]
    s_nop 5
    v_cvt_pk_bf16_f32 v82, v46, v47
    v_cvt_pk_bf16_f32 v83, v48, v49
    ds_write_b64 v0, v[82:83] offset:24584
    v_cvt_pk_bf16_f32 v84, v50, v51
    v_cvt_pk_bf16_f32 v85, v52, v53
    ds_write_b64 v0, v[84:85] offset:25600
    v_cvt_pk_bf16_f32 v86, v54, v55
    v_cvt_pk_bf16_f32 v87, v56, v57
    ds_write_b64 v0, v[86:87] offset:25608
    s_waitcnt lgkmcnt(0)
    s_barrier
    ds_read_b128 v[46:49], v0 offset:20480
    ds_read_b128 v[50:53], v0 offset:21504
    ds_read_b128 v[54:57], v0 offset:22528
    s_waitcnt lgkmcnt(2)
    v_mfma_f32_16x16x32_bf16 v[38:41], v[58:61], v[46:49], 0
    v_mfma_f32_16x16x32_bf16 v[42:45], v[70:73], v[46:49], 0
    s_waitcnt lgkmcnt(1)
    v_mfma_f32_16x16x32_bf16 v[38:41], v[62:65], v[50:53], v[38:41]
    v_mfma_f32_16x16x32_bf16 v[42:45], v[74:77], v[50:53], v[42:45]
    s_waitcnt lgkmcnt(0)
    v_mfma_f32_16x16x32_bf16 v[38:41], v[66:69], v[54:57], v[38:41]
    v_mfma_f32_16x16x32_bf16 v[42:45], v[78:81], v[54:57], v[42:45]
    s_nop 7
    v_cndmask_b32 v38, v42, v38, s[48:49]
    v_cndmask_b32 v39, v43, v39, s[48:49]
    v_cndmask_b32 v40, v44, v40, s[48:49]
    v_cndmask_b32 v41, v45, v41, s[48:49]
    v_and_or_b32 v38, v38, -2, s22
    buffer_store_dwordx4 v[38:41], v0, s[4:7], s29 offen sc1
    v_pk_mul_f32 v[42:43], v[38:39], s[52:53]
    v_pk_mul_f32 v[44:45], v[40:41], s[52:53]
    s_waitcnt vmcnt(0)
    buffer_load_dwordx4 v[82:85], v0, s[4:7], s30 offen sc1
    s_mov_b32 s19, 0
    ds_read_b128 v[58:61], v0 offset:23552
    ds_read_b128 v[62:65], v0 offset:24576
    ds_read_b128 v[66:69], v0 offset:25600
    s_add_u32 s60, s31, 5120
    s_cmp_eq_u32 s20, 68
    s_cbranch_scc1 L_Rs3_tail
L_Rs3_ha_6:
    s_waitcnt vmcnt(0)
    v_lshlrev_b32 v1, 31, v82
    v_pk_fma_f32 v[38:39], v[82:83], s[52:53], v[42:43]
    v_pk_fma_f32 v[40:41], v[84:85], s[52:53], v[44:45]
    ds_write_b128 v0, v[38:41] offset:28672
    v_cmp_ne_u32 vcc, s21, v1
    s_nop 0
    s_cbranch_vccnz L_Rs3_hafix_7
    s_waitcnt vmcnt(0) lgkmcnt(0)
    s_barrier
    buffer_store_dwordx4 v[58:61], v0, s[4:7], s31 offen offset:0 sc1
    buffer_store_dwordx4 v[62:65], v0, s[4:7], s31 offen offset:1024 sc1
    buffer_store_dwordx4 v[66:69], v0, s[4:7], s31 offen offset:2048 sc1
    s_mov_b32 s19, 0
L_Rs3_kvchk_8:
    v_cmp_lt_u32 vcc, v218, v216
    s_and_b64 vcc, vcc, 0x0fff0fff
    s_cbranch_vccnz L_Rs3_kvretry_9
    s_cmp_eq_u32 s58, 0
    s_cbranch_scc1 L_Rs3_kv1_10
    s_sub_u32 s60, s58, 1
    s_lshl_b32 s60, s60, 6
    s_add_u32 s60, s60, s13
    s_mul_i32 s60, s60, 12288
    s_add_u32 s60, s60, 37355520
    s_mov_b32 m0, 29696
    s_nop 0
    buffer_load_dwordx4 v0, s[4:7], s60 offen offset:0 sc1 lds
    buffer_load_dwordx4 v0, s[4:7], s60 offen offset:1024 sc1 lds
    buffer_load_dwordx4 v0, s[4:7], s60 offen offset:2048 sc1 lds
    s_add_u32 s60, s60, 3072
    s_mov_b32 m0, 32768
    s_nop 0
    buffer_load_dwordx4 v0, s[4:7], s60 offen offset:0 sc1 lds
    buffer_load_dwordx4 v0, s[4:7], s60 offen offset:1024 sc1 lds
    buffer_load_dwordx4 v0, s[4:7], s60 offen offset:2048 sc1 lds
L_Rs3_kv1_10:
    s_cmp_eq_u32 s59, 0
    s_cbranch_scc1 L_Rs3_kv2_11
    s_sub_u32 s60, s59, 1
    s_lshl_b32 s60, s60, 6
    s_add_u32 s60, s60, s13
    s_mul_i32 s60, s60, 12288
    s_add_u32 s60, s60, 87687168
    s_mov_b32 m0, 41984
    s_nop 0
    buffer_load_dwordx4 v0, s[4:7], s60 offen offset:0 sc1 lds
    buffer_load_dwordx4 v0, s[4:7], s60 offen offset:1024 sc1 lds
    buffer_load_dwordx4 v0, s[4:7], s60 offen offset:2048 sc1 lds
    s_add_u32 s60, s60, 3072
    s_mov_b32 m0, 45056
    s_nop 0
    buffer_load_dwordx4 v0, s[4:7], s60 offen offset:0 sc1 lds
    buffer_load_dwordx4 v0, s[4:7], s60 offen offset:1024 sc1 lds
    buffer_load_dwordx4 v0, s[4:7], s60 offen offset:2048 sc1 lds
L_Rs3_kv2_11:
    s_barrier
    ds_read_b128 v[10:13], v0 offset:0
    ds_read_b128 v[14:17], v0 offset:1024
    ds_read_b128 v[18:21], v0 offset:2048
    s_add_u32 s20, s20, 1
    s_waitcnt lgkmcnt(2)
    v_mfma_f32_16x16x32_bf16 v[46:49], v[96:99], v[10:13], 0
    s_waitcnt lgkmcnt(1)
    v_mfma_f32_16x16x32_bf16 v[46:49], v[100:103], v[14:17], v[46:49]
    s_waitcnt lgkmcnt(0)
    v_mfma_f32_16x16x32_bf16 v[46:49], v[104:107], v[18:21], v[46:49]
    v_mfma_f32_16x16x32_bf16 v[50:53], v[108:111], v[10:13], 0
    v_mfma_f32_16x16x32_bf16 v[50:53], v[112:115], v[14:17], v[50:53]
    v_mfma_f32_16x16x32_bf16 v[50:53], v[116:119], v[18:21], v[50:53]
    v_mfma_f32_16x16x32_bf16 v[54:57], v[120:123], v[10:13], 0
    s_nop 3
    v_cvt_pk_bf16_f32 v62, v46, v47
    v_mfma_f32_16x16x32_bf16 v[54:57], v[124:127], v[14:17], v[54:57]
    v_cvt_pk_bf16_f32 v63, v48, v49
    v_and_or_b32 v62, v62, -2, s22
    v_mfma_f32_16x16x32_bf16 v[54:57], v[128:131], v[18:21], v[54:57]
    v_cvt_pk_bf16_f32 v64, v50, v51
    v_mfma_f32_16x16x32_bf16 v[58:61], v[132:135], v[10:13], 0
    v_cvt_pk_bf16_f32 v65, v52, v53
    v_mfma_f32_16x16x32_bf16 v[58:61], v[136:139], v[14:17], v[58:61]
    v_mfma_f32_16x16x32_bf16 v[58:61], v[140:143], v[18:21], v[58:61]
    v_mfma_f32_16x16x32_bf16 v[46:49], v[144:147], v[10:13], 0
    buffer_store_dwordx4 v[62:65], v3, s[4:7], s32 offen sc1
    s_nop 0
    v_cvt_pk_bf16_f32 v66, v54, v55
    v_mfma_f32_16x16x32_bf16 v[46:49], v[148:151], v[14:17], v[46:49]
    v_cvt_pk_bf16_f32 v67, v56, v57
    v_and_or_b32 v66, v66, -2, s22
    v_mfma_f32_16x16x32_bf16 v[46:49], v[152:155], v[18:21], v[46:49]
    v_cvt_pk_bf16_f32 v68, v58, v59
    v_mfma_f32_16x16x32_bf16 v[50:53], v[156:159], v[10:13], 0
    v_cvt_pk_bf16_f32 v69, v60, v61
    v_mfma_f32_16x16x32_bf16 v[50:53], v[160:163], v[14:17], v[50:53]
    v_mfma_f32_16x16x32_bf16 v[50:53], v[164:167], v[18:21], v[50:53]
    v_mfma_f32_16x16x32_bf16 v[54:57], v[168:171], v[10:13], 0
    buffer_store_dwordx4 v[66:69], v4, s[4:7], s32 offen sc1
    s_nop 0
    v_cvt_pk_bf16_f32 v62, v46, v47
    v_mfma_f32_16x16x32_bf16 v[54:57], v[172:175], v[14:17], v[54:57]
    v_cvt_pk_bf16_f32 v63, v48, v49
    v_and_or_b32 v62, v62, -2, s22
    v_mfma_f32_16x16x32_bf16 v[54:57], v[176:179], v[18:21], v[54:57]
    v_cvt_pk_bf16_f32 v64, v50, v51
    v_mfma_f32_16x16x32_bf16 v[58:61], v[180:183], v[10:13], 0
    v_cvt_pk_bf16_f32 v65, v52, v53
    v_mfma_f32_16x16x32_bf16 v[58:61], v[184:187], v[14:17], v[58:61]
    v_mfma_f32_16x16x32_bf16 v[58:61], v[188:191], v[18:21], v[58:61]
    v_mfma_f32_16x16x32_bf16 v[46:49], v[192:195], v[10:13], 0
    buffer_store_dwordx4 v[62:65], v5, s[4:7], s32 offen sc1
    s_nop 0
    v_cvt_pk_bf16_f32 v66, v54, v55
    v_mfma_f32_16x16x32_bf16 v[46:49], v[196:199], v[14:17], v[46:49]
    v_cvt_pk_bf16_f32 v67, v56, v57
    v_and_or_b32 v66, v66, -2, s22
    v_mfma_f32_16x16x32_bf16 v[46:49], v[200:203], v[18:21], v[46:49]
    v_cvt_pk_bf16_f32 v68, v58, v59
    v_mfma_f32_16x16x32_bf16 v[50:53], v[204:207], v[10:13], 0
    v_cvt_pk_bf16_f32 v69, v60, v61
    v_mfma_f32_16x16x32_bf16 v[50:53], v[208:211], v[14:17], v[50:53]
    v_mfma_f32_16x16x32_bf16 v[50:53], v[212:215], v[18:21], v[50:53]
    buffer_store_dwordx4 v[66:69], v6, s[4:7], s32 offen sc1
    s_nop 1
    v_cvt_pk_bf16_f32 v62, v46, v47
    v_cvt_pk_bf16_f32 v63, v48, v49
    v_and_or_b32 v62, v62, -2, s22
    s_nop 1
    v_cvt_pk_bf16_f32 v64, v50, v51
    v_cvt_pk_bf16_f32 v65, v52, v53
    buffer_store_dwordx4 v[62:65], v7, s[4:7], s32 offen sc1
    s_add_u32 s60, s20, 1
    s_and_b32 s22, s60, 1
    s_lshl_b32 s21, s22, 31
    s_sub_u32 s44, 0, s22
    s_bfe_u32 s23, s20, 0x10001
    s_sub_u32 s23, s23, 1
    s_lshr_b32 s24, s60, 1
    s_andn2_b32 s24, 1, s24
    s_lshl_b32 s61, s14, 15
    s_add_u32 s61, s61, 1179648
    s_and_b32 s25, s20, 1
    s_lshl_b32 s25, s25, 16
    s_add_u32 s25, s25, s61
    s_add_u32 s25, s25, 15360
    s_add_u32 s26, s25, 4096
    s_lshl_b32 s36, s22, 16
    s_add_u32 s36, s36, s61
    s_lshl_b32 s27, s20, 1
    s_add_u32 s37, s27, 2
    s_add_u32 s37, s37, s14
    s_mul_i32 s37, s37, 20480
    s_add_u32 s37, s37, 2621440
    s_add_u32 s27, s27, 1
    s_sub_u32 s27, s27, s14
    s_mul_i32 s27, s27, 20480
    s_add_u32 s27, s27, 2636800
    s_add_u32 s28, s27, 4096
    s_lshl_b32 s31, s20, 6
    s_add_u32 s31, s31, s13
    s_mul_i32 s31, s31, 6144
    s_add_u32 s31, s31, 5898240
    s_min_u32 s56, s20, 63
    s_lshl_b32 s56, s56, 6
    s_add_u32 s56, s56, s13
    s_mul_i32 s56, s56, 12288
    s_add_u32 s56, s56, 37364736
    s_max_u32 s57, s20, 5
    s_sub_u32 s57, s57, 5
    s_lshl_b32 s57, s57, 6
    s_add_u32 s57, s57, s13
    s_mul_i32 s57, s57, 12288
    s_add_u32 s57, s57, 87696384
    s_cmp_lt_u32 s20, 5
    s_cselect_b32 s57, s56, s57
    s_cmp_gt_u32 s60, 63
    s_cselect_b64 s[42:43], s[38:39], 0
    s_cmp_le_u32 s60, 5
    s_cselect_b64 vcc, s[40:41], 0
    s_or_b64 s[42:43], s[42:43], vcc
    s_add_u32 s60, s20, 1
    s_add_u32 s58, s60, 1
    s_cmp_gt_u32 s60, 63
    s_cselect_b32 s58, 0, s58
    s_sub_u32 s59, s60, 4
    s_cmp_lt_u32 s60, 5
    s_cselect_b32 s59, 0, s59
    v_mov_b32 v216, s58
    v_mov_b32 v218, s59
    v_cmp_gt_u32 vcc, 256, v0
    s_nop 1
    v_cndmask_b32 v216, v218, v216, vcc
    s_branch L_Rs3_top
L_Rs3_tail:
    s_waitcnt lgkmcnt(0)
    buffer_store_dwordx4 v[58:61], v0, s[4:7], s31 offen offset:0 sc1
    buffer_store_dwordx4 v[62:65], v0, s[4:7], s31 offen offset:1024 sc1
    buffer_store_dwordx4 v[66:69], v0, s[4:7], s31 offen offset:2048 sc1
    s_waitcnt vmcnt(0) lgkmcnt(0)
    s_barrier
    v_mov_b32 v22, 69
    s_mov_b64 exec, 1
    buffer_store_dword v22, v0, s[4:7], s54 offen sc1
    s_mov_b64 exec, -1
    s_waitcnt vmcnt(0)
    s_endpgm
L_Rs3_glfix_3:
    buffer_load_dwordx4 v[10:13], v0, s[4:7], s25 offen offset:0 sc1
    buffer_load_dwordx4 v[14:17], v0, s[4:7], s25 offen offset:1024 sc1
    buffer_load_dwordx4 v[18:21], v0, s[4:7], s25 offen offset:2048 sc1
    buffer_load_dwordx4 v[22:25], v0, s[4:7], s25 offen offset:3072 sc1
    buffer_load_dwordx4 v[26:29], v0, s[4:7], s26 offen offset:0 sc1
    buffer_load_dwordx4 v[46:49], v0, s[4:7], s27 offen offset:0 sc1
    buffer_load_dwordx4 v[30:33], v0, s[4:7], s27 offen offset:1024 sc1
    buffer_load_dwordx4 v[34:37], v0, s[4:7], s27 offen offset:2048 sc1
    buffer_load_dwordx4 v[38:41], v0, s[4:7], s27 offen offset:3072 sc1
    buffer_load_dwordx4 v[42:45], v0, s[4:7], s28 offen offset:0 sc1
    s_add_u32 s19, s19, 1
    s_cmp_lt_u32 s19, 524288
    s_cbranch_scc1 L_Rs3_gl_1
    s_branch L_fail
L_Rs3_grfix_5:
    buffer_load_dwordx4 v[46:49], v0, s[4:7], s27 offen offset:0 sc1
    buffer_load_dwordx4 v[30:33], v0, s[4:7], s27 offen offset:1024 sc1
    buffer_load_dwordx4 v[34:37], v0, s[4:7], s27 offen offset:2048 sc1
    buffer_load_dwordx4 v[38:41], v0, s[4:7], s27 offen offset:3072 sc1
    buffer_load_dwordx4 v[42:45], v0, s[4:7], s28 offen offset:0 sc1
    s_add_u32 s19, s19, 1
    s_cmp_lt_u32 s19, 524288
    s_cbranch_scc1 L_Rs3_gr2_4
    s_branch L_fail
L_Rs3_gr2_4:
    v_mfma_f32_16x16x32_bf16 v[50:53], a[240:243], v[10:13], 0
    v_mfma_f32_16x16x32_bf16 v[54:57], a[244:247], v[10:13], 0
    v_mfma_f32_16x16x32_bf16 v[58:61], a[240:243], v[14:17], 0
    v_mfma_f32_16x16x32_bf16 v[62:65], a[244:247], v[14:17], 0
    v_mfma_f32_16x16x32_bf16 v[66:69], a[240:243], v[18:21], 0
    v_mfma_f32_16x16x32_bf16 v[70:73], a[244:247], v[18:21], 0
    v_mfma_f32_16x16x32_bf16 v[74:77], a[240:243], v[22:25], 0
    v_mfma_f32_16x16x32_bf16 v[78:81], a[244:247], v[22:25], 0
    v_mfma_f32_16x16x32_bf16 v[82:85], a[240:243], v[26:29], 0
    v_mfma_f32_16x16x32_bf16 v[86:89], a[244:247], v[26:29], 0
    s_branch L_Rs3_gr_2
L_Rs3_hafix_7:
    buffer_load_dwordx4 v[82:85], v0, s[4:7], s30 offen sc1
    s_add_u32 s19, s19, 1
    s_cmp_lt_u32 s19, 524288
    s_cbranch_scc1 L_Rs3_ha_6
    s_branch L_fail
L_Rs3_kvretry_9:
    s_add_u32 s19, s19, 1
    s_cmp_ge_u32 s19, 524288
    s_cbranch_scc1 L_fail
    s_waitcnt vmcnt(0) lgkmcnt(0)
    buffer_load_dword v218, v217, s[4:7], s55 offen sc1
    s_waitcnt vmcnt(0)
    s_branch L_Rs3_kvchk_8
L_roleP:
    v_lshlrev_b32 v10, 4, v0
    s_lshl_b32 s34, s13, 2
    s_add_u32 s34, s34, s12
    s_lshl_b32 s34, s34, 7
    s_add_u32 s34, s34, 0
    v_mov_b32 v12, 0
    v_mov_b32 v13, 0
    v_mov_b32 v14, 0
    v_mov_b32 v15, 0
    s_mov_b64 exec, 1
    buffer_store_dwordx4 v[12:15], v10, s[4:7], s34 offen sc1
    s_mov_b64 exec, -1
    s_sub_u32 s40, s13, 64
    s_mul_i32 s20, s40, 21846
    s_lshr_b32 s20, s20, 16
    s_mul_i32 s41, s20, 3
    s_sub_u32 s21, s40, s41
    s_lshl_b32 s21, s21, 2
    s_add_u32 s21, s21, s12
    s_mul_i32 s43, s12, 40960
    s_mov_b32 s8, s70
    s_and_b32 s9, s71, 0xffff
    s_mov_b32 s10, 7864320
    s_mov_b32 s11, 0x20000
    s_mov_b32 s48, s72
    s_and_b32 s49, s73, 0xffff
    s_mov_b32 s50, 7864320
    s_mov_b32 s51, 0x20000
    s_cmp_ge_u32 s21, 6
    s_cselect_b32 s8, s68, s70
    s_cselect_b32 s9, s69, s71
    s_cselect_b32 s40, 6, 0
    s_and_b32 s9, s9, 0xffff
    s_sub_u32 s40, s21, s40
    s_mul_i32 s41, s20, 384
    s_lshl_b32 s52, s40, 6
    s_add_u32 s52, s52, s41
    s_lshl_b32 s53, s21, 5
    s_add_u32 s53, s53, s41
    s_cmp_ge_u32 s40, 3
    s_cselect_b32 s41, 9216, 0
    s_lshl_b32 s42, s40, 10
    s_add_u32 s41, s41, s42
    s_mul_i32 s30, s20, 24576
    s_add_u32 s41, s41, s30
    s_add_u32 s41, s41, 37355520
    s_mul_i32 s27, s20, 12288
    s_add_u32 s27, s27, s42
    s_add_u32 s27, s27, 138018816
    s_cmp_ge_u32 s21, 6
    s_cselect_b32 s27, s27, s41
    s_cselect_b32 s28, 32, 64
    s_cselect_b32 s29, 6, 3
    s_cselect_b32 s41, 6144, 0
    s_mul_i32 s28, s28, 12288
    s_lshl_b32 s29, s29, 10
    s_lshl_b32 s42, s21, 10
    s_add_u32 s30, s30, s42
    s_add_u32 s30, s30, s41
    s_add_u32 s30, s30, 37361664
    v_add_u32 v26, 0, v0
    v_mul_u32_u24 v27, 16385, v26
    v_lshrrev_b32 v27, 16, v27
    v_mul_u32_u24 v20, 4, v27
    v_sub_u32 v20, v26, v20
    v_lshrrev_b32 v20, 0, v20
    v_lshlrev_b32 v20, 4, v20
    v_mul_u32_u24 v27, 12288, v27
    v_add_u32 v20, v20, v27
    v_add_u32 v26, 64, v0
    v_mul_u32_u24 v27, 16385, v26
    v_lshrrev_b32 v27, 16, v27
    v_mul_u32_u24 v21, 4, v27
    v_sub_u32 v21, v26, v21
    v_lshrrev_b32 v21, 0, v21
    v_lshlrev_b32 v21, 4, v21
    v_mul_u32_u24 v27, 12288, v27
    v_add_u32 v21, v21, v27
    v_add_u32 v26, 0, v0
    v_mul_u32_u24 v27, 32769, v26
    v_lshrrev_b32 v27, 16, v27
    v_mul_u32_u24 v22, 2, v27
    v_sub_u32 v22, v26, v22
    v_lshrrev_b32 v22, 0, v22
    v_lshlrev_b32 v22, 4, v22
    v_mul_u32_u24 v27, 12288, v27
    v_add_u32 v22, v22, v27
    v_lshrrev_b32 v23, 2, v0
    v_mul_u32_u24 v23, 64, v23
    v_and_b32 v26, 3, v0
    v_lshl_add_u32 v23, v26, 3, v23
    v_add_u32 v23, s43, v23
    v_lshrrev_b32 v24, 2, v0
    v_mul_u32_u24 v24, 32, v24
    v_and_b32 v26, 3, v0
    v_lshl_add_u32 v24, v26, 3, v24
    v_add_u32 v24, s43, v24
    s_add_u32 m0, s43, 0
    s_nop 0
    buffer_load_dwordx4 v20, s[8:11], s52 offen lds
    s_add_u32 m0, s43, 1024
    s_nop 0
    buffer_load_dwordx4 v21, s[8:11], s52 offen lds
    s_add_u32 m0, s43, 2048
    s_nop 0
    buffer_load_dwordx4 v22, s[48:51], s53 offen lds
    s_add_u32 s52, s52, 393216
    s_add_u32 m0, s43, 3072
    s_nop 0
    buffer_load_dwordx4 v20, s[8:11], s52 offen lds
    s_add_u32 m0, s43, 4096
    s_nop 0
    buffer_load_dwordx4 v21, s[8:11], s52 offen lds
    s_add_u32 s53, s53, 393216
    s_add_u32 m0, s43, 5120
    s_nop 0
    buffer_load_dwordx4 v22, s[48:51], s53 offen lds
    s_add_u32 s52, s52, 393216
    s_add_u32 m0, s43, 6144
    s_nop 0
    buffer_load_dwordx4 v20, s[8:11], s52 offen lds
    s_add_u32 m0, s43, 7168
    s_nop 0
    buffer_load_dwordx4 v21, s[8:11], s52 offen lds
    s_add_u32 s53, s53, 393216
    s_add_u32 m0, s43, 8192
    s_nop 0
    buffer_load_dwordx4 v22, s[48:51], s53 offen lds
    s_add_u32 s52, s52, 393216
    s_add_u32 m0, s43, 9216
    s_nop 0
    buffer_load_dwordx4 v20, s[8:11], s52 offen lds
    s_add_u32 m0, s43, 10240
    s_nop 0
    buffer_load_dwordx4 v21, s[8:11], s52 offen lds
    s_add_u32 s53, s53, 393216
    s_add_u32 m0, s43, 11264
    s_nop 0
    buffer_load_dwordx4 v22, s[48:51], s53 offen lds
    s_add_u32 s52, s52, 393216
    s_add_u32 m0, s43, 12288
    s_nop 0
    buffer_load_dwordx4 v20, s[8:11], s52 offen lds
    s_add_u32 m0, s43, 13312
    s_nop 0
    buffer_load_dwordx4 v21, s[8:11], s52 offen lds
    s_add_u32 s53, s53, 393216
    s_add_u32 m0, s43, 14336
    s_nop 0
    buffer_load_dwordx4 v22, s[48:51], s53 offen lds
    s_add_u32 s52, s52, 393216
    s_add_u32 m0, s43, 15360
    s_nop 0
    buffer_load_dwordx4 v20, s[8:11], s52 offen lds
    s_add_u32 m0, s43, 16384
    s_nop 0
    buffer_load_dwordx4 v21, s[8:11], s52 offen lds
    s_add_u32 s53, s53, 393216
    s_add_u32 m0, s43, 17408
    s_nop 0
    buffer_load_dwordx4 v22, s[48:51], s53 offen lds
    s_add_u32 s52, s52, 393216
    s_add_u32 m0, s43, 18432
    s_nop 0
    buffer_load_dwordx4 v20, s[8:11], s52 offen lds
    s_add_u32 m0, s43, 19456
    s_nop 0
    buffer_load_dwordx4 v21, s[8:11], s52 offen lds
    s_add_u32 s53, s53, 393216
    s_add_u32 m0, s43, 20480
    s_nop 0
    buffer_load_dwordx4 v22, s[48:51], s53 offen lds
    s_add_u32 s52, s52, 393216
    s_add_u32 m0, s43, 21504
    s_nop 0
    buffer_load_dwordx4 v20, s[8:11], s52 offen lds
    s_add_u32 m0, s43, 22528
    s_nop 0
    buffer_load_dwordx4 v21, s[8:11], s52 offen lds
    s_add_u32 s53, s53, 393216
    s_add_u32 m0, s43, 23552
    s_nop 0
    buffer_load_dwordx4 v22, s[48:51], s53 offen lds
    s_add_u32 s52, s52, 393216
    s_add_u32 m0, s43, 24576
    s_nop 0
    buffer_load_dwordx4 v20, s[8:11], s52 offen lds
    s_add_u32 m0, s43, 25600
    s_nop 0
    buffer_load_dwordx4 v21, s[8:11], s52 offen lds
    s_add_u32 s53, s53, 393216
    s_add_u32 m0, s43, 26624
    s_nop 0
    buffer_load_dwordx4 v22, s[48:51], s53 offen lds
    s_add_u32 s52, s52, 393216
    s_add_u32 m0, s43, 27648
    s_nop 0
    buffer_load_dwordx4 v20, s[8:11], s52 offen lds
    s_add_u32 m0, s43, 28672
    s_nop 0
    buffer_load_dwordx4 v21, s[8:11], s52 offen lds
    s_add_u32 s53, s53, 393216
    s_add_u32 m0, s43, 29696
    s_nop 0
    buffer_load_dwordx4 v22, s[48:51], s53 offen lds
    s_add_u32 s52, s52, 393216
    s_add_u32 m0, s43, 30720
    s_nop 0
    buffer_load_dwordx4 v20, s[8:11], s52 offen lds
    s_add_u32 m0, s43, 31744
    s_nop 0
    buffer_load_dwordx4 v21, s[8:11], s52 offen lds
    s_add_u32 s53, s53, 393216
    s_add_u32 m0, s43, 32768
    s_nop 0
    buffer_load_dwordx4 v22, s[48:51], s53 offen lds
    s_add_u32 s52, s52, 393216
    s_add_u32 m0, s43, 33792
    s_nop 0
    buffer_load_dwordx4 v20, s[8:11], s52 offen lds
    s_add_u32 m0, s43, 34816
    s_nop 0
    buffer_load_dwordx4 v21, s[8:11], s52 offen lds
    s_add_u32 s53, s53, 393216
    s_add_u32 m0, s43, 35840
    s_nop 0
    buffer_load_dwordx4 v22, s[48:51], s53 offen lds
    s_waitcnt vmcnt(34)
    s_barrier
    s_cmp_lg_u32 s12, 0
    s_cbranch_scc1 L_P_arr_1
    s_lshl_b32 s3, s18, 2
    s_add_u32 s3, s3, 64
    v_mov_b32 v92, s3
    v_mov_b32 v93, 1
    s_mov_b64 exec, 1
    global_atomic_add v92, v93, s[16:17] sc1
    s_waitcnt vmcnt(0)
    s_mov_b64 exec, -1
L_P_arr_1:
    ds_read_b64_tr_b16 a[0:1], v23 offset:0
    ds_read_b64_tr_b16 a[2:3], v23 offset:1024
    ds_read_b64_tr_b16 a[80:81], v23 offset:32
    ds_read_b64_tr_b16 a[82:83], v23 offset:1056
    s_waitcnt lgkmcnt(0)
    s_add_u32 s52, s52, 393216
    s_add_u32 m0, s43, 0
    s_nop 0
    buffer_load_dwordx4 v20, s[8:11], s52 offen lds
    s_add_u32 m0, s43, 1024
    s_nop 0
    buffer_load_dwordx4 v21, s[8:11], s52 offen lds
    s_waitcnt vmcnt(35)
    ds_read_b64_tr_b16 a[160:161], v24 offset:2048
    ds_read_b64_tr_b16 a[162:163], v24 offset:2560
    s_waitcnt lgkmcnt(0)
    s_add_u32 s53, s53, 393216
    s_add_u32 m0, s43, 2048
    s_nop 0
    buffer_load_dwordx4 v22, s[48:51], s53 offen lds
    s_waitcnt vmcnt(34)
    ds_read_b64_tr_b16 a[4:5], v23 offset:3072
    ds_read_b64_tr_b16 a[6:7], v23 offset:4096
    ds_read_b64_tr_b16 a[84:85], v23 offset:3104
    ds_read_b64_tr_b16 a[86:87], v23 offset:4128
    s_waitcnt lgkmcnt(0)
    s_add_u32 s52, s52, 393216
    s_add_u32 m0, s43, 3072
    s_nop 0
    buffer_load_dwordx4 v20, s[8:11], s52 offen lds
    s_add_u32 m0, s43, 4096
    s_nop 0
    buffer_load_dwordx4 v21, s[8:11], s52 offen lds
    s_waitcnt vmcnt(35)
    ds_read_b64_tr_b16 a[164:165], v24 offset:5120
    ds_read_b64_tr_b16 a[166:167], v24 offset:5632
    s_waitcnt lgkmcnt(0)
    s_add_u32 s53, s53, 393216
    s_add_u32 m0, s43, 5120
    s_nop 0
    buffer_load_dwordx4 v22, s[48:51], s53 offen lds
    s_waitcnt vmcnt(34)
    ds_read_b64_tr_b16 a[8:9], v23 offset:6144
    ds_read_b64_tr_b16 a[10:11], v23 offset:7168
    ds_read_b64_tr_b16 a[88:89], v23 offset:6176
    ds_read_b64_tr_b16 a[90:91], v23 offset:7200
    s_waitcnt lgkmcnt(0)
    s_add_u32 s52, s52, 393216
    s_add_u32 m0, s43, 6144
    s_nop 0
    buffer_load_dwordx4 v20, s[8:11], s52 offen lds
    s_add_u32 m0, s43, 7168
    s_nop 0
    buffer_load_dwordx4 v21, s[8:11], s52 offen lds
    s_waitcnt vmcnt(35)
    ds_read_b64_tr_b16 a[168:169], v24 offset:8192
    ds_read_b64_tr_b16 a[170:171], v24 offset:8704
    s_waitcnt lgkmcnt(0)
    s_add_u32 s53, s53, 393216
    s_add_u32 m0, s43, 8192
    s_nop 0
    buffer_load_dwordx4 v22, s[48:51], s53 offen lds
    s_waitcnt vmcnt(34)
    ds_read_b64_tr_b16 a[12:13], v23 offset:9216
    ds_read_b64_tr_b16 a[14:15], v23 offset:10240
    ds_read_b64_tr_b16 a[92:93], v23 offset:9248
    ds_read_b64_tr_b16 a[94:95], v23 offset:10272
    s_waitcnt lgkmcnt(0)
    s_add_u32 s52, s52, 393216
    s_add_u32 m0, s43, 9216
    s_nop 0
    buffer_load_dwordx4 v20, s[8:11], s52 offen lds
    s_add_u32 m0, s43, 10240
    s_nop 0
    buffer_load_dwordx4 v21, s[8:11], s52 offen lds
    s_waitcnt vmcnt(35)
    ds_read_b64_tr_b16 a[172:173], v24 offset:11264
    ds_read_b64_tr_b16 a[174:175], v24 offset:11776
    s_waitcnt lgkmcnt(0)
    s_add_u32 s53, s53, 393216
    s_add_u32 m0, s43, 11264
    s_nop 0
    buffer_load_dwordx4 v22, s[48:51], s53 offen lds
    s_waitcnt vmcnt(34)
    ds_read_b64_tr_b16 a[16:17], v23 offset:12288
    ds_read_b64_tr_b16 a[18:19], v23 offset:13312
    ds_read_b64_tr_b16 a[96:97], v23 offset:12320
    ds_read_b64_tr_b16 a[98:99], v23 offset:13344
    s_waitcnt lgkmcnt(0)
    s_add_u32 s52, s52, 393216
    s_add_u32 m0, s43, 12288
    s_nop 0
    buffer_load_dwordx4 v20, s[8:11], s52 offen lds
    s_add_u32 m0, s43, 13312
    s_nop 0
    buffer_load_dwordx4 v21, s[8:11], s52 offen lds
    s_waitcnt vmcnt(35)
    ds_read_b64_tr_b16 a[176:177], v24 offset:14336
    ds_read_b64_tr_b16 a[178:179], v24 offset:14848
    s_waitcnt lgkmcnt(0)
    s_add_u32 s53, s53, 393216
    s_add_u32 m0, s43, 14336
    s_nop 0
    buffer_load_dwordx4 v22, s[48:51], s53 offen lds
    s_waitcnt vmcnt(34)
    ds_read_b64_tr_b16 a[20:21], v23 offset:15360
    ds_read_b64_tr_b16 a[22:23], v23 offset:16384
    ds_read_b64_tr_b16 a[100:101], v23 offset:15392
    ds_read_b64_tr_b16 a[102:103], v23 offset:16416
    s_waitcnt lgkmcnt(0)
    s_add_u32 s52, s52, 393216
    s_add_u32 m0, s43, 15360
    s_nop 0
    buffer_load_dwordx4 v20, s[8:11], s52 offen lds
    s_add_u32 m0, s43, 16384
    s_nop 0
    buffer_load_dwordx4 v21, s[8:11], s52 offen lds
    s_waitcnt vmcnt(35)
    ds_read_b64_tr_b16 a[180:181], v24 offset:17408
    ds_read_b64_tr_b16 a[182:183], v24 offset:17920
    s_waitcnt lgkmcnt(0)
    s_add_u32 s53, s53, 393216
    s_add_u32 m0, s43, 17408
    s_nop 0
    buffer_load_dwordx4 v22, s[48:51], s53 offen lds
    s_waitcnt vmcnt(34)
    ds_read_b64_tr_b16 a[24:25], v23 offset:18432
    ds_read_b64_tr_b16 a[26:27], v23 offset:19456
    ds_read_b64_tr_b16 a[104:105], v23 offset:18464
    ds_read_b64_tr_b16 a[106:107], v23 offset:19488
    s_waitcnt lgkmcnt(0)
    s_add_u32 s52, s52, 393216
    s_add_u32 m0, s43, 18432
    s_nop 0
    buffer_load_dwordx4 v20, s[8:11], s52 offen lds
    s_add_u32 m0, s43, 19456
    s_nop 0
    buffer_load_dwordx4 v21, s[8:11], s52 offen lds
    s_waitcnt vmcnt(35)
    ds_read_b64_tr_b16 a[184:185], v24 offset:20480
    ds_read_b64_tr_b16 a[186:187], v24 offset:20992
    s_waitcnt lgkmcnt(0)
    s_add_u32 s53, s53, 393216
    s_add_u32 m0, s43, 20480
    s_nop 0
    buffer_load_dwordx4 v22, s[48:51], s53 offen lds
    s_waitcnt vmcnt(34)
    ds_read_b64_tr_b16 a[28:29], v23 offset:21504
    ds_read_b64_tr_b16 a[30:31], v23 offset:22528
    ds_read_b64_tr_b16 a[108:109], v23 offset:21536
    ds_read_b64_tr_b16 a[110:111], v23 offset:22560
    s_waitcnt lgkmcnt(0)
    s_add_u32 s52, s52, 393216
    s_add_u32 m0, s43, 21504
    s_nop 0
    buffer_load_dwordx4 v20, s[8:11], s52 offen lds
    s_add_u32 m0, s43, 22528
    s_nop 0
    buffer_load_dwordx4 v21, s[8:11], s52 offen lds
    s_waitcnt vmcnt(35)
    ds_read_b64_tr_b16 a[188:189], v24 offset:23552
    ds_read_b64_tr_b16 a[190:191], v24 offset:24064
    s_waitcnt lgkmcnt(0)
    s_add_u32 s53, s53, 393216
    s_add_u32 m0, s43, 23552
    s_nop 0
    buffer_load_dwordx4 v22, s[48:51], s53 offen lds
    s_waitcnt vmcnt(34)
    ds_read_b64_tr_b16 a[32:33], v23 offset:24576
    ds_read_b64_tr_b16 a[34:35], v23 offset:25600
    ds_read_b64_tr_b16 a[112:113], v23 offset:24608
    ds_read_b64_tr_b16 a[114:115], v23 offset:25632
    s_waitcnt lgkmcnt(0)
    s_waitcnt vmcnt(33)
    ds_read_b64_tr_b16 a[192:193], v24 offset:26624
    ds_read_b64_tr_b16 a[194:195], v24 offset:27136
    s_waitcnt lgkmcnt(0)
    s_waitcnt vmcnt(31)
    ds_read_b64_tr_b16 a[36:37], v23 offset:27648
    ds_read_b64_tr_b16 a[38:39], v23 offset:28672
    ds_read_b64_tr_b16 a[116:117], v23 offset:27680
    ds_read_b64_tr_b16 a[118:119], v23 offset:28704
    s_waitcnt lgkmcnt(0)
    s_waitcnt vmcnt(30)
    ds_read_b64_tr_b16 a[196:197], v24 offset:29696
    ds_read_b64_tr_b16 a[198:199], v24 offset:30208
    s_waitcnt lgkmcnt(0)
    s_waitcnt vmcnt(28)
    ds_read_b64_tr_b16 a[40:41], v23 offset:30720
    ds_read_b64_tr_b16 a[42:43], v23 offset:31744
    ds_read_b64_tr_b16 a[120:121], v23 offset:30752
    ds_read_b64_tr_b16 a[122:123], v23 offset:31776
    s_waitcnt lgkmcnt(0)
    s_waitcnt vmcnt(27)
    ds_read_b64_tr_b16 a[200:201], v24 offset:32768
    ds_read_b64_tr_b16 a[202:203], v24 offset:33280
    s_waitcnt lgkmcnt(0)
    s_waitcnt vmcnt(25)
    ds_read_b64_tr_b16 a[44:45], v23 offset:33792
    ds_read_b64_tr_b16 a[46:47], v23 offset:34816
    ds_read_b64_tr_b16 a[124:125], v23 offset:33824
    ds_read_b64_tr_b16 a[126:127], v23 offset:34848
    s_waitcnt lgkmcnt(0)
    s_waitcnt vmcnt(24)
    ds_read_b64_tr_b16 a[204:205], v24 offset:35840
    ds_read_b64_tr_b16 a[206:207], v24 offset:36352
    s_waitcnt lgkmcnt(0)
    s_waitcnt vmcnt(22)
    ds_read_b64_tr_b16 a[48:49], v23 offset:0
    ds_read_b64_tr_b16 a[50:51], v23 offset:1024
    ds_read_b64_tr_b16 a[128:129], v23 offset:32
    ds_read_b64_tr_b16 a[130:131], v23 offset:1056
    s_waitcnt lgkmcnt(0)
    s_waitcnt vmcnt(21)
    ds_read_b64_tr_b16 a[208:209], v24 offset:2048
    ds_read_b64_tr_b16 a[210:211], v24 offset:2560
    s_waitcnt lgkmcnt(0)
    s_waitcnt vmcnt(19)
    ds_read_b64_tr_b16 a[52:53], v23 offset:3072
    ds_read_b64_tr_b16 a[54:55], v23 offset:4096
    ds_read_b64_tr_b16 a[132:133], v23 offset:3104
    ds_read_b64_tr_b16 a[134:135], v23 offset:4128
    s_waitcnt lgkmcnt(0)
    s_waitcnt vmcnt(18)
    ds_read_b64_tr_b16 a[212:213], v24 offset:5120
    ds_read_b64_tr_b16 a[214:215], v24 offset:5632
    s_waitcnt lgkmcnt(0)
    s_waitcnt vmcnt(16)
    ds_read_b64_tr_b16 a[56:57], v23 offset:6144
    ds_read_b64_tr_b16 a[58:59], v23 offset:7168
    ds_read_b64_tr_b16 a[136:137], v23 offset:6176
    ds_read_b64_tr_b16 a[138:139], v23 offset:7200
    s_waitcnt lgkmcnt(0)
    s_waitcnt vmcnt(15)
    ds_read_b64_tr_b16 a[216:217], v24 offset:8192
    ds_read_b64_tr_b16 a[218:219], v24 offset:8704
    s_waitcnt lgkmcnt(0)
    s_waitcnt vmcnt(13)
    ds_read_b64_tr_b16 a[60:61], v23 offset:9216
    ds_read_b64_tr_b16 a[62:63], v23 offset:10240
    ds_read_b64_tr_b16 a[140:141], v23 offset:9248
    ds_read_b64_tr_b16 a[142:143], v23 offset:10272
    s_waitcnt lgkmcnt(0)
    s_waitcnt vmcnt(12)
    ds_read_b64_tr_b16 a[220:221], v24 offset:11264
    ds_read_b64_tr_b16 a[222:223], v24 offset:11776
    s_waitcnt lgkmcnt(0)
    s_waitcnt vmcnt(10)
    ds_read_b64_tr_b16 a[64:65], v23 offset:12288
    ds_read_b64_tr_b16 a[66:67], v23 offset:13312
    ds_read_b64_tr_b16 a[144:145], v23 offset:12320
    ds_read_b64_tr_b16 a[146:147], v23 offset:13344
    s_waitcnt lgkmcnt(0)
    s_waitcnt vmcnt(9)
    ds_read_b64_tr_b16 a[224:225], v24 offset:14336
    ds_read_b64_tr_b16 a[226:227], v24 offset:14848
    s_waitcnt lgkmcnt(0)
    s_waitcnt vmcnt(7)
    ds_read_b64_tr_b16 a[68:69], v23 offset:15360
    ds_read_b64_tr_b16 a[70:71], v23 offset:16384
    ds_read_b64_tr_b16 a[148:149], v23 offset:15392
    ds_read_b64_tr_b16 a[150:151], v23 offset:16416
    s_waitcnt lgkmcnt(0)
    s_waitcnt vmcnt(6)
    ds_read_b64_tr_b16 a[228:229], v24 offset:17408
    ds_read_b64_tr_b16 a[230:231], v24 offset:17920
    s_waitcnt lgkmcnt(0)
    s_waitcnt vmcnt(4)
    ds_read_b64_tr_b16 a[72:73], v23 offset:18432
    ds_read_b64_tr_b16 a[74:75], v23 offset:19456
    ds_read_b64_tr_b16 a[152:153], v23 offset:18464
    ds_read_b64_tr_b16 a[154:155], v23 offset:19488
    s_waitcnt lgkmcnt(0)
    s_waitcnt vmcnt(3)
    ds_read_b64_tr_b16 a[232:233], v24 offset:20480
    ds_read_b64_tr_b16 a[234:235], v24 offset:20992
    s_waitcnt lgkmcnt(0)
    s_waitcnt vmcnt(1)
    ds_read_b64_tr_b16 a[76:77], v23 offset:21504
    ds_read_b64_tr_b16 a[78:79], v23 offset:22528
    ds_read_b64_tr_b16 a[156:157], v23 offset:21536
    ds_read_b64_tr_b16 a[158:159], v23 offset:22560
    s_waitcnt lgkmcnt(0)
    s_waitcnt vmcnt(0)
    ds_read_b64_tr_b16 a[236:237], v24 offset:23552
    ds_read_b64_tr_b16 a[238:239], v24 offset:24064
    s_waitcnt lgkmcnt(0)
    s_mul_i32 s63, s12, 10240
    s_and_b32 s3, s12, 1
    s_lshl_b32 s3, s3, 2
    v_lshrrev_b32 v10, 3, v0
    v_mul_u32_u24 v1, 1280, v10
    v_lshrrev_b32 v10, 4, v0
    v_add_u32 v10, s3, v10
    v_and_b32 v11, 7, v0
    v_xor_b32 v10, v10, v11
    v_lshl_add_u32 v1, v10, 4, v1
    v_add_u32 v1, s63, v1
    v_bfe_u32 v10, v0, 3, 1
    v_mul_u32_u24 v2, 10240, v10
    v_lshl_add_u32 v2, v11, 7, v2
    v_bfe_u32 v10, v0, 1, 3
    v_lshrrev_b32 v11, 4, v0
    v_xor_b32 v10, v10, v11
    v_lshl_add_u32 v2, v10, 4, v2
    v_xor_b32 v3, 64, v2
    v_lshlrev_b32 v4, 7, v0
    v_and_b32 v5, 31, v0
    v_lshlrev_b32 v5, 8, v5
    s_lshl_b32 s3, s18, 2
    s_add_u32 s3, s3, 64
    v_mov_b32 v92, s3
    v_lshlrev_b32 v94, 2, v0
    v_and_b32 v94, 28, v94
    s_mov_b32 s19, 0
L_P_warr_2:
    global_load_dword v93, v92, s[16:17] sc1
    s_add_u32 s19, s19, 1
    s_cmp_ge_u32 s19, 524288
    s_cbranch_scc1 L_fail
    s_waitcnt vmcnt(0)
    v_cmp_gt_u32 vcc, 256, v93
    s_nop 0
    s_cbranch_vccnz L_P_warr_2
    s_cmp_lg_u32 s18, 0
    s_cbranch_scc1 L_P_placed_3
    global_load_dword v93, v94, s[16:17] sc1
    s_waitcnt vmcnt(0)
    v_cmp_ne_u32 vcc, 32, v93
    s_nop 0
    s_cbranch_vccnz L_fallback
L_P_placed_3:
    v_lshlrev_b32 v0, 4, v0
    s_mov_b32 s22, 0
    s_mov_b32 s23, 0
    s_add_u32 s31, s63, 40960
    s_mov_b32 s32, s63
    s_mov_b32 s33, 40960
    s_mov_b32 s44, 0
    s_mov_b32 s45, 0
    v_add_u32 v2, s33, v2
    v_add_u32 v3, s33, v3
    s_barrier
    s_mov_b32 s39, 98304
    buffer_load_dword v7, v4, s[4:7], s39 offen offset:8 sc1
    s_waitcnt vmcnt(0)
    s_mov_b32 s19, 0
    v_cmp_gt_u32 vcc, 1, v7
    s_nop 0
    s_cbranch_vccnz L_P_flspin_5
L_P_fl_4:
    s_mov_b32 s39, 106496
    buffer_load_dword v7, v4, s[4:7], s39 offen offset:8 sc1
    s_waitcnt vmcnt(0)
    s_mov_b32 s19, 0
    v_cmp_gt_u32 vcc, 1, v7
    s_nop 0
    s_cbranch_vccnz L_P_flspin_7
L_P_fl_6:
    s_mov_b32 s39, 114688
    s_sub_u32 s40, s22, s23
    s_cmp_ge_u32 s40, 7
    s_cselect_b32 s25, 1, 0
    s_cmp_eq_u32 s22, 64
    s_cselect_b32 s25, 1, s25
    s_cmp_eq_u32 s25, 1
    s_cselect_b32 s26, s23, s22
    s_add_u32 s23, s23, s25
    s_add_u32 s22, s22, 1
    s_sub_u32 s22, s22, s25
    s_add_u32 s38, s26, 1
    s_lshl_b32 s41, s25, 6
    s_add_u32 s40, s26, s41
    s_mul_i32 s35, s40, 40960
    s_add_u32 s35, s35, 188350464
    s_add_u32 m0, s32, 0
    s_nop 0
    buffer_load_dwordx4 v1, s[4:7], s35 offen offset:0 sc1 lds
    s_add_u32 m0, s32, 896
    s_nop 0
    buffer_load_dwordx4 v1, s[4:7], s35 offen offset:128 sc1 lds
    s_add_u32 m0, s32, 1792
    s_nop 0
    buffer_load_dwordx4 v1, s[4:7], s35 offen offset:256 sc1 lds
    s_add_u32 m0, s32, 2688
    s_nop 0
    buffer_load_dwordx4 v1, s[4:7], s35 offen offset:384 sc1 lds
    s_add_u32 m0, s32, 3584
    s_nop 0
    buffer_load_dwordx4 v1, s[4:7], s35 offen offset:512 sc1 lds
    s_add_u32 m0, s32, 4480
    s_nop 0
    buffer_load_dwordx4 v1, s[4:7], s35 offen offset:640 sc1 lds
    s_add_u32 m0, s32, 5376
    s_nop 0
    buffer_load_dwordx4 v1, s[4:7], s35 offen offset:768 sc1 lds
    s_add_u32 m0, s32, 6272
    s_nop 0
    buffer_load_dwordx4 v1, s[4:7], s35 offen offset:896 sc1 lds
    s_add_u32 m0, s32, 7168
    s_nop 0
    buffer_load_dwordx4 v1, s[4:7], s35 offen offset:1024 sc1 lds
    s_add_u32 m0, s32, 8064
    s_nop 0
    buffer_load_dwordx4 v1, s[4:7], s35 offen offset:1152 sc1 lds
    s_waitcnt vmcnt(0)
L_P_top:
    s_waitcnt vmcnt(3)
    s_barrier
    s_mov_b32 s36, s44
    s_mov_b32 s37, s45
    s_lshl_b32 s44, s25, 2
    s_add_u32 s44, s44, s34
    s_add_u32 s45, s26, 1
    s_lshl_b32 s24, s25, 6
    s_add_u32 s24, s24, s26
    s_sub_u32 s33, 0, s33
    s_mov_b32 s40, s31
    s_mov_b32 s31, s32
    s_mov_b32 s32, s40
    v_add_u32 v2, s33, v2
    v_add_u32 v3, s33, v3
    s_sub_u32 s40, s22, s23
    s_cmp_ge_u32 s40, 7
    s_cselect_b32 s25, 1, 0
    s_cmp_eq_u32 s22, 64
    s_cselect_b32 s25, 1, s25
    s_cmp_eq_u32 s25, 1
    s_cselect_b32 s26, s23, s22
    s_add_u32 s23, s23, s25
    s_add_u32 s22, s22, 1
    s_sub_u32 s22, s22, s25
    s_add_u32 s38, s26, 1
    s_lshl_b32 s41, s25, 6
    s_add_u32 s40, s26, s41
    s_mul_i32 s35, s40, 40960
    s_add_u32 s35, s35, 188350464
    s_cmp_eq_u32 s25, 1
    s_cbranch_scc1 L_P_late
    ds_read_b128 v[12:15], v2 offset:0
    ds_read_b128 v[16:19], v2 offset:20480
    ds_read_b128 v[20:23], v3 offset:0
    ds_read_b128 v[24:27], v3 offset:20480
    ds_read_b128 v[28:31], v2 offset:1024
    ds_read_b128 v[32:35], v2 offset:21504
    s_waitcnt lgkmcnt(4)
    v_mfma_f32_16x16x32_bf16 v[36:39], a[0:3], v[12:15], 0
    s_add_u32 m0, s32, 0
    s_nop 0
    buffer_load_dwordx4 v1, s[4:7], s35 offen offset:0 sc1 lds
    v_mfma_f32_16x16x32_bf16 v[40:43], a[80:83], v[12:15], 0
    v_mfma_f32_16x16x32_bf16 v[52:55], v[12:15], a[160:163], 0
    s_add_u32 m0, s32, 896
    s_nop 0
    buffer_load_dwordx4 v1, s[4:7], s35 offen offset:128 sc1 lds
    v_mfma_f32_16x16x32_bf16 v[44:47], a[0:3], v[16:19], 0
    v_mfma_f32_16x16x32_bf16 v[48:51], a[80:83], v[16:19], 0
    v_mfma_f32_16x16x32_bf16 v[56:59], v[16:19], a[160:163], 0
    ds_read_b128 v[12:15], v3 offset:1024
    ds_read_b128 v[16:19], v3 offset:21504
    s_waitcnt lgkmcnt(4)
    v_mfma_f32_16x16x32_bf16 v[36:39], a[4:7], v[20:23], v[36:39]
    s_add_u32 m0, s32, 1792
    s_nop 0
    buffer_load_dwordx4 v1, s[4:7], s35 offen offset:256 sc1 lds
    v_mfma_f32_16x16x32_bf16 v[40:43], a[84:87], v[20:23], v[40:43]
    v_mfma_f32_16x16x32_bf16 v[52:55], v[20:23], a[164:167], v[52:55]
    s_add_u32 m0, s32, 2688
    s_nop 0
    buffer_load_dwordx4 v1, s[4:7], s35 offen offset:384 sc1 lds
    v_mfma_f32_16x16x32_bf16 v[44:47], a[4:7], v[24:27], v[44:47]
    v_mfma_f32_16x16x32_bf16 v[48:51], a[84:87], v[24:27], v[48:51]
    v_mfma_f32_16x16x32_bf16 v[56:59], v[24:27], a[164:167], v[56:59]
    ds_read_b128 v[20:23], v2 offset:2048
    ds_read_b128 v[24:27], v2 offset:22528
    s_waitcnt lgkmcnt(4)
    v_mfma_f32_16x16x32_bf16 v[36:39], a[8:11], v[28:31], v[36:39]
    s_add_u32 m0, s32, 3584
    s_nop 0
    buffer_load_dwordx4 v1, s[4:7], s35 offen offset:512 sc1 lds
    v_mfma_f32_16x16x32_bf16 v[40:43], a[88:91], v[28:31], v[40:43]
    v_mfma_f32_16x16x32_bf16 v[52:55], v[28:31], a[168:171], v[52:55]
    s_add_u32 m0, s32, 4480
    s_nop 0
    buffer_load_dwordx4 v1, s[4:7], s35 offen offset:640 sc1 lds
    v_mfma_f32_16x16x32_bf16 v[44:47], a[8:11], v[32:35], v[44:47]
    v_mfma_f32_16x16x32_bf16 v[48:51], a[88:91], v[32:35], v[48:51]
    v_mfma_f32_16x16x32_bf16 v[56:59], v[32:35], a[168:171], v[56:59]
    ds_read_b128 v[28:31], v3 offset:2048
    ds_read_b128 v[32:35], v3 offset:22528
    s_waitcnt lgkmcnt(4)
    v_mfma_f32_16x16x32_bf16 v[36:39], a[12:15], v[12:15], v[36:39]
    s_add_u32 m0, s32, 5376
    s_nop 0
    buffer_load_dwordx4 v1, s[4:7], s35 offen offset:768 sc1 lds
    v_mfma_f32_16x16x32_bf16 v[40:43], a[92:95], v[12:15], v[40:43]
    v_mfma_f32_16x16x32_bf16 v[52:55], v[12:15], a[172:175], v[52:55]
    s_add_u32 m0, s32, 6272
    s_nop 0
    buffer_load_dwordx4 v1, s[4:7], s35 offen offset:896 sc1 lds
    v_mfma_f32_16x16x32_bf16 v[44:47], a[12:15], v[16:19], v[44:47]
    v_mfma_f32_16x16x32_bf16 v[48:51], a[92:95], v[16:19], v[48:51]
    v_mfma_f32_16x16x32_bf16 v[56:59], v[16:19], a[172:175], v[56:59]
    ds_read_b128 v[12:15], v2 offset:3072
    ds_read_b128 v[16:19], v2 offset:23552
    s_waitcnt lgkmcnt(4)
    v_mfma_f32_16x16x32_bf16 v[36:39], a[16:19], v[20:23], v[36:39]
    s_add_u32 m0, s32, 7168
    s_nop 0
    buffer_load_dwordx4 v1, s[4:7], s35 offen offset:1024 sc1 lds
    v_mfma_f32_16x16x32_bf16 v[40:43], a[96:99], v[20:23], v[40:43]
    v_mfma_f32_16x16x32_bf16 v[52:55], v[20:23], a[176:179], v[52:55]
    s_add_u32 m0, s32, 8064
    s_nop 0
    buffer_load_dwordx4 v1, s[4:7], s35 offen offset:1152 sc1 lds
    v_mfma_f32_16x16x32_bf16 v[44:47], a[16:19], v[24:27], v[44:47]
    v_mfma_f32_16x16x32_bf16 v[48:51], a[96:99], v[24:27], v[48:51]
    v_mfma_f32_16x16x32_bf16 v[56:59], v[24:27], a[176:179], v[56:59]
    ds_read_b128 v[20:23], v3 offset:3072
    ds_read_b128 v[24:27], v3 offset:23552
    s_waitcnt lgkmcnt(4)
    v_mfma_f32_16x16x32_bf16 v[36:39], a[20:23], v[28:31], v[36:39]
    v_mfma_f32_16x16x32_bf16 v[40:43], a[100:103], v[28:31], v[40:43]
    v_mfma_f32_16x16x32_bf16 v[52:55], v[28:31], a[180:183], v[52:55]
    v_mfma_f32_16x16x32_bf16 v[44:47], a[20:23], v[32:35], v[44:47]
    v_mfma_f32_16x16x32_bf16 v[48:51], a[100:103], v[32:35], v[48:51]
    v_mfma_f32_16x16x32_bf16 v[56:59], v[32:35], a[180:183], v[56:59]
    ds_read_b128 v[28:31], v2 offset:4096
    ds_read_b128 v[32:35], v2 offset:24576
    s_waitcnt lgkmcnt(4)
    v_mfma_f32_16x16x32_bf16 v[36:39], a[24:27], v[12:15], v[36:39]
    v_mfma_f32_16x16x32_bf16 v[40:43], a[104:107], v[12:15], v[40:43]
    v_mfma_f32_16x16x32_bf16 v[52:55], v[12:15], a[184:187], v[52:55]
    v_mfma_f32_16x16x32_bf16 v[44:47], a[24:27], v[16:19], v[44:47]
    v_mfma_f32_16x16x32_bf16 v[48:51], a[104:107], v[16:19], v[48:51]
    v_mfma_f32_16x16x32_bf16 v[56:59], v[16:19], a[184:187], v[56:59]
    ds_read_b128 v[12:15], v3 offset:4096
    ds_read_b128 v[16:19], v3 offset:24576
    s_waitcnt lgkmcnt(4)
    v_mfma_f32_16x16x32_bf16 v[36:39], a[28:31], v[20:23], v[36:39]
    v_mfma_f32_16x16x32_bf16 v[40:43], a[108:111], v[20:23], v[40:43]
    v_mfma_f32_16x16x32_bf16 v[52:55], v[20:23], a[188:191], v[52:55]
    v_mfma_f32_16x16x32_bf16 v[44:47], a[28:31], v[24:27], v[44:47]
    v_mfma_f32_16x16x32_bf16 v[48:51], a[108:111], v[24:27], v[48:51]
    v_mfma_f32_16x16x32_bf16 v[56:59], v[24:27], a[188:191], v[56:59]
    ds_read_b128 v[20:23], v2 offset:5120
    ds_read_b128 v[24:27], v2 offset:25600
    s_waitcnt vmcnt(10)
    s_cmp_eq_u32 s37, 0
    s_cbranch_scc1 L_P_nofl_8
    v_mov_b32 v8, s37
    s_mov_b64 exec, 1
    buffer_store_dword v8, v0, s[4:7], s36 offen offset:0 sc1
    s_mov_b64 exec, -1
L_P_nofl_8:
    s_waitcnt lgkmcnt(4)
    v_mfma_f32_16x16x32_bf16 v[36:39], a[32:35], v[28:31], v[36:39]
    v_mfma_f32_16x16x32_bf16 v[40:43], a[112:115], v[28:31], v[40:43]
    v_mfma_f32_16x16x32_bf16 v[52:55], v[28:31], a[192:195], v[52:55]
    v_mfma_f32_16x16x32_bf16 v[44:47], a[32:35], v[32:35], v[44:47]
    v_mfma_f32_16x16x32_bf16 v[48:51], a[112:115], v[32:35], v[48:51]
    v_mfma_f32_16x16x32_bf16 v[56:59], v[32:35], a[192:195], v[56:59]
    ds_read_b128 v[28:31], v3 offset:5120
    ds_read_b128 v[32:35], v3 offset:25600
    s_waitcnt lgkmcnt(4)
    v_mfma_f32_16x16x32_bf16 v[36:39], a[36:39], v[12:15], v[36:39]
    v_mfma_f32_16x16x32_bf16 v[40:43], a[116:119], v[12:15], v[40:43]
    v_mfma_f32_16x16x32_bf16 v[52:55], v[12:15], a[196:199], v[52:55]
    v_mfma_f32_16x16x32_bf16 v[44:47], a[36:39], v[16:19], v[44:47]
    v_mfma_f32_16x16x32_bf16 v[48:51], a[116:119], v[16:19], v[48:51]
    v_mfma_f32_16x16x32_bf16 v[56:59], v[16:19], a[196:199], v[56:59]
    ds_read_b128 v[12:15], v2 offset:6144
    ds_read_b128 v[16:19], v2 offset:26624
    s_waitcnt lgkmcnt(4)
    v_mfma_f32_16x16x32_bf16 v[36:39], a[40:43], v[20:23], v[36:39]
    v_mfma_f32_16x16x32_bf16 v[40:43], a[120:123], v[20:23], v[40:43]
    v_mfma_f32_16x16x32_bf16 v[52:55], v[20:23], a[200:203], v[52:55]
    v_mfma_f32_16x16x32_bf16 v[44:47], a[40:43], v[24:27], v[44:47]
    v_mfma_f32_16x16x32_bf16 v[48:51], a[120:123], v[24:27], v[48:51]
    v_mfma_f32_16x16x32_bf16 v[56:59], v[24:27], a[200:203], v[56:59]
    ds_read_b128 v[20:23], v3 offset:6144
    ds_read_b128 v[24:27], v3 offset:26624
    s_waitcnt lgkmcnt(4)
    v_mfma_f32_16x16x32_bf16 v[36:39], a[44:47], v[28:31], v[36:39]
    v_mfma_f32_16x16x32_bf16 v[40:43], a[124:127], v[28:31], v[40:43]
    v_mfma_f32_16x16x32_bf16 v[52:55], v[28:31], a[204:207], v[52:55]
    v_mfma_f32_16x16x32_bf16 v[44:47], a[44:47], v[32:35], v[44:47]
    v_mfma_f32_16x16x32_bf16 v[48:51], a[124:127], v[32:35], v[48:51]
    v_mfma_f32_16x16x32_bf16 v[56:59], v[32:35], a[204:207], v[56:59]
    ds_read_b128 v[28:31], v2 offset:7168
    ds_read_b128 v[32:35], v2 offset:27648
    s_waitcnt lgkmcnt(4)
    v_mfma_f32_16x16x32_bf16 v[36:39], a[48:51], v[12:15], v[36:39]
    v_mfma_f32_16x16x32_bf16 v[40:43], a[128:131], v[12:15], v[40:43]
    v_mfma_f32_16x16x32_bf16 v[52:55], v[12:15], a[208:211], v[52:55]
    v_mfma_f32_16x16x32_bf16 v[44:47], a[48:51], v[16:19], v[44:47]
    v_mfma_f32_16x16x32_bf16 v[48:51], a[128:131], v[16:19], v[48:51]
    v_mfma_f32_16x16x32_bf16 v[56:59], v[16:19], a[208:211], v[56:59]
    ds_read_b128 v[12:15], v3 offset:7168
    ds_read_b128 v[16:19], v3 offset:27648
    s_waitcnt lgkmcnt(4)
    v_mfma_f32_16x16x32_bf16 v[36:39], a[52:55], v[20:23], v[36:39]
    v_mfma_f32_16x16x32_bf16 v[40:43], a[132:135], v[20:23], v[40:43]
    v_mfma_f32_16x16x32_bf16 v[52:55], v[20:23], a[212:215], v[52:55]
    v_mfma_f32_16x16x32_bf16 v[44:47], a[52:55], v[24:27], v[44:47]
    v_mfma_f32_16x16x32_bf16 v[48:51], a[132:135], v[24:27], v[48:51]
    v_mfma_f32_16x16x32_bf16 v[56:59], v[24:27], a[212:215], v[56:59]
    ds_read_b128 v[20:23], v2 offset:8192
    ds_read_b128 v[24:27], v2 offset:28672
    s_waitcnt lgkmcnt(4)
    v_mfma_f32_16x16x32_bf16 v[36:39], a[56:59], v[28:31], v[36:39]
    v_mfma_f32_16x16x32_bf16 v[40:43], a[136:139], v[28:31], v[40:43]
    v_mfma_f32_16x16x32_bf16 v[52:55], v[28:31], a[216:219], v[52:55]
    v_mfma_f32_16x16x32_bf16 v[44:47], a[56:59], v[32:35], v[44:47]
    v_mfma_f32_16x16x32_bf16 v[48:51], a[136:139], v[32:35], v[48:51]
    v_mfma_f32_16x16x32_bf16 v[56:59], v[32:35], a[216:219], v[56:59]
    ds_read_b128 v[28:31], v3 offset:8192
    ds_read_b128 v[32:35], v3 offset:28672
    s_waitcnt lgkmcnt(4)
    v_mfma_f32_16x16x32_bf16 v[36:39], a[60:63], v[12:15], v[36:39]
    v_mfma_f32_16x16x32_bf16 v[40:43], a[140:143], v[12:15], v[40:43]
    v_mfma_f32_16x16x32_bf16 v[52:55], v[12:15], a[220:223], v[52:55]
    v_mfma_f32_16x16x32_bf16 v[44:47], a[60:63], v[16:19], v[44:47]
    v_mfma_f32_16x16x32_bf16 v[48:51], a[140:143], v[16:19], v[48:51]
    v_mfma_f32_16x16x32_bf16 v[56:59], v[16:19], a[220:223], v[56:59]
    ds_read_b128 v[12:15], v2 offset:9216
    ds_read_b128 v[16:19], v2 offset:29696
    s_waitcnt lgkmcnt(4)
    v_mfma_f32_16x16x32_bf16 v[36:39], a[64:67], v[20:23], v[36:39]
    v_mfma_f32_16x16x32_bf16 v[40:43], a[144:147], v[20:23], v[40:43]
    v_mfma_f32_16x16x32_bf16 v[52:55], v[20:23], a[224:227], v[52:55]
    v_mfma_f32_16x16x32_bf16 v[44:47], a[64:67], v[24:27], v[44:47]
    v_mfma_f32_16x16x32_bf16 v[48:51], a[144:147], v[24:27], v[48:51]
    v_mfma_f32_16x16x32_bf16 v[56:59], v[24:27], a[224:227], v[56:59]
    ds_read_b128 v[20:23], v3 offset:9216
    ds_read_b128 v[24:27], v3 offset:29696
    s_waitcnt lgkmcnt(4)
    v_mfma_f32_16x16x32_bf16 v[36:39], a[68:71], v[28:31], v[36:39]
    v_mfma_f32_16x16x32_bf16 v[40:43], a[148:151], v[28:31], v[40:43]
    v_mfma_f32_16x16x32_bf16 v[52:55], v[28:31], a[228:231], v[52:55]
    v_mfma_f32_16x16x32_bf16 v[44:47], a[68:71], v[32:35], v[44:47]
    v_mfma_f32_16x16x32_bf16 v[48:51], a[148:151], v[32:35], v[48:51]
    v_mfma_f32_16x16x32_bf16 v[56:59], v[32:35], a[228:231], v[56:59]
    s_waitcnt lgkmcnt(2)
    v_mfma_f32_16x16x32_bf16 v[36:39], a[72:75], v[12:15], v[36:39]
    v_mfma_f32_16x16x32_bf16 v[40:43], a[152:155], v[12:15], v[40:43]
    v_mfma_f32_16x16x32_bf16 v[52:55], v[12:15], a[232:235], v[52:55]
    v_mfma_f32_16x16x32_bf16 v[44:47], a[72:75], v[16:19], v[44:47]
    v_mfma_f32_16x16x32_bf16 v[48:51], a[152:155], v[16:19], v[48:51]
    v_mfma_f32_16x16x32_bf16 v[56:59], v[16:19], a[232:235], v[56:59]
    s_waitcnt lgkmcnt(0)
    v_mfma_f32_16x16x32_bf16 v[36:39], a[76:79], v[20:23], v[36:39]
    v_mfma_f32_16x16x32_bf16 v[40:43], a[156:159], v[20:23], v[40:43]
    v_mfma_f32_16x16x32_bf16 v[52:55], v[20:23], a[236:239], v[52:55]
    v_mfma_f32_16x16x32_bf16 v[44:47], a[76:79], v[24:27], v[44:47]
    v_mfma_f32_16x16x32_bf16 v[48:51], a[156:159], v[24:27], v[48:51]
    v_mfma_f32_16x16x32_bf16 v[56:59], v[24:27], a[236:239], v[56:59]
    s_mul_i32 s40, s24, s28
    s_add_u32 s40, s40, s27
    s_add_u32 s41, s40, s29
    s_mul_i32 s42, s24, 786432
    s_add_u32 s42, s42, s30
    v_cvt_pk_bf16_f32 v60, v36, v37
    v_cvt_pk_bf16_f32 v61, v38, v39
    v_cvt_pk_bf16_f32 v62, v40, v41
    v_cvt_pk_bf16_f32 v63, v42, v43
    buffer_store_dwordx4 v[60:63], v0, s[4:7], s40 offen sc1
    v_cvt_pk_bf16_f32 v64, v44, v45
    v_cvt_pk_bf16_f32 v65, v46, v47
    v_cvt_pk_bf16_f32 v66, v48, v49
    v_cvt_pk_bf16_f32 v67, v50, v51
    buffer_store_dwordx4 v[64:67], v0, s[4:7], s41 offen sc1
    v_cvt_pk_bf16_f32 v68, v52, v53
    v_cvt_pk_bf16_f32 v69, v54, v55
    v_cvt_pk_bf16_f32 v70, v56, v57
    v_cvt_pk_bf16_f32 v71, v58, v59
    buffer_store_dwordx4 v[68:71], v0, s[4:7], s42 offen sc1
    s_branch L_P_top
L_P_late:
    ds_read_b128 v[12:15], v2 offset:0
    ds_read_b128 v[16:19], v2 offset:20480
    ds_read_b128 v[20:23], v3 offset:0
    ds_read_b128 v[24:27], v3 offset:20480
    ds_read_b128 v[28:31], v2 offset:1024
    ds_read_b128 v[32:35], v2 offset:21504
    s_waitcnt lgkmcnt(4)
    v_mfma_f32_16x16x32_bf16 v[36:39], a[0:3], v[12:15], 0
    v_mfma_f32_16x16x32_bf16 v[40:43], a[80:83], v[12:15], 0
    v_mfma_f32_16x16x32_bf16 v[52:55], v[12:15], a[160:163], 0
    v_mfma_f32_16x16x32_bf16 v[44:47], a[0:3], v[16:19], 0
    v_mfma_f32_16x16x32_bf16 v[48:51], a[80:83], v[16:19], 0
    v_mfma_f32_16x16x32_bf16 v[56:59], v[16:19], a[160:163], 0
    ds_read_b128 v[12:15], v3 offset:1024
    ds_read_b128 v[16:19], v3 offset:21504
    s_waitcnt lgkmcnt(4)
    v_mfma_f32_16x16x32_bf16 v[36:39], a[4:7], v[20:23], v[36:39]
    v_mfma_f32_16x16x32_bf16 v[40:43], a[84:87], v[20:23], v[40:43]
    v_mfma_f32_16x16x32_bf16 v[52:55], v[20:23], a[164:167], v[52:55]
    v_mfma_f32_16x16x32_bf16 v[44:47], a[4:7], v[24:27], v[44:47]
    v_mfma_f32_16x16x32_bf16 v[48:51], a[84:87], v[24:27], v[48:51]
    v_mfma_f32_16x16x32_bf16 v[56:59], v[24:27], a[164:167], v[56:59]
    ds_read_b128 v[20:23], v2 offset:2048
    ds_read_b128 v[24:27], v2 offset:22528
    s_waitcnt lgkmcnt(4)
    v_mfma_f32_16x16x32_bf16 v[36:39], a[8:11], v[28:31], v[36:39]
    v_mfma_f32_16x16x32_bf16 v[40:43], a[88:91], v[28:31], v[40:43]
    v_mfma_f32_16x16x32_bf16 v[52:55], v[28:31], a[168:171], v[52:55]
    v_mfma_f32_16x16x32_bf16 v[44:47], a[8:11], v[32:35], v[44:47]
    v_mfma_f32_16x16x32_bf16 v[48:51], a[88:91], v[32:35], v[48:51]
    v_mfma_f32_16x16x32_bf16 v[56:59], v[32:35], a[168:171], v[56:59]
    ds_read_b128 v[28:31], v3 offset:2048
    ds_read_b128 v[32:35], v3 offset:22528
    s_waitcnt lgkmcnt(4)
    v_mfma_f32_16x16x32_bf16 v[36:39], a[12:15], v[12:15], v[36:39]
    v_mfma_f32_16x16x32_bf16 v[40:43], a[92:95], v[12:15], v[40:43]
    v_mfma_f32_16x16x32_bf16 v[52:55], v[12:15], a[172:175], v[52:55]
    v_mfma_f32_16x16x32_bf16 v[44:47], a[12:15], v[16:19], v[44:47]
    v_mfma_f32_16x16x32_bf16 v[48:51], a[92:95], v[16:19], v[48:51]
    v_mfma_f32_16x16x32_bf16 v[56:59], v[16:19], a[172:175], v[56:59]
    ds_read_b128 v[12:15], v2 offset:3072
    ds_read_b128 v[16:19], v2 offset:23552
    s_waitcnt lgkmcnt(4)
    v_mfma_f32_16x16x32_bf16 v[36:39], a[16:19], v[20:23], v[36:39]
    v_mfma_f32_16x16x32_bf16 v[40:43], a[96:99], v[20:23], v[40:43]
    v_mfma_f32_16x16x32_bf16 v[52:55], v[20:23], a[176:179], v[52:55]
    v_mfma_f32_16x16x32_bf16 v[44:47], a[16:19], v[24:27], v[44:47]
    v_mfma_f32_16x16x32_bf16 v[48:51], a[96:99], v[24:27], v[48:51]
    v_mfma_f32_16x16x32_bf16 v[56:59], v[24:27], a[176:179], v[56:59]
    ds_read_b128 v[20:23], v3 offset:3072
    ds_read_b128 v[24:27], v3 offset:23552
    s_waitcnt lgkmcnt(4)
    v_mfma_f32_16x16x32_bf16 v[36:39], a[20:23], v[28:31], v[36:39]
    v_mfma_f32_16x16x32_bf16 v[40:43], a[100:103], v[28:31], v[40:43]
    v_mfma_f32_16x16x32_bf16 v[52:55], v[28:31], a[180:183], v[52:55]
    v_mfma_f32_16x16x32_bf16 v[44:47], a[20:23], v[32:35], v[44:47]
    v_mfma_f32_16x16x32_bf16 v[48:51], a[100:103], v[32:35], v[48:51]
    v_mfma_f32_16x16x32_bf16 v[56:59], v[32:35], a[180:183], v[56:59]
    ds_read_b128 v[28:31], v2 offset:4096
    ds_read_b128 v[32:35], v2 offset:24576
    s_waitcnt lgkmcnt(4)
    v_mfma_f32_16x16x32_bf16 v[36:39], a[24:27], v[12:15], v[36:39]
    v_mfma_f32_16x16x32_bf16 v[40:43], a[104:107], v[12:15], v[40:43]
    v_mfma_f32_16x16x32_bf16 v[52:55], v[12:15], a[184:187], v[52:55]
    v_mfma_f32_16x16x32_bf16 v[44:47], a[24:27], v[16:19], v[44:47]
    v_mfma_f32_16x16x32_bf16 v[48:51], a[104:107], v[16:19], v[48:51]
    v_mfma_f32_16x16x32_bf16 v[56:59], v[16:19], a[184:187], v[56:59]
    ds_read_b128 v[12:15], v3 offset:4096
    ds_read_b128 v[16:19], v3 offset:24576
    s_waitcnt lgkmcnt(4)
    v_mfma_f32_16x16x32_bf16 v[36:39], a[28:31], v[20:23], v[36:39]
    v_mfma_f32_16x16x32_bf16 v[40:43], a[108:111], v[20:23], v[40:43]
    v_mfma_f32_16x16x32_bf16 v[52:55], v[20:23], a[188:191], v[52:55]
    v_mfma_f32_16x16x32_bf16 v[44:47], a[28:31], v[24:27], v[44:47]
    v_mfma_f32_16x16x32_bf16 v[48:51], a[108:111], v[24:27], v[48:51]
    v_mfma_f32_16x16x32_bf16 v[56:59], v[24:27], a[188:191], v[56:59]
    ds_read_b128 v[20:23], v2 offset:5120
    ds_read_b128 v[24:27], v2 offset:25600
    s_waitcnt vmcnt(0)
    s_cmp_eq_u32 s37, 0
    s_cbranch_scc1 L_P_nofl_9
    v_mov_b32 v8, s37
    s_mov_b64 exec, 1
    buffer_store_dword v8, v0, s[4:7], s36 offen offset:0 sc1
    s_mov_b64 exec, -1
L_P_nofl_9:
    s_waitcnt lgkmcnt(4)
    v_mfma_f32_16x16x32_bf16 v[36:39], a[32:35], v[28:31], v[36:39]
    v_mfma_f32_16x16x32_bf16 v[40:43], a[112:115], v[28:31], v[40:43]
    v_mfma_f32_16x16x32_bf16 v[52:55], v[28:31], a[192:195], v[52:55]
    v_mfma_f32_16x16x32_bf16 v[44:47], a[32:35], v[32:35], v[44:47]
    v_mfma_f32_16x16x32_bf16 v[48:51], a[112:115], v[32:35], v[48:51]
    v_mfma_f32_16x16x32_bf16 v[56:59], v[32:35], a[192:195], v[56:59]
    ds_read_b128 v[28:31], v3 offset:5120
    ds_read_b128 v[32:35], v3 offset:25600
    s_waitcnt lgkmcnt(4)
    v_mfma_f32_16x16x32_bf16 v[36:39], a[36:39], v[12:15], v[36:39]
    v_mfma_f32_16x16x32_bf16 v[40:43], a[116:119], v[12:15], v[40:43]
    v_mfma_f32_16x16x32_bf16 v[52:55], v[12:15], a[196:199], v[52:55]
    v_mfma_f32_16x16x32_bf16 v[44:47], a[36:39], v[16:19], v[44:47]
    v_mfma_f32_16x16x32_bf16 v[48:51], a[116:119], v[16:19], v[48:51]
    v_mfma_f32_16x16x32_bf16 v[56:59], v[16:19], a[196:199], v[56:59]
    ds_read_b128 v[12:15], v2 offset:6144
    ds_read_b128 v[16:19], v2 offset:26624
    s_waitcnt lgkmcnt(4)
    v_mfma_f32_16x16x32_bf16 v[36:39], a[40:43], v[20:23], v[36:39]
    v_mfma_f32_16x16x32_bf16 v[40:43], a[120:123], v[20:23], v[40:43]
    v_mfma_f32_16x16x32_bf16 v[52:55], v[20:23], a[200:203], v[52:55]
    v_mfma_f32_16x16x32_bf16 v[44:47], a[40:43], v[24:27], v[44:47]
    v_mfma_f32_16x16x32_bf16 v[48:51], a[120:123], v[24:27], v[48:51]
    v_mfma_f32_16x16x32_bf16 v[56:59], v[24:27], a[200:203], v[56:59]
    ds_read_b128 v[20:23], v3 offset:6144
    ds_read_b128 v[24:27], v3 offset:26624
    s_waitcnt lgkmcnt(4)
    v_mfma_f32_16x16x32_bf16 v[36:39], a[44:47], v[28:31], v[36:39]
    v_mfma_f32_16x16x32_bf16 v[40:43], a[124:127], v[28:31], v[40:43]
    v_mfma_f32_16x16x32_bf16 v[52:55], v[28:31], a[204:207], v[52:55]
    v_mfma_f32_16x16x32_bf16 v[44:47], a[44:47], v[32:35], v[44:47]
    v_mfma_f32_16x16x32_bf16 v[48:51], a[124:127], v[32:35], v[48:51]
    v_mfma_f32_16x16x32_bf16 v[56:59], v[32:35], a[204:207], v[56:59]
    ds_read_b128 v[28:31], v2 offset:7168
    ds_read_b128 v[32:35], v2 offset:27648
    s_waitcnt lgkmcnt(4)
    v_mfma_f32_16x16x32_bf16 v[36:39], a[48:51], v[12:15], v[36:39]
    v_mfma_f32_16x16x32_bf16 v[40:43], a[128:131], v[12:15], v[40:43]
    v_mfma_f32_16x16x32_bf16 v[52:55], v[12:15], a[208:211], v[52:55]
    v_mfma_f32_16x16x32_bf16 v[44:47], a[48:51], v[16:19], v[44:47]
    v_mfma_f32_16x16x32_bf16 v[48:51], a[128:131], v[16:19], v[48:51]
    v_mfma_f32_16x16x32_bf16 v[56:59], v[16:19], a[208:211], v[56:59]
    ds_read_b128 v[12:15], v3 offset:7168
    ds_read_b128 v[16:19], v3 offset:27648
    s_waitcnt lgkmcnt(4)
    v_mfma_f32_16x16x32_bf16 v[36:39], a[52:55], v[20:23], v[36:39]
    v_mfma_f32_16x16x32_bf16 v[40:43], a[132:135], v[20:23], v[40:43]
    v_mfma_f32_16x16x32_bf16 v[52:55], v[20:23], a[212:215], v[52:55]
    v_mfma_f32_16x16x32_bf16 v[44:47], a[52:55], v[24:27], v[44:47]
    v_mfma_f32_16x16x32_bf16 v[48:51], a[132:135], v[24:27], v[48:51]
    v_mfma_f32_16x16x32_bf16 v[56:59], v[24:27], a[212:215], v[56:59]
    ds_read_b128 v[20:23], v2 offset:8192
    ds_read_b128 v[24:27], v2 offset:28672
    s_waitcnt lgkmcnt(4)
    v_mfma_f32_16x16x32_bf16 v[36:39], a[56:59], v[28:31], v[36:39]
    v_mfma_f32_16x16x32_bf16 v[40:43], a[136:139], v[28:31], v[40:43]
    v_mfma_f32_16x16x32_bf16 v[52:55], v[28:31], a[216:219], v[52:55]
    v_mfma_f32_16x16x32_bf16 v[44:47], a[56:59], v[32:35], v[44:47]
    v_mfma_f32_16x16x32_bf16 v[48:51], a[136:139], v[32:35], v[48:51]
    v_mfma_f32_16x16x32_bf16 v[56:59], v[32:35], a[216:219], v[56:59]
    ds_read_b128 v[28:31], v3 offset:8192
    ds_read_b128 v[32:35], v3 offset:28672
    s_waitcnt lgkmcnt(4)
    v_mfma_f32_16x16x32_bf16 v[36:39], a[60:63], v[12:15], v[36:39]
    v_mfma_f32_16x16x32_bf16 v[40:43], a[140:143], v[12:15], v[40:43]
    v_mfma_f32_16x16x32_bf16 v[52:55], v[12:15], a[220:223], v[52:55]
    v_mfma_f32_16x16x32_bf16 v[44:47], a[60:63], v[16:19], v[44:47]
    v_mfma_f32_16x16x32_bf16 v[48:51], a[140:143], v[16:19], v[48:51]
    v_mfma_f32_16x16x32_bf16 v[56:59], v[16:19], a[220:223], v[56:59]
    ds_read_b128 v[12:15], v2 offset:9216
    ds_read_b128 v[16:19], v2 offset:29696
    s_waitcnt lgkmcnt(4)
    v_mfma_f32_16x16x32_bf16 v[36:39], a[64:67], v[20:23], v[36:39]
    v_mfma_f32_16x16x32_bf16 v[40:43], a[144:147], v[20:23], v[40:43]
    v_mfma_f32_16x16x32_bf16 v[52:55], v[20:23], a[224:227], v[52:55]
    v_mfma_f32_16x16x32_bf16 v[44:47], a[64:67], v[24:27], v[44:47]
    v_mfma_f32_16x16x32_bf16 v[48:51], a[144:147], v[24:27], v[48:51]
    v_mfma_f32_16x16x32_bf16 v[56:59], v[24:27], a[224:227], v[56:59]
    ds_read_b128 v[20:23], v3 offset:9216
    ds_read_b128 v[24:27], v3 offset:29696
    s_waitcnt lgkmcnt(4)
    v_mfma_f32_16x16x32_bf16 v[36:39], a[68:71], v[28:31], v[36:39]
    v_mfma_f32_16x16x32_bf16 v[40:43], a[148:151], v[28:31], v[40:43]
    v_mfma_f32_16x16x32_bf16 v[52:55], v[28:31], a[228:231], v[52:55]
    v_mfma_f32_16x16x32_bf16 v[44:47], a[68:71], v[32:35], v[44:47]
    v_mfma_f32_16x16x32_bf16 v[48:51], a[148:151], v[32:35], v[48:51]
    v_mfma_f32_16x16x32_bf16 v[56:59], v[32:35], a[228:231], v[56:59]
    s_waitcnt lgkmcnt(2)
    v_mfma_f32_16x16x32_bf16 v[36:39], a[72:75], v[12:15], v[36:39]
    v_mfma_f32_16x16x32_bf16 v[40:43], a[152:155], v[12:15], v[40:43]
    v_mfma_f32_16x16x32_bf16 v[52:55], v[12:15], a[232:235], v[52:55]
    v_mfma_f32_16x16x32_bf16 v[44:47], a[72:75], v[16:19], v[44:47]
    v_mfma_f32_16x16x32_bf16 v[48:51], a[152:155], v[16:19], v[48:51]
    v_mfma_f32_16x16x32_bf16 v[56:59], v[16:19], a[232:235], v[56:59]
    s_waitcnt lgkmcnt(0)
    v_mfma_f32_16x16x32_bf16 v[36:39], a[76:79], v[20:23], v[36:39]
    v_mfma_f32_16x16x32_bf16 v[40:43], a[156:159], v[20:23], v[40:43]
    v_mfma_f32_16x16x32_bf16 v[52:55], v[20:23], a[236:239], v[52:55]
    v_mfma_f32_16x16x32_bf16 v[44:47], a[76:79], v[24:27], v[44:47]
    v_mfma_f32_16x16x32_bf16 v[48:51], a[156:159], v[24:27], v[48:51]
    v_mfma_f32_16x16x32_bf16 v[56:59], v[24:27], a[236:239], v[56:59]
    s_mul_i32 s40, s24, s28
    s_add_u32 s40, s40, s27
    s_add_u32 s41, s40, s29
    s_mul_i32 s42, s24, 786432
    s_add_u32 s42, s42, s30
    v_cvt_pk_bf16_f32 v60, v36, v37
    v_cvt_pk_bf16_f32 v61, v38, v39
    v_cvt_pk_bf16_f32 v62, v40, v41
    v_cvt_pk_bf16_f32 v63, v42, v43
    buffer_store_dwordx4 v[60:63], v0, s[4:7], s40 offen sc1
    v_cvt_pk_bf16_f32 v64, v44, v45
    v_cvt_pk_bf16_f32 v65, v46, v47
    v_cvt_pk_bf16_f32 v66, v48, v49
    v_cvt_pk_bf16_f32 v67, v50, v51
    buffer_store_dwordx4 v[64:67], v0, s[4:7], s41 offen sc1
    v_cvt_pk_bf16_f32 v68, v52, v53
    v_cvt_pk_bf16_f32 v69, v54, v55
    v_cvt_pk_bf16_f32 v70, v56, v57
    v_cvt_pk_bf16_f32 v71, v58, v59
    buffer_store_dwordx4 v[68:71], v0, s[4:7], s42 offen sc1
    buffer_load_dword v7, v5, s[4:7], s39 offen sc1
    s_waitcnt vmcnt(0)
    v_mov_b32 v8, s45
    s_mov_b64 exec, 1
    buffer_store_dword v8, v0, s[4:7], s44 offen offset:0 sc1
    s_mov_b64 exec, -1
    s_mov_b32 s45, 0
    s_cmp_ge_u32 s26, 64
    s_cbranch_scc1 L_P_end
    s_mov_b32 s19, 0
    v_cmp_gt_u32 vcc, s38, v7
    s_nop 0
    s_cbranch_vccnz L_P_flspin_11
L_P_fl_10:
    s_add_u32 m0, s32, 0
    s_nop 0
    buffer_load_dwordx4 v1, s[4:7], s35 offen offset:0 sc1 lds
    s_add_u32 m0, s32, 896
    s_nop 0
    buffer_load_dwordx4 v1, s[4:7], s35 offen offset:128 sc1 lds
    s_add_u32 m0, s32, 1792
    s_nop 0
    buffer_load_dwordx4 v1, s[4:7], s35 offen offset:256 sc1 lds
    s_add_u32 m0, s32, 2688
    s_nop 0
    buffer_load_dwordx4 v1, s[4:7], s35 offen offset:384 sc1 lds
    s_add_u32 m0, s32, 3584
    s_nop 0
    buffer_load_dwordx4 v1, s[4:7], s35 offen offset:512 sc1 lds
    s_add_u32 m0, s32, 4480
    s_nop 0
    buffer_load_dwordx4 v1, s[4:7], s35 offen offset:640 sc1 lds
    s_add_u32 m0, s32, 5376
    s_nop 0
    buffer_load_dwordx4 v1, s[4:7], s35 offen offset:768 sc1 lds
    s_add_u32 m0, s32, 6272
    s_nop 0
    buffer_load_dwordx4 v1, s[4:7], s35 offen offset:896 sc1 lds
    s_add_u32 m0, s32, 7168
    s_nop 0
    buffer_load_dwordx4 v1, s[4:7], s35 offen offset:1024 sc1 lds
    s_add_u32 m0, s32, 8064
    s_nop 0
    buffer_load_dwordx4 v1, s[4:7], s35 offen offset:1152 sc1 lds
    s_waitcnt vmcnt(0)
    s_branch L_P_top
L_P_end:
    s_waitcnt vmcnt(0)
    s_endpgm
L_P_flspin_5:
    buffer_load_dword v7, v4, s[4:7], s39 offen offset:8 sc1
    s_add_u32 s19, s19, 1
    s_cmp_ge_u32 s19, 524288
    s_cbranch_scc1 L_fail
    s_waitcnt vmcnt(0)
    v_cmp_gt_u32 vcc, 1, v7
    s_nop 0
    s_cbranch_vccnz L_P_flspin_5
    s_branch L_P_fl_4
L_P_flspin_7:
    buffer_load_dword v7, v4, s[4:7], s39 offen offset:8 sc1
    s_add_u32 s19, s19, 1
    s_cmp_ge_u32 s19, 524288
    s_cbranch_scc1 L_fail
    s_waitcnt vmcnt(0)
    v_cmp_gt_u32 vcc, 1, v7
    s_nop 0
    s_cbranch_vccnz L_P_flspin_7
    s_branch L_P_fl_6
L_P_flspin_11:
    buffer_load_dword v7, v5, s[4:7], s39 offen sc1
    s_add_u32 s19, s19, 1
    s_cmp_ge_u32 s19, 524288
    s_cbranch_scc1 L_fail
    s_waitcnt vmcnt(0)
    v_cmp_gt_u32 vcc, s38, v7
    s_nop 0
    s_cbranch_vccnz L_P_flspin_11
    s_branch L_P_fl_10
L_roleO:
    v_lshlrev_b32 v16, 4, v0
    s_sub_u32 s27, s13, 160
    s_lshr_b32 s20, s27, 5
    s_and_b32 s21, s27, 31
    s_lshl_b32 s24, s13, 2
    s_add_u32 s24, s24, s12
    s_lshl_b32 s24, s24, 7
    s_add_u32 s24, s24, 0
    v_mov_b32 v20, 0
    v_mov_b32 v21, 0
    v_mov_b32 v22, 0
    v_mov_b32 v23, 0
    s_mov_b64 exec, 1
    buffer_store_dwordx4 v[20:23], v16, s[4:7], s24 offen sc1
    s_mov_b64 exec, -1
    s_mul_i32 s36, s27, 40960
    s_mul_i32 s28, s12, 10240
    s_add_u32 s36, s36, s28
    s_add_u32 s36, s36, 206700544
    s_add_u32 s37, s36, 5120
    s_mov_b32 s28, s36
    buffer_store_dwordx4 v[20:23], v16, s[4:7], s28 offen sc1
    s_add_u32 s28, s28, 1024
    buffer_store_dwordx4 v[20:23], v16, s[4:7], s28 offen sc1
    s_add_u32 s28, s28, 1024
    buffer_store_dwordx4 v[20:23], v16, s[4:7], s28 offen sc1
    s_add_u32 s28, s28, 1024
    buffer_store_dwordx4 v[20:23], v16, s[4:7], s28 offen sc1
    s_add_u32 s28, s28, 1024
    buffer_store_dwordx4 v[20:23], v16, s[4:7], s28 offen sc1
    s_add_u32 s28, s28, 1024
    buffer_store_dwordx4 v[20:23], v16, s[4:7], s28 offen sc1
    s_add_u32 s28, s28, 1024
    buffer_store_dwordx4 v[20:23], v16, s[4:7], s28 offen sc1
    s_add_u32 s28, s28, 1024
    buffer_store_dwordx4 v[20:23], v16, s[4:7], s28 offen sc1
    s_add_u32 s28, s28, 1024
    buffer_store_dwordx4 v[20:23], v16, s[4:7], s28 offen sc1
    s_add_u32 s28, s28, 1024
    buffer_store_dwordx4 v[20:23], v16, s[4:7], s28 offen sc1
    s_add_u32 s28, s28, 2612224
    buffer_store_dwordx4 v[20:23], v16, s[4:7], s28 offen sc1
    s_add_u32 s28, s28, 1024
    buffer_store_dwordx4 v[20:23], v16, s[4:7], s28 offen sc1
    s_add_u32 s28, s28, 1024
    buffer_store_dwordx4 v[20:23], v16, s[4:7], s28 offen sc1
    s_add_u32 s28, s28, 1024
    buffer_store_dwordx4 v[20:23], v16, s[4:7], s28 offen sc1
    s_add_u32 s28, s28, 1024
    buffer_store_dwordx4 v[20:23], v16, s[4:7], s28 offen sc1
    s_add_u32 s28, s28, 1024
    buffer_store_dwordx4 v[20:23], v16, s[4:7], s28 offen sc1
    s_add_u32 s28, s28, 1024
    buffer_store_dwordx4 v[20:23], v16, s[4:7], s28 offen sc1
    s_add_u32 s28, s28, 1024
    buffer_store_dwordx4 v[20:23], v16, s[4:7], s28 offen sc1
    s_add_u32 s28, s28, 1024
    buffer_store_dwordx4 v[20:23], v16, s[4:7], s28 offen sc1
    s_add_u32 s28, s28, 1024
    buffer_store_dwordx4 v[20:23], v16, s[4:7], s28 offen sc1
    s_add_u32 s28, s28, 1024
    v_and_b32 v24, 15, v0
    v_lshrrev_b32 v25, 5, v0
    v_lshl_add_u32 v25, v25, 4, v24
    v_bfe_u32 v26, v0, 4, 1
    v_lshlrev_b32 v7, 4, v25
    v_lshl_add_u32 v7, v26, 3, v7
    v_lshrrev_b32 v8, 2, v25
    v_lshlrev_b32 v8, 6, v8
    v_lshl_add_u32 v8, v26, 5, v8
    v_and_b32 v25, 3, v25
    v_lshl_add_u32 v8, v25, 3, v8
    v_lshrrev_b32 v25, 5, v0
    v_lshl_add_u32 v25, v26, 1, v25
    v_lshl_add_u32 v25, v25, 4, v24
    v_lshlrev_b32 v9, 4, v25
    v_cmp_gt_u32 s[62:63], 32, v0
    s_mov_b32 s92, s64
    s_and_b32 s93, s65, 0xffff
    s_mov_b32 s94, 2621440
    s_mov_b32 s95, 0x20000
    s_cmp_eq_u32 s20, 0
    s_cbranch_scc1 L_O_noln0
    s_lshl_b32 s27, s21, 2
    s_add_u32 s27, s27, s12
    s_mul_i32 s27, s27, 20480
    s_add_u32 s28, s27, 188350464
    s_mov_b32 s29, 0
    buffer_load_dwordx2 v[72:73], v8, s[92:95], s27 offen offset:0 sc1
    buffer_load_dwordx2 v[74:75], v8, s[92:95], s27 offen offset:512 sc1
    s_mov_b64 exec, s[62:63]
    buffer_load_dwordx2 v[76:77], v8, s[92:95], s27 offen offset:1024 sc1
    s_mov_b64 exec, -1
    s_waitcnt vmcnt(0)
L_O_ln0:
    s_waitcnt vmcnt(2)
    v_lshlrev_b32 v32, 16, v72
    v_and_b32 v33, 0xffff0000, v72
    v_lshlrev_b32 v34, 16, v73
    v_and_b32 v35, 0xffff0000, v73
    v_lshlrev_b32 v36, 16, v74
    v_and_b32 v37, 0xffff0000, v74
    v_lshlrev_b32 v38, 16, v75
    v_and_b32 v39, 0xffff0000, v75
    v_lshlrev_b32 v40, 16, v76
    v_and_b32 v41, 0xffff0000, v76
    v_lshlrev_b32 v42, 16, v77
    v_and_b32 v43, 0xffff0000, v77
    v_cndmask_b32 v40, 0, v40, s[62:63]
    v_cndmask_b32 v41, 0, v41, s[62:63]
    v_cndmask_b32 v42, 0, v42, s[62:63]
    v_cndmask_b32 v43, 0, v43, s[62:63]
    s_add_u32 s27, s27, 1280
    buffer_load_dwordx2 v[72:73], v8, s[92:95], s27 offen offset:0 sc1
    buffer_load_dwordx2 v[74:75], v8, s[92:95], s27 offen offset:512 sc1
    s_mov_b64 exec, s[62:63]
    buffer_load_dwordx2 v[76:77], v8, s[92:95], s27 offen offset:1024 sc1
    s_mov_b64 exec, -1
    v_pk_add_f32 v[48:49], v[32:33], v[34:35]
    v_pk_add_f32 v[48:49], v[48:49], v[36:37]
    v_pk_add_f32 v[48:49], v[48:49], v[38:39]
    v_pk_add_f32 v[48:49], v[48:49], v[40:41]
    v_pk_add_f32 v[48:49], v[48:49], v[42:43]
    v_add_f32 v44, v48, v49
    s_nop 1
    v_add_f32_dpp v44, v44, v44 quad_perm:[1,0,3,2] row_mask:0xf bank_mask:0xf
    s_nop 1
    v_add_f32_dpp v44, v44, v44 quad_perm:[2,3,0,1] row_mask:0xf bank_mask:0xf
    s_nop 1
    v_add_f32_dpp v44, v44, v44 row_half_mirror row_mask:0xf bank_mask:0xf
    s_nop 1
    v_add_f32_dpp v44, v44, v44 row_mirror row_mask:0xf bank_mask:0xf
    v_mov_b32 v45, v44
    s_nop 1
    v_permlane16_swap_b32 v44, v45
    v_add_f32 v44, v44, v45
    v_mov_b32 v45, v44
    s_nop 1
    v_permlane32_swap_b32 v44, v45
    v_add_f32 v44, v44, v45
    v_mul_f32 v46, 1.5625000000e-03, v44
    v_sub_f32 v48, v32, v46
    v_sub_f32 v49, v33, v46
    v_sub_f32 v50, v34, v46
    v_sub_f32 v51, v35, v46
    v_sub_f32 v52, v36, v46
    v_sub_f32 v53, v37, v46
    v_sub_f32 v54, v38, v46
    v_sub_f32 v55, v39, v46
    v_sub_f32 v56, v40, v46
    v_sub_f32 v57, v41, v46
    v_sub_f32 v58, v42, v46
    v_sub_f32 v59, v43, v46
    v_cndmask_b32 v56, 0, v56, s[62:63]
    v_cndmask_b32 v57, 0, v57, s[62:63]
    v_cndmask_b32 v58, 0, v58, s[62:63]
    v_cndmask_b32 v59, 0, v59, s[62:63]
    v_mul_f32 v44, v48, v48
    v_fmac_f32 v44, v49, v49
    v_fmac_f32 v44, v50, v50
    v_fmac_f32 v44, v51, v51
    v_fmac_f32 v44, v52, v52
    v_fmac_f32 v44, v53, v53
    v_fmac_f32 v44, v54, v54
    v_fmac_f32 v44, v55, v55
    v_fmac_f32 v44, v56, v56
    v_fmac_f32 v44, v57, v57
    v_fmac_f32 v44, v58, v58
    v_fmac_f32 v44, v59, v59
    s_nop 1
    v_add_f32_dpp v44, v44, v44 quad_perm:[1,0,3,2] row_mask:0xf bank_mask:0xf
    s_nop 1
    v_add_f32_dpp v44, v44, v44 quad_perm:[2,3,0,1] row_mask:0xf bank_mask:0xf
    s_nop 1
    v_add_f32_dpp v44, v44, v44 row_half_mirror row_mask:0xf bank_mask:0xf
    s_nop 1
    v_add_f32_dpp v44, v44, v44 row_mirror row_mask:0xf bank_mask:0xf
    v_mov_b32 v45, v44
    s_nop 1
    v_permlane16_swap_b32 v44, v45
    v_add_f32 v44, v44, v45
    v_mov_b32 v45, v44
    s_nop 1
    v_permlane32_swap_b32 v44, v45
    v_add_f32 v44, v44, v45
    v_mul_f32 v44, 1.5625000000e-03, v44
    v_cvt_pk_bf16_f32 v45, v44, v46
    v_lshlrev_b32 v44, 16, v45
    v_and_b32 v46, 0xffff0000, v45
    v_add_f32 v44, 0x3727c5ac, v44
    v_cvt_pk_bf16_f32 v45, v44, v44
    v_lshlrev_b32 v44, 16, v45
    v_sqrt_f32 v44, v44
    v_sub_f32 v48, v32, v46
    v_sub_f32 v49, v33, v46
    v_sub_f32 v50, v34, v46
    v_sub_f32 v51, v35, v46
    v_sub_f32 v52, v36, v46
    v_sub_f32 v53, v37, v46
    v_sub_f32 v54, v38, v46
    v_sub_f32 v55, v39, v46
    v_sub_f32 v56, v40, v46
    v_sub_f32 v57, v41, v46
    v_sub_f32 v58, v42, v46
    v_sub_f32 v59, v43, v46
    v_cvt_pk_bf16_f32 v45, v44, v44
    v_lshlrev_b32 v44, 16, v45
    v_rcp_f32 v44, v44
    v_cvt_pk_bf16_f32 v64, v48, v49
    v_cvt_pk_bf16_f32 v65, v50, v51
    v_cvt_pk_bf16_f32 v66, v52, v53
    v_cvt_pk_bf16_f32 v67, v54, v55
    v_cvt_pk_bf16_f32 v68, v56, v57
    v_cvt_pk_bf16_f32 v69, v58, v59
    v_lshlrev_b32 v48, 16, v64
    v_and_b32 v49, 0xffff0000, v64
    v_lshlrev_b32 v50, 16, v65
    v_and_b32 v51, 0xffff0000, v65
    v_lshlrev_b32 v52, 16, v66
    v_and_b32 v53, 0xffff0000, v66
    v_lshlrev_b32 v54, 16, v67
    v_and_b32 v55, 0xffff0000, v67
    v_lshlrev_b32 v56, 16, v68
    v_and_b32 v57, 0xffff0000, v68
    v_lshlrev_b32 v58, 16, v69
    v_and_b32 v59, 0xffff0000, v69
    v_mul_f32 v48, v48, v44
    v_mul_f32 v49, v49, v44
    v_mul_f32 v50, v50, v44
    v_mul_f32 v51, v51, v44
    v_mul_f32 v52, v52, v44
    v_mul_f32 v53, v53, v44
    v_mul_f32 v54, v54, v44
    v_mul_f32 v55, v55, v44
    v_mul_f32 v56, v56, v44
    v_mul_f32 v57, v57, v44
    v_mul_f32 v58, v58, v44
    v_mul_f32 v59, v59, v44
    v_cvt_pk_bf16_f32 v64, v48, v49
    v_cvt_pk_bf16_f32 v65, v50, v51
    v_cvt_pk_bf16_f32 v66, v52, v53
    v_cvt_pk_bf16_f32 v67, v54, v55
    v_cvt_pk_bf16_f32 v68, v56, v57
    v_cvt_pk_bf16_f32 v69, v58, v59
    v_mov_b32 v80, v64
    v_mov_b32 v81, v65
    v_mov_b32 v82, v66
    v_mov_b32 v83, v67
    v_mov_b32 v84, v68
    v_mov_b32 v85, v69
    v_mov_b32 v86, v68
    v_mov_b32 v87, v69
    v_permlane16_swap_b32 v80, v82
    v_permlane16_swap_b32 v81, v83
    v_permlane16_swap_b32 v84, v86
    v_permlane16_swap_b32 v85, v87
    buffer_store_dwordx4 v[80:83], v9, s[4:7], s28 offen sc1
    s_mov_b64 exec, 0xffff
    buffer_store_dwordx4 v[84:87], v9, s[4:7], s28 offen offset:1024 sc1
    s_mov_b64 exec, -1
    s_add_u32 s28, s28, 1280
    s_add_u32 s29, s29, 1
    s_cmp_lt_u32 s29, 16
    s_cbranch_scc1 L_O_ln0
    s_waitcnt vmcnt(0)
    v_mov_b32 v24, 1
    s_mov_b64 exec, 1
    buffer_store_dword v24, v16, s[4:7], s24 offen offset:8 sc1
    s_mov_b64 exec, -1
L_O_noln0:
    s_waitcnt vmcnt(0)
    s_mul_i32 s38, s12, 40960
    v_add_u32 v36, 0, v0
    v_mul_u32_u24 v37, 3277, v36
    v_lshrrev_b32 v37, 16, v37
    v_mul_u32_u24 v24, 20, v37
    v_sub_u32 v24, v36, v24
    v_lshrrev_b32 v24, 0, v24
    v_lshlrev_b32 v24, 4, v24
    v_mul_u32_u24 v37, 1280, v37
    v_add_u32 v24, v24, v37
    v_add_u32 v36, 64, v0
    v_mul_u32_u24 v37, 3277, v36
    v_lshrrev_b32 v37, 16, v37
    v_mul_u32_u24 v25, 20, v37
    v_sub_u32 v25, v36, v25
    v_lshrrev_b32 v25, 0, v25
    v_lshlrev_b32 v25, 4, v25
    v_mul_u32_u24 v37, 1280, v37
    v_add_u32 v25, v25, v37
    v_add_u32 v36, 128, v0
    v_mul_u32_u24 v37, 3277, v36
    v_lshrrev_b32 v37, 16, v37
    v_mul_u32_u24 v26, 20, v37
    v_sub_u32 v26, v36, v26
    v_lshrrev_b32 v26, 0, v26
    v_lshlrev_b32 v26, 4, v26
    v_mul_u32_u24 v37, 1280, v37
    v_add_u32 v26, v26, v37
    v_add_u32 v36, 192, v0
    v_mul_u32_u24 v37, 3277, v36
    v_lshrrev_b32 v37, 16, v37
    v_mul_u32_u24 v27, 20, v37
    v_sub_u32 v27, v36, v27
    v_lshrrev_b32 v27, 0, v27
    v_lshlrev_b32 v27, 4, v27
    v_mul_u32_u24 v37, 1280, v37
    v_add_u32 v27, v27, v37
    v_add_u32 v36, 256, v0
    v_mul_u32_u24 v37, 3277, v36
    v_lshrrev_b32 v37, 16, v37
    v_mul_u32_u24 v28, 20, v37
    v_sub_u32 v28, v36, v28
    v_lshrrev_b32 v28, 0, v28
    v_lshlrev_b32 v28, 4, v28
    v_mul_u32_u24 v37, 1280, v37
    v_add_u32 v28, v28, v37
    v_add_u32 v36, 320, v0
    v_mul_u32_u24 v37, 3277, v36
    v_lshrrev_b32 v37, 16, v37
    v_mul_u32_u24 v29, 20, v37
    v_sub_u32 v29, v36, v29
    v_lshrrev_b32 v29, 0, v29
    v_lshlrev_b32 v29, 4, v29
    v_mul_u32_u24 v37, 1280, v37
    v_add_u32 v29, v29, v37
    v_add_u32 v36, 384, v0
    v_mul_u32_u24 v37, 3277, v36
    v_lshrrev_b32 v37, 16, v37
    v_mul_u32_u24 v30, 20, v37
    v_sub_u32 v30, v36, v30
    v_lshrrev_b32 v30, 0, v30
    v_lshlrev_b32 v30, 4, v30
    v_mul_u32_u24 v37, 1280, v37
    v_add_u32 v30, v30, v37
    v_add_u32 v36, 448, v0
    v_mul_u32_u24 v37, 3277, v36
    v_lshrrev_b32 v37, 16, v37
    v_mul_u32_u24 v31, 20, v37
    v_sub_u32 v31, v36, v31
    v_lshrrev_b32 v31, 0, v31
    v_lshlrev_b32 v31, 4, v31
    v_mul_u32_u24 v37, 1280, v37
    v_add_u32 v31, v31, v37
    v_add_u32 v36, 512, v0
    v_mul_u32_u24 v37, 3277, v36
    v_lshrrev_b32 v37, 16, v37
    v_mul_u32_u24 v32, 20, v37
    v_sub_u32 v32, v36, v32
    v_lshrrev_b32 v32, 0, v32
    v_lshlrev_b32 v32, 4, v32
    v_mul_u32_u24 v37, 1280, v37
    v_add_u32 v32, v32, v37
    v_add_u32 v36, 576, v0
    v_mul_u32_u24 v37, 3277, v36
    v_lshrrev_b32 v37, 16, v37
    v_mul_u32_u24 v33, 20, v37
    v_sub_u32 v33, v36, v33
    v_lshrrev_b32 v33, 0, v33
    v_lshlrev_b32 v33, 4, v33
    v_mul_u32_u24 v37, 1280, v37
    v_add_u32 v33, v33, v37
    v_lshrrev_b32 v34, 2, v0
    v_mul_u32_u24 v34, 320, v34
    v_and_b32 v36, 3, v0
    v_lshl_add_u32 v34, v36, 3, v34
    v_add_u32 v34, s38, v34
    s_mov_b32 s8, s74
    s_and_b32 s9, s75, 0xffff
    s_mov_b32 s10, 7864320
    s_mov_b32 s11, 0x20000
    s_mul_i32 s96, s21, 245760
    s_mul_i32 s27, s12, 320
    s_add_u32 s96, s96, s27
    s_add_u32 m0, s38, 0
    s_nop 0
    buffer_load_dwordx4 v24, s[8:11], s96 offen lds
    s_add_u32 m0, s38, 1024
    s_nop 0
    buffer_load_dwordx4 v25, s[8:11], s96 offen lds
    s_add_u32 m0, s38, 2048
    s_nop 0
    buffer_load_dwordx4 v26, s[8:11], s96 offen lds
    s_add_u32 m0, s38, 3072
    s_nop 0
    buffer_load_dwordx4 v27, s[8:11], s96 offen lds
    s_add_u32 m0, s38, 4096
    s_nop 0
    buffer_load_dwordx4 v28, s[8:11], s96 offen lds
    s_add_u32 m0, s38, 5120
    s_nop 0
    buffer_load_dwordx4 v29, s[8:11], s96 offen lds
    s_add_u32 m0, s38, 6144
    s_nop 0
    buffer_load_dwordx4 v30, s[8:11], s96 offen lds
    s_add_u32 m0, s38, 7168
    s_nop 0
    buffer_load_dwordx4 v31, s[8:11], s96 offen lds
    s_add_u32 m0, s38, 8192
    s_nop 0
    buffer_load_dwordx4 v32, s[8:11], s96 offen lds
    s_add_u32 m0, s38, 9216
    s_nop 0
    buffer_load_dwordx4 v33, s[8:11], s96 offen lds
    s_add_u32 s96, s96, 40960
    s_add_u32 m0, s38, 10240
    s_nop 0
    buffer_load_dwordx4 v24, s[8:11], s96 offen lds
    s_add_u32 m0, s38, 11264
    s_nop 0
    buffer_load_dwordx4 v25, s[8:11], s96 offen lds
    s_add_u32 m0, s38, 12288
    s_nop 0
    buffer_load_dwordx4 v26, s[8:11], s96 offen lds
    s_add_u32 m0, s38, 13312
    s_nop 0
    buffer_load_dwordx4 v27, s[8:11], s96 offen lds
    s_add_u32 m0, s38, 14336
    s_nop 0
    buffer_load_dwordx4 v28, s[8:11], s96 offen lds
    s_add_u32 m0, s38, 15360
    s_nop 0
    buffer_load_dwordx4 v29, s[8:11], s96 offen lds
    s_add_u32 m0, s38, 16384
    s_nop 0
    buffer_load_dwordx4 v30, s[8:11], s96 offen lds
    s_add_u32 m0, s38, 17408
    s_nop 0
    buffer_load_dwordx4 v31, s[8:11], s96 offen lds
    s_add_u32 m0, s38, 18432
    s_nop 0
    buffer_load_dwordx4 v32, s[8:11], s96 offen lds
    s_add_u32 m0, s38, 19456
    s_nop 0
    buffer_load_dwordx4 v33, s[8:11], s96 offen lds
    s_add_u32 s96, s96, 40960
    s_add_u32 m0, s38, 20480
    s_nop 0
    buffer_load_dwordx4 v24, s[8:11], s96 offen lds
    s_add_u32 m0, s38, 21504
    s_nop 0
    buffer_load_dwordx4 v25, s[8:11], s96 offen lds
    s_add_u32 m0, s38, 22528
    s_nop 0
    buffer_load_dwordx4 v26, s[8:11], s96 offen lds
    s_add_u32 m0, s38, 23552
    s_nop 0
    buffer_load_dwordx4 v27, s[8:11], s96 offen lds
    s_add_u32 m0, s38, 24576
    s_nop 0
    buffer_load_dwordx4 v28, s[8:11], s96 offen lds
    s_add_u32 m0, s38, 25600
    s_nop 0
    buffer_load_dwordx4 v29, s[8:11], s96 offen lds
    s_add_u32 m0, s38, 26624
    s_nop 0
    buffer_load_dwordx4 v30, s[8:11], s96 offen lds
    s_add_u32 m0, s38, 27648
    s_nop 0
    buffer_load_dwordx4 v31, s[8:11], s96 offen lds
    s_add_u32 m0, s38, 28672
    s_nop 0
    buffer_load_dwordx4 v32, s[8:11], s96 offen lds
    s_add_u32 m0, s38, 29696
    s_nop 0
    buffer_load_dwordx4 v33, s[8:11], s96 offen lds
    s_waitcnt vmcnt(20)
    s_barrier
    s_cmp_lg_u32 s12, 0
    s_cbranch_scc1 L_O_arr_1
    s_lshl_b32 s3, s18, 2
    s_add_u32 s3, s3, 64
    v_mov_b32 v92, s3
    v_mov_b32 v93, 1
    s_mov_b64 exec, 1
    global_atomic_add v92, v93, s[16:17] sc1
    s_waitcnt vmcnt(0)
    s_mov_b64 exec, -1
L_O_arr_1:
    ds_read_b64_tr_b16 a[0:1], v34 offset:0
    ds_read_b64_tr_b16 a[2:3], v34 offset:5120
    ds_read_b64_tr_b16 a[24:25], v34 offset:32
    ds_read_b64_tr_b16 a[26:27], v34 offset:5152
    ds_read_b64_tr_b16 a[48:49], v34 offset:64
    ds_read_b64_tr_b16 a[50:51], v34 offset:5184
    ds_read_b64_tr_b16 a[72:73], v34 offset:96
    ds_read_b64_tr_b16 a[74:75], v34 offset:5216
    ds_read_b64_tr_b16 a[96:97], v34 offset:128
    ds_read_b64_tr_b16 a[98:99], v34 offset:5248
    ds_read_b64_tr_b16 a[120:121], v34 offset:160
    ds_read_b64_tr_b16 a[122:123], v34 offset:5280
    ds_read_b64_tr_b16 a[144:145], v34 offset:192
    ds_read_b64_tr_b16 a[146:147], v34 offset:5312
    ds_read_b64_tr_b16 a[168:169], v34 offset:224
    ds_read_b64_tr_b16 a[170:171], v34 offset:5344
    ds_read_b64_tr_b16 a[192:193], v34 offset:256
    ds_read_b64_tr_b16 a[194:195], v34 offset:5376
    ds_read_b64_tr_b16 a[216:217], v34 offset:288
    ds_read_b64_tr_b16 a[218:219], v34 offset:5408
    s_waitcnt lgkmcnt(0)
    s_add_u32 s96, s96, 40960
    s_add_u32 m0, s38, 0
    s_nop 0
    buffer_load_dwordx4 v24, s[8:11], s96 offen lds
    s_add_u32 m0, s38, 1024
    s_nop 0
    buffer_load_dwordx4 v25, s[8:11], s96 offen lds
    s_add_u32 m0, s38, 2048
    s_nop 0
    buffer_load_dwordx4 v26, s[8:11], s96 offen lds
    s_add_u32 m0, s38, 3072
    s_nop 0
    buffer_load_dwordx4 v27, s[8:11], s96 offen lds
    s_add_u32 m0, s38, 4096
    s_nop 0
    buffer_load_dwordx4 v28, s[8:11], s96 offen lds
    s_add_u32 m0, s38, 5120
    s_nop 0
    buffer_load_dwordx4 v29, s[8:11], s96 offen lds
    s_add_u32 m0, s38, 6144
    s_nop 0
    buffer_load_dwordx4 v30, s[8:11], s96 offen lds
    s_add_u32 m0, s38, 7168
    s_nop 0
    buffer_load_dwordx4 v31, s[8:11], s96 offen lds
    s_add_u32 m0, s38, 8192
    s_nop 0
    buffer_load_dwordx4 v32, s[8:11], s96 offen lds
    s_add_u32 m0, s38, 9216
    s_nop 0
    buffer_load_dwordx4 v33, s[8:11], s96 offen lds
    s_waitcnt vmcnt(20)
    ds_read_b64_tr_b16 a[4:5], v34 offset:10240
    ds_read_b64_tr_b16 a[6:7], v34 offset:15360
    ds_read_b64_tr_b16 a[28:29], v34 offset:10272
    ds_read_b64_tr_b16 a[30:31], v34 offset:15392
    ds_read_b64_tr_b16 a[52:53], v34 offset:10304
    ds_read_b64_tr_b16 a[54:55], v34 offset:15424
    ds_read_b64_tr_b16 a[76:77], v34 offset:10336
    ds_read_b64_tr_b16 a[78:79], v34 offset:15456
    ds_read_b64_tr_b16 a[100:101], v34 offset:10368
    ds_read_b64_tr_b16 a[102:103], v34 offset:15488
    ds_read_b64_tr_b16 a[124:125], v34 offset:10400
    ds_read_b64_tr_b16 a[126:127], v34 offset:15520
    ds_read_b64_tr_b16 a[148:149], v34 offset:10432
    ds_read_b64_tr_b16 a[150:151], v34 offset:15552
    ds_read_b64_tr_b16 a[172:173], v34 offset:10464
    ds_read_b64_tr_b16 a[174:175], v34 offset:15584
    ds_read_b64_tr_b16 a[196:197], v34 offset:10496
    ds_read_b64_tr_b16 a[198:199], v34 offset:15616
    ds_read_b64_tr_b16 a[220:221], v34 offset:10528
    ds_read_b64_tr_b16 a[222:223], v34 offset:15648
    s_waitcnt lgkmcnt(0)
    s_add_u32 s96, s96, 40960
    s_add_u32 m0, s38, 10240
    s_nop 0
    buffer_load_dwordx4 v24, s[8:11], s96 offen lds
    s_add_u32 m0, s38, 11264
    s_nop 0
    buffer_load_dwordx4 v25, s[8:11], s96 offen lds
    s_add_u32 m0, s38, 12288
    s_nop 0
    buffer_load_dwordx4 v26, s[8:11], s96 offen lds
    s_add_u32 m0, s38, 13312
    s_nop 0
    buffer_load_dwordx4 v27, s[8:11], s96 offen lds
    s_add_u32 m0, s38, 14336
    s_nop 0
    buffer_load_dwordx4 v28, s[8:11], s96 offen lds
    s_add_u32 m0, s38, 15360
    s_nop 0
    buffer_load_dwordx4 v29, s[8:11], s96 offen lds
    s_add_u32 m0, s38, 16384
    s_nop 0
    buffer_load_dwordx4 v30, s[8:11], s96 offen lds
    s_add_u32 m0, s38, 17408
    s_nop 0
    buffer_load_dwordx4 v31, s[8:11], s96 offen lds
    s_add_u32 m0, s38, 18432
    s_nop 0
    buffer_load_dwordx4 v32, s[8:11], s96 offen lds
    s_add_u32 m0, s38, 19456
    s_nop 0
    buffer_load_dwordx4 v33, s[8:11], s96 offen lds
    s_waitcnt vmcnt(20)
    ds_read_b64_tr_b16 a[8:9], v34 offset:20480
    ds_read_b64_tr_b16 a[10:11], v34 offset:25600
    ds_read_b64_tr_b16 a[32:33], v34 offset:20512
    ds_read_b64_tr_b16 a[34:35], v34 offset:25632
    ds_read_b64_tr_b16 a[56:57], v34 offset:20544
    ds_read_b64_tr_b16 a[58:59], v34 offset:25664
    ds_read_b64_tr_b16 a[80:81], v34 offset:20576
    ds_read_b64_tr_b16 a[82:83], v34 offset:25696
    ds_read_b64_tr_b16 a[104:105], v34 offset:20608
    ds_read_b64_tr_b16 a[106:107], v34 offset:25728
    ds_read_b64_tr_b16 a[128:129], v34 offset:20640
    ds_read_b64_tr_b16 a[130:131], v34 offset:25760
    ds_read_b64_tr_b16 a[152:153], v34 offset:20672
    ds_read_b64_tr_b16 a[154:155], v34 offset:25792
    ds_read_b64_tr_b16 a[176:177], v34 offset:20704
    ds_read_b64_tr_b16 a[178:179], v34 offset:25824
    ds_read_b64_tr_b16 a[200:201], v34 offset:20736
    ds_read_b64_tr_b16 a[202:203], v34 offset:25856
    ds_read_b64_tr_b16 a[224:225], v34 offset:20768
    ds_read_b64_tr_b16 a[226:227], v34 offset:25888
    s_waitcnt lgkmcnt(0)
    s_add_u32 s96, s96, 40960
    s_add_u32 m0, s38, 20480
    s_nop 0
    buffer_load_dwordx4 v24, s[8:11], s96 offen lds
    s_add_u32 m0, s38, 21504
    s_nop 0
    buffer_load_dwordx4 v25, s[8:11], s96 offen lds
    s_add_u32 m0, s38, 22528
    s_nop 0
    buffer_load_dwordx4 v26, s[8:11], s96 offen lds
    s_add_u32 m0, s38, 23552
    s_nop 0
    buffer_load_dwordx4 v27, s[8:11], s96 offen lds
    s_add_u32 m0, s38, 24576
    s_nop 0
    buffer_load_dwordx4 v28, s[8:11], s96 offen lds
    s_add_u32 m0, s38, 25600
    s_nop 0
    buffer_load_dwordx4 v29, s[8:11], s96 offen lds
    s_add_u32 m0, s38, 26624
    s_nop 0
    buffer_load_dwordx4 v30, s[8:11], s96 offen lds
    s_add_u32 m0, s38, 27648
    s_nop 0
    buffer_load_dwordx4 v31, s[8:11], s96 offen lds
    s_add_u32 m0, s38, 28672
    s_nop 0
    buffer_load_dwordx4 v32, s[8:11], s96 offen lds
    s_add_u32 m0, s38, 29696
    s_nop 0
    buffer_load_dwordx4 v33, s[8:11], s96 offen lds
    s_waitcnt vmcnt(20)
    ds_read_b64_tr_b16 a[12:13], v34 offset:0
    ds_read_b64_tr_b16 a[14:15], v34 offset:5120
    ds_read_b64_tr_b16 a[36:37], v34 offset:32
    ds_read_b64_tr_b16 a[38:39], v34 offset:5152
    ds_read_b64_tr_b16 a[60:61], v34 offset:64
    ds_read_b64_tr_b16 a[62:63], v34 offset:5184
    ds_read_b64_tr_b16 a[84:85], v34 offset:96
    ds_read_b64_tr_b16 a[86:87], v34 offset:5216
    ds_read_b64_tr_b16 a[108:109], v34 offset:128
    ds_read_b64_tr_b16 a[110:111], v34 offset:5248
    ds_read_b64_tr_b16 a[132:133], v34 offset:160
    ds_read_b64_tr_b16 a[134:135], v34 offset:5280
    ds_read_b64_tr_b16 a[156:157], v34 offset:192
    ds_read_b64_tr_b16 a[158:159], v34 offset:5312
    ds_read_b64_tr_b16 a[180:181], v34 offset:224
    ds_read_b64_tr_b16 a[182:183], v34 offset:5344
    ds_read_b64_tr_b16 a[204:205], v34 offset:256
    ds_read_b64_tr_b16 a[206:207], v34 offset:5376
    ds_read_b64_tr_b16 a[228:229], v34 offset:288
    ds_read_b64_tr_b16 a[230:231], v34 offset:5408
    s_waitcnt lgkmcnt(0)
    s_waitcnt vmcnt(10)
    ds_read_b64_tr_b16 a[16:17], v34 offset:10240
    ds_read_b64_tr_b16 a[18:19], v34 offset:15360
    ds_read_b64_tr_b16 a[40:41], v34 offset:10272
    ds_read_b64_tr_b16 a[42:43], v34 offset:15392
    ds_read_b64_tr_b16 a[64:65], v34 offset:10304
    ds_read_b64_tr_b16 a[66:67], v34 offset:15424
    ds_read_b64_tr_b16 a[88:89], v34 offset:10336
    ds_read_b64_tr_b16 a[90:91], v34 offset:15456
    ds_read_b64_tr_b16 a[112:113], v34 offset:10368
    ds_read_b64_tr_b16 a[114:115], v34 offset:15488
    ds_read_b64_tr_b16 a[136:137], v34 offset:10400
    ds_read_b64_tr_b16 a[138:139], v34 offset:15520
    ds_read_b64_tr_b16 a[160:161], v34 offset:10432
    ds_read_b64_tr_b16 a[162:163], v34 offset:15552
    ds_read_b64_tr_b16 a[184:185], v34 offset:10464
    ds_read_b64_tr_b16 a[186:187], v34 offset:15584
    ds_read_b64_tr_b16 a[208:209], v34 offset:10496
    ds_read_b64_tr_b16 a[210:211], v34 offset:15616
    ds_read_b64_tr_b16 a[232:233], v34 offset:10528
    ds_read_b64_tr_b16 a[234:235], v34 offset:15648
    s_waitcnt lgkmcnt(0)
    s_waitcnt vmcnt(0)
    ds_read_b64_tr_b16 a[20:21], v34 offset:20480
    ds_read_b64_tr_b16 a[22:23], v34 offset:25600
    ds_read_b64_tr_b16 a[44:45], v34 offset:20512
    ds_read_b64_tr_b16 a[46:47], v34 offset:25632
    ds_read_b64_tr_b16 a[68:69], v34 offset:20544
    ds_read_b64_tr_b16 a[70:71], v34 offset:25664
    ds_read_b64_tr_b16 a[92:93], v34 offset:20576
    ds_read_b64_tr_b16 a[94:95], v34 offset:25696
    ds_read_b64_tr_b16 a[116:117], v34 offset:20608
    ds_read_b64_tr_b16 a[118:119], v34 offset:25728
    ds_read_b64_tr_b16 a[140:141], v34 offset:20640
    ds_read_b64_tr_b16 a[142:143], v34 offset:25760
    ds_read_b64_tr_b16 a[164:165], v34 offset:20672
    ds_read_b64_tr_b16 a[166:167], v34 offset:25792
    ds_read_b64_tr_b16 a[188:189], v34 offset:20704
    ds_read_b64_tr_b16 a[190:191], v34 offset:25824
    ds_read_b64_tr_b16 a[212:213], v34 offset:20736
    ds_read_b64_tr_b16 a[214:215], v34 offset:25856
    ds_read_b64_tr_b16 a[236:237], v34 offset:20768
    ds_read_b64_tr_b16 a[238:239], v34 offset:25888
    s_waitcnt lgkmcnt(0)
    v_and_b32 v24, 1, v0
    v_lshlrev_b32 v24, 4, v24
    v_mov_b32 v25, 0x3f80
    v_lshlrev_b32 v25, v24, v25
    v_bfe_u32 v24, v0, 1, 3
    v_cmp_eq_u32 vcc, 0, v24
    s_nop 1
    v_cndmask_b32 v26, 0, v25, vcc
    v_accvgpr_write_b32 a240, v26
    v_cmp_eq_u32 vcc, 4, v24
    s_nop 1
    v_cndmask_b32 v26, 0, v25, vcc
    v_accvgpr_write_b32 a244, v26
    v_cmp_eq_u32 vcc, 1, v24
    s_nop 1
    v_cndmask_b32 v26, 0, v25, vcc
    v_accvgpr_write_b32 a241, v26
    v_cmp_eq_u32 vcc, 5, v24
    s_nop 1
    v_cndmask_b32 v26, 0, v25, vcc
    v_accvgpr_write_b32 a245, v26
    v_cmp_eq_u32 vcc, 2, v24
    s_nop 1
    v_cndmask_b32 v26, 0, v25, vcc
    v_accvgpr_write_b32 a242, v26
    v_cmp_eq_u32 vcc, 6, v24
    s_nop 1
    v_cndmask_b32 v26, 0, v25, vcc
    v_accvgpr_write_b32 a246, v26
    v_cmp_eq_u32 vcc, 3, v24
    s_nop 1
    v_cndmask_b32 v26, 0, v25, vcc
    v_accvgpr_write_b32 a243, v26
    v_cmp_eq_u32 vcc, 7, v24
    s_nop 1
    v_cndmask_b32 v26, 0, v25, vcc
    v_accvgpr_write_b32 a247, v26
    v_and_b32 v24, 15, v0
    v_lshrrev_b32 v25, 4, v0
    s_and_b32 s28, s12, 1
    s_lshr_b32 s29, s12, 1
    v_lshrrev_b32 v26, 1, v25
    v_cmp_eq_u32 s[44:45], s20, v26
    s_lshl_b32 s3, s28, 4
    v_add_u32 v26, s3, v24
    v_lshlrev_b32 v27, 2, v25
    v_sub_u32 v26, v26, v27
    v_cmp_le_i32 s[46:47], 0, v26
    v_cmp_le_i32 s[48:49], 1, v26
    v_cmp_le_i32 s[50:51], 2, v26
    v_cmp_le_i32 s[52:53], 3, v26
    v_cmp_le_i32 s[54:55], 16, v26
    v_cmp_le_i32 s[56:57], 17, v26
    v_cmp_le_i32 s[58:59], 18, v26
    v_cmp_le_i32 s[60:61], 19, v26
    s_mov_b32 s3, 40960
    v_mul_lo_u32 v5, v24, s3
    v_lshl_add_u32 v5, v25, 4, v5
    v_add_u32 v5, s27, v5
    v_mul_u32_u24 v6, 1280, v25
    v_lshl_add_u32 v6, v24, 4, v6
    s_mul_i32 s34, s20, 1310720
    s_mul_i32 s3, s21, 1280
    s_add_u32 s34, s34, s3
    s_add_u32 s34, s34, 206700544
    s_add_u32 s35, s34, 655360
    v_and_b32 v10, 1, v0
    v_lshlrev_b32 v10, 9, v10
    s_lshl_b32 s25, s21, 10
    s_add_u32 s25, s25, 384
    s_mov_b32 s26, 2621440
    s_mul_i32 s3, s28, 6144
    v_add_u32 v1, s3, v16
    v_add_u32 v2, 12288, v16
    s_mul_i32 s3, s29, 12288
    s_add_u32 s3, s3, 18432
    v_add_u32 v3, s3, v16
    v_add_u32 v4, 73728, v16
    s_mul_i32 s3, s29, 6144
    v_add_u32 v15, s3, v4
    s_mov_b32 s42, 1033096506
    s_mov_b32 s43, 1069066811
    s_mul_i32 s23, s20, 5
    s_add_u32 s23, s23, 1
    s_mov_b32 s22, 0
    s_mov_b32 s30, 0
    s_mov_b32 s31, 36864
    s_mul_i32 s39, s21, 1280
    s_mul_i32 s3, s20, 2621440
    s_add_u32 s3, s3, s39
    s_add_u32 s40, s3, 198836224
    s_add_u32 s41, s3, 193593344
    s_cmp_eq_u32 s20, 0
    s_cbranch_scc1 L_O_res0
    s_mov_b32 s92, s4
    s_mov_b32 s93, s5
    s_mov_b32 s94, s6
    s_add_u32 s39, s39, 204079104
    v_mov_b32 v8, v7
L_O_res0:
    s_lshl_b32 s3, s18, 2
    s_add_u32 s3, s3, 64
    v_mov_b32 v92, s3
    v_lshlrev_b32 v94, 2, v0
    v_and_b32 v94, 28, v94
    s_mov_b32 s19, 0
L_O_warr_2:
    global_load_dword v93, v92, s[16:17] sc1
    s_add_u32 s19, s19, 1
    s_cmp_ge_u32 s19, 524288
    s_cbranch_scc1 L_fail
    s_waitcnt vmcnt(0)
    v_cmp_gt_u32 vcc, 256, v93
    s_nop 0
    s_cbranch_vccnz L_O_warr_2
    s_cmp_lg_u32 s18, 0
    s_cbranch_scc1 L_O_placed_3
    global_load_dword v93, v94, s[16:17] sc1
    s_waitcnt vmcnt(0)
    v_cmp_ne_u32 vcc, 32, v93
    s_nop 0
    s_cbranch_vccnz L_fallback
L_O_placed_3:
    v_mov_b32 v0, v16
    s_barrier
    buffer_load_dword v12, v10, s[4:7], s25 offen sc1
    s_waitcnt vmcnt(0)
    s_mov_b32 s19, 0
    v_cmp_gt_u32 vcc, s23, v12
    s_nop 0
    s_cbranch_vccnz L_O_flspin_5
L_O_fl_4:
    s_add_u32 s27, s22, 0
    s_min_u32 s27, s27, 63
    s_lshl_b32 s28, s20, 6
    s_add_u32 s27, s27, s28
    s_lshl_b32 s27, s27, 5
    s_add_u32 s27, s27, s21
    s_lshl_b32 s27, s27, 2
    s_add_u32 s27, s27, s12
    s_mul_i32 s28, s27, 3072
    s_add_u32 s28, s28, 138018816
    s_mul_i32 s27, s27, 6144
    s_add_u32 s27, s27, 37355520
    s_mul_i32 s29, s12, 3072
    s_add_u32 m0, s29, s30
    s_nop 0
    buffer_load_dwordx4 v0, s[4:7], s28 offen offset:0 sc1 lds
    buffer_load_dwordx4 v0, s[4:7], s28 offen offset:1024 sc1 lds
    buffer_load_dwordx4 v0, s[4:7], s28 offen offset:2048 sc1 lds
    s_lshl_b32 s29, s29, 1
    s_add_u32 s29, s29, s30
    s_add_u32 m0, s29, 12288
    s_nop 0
    buffer_load_dwordx4 v0, s[4:7], s27 offen offset:0 sc1 lds
    buffer_load_dwordx4 v0, s[4:7], s27 offen offset:1024 sc1 lds
    buffer_load_dwordx4 v0, s[4:7], s27 offen offset:2048 sc1 lds
    s_add_u32 s27, s27, 3072
    s_add_u32 m0, s29, 15360
    s_nop 0
    buffer_load_dwordx4 v0, s[4:7], s27 offen offset:0 sc1 lds
    buffer_load_dwordx4 v0, s[4:7], s27 offen offset:1024 sc1 lds
    buffer_load_dwordx4 v0, s[4:7], s27 offen offset:2048 sc1 lds
    s_waitcnt vmcnt(0)
    s_mov_b32 s30, 36864
    s_barrier
    s_cmp_lg_u32 s18, 0
    s_cbranch_scc1 L_O_slow
    s_branch L_O_fast
L_O_flspin_5:
    buffer_load_dword v12, v10, s[4:7], s25 offen sc1
    s_add_u32 s19, s19, 1
    s_cmp_ge_u32 s19, 524288
    s_cbranch_scc1 L_fail
    s_waitcnt vmcnt(0)
    v_cmp_gt_u32 vcc, s23, v12
    s_nop 0
    s_cbranch_vccnz L_O_flspin_5
    s_branch L_O_fl_4
L_O_fast:
L_Of_top:
    buffer_load_dword v12, v10, s[4:7], s25 offen sc1
    ds_read_b128 v[16:19], v1 offset:0
    ds_read_b128 v[40:43], v2 offset:0
    ds_read_b128 v[64:67], v2 offset:3072
    ds_read_b128 v[20:23], v1 offset:1024
    ds_read_b128 v[44:47], v2 offset:1024
    ds_read_b128 v[68:71], v2 offset:4096
    ds_read_b128 v[24:27], v1 offset:2048
    ds_read_b128 v[48:51], v2 offset:2048
    ds_read_b128 v[72:75], v2 offset:5120
    ds_read_b128 v[28:31], v1 offset:3072
    ds_read_b128 v[52:55], v2 offset:12288
    ds_read_b128 v[76:79], v2 offset:15360
    ds_read_b128 v[32:35], v1 offset:4096
    ds_read_b128 v[56:59], v2 offset:13312
    ds_read_b128 v[80:83], v2 offset:16384
    ds_read_b128 v[36:39], v1 offset:5120
    ds_read_b128 v[60:63], v2 offset:14336
    ds_read_b128 v[84:87], v2 offset:17408
    s_waitcnt lgkmcnt(15)
    v_mfma_f32_16x16x32_bf16 v[152:155], v[40:43], v[16:19], 0
    v_mfma_f32_16x16x32_bf16 v[156:159], v[64:67], v[16:19], 0
    s_waitcnt lgkmcnt(12)
    v_mfma_f32_16x16x32_bf16 v[152:155], v[44:47], v[20:23], v[152:155]
    v_mfma_f32_16x16x32_bf16 v[156:159], v[68:71], v[20:23], v[156:159]
    s_waitcnt lgkmcnt(9)
    v_mfma_f32_16x16x32_bf16 v[152:155], v[48:51], v[24:27], v[152:155]
    v_mfma_f32_16x16x32_bf16 v[156:159], v[72:75], v[24:27], v[156:159]
    s_waitcnt lgkmcnt(6)
    v_mfma_f32_16x16x32_bf16 v[152:155], v[52:55], v[28:31], v[152:155]
    v_mfma_f32_16x16x32_bf16 v[156:159], v[76:79], v[28:31], v[156:159]
    s_waitcnt lgkmcnt(3)
    v_mfma_f32_16x16x32_bf16 v[152:155], v[56:59], v[32:35], v[152:155]
    v_mfma_f32_16x16x32_bf16 v[156:159], v[80:83], v[32:35], v[156:159]
    s_waitcnt lgkmcnt(0)
    v_mfma_f32_16x16x32_bf16 v[152:155], v[60:63], v[36:39], v[152:155]
    v_mfma_f32_16x16x32_bf16 v[156:159], v[84:87], v[36:39], v[156:159]
    ds_read_b128 v[112:115], v3 offset:0
    ds_read_b128 v[116:119], v3 offset:1024
    ds_read_b128 v[120:123], v3 offset:2048
    ds_read_b128 v[124:127], v3 offset:3072
    ds_read_b128 v[128:131], v3 offset:4096
    ds_read_b128 v[132:135], v3 offset:5120
    s_lshr_b32 s27, s22, 1
    s_andn2_b32 s32, 1, s27
    s_sub_u32 s33, 0, s32
    s_sub_u32 s27, s23, 1
    s_lshl_b32 s27, s27, 5
    s_add_u32 s27, s27, s21
    s_lshl_b32 s27, s27, 2
    s_add_u32 s27, s27, s12
    s_mul_i32 s27, s27, 3072
    s_add_u32 s27, s27, 5898240
    s_mul_i32 s28, s12, 3072
    s_add_u32 m0, s28, 73728
    v_cvt_pk_bf16_f32 v162, v152, v153
    v_cvt_pk_bf16_f32 v163, v154, v155
    v_cvt_pk_bf16_f32 v164, v156, v157
    v_cvt_pk_bf16_f32 v165, v158, v159
    v_lshlrev_b32 v152, 16, v162
    v_and_b32 v153, 0xffff0000, v162
    v_lshlrev_b32 v154, 16, v163
    v_and_b32 v155, 0xffff0000, v163
    v_lshlrev_b32 v156, 16, v164
    v_and_b32 v157, 0xffff0000, v164
    v_lshlrev_b32 v158, 16, v165
    v_and_b32 v159, 0xffff0000, v165
    v_mul_f32 v152, s42, v152
    v_mul_f32 v153, s42, v153
    v_mul_f32 v154, s42, v154
    v_mul_f32 v155, s42, v155
    v_mul_f32 v156, s42, v156
    v_mul_f32 v157, s42, v157
    v_mul_f32 v158, s42, v158
    v_mul_f32 v159, s42, v159
    v_cvt_pk_bf16_f32 v162, v152, v153
    v_cvt_pk_bf16_f32 v163, v154, v155
    v_cvt_pk_bf16_f32 v164, v156, v157
    v_cvt_pk_bf16_f32 v165, v158, v159
    v_lshlrev_b32 v152, 16, v162
    v_and_b32 v153, 0xffff0000, v162
    v_lshlrev_b32 v154, 16, v163
    v_and_b32 v155, 0xffff0000, v163
    v_lshlrev_b32 v156, 16, v164
    v_and_b32 v157, 0xffff0000, v164
    v_lshlrev_b32 v158, 16, v165
    v_and_b32 v159, 0xffff0000, v165
    v_mov_b32 v14, 0xff800000
    v_cndmask_b32 v152, v14, v152, s[46:47]
    v_cndmask_b32 v153, v14, v153, s[48:49]
    v_cndmask_b32 v154, v14, v154, s[50:51]
    v_cndmask_b32 v155, v14, v155, s[52:53]
    v_cndmask_b32 v156, v14, v156, s[54:55]
    v_cndmask_b32 v157, v14, v157, s[56:57]
    v_cndmask_b32 v158, v14, v158, s[58:59]
    v_cndmask_b32 v159, v14, v159, s[60:61]
    s_waitcnt vmcnt(0)
    s_cmp_lg_u32 s12, 0
    s_cbranch_scc1 L_Of_noflag_1
    v_mov_b32 v13, s22
    s_mov_b64 exec, 1
    buffer_store_dword v13, v0, s[4:7], s24 offen offset:0 sc1
    s_mov_b64 exec, -1
L_Of_noflag_1:
    s_mov_b32 s19, 0
    v_cmp_gt_u32 vcc, s23, v12
    s_nop 0
    s_cbranch_vccnz L_Of_flspin_3
L_Of_fl_2:
    buffer_load_dwordx4 v0, s[4:7], s27 offen offset:0 sc1 lds
    buffer_load_dwordx4 v0, s[4:7], s27 offen offset:1024 sc1 lds
    buffer_load_dwordx4 v0, s[4:7], s27 offen offset:2048 sc1 lds
    buffer_load_dwordx2 v[208:209], v8, s[92:95], s39 offen offset:0 sc1
    buffer_load_dwordx2 v[210:211], v8, s[92:95], s39 offen offset:512 sc1
    s_mov_b64 exec, s[62:63]
    buffer_load_dwordx2 v[212:213], v8, s[92:95], s39 offen offset:1024 sc1
    s_mov_b64 exec, -1
    s_waitcnt vmcnt(3) lgkmcnt(0)
    s_barrier
    ds_read_b128 v[88:91], v4 offset:0
    ds_read_b128 v[92:95], v4 offset:1024
    ds_read_b128 v[96:99], v4 offset:2048
    ds_read_b128 v[100:103], v4 offset:6144
    ds_read_b128 v[104:107], v4 offset:7168
    ds_read_b128 v[108:111], v4 offset:8192
    ds_read_b128 v[136:139], v15 offset:3072
    ds_read_b128 v[140:143], v15 offset:4096
    ds_read_b128 v[144:147], v15 offset:5120
    s_add_u32 s27, s22, 1
    s_min_u32 s27, s27, 63
    s_lshl_b32 s28, s20, 6
    s_add_u32 s27, s27, s28
    s_lshl_b32 s27, s27, 5
    s_add_u32 s27, s27, s21
    s_lshl_b32 s27, s27, 2
    s_add_u32 s27, s27, s12
    s_mul_i32 s28, s27, 3072
    s_add_u32 s28, s28, 138018816
    s_mul_i32 s27, s27, 6144
    s_add_u32 s27, s27, 37355520
    s_mul_i32 s29, s12, 3072
    s_add_u32 m0, s29, s30
    s_nop 0
    buffer_load_dwordx4 v0, s[4:7], s28 offen offset:0 sc1 lds
    buffer_load_dwordx4 v0, s[4:7], s28 offen offset:1024 sc1 lds
    buffer_load_dwordx4 v0, s[4:7], s28 offen offset:2048 sc1 lds
    s_lshl_b32 s29, s29, 1
    s_add_u32 s29, s29, s30
    s_add_u32 m0, s29, 12288
    s_nop 0
    buffer_load_dwordx4 v0, s[4:7], s27 offen offset:0 sc1 lds
    buffer_load_dwordx4 v0, s[4:7], s27 offen offset:1024 sc1 lds
    buffer_load_dwordx4 v0, s[4:7], s27 offen offset:2048 sc1 lds
    s_add_u32 s27, s27, 3072
    s_add_u32 m0, s29, 15360
    s_nop 0
    buffer_load_dwordx4 v0, s[4:7], s27 offen offset:0 sc1 lds
    buffer_load_dwordx4 v0, s[4:7], s27 offen offset:1024 sc1 lds
    buffer_load_dwordx4 v0, s[4:7], s27 offen offset:2048 sc1 lds
    s_waitcnt lgkmcnt(8)
    v_mfma_f32_16x16x32_bf16 v[148:151], v[88:91], v[16:19], 0
    s_waitcnt lgkmcnt(7)
    v_mfma_f32_16x16x32_bf16 v[148:151], v[92:95], v[20:23], v[148:151]
    s_waitcnt lgkmcnt(6)
    v_mfma_f32_16x16x32_bf16 v[148:151], v[96:99], v[24:27], v[148:151]
    s_waitcnt lgkmcnt(5)
    v_mfma_f32_16x16x32_bf16 v[148:151], v[100:103], v[28:31], v[148:151]
    s_waitcnt lgkmcnt(4)
    v_mfma_f32_16x16x32_bf16 v[148:151], v[104:107], v[32:35], v[148:151]
    s_waitcnt lgkmcnt(3)
    v_mfma_f32_16x16x32_bf16 v[148:151], v[108:111], v[36:39], v[148:151]
    v_max3_f32 v161, v152, v153, v154
    v_max3_f32 v161, v161, v155, v156
    v_max3_f32 v161, v161, v157, v158
    v_max_f32 v161, v161, v159
    s_nop 3
    v_cvt_pk_bf16_f32 v162, v148, v149
    v_cvt_pk_bf16_f32 v163, v150, v151
    v_lshlrev_b32 v148, 16, v162
    v_and_b32 v149, 0xffff0000, v162
    v_lshlrev_b32 v150, 16, v163
    v_and_b32 v151, 0xffff0000, v163
    v_mul_f32 v148, s42, v148
    v_mul_f32 v149, s42, v149
    v_mul_f32 v150, s42, v150
    v_mul_f32 v151, s42, v151
    v_cvt_pk_bf16_f32 v162, v148, v149
    v_cvt_pk_bf16_f32 v163, v150, v151
    v_lshlrev_b32 v148, 16, v162
    v_and_b32 v149, 0xffff0000, v162
    v_lshlrev_b32 v150, 16, v163
    v_and_b32 v151, 0xffff0000, v163
    v_cndmask_b32 v148, v14, v148, s[44:45]
    v_cndmask_b32 v149, v14, v149, s[44:45]
    v_cndmask_b32 v150, v14, v150, s[44:45]
    v_cndmask_b32 v151, v14, v151, s[44:45]
    v_max3_f32 v160, v148, v149, v161
    v_max3_f32 v160, v150, v151, v160
    v_mov_b32 v161, v160
    s_nop 1
    v_permlane32_swap_b32 v160, v161
    v_max_f32 v160, v160, v161
    v_mov_b32 v161, v160
    s_nop 1
    v_permlane16_swap_b32 v160, v161
    v_max_f32 v160, v160, v161
    v_mul_f32 v160, s43, v160
    v_fma_f32 v148, v148, s43, -v160
    v_fma_f32 v149, v149, s43, -v160
    v_fma_f32 v150, v150, s43, -v160
    v_fma_f32 v151, v151, s43, -v160
    v_fma_f32 v152, v152, s43, -v160
    v_fma_f32 v153, v153, s43, -v160
    v_fma_f32 v154, v154, s43, -v160
    v_fma_f32 v155, v155, s43, -v160
    v_fma_f32 v156, v156, s43, -v160
    v_fma_f32 v157, v157, s43, -v160
    v_fma_f32 v158, v158, s43, -v160
    v_fma_f32 v159, v159, s43, -v160
    v_exp_f32 v148, v148
    v_exp_f32 v149, v149
    v_exp_f32 v150, v150
    v_exp_f32 v151, v151
    v_exp_f32 v152, v152
    v_exp_f32 v153, v153
    v_exp_f32 v154, v154
    v_exp_f32 v155, v155
    v_exp_f32 v156, v156
    v_exp_f32 v157, v157
    v_exp_f32 v158, v158
    v_exp_f32 v159, v159
    v_pk_add_f32 v[160:161], v[148:149], v[150:151]
    v_pk_add_f32 v[160:161], v[160:161], v[152:153]
    v_pk_add_f32 v[160:161], v[160:161], v[154:155]
    v_pk_add_f32 v[160:161], v[160:161], v[156:157]
    v_pk_add_f32 v[160:161], v[160:161], v[158:159]
    v_add_f32 v160, v160, v161
    v_mov_b32 v161, v160
    s_nop 1
    v_permlane32_swap_b32 v160, v161
    v_add_f32 v160, v160, v161
    v_mov_b32 v161, v160
    s_nop 1
    v_permlane16_swap_b32 v160, v161
    v_add_f32 v160, v160, v161
    v_rcp_f32 v160, v160
    s_nop 0
    v_pk_mul_f32 v[148:149], v[148:149], v[160:161] op_sel_hi:[1,0]
    v_pk_mul_f32 v[150:151], v[150:151], v[160:161] op_sel_hi:[1,0]
    v_pk_mul_f32 v[152:153], v[152:153], v[160:161] op_sel_hi:[1,0]
    v_pk_mul_f32 v[154:155], v[154:155], v[160:161] op_sel_hi:[1,0]
    v_pk_mul_f32 v[156:157], v[156:157], v[160:161] op_sel_hi:[1,0]
    v_pk_mul_f32 v[158:159], v[158:159], v[160:161] op_sel_hi:[1,0]
    v_cvt_pk_bf16_f32 v164, v148, v149
    v_cvt_pk_bf16_f32 v165, v150, v151
    v_cvt_pk_bf16_f32 v166, v152, v153
    v_cvt_pk_bf16_f32 v167, v154, v155
    v_cvt_pk_bf16_f32 v168, v156, v157
    v_cvt_pk_bf16_f32 v169, v158, v159
    s_waitcnt lgkmcnt(0)
    v_mfma_f32_16x16x16_bf16 v[170:173], v[136:137], v[164:165], 0
    v_mfma_f32_16x16x16_bf16 v[174:177], v[138:139], v[164:165], 0
    v_mfma_f32_16x16x16_bf16 v[178:181], v[140:141], v[164:165], 0
    v_mfma_f32_16x16x16_bf16 v[182:185], v[142:143], v[164:165], 0
    v_mfma_f32_16x16x16_bf16 v[186:189], v[144:145], v[164:165], 0
    v_mfma_f32_16x16x16_bf16 v[190:193], v[146:147], v[164:165], 0
    s_nop 0
    v_mfma_f32_16x16x32_bf16 v[170:173], v[112:115], v[166:169], v[170:173]
    v_mfma_f32_16x16x32_bf16 v[174:177], v[116:119], v[166:169], v[174:177]
    v_mfma_f32_16x16x32_bf16 v[178:181], v[120:123], v[166:169], v[178:181]
    v_mfma_f32_16x16x32_bf16 v[182:185], v[124:127], v[166:169], v[182:185]
    v_mfma_f32_16x16x32_bf16 v[186:189], v[128:131], v[166:169], v[186:189]
    v_mfma_f32_16x16x32_bf16 v[190:193], v[132:135], v[166:169], v[190:193]
    s_lshr_b32 s27, s12, 1
    s_mul_i32 s27, s27, 3072
    s_and_b32 s28, s12, 1
    s_mul_i32 s28, s28, 6144
    s_add_u32 s27, s27, s28
    v_add_u32 v160, s27, v4
    v_cvt_pk_bf16_f32 v194, v170, v171
    v_cvt_pk_bf16_f32 v195, v172, v173
    v_cvt_pk_bf16_f32 v196, v174, v175
    v_cvt_pk_bf16_f32 v197, v176, v177
    ds_write_b128 v160, v[194:197] offset:12288
    v_cvt_pk_bf16_f32 v198, v178, v179
    v_cvt_pk_bf16_f32 v199, v180, v181
    v_cvt_pk_bf16_f32 v200, v182, v183
    v_cvt_pk_bf16_f32 v201, v184, v185
    ds_write_b128 v160, v[198:201] offset:13312
    v_cvt_pk_bf16_f32 v202, v186, v187
    v_cvt_pk_bf16_f32 v203, v188, v189
    v_cvt_pk_bf16_f32 v204, v190, v191
    v_cvt_pk_bf16_f32 v205, v192, v193
    ds_write_b128 v160, v[202:205] offset:14336
    s_waitcnt lgkmcnt(0)
    s_barrier
    ds_read_b128 v[16:19], v4 offset:12288
    ds_read_b128 v[20:23], v4 offset:13312
    ds_read_b128 v[24:27], v4 offset:14336
    ds_read_b128 v[28:31], v4 offset:15360
    ds_read_b128 v[32:35], v4 offset:16384
    ds_read_b128 v[36:39], v4 offset:17408
    ds_read_b128 v[40:43], v4 offset:18432
    ds_read_b128 v[44:47], v4 offset:19456
    ds_read_b128 v[48:51], v4 offset:20480
    ds_read_b128 v[52:55], v4 offset:21504
    ds_read_b128 v[56:59], v4 offset:22528
    ds_read_b128 v[60:63], v4 offset:23552
    s_waitcnt lgkmcnt(11)
    v_mfma_f32_16x16x32_bf16 v[64:67], a[0:3], v[16:19], 0
    s_waitcnt lgkmcnt(10)
    v_mfma_f32_16x16x32_bf16 v[64:67], a[4:7], v[20:23], v[64:67]
    s_waitcnt lgkmcnt(9)
    v_mfma_f32_16x16x32_bf16 v[64:67], a[8:11], v[24:27], v[64:67]
    s_waitcnt lgkmcnt(8)
    v_mfma_f32_16x16x32_bf16 v[64:67], a[12:15], v[28:31], v[64:67]
    s_waitcnt lgkmcnt(7)
    v_mfma_f32_16x16x32_bf16 v[64:67], a[16:19], v[32:35], v[64:67]
    s_waitcnt lgkmcnt(6)
    v_mfma_f32_16x16x32_bf16 v[64:67], a[20:23], v[36:39], v[64:67]
    v_mfma_f32_16x16x32_bf16 v[68:71], a[24:27], v[16:19], 0
    v_mfma_f32_16x16x32_bf16 v[68:71], a[28:31], v[20:23], v[68:71]
    v_mfma_f32_16x16x32_bf16 v[68:71], a[32:35], v[24:27], v[68:71]
    v_mfma_f32_16x16x32_bf16 v[68:71], a[36:39], v[28:31], v[68:71]
    v_mfma_f32_16x16x32_bf16 v[68:71], a[40:43], v[32:35], v[68:71]
    v_mfma_f32_16x16x32_bf16 v[68:71], a[44:47], v[36:39], v[68:71]
    s_waitcnt lgkmcnt(5)
    v_mfma_f32_16x16x32_bf16 v[72:75], a[0:3], v[40:43], 0
    s_waitcnt lgkmcnt(4)
    v_mfma_f32_16x16x32_bf16 v[72:75], a[4:7], v[44:47], v[72:75]
    s_waitcnt lgkmcnt(3)
    v_mfma_f32_16x16x32_bf16 v[72:75], a[8:11], v[48:51], v[72:75]
    v_cvt_pk_bf16_f32 v80, v64, v65
    s_waitcnt lgkmcnt(2)
    v_mfma_f32_16x16x32_bf16 v[72:75], a[12:15], v[52:55], v[72:75]
    v_cvt_pk_bf16_f32 v81, v66, v67
    s_waitcnt lgkmcnt(1)
    v_mfma_f32_16x16x32_bf16 v[72:75], a[16:19], v[56:59], v[72:75]
    v_and_or_b32 v80, v80, -2, s32
    s_waitcnt lgkmcnt(0)
    v_mfma_f32_16x16x32_bf16 v[72:75], a[20:23], v[60:63], v[72:75]
    v_cvt_pk_bf16_f32 v82, v68, v69
    v_mfma_f32_16x16x32_bf16 v[76:79], a[24:27], v[40:43], 0
    v_cvt_pk_bf16_f32 v83, v70, v71
    v_mfma_f32_16x16x32_bf16 v[76:79], a[28:31], v[44:47], v[76:79]
    buffer_store_dwordx4 v[80:83], v5, s[4:7], s34 offen offset:0
    v_mfma_f32_16x16x32_bf16 v[76:79], a[32:35], v[48:51], v[76:79]
    v_mfma_f32_16x16x32_bf16 v[76:79], a[36:39], v[52:55], v[76:79]
    v_mfma_f32_16x16x32_bf16 v[76:79], a[40:43], v[56:59], v[76:79]
    v_mfma_f32_16x16x32_bf16 v[76:79], a[44:47], v[60:63], v[76:79]
    v_mfma_f32_16x16x32_bf16 v[64:67], a[48:51], v[16:19], 0
    v_mfma_f32_16x16x32_bf16 v[64:67], a[52:55], v[20:23], v[64:67]
    v_mfma_f32_16x16x32_bf16 v[64:67], a[56:59], v[24:27], v[64:67]
    v_cvt_pk_bf16_f32 v84, v72, v73
    v_mfma_f32_16x16x32_bf16 v[64:67], a[60:63], v[28:31], v[64:67]
    v_cvt_pk_bf16_f32 v85, v74, v75
    v_mfma_f32_16x16x32_bf16 v[64:67], a[64:67], v[32:35], v[64:67]
    v_and_or_b32 v84, v84, -2, s32
    v_mfma_f32_16x16x32_bf16 v[64:67], a[68:71], v[36:39], v[64:67]
    v_cvt_pk_bf16_f32 v86, v76, v77
    v_mfma_f32_16x16x32_bf16 v[68:71], a[72:75], v[16:19], 0
    v_cvt_pk_bf16_f32 v87, v78, v79
    v_mfma_f32_16x16x32_bf16 v[68:71], a[76:79], v[20:23], v[68:71]
    buffer_store_dwordx4 v[84:87], v5, s[4:7], s35 offen offset:0
    v_mfma_f32_16x16x32_bf16 v[68:71], a[80:83], v[24:27], v[68:71]
    v_mfma_f32_16x16x32_bf16 v[68:71], a[84:87], v[28:31], v[68:71]
    v_mfma_f32_16x16x32_bf16 v[68:71], a[88:91], v[32:35], v[68:71]
    v_mfma_f32_16x16x32_bf16 v[68:71], a[92:95], v[36:39], v[68:71]
    v_mfma_f32_16x16x32_bf16 v[72:75], a[48:51], v[40:43], 0
    v_mfma_f32_16x16x32_bf16 v[72:75], a[52:55], v[44:47], v[72:75]
    v_mfma_f32_16x16x32_bf16 v[72:75], a[56:59], v[48:51], v[72:75]
    v_cvt_pk_bf16_f32 v80, v64, v65
    v_mfma_f32_16x16x32_bf16 v[72:75], a[60:63], v[52:55], v[72:75]
    v_cvt_pk_bf16_f32 v81, v66, v67
    v_mfma_f32_16x16x32_bf16 v[72:75], a[64:67], v[56:59], v[72:75]
    v_and_or_b32 v80, v80, -2, s32
    v_mfma_f32_16x16x32_bf16 v[72:75], a[68:71], v[60:63], v[72:75]
    v_cvt_pk_bf16_f32 v82, v68, v69
    v_mfma_f32_16x16x32_bf16 v[76:79], a[72:75], v[40:43], 0
    v_cvt_pk_bf16_f32 v83, v70, v71
    v_mfma_f32_16x16x32_bf16 v[76:79], a[76:79], v[44:47], v[76:79]
    buffer_store_dwordx4 v[80:83], v5, s[4:7], s34 offen offset:64
    v_mfma_f32_16x16x32_bf16 v[76:79], a[80:83], v[48:51], v[76:79]
    v_mfma_f32_16x16x32_bf16 v[76:79], a[84:87], v[52:55], v[76:79]
    v_mfma_f32_16x16x32_bf16 v[76:79], a[88:91], v[56:59], v[76:79]
    v_mfma_f32_16x16x32_bf16 v[76:79], a[92:95], v[60:63], v[76:79]
    v_mfma_f32_16x16x32_bf16 v[64:67], a[96:99], v[16:19], 0
    v_mfma_f32_16x16x32_bf16 v[64:67], a[100:103], v[20:23], v[64:67]
    v_mfma_f32_16x16x32_bf16 v[64:67], a[104:107], v[24:27], v[64:67]
    v_cvt_pk_bf16_f32 v84, v72, v73
    v_mfma_f32_16x16x32_bf16 v[64:67], a[108:111], v[28:31], v[64:67]
    v_cvt_pk_bf16_f32 v85, v74, v75
    v_mfma_f32_16x16x32_bf16 v[64:67], a[112:115], v[32:35], v[64:67]
    v_and_or_b32 v84, v84, -2, s32
    v_mfma_f32_16x16x32_bf16 v[64:67], a[116:119], v[36:39], v[64:67]
    v_cvt_pk_bf16_f32 v86, v76, v77
    v_mfma_f32_16x16x32_bf16 v[68:71], a[120:123], v[16:19], 0
    v_cvt_pk_bf16_f32 v87, v78, v79
    v_mfma_f32_16x16x32_bf16 v[68:71], a[124:127], v[20:23], v[68:71]
    buffer_store_dwordx4 v[84:87], v5, s[4:7], s35 offen offset:64
    v_mfma_f32_16x16x32_bf16 v[68:71], a[128:131], v[24:27], v[68:71]
    v_mfma_f32_16x16x32_bf16 v[68:71], a[132:135], v[28:31], v[68:71]
    v_mfma_f32_16x16x32_bf16 v[68:71], a[136:139], v[32:35], v[68:71]
    v_mfma_f32_16x16x32_bf16 v[68:71], a[140:143], v[36:39], v[68:71]
    v_mfma_f32_16x16x32_bf16 v[72:75], a[96:99], v[40:43], 0
    v_mfma_f32_16x16x32_bf16 v[72:75], a[100:103], v[44:47], v[72:75]
    v_mfma_f32_16x16x32_bf16 v[72:75], a[104:107], v[48:51], v[72:75]
    v_cvt_pk_bf16_f32 v80, v64, v65
    v_mfma_f32_16x16x32_bf16 v[72:75], a[108:111], v[52:55], v[72:75]
    v_cvt_pk_bf16_f32 v81, v66, v67
    v_mfma_f32_16x16x32_bf16 v[72:75], a[112:115], v[56:59], v[72:75]
    v_and_or_b32 v80, v80, -2, s32
    v_mfma_f32_16x16x32_bf16 v[72:75], a[116:119], v[60:63], v[72:75]
    v_cvt_pk_bf16_f32 v82, v68, v69
    v_mfma_f32_16x16x32_bf16 v[76:79], a[120:123], v[40:43], 0
    v_cvt_pk_bf16_f32 v83, v70, v71
    v_mfma_f32_16x16x32_bf16 v[76:79], a[124:127], v[44:47], v[76:79]
    buffer_store_dwordx4 v[80:83], v5, s[4:7], s34 offen offset:128
    v_mfma_f32_16x16x32_bf16 v[76:79], a[128:131], v[48:51], v[76:79]
    v_mfma_f32_16x16x32_bf16 v[76:79], a[132:135], v[52:55], v[76:79]
    v_mfma_f32_16x16x32_bf16 v[76:79], a[136:139], v[56:59], v[76:79]
    v_mfma_f32_16x16x32_bf16 v[76:79], a[140:143], v[60:63], v[76:79]
    v_mfma_f32_16x16x32_bf16 v[64:67], a[144:147], v[16:19], 0
    v_mfma_f32_16x16x32_bf16 v[64:67], a[148:151], v[20:23], v[64:67]
    v_mfma_f32_16x16x32_bf16 v[64:67], a[152:155], v[24:27], v[64:67]
    v_cvt_pk_bf16_f32 v84, v72, v73
    v_mfma_f32_16x16x32_bf16 v[64:67], a[156:159], v[28:31], v[64:67]
    v_cvt_pk_bf16_f32 v85, v74, v75
    v_mfma_f32_16x16x32_bf16 v[64:67], a[160:163], v[32:35], v[64:67]
    v_and_or_b32 v84, v84, -2, s32
    v_mfma_f32_16x16x32_bf16 v[64:67], a[164:167], v[36:39], v[64:67]
    v_cvt_pk_bf16_f32 v86, v76, v77
    v_mfma_f32_16x16x32_bf16 v[68:71], a[168:171], v[16:19], 0
    v_cvt_pk_bf16_f32 v87, v78, v79
    v_mfma_f32_16x16x32_bf16 v[68:71], a[172:175], v[20:23], v[68:71]
    buffer_store_dwordx4 v[84:87], v5, s[4:7], s35 offen offset:128
    v_mfma_f32_16x16x32_bf16 v[68:71], a[176:179], v[24:27], v[68:71]
    v_mfma_f32_16x16x32_bf16 v[68:71], a[180:183], v[28:31], v[68:71]
    v_mfma_f32_16x16x32_bf16 v[68:71], a[184:187], v[32:35], v[68:71]
    v_mfma_f32_16x16x32_bf16 v[68:71], a[188:191], v[36:39], v[68:71]
    v_mfma_f32_16x16x32_bf16 v[72:75], a[144:147], v[40:43], 0
    v_mfma_f32_16x16x32_bf16 v[72:75], a[148:151], v[44:47], v[72:75]
    v_mfma_f32_16x16x32_bf16 v[72:75], a[152:155], v[48:51], v[72:75]
    v_cvt_pk_bf16_f32 v80, v64, v65
    v_mfma_f32_16x16x32_bf16 v[72:75], a[156:159], v[52:55], v[72:75]
    v_cvt_pk_bf16_f32 v81, v66, v67
    v_mfma_f32_16x16x32_bf16 v[72:75], a[160:163], v[56:59], v[72:75]
    v_and_or_b32 v80, v80, -2, s32
    v_mfma_f32_16x16x32_bf16 v[72:75], a[164:167], v[60:63], v[72:75]
    v_cvt_pk_bf16_f32 v82, v68, v69
    v_mfma_f32_16x16x32_bf16 v[76:79], a[168:171], v[40:43], 0
    v_cvt_pk_bf16_f32 v83, v70, v71
    v_mfma_f32_16x16x32_bf16 v[76:79], a[172:175], v[44:47], v[76:79]
    buffer_store_dwordx4 v[80:83], v5, s[4:7], s34 offen offset:192
    v_mfma_f32_16x16x32_bf16 v[76:79], a[176:179], v[48:51], v[76:79]
    v_mfma_f32_16x16x32_bf16 v[76:79], a[180:183], v[52:55], v[76:79]
    v_mfma_f32_16x16x32_bf16 v[76:79], a[184:187], v[56:59], v[76:79]
    v_mfma_f32_16x16x32_bf16 v[76:79], a[188:191], v[60:63], v[76:79]
    v_mfma_f32_16x16x32_bf16 v[64:67], a[192:195], v[16:19], 0
    v_mfma_f32_16x16x32_bf16 v[64:67], a[196:199], v[20:23], v[64:67]
    v_mfma_f32_16x16x32_bf16 v[64:67], a[200:203], v[24:27], v[64:67]
    v_cvt_pk_bf16_f32 v84, v72, v73
    v_mfma_f32_16x16x32_bf16 v[64:67], a[204:207], v[28:31], v[64:67]
    v_cvt_pk_bf16_f32 v85, v74, v75
    v_mfma_f32_16x16x32_bf16 v[64:67], a[208:211], v[32:35], v[64:67]
    v_and_or_b32 v84, v84, -2, s32
    v_mfma_f32_16x16x32_bf16 v[64:67], a[212:215], v[36:39], v[64:67]
    v_cvt_pk_bf16_f32 v86, v76, v77
    v_mfma_f32_16x16x32_bf16 v[68:71], a[216:219], v[16:19], 0
    v_cvt_pk_bf16_f32 v87, v78, v79
    v_mfma_f32_16x16x32_bf16 v[68:71], a[220:223], v[20:23], v[68:71]
    buffer_store_dwordx4 v[84:87], v5, s[4:7], s35 offen offset:192
    v_mfma_f32_16x16x32_bf16 v[68:71], a[224:227], v[24:27], v[68:71]
    v_mfma_f32_16x16x32_bf16 v[68:71], a[228:231], v[28:31], v[68:71]
    v_mfma_f32_16x16x32_bf16 v[68:71], a[232:235], v[32:35], v[68:71]
    v_mfma_f32_16x16x32_bf16 v[68:71], a[236:239], v[36:39], v[68:71]
    v_mfma_f32_16x16x32_bf16 v[72:75], a[192:195], v[40:43], 0
    v_mfma_f32_16x16x32_bf16 v[72:75], a[196:199], v[44:47], v[72:75]
    v_mfma_f32_16x16x32_bf16 v[72:75], a[200:203], v[48:51], v[72:75]
    v_cvt_pk_bf16_f32 v80, v64, v65
    v_mfma_f32_16x16x32_bf16 v[72:75], a[204:207], v[52:55], v[72:75]
    v_cvt_pk_bf16_f32 v81, v66, v67
    v_mfma_f32_16x16x32_bf16 v[72:75], a[208:211], v[56:59], v[72:75]
    v_and_or_b32 v80, v80, -2, s32
    v_mfma_f32_16x16x32_bf16 v[72:75], a[212:215], v[60:63], v[72:75]
    v_cvt_pk_bf16_f32 v82, v68, v69
    v_mfma_f32_16x16x32_bf16 v[76:79], a[216:219], v[40:43], 0
    v_cvt_pk_bf16_f32 v83, v70, v71
    v_mfma_f32_16x16x32_bf16 v[76:79], a[220:223], v[44:47], v[76:79]
    buffer_store_dwordx4 v[80:83], v5, s[4:7], s34 offen offset:256
    v_mfma_f32_16x16x32_bf16 v[76:79], a[224:227], v[48:51], v[76:79]
    v_mfma_f32_16x16x32_bf16 v[76:79], a[228:231], v[52:55], v[76:79]
    v_mfma_f32_16x16x32_bf16 v[76:79], a[232:235], v[56:59], v[76:79]
    v_mfma_f32_16x16x32_bf16 v[76:79], a[236:239], v[60:63], v[76:79]
    v_cvt_pk_bf16_f32 v84, v72, v73
    v_cvt_pk_bf16_f32 v85, v74, v75
    v_and_or_b32 v84, v84, -2, s32
    s_nop 4
    v_cvt_pk_bf16_f32 v86, v76, v77
    v_cvt_pk_bf16_f32 v87, v78, v79
    buffer_store_dwordx4 v[84:87], v5, s[4:7], s35 offen offset:256
    s_mul_i32 s27, s12, 3072
    v_add_u32 v160, s27, v4
    s_waitcnt vmcnt(0)
    buffer_load_dwordx4 v[88:91], v6, s[4:7], s36 offen offset:0 sc1
    buffer_load_dwordx4 v[92:95], v6, s[4:7], s37 offen offset:0 sc1
    buffer_load_dwordx4 v[96:99], v6, s[4:7], s36 offen offset:256 sc1
    buffer_load_dwordx4 v[100:103], v6, s[4:7], s37 offen offset:256 sc1
    buffer_load_dwordx4 v[104:107], v6, s[4:7], s36 offen offset:512 sc1
    buffer_load_dwordx4 v[108:111], v6, s[4:7], s37 offen offset:512 sc1
    buffer_load_dwordx4 v[112:115], v6, s[4:7], s36 offen offset:768 sc1
    buffer_load_dwordx4 v[116:119], v6, s[4:7], s37 offen offset:768 sc1
    buffer_load_dwordx4 v[120:123], v6, s[4:7], s36 offen offset:1024 sc1
    buffer_load_dwordx4 v[124:127], v6, s[4:7], s37 offen offset:1024 sc1
    s_mov_b32 s19, 0
L_Of_red_4:
    s_waitcnt vmcnt(9)
    v_mfma_f32_16x16x32_bf16 v[128:131], a[240:243], v[88:91], 0
    v_xor_b32 v14, s33, v88
    s_waitcnt vmcnt(8)
    v_mfma_f32_16x16x32_bf16 v[128:131], a[240:243], v[92:95], v[128:131]
    v_bitop3_b32 v14, v14, v92, s33 bitop3:0xf6
    s_waitcnt vmcnt(7)
    v_mfma_f32_16x16x32_bf16 v[128:131], a[244:247], v[96:99], v[128:131]
    v_bitop3_b32 v14, v14, v96, s33 bitop3:0xf6
    s_waitcnt vmcnt(6)
    v_mfma_f32_16x16x32_bf16 v[128:131], a[244:247], v[100:103], v[128:131]
    v_bitop3_b32 v14, v14, v100, s33 bitop3:0xf6
    s_waitcnt vmcnt(5)
    v_mfma_f32_16x16x32_bf16 v[132:135], a[240:243], v[104:107], 0
    v_bitop3_b32 v14, v14, v104, s33 bitop3:0xf6
    s_waitcnt vmcnt(4)
    v_mfma_f32_16x16x32_bf16 v[132:135], a[240:243], v[108:111], v[132:135]
    v_bitop3_b32 v14, v14, v108, s33 bitop3:0xf6
    s_waitcnt vmcnt(3)
    v_mfma_f32_16x16x32_bf16 v[132:135], a[244:247], v[112:115], v[132:135]
    v_bitop3_b32 v14, v14, v112, s33 bitop3:0xf6
    s_waitcnt vmcnt(2)
    v_mfma_f32_16x16x32_bf16 v[132:135], a[244:247], v[116:119], v[132:135]
    v_bitop3_b32 v14, v14, v116, s33 bitop3:0xf6
    s_waitcnt vmcnt(1)
    v_mfma_f32_16x16x32_bf16 v[136:139], a[240:243], v[120:123], 0
    v_bitop3_b32 v14, v14, v120, s33 bitop3:0xf6
    s_waitcnt vmcnt(0)
    v_mfma_f32_16x16x32_bf16 v[136:139], a[240:243], v[124:127], v[136:139]
    v_bitop3_b32 v14, v14, v124, s33 bitop3:0xf6
    v_and_b32 v14, 1, v14
    v_cmp_ne_u32 vcc, 0, v14
    s_nop 0
    s_cbranch_vccnz L_Of_redfix_5
    ds_write_b128 v160, v[128:131] offset:24576
    ds_write_b128 v160, v[132:135] offset:25600
    s_nop 0
    ds_write_b128 v160, v[136:139] offset:26624
    s_sub_u32 s30, 36864, s30
    v_add_u32 v1, s31, v1
    v_add_u32 v2, s31, v2
    v_add_u32 v3, s31, v3
    s_sub_u32 s31, 0, s31
    s_add_u32 s36, s36, s26
    s_add_u32 s37, s37, s26
    s_add_u32 s34, s34, s26
    s_add_u32 s35, s35, s26
    s_sub_u32 s26, 0, s26
    s_add_u32 s22, s22, 1
    s_add_u32 s23, s23, 1
    s_waitcnt lgkmcnt(0)
    s_barrier
    s_cmp_lg_u32 s12, 0
    s_cbranch_scc1 L_Of_nofin_6
    ds_read_b128 v[16:19], v4 offset:24576
    ds_read_b128 v[20:23], v4 offset:25600
    ds_read_b128 v[24:27], v4 offset:26624
    ds_read_b128 v[28:31], v4 offset:27648
    ds_read_b128 v[32:35], v4 offset:28672
    ds_read_b128 v[36:39], v4 offset:29696
    ds_read_b128 v[40:43], v4 offset:30720
    ds_read_b128 v[44:47], v4 offset:31744
    ds_read_b128 v[48:51], v4 offset:32768
    ds_read_b128 v[52:55], v4 offset:33792
    ds_read_b128 v[56:59], v4 offset:34816
    ds_read_b128 v[60:63], v4 offset:35840
    s_waitcnt lgkmcnt(6)
    v_pk_add_f32 v[16:17], v[16:17], v[28:29]
    v_pk_add_f32 v[18:19], v[18:19], v[30:31]
    v_pk_add_f32 v[20:21], v[20:21], v[32:33]
    v_pk_add_f32 v[22:23], v[22:23], v[34:35]
    v_pk_add_f32 v[24:25], v[24:25], v[36:37]
    v_pk_add_f32 v[26:27], v[26:27], v[38:39]
    s_waitcnt lgkmcnt(3)
    v_pk_add_f32 v[16:17], v[16:17], v[40:41]
    v_pk_add_f32 v[18:19], v[18:19], v[42:43]
    v_pk_add_f32 v[20:21], v[20:21], v[44:45]
    v_pk_add_f32 v[22:23], v[22:23], v[46:47]
    v_pk_add_f32 v[24:25], v[24:25], v[48:49]
    v_pk_add_f32 v[26:27], v[26:27], v[50:51]
    s_waitcnt lgkmcnt(0)
    v_pk_add_f32 v[16:17], v[16:17], v[52:53]
    v_pk_add_f32 v[18:19], v[18:19], v[54:55]
    v_pk_add_f32 v[20:21], v[20:21], v[56:57]
    v_pk_add_f32 v[22:23], v[22:23], v[58:59]
    v_pk_add_f32 v[24:25], v[24:25], v[60:61]
    v_pk_add_f32 v[26:27], v[26:27], v[62:63]
    v_cvt_pk_bf16_f32 v146, v16, v17
    v_cvt_pk_bf16_f32 v147, v18, v19
    v_cvt_pk_bf16_f32 v148, v20, v21
    v_cvt_pk_bf16_f32 v149, v22, v23
    v_cvt_pk_bf16_f32 v150, v24, v25
    v_cvt_pk_bf16_f32 v151, v26, v27
    v_lshlrev_b32 v16, 16, v146
    v_and_b32 v17, 0xffff0000, v146
    v_lshlrev_b32 v18, 16, v147
    v_and_b32 v19, 0xffff0000, v147
    v_lshlrev_b32 v20, 16, v148
    v_and_b32 v21, 0xffff0000, v148
    v_lshlrev_b32 v22, 16, v149
    v_and_b32 v23, 0xffff0000, v149
    v_lshlrev_b32 v24, 16, v150
    v_and_b32 v25, 0xffff0000, v150
    v_lshlrev_b32 v26, 16, v151
    v_and_b32 v27, 0xffff0000, v151
    v_lshlrev_b32 v28, 16, v208
    v_and_b32 v29, 0xffff0000, v208
    v_lshlrev_b32 v30, 16, v209
    v_and_b32 v31, 0xffff0000, v209
    v_lshlrev_b32 v32, 16, v210
    v_and_b32 v33, 0xffff0000, v210
    v_lshlrev_b32 v34, 16, v211
    v_and_b32 v35, 0xffff0000, v211
    v_lshlrev_b32 v36, 16, v212
    v_and_b32 v37, 0xffff0000, v212
    v_lshlrev_b32 v38, 16, v213
    v_and_b32 v39, 0xffff0000, v213
    v_pk_add_f32 v[16:17], v[16:17], v[28:29]
    v_pk_add_f32 v[18:19], v[18:19], v[30:31]
    v_pk_add_f32 v[20:21], v[20:21], v[32:33]
    v_pk_add_f32 v[22:23], v[22:23], v[34:35]
    v_pk_add_f32 v[24:25], v[24:25], v[36:37]
    v_pk_add_f32 v[26:27], v[26:27], v[38:39]
    v_cndmask_b32 v24, 0, v24, s[62:63]
    v_cndmask_b32 v25, 0, v25, s[62:63]
    v_cndmask_b32 v26, 0, v26, s[62:63]
    v_cndmask_b32 v27, 0, v27, s[62:63]
    v_cvt_pk_bf16_f32 v146, v16, v17
    v_cvt_pk_bf16_f32 v147, v18, v19
    v_cvt_pk_bf16_f32 v148, v20, v21
    v_cvt_pk_bf16_f32 v149, v22, v23
    v_cvt_pk_bf16_f32 v150, v24, v25
    v_cvt_pk_bf16_f32 v151, v26, v27
    v_lshlrev_b32 v16, 16, v146
    v_and_b32 v17, 0xffff0000, v146
    v_lshlrev_b32 v18, 16, v147
    v_and_b32 v19, 0xffff0000, v147
    v_lshlrev_b32 v20, 16, v148
    v_and_b32 v21, 0xffff0000, v148
    v_lshlrev_b32 v22, 16, v149
    v_and_b32 v23, 0xffff0000, v149
    v_lshlrev_b32 v24, 16, v150
    v_and_b32 v25, 0xffff0000, v150
    v_lshlrev_b32 v26, 16, v151
    v_and_b32 v27, 0xffff0000, v151
    v_mov_b32 v152, v146
    v_mov_b32 v153, v147
    v_mov_b32 v154, v148
    v_mov_b32 v155, v149
    v_mov_b32 v156, v150
    v_mov_b32 v157, v151
    v_mov_b32 v158, v150
    v_mov_b32 v159, v151
    v_permlane16_swap_b32 v152, v154
    v_permlane16_swap_b32 v153, v155
    v_permlane16_swap_b32 v156, v158
    v_permlane16_swap_b32 v157, v159
    buffer_store_dwordx4 v[152:155], v9, s[4:7], s40 offen sc1
    s_mov_b64 exec, 0xffff
    buffer_store_dwordx4 v[156:159], v9, s[4:7], s40 offen offset:1024 sc1
    s_mov_b64 exec, -1
    v_pk_add_f32 v[32:33], v[16:17], v[18:19]
    v_pk_add_f32 v[32:33], v[32:33], v[20:21]
    v_pk_add_f32 v[32:33], v[32:33], v[22:23]
    v_pk_add_f32 v[32:33], v[32:33], v[24:25]
    v_pk_add_f32 v[32:33], v[32:33], v[26:27]
    v_add_f32 v28, v32, v33
    s_nop 1
    v_add_f32_dpp v28, v28, v28 quad_perm:[1,0,3,2] row_mask:0xf bank_mask:0xf
    s_nop 1
    v_add_f32_dpp v28, v28, v28 quad_perm:[2,3,0,1] row_mask:0xf bank_mask:0xf
    s_nop 1
    v_add_f32_dpp v28, v28, v28 row_half_mirror row_mask:0xf bank_mask:0xf
    s_nop 1
    v_add_f32_dpp v28, v28, v28 row_mirror row_mask:0xf bank_mask:0xf
    v_mov_b32 v29, v28
    s_nop 1
    v_permlane16_swap_b32 v28, v29
    v_add_f32 v28, v28, v29
    v_mov_b32 v29, v28
    s_nop 1
    v_permlane32_swap_b32 v28, v29
    v_add_f32 v28, v28, v29
    v_mul_f32 v30, 1.5625000000e-03, v28
    v_sub_f32 v32, v16, v30
    v_sub_f32 v33, v17, v30
    v_sub_f32 v34, v18, v30
    v_sub_f32 v35, v19, v30
    v_sub_f32 v36, v20, v30
    v_sub_f32 v37, v21, v30
    v_sub_f32 v38, v22, v30
    v_sub_f32 v39, v23, v30
    v_sub_f32 v40, v24, v30
    v_sub_f32 v41, v25, v30
    v_sub_f32 v42, v26, v30
    v_sub_f32 v43, v27, v30
    v_cndmask_b32 v40, 0, v40, s[62:63]
    v_cndmask_b32 v41, 0, v41, s[62:63]
    v_cndmask_b32 v42, 0, v42, s[62:63]
    v_cndmask_b32 v43, 0, v43, s[62:63]
    v_mul_f32 v28, v32, v32
    v_fmac_f32 v28, v33, v33
    v_fmac_f32 v28, v34, v34
    v_fmac_f32 v28, v35, v35
    v_fmac_f32 v28, v36, v36
    v_fmac_f32 v28, v37, v37
    v_fmac_f32 v28, v38, v38
    v_fmac_f32 v28, v39, v39
    v_fmac_f32 v28, v40, v40
    v_fmac_f32 v28, v41, v41
    v_fmac_f32 v28, v42, v42
    v_fmac_f32 v28, v43, v43
    s_nop 1
    v_add_f32_dpp v28, v28, v28 quad_perm:[1,0,3,2] row_mask:0xf bank_mask:0xf
    s_nop 1
    v_add_f32_dpp v28, v28, v28 quad_perm:[2,3,0,1] row_mask:0xf bank_mask:0xf
    s_nop 1
    v_add_f32_dpp v28, v28, v28 row_half_mirror row_mask:0xf bank_mask:0xf
    s_nop 1
    v_add_f32_dpp v28, v28, v28 row_mirror row_mask:0xf bank_mask:0xf
    v_mov_b32 v29, v28
    s_nop 1
    v_permlane16_swap_b32 v28, v29
    v_add_f32 v28, v28, v29
    v_mov_b32 v29, v28
    s_nop 1
    v_permlane32_swap_b32 v28, v29
    v_add_f32 v28, v28, v29
    v_mul_f32 v28, 1.5625000000e-03, v28
    v_cvt_pk_bf16_f32 v29, v28, v30
    v_lshlrev_b32 v28, 16, v29
    v_and_b32 v30, 0xffff0000, v29
    v_add_f32 v28, 0x3727c5ac, v28
    v_cvt_pk_bf16_f32 v29, v28, v28
    v_lshlrev_b32 v28, 16, v29
    v_sqrt_f32 v28, v28
    v_sub_f32 v32, v16, v30
    v_sub_f32 v33, v17, v30
    v_sub_f32 v34, v18, v30
    v_sub_f32 v35, v19, v30
    v_sub_f32 v36, v20, v30
    v_sub_f32 v37, v21, v30
    v_sub_f32 v38, v22, v30
    v_sub_f32 v39, v23, v30
    v_sub_f32 v40, v24, v30
    v_sub_f32 v41, v25, v30
    v_sub_f32 v42, v26, v30
    v_sub_f32 v43, v27, v30
    v_cvt_pk_bf16_f32 v29, v28, v28
    v_lshlrev_b32 v28, 16, v29
    v_rcp_f32 v28, v28
    v_cvt_pk_bf16_f32 v146, v32, v33
    v_cvt_pk_bf16_f32 v147, v34, v35
    v_cvt_pk_bf16_f32 v148, v36, v37
    v_cvt_pk_bf16_f32 v149, v38, v39
    v_cvt_pk_bf16_f32 v150, v40, v41
    v_cvt_pk_bf16_f32 v151, v42, v43
    v_lshlrev_b32 v32, 16, v146
    v_and_b32 v33, 0xffff0000, v146
    v_lshlrev_b32 v34, 16, v147
    v_and_b32 v35, 0xffff0000, v147
    v_lshlrev_b32 v36, 16, v148
    v_and_b32 v37, 0xffff0000, v148
    v_lshlrev_b32 v38, 16, v149
    v_and_b32 v39, 0xffff0000, v149
    v_lshlrev_b32 v40, 16, v150
    v_and_b32 v41, 0xffff0000, v150
    v_lshlrev_b32 v42, 16, v151
    v_and_b32 v43, 0xffff0000, v151
    v_mul_f32 v32, v32, v28
    v_mul_f32 v33, v33, v28
    v_mul_f32 v34, v34, v28
    v_mul_f32 v35, v35, v28
    v_mul_f32 v36, v36, v28
    v_mul_f32 v37, v37, v28
    v_mul_f32 v38, v38, v28
    v_mul_f32 v39, v39, v28
    v_mul_f32 v40, v40, v28
    v_mul_f32 v41, v41, v28
    v_mul_f32 v42, v42, v28
    v_mul_f32 v43, v43, v28
    v_cvt_pk_bf16_f32 v146, v32, v33
    v_cvt_pk_bf16_f32 v147, v34, v35
    v_cvt_pk_bf16_f32 v148, v36, v37
    v_cvt_pk_bf16_f32 v149, v38, v39
    v_cvt_pk_bf16_f32 v150, v40, v41
    v_cvt_pk_bf16_f32 v151, v42, v43
    v_mov_b32 v152, v146
    v_mov_b32 v153, v147
    v_mov_b32 v154, v148
    v_mov_b32 v155, v149
    v_mov_b32 v156, v150
    v_mov_b32 v157, v151
    v_mov_b32 v158, v150
    v_mov_b32 v159, v151
    v_permlane16_swap_b32 v152, v154
    v_permlane16_swap_b32 v153, v155
    v_permlane16_swap_b32 v156, v158
    v_permlane16_swap_b32 v157, v159
    buffer_store_dwordx4 v[152:155], v9, s[4:7], s41 offen sc1
    s_mov_b64 exec, 0xffff
    buffer_store_dwordx4 v[156:159], v9, s[4:7], s41 offen offset:1024 sc1
    s_mov_b64 exec, -1
L_Of_nofin_6:
    s_add_u32 s39, s39, 40960
    s_add_u32 s40, s40, 40960
    s_add_u32 s41, s41, 40960
    s_cmp_lt_u32 s22, 64
    s_cbranch_scc1 L_Of_top
    s_waitcnt vmcnt(0)
    s_cmp_lg_u32 s12, 0
    s_cbranch_scc1 L_Of_nofin_6x
    v_mov_b32 v13, s22
    s_mov_b64 exec, 1
    buffer_store_dword v13, v0, s[4:7], s24 offen offset:0 sc1
    s_mov_b64 exec, -1
L_Of_nofin_6x:
    s_waitcnt vmcnt(0)
    s_endpgm
L_Of_flspin_3:
    buffer_load_dword v12, v10, s[4:7], s25 offen sc1
    s_add_u32 s19, s19, 1
    s_cmp_ge_u32 s19, 524288
    s_cbranch_scc1 L_fail
    s_waitcnt vmcnt(0)
    v_cmp_gt_u32 vcc, s23, v12
    s_nop 0
    s_cbranch_vccnz L_Of_flspin_3
    s_branch L_Of_fl_2
L_Of_redfix_5:
    buffer_load_dwordx4 v[88:91], v6, s[4:7], s36 offen offset:0 sc1
    buffer_load_dwordx4 v[92:95], v6, s[4:7], s37 offen offset:0 sc1
    buffer_load_dwordx4 v[96:99], v6, s[4:7], s36 offen offset:256 sc1
    buffer_load_dwordx4 v[100:103], v6, s[4:7], s37 offen offset:256 sc1
    buffer_load_dwordx4 v[104:107], v6, s[4:7], s36 offen offset:512 sc1
    buffer_load_dwordx4 v[108:111], v6, s[4:7], s37 offen offset:512 sc1
    buffer_load_dwordx4 v[112:115], v6, s[4:7], s36 offen offset:768 sc1
    buffer_load_dwordx4 v[116:119], v6, s[4:7], s37 offen offset:768 sc1
    buffer_load_dwordx4 v[120:123], v6, s[4:7], s36 offen offset:1024 sc1
    buffer_load_dwordx4 v[124:127], v6, s[4:7], s37 offen offset:1024 sc1
    s_add_u32 s19, s19, 1
    s_cmp_lt_u32 s19, 524288
    s_cbranch_scc1 L_Of_red_4
    s_branch L_fail
L_O_slow:
L_Os_top:
    buffer_load_dword v12, v10, s[4:7], s25 offen sc1
    ds_read_b128 v[16:19], v1 offset:0
    ds_read_b128 v[40:43], v2 offset:0
    ds_read_b128 v[64:67], v2 offset:3072
    ds_read_b128 v[20:23], v1 offset:1024
    ds_read_b128 v[44:47], v2 offset:1024
    ds_read_b128 v[68:71], v2 offset:4096
    ds_read_b128 v[24:27], v1 offset:2048
    ds_read_b128 v[48:51], v2 offset:2048
    ds_read_b128 v[72:75], v2 offset:5120
    ds_read_b128 v[28:31], v1 offset:3072
    ds_read_b128 v[52:55], v2 offset:12288
    ds_read_b128 v[76:79], v2 offset:15360
    ds_read_b128 v[32:35], v1 offset:4096
    ds_read_b128 v[56:59], v2 offset:13312
    ds_read_b128 v[80:83], v2 offset:16384
    ds_read_b128 v[36:39], v1 offset:5120
    ds_read_b128 v[60:63], v2 offset:14336
    ds_read_b128 v[84:87], v2 offset:17408
    s_waitcnt lgkmcnt(15)
    v_mfma_f32_16x16x32_bf16 v[152:155], v[40:43], v[16:19], 0
    v_mfma_f32_16x16x32_bf16 v[156:159], v[64:67], v[16:19], 0
    s_waitcnt lgkmcnt(12)
    v_mfma_f32_16x16x32_bf16 v[152:155], v[44:47], v[20:23], v[152:155]
    v_mfma_f32_16x16x32_bf16 v[156:159], v[68:71], v[20:23], v[156:159]
    s_waitcnt lgkmcnt(9)
    v_mfma_f32_16x16x32_bf16 v[152:155], v[48:51], v[24:27], v[152:155]
    v_mfma_f32_16x16x32_bf16 v[156:159], v[72:75], v[24:27], v[156:159]
    s_waitcnt lgkmcnt(6)
    v_mfma_f32_16x16x32_bf16 v[152:155], v[52:55], v[28:31], v[152:155]
    v_mfma_f32_16x16x32_bf16 v[156:159], v[76:79], v[28:31], v[156:159]
    s_waitcnt lgkmcnt(3)
    v_mfma_f32_16x16x32_bf16 v[152:155], v[56:59], v[32:35], v[152:155]
    v_mfma_f32_16x16x32_bf16 v[156:159], v[80:83], v[32:35], v[156:159]
    s_waitcnt lgkmcnt(0)
    v_mfma_f32_16x16x32_bf16 v[152:155], v[60:63], v[36:39], v[152:155]
    v_mfma_f32_16x16x32_bf16 v[156:159], v[84:87], v[36:39], v[156:159]
    ds_read_b128 v[112:115], v3 offset:0
    ds_read_b128 v[116:119], v3 offset:1024
    ds_read_b128 v[120:123], v3 offset:2048
    ds_read_b128 v[124:127], v3 offset:3072
    ds_read_b128 v[128:131], v3 offset:4096
    ds_read_b128 v[132:135], v3 offset:5120
    s_lshr_b32 s27, s22, 1
    s_andn2_b32 s32, 1, s27
    s_sub_u32 s33, 0, s32
    s_sub_u32 s27, s23, 1
    s_lshl_b32 s27, s27, 5
    s_add_u32 s27, s27, s21
    s_lshl_b32 s27, s27, 2
    s_add_u32 s27, s27, s12
    s_mul_i32 s27, s27, 3072
    s_add_u32 s27, s27, 5898240
    s_mul_i32 s28, s12, 3072
    s_add_u32 m0, s28, 73728
    v_cvt_pk_bf16_f32 v162, v152, v153
    v_cvt_pk_bf16_f32 v163, v154, v155
    v_cvt_pk_bf16_f32 v164, v156, v157
    v_cvt_pk_bf16_f32 v165, v158, v159
    v_lshlrev_b32 v152, 16, v162
    v_and_b32 v153, 0xffff0000, v162
    v_lshlrev_b32 v154, 16, v163
    v_and_b32 v155, 0xffff0000, v163
    v_lshlrev_b32 v156, 16, v164
    v_and_b32 v157, 0xffff0000, v164
    v_lshlrev_b32 v158, 16, v165
    v_and_b32 v159, 0xffff0000, v165
    v_mul_f32 v152, s42, v152
    v_mul_f32 v153, s42, v153
    v_mul_f32 v154, s42, v154
    v_mul_f32 v155, s42, v155
    v_mul_f32 v156, s42, v156
    v_mul_f32 v157, s42, v157
    v_mul_f32 v158, s42, v158
    v_mul_f32 v159, s42, v159
    v_cvt_pk_bf16_f32 v162, v152, v153
    v_cvt_pk_bf16_f32 v163, v154, v155
    v_cvt_pk_bf16_f32 v164, v156, v157
    v_cvt_pk_bf16_f32 v165, v158, v159
    v_lshlrev_b32 v152, 16, v162
    v_and_b32 v153, 0xffff0000, v162
    v_lshlrev_b32 v154, 16, v163
    v_and_b32 v155, 0xffff0000, v163
    v_lshlrev_b32 v156, 16, v164
    v_and_b32 v157, 0xffff0000, v164
    v_lshlrev_b32 v158, 16, v165
    v_and_b32 v159, 0xffff0000, v165
    v_mov_b32 v14, 0xff800000
    v_cndmask_b32 v152, v14, v152, s[46:47]
    v_cndmask_b32 v153, v14, v153, s[48:49]
    v_cndmask_b32 v154, v14, v154, s[50:51]
    v_cndmask_b32 v155, v14, v155, s[52:53]
    v_cndmask_b32 v156, v14, v156, s[54:55]
    v_cndmask_b32 v157, v14, v157, s[56:57]
    v_cndmask_b32 v158, v14, v158, s[58:59]
    v_cndmask_b32 v159, v14, v159, s[60:61]
    s_waitcnt vmcnt(0)
    s_cmp_lg_u32 s12, 0
    s_cbranch_scc1 L_Os_noflag_1
    v_mov_b32 v13, s22
    s_mov_b64 exec, 1
    buffer_store_dword v13, v0, s[4:7], s24 offen offset:0 sc1
    s_mov_b64 exec, -1
L_Os_noflag_1:
    s_mov_b32 s19, 0
    v_cmp_gt_u32 vcc, s23, v12
    s_nop 0
    s_cbranch_vccnz L_Os_flspin_3
L_Os_fl_2:
    buffer_load_dwordx4 v0, s[4:7], s27 offen offset:0 sc1 lds
    buffer_load_dwordx4 v0, s[4:7], s27 offen offset:1024 sc1 lds
    buffer_load_dwordx4 v0, s[4:7], s27 offen offset:2048 sc1 lds
    buffer_load_dwordx2 v[208:209], v8, s[92:95], s39 offen offset:0 sc1
    buffer_load_dwordx2 v[210:211], v8, s[92:95], s39 offen offset:512 sc1
    s_mov_b64 exec, s[62:63]
    buffer_load_dwordx2 v[212:213], v8, s[92:95], s39 offen offset:1024 sc1
    s_mov_b64 exec, -1
    s_waitcnt vmcnt(3) lgkmcnt(0)
    s_barrier
    ds_read_b128 v[88:91], v4 offset:0
    ds_read_b128 v[92:95], v4 offset:1024
    ds_read_b128 v[96:99], v4 offset:2048
    ds_read_b128 v[100:103], v4 offset:6144
    ds_read_b128 v[104:107], v4 offset:7168
    ds_read_b128 v[108:111], v4 offset:8192
    ds_read_b128 v[136:139], v15 offset:3072
    ds_read_b128 v[140:143], v15 offset:4096
    ds_read_b128 v[144:147], v15 offset:5120
    s_add_u32 s27, s22, 1
    s_min_u32 s27, s27, 63
    s_lshl_b32 s28, s20, 6
    s_add_u32 s27, s27, s28
    s_lshl_b32 s27, s27, 5
    s_add_u32 s27, s27, s21
    s_lshl_b32 s27, s27, 2
    s_add_u32 s27, s27, s12
    s_mul_i32 s28, s27, 3072
    s_add_u32 s28, s28, 138018816
    s_mul_i32 s27, s27, 6144
    s_add_u32 s27, s27, 37355520
    s_mul_i32 s29, s12, 3072
    s_add_u32 m0, s29, s30
    s_nop 0
    buffer_load_dwordx4 v0, s[4:7], s28 offen offset:0 sc1 lds
    buffer_load_dwordx4 v0, s[4:7], s28 offen offset:1024 sc1 lds
    buffer_load_dwordx4 v0, s[4:7], s28 offen offset:2048 sc1 lds
    s_lshl_b32 s29, s29, 1
    s_add_u32 s29, s29, s30
    s_add_u32 m0, s29, 12288
    s_nop 0
    buffer_load_dwordx4 v0, s[4:7], s27 offen offset:0 sc1 lds
    buffer_load_dwordx4 v0, s[4:7], s27 offen offset:1024 sc1 lds
    buffer_load_dwordx4 v0, s[4:7], s27 offen offset:2048 sc1 lds
    s_add_u32 s27, s27, 3072
    s_add_u32 m0, s29, 15360
    s_nop 0
    buffer_load_dwordx4 v0, s[4:7], s27 offen offset:0 sc1 lds
    buffer_load_dwordx4 v0, s[4:7], s27 offen offset:1024 sc1 lds
    buffer_load_dwordx4 v0, s[4:7], s27 offen offset:2048 sc1 lds
    s_waitcnt lgkmcnt(8)
    v_mfma_f32_16x16x32_bf16 v[148:151], v[88:91], v[16:19], 0
    s_waitcnt lgkmcnt(7)
    v_mfma_f32_16x16x32_bf16 v[148:151], v[92:95], v[20:23], v[148:151]
    s_waitcnt lgkmcnt(6)
    v_mfma_f32_16x16x32_bf16 v[148:151], v[96:99], v[24:27], v[148:151]
    s_waitcnt lgkmcnt(5)
    v_mfma_f32_16x16x32_bf16 v[148:151], v[100:103], v[28:31], v[148:151]
    s_waitcnt lgkmcnt(4)
    v_mfma_f32_16x16x32_bf16 v[148:151], v[104:107], v[32:35], v[148:151]
    s_waitcnt lgkmcnt(3)
    v_mfma_f32_16x16x32_bf16 v[148:151], v[108:111], v[36:39], v[148:151]
    v_max3_f32 v161, v152, v153, v154
    v_max3_f32 v161, v161, v155, v156
    v_max3_f32 v161, v161, v157, v158
    v_max_f32 v161, v161, v159
    s_nop 3
    v_cvt_pk_bf16_f32 v162, v148, v149
    v_cvt_pk_bf16_f32 v163, v150, v151
    v_lshlrev_b32 v148, 16, v162
    v_and_b32 v149, 0xffff0000, v162
    v_lshlrev_b32 v150, 16, v163
    v_and_b32 v151, 0xffff0000, v163
    v_mul_f32 v148, s42, v148
    v_mul_f32 v149, s42, v149
    v_mul_f32 v150, s42, v150
    v_mul_f32 v151, s42, v151
    v_cvt_pk_bf16_f32 v162, v148, v149
    v_cvt_pk_bf16_f32 v163, v150, v151
    v_lshlrev_b32 v148, 16, v162
    v_and_b32 v149, 0xffff0000, v162
    v_lshlrev_b32 v150, 16, v163
    v_and_b32 v151, 0xffff0000, v163
    v_cndmask_b32 v148, v14, v148, s[44:45]
    v_cndmask_b32 v149, v14, v149, s[44:45]
    v_cndmask_b32 v150, v14, v150, s[44:45]
    v_cndmask_b32 v151, v14, v151, s[44:45]
    v_max3_f32 v160, v148, v149, v161
    v_max3_f32 v160, v150, v151, v160
    v_mov_b32 v161, v160
    s_nop 1
    v_permlane32_swap_b32 v160, v161
    v_max_f32 v160, v160, v161
    v_mov_b32 v161, v160
    s_nop 1
    v_permlane16_swap_b32 v160, v161
    v_max_f32 v160, v160, v161
    v_mul_f32 v160, s43, v160
    v_fma_f32 v148, v148, s43, -v160
    v_fma_f32 v149, v149, s43, -v160
    v_fma_f32 v150, v150, s43, -v160
    v_fma_f32 v151, v151, s43, -v160
    v_fma_f32 v152, v152, s43, -v160
    v_fma_f32 v153, v153, s43, -v160
    v_fma_f32 v154, v154, s43, -v160
    v_fma_f32 v155, v155, s43, -v160
    v_fma_f32 v156, v156, s43, -v160
    v_fma_f32 v157, v157, s43, -v160
    v_fma_f32 v158, v158, s43, -v160
    v_fma_f32 v159, v159, s43, -v160
    v_exp_f32 v148, v148
    v_exp_f32 v149, v149
    v_exp_f32 v150, v150
    v_exp_f32 v151, v151
    v_exp_f32 v152, v152
    v_exp_f32 v153, v153
    v_exp_f32 v154, v154
    v_exp_f32 v155, v155
    v_exp_f32 v156, v156
    v_exp_f32 v157, v157
    v_exp_f32 v158, v158
    v_exp_f32 v159, v159
    v_pk_add_f32 v[160:161], v[148:149], v[150:151]
    v_pk_add_f32 v[160:161], v[160:161], v[152:153]
    v_pk_add_f32 v[160:161], v[160:161], v[154:155]
    v_pk_add_f32 v[160:161], v[160:161], v[156:157]
    v_pk_add_f32 v[160:161], v[160:161], v[158:159]
    v_add_f32 v160, v160, v161
    v_mov_b32 v161, v160
    s_nop 1
    v_permlane32_swap_b32 v160, v161
    v_add_f32 v160, v160, v161
    v_mov_b32 v161, v160
    s_nop 1
    v_permlane16_swap_b32 v160, v161
    v_add_f32 v160, v160, v161
    v_rcp_f32 v160, v160
    s_nop 0
    v_pk_mul_f32 v[148:149], v[148:149], v[160:161] op_sel_hi:[1,0]
    v_pk_mul_f32 v[150:151], v[150:151], v[160:161] op_sel_hi:[1,0]
    v_pk_mul_f32 v[152:153], v[152:153], v[160:161] op_sel_hi:[1,0]
    v_pk_mul_f32 v[154:155], v[154:155], v[160:161] op_sel_hi:[1,0]
    v_pk_mul_f32 v[156:157], v[156:157], v[160:161] op_sel_hi:[1,0]
    v_pk_mul_f32 v[158:159], v[158:159], v[160:161] op_sel_hi:[1,0]
    v_cvt_pk_bf16_f32 v164, v148, v149
    v_cvt_pk_bf16_f32 v165, v150, v151
    v_cvt_pk_bf16_f32 v166, v152, v153
    v_cvt_pk_bf16_f32 v167, v154, v155
    v_cvt_pk_bf16_f32 v168, v156, v157
    v_cvt_pk_bf16_f32 v169, v158, v159
    s_waitcnt lgkmcnt(0)
    v_mfma_f32_16x16x16_bf16 v[170:173], v[136:137], v[164:165], 0
    v_mfma_f32_16x16x16_bf16 v[174:177], v[138:139], v[164:165], 0
    v_mfma_f32_16x16x16_bf16 v[178:181], v[140:141], v[164:165], 0
    v_mfma_f32_16x16x16_bf16 v[182:185], v[142:143], v[164:165], 0
    v_mfma_f32_16x16x16_bf16 v[186:189], v[144:145], v[164:165], 0
    v_mfma_f32_16x16x16_bf16 v[190:193], v[146:147], v[164:165], 0
    s_nop 0
    v_mfma_f32_16x16x32_bf16 v[170:173], v[112:115], v[166:169], v[170:173]
    v_mfma_f32_16x16x32_bf16 v[174:177], v[116:119], v[166:169], v[174:177]
    v_mfma_f32_16x16x32_bf16 v[178:181], v[120:123], v[166:169], v[178:181]
    v_mfma_f32_16x16x32_bf16 v[182:185], v[124:127], v[166:169], v[182:185]
    v_mfma_f32_16x16x32_bf16 v[186:189], v[128:131], v[166:169], v[186:189]
    v_mfma_f32_16x16x32_bf16 v[190:193], v[132:135], v[166:169], v[190:193]
    s_lshr_b32 s27, s12, 1
    s_mul_i32 s27, s27, 3072
    s_and_b32 s28, s12, 1
    s_mul_i32 s28, s28, 6144
    s_add_u32 s27, s27, s28
    v_add_u32 v160, s27, v4
    v_cvt_pk_bf16_f32 v194, v170, v171
    v_cvt_pk_bf16_f32 v195, v172, v173
    v_cvt_pk_bf16_f32 v196, v174, v175
    v_cvt_pk_bf16_f32 v197, v176, v177
    ds_write_b128 v160, v[194:197] offset:12288
    v_cvt_pk_bf16_f32 v198, v178, v179
    v_cvt_pk_bf16_f32 v199, v180, v181
    v_cvt_pk_bf16_f32 v200, v182, v183
    v_cvt_pk_bf16_f32 v201, v184, v185
    ds_write_b128 v160, v[198:201] offset:13312
    v_cvt_pk_bf16_f32 v202, v186, v187
    v_cvt_pk_bf16_f32 v203, v188, v189
    v_cvt_pk_bf16_f32 v204, v190, v191
    v_cvt_pk_bf16_f32 v205, v192, v193
    ds_write_b128 v160, v[202:205] offset:14336
    s_waitcnt lgkmcnt(0)
    s_barrier
    ds_read_b128 v[16:19], v4 offset:12288
    ds_read_b128 v[20:23], v4 offset:13312
    ds_read_b128 v[24:27], v4 offset:14336
    ds_read_b128 v[28:31], v4 offset:15360
    ds_read_b128 v[32:35], v4 offset:16384
    ds_read_b128 v[36:39], v4 offset:17408
    ds_read_b128 v[40:43], v4 offset:18432
    ds_read_b128 v[44:47], v4 offset:19456
    ds_read_b128 v[48:51], v4 offset:20480
    ds_read_b128 v[52:55], v4 offset:21504
    ds_read_b128 v[56:59], v4 offset:22528
    ds_read_b128 v[60:63], v4 offset:23552
    s_waitcnt lgkmcnt(11)
    v_mfma_f32_16x16x32_bf16 v[64:67], a[0:3], v[16:19], 0
    s_waitcnt lgkmcnt(10)
    v_mfma_f32_16x16x32_bf16 v[64:67], a[4:7], v[20:23], v[64:67]
    s_waitcnt lgkmcnt(9)
    v_mfma_f32_16x16x32_bf16 v[64:67], a[8:11], v[24:27], v[64:67]
    s_waitcnt lgkmcnt(8)
    v_mfma_f32_16x16x32_bf16 v[64:67], a[12:15], v[28:31], v[64:67]
    s_waitcnt lgkmcnt(7)
    v_mfma_f32_16x16x32_bf16 v[64:67], a[16:19], v[32:35], v[64:67]
    s_waitcnt lgkmcnt(6)
    v_mfma_f32_16x16x32_bf16 v[64:67], a[20:23], v[36:39], v[64:67]
    v_mfma_f32_16x16x32_bf16 v[68:71], a[24:27], v[16:19], 0
    v_mfma_f32_16x16x32_bf16 v[68:71], a[28:31], v[20:23], v[68:71]
    v_mfma_f32_16x16x32_bf16 v[68:71], a[32:35], v[24:27], v[68:71]
    v_mfma_f32_16x16x32_bf16 v[68:71], a[36:39], v[28:31], v[68:71]
    v_mfma_f32_16x16x32_bf16 v[68:71], a[40:43], v[32:35], v[68:71]
    v_mfma_f32_16x16x32_bf16 v[68:71], a[44:47], v[36:39], v[68:71]
    s_waitcnt lgkmcnt(5)
    v_mfma_f32_16x16x32_bf16 v[72:75], a[0:3], v[40:43], 0
    s_waitcnt lgkmcnt(4)
    v_mfma_f32_16x16x32_bf16 v[72:75], a[4:7], v[44:47], v[72:75]
    s_waitcnt lgkmcnt(3)
    v_mfma_f32_16x16x32_bf16 v[72:75], a[8:11], v[48:51], v[72:75]
    v_cvt_pk_bf16_f32 v80, v64, v65
    s_waitcnt lgkmcnt(2)
    v_mfma_f32_16x16x32_bf16 v[72:75], a[12:15], v[52:55], v[72:75]
    v_cvt_pk_bf16_f32 v81, v66, v67
    s_waitcnt lgkmcnt(1)
    v_mfma_f32_16x16x32_bf16 v[72:75], a[16:19], v[56:59], v[72:75]
    v_and_or_b32 v80, v80, -2, s32
    s_waitcnt lgkmcnt(0)
    v_mfma_f32_16x16x32_bf16 v[72:75], a[20:23], v[60:63], v[72:75]
    v_cvt_pk_bf16_f32 v82, v68, v69
    v_mfma_f32_16x16x32_bf16 v[76:79], a[24:27], v[40:43], 0
    v_cvt_pk_bf16_f32 v83, v70, v71
    v_mfma_f32_16x16x32_bf16 v[76:79], a[28:31], v[44:47], v[76:79]
    buffer_store_dwordx4 v[80:83], v5, s[4:7], s34 offen offset:0 sc1
    v_mfma_f32_16x16x32_bf16 v[76:79], a[32:35], v[48:51], v[76:79]
    v_mfma_f32_16x16x32_bf16 v[76:79], a[36:39], v[52:55], v[76:79]
    v_mfma_f32_16x16x32_bf16 v[76:79], a[40:43], v[56:59], v[76:79]
    v_mfma_f32_16x16x32_bf16 v[76:79], a[44:47], v[60:63], v[76:79]
    v_mfma_f32_16x16x32_bf16 v[64:67], a[48:51], v[16:19], 0
    v_mfma_f32_16x16x32_bf16 v[64:67], a[52:55], v[20:23], v[64:67]
    v_mfma_f32_16x16x32_bf16 v[64:67], a[56:59], v[24:27], v[64:67]
    v_cvt_pk_bf16_f32 v84, v72, v73
    v_mfma_f32_16x16x32_bf16 v[64:67], a[60:63], v[28:31], v[64:67]
    v_cvt_pk_bf16_f32 v85, v74, v75
    v_mfma_f32_16x16x32_bf16 v[64:67], a[64:67], v[32:35], v[64:67]
    v_and_or_b32 v84, v84, -2, s32
    v_mfma_f32_16x16x32_bf16 v[64:67], a[68:71], v[36:39], v[64:67]
    v_cvt_pk_bf16_f32 v86, v76, v77
    v_mfma_f32_16x16x32_bf16 v[68:71], a[72:75], v[16:19], 0
    v_cvt_pk_bf16_f32 v87, v78, v79
    v_mfma_f32_16x16x32_bf16 v[68:71], a[76:79], v[20:23], v[68:71]
    buffer_store_dwordx4 v[84:87], v5, s[4:7], s35 offen offset:0 sc1
    v_mfma_f32_16x16x32_bf16 v[68:71], a[80:83], v[24:27], v[68:71]
    v_mfma_f32_16x16x32_bf16 v[68:71], a[84:87], v[28:31], v[68:71]
    v_mfma_f32_16x16x32_bf16 v[68:71], a[88:91], v[32:35], v[68:71]
    v_mfma_f32_16x16x32_bf16 v[68:71], a[92:95], v[36:39], v[68:71]
    v_mfma_f32_16x16x32_bf16 v[72:75], a[48:51], v[40:43], 0
    v_mfma_f32_16x16x32_bf16 v[72:75], a[52:55], v[44:47], v[72:75]
    v_mfma_f32_16x16x32_bf16 v[72:75], a[56:59], v[48:51], v[72:75]
    v_cvt_pk_bf16_f32 v80, v64, v65
    v_mfma_f32_16x16x32_bf16 v[72:75], a[60:63], v[52:55], v[72:75]
    v_cvt_pk_bf16_f32 v81, v66, v67
    v_mfma_f32_16x16x32_bf16 v[72:75], a[64:67], v[56:59], v[72:75]
    v_and_or_b32 v80, v80, -2, s32
    v_mfma_f32_16x16x32_bf16 v[72:75], a[68:71], v[60:63], v[72:75]
    v_cvt_pk_bf16_f32 v82, v68, v69
    v_mfma_f32_16x16x32_bf16 v[76:79], a[72:75], v[40:43], 0
    v_cvt_pk_bf16_f32 v83, v70, v71
    v_mfma_f32_16x16x32_bf16 v[76:79], a[76:79], v[44:47], v[76:79]
    buffer_store_dwordx4 v[80:83], v5, s[4:7], s34 offen offset:64 sc1
    v_mfma_f32_16x16x32_bf16 v[76:79], a[80:83], v[48:51], v[76:79]
    v_mfma_f32_16x16x32_bf16 v[76:79], a[84:87], v[52:55], v[76:79]
    v_mfma_f32_16x16x32_bf16 v[76:79], a[88:91], v[56:59], v[76:79]
    v_mfma_f32_16x16x32_bf16 v[76:79], a[92:95], v[60:63], v[76:79]
    v_mfma_f32_16x16x32_bf16 v[64:67], a[96:99], v[16:19], 0
    v_mfma_f32_16x16x32_bf16 v[64:67], a[100:103], v[20:23], v[64:67]
    v_mfma_f32_16x16x32_bf16 v[64:67], a[104:107], v[24:27], v[64:67]
    v_cvt_pk_bf16_f32 v84, v72, v73
    v_mfma_f32_16x16x32_bf16 v[64:67], a[108:111], v[28:31], v[64:67]
    v_cvt_pk_bf16_f32 v85, v74, v75
    v_mfma_f32_16x16x32_bf16 v[64:67], a[112:115], v[32:35], v[64:67]
    v_and_or_b32 v84, v84, -2, s32
    v_mfma_f32_16x16x32_bf16 v[64:67], a[116:119], v[36:39], v[64:67]
    v_cvt_pk_bf16_f32 v86, v76, v77
    v_mfma_f32_16x16x32_bf16 v[68:71], a[120:123], v[16:19], 0
    v_cvt_pk_bf16_f32 v87, v78, v79
    v_mfma_f32_16x16x32_bf16 v[68:71], a[124:127], v[20:23], v[68:71]
    buffer_store_dwordx4 v[84:87], v5, s[4:7], s35 offen offset:64 sc1
    v_mfma_f32_16x16x32_bf16 v[68:71], a[128:131], v[24:27], v[68:71]
    v_mfma_f32_16x16x32_bf16 v[68:71], a[132:135], v[28:31], v[68:71]
    v_mfma_f32_16x16x32_bf16 v[68:71], a[136:139], v[32:35], v[68:71]
    v_mfma_f32_16x16x32_bf16 v[68:71], a[140:143], v[36:39], v[68:71]
    v_mfma_f32_16x16x32_bf16 v[72:75], a[96:99], v[40:43], 0
    v_mfma_f32_16x16x32_bf16 v[72:75], a[100:103], v[44:47], v[72:75]
    v_mfma_f32_16x16x32_bf16 v[72:75], a[104:107], v[48:51], v[72:75]
    v_cvt_pk_bf16_f32 v80, v64, v65
    v_mfma_f32_16x16x32_bf16 v[72:75], a[108:111], v[52:55], v[72:75]
    v_cvt_pk_bf16_f32 v81, v66, v67
    v_mfma_f32_16x16x32_bf16 v[72:75], a[112:115], v[56:59], v[72:75]
    v_and_or_b32 v80, v80, -2, s32
    v_mfma_f32_16x16x32_bf16 v[72:75], a[116:119], v[60:63], v[72:75]
    v_cvt_pk_bf16_f32 v82, v68, v69
    v_mfma_f32_16x16x32_bf16 v[76:79], a[120:123], v[40:43], 0
    v_cvt_pk_bf16_f32 v83, v70, v71
    v_mfma_f32_16x16x32_bf16 v[76:79], a[124:127], v[44:47], v[76:79]
    buffer_store_dwordx4 v[80:83], v5, s[4:7], s34 offen offset:128 sc1
    v_mfma_f32_16x16x32_bf16 v[76:79], a[128:131], v[48:51], v[76:79]
    v_mfma_f32_16x16x32_bf16 v[76:79], a[132:135], v[52:55], v[76:79]
    v_mfma_f32_16x16x32_bf16 v[76:79], a[136:139], v[56:59], v[76:79]
    v_mfma_f32_16x16x32_bf16 v[76:79], a[140:143], v[60:63], v[76:79]
    v_mfma_f32_16x16x32_bf16 v[64:67], a[144:147], v[16:19], 0
    v_mfma_f32_16x16x32_bf16 v[64:67], a[148:151], v[20:23], v[64:67]
    v_mfma_f32_16x16x32_bf16 v[64:67], a[152:155], v[24:27], v[64:67]
    v_cvt_pk_bf16_f32 v84, v72, v73
    v_mfma_f32_16x16x32_bf16 v[64:67], a[156:159], v[28:31], v[64:67]
    v_cvt_pk_bf16_f32 v85, v74, v75
    v_mfma_f32_16x16x32_bf16 v[64:67], a[160:163], v[32:35], v[64:67]
    v_and_or_b32 v84, v84, -2, s32
    v_mfma_f32_16x16x32_bf16 v[64:67], a[164:167], v[36:39], v[64:67]
    v_cvt_pk_bf16_f32 v86, v76, v77
    v_mfma_f32_16x16x32_bf16 v[68:71], a[168:171], v[16:19], 0
    v_cvt_pk_bf16_f32 v87, v78, v79
    v_mfma_f32_16x16x32_bf16 v[68:71], a[172:175], v[20:23], v[68:71]
    buffer_store_dwordx4 v[84:87], v5, s[4:7], s35 offen offset:128 sc1
    v_mfma_f32_16x16x32_bf16 v[68:71], a[176:179], v[24:27], v[68:71]
    v_mfma_f32_16x16x32_bf16 v[68:71], a[180:183], v[28:31], v[68:71]
    v_mfma_f32_16x16x32_bf16 v[68:71], a[184:187], v[32:35], v[68:71]
    v_mfma_f32_16x16x32_bf16 v[68:71], a[188:191], v[36:39], v[68:71]
    v_mfma_f32_16x16x32_bf16 v[72:75], a[144:147], v[40:43], 0
    v_mfma_f32_16x16x32_bf16 v[72:75], a[148:151], v[44:47], v[72:75]
    v_mfma_f32_16x16x32_bf16 v[72:75], a[152:155], v[48:51], v[72:75]
    v_cvt_pk_bf16_f32 v80, v64, v65
    v_mfma_f32_16x16x32_bf16 v[72:75], a[156:159], v[52:55], v[72:75]
    v_cvt_pk_bf16_f32 v81, v66, v67
    v_mfma_f32_16x16x32_bf16 v[72:75], a[160:163], v[56:59], v[72:75]
    v_and_or_b32 v80, v80, -2, s32
    v_mfma_f32_16x16x32_bf16 v[72:75], a[164:167], v[60:63], v[72:75]
    v_cvt_pk_bf16_f32 v82, v68, v69
    v_mfma_f32_16x16x32_bf16 v[76:79], a[168:171], v[40:43], 0
    v_cvt_pk_bf16_f32 v83, v70, v71
    v_mfma_f32_16x16x32_bf16 v[76:79], a[172:175], v[44:47], v[76:79]
    buffer_store_dwordx4 v[80:83], v5, s[4:7], s34 offen offset:192 sc1
    v_mfma_f32_16x16x32_bf16 v[76:79], a[176:179], v[48:51], v[76:79]
    v_mfma_f32_16x16x32_bf16 v[76:79], a[180:183], v[52:55], v[76:79]
    v_mfma_f32_16x16x32_bf16 v[76:79], a[184:187], v[56:59], v[76:79]
    v_mfma_f32_16x16x32_bf16 v[76:79], a[188:191], v[60:63], v[76:79]
    v_mfma_f32_16x16x32_bf16 v[64:67], a[192:195], v[16:19], 0
    v_mfma_f32_16x16x32_bf16 v[64:67], a[196:199], v[20:23], v[64:67]
    v_mfma_f32_16x16x32_bf16 v[64:67], a[200:203], v[24:27], v[64:67]
    v_cvt_pk_bf16_f32 v84, v72, v73
    v_mfma_f32_16x16x32_bf16 v[64:67], a[204:207], v[28:31], v[64:67]
    v_cvt_pk_bf16_f32 v85, v74, v75
    v_mfma_f32_16x16x32_bf16 v[64:67], a[208:211], v[32:35], v[64:67]
    v_and_or_b32 v84, v84, -2, s32
    v_mfma_f32_16x16x32_bf16 v[64:67], a[212:215], v[36:39], v[64:67]
    v_cvt_pk_bf16_f32 v86, v76, v77
    v_mfma_f32_16x16x32_bf16 v[68:71], a[216:219], v[16:19], 0
    v_cvt_pk_bf16_f32 v87, v78, v79
    v_mfma_f32_16x16x32_bf16 v[68:71], a[220:223], v[20:23], v[68:71]
    buffer_store_dwordx4 v[84:87], v5, s[4:7], s35 offen offset:192 sc1
    v_mfma_f32_16x16x32_bf16 v[68:71], a[224:227], v[24:27], v[68:71]
    v_mfma_f32_16x16x32_bf16 v[68:71], a[228:231], v[28:31], v[68:71]
    v_mfma_f32_16x16x32_bf16 v[68:71], a[232:235], v[32:35], v[68:71]
    v_mfma_f32_16x16x32_bf16 v[68:71], a[236:239], v[36:39], v[68:71]
    v_mfma_f32_16x16x32_bf16 v[72:75], a[192:195], v[40:43], 0
    v_mfma_f32_16x16x32_bf16 v[72:75], a[196:199], v[44:47], v[72:75]
    v_mfma_f32_16x16x32_bf16 v[72:75], a[200:203], v[48:51], v[72:75]
    v_cvt_pk_bf16_f32 v80, v64, v65
    v_mfma_f32_16x16x32_bf16 v[72:75], a[204:207], v[52:55], v[72:75]
    v_cvt_pk_bf16_f32 v81, v66, v67
    v_mfma_f32_16x16x32_bf16 v[72:75], a[208:211], v[56:59], v[72:75]
    v_and_or_b32 v80, v80, -2, s32
    v_mfma_f32_16x16x32_bf16 v[72:75], a[212:215], v[60:63], v[72:75]
    v_cvt_pk_bf16_f32 v82, v68, v69
    v_mfma_f32_16x16x32_bf16 v[76:79], a[216:219], v[40:43], 0
    v_cvt_pk_bf16_f32 v83, v70, v71
    v_mfma_f32_16x16x32_bf16 v[76:79], a[220:223], v[44:47], v[76:79]
    buffer_store_dwordx4 v[80:83], v5, s[4:7], s34 offen offset:256 sc1
    v_mfma_f32_16x16x32_bf16 v[76:79], a[224:227], v[48:51], v[76:79]
    v_mfma_f32_16x16x32_bf16 v[76:79], a[228:231], v[52:55], v[76:79]
    v_mfma_f32_16x16x32_bf16 v[76:79], a[232:235], v[56:59], v[76:79]
    v_mfma_f32_16x16x32_bf16 v[76:79], a[236:239], v[60:63], v[76:79]
    v_cvt_pk_bf16_f32 v84, v72, v73
    v_cvt_pk_bf16_f32 v85, v74, v75
    v_and_or_b32 v84, v84, -2, s32
    s_nop 4
    v_cvt_pk_bf16_f32 v86, v76, v77
    v_cvt_pk_bf16_f32 v87, v78, v79
    buffer_store_dwordx4 v[84:87], v5, s[4:7], s35 offen offset:256 sc1
    s_mul_i32 s27, s12, 3072
    v_add_u32 v160, s27, v4
    s_waitcnt vmcnt(0)
    buffer_load_dwordx4 v[88:91], v6, s[4:7], s36 offen offset:0 sc1
    buffer_load_dwordx4 v[92:95], v6, s[4:7], s37 offen offset:0 sc1
    buffer_load_dwordx4 v[96:99], v6, s[4:7], s36 offen offset:256 sc1
    buffer_load_dwordx4 v[100:103], v6, s[4:7], s37 offen offset:256 sc1
    buffer_load_dwordx4 v[104:107], v6, s[4:7], s36 offen offset:512 sc1
    buffer_load_dwordx4 v[108:111], v6, s[4:7], s37 offen offset:512 sc1
    buffer_load_dwordx4 v[112:115], v6, s[4:7], s36 offen offset:768 sc1
    buffer_load_dwordx4 v[116:119], v6, s[4:7], s37 offen offset:768 sc1
    buffer_load_dwordx4 v[120:123], v6, s[4:7], s36 offen offset:1024 sc1
    buffer_load_dwordx4 v[124:127], v6, s[4:7], s37 offen offset:1024 sc1
    s_mov_b32 s19, 0
L_Os_red_4:
    s_waitcnt vmcnt(9)
    v_mfma_f32_16x16x32_bf16 v[128:131], a[240:243], v[88:91], 0
    v_xor_b32 v14, s33, v88
    s_waitcnt vmcnt(8)
    v_mfma_f32_16x16x32_bf16 v[128:131], a[240:243], v[92:95], v[128:131]
    v_bitop3_b32 v14, v14, v92, s33 bitop3:0xf6
    s_waitcnt vmcnt(7)
    v_mfma_f32_16x16x32_bf16 v[128:131], a[244:247], v[96:99], v[128:131]
    v_bitop3_b32 v14, v14, v96, s33 bitop3:0xf6
    s_waitcnt vmcnt(6)
    v_mfma_f32_16x16x32_bf16 v[128:131], a[244:247], v[100:103], v[128:131]
    v_bitop3_b32 v14, v14, v100, s33 bitop3:0xf6
    s_waitcnt vmcnt(5)
    v_mfma_f32_16x16x32_bf16 v[132:135], a[240:243], v[104:107], 0
    v_bitop3_b32 v14, v14, v104, s33 bitop3:0xf6
    s_waitcnt vmcnt(4)
    v_mfma_f32_16x16x32_bf16 v[132:135], a[240:243], v[108:111], v[132:135]
    v_bitop3_b32 v14, v14, v108, s33 bitop3:0xf6
    s_waitcnt vmcnt(3)
    v_mfma_f32_16x16x32_bf16 v[132:135], a[244:247], v[112:115], v[132:135]
    v_bitop3_b32 v14, v14, v112, s33 bitop3:0xf6
    s_waitcnt vmcnt(2)
    v_mfma_f32_16x16x32_bf16 v[132:135], a[244:247], v[116:119], v[132:135]
    v_bitop3_b32 v14, v14, v116, s33 bitop3:0xf6
    s_waitcnt vmcnt(1)
    v_mfma_f32_16x16x32_bf16 v[136:139], a[240:243], v[120:123], 0
    v_bitop3_b32 v14, v14, v120, s33 bitop3:0xf6
    s_waitcnt vmcnt(0)
    v_mfma_f32_16x16x32_bf16 v[136:139], a[240:243], v[124:127], v[136:139]
    v_bitop3_b32 v14, v14, v124, s33 bitop3:0xf6
    v_and_b32 v14, 1, v14
    v_cmp_ne_u32 vcc, 0, v14
    s_nop 0
    s_cbranch_vccnz L_Os_redfix_5
    ds_write_b128 v160, v[128:131] offset:24576
    ds_write_b128 v160, v[132:135] offset:25600
    s_nop 0
    ds_write_b128 v160, v[136:139] offset:26624
    s_sub_u32 s30, 36864, s30
    v_add_u32 v1, s31, v1
    v_add_u32 v2, s31, v2
    v_add_u32 v3, s31, v3
    s_sub_u32 s31, 0, s31
    s_add_u32 s36, s36, s26
    s_add_u32 s37, s37, s26
    s_add_u32 s34, s34, s26
    s_add_u32 s35, s35, s26
    s_sub_u32 s26, 0, s26
    s_add_u32 s22, s22, 1
    s_add_u32 s23, s23, 1
    s_waitcnt lgkmcnt(0)
    s_barrier
    s_cmp_lg_u32 s12, 0
    s_cbranch_scc1 L_Os_nofin_6
    ds_read_b128 v[16:19], v4 offset:24576
    ds_read_b128 v[20:23], v4 offset:25600
    ds_read_b128 v[24:27], v4 offset:26624
    ds_read_b128 v[28:31], v4 offset:27648
    ds_read_b128 v[32:35], v4 offset:28672
    ds_read_b128 v[36:39], v4 offset:29696
    ds_read_b128 v[40:43], v4 offset:30720
    ds_read_b128 v[44:47], v4 offset:31744
    ds_read_b128 v[48:51], v4 offset:32768
    ds_read_b128 v[52:55], v4 offset:33792
    ds_read_b128 v[56:59], v4 offset:34816
    ds_read_b128 v[60:63], v4 offset:35840
    s_waitcnt lgkmcnt(6)
    v_pk_add_f32 v[16:17], v[16:17], v[28:29]
    v_pk_add_f32 v[18:19], v[18:19], v[30:31]
    v_pk_add_f32 v[20:21], v[20:21], v[32:33]
    v_pk_add_f32 v[22:23], v[22:23], v[34:35]
    v_pk_add_f32 v[24:25], v[24:25], v[36:37]
    v_pk_add_f32 v[26:27], v[26:27], v[38:39]
    s_waitcnt lgkmcnt(3)
    v_pk_add_f32 v[16:17], v[16:17], v[40:41]
    v_pk_add_f32 v[18:19], v[18:19], v[42:43]
    v_pk_add_f32 v[20:21], v[20:21], v[44:45]
    v_pk_add_f32 v[22:23], v[22:23], v[46:47]
    v_pk_add_f32 v[24:25], v[24:25], v[48:49]
    v_pk_add_f32 v[26:27], v[26:27], v[50:51]
    s_waitcnt lgkmcnt(0)
    v_pk_add_f32 v[16:17], v[16:17], v[52:53]
    v_pk_add_f32 v[18:19], v[18:19], v[54:55]
    v_pk_add_f32 v[20:21], v[20:21], v[56:57]
    v_pk_add_f32 v[22:23], v[22:23], v[58:59]
    v_pk_add_f32 v[24:25], v[24:25], v[60:61]
    v_pk_add_f32 v[26:27], v[26:27], v[62:63]
    v_cvt_pk_bf16_f32 v146, v16, v17
    v_cvt_pk_bf16_f32 v147, v18, v19
    v_cvt_pk_bf16_f32 v148, v20, v21
    v_cvt_pk_bf16_f32 v149, v22, v23
    v_cvt_pk_bf16_f32 v150, v24, v25
    v_cvt_pk_bf16_f32 v151, v26, v27
    v_lshlrev_b32 v16, 16, v146
    v_and_b32 v17, 0xffff0000, v146
    v_lshlrev_b32 v18, 16, v147
    v_and_b32 v19, 0xffff0000, v147
    v_lshlrev_b32 v20, 16, v148
    v_and_b32 v21, 0xffff0000, v148
    v_lshlrev_b32 v22, 16, v149
    v_and_b32 v23, 0xffff0000, v149
    v_lshlrev_b32 v24, 16, v150
    v_and_b32 v25, 0xffff0000, v150
    v_lshlrev_b32 v26, 16, v151
    v_and_b32 v27, 0xffff0000, v151
    v_lshlrev_b32 v28, 16, v208
    v_and_b32 v29, 0xffff0000, v208
    v_lshlrev_b32 v30, 16, v209
    v_and_b32 v31, 0xffff0000, v209
    v_lshlrev_b32 v32, 16, v210
    v_and_b32 v33, 0xffff0000, v210
    v_lshlrev_b32 v34, 16, v211
    v_and_b32 v35, 0xffff0000, v211
    v_lshlrev_b32 v36, 16, v212
    v_and_b32 v37, 0xffff0000, v212
    v_lshlrev_b32 v38, 16, v213
    v_and_b32 v39, 0xffff0000, v213
    v_pk_add_f32 v[16:17], v[16:17], v[28:29]
    v_pk_add_f32 v[18:19], v[18:19], v[30:31]
    v_pk_add_f32 v[20:21], v[20:21], v[32:33]
    v_pk_add_f32 v[22:23], v[22:23], v[34:35]
    v_pk_add_f32 v[24:25], v[24:25], v[36:37]
    v_pk_add_f32 v[26:27], v[26:27], v[38:39]
    v_cndmask_b32 v24, 0, v24, s[62:63]
    v_cndmask_b32 v25, 0, v25, s[62:63]
    v_cndmask_b32 v26, 0, v26, s[62:63]
    v_cndmask_b32 v27, 0, v27, s[62:63]
    v_cvt_pk_bf16_f32 v146, v16, v17
    v_cvt_pk_bf16_f32 v147, v18, v19
    v_cvt_pk_bf16_f32 v148, v20, v21
    v_cvt_pk_bf16_f32 v149, v22, v23
    v_cvt_pk_bf16_f32 v150, v24, v25
    v_cvt_pk_bf16_f32 v151, v26, v27
    v_lshlrev_b32 v16, 16, v146
    v_and_b32 v17, 0xffff0000, v146
    v_lshlrev_b32 v18, 16, v147
    v_and_b32 v19, 0xffff0000, v147
    v_lshlrev_b32 v20, 16, v148
    v_and_b32 v21, 0xffff0000, v148
    v_lshlrev_b32 v22, 16, v149
    v_and_b32 v23, 0xffff0000, v149
    v_lshlrev_b32 v24, 16, v150
    v_and_b32 v25, 0xffff0000, v150
    v_lshlrev_b32 v26, 16, v151
    v_and_b32 v27, 0xffff0000, v151
    v_mov_b32 v152, v146
    v_mov_b32 v153, v147
    v_mov_b32 v154, v148
    v_mov_b32 v155, v149
    v_mov_b32 v156, v150
    v_mov_b32 v157, v151
    v_mov_b32 v158, v150
    v_mov_b32 v159, v151
    v_permlane16_swap_b32 v152, v154
    v_permlane16_swap_b32 v153, v155
    v_permlane16_swap_b32 v156, v158
    v_permlane16_swap_b32 v157, v159
    buffer_store_dwordx4 v[152:155], v9, s[4:7], s40 offen sc1
    s_mov_b64 exec, 0xffff
    buffer_store_dwordx4 v[156:159], v9, s[4:7], s40 offen offset:1024 sc1
    s_mov_b64 exec, -1
    v_pk_add_f32 v[32:33], v[16:17], v[18:19]
    v_pk_add_f32 v[32:33], v[32:33], v[20:21]
    v_pk_add_f32 v[32:33], v[32:33], v[22:23]
    v_pk_add_f32 v[32:33], v[32:33], v[24:25]
    v_pk_add_f32 v[32:33], v[32:33], v[26:27]
    v_add_f32 v28, v32, v33
    s_nop 1
    v_add_f32_dpp v28, v28, v28 quad_perm:[1,0,3,2] row_mask:0xf bank_mask:0xf
    s_nop 1
    v_add_f32_dpp v28, v28, v28 quad_perm:[2,3,0,1] row_mask:0xf bank_mask:0xf
    s_nop 1
    v_add_f32_dpp v28, v28, v28 row_half_mirror row_mask:0xf bank_mask:0xf
    s_nop 1
    v_add_f32_dpp v28, v28, v28 row_mirror row_mask:0xf bank_mask:0xf
    v_mov_b32 v29, v28
    s_nop 1
    v_permlane16_swap_b32 v28, v29
    v_add_f32 v28, v28, v29
    v_mov_b32 v29, v28
    s_nop 1
    v_permlane32_swap_b32 v28, v29
    v_add_f32 v28, v28, v29
    v_mul_f32 v30, 1.5625000000e-03, v28
    v_sub_f32 v32, v16, v30
    v_sub_f32 v33, v17, v30
    v_sub_f32 v34, v18, v30
    v_sub_f32 v35, v19, v30
    v_sub_f32 v36, v20, v30
    v_sub_f32 v37, v21, v30
    v_sub_f32 v38, v22, v30
    v_sub_f32 v39, v23, v30
    v_sub_f32 v40, v24, v30
    v_sub_f32 v41, v25, v30
    v_sub_f32 v42, v26, v30
    v_sub_f32 v43, v27, v30
    v_cndmask_b32 v40, 0, v40, s[62:63]
    v_cndmask_b32 v41, 0, v41, s[62:63]
    v_cndmask_b32 v42, 0, v42, s[62:63]
    v_cndmask_b32 v43, 0, v43, s[62:63]
    v_mul_f32 v28, v32, v32
    v_fmac_f32 v28, v33, v33
    v_fmac_f32 v28, v34, v34
    v_fmac_f32 v28, v35, v35
    v_fmac_f32 v28, v36, v36
    v_fmac_f32 v28, v37, v37
    v_fmac_f32 v28, v38, v38
    v_fmac_f32 v28, v39, v39
    v_fmac_f32 v28, v40, v40
    v_fmac_f32 v28, v41, v41
    v_fmac_f32 v28, v42, v42
    v_fmac_f32 v28, v43, v43
    s_nop 1
    v_add_f32_dpp v28, v28, v28 quad_perm:[1,0,3,2] row_mask:0xf bank_mask:0xf
    s_nop 1
    v_add_f32_dpp v28, v28, v28 quad_perm:[2,3,0,1] row_mask:0xf bank_mask:0xf
    s_nop 1
    v_add_f32_dpp v28, v28, v28 row_half_mirror row_mask:0xf bank_mask:0xf
    s_nop 1
    v_add_f32_dpp v28, v28, v28 row_mirror row_mask:0xf bank_mask:0xf
    v_mov_b32 v29, v28
    s_nop 1
    v_permlane16_swap_b32 v28, v29
    v_add_f32 v28, v28, v29
    v_mov_b32 v29, v28
    s_nop 1
    v_permlane32_swap_b32 v28, v29
    v_add_f32 v28, v28, v29
    v_mul_f32 v28, 1.5625000000e-03, v28
    v_cvt_pk_bf16_f32 v29, v28, v30
    v_lshlrev_b32 v28, 16, v29
    v_and_b32 v30, 0xffff0000, v29
    v_add_f32 v28, 0x3727c5ac, v28
    v_cvt_pk_bf16_f32 v29, v28, v28
    v_lshlrev_b32 v28, 16, v29
    v_sqrt_f32 v28, v28
    v_sub_f32 v32, v16, v30
    v_sub_f32 v33, v17, v30
    v_sub_f32 v34, v18, v30
    v_sub_f32 v35, v19, v30
    v_sub_f32 v36, v20, v30
    v_sub_f32 v37, v21, v30
    v_sub_f32 v38, v22, v30
    v_sub_f32 v39, v23, v30
    v_sub_f32 v40, v24, v30
    v_sub_f32 v41, v25, v30
    v_sub_f32 v42, v26, v30
    v_sub_f32 v43, v27, v30
    v_cvt_pk_bf16_f32 v29, v28, v28
    v_lshlrev_b32 v28, 16, v29
    v_rcp_f32 v28, v28
    v_cvt_pk_bf16_f32 v146, v32, v33
    v_cvt_pk_bf16_f32 v147, v34, v35
    v_cvt_pk_bf16_f32 v148, v36, v37
    v_cvt_pk_bf16_f32 v149, v38, v39
    v_cvt_pk_bf16_f32 v150, v40, v41
    v_cvt_pk_bf16_f32 v151, v42, v43
    v_lshlrev_b32 v32, 16, v146
    v_and_b32 v33, 0xffff0000, v146
    v_lshlrev_b32 v34, 16, v147
    v_and_b32 v35, 0xffff0000, v147
    v_lshlrev_b32 v36, 16, v148
    v_and_b32 v37, 0xffff0000, v148
    v_lshlrev_b32 v38, 16, v149
    v_and_b32 v39, 0xffff0000, v149
    v_lshlrev_b32 v40, 16, v150
    v_and_b32 v41, 0xffff0000, v150
    v_lshlrev_b32 v42, 16, v151
    v_and_b32 v43, 0xffff0000, v151
    v_mul_f32 v32, v32, v28
    v_mul_f32 v33, v33, v28
    v_mul_f32 v34, v34, v28
    v_mul_f32 v35, v35, v28
    v_mul_f32 v36, v36, v28
    v_mul_f32 v37, v37, v28
    v_mul_f32 v38, v38, v28
    v_mul_f32 v39, v39, v28
    v_mul_f32 v40, v40, v28
    v_mul_f32 v41, v41, v28
    v_mul_f32 v42, v42, v28
    v_mul_f32 v43, v43, v28
    v_cvt_pk_bf16_f32 v146, v32, v33
    v_cvt_pk_bf16_f32 v147, v34, v35
    v_cvt_pk_bf16_f32 v148, v36, v37
    v_cvt_pk_bf16_f32 v149, v38, v39
    v_cvt_pk_bf16_f32 v150, v40, v41
    v_cvt_pk_bf16_f32 v151, v42, v43
    v_mov_b32 v152, v146
    v_mov_b32 v153, v147
    v_mov_b32 v154, v148
    v_mov_b32 v155, v149
    v_mov_b32 v156, v150
    v_mov_b32 v157, v151
    v_mov_b32 v158, v150
    v_mov_b32 v159, v151
    v_permlane16_swap_b32 v152, v154
    v_permlane16_swap_b32 v153, v155
    v_permlane16_swap_b32 v156, v158
    v_permlane16_swap_b32 v157, v159
    buffer_store_dwordx4 v[152:155], v9, s[4:7], s41 offen sc1
    s_mov_b64 exec, 0xffff
    buffer_store_dwordx4 v[156:159], v9, s[4:7], s41 offen offset:1024 sc1
    s_mov_b64 exec, -1
L_Os_nofin_6:
    s_add_u32 s39, s39, 40960
    s_add_u32 s40, s40, 40960
    s_add_u32 s41, s41, 40960
    s_cmp_lt_u32 s22, 64
    s_cbranch_scc1 L_Os_top
    s_waitcnt vmcnt(0)
    s_cmp_lg_u32 s12, 0
    s_cbranch_scc1 L_Os_nofin_6x
    v_mov_b32 v13, s22
    s_mov_b64 exec, 1
    buffer_store_dword v13, v0, s[4:7], s24 offen offset:0 sc1
    s_mov_b64 exec, -1
L_Os_nofin_6x:
    s_waitcnt vmcnt(0)
    s_endpgm
L_Os_flspin_3:
    buffer_load_dword v12, v10, s[4:7], s25 offen sc1
    s_add_u32 s19, s19, 1
    s_cmp_ge_u32 s19, 524288
    s_cbranch_scc1 L_fail
    s_waitcnt vmcnt(0)
    v_cmp_gt_u32 vcc, s23, v12
    s_nop 0
    s_cbranch_vccnz L_Os_flspin_3
    s_branch L_Os_fl_2
L_Os_redfix_5:
    buffer_load_dwordx4 v[88:91], v6, s[4:7], s36 offen offset:0 sc1
    buffer_load_dwordx4 v[92:95], v6, s[4:7], s37 offen offset:0 sc1
    buffer_load_dwordx4 v[96:99], v6, s[4:7], s36 offen offset:256 sc1
    buffer_load_dwordx4 v[100:103], v6, s[4:7], s37 offen offset:256 sc1
    buffer_load_dwordx4 v[104:107], v6, s[4:7], s36 offen offset:512 sc1
    buffer_load_dwordx4 v[108:111], v6, s[4:7], s37 offen offset:512 sc1
    buffer_load_dwordx4 v[112:115], v6, s[4:7], s36 offen offset:768 sc1
    buffer_load_dwordx4 v[116:119], v6, s[4:7], s37 offen offset:768 sc1
    buffer_load_dwordx4 v[120:123], v6, s[4:7], s36 offen offset:1024 sc1
    buffer_load_dwordx4 v[124:127], v6, s[4:7], s37 offen offset:1024 sc1
    s_add_u32 s19, s19, 1
    s_cmp_lt_u32 s19, 524288
    s_cbranch_scc1 L_Os_red_4
    s_branch L_fail
L_roleG:
    v_lshlrev_b32 v16, 4, v0
    s_sub_u32 s25, s13, 224
    s_lshr_b32 s20, s25, 4
    s_and_b32 s21, s25, 15
    s_lshl_b32 s23, s13, 2
    s_add_u32 s23, s23, s12
    s_lshl_b32 s23, s23, 7
    s_add_u32 s23, s23, 0
    v_mov_b32 v20, 0
    v_mov_b32 v21, 0
    v_mov_b32 v22, 0
    v_mov_b32 v23, 0
    s_mov_b64 exec, 1
    buffer_store_dwordx4 v[20:23], v16, s[4:7], s23 offen sc1
    s_mov_b64 exec, -1
    s_mul_i32 s32, s25, 40960
    s_mul_i32 s26, s12, 10240
    s_add_u32 s32, s32, s26
    s_add_u32 s32, s32, 211943424
    s_add_u32 s33, s32, 5120
    s_mov_b32 s26, s32
    buffer_store_dwordx4 v[20:23], v16, s[4:7], s26 offen sc1
    s_add_u32 s26, s26, 1024
    buffer_store_dwordx4 v[20:23], v16, s[4:7], s26 offen sc1
    s_add_u32 s26, s26, 1024
    buffer_store_dwordx4 v[20:23], v16, s[4:7], s26 offen sc1
    s_add_u32 s26, s26, 1024
    buffer_store_dwordx4 v[20:23], v16, s[4:7], s26 offen sc1
    s_add_u32 s26, s26, 1024
    buffer_store_dwordx4 v[20:23], v16, s[4:7], s26 offen sc1
    s_add_u32 s26, s26, 1024
    buffer_store_dwordx4 v[20:23], v16, s[4:7], s26 offen sc1
    s_add_u32 s26, s26, 1024
    buffer_store_dwordx4 v[20:23], v16, s[4:7], s26 offen sc1
    s_add_u32 s26, s26, 1024
    buffer_store_dwordx4 v[20:23], v16, s[4:7], s26 offen sc1
    s_add_u32 s26, s26, 1024
    buffer_store_dwordx4 v[20:23], v16, s[4:7], s26 offen sc1
    s_add_u32 s26, s26, 1024
    buffer_store_dwordx4 v[20:23], v16, s[4:7], s26 offen sc1
    s_add_u32 s26, s26, 1301504
    buffer_store_dwordx4 v[20:23], v16, s[4:7], s26 offen sc1
    s_add_u32 s26, s26, 1024
    buffer_store_dwordx4 v[20:23], v16, s[4:7], s26 offen sc1
    s_add_u32 s26, s26, 1024
    buffer_store_dwordx4 v[20:23], v16, s[4:7], s26 offen sc1
    s_add_u32 s26, s26, 1024
    buffer_store_dwordx4 v[20:23], v16, s[4:7], s26 offen sc1
    s_add_u32 s26, s26, 1024
    buffer_store_dwordx4 v[20:23], v16, s[4:7], s26 offen sc1
    s_add_u32 s26, s26, 1024
    buffer_store_dwordx4 v[20:23], v16, s[4:7], s26 offen sc1
    s_add_u32 s26, s26, 1024
    buffer_store_dwordx4 v[20:23], v16, s[4:7], s26 offen sc1
    s_add_u32 s26, s26, 1024
    buffer_store_dwordx4 v[20:23], v16, s[4:7], s26 offen sc1
    s_add_u32 s26, s26, 1024
    buffer_store_dwordx4 v[20:23], v16, s[4:7], s26 offen sc1
    s_add_u32 s26, s26, 1024
    buffer_store_dwordx4 v[20:23], v16, s[4:7], s26 offen sc1
    s_add_u32 s26, s26, 1024
    v_and_b32 v24, 15, v0
    v_lshrrev_b32 v25, 5, v0
    v_lshl_add_u32 v25, v25, 4, v24
    v_bfe_u32 v26, v0, 4, 1
    v_lshlrev_b32 v6, 4, v25
    v_lshl_add_u32 v6, v26, 3, v6
    v_lshrrev_b32 v7, 2, v25
    v_lshlrev_b32 v7, 6, v7
    v_lshl_add_u32 v7, v26, 5, v7
    v_and_b32 v25, 3, v25
    v_lshl_add_u32 v7, v25, 3, v7
    v_lshrrev_b32 v25, 5, v0
    v_lshl_add_u32 v25, v26, 1, v25
    v_lshl_add_u32 v25, v25, 4, v24
    v_lshlrev_b32 v8, 4, v25
    v_cmp_gt_u32 s[44:45], 32, v0
    s_mul_i32 s34, s12, 40960
    v_add_u32 v40, 0, v0
    v_mul_u32_u24 v41, 10923, v40
    v_lshrrev_b32 v41, 16, v41
    v_mul_u32_u24 v24, 6, v41
    v_sub_u32 v24, v40, v24
    v_lshrrev_b32 v24, 1, v24
    v_lshlrev_b32 v24, 4, v24
    v_mul_u32_u24 v41, 3072, v41
    v_add_u32 v24, v24, v41
    v_add_u32 v40, 64, v0
    v_mul_u32_u24 v41, 10923, v40
    v_lshrrev_b32 v41, 16, v41
    v_mul_u32_u24 v25, 6, v41
    v_sub_u32 v25, v40, v25
    v_lshrrev_b32 v25, 1, v25
    v_lshlrev_b32 v25, 4, v25
    v_mul_u32_u24 v41, 3072, v41
    v_add_u32 v25, v25, v41
    v_add_u32 v40, 128, v0
    v_mul_u32_u24 v41, 10923, v40
    v_lshrrev_b32 v41, 16, v41
    v_mul_u32_u24 v26, 6, v41
    v_sub_u32 v26, v40, v26
    v_lshrrev_b32 v26, 1, v26
    v_lshlrev_b32 v26, 4, v26
    v_mul_u32_u24 v41, 3072, v41
    v_add_u32 v26, v26, v41
    v_lshrrev_b32 v27, 2, v0
    v_mul_u32_u24 v27, 96, v27
    v_and_b32 v40, 3, v0
    v_lshl_add_u32 v27, v40, 3, v27
    v_add_u32 v27, s34, v27
    v_add_u32 v40, 0, v0
    v_mul_u32_u24 v41, 3277, v40
    v_lshrrev_b32 v41, 16, v41
    v_mul_u32_u24 v28, 20, v41
    v_sub_u32 v28, v40, v28
    v_lshrrev_b32 v28, 0, v28
    v_lshlrev_b32 v28, 4, v28
    v_mul_u32_u24 v41, 1280, v41
    v_add_u32 v28, v28, v41
    v_add_u32 v40, 64, v0
    v_mul_u32_u24 v41, 3277, v40
    v_lshrrev_b32 v41, 16, v41
    v_mul_u32_u24 v29, 20, v41
    v_sub_u32 v29, v40, v29
    v_lshrrev_b32 v29, 0, v29
    v_lshlrev_b32 v29, 4, v29
    v_mul_u32_u24 v41, 1280, v41
    v_add_u32 v29, v29, v41
    v_add_u32 v40, 128, v0
    v_mul_u32_u24 v41, 3277, v40
    v_lshrrev_b32 v41, 16, v41
    v_mul_u32_u24 v30, 20, v41
    v_sub_u32 v30, v40, v30
    v_lshrrev_b32 v30, 0, v30
    v_lshlrev_b32 v30, 4, v30
    v_mul_u32_u24 v41, 1280, v41
    v_add_u32 v30, v30, v41
    v_add_u32 v40, 192, v0
    v_mul_u32_u24 v41, 3277, v40
    v_lshrrev_b32 v41, 16, v41
    v_mul_u32_u24 v31, 20, v41
    v_sub_u32 v31, v40, v31
    v_lshrrev_b32 v31, 0, v31
    v_lshlrev_b32 v31, 4, v31
    v_mul_u32_u24 v41, 1280, v41
    v_add_u32 v31, v31, v41
    v_add_u32 v40, 256, v0
    v_mul_u32_u24 v41, 3277, v40
    v_lshrrev_b32 v41, 16, v41
    v_mul_u32_u24 v32, 20, v41
    v_sub_u32 v32, v40, v32
    v_lshrrev_b32 v32, 0, v32
    v_lshlrev_b32 v32, 4, v32
    v_mul_u32_u24 v41, 1280, v41
    v_add_u32 v32, v32, v41
    v_add_u32 v40, 320, v0
    v_mul_u32_u24 v41, 3277, v40
    v_lshrrev_b32 v41, 16, v41
    v_mul_u32_u24 v33, 20, v41
    v_sub_u32 v33, v40, v33
    v_lshrrev_b32 v33, 0, v33
    v_lshlrev_b32 v33, 4, v33
    v_mul_u32_u24 v41, 1280, v41
    v_add_u32 v33, v33, v41
    v_add_u32 v40, 384, v0
    v_mul_u32_u24 v41, 3277, v40
    v_lshrrev_b32 v41, 16, v41
    v_mul_u32_u24 v34, 20, v41
    v_sub_u32 v34, v40, v34
    v_lshrrev_b32 v34, 0, v34
    v_lshlrev_b32 v34, 4, v34
    v_mul_u32_u24 v41, 1280, v41
    v_add_u32 v34, v34, v41
    v_add_u32 v40, 448, v0
    v_mul_u32_u24 v41, 3277, v40
    v_lshrrev_b32 v41, 16, v41
    v_mul_u32_u24 v35, 20, v41
    v_sub_u32 v35, v40, v35
    v_lshrrev_b32 v35, 0, v35
    v_lshlrev_b32 v35, 4, v35
    v_mul_u32_u24 v41, 1280, v41
    v_add_u32 v35, v35, v41
    v_add_u32 v40, 512, v0
    v_mul_u32_u24 v41, 3277, v40
    v_lshrrev_b32 v41, 16, v41
    v_mul_u32_u24 v36, 20, v41
    v_sub_u32 v36, v40, v36
    v_lshrrev_b32 v36, 0, v36
    v_lshlrev_b32 v36, 4, v36
    v_mul_u32_u24 v41, 1280, v41
    v_add_u32 v36, v36, v41
    v_add_u32 v40, 576, v0
    v_mul_u32_u24 v41, 3277, v40
    v_lshrrev_b32 v41, 16, v41
    v_mul_u32_u24 v37, 20, v41
    v_sub_u32 v37, v40, v37
    v_lshrrev_b32 v37, 0, v37
    v_lshlrev_b32 v37, 4, v37
    v_mul_u32_u24 v41, 1280, v41
    v_add_u32 v37, v37, v41
    v_lshrrev_b32 v38, 2, v0
    v_mul_u32_u24 v38, 320, v38
    v_and_b32 v40, 3, v0
    v_lshl_add_u32 v38, v40, 3, v38
    v_add_u32 v38, s34, v38
    s_mov_b32 s8, s80
    s_and_b32 s9, s81, 0xffff
    s_mov_b32 s10, 1966080
    s_mov_b32 s11, 0x20000
    s_mov_b32 s48, s82
    s_and_b32 s49, s83, 0xffff
    s_mov_b32 s50, 1966080
    s_mov_b32 s51, 0x20000
    s_mov_b32 s92, s84
    s_and_b32 s93, s85, 0xffff
    s_mov_b32 s94, 1966080
    s_mov_b32 s95, 0x20000
    s_mul_i32 s96, s21, 192
    s_mul_i32 s26, s12, 48
    s_add_u32 s96, s96, s26
    s_mul_i32 s97, s21, 122880
    s_mul_i32 s25, s12, 320
    s_add_u32 s97, s97, s25
    s_add_u32 m0, s34, 0
    s_mov_b32 exec_lo, 1431655765
    s_mov_b32 exec_hi, 1431655765
    buffer_load_dwordx4 v24, s[8:11], s96 offen lds
    s_mov_b32 exec_lo, 2863311530
    s_mov_b32 exec_hi, 2863311530
    buffer_load_dwordx4 v24, s[48:51], s96 offen lds
    s_mov_b64 exec, -1
    s_add_u32 m0, s34, 1024
    s_mov_b32 exec_lo, 1431655765
    s_mov_b32 exec_hi, 1431655765
    buffer_load_dwordx4 v25, s[8:11], s96 offen lds
    s_mov_b32 exec_lo, 2863311530
    s_mov_b32 exec_hi, 2863311530
    buffer_load_dwordx4 v25, s[48:51], s96 offen lds
    s_mov_b64 exec, -1
    s_add_u32 m0, s34, 2048
    s_mov_b32 exec_lo, 1431655765
    s_mov_b32 exec_hi, 1431655765
    buffer_load_dwordx4 v26, s[8:11], s96 offen lds
    s_mov_b32 exec_lo, 2863311530
    s_mov_b32 exec_hi, 2863311530
    buffer_load_dwordx4 v26, s[48:51], s96 offen lds
    s_mov_b64 exec, -1
    s_add_u32 s96, s96, 98304
    s_add_u32 m0, s34, 3072
    s_mov_b32 exec_lo, 1431655765
    s_mov_b32 exec_hi, 1431655765
    buffer_load_dwordx4 v24, s[8:11], s96 offen lds
    s_mov_b32 exec_lo, 2863311530
    s_mov_b32 exec_hi, 2863311530
    buffer_load_dwordx4 v24, s[48:51], s96 offen lds
    s_mov_b64 exec, -1
    s_add_u32 m0, s34, 4096
    s_mov_b32 exec_lo, 1431655765
    s_mov_b32 exec_hi, 1431655765
    buffer_load_dwordx4 v25, s[8:11], s96 offen lds
    s_mov_b32 exec_lo, 2863311530
    s_mov_b32 exec_hi, 2863311530
    buffer_load_dwordx4 v25, s[48:51], s96 offen lds
    s_mov_b64 exec, -1
    s_add_u32 m0, s34, 5120
    s_mov_b32 exec_lo, 1431655765
    s_mov_b32 exec_hi, 1431655765
    buffer_load_dwordx4 v26, s[8:11], s96 offen lds
    s_mov_b32 exec_lo, 2863311530
    s_mov_b32 exec_hi, 2863311530
    buffer_load_dwordx4 v26, s[48:51], s96 offen lds
    s_mov_b64 exec, -1
    s_add_u32 s96, s96, 98304
    s_add_u32 m0, s34, 6144
    s_mov_b32 exec_lo, 1431655765
    s_mov_b32 exec_hi, 1431655765
    buffer_load_dwordx4 v24, s[8:11], s96 offen lds
    s_mov_b32 exec_lo, 2863311530
    s_mov_b32 exec_hi, 2863311530
    buffer_load_dwordx4 v24, s[48:51], s96 offen lds
    s_mov_b64 exec, -1
    s_add_u32 m0, s34, 7168
    s_mov_b32 exec_lo, 1431655765
    s_mov_b32 exec_hi, 1431655765
    buffer_load_dwordx4 v25, s[8:11], s96 offen lds
    s_mov_b32 exec_lo, 2863311530
    s_mov_b32 exec_hi, 2863311530
    buffer_load_dwordx4 v25, s[48:51], s96 offen lds
    s_mov_b64 exec, -1
    s_add_u32 m0, s34, 8192
    s_mov_b32 exec_lo, 1431655765
    s_mov_b32 exec_hi, 1431655765
    buffer_load_dwordx4 v26, s[8:11], s96 offen lds
    s_mov_b32 exec_lo, 2863311530
    s_mov_b32 exec_hi, 2863311530
    buffer_load_dwordx4 v26, s[48:51], s96 offen lds
    s_mov_b64 exec, -1
    s_add_u32 s96, s96, 98304
    s_add_u32 m0, s34, 9216
    s_mov_b32 exec_lo, 1431655765
    s_mov_b32 exec_hi, 1431655765
    buffer_load_dwordx4 v24, s[8:11], s96 offen lds
    s_mov_b32 exec_lo, 2863311530
    s_mov_b32 exec_hi, 2863311530
    buffer_load_dwordx4 v24, s[48:51], s96 offen lds
    s_mov_b64 exec, -1
    s_add_u32 m0, s34, 10240
    s_mov_b32 exec_lo, 1431655765
    s_mov_b32 exec_hi, 1431655765
    buffer_load_dwordx4 v25, s[8:11], s96 offen lds
    s_mov_b32 exec_lo, 2863311530
    s_mov_b32 exec_hi, 2863311530
    buffer_load_dwordx4 v25, s[48:51], s96 offen lds
    s_mov_b64 exec, -1
    s_add_u32 m0, s34, 11264
    s_mov_b32 exec_lo, 1431655765
    s_mov_b32 exec_hi, 1431655765
    buffer_load_dwordx4 v26, s[8:11], s96 offen lds
    s_mov_b32 exec_lo, 2863311530
    s_mov_b32 exec_hi, 2863311530
    buffer_load_dwordx4 v26, s[48:51], s96 offen lds
    s_mov_b64 exec, -1
    s_add_u32 s96, s96, 98304
    s_add_u32 m0, s34, 12288
    s_mov_b32 exec_lo, 1431655765
    s_mov_b32 exec_hi, 1431655765
    buffer_load_dwordx4 v24, s[8:11], s96 offen lds
    s_mov_b32 exec_lo, 2863311530
    s_mov_b32 exec_hi, 2863311530
    buffer_load_dwordx4 v24, s[48:51], s96 offen lds
    s_mov_b64 exec, -1
    s_add_u32 m0, s34, 13312
    s_mov_b32 exec_lo, 1431655765
    s_mov_b32 exec_hi, 1431655765
    buffer_load_dwordx4 v25, s[8:11], s96 offen lds
    s_mov_b32 exec_lo, 2863311530
    s_mov_b32 exec_hi, 2863311530
    buffer_load_dwordx4 v25, s[48:51], s96 offen lds
    s_mov_b64 exec, -1
    s_add_u32 m0, s34, 14336
    s_mov_b32 exec_lo, 1431655765
    s_mov_b32 exec_hi, 1431655765
    buffer_load_dwordx4 v26, s[8:11], s96 offen lds
    s_mov_b32 exec_lo, 2863311530
    s_mov_b32 exec_hi, 2863311530
    buffer_load_dwordx4 v26, s[48:51], s96 offen lds
    s_mov_b64 exec, -1
    s_add_u32 s96, s96, 98304
    s_add_u32 m0, s34, 15360
    s_mov_b32 exec_lo, 1431655765
    s_mov_b32 exec_hi, 1431655765
    buffer_load_dwordx4 v24, s[8:11], s96 offen lds
    s_mov_b32 exec_lo, 2863311530
    s_mov_b32 exec_hi, 2863311530
    buffer_load_dwordx4 v24, s[48:51], s96 offen lds
    s_mov_b64 exec, -1
    s_add_u32 m0, s34, 16384
    s_mov_b32 exec_lo, 1431655765
    s_mov_b32 exec_hi, 1431655765
    buffer_load_dwordx4 v25, s[8:11], s96 offen lds
    s_mov_b32 exec_lo, 2863311530
    s_mov_b32 exec_hi, 2863311530
    buffer_load_dwordx4 v25, s[48:51], s96 offen lds
    s_mov_b64 exec, -1
    s_add_u32 m0, s34, 17408
    s_mov_b32 exec_lo, 1431655765
    s_mov_b32 exec_hi, 1431655765
    buffer_load_dwordx4 v26, s[8:11], s96 offen lds
    s_mov_b32 exec_lo, 2863311530
    s_mov_b32 exec_hi, 2863311530
    buffer_load_dwordx4 v26, s[48:51], s96 offen lds
    s_mov_b64 exec, -1
    s_waitcnt vmcnt(30)
    s_barrier
    s_cmp_lg_u32 s12, 0
    s_cbranch_scc1 L_G_arr_1
    s_lshl_b32 s3, s18, 2
    s_add_u32 s3, s3, 64
    v_mov_b32 v92, s3
    v_mov_b32 v93, 1
    s_mov_b64 exec, 1
    global_atomic_add v92, v93, s[16:17] sc1
    s_waitcnt vmcnt(0)
    s_mov_b64 exec, -1
L_G_arr_1:
    ds_read_b64_tr_b16 a[0:1], v27 offset:0
    ds_read_b64_tr_b16 a[2:3], v27 offset:1536
    ds_read_b64_tr_b16 a[80:81], v27 offset:32
    ds_read_b64_tr_b16 a[82:83], v27 offset:1568
    ds_read_b64_tr_b16 a[160:161], v27 offset:64
    ds_read_b64_tr_b16 a[162:163], v27 offset:1600
    s_waitcnt lgkmcnt(0)
    s_add_u32 s96, s96, 98304
    s_add_u32 m0, s34, 18432
    s_mov_b32 exec_lo, 1431655765
    s_mov_b32 exec_hi, 1431655765
    buffer_load_dwordx4 v24, s[8:11], s96 offen lds
    s_mov_b32 exec_lo, 2863311530
    s_mov_b32 exec_hi, 2863311530
    buffer_load_dwordx4 v24, s[48:51], s96 offen lds
    s_mov_b64 exec, -1
    s_add_u32 m0, s34, 19456
    s_mov_b32 exec_lo, 1431655765
    s_mov_b32 exec_hi, 1431655765
    buffer_load_dwordx4 v25, s[8:11], s96 offen lds
    s_mov_b32 exec_lo, 2863311530
    s_mov_b32 exec_hi, 2863311530
    buffer_load_dwordx4 v25, s[48:51], s96 offen lds
    s_mov_b64 exec, -1
    s_add_u32 m0, s34, 20480
    s_mov_b32 exec_lo, 1431655765
    s_mov_b32 exec_hi, 1431655765
    buffer_load_dwordx4 v26, s[8:11], s96 offen lds
    s_mov_b32 exec_lo, 2863311530
    s_mov_b32 exec_hi, 2863311530
    buffer_load_dwordx4 v26, s[48:51], s96 offen lds
    s_mov_b64 exec, -1
    s_add_u32 s96, s96, 98304
    s_add_u32 m0, s34, 21504
    s_mov_b32 exec_lo, 1431655765
    s_mov_b32 exec_hi, 1431655765
    buffer_load_dwordx4 v24, s[8:11], s96 offen lds
    s_mov_b32 exec_lo, 2863311530
    s_mov_b32 exec_hi, 2863311530
    buffer_load_dwordx4 v24, s[48:51], s96 offen lds
    s_mov_b64 exec, -1
    s_add_u32 m0, s34, 22528
    s_mov_b32 exec_lo, 1431655765
    s_mov_b32 exec_hi, 1431655765
    buffer_load_dwordx4 v25, s[8:11], s96 offen lds
    s_mov_b32 exec_lo, 2863311530
    s_mov_b32 exec_hi, 2863311530
    buffer_load_dwordx4 v25, s[48:51], s96 offen lds
    s_mov_b64 exec, -1
    s_add_u32 m0, s34, 23552
    s_mov_b32 exec_lo, 1431655765
    s_mov_b32 exec_hi, 1431655765
    buffer_load_dwordx4 v26, s[8:11], s96 offen lds
    s_mov_b32 exec_lo, 2863311530
    s_mov_b32 exec_hi, 2863311530
    buffer_load_dwordx4 v26, s[48:51], s96 offen lds
    s_mov_b64 exec, -1
    s_add_u32 s96, s96, 98304
    s_add_u32 m0, s34, 24576
    s_mov_b32 exec_lo, 1431655765
    s_mov_b32 exec_hi, 1431655765
    buffer_load_dwordx4 v24, s[8:11], s96 offen lds
    s_mov_b32 exec_lo, 2863311530
    s_mov_b32 exec_hi, 2863311530
    buffer_load_dwordx4 v24, s[48:51], s96 offen lds
    s_mov_b64 exec, -1
    s_add_u32 m0, s34, 25600
    s_mov_b32 exec_lo, 1431655765
    s_mov_b32 exec_hi, 1431655765
    buffer_load_dwordx4 v25, s[8:11], s96 offen lds
    s_mov_b32 exec_lo, 2863311530
    s_mov_b32 exec_hi, 2863311530
    buffer_load_dwordx4 v25, s[48:51], s96 offen lds
    s_mov_b64 exec, -1
    s_add_u32 m0, s34, 26624
    s_mov_b32 exec_lo, 1431655765
    s_mov_b32 exec_hi, 1431655765
    buffer_load_dwordx4 v26, s[8:11], s96 offen lds
    s_mov_b32 exec_lo, 2863311530
    s_mov_b32 exec_hi, 2863311530
    buffer_load_dwordx4 v26, s[48:51], s96 offen lds
    s_mov_b64 exec, -1
    s_add_u32 s96, s96, 98304
    s_add_u32 m0, s34, 27648
    s_mov_b32 exec_lo, 1431655765
    s_mov_b32 exec_hi, 1431655765
    buffer_load_dwordx4 v24, s[8:11], s96 offen lds
    s_mov_b32 exec_lo, 2863311530
    s_mov_b32 exec_hi, 2863311530
    buffer_load_dwordx4 v24, s[48:51], s96 offen lds
    s_mov_b64 exec, -1
    s_add_u32 m0, s34, 28672
    s_mov_b32 exec_lo, 1431655765
    s_mov_b32 exec_hi, 1431655765
    buffer_load_dwordx4 v25, s[8:11], s96 offen lds
    s_mov_b32 exec_lo, 2863311530
    s_mov_b32 exec_hi, 2863311530
    buffer_load_dwordx4 v25, s[48:51], s96 offen lds
    s_mov_b64 exec, -1
    s_add_u32 m0, s34, 29696
    s_mov_b32 exec_lo, 1431655765
    s_mov_b32 exec_hi, 1431655765
    buffer_load_dwordx4 v26, s[8:11], s96 offen lds
    s_mov_b32 exec_lo, 2863311530
    s_mov_b32 exec_hi, 2863311530
    buffer_load_dwordx4 v26, s[48:51], s96 offen lds
    s_mov_b64 exec, -1
    s_add_u32 s96, s96, 98304
    s_add_u32 m0, s34, 0
    s_mov_b32 exec_lo, 1431655765
    s_mov_b32 exec_hi, 1431655765
    buffer_load_dwordx4 v24, s[8:11], s96 offen lds
    s_mov_b32 exec_lo, 2863311530
    s_mov_b32 exec_hi, 2863311530
    buffer_load_dwordx4 v24, s[48:51], s96 offen lds
    s_mov_b64 exec, -1
    s_add_u32 m0, s34, 1024
    s_mov_b32 exec_lo, 1431655765
    s_mov_b32 exec_hi, 1431655765
    buffer_load_dwordx4 v25, s[8:11], s96 offen lds
    s_mov_b32 exec_lo, 2863311530
    s_mov_b32 exec_hi, 2863311530
    buffer_load_dwordx4 v25, s[48:51], s96 offen lds
    s_mov_b64 exec, -1
    s_add_u32 m0, s34, 2048
    s_mov_b32 exec_lo, 1431655765
    s_mov_b32 exec_hi, 1431655765
    buffer_load_dwordx4 v26, s[8:11], s96 offen lds
    s_mov_b32 exec_lo, 2863311530
    s_mov_b32 exec_hi, 2863311530
    buffer_load_dwordx4 v26, s[48:51], s96 offen lds
    s_mov_b64 exec, -1
    s_waitcnt vmcnt(54)
    ds_read_b64_tr_b16 a[4:5], v27 offset:3072
    ds_read_b64_tr_b16 a[6:7], v27 offset:4608
    ds_read_b64_tr_b16 a[84:85], v27 offset:3104
    ds_read_b64_tr_b16 a[86:87], v27 offset:4640
    ds_read_b64_tr_b16 a[164:165], v27 offset:3136
    ds_read_b64_tr_b16 a[166:167], v27 offset:4672
    s_waitcnt lgkmcnt(0)
    s_add_u32 s96, s96, 98304
    s_add_u32 m0, s34, 3072
    s_mov_b32 exec_lo, 1431655765
    s_mov_b32 exec_hi, 1431655765
    buffer_load_dwordx4 v24, s[8:11], s96 offen lds
    s_mov_b32 exec_lo, 2863311530
    s_mov_b32 exec_hi, 2863311530
    buffer_load_dwordx4 v24, s[48:51], s96 offen lds
    s_mov_b64 exec, -1
    s_add_u32 m0, s34, 4096
    s_mov_b32 exec_lo, 1431655765
    s_mov_b32 exec_hi, 1431655765
    buffer_load_dwordx4 v25, s[8:11], s96 offen lds
    s_mov_b32 exec_lo, 2863311530
    s_mov_b32 exec_hi, 2863311530
    buffer_load_dwordx4 v25, s[48:51], s96 offen lds
    s_mov_b64 exec, -1
    s_add_u32 m0, s34, 5120
    s_mov_b32 exec_lo, 1431655765
    s_mov_b32 exec_hi, 1431655765
    buffer_load_dwordx4 v26, s[8:11], s96 offen lds
    s_mov_b32 exec_lo, 2863311530
    s_mov_b32 exec_hi, 2863311530
    buffer_load_dwordx4 v26, s[48:51], s96 offen lds
    s_mov_b64 exec, -1
    s_waitcnt vmcnt(54)
    ds_read_b64_tr_b16 a[8:9], v27 offset:6144
    ds_read_b64_tr_b16 a[10:11], v27 offset:7680
    ds_read_b64_tr_b16 a[88:89], v27 offset:6176
    ds_read_b64_tr_b16 a[90:91], v27 offset:7712
    ds_read_b64_tr_b16 a[168:169], v27 offset:6208
    ds_read_b64_tr_b16 a[170:171], v27 offset:7744
    s_waitcnt lgkmcnt(0)
    s_add_u32 s96, s96, 98304
    s_add_u32 m0, s34, 6144
    s_mov_b32 exec_lo, 1431655765
    s_mov_b32 exec_hi, 1431655765
    buffer_load_dwordx4 v24, s[8:11], s96 offen lds
    s_mov_b32 exec_lo, 2863311530
    s_mov_b32 exec_hi, 2863311530
    buffer_load_dwordx4 v24, s[48:51], s96 offen lds
    s_mov_b64 exec, -1
    s_add_u32 m0, s34, 7168
    s_mov_b32 exec_lo, 1431655765
    s_mov_b32 exec_hi, 1431655765
    buffer_load_dwordx4 v25, s[8:11], s96 offen lds
    s_mov_b32 exec_lo, 2863311530
    s_mov_b32 exec_hi, 2863311530
    buffer_load_dwordx4 v25, s[48:51], s96 offen lds
    s_mov_b64 exec, -1
    s_add_u32 m0, s34, 8192
    s_mov_b32 exec_lo, 1431655765
    s_mov_b32 exec_hi, 1431655765
    buffer_load_dwordx4 v26, s[8:11], s96 offen lds
    s_mov_b32 exec_lo, 2863311530
    s_mov_b32 exec_hi, 2863311530
    buffer_load_dwordx4 v26, s[48:51], s96 offen lds
    s_mov_b64 exec, -1
    s_waitcnt vmcnt(54)
    ds_read_b64_tr_b16 a[12:13], v27 offset:9216
    ds_read_b64_tr_b16 a[14:15], v27 offset:10752
    ds_read_b64_tr_b16 a[92:93], v27 offset:9248
    ds_read_b64_tr_b16 a[94:95], v27 offset:10784
    ds_read_b64_tr_b16 a[172:173], v27 offset:9280
    ds_read_b64_tr_b16 a[174:175], v27 offset:10816
    s_waitcnt lgkmcnt(0)
    s_add_u32 s96, s96, 98304
    s_add_u32 m0, s34, 9216
    s_mov_b32 exec_lo, 1431655765
    s_mov_b32 exec_hi, 1431655765
    buffer_load_dwordx4 v24, s[8:11], s96 offen lds
    s_mov_b32 exec_lo, 2863311530
    s_mov_b32 exec_hi, 2863311530
    buffer_load_dwordx4 v24, s[48:51], s96 offen lds
    s_mov_b64 exec, -1
    s_add_u32 m0, s34, 10240
    s_mov_b32 exec_lo, 1431655765
    s_mov_b32 exec_hi, 1431655765
    buffer_load_dwordx4 v25, s[8:11], s96 offen lds
    s_mov_b32 exec_lo, 2863311530
    s_mov_b32 exec_hi, 2863311530
    buffer_load_dwordx4 v25, s[48:51], s96 offen lds
    s_mov_b64 exec, -1
    s_add_u32 m0, s34, 11264
    s_mov_b32 exec_lo, 1431655765
    s_mov_b32 exec_hi, 1431655765
    buffer_load_dwordx4 v26, s[8:11], s96 offen lds
    s_mov_b32 exec_lo, 2863311530
    s_mov_b32 exec_hi, 2863311530
    buffer_load_dwordx4 v26, s[48:51], s96 offen lds
    s_mov_b64 exec, -1
    s_waitcnt vmcnt(54)
    ds_read_b64_tr_b16 a[16:17], v27 offset:12288
    ds_read_b64_tr_b16 a[18:19], v27 offset:13824
    ds_read_b64_tr_b16 a[96:97], v27 offset:12320
    ds_read_b64_tr_b16 a[98:99], v27 offset:13856
    ds_read_b64_tr_b16 a[176:177], v27 offset:12352
    ds_read_b64_tr_b16 a[178:179], v27 offset:13888
    s_waitcnt lgkmcnt(0)
    s_add_u32 s96, s96, 98304
    s_add_u32 m0, s34, 12288
    s_mov_b32 exec_lo, 1431655765
    s_mov_b32 exec_hi, 1431655765
    buffer_load_dwordx4 v24, s[8:11], s96 offen lds
    s_mov_b32 exec_lo, 2863311530
    s_mov_b32 exec_hi, 2863311530
    buffer_load_dwordx4 v24, s[48:51], s96 offen lds
    s_mov_b64 exec, -1
    s_add_u32 m0, s34, 13312
    s_mov_b32 exec_lo, 1431655765
    s_mov_b32 exec_hi, 1431655765
    buffer_load_dwordx4 v25, s[8:11], s96 offen lds
    s_mov_b32 exec_lo, 2863311530
    s_mov_b32 exec_hi, 2863311530
    buffer_load_dwordx4 v25, s[48:51], s96 offen lds
    s_mov_b64 exec, -1
    s_add_u32 m0, s34, 14336
    s_mov_b32 exec_lo, 1431655765
    s_mov_b32 exec_hi, 1431655765
    buffer_load_dwordx4 v26, s[8:11], s96 offen lds
    s_mov_b32 exec_lo, 2863311530
    s_mov_b32 exec_hi, 2863311530
    buffer_load_dwordx4 v26, s[48:51], s96 offen lds
    s_mov_b64 exec, -1
    s_waitcnt vmcnt(54)
    ds_read_b64_tr_b16 a[20:21], v27 offset:15360
    ds_read_b64_tr_b16 a[22:23], v27 offset:16896
    ds_read_b64_tr_b16 a[100:101], v27 offset:15392
    ds_read_b64_tr_b16 a[102:103], v27 offset:16928
    ds_read_b64_tr_b16 a[180:181], v27 offset:15424
    ds_read_b64_tr_b16 a[182:183], v27 offset:16960
    s_waitcnt lgkmcnt(0)
    s_add_u32 s96, s96, 98304
    s_add_u32 m0, s34, 15360
    s_mov_b32 exec_lo, 1431655765
    s_mov_b32 exec_hi, 1431655765
    buffer_load_dwordx4 v24, s[8:11], s96 offen lds
    s_mov_b32 exec_lo, 2863311530
    s_mov_b32 exec_hi, 2863311530
    buffer_load_dwordx4 v24, s[48:51], s96 offen lds
    s_mov_b64 exec, -1
    s_add_u32 m0, s34, 16384
    s_mov_b32 exec_lo, 1431655765
    s_mov_b32 exec_hi, 1431655765
    buffer_load_dwordx4 v25, s[8:11], s96 offen lds
    s_mov_b32 exec_lo, 2863311530
    s_mov_b32 exec_hi, 2863311530
    buffer_load_dwordx4 v25, s[48:51], s96 offen lds
    s_mov_b64 exec, -1
    s_add_u32 m0, s34, 17408
    s_mov_b32 exec_lo, 1431655765
    s_mov_b32 exec_hi, 1431655765
    buffer_load_dwordx4 v26, s[8:11], s96 offen lds
    s_mov_b32 exec_lo, 2863311530
    s_mov_b32 exec_hi, 2863311530
    buffer_load_dwordx4 v26, s[48:51], s96 offen lds
    s_mov_b64 exec, -1
    s_waitcnt vmcnt(54)
    ds_read_b64_tr_b16 a[24:25], v27 offset:18432
    ds_read_b64_tr_b16 a[26:27], v27 offset:19968
    ds_read_b64_tr_b16 a[104:105], v27 offset:18464
    ds_read_b64_tr_b16 a[106:107], v27 offset:20000
    ds_read_b64_tr_b16 a[184:185], v27 offset:18496
    ds_read_b64_tr_b16 a[186:187], v27 offset:20032
    s_waitcnt lgkmcnt(0)
    s_add_u32 s96, s96, 98304
    s_add_u32 m0, s34, 18432
    s_mov_b32 exec_lo, 1431655765
    s_mov_b32 exec_hi, 1431655765
    buffer_load_dwordx4 v24, s[8:11], s96 offen lds
    s_mov_b32 exec_lo, 2863311530
    s_mov_b32 exec_hi, 2863311530
    buffer_load_dwordx4 v24, s[48:51], s96 offen lds
    s_mov_b64 exec, -1
    s_add_u32 m0, s34, 19456
    s_mov_b32 exec_lo, 1431655765
    s_mov_b32 exec_hi, 1431655765
    buffer_load_dwordx4 v25, s[8:11], s96 offen lds
    s_mov_b32 exec_lo, 2863311530
    s_mov_b32 exec_hi, 2863311530
    buffer_load_dwordx4 v25, s[48:51], s96 offen lds
    s_mov_b64 exec, -1
    s_add_u32 m0, s34, 20480
    s_mov_b32 exec_lo, 1431655765
    s_mov_b32 exec_hi, 1431655765
    buffer_load_dwordx4 v26, s[8:11], s96 offen lds
    s_mov_b32 exec_lo, 2863311530
    s_mov_b32 exec_hi, 2863311530
    buffer_load_dwordx4 v26, s[48:51], s96 offen lds
    s_mov_b64 exec, -1
    s_waitcnt vmcnt(54)
    ds_read_b64_tr_b16 a[28:29], v27 offset:21504
    ds_read_b64_tr_b16 a[30:31], v27 offset:23040
    ds_read_b64_tr_b16 a[108:109], v27 offset:21536
    ds_read_b64_tr_b16 a[110:111], v27 offset:23072
    ds_read_b64_tr_b16 a[188:189], v27 offset:21568
    ds_read_b64_tr_b16 a[190:191], v27 offset:23104
    s_waitcnt lgkmcnt(0)
    s_add_u32 s96, s96, 98304
    s_add_u32 m0, s34, 21504
    s_mov_b32 exec_lo, 1431655765
    s_mov_b32 exec_hi, 1431655765
    buffer_load_dwordx4 v24, s[8:11], s96 offen lds
    s_mov_b32 exec_lo, 2863311530
    s_mov_b32 exec_hi, 2863311530
    buffer_load_dwordx4 v24, s[48:51], s96 offen lds
    s_mov_b64 exec, -1
    s_add_u32 m0, s34, 22528
    s_mov_b32 exec_lo, 1431655765
    s_mov_b32 exec_hi, 1431655765
    buffer_load_dwordx4 v25, s[8:11], s96 offen lds
    s_mov_b32 exec_lo, 2863311530
    s_mov_b32 exec_hi, 2863311530
    buffer_load_dwordx4 v25, s[48:51], s96 offen lds
    s_mov_b64 exec, -1
    s_add_u32 m0, s34, 23552
    s_mov_b32 exec_lo, 1431655765
    s_mov_b32 exec_hi, 1431655765
    buffer_load_dwordx4 v26, s[8:11], s96 offen lds
    s_mov_b32 exec_lo, 2863311530
    s_mov_b32 exec_hi, 2863311530
    buffer_load_dwordx4 v26, s[48:51], s96 offen lds
    s_mov_b64 exec, -1
    s_waitcnt vmcnt(54)
    ds_read_b64_tr_b16 a[32:33], v27 offset:24576
    ds_read_b64_tr_b16 a[34:35], v27 offset:26112
    ds_read_b64_tr_b16 a[112:113], v27 offset:24608
    ds_read_b64_tr_b16 a[114:115], v27 offset:26144
    ds_read_b64_tr_b16 a[192:193], v27 offset:24640
    ds_read_b64_tr_b16 a[194:195], v27 offset:26176
    s_waitcnt lgkmcnt(0)
    s_add_u32 s96, s96, 98304
    s_add_u32 m0, s34, 24576
    s_mov_b32 exec_lo, 1431655765
    s_mov_b32 exec_hi, 1431655765
    buffer_load_dwordx4 v24, s[8:11], s96 offen lds
    s_mov_b32 exec_lo, 2863311530
    s_mov_b32 exec_hi, 2863311530
    buffer_load_dwordx4 v24, s[48:51], s96 offen lds
    s_mov_b64 exec, -1
    s_add_u32 m0, s34, 25600
    s_mov_b32 exec_lo, 1431655765
    s_mov_b32 exec_hi, 1431655765
    buffer_load_dwordx4 v25, s[8:11], s96 offen lds
    s_mov_b32 exec_lo, 2863311530
    s_mov_b32 exec_hi, 2863311530
    buffer_load_dwordx4 v25, s[48:51], s96 offen lds
    s_mov_b64 exec, -1
    s_add_u32 m0, s34, 26624
    s_mov_b32 exec_lo, 1431655765
    s_mov_b32 exec_hi, 1431655765
    buffer_load_dwordx4 v26, s[8:11], s96 offen lds
    s_mov_b32 exec_lo, 2863311530
    s_mov_b32 exec_hi, 2863311530
    buffer_load_dwordx4 v26, s[48:51], s96 offen lds
    s_mov_b64 exec, -1
    s_waitcnt vmcnt(54)
    ds_read_b64_tr_b16 a[36:37], v27 offset:27648
    ds_read_b64_tr_b16 a[38:39], v27 offset:29184
    ds_read_b64_tr_b16 a[116:117], v27 offset:27680
    ds_read_b64_tr_b16 a[118:119], v27 offset:29216
    ds_read_b64_tr_b16 a[196:197], v27 offset:27712
    ds_read_b64_tr_b16 a[198:199], v27 offset:29248
    s_waitcnt lgkmcnt(0)
    s_add_u32 s96, s96, 98304
    s_add_u32 m0, s34, 27648
    s_mov_b32 exec_lo, 1431655765
    s_mov_b32 exec_hi, 1431655765
    buffer_load_dwordx4 v24, s[8:11], s96 offen lds
    s_mov_b32 exec_lo, 2863311530
    s_mov_b32 exec_hi, 2863311530
    buffer_load_dwordx4 v24, s[48:51], s96 offen lds
    s_mov_b64 exec, -1
    s_add_u32 m0, s34, 28672
    s_mov_b32 exec_lo, 1431655765
    s_mov_b32 exec_hi, 1431655765
    buffer_load_dwordx4 v25, s[8:11], s96 offen lds
    s_mov_b32 exec_lo, 2863311530
    s_mov_b32 exec_hi, 2863311530
    buffer_load_dwordx4 v25, s[48:51], s96 offen lds
    s_mov_b64 exec, -1
    s_add_u32 m0, s34, 29696
    s_mov_b32 exec_lo, 1431655765
    s_mov_b32 exec_hi, 1431655765
    buffer_load_dwordx4 v26, s[8:11], s96 offen lds
    s_mov_b32 exec_lo, 2863311530
    s_mov_b32 exec_hi, 2863311530
    buffer_load_dwordx4 v26, s[48:51], s96 offen lds
    s_mov_b64 exec, -1
    s_waitcnt vmcnt(54)
    ds_read_b64_tr_b16 a[40:41], v27 offset:0
    ds_read_b64_tr_b16 a[42:43], v27 offset:1536
    ds_read_b64_tr_b16 a[120:121], v27 offset:32
    ds_read_b64_tr_b16 a[122:123], v27 offset:1568
    ds_read_b64_tr_b16 a[200:201], v27 offset:64
    ds_read_b64_tr_b16 a[202:203], v27 offset:1600
    s_waitcnt lgkmcnt(0)
    s_waitcnt vmcnt(48)
    ds_read_b64_tr_b16 a[44:45], v27 offset:3072
    ds_read_b64_tr_b16 a[46:47], v27 offset:4608
    ds_read_b64_tr_b16 a[124:125], v27 offset:3104
    ds_read_b64_tr_b16 a[126:127], v27 offset:4640
    ds_read_b64_tr_b16 a[204:205], v27 offset:3136
    ds_read_b64_tr_b16 a[206:207], v27 offset:4672
    s_waitcnt lgkmcnt(0)
    s_waitcnt vmcnt(42)
    ds_read_b64_tr_b16 a[48:49], v27 offset:6144
    ds_read_b64_tr_b16 a[50:51], v27 offset:7680
    ds_read_b64_tr_b16 a[128:129], v27 offset:6176
    ds_read_b64_tr_b16 a[130:131], v27 offset:7712
    ds_read_b64_tr_b16 a[208:209], v27 offset:6208
    ds_read_b64_tr_b16 a[210:211], v27 offset:7744
    s_waitcnt lgkmcnt(0)
    s_waitcnt vmcnt(36)
    ds_read_b64_tr_b16 a[52:53], v27 offset:9216
    ds_read_b64_tr_b16 a[54:55], v27 offset:10752
    ds_read_b64_tr_b16 a[132:133], v27 offset:9248
    ds_read_b64_tr_b16 a[134:135], v27 offset:10784
    ds_read_b64_tr_b16 a[212:213], v27 offset:9280
    ds_read_b64_tr_b16 a[214:215], v27 offset:10816
    s_waitcnt lgkmcnt(0)
    s_add_u32 m0, s34, 0
    s_nop 0
    buffer_load_dwordx4 v28, s[92:95], s97 offen lds
    s_add_u32 m0, s34, 1024
    s_nop 0
    buffer_load_dwordx4 v29, s[92:95], s97 offen lds
    s_add_u32 m0, s34, 2048
    s_nop 0
    buffer_load_dwordx4 v30, s[92:95], s97 offen lds
    s_add_u32 m0, s34, 3072
    s_nop 0
    buffer_load_dwordx4 v31, s[92:95], s97 offen lds
    s_add_u32 m0, s34, 4096
    s_nop 0
    buffer_load_dwordx4 v32, s[92:95], s97 offen lds
    s_add_u32 m0, s34, 5120
    s_nop 0
    buffer_load_dwordx4 v33, s[92:95], s97 offen lds
    s_add_u32 m0, s34, 6144
    s_nop 0
    buffer_load_dwordx4 v34, s[92:95], s97 offen lds
    s_add_u32 m0, s34, 7168
    s_nop 0
    buffer_load_dwordx4 v35, s[92:95], s97 offen lds
    s_add_u32 m0, s34, 8192
    s_nop 0
    buffer_load_dwordx4 v36, s[92:95], s97 offen lds
    s_add_u32 m0, s34, 9216
    s_nop 0
    buffer_load_dwordx4 v37, s[92:95], s97 offen lds
    s_waitcnt vmcnt(40)
    ds_read_b64_tr_b16 a[56:57], v27 offset:12288
    ds_read_b64_tr_b16 a[58:59], v27 offset:13824
    ds_read_b64_tr_b16 a[136:137], v27 offset:12320
    ds_read_b64_tr_b16 a[138:139], v27 offset:13856
    ds_read_b64_tr_b16 a[216:217], v27 offset:12352
    ds_read_b64_tr_b16 a[218:219], v27 offset:13888
    s_waitcnt lgkmcnt(0)
    s_waitcnt vmcnt(34)
    ds_read_b64_tr_b16 a[60:61], v27 offset:15360
    ds_read_b64_tr_b16 a[62:63], v27 offset:16896
    ds_read_b64_tr_b16 a[140:141], v27 offset:15392
    ds_read_b64_tr_b16 a[142:143], v27 offset:16928
    ds_read_b64_tr_b16 a[220:221], v27 offset:15424
    ds_read_b64_tr_b16 a[222:223], v27 offset:16960
    s_waitcnt lgkmcnt(0)
    s_waitcnt vmcnt(28)
    ds_read_b64_tr_b16 a[64:65], v27 offset:18432
    ds_read_b64_tr_b16 a[66:67], v27 offset:19968
    ds_read_b64_tr_b16 a[144:145], v27 offset:18464
    ds_read_b64_tr_b16 a[146:147], v27 offset:20000
    ds_read_b64_tr_b16 a[224:225], v27 offset:18496
    ds_read_b64_tr_b16 a[226:227], v27 offset:20032
    s_waitcnt lgkmcnt(0)
    s_add_u32 s97, s97, 40960
    s_add_u32 m0, s34, 10240
    s_nop 0
    buffer_load_dwordx4 v28, s[92:95], s97 offen lds
    s_add_u32 m0, s34, 11264
    s_nop 0
    buffer_load_dwordx4 v29, s[92:95], s97 offen lds
    s_add_u32 m0, s34, 12288
    s_nop 0
    buffer_load_dwordx4 v30, s[92:95], s97 offen lds
    s_add_u32 m0, s34, 13312
    s_nop 0
    buffer_load_dwordx4 v31, s[92:95], s97 offen lds
    s_add_u32 m0, s34, 14336
    s_nop 0
    buffer_load_dwordx4 v32, s[92:95], s97 offen lds
    s_add_u32 m0, s34, 15360
    s_nop 0
    buffer_load_dwordx4 v33, s[92:95], s97 offen lds
    s_add_u32 m0, s34, 16384
    s_nop 0
    buffer_load_dwordx4 v34, s[92:95], s97 offen lds
    s_add_u32 m0, s34, 17408
    s_nop 0
    buffer_load_dwordx4 v35, s[92:95], s97 offen lds
    s_add_u32 m0, s34, 18432
    s_nop 0
    buffer_load_dwordx4 v36, s[92:95], s97 offen lds
    s_add_u32 m0, s34, 19456
    s_nop 0
    buffer_load_dwordx4 v37, s[92:95], s97 offen lds
    s_waitcnt vmcnt(32)
    ds_read_b64_tr_b16 a[68:69], v27 offset:21504
    ds_read_b64_tr_b16 a[70:71], v27 offset:23040
    ds_read_b64_tr_b16 a[148:149], v27 offset:21536
    ds_read_b64_tr_b16 a[150:151], v27 offset:23072
    ds_read_b64_tr_b16 a[228:229], v27 offset:21568
    ds_read_b64_tr_b16 a[230:231], v27 offset:23104
    s_waitcnt lgkmcnt(0)
    s_waitcnt vmcnt(26)
    ds_read_b64_tr_b16 a[72:73], v27 offset:24576
    ds_read_b64_tr_b16 a[74:75], v27 offset:26112
    ds_read_b64_tr_b16 a[152:153], v27 offset:24608
    ds_read_b64_tr_b16 a[154:155], v27 offset:26144
    ds_read_b64_tr_b16 a[232:233], v27 offset:24640
    ds_read_b64_tr_b16 a[234:235], v27 offset:26176
    s_waitcnt lgkmcnt(0)
    s_waitcnt vmcnt(20)
    ds_read_b64_tr_b16 a[76:77], v27 offset:27648
    ds_read_b64_tr_b16 a[78:79], v27 offset:29184
    ds_read_b64_tr_b16 a[156:157], v27 offset:27680
    ds_read_b64_tr_b16 a[158:159], v27 offset:29216
    ds_read_b64_tr_b16 a[236:237], v27 offset:27712
    ds_read_b64_tr_b16 a[238:239], v27 offset:29248
    s_waitcnt lgkmcnt(0)
    s_add_u32 s97, s97, 40960
    s_add_u32 m0, s34, 20480
    s_nop 0
    buffer_load_dwordx4 v28, s[92:95], s97 offen lds
    s_add_u32 m0, s34, 21504
    s_nop 0
    buffer_load_dwordx4 v29, s[92:95], s97 offen lds
    s_add_u32 m0, s34, 22528
    s_nop 0
    buffer_load_dwordx4 v30, s[92:95], s97 offen lds
    s_add_u32 m0, s34, 23552
    s_nop 0
    buffer_load_dwordx4 v31, s[92:95], s97 offen lds
    s_add_u32 m0, s34, 24576
    s_nop 0
    buffer_load_dwordx4 v32, s[92:95], s97 offen lds
    s_add_u32 m0, s34, 25600
    s_nop 0
    buffer_load_dwordx4 v33, s[92:95], s97 offen lds
    s_add_u32 m0, s34, 26624
    s_nop 0
    buffer_load_dwordx4 v34, s[92:95], s97 offen lds
    s_add_u32 m0, s34, 27648
    s_nop 0
    buffer_load_dwordx4 v35, s[92:95], s97 offen lds
    s_add_u32 m0, s34, 28672
    s_nop 0
    buffer_load_dwordx4 v36, s[92:95], s97 offen lds
    s_add_u32 m0, s34, 29696
    s_nop 0
    buffer_load_dwordx4 v37, s[92:95], s97 offen lds
    s_waitcnt vmcnt(20)
    ds_read_b64_tr_b16 v[136:137], v38 offset:0
    ds_read_b64_tr_b16 v[138:139], v38 offset:5120
    ds_read_b64_tr_b16 v[148:149], v38 offset:32
    ds_read_b64_tr_b16 v[150:151], v38 offset:5152
    ds_read_b64_tr_b16 v[160:161], v38 offset:64
    ds_read_b64_tr_b16 v[162:163], v38 offset:5184
    ds_read_b64_tr_b16 v[172:173], v38 offset:96
    ds_read_b64_tr_b16 v[174:175], v38 offset:5216
    ds_read_b64_tr_b16 v[184:185], v38 offset:128
    ds_read_b64_tr_b16 v[186:187], v38 offset:5248
    ds_read_b64_tr_b16 v[196:197], v38 offset:160
    ds_read_b64_tr_b16 v[198:199], v38 offset:5280
    ds_read_b64_tr_b16 v[208:209], v38 offset:192
    ds_read_b64_tr_b16 v[210:211], v38 offset:5312
    ds_read_b64_tr_b16 v[220:221], v38 offset:224
    ds_read_b64_tr_b16 v[222:223], v38 offset:5344
    ds_read_b64_tr_b16 v[232:233], v38 offset:256
    ds_read_b64_tr_b16 v[234:235], v38 offset:5376
    ds_read_b64_tr_b16 v[244:245], v38 offset:288
    ds_read_b64_tr_b16 v[246:247], v38 offset:5408
    s_waitcnt lgkmcnt(0)
    s_waitcnt vmcnt(10)
    ds_read_b64_tr_b16 v[140:141], v38 offset:10240
    ds_read_b64_tr_b16 v[142:143], v38 offset:15360
    ds_read_b64_tr_b16 v[152:153], v38 offset:10272
    ds_read_b64_tr_b16 v[154:155], v38 offset:15392
    ds_read_b64_tr_b16 v[164:165], v38 offset:10304
    ds_read_b64_tr_b16 v[166:167], v38 offset:15424
    ds_read_b64_tr_b16 v[176:177], v38 offset:10336
    ds_read_b64_tr_b16 v[178:179], v38 offset:15456
    ds_read_b64_tr_b16 v[188:189], v38 offset:10368
    ds_read_b64_tr_b16 v[190:191], v38 offset:15488
    ds_read_b64_tr_b16 v[200:201], v38 offset:10400
    ds_read_b64_tr_b16 v[202:203], v38 offset:15520
    ds_read_b64_tr_b16 v[212:213], v38 offset:10432
    ds_read_b64_tr_b16 v[214:215], v38 offset:15552
    ds_read_b64_tr_b16 v[224:225], v38 offset:10464
    ds_read_b64_tr_b16 v[226:227], v38 offset:15584
    ds_read_b64_tr_b16 v[236:237], v38 offset:10496
    ds_read_b64_tr_b16 v[238:239], v38 offset:15616
    ds_read_b64_tr_b16 v[248:249], v38 offset:10528
    ds_read_b64_tr_b16 v[250:251], v38 offset:15648
    s_waitcnt lgkmcnt(0)
    s_waitcnt vmcnt(0)
    ds_read_b64_tr_b16 v[144:145], v38 offset:20480
    ds_read_b64_tr_b16 v[146:147], v38 offset:25600
    ds_read_b64_tr_b16 v[156:157], v38 offset:20512
    ds_read_b64_tr_b16 v[158:159], v38 offset:25632
    ds_read_b64_tr_b16 v[168:169], v38 offset:20544
    ds_read_b64_tr_b16 v[170:171], v38 offset:25664
    ds_read_b64_tr_b16 v[180:181], v38 offset:20576
    ds_read_b64_tr_b16 v[182:183], v38 offset:25696
    ds_read_b64_tr_b16 v[192:193], v38 offset:20608
    ds_read_b64_tr_b16 v[194:195], v38 offset:25728
    ds_read_b64_tr_b16 v[204:205], v38 offset:20640
    ds_read_b64_tr_b16 v[206:207], v38 offset:25760
    ds_read_b64_tr_b16 v[216:217], v38 offset:20672
    ds_read_b64_tr_b16 v[218:219], v38 offset:25792
    ds_read_b64_tr_b16 v[228:229], v38 offset:20704
    ds_read_b64_tr_b16 v[230:231], v38 offset:25824
    ds_read_b64_tr_b16 v[240:241], v38 offset:20736
    ds_read_b64_tr_b16 v[242:243], v38 offset:25856
    ds_read_b64_tr_b16 v[252:253], v38 offset:20768
    ds_read_b64_tr_b16 v[254:255], v38 offset:25888
    s_waitcnt lgkmcnt(0)
    v_and_b32 v24, 1, v0
    v_lshlrev_b32 v24, 4, v24
    v_mov_b32 v25, 0x3f80
    v_lshlrev_b32 v25, v24, v25
    v_bfe_u32 v24, v0, 1, 3
    v_cmp_eq_u32 vcc, 0, v24
    s_nop 1
    v_cndmask_b32 v26, 0, v25, vcc
    v_accvgpr_write_b32 a240, v26
    v_cmp_eq_u32 vcc, 4, v24
    s_nop 1
    v_cndmask_b32 v26, 0, v25, vcc
    v_accvgpr_write_b32 a244, v26
    v_cmp_eq_u32 vcc, 1, v24
    s_nop 1
    v_cndmask_b32 v26, 0, v25, vcc
    v_accvgpr_write_b32 a241, v26
    v_cmp_eq_u32 vcc, 5, v24
    s_nop 1
    v_cndmask_b32 v26, 0, v25, vcc
    v_accvgpr_write_b32 a245, v26
    v_cmp_eq_u32 vcc, 2, v24
    s_nop 1
    v_cndmask_b32 v26, 0, v25, vcc
    v_accvgpr_write_b32 a242, v26
    v_cmp_eq_u32 vcc, 6, v24
    s_nop 1
    v_cndmask_b32 v26, 0, v25, vcc
    v_accvgpr_write_b32 a246, v26
    v_cmp_eq_u32 vcc, 3, v24
    s_nop 1
    v_cndmask_b32 v26, 0, v25, vcc
    v_accvgpr_write_b32 a243, v26
    v_cmp_eq_u32 vcc, 7, v24
    s_nop 1
    v_cndmask_b32 v26, 0, v25, vcc
    v_accvgpr_write_b32 a247, v26
    s_mul_i32 s63, s12, 10240
    s_and_b32 s3, s12, 1
    s_lshl_b32 s3, s3, 2
    v_lshrrev_b32 v24, 3, v0
    v_mul_u32_u24 v1, 1280, v24
    v_lshrrev_b32 v24, 4, v0
    v_add_u32 v24, s3, v24
    v_and_b32 v25, 7, v0
    v_xor_b32 v24, v24, v25
    v_lshl_add_u32 v1, v24, 4, v1
    v_add_u32 v1, s63, v1
    v_bfe_u32 v24, v0, 3, 1
    v_mul_u32_u24 v2, 10240, v24
    v_lshl_add_u32 v2, v25, 7, v2
    v_bfe_u32 v24, v0, 1, 3
    v_lshrrev_b32 v25, 4, v0
    v_xor_b32 v24, v24, v25
    v_lshl_add_u32 v2, v24, 4, v2
    v_xor_b32 v3, 64, v2
    s_mov_b32 s92, s86
    s_and_b32 s93, s87, 0xffff
    s_mov_b32 s94, 2621440
    s_mov_b32 s95, 0x20000
    v_and_b32 v24, 15, v0
    v_lshrrev_b32 v25, 4, v0
    s_mov_b32 s3, 20480
    v_mul_lo_u32 v4, v24, s3
    v_lshl_add_u32 v4, v25, 4, v4
    v_add_u32 v4, s25, v4
    v_mul_u32_u24 v5, 1280, v25
    v_lshl_add_u32 v5, v24, 4, v5
    s_mul_i32 s30, s20, 655360
    s_mul_i32 s3, s21, 1280
    s_add_u32 s30, s30, s3
    s_add_u32 s30, s30, 211943424
    s_add_u32 s31, s30, 327680
    s_mov_b32 s39, 1310720
    v_and_b32 v9, 31, v0
    v_lshlrev_b32 v9, 9, v9
    s_lshl_b32 s24, s20, 14
    s_add_u32 s24, s24, 81920
    v_lshrrev_b32 v26, 5, v0
    v_mul_u32_u24 v26, 3072, v26
    v_lshl_add_u32 v26, v24, 4, v26
    v_and_b32 v27, 1, v25
    v_lshl_add_u32 v26, v27, 8, v26
    v_add_u32 v13, 40960, v26
    s_mul_i32 s3, s12, 3072
    s_add_u32 s3, s3, 47104
    v_add_u32 v14, s3, v16
    s_mov_b32 s40, 3216550459
    s_mov_b32 s22, 0
    s_mul_i32 s38, s20, 2621440
    s_lshl_b32 s26, s21, 1
    s_lshr_b32 s27, s12, 1
    s_add_u32 s26, s26, s27
    s_mul_i32 s26, s26, 1280
    s_add_u32 s35, s38, s26
    s_add_u32 s35, s35, 198836224
    s_add_u32 s38, s38, 193593344
    s_add_u32 s37, s26, 190971904
    s_add_u32 s36, s26, 204079104
    s_cmp_eq_u32 s20, 0
    s_cselect_b32 s36, s36, s26
    s_lshl_b32 s3, s18, 2
    s_add_u32 s3, s3, 64
    v_mov_b32 v92, s3
    v_lshlrev_b32 v94, 2, v0
    v_and_b32 v94, 28, v94
    s_mov_b32 s19, 0
L_G_warr_2:
    global_load_dword v93, v92, s[16:17] sc1
    s_add_u32 s19, s19, 1
    s_cmp_ge_u32 s19, 524288
    s_cbranch_scc1 L_fail
    s_waitcnt vmcnt(0)
    v_cmp_gt_u32 vcc, 256, v93
    s_nop 0
    s_cbranch_vccnz L_G_warr_2
    s_cmp_lg_u32 s18, 0
    s_cbranch_scc1 L_G_placed_3
    global_load_dword v93, v94, s[16:17] sc1
    s_waitcnt vmcnt(0)
    v_cmp_ne_u32 vcc, 32, v93
    s_nop 0
    s_cbranch_vccnz L_fallback
L_G_placed_3:
    v_mov_b32 v0, v16
    s_barrier
    s_cmp_lg_u32 s18, 0
    s_cbranch_scc1 L_G_slow
L_Gf_top:
    buffer_load_dword v10, v9, s[4:7], s24 offen sc1
    s_lshr_b32 s25, s22, 1
    s_andn2_b32 s28, 1, s25
    s_sub_u32 s29, 0, s28
    s_add_u32 s41, s22, 1
    s_waitcnt vmcnt(0)
    s_bitcmp1_b32 s12, 0
    s_cbranch_scc1 L_Gf_noflag_1
    v_mov_b32 v11, s22
    s_mov_b64 exec, 1
    buffer_store_dword v11, v0, s[4:7], s23 offen offset:0 sc1
    s_mov_b64 exec, -1
L_Gf_noflag_1:
    s_mov_b32 s19, 0
    v_cmp_gt_u32 vcc, s41, v10
    s_nop 0
    s_cbranch_vccnz L_Gf_flspin_3
L_Gf_fl_2:
    s_add_u32 m0, s63, 0
    s_nop 0
    buffer_load_dwordx4 v1, s[4:7], s38 offen offset:0 sc1 lds
    s_add_u32 m0, s63, 896
    s_nop 0
    buffer_load_dwordx4 v1, s[4:7], s38 offen offset:128 sc1 lds
    s_add_u32 m0, s63, 1792
    s_nop 0
    buffer_load_dwordx4 v1, s[4:7], s38 offen offset:256 sc1 lds
    s_add_u32 m0, s63, 2688
    s_nop 0
    buffer_load_dwordx4 v1, s[4:7], s38 offen offset:384 sc1 lds
    s_add_u32 m0, s63, 3584
    s_nop 0
    buffer_load_dwordx4 v1, s[4:7], s38 offen offset:512 sc1 lds
    s_add_u32 m0, s63, 4480
    s_nop 0
    buffer_load_dwordx4 v1, s[4:7], s38 offen offset:640 sc1 lds
    s_add_u32 m0, s63, 5376
    s_nop 0
    buffer_load_dwordx4 v1, s[4:7], s38 offen offset:768 sc1 lds
    s_add_u32 m0, s63, 6272
    s_nop 0
    buffer_load_dwordx4 v1, s[4:7], s38 offen offset:896 sc1 lds
    s_add_u32 m0, s63, 7168
    s_nop 0
    buffer_load_dwordx4 v1, s[4:7], s38 offen offset:1024 sc1 lds
    s_add_u32 m0, s63, 8064
    s_nop 0
    buffer_load_dwordx4 v1, s[4:7], s38 offen offset:1152 sc1 lds
    buffer_load_dwordx2 v[120:121], v6, s[4:7], s35 offen offset:0 sc1
    buffer_load_dwordx2 v[122:123], v6, s[4:7], s35 offen offset:512 sc1
    s_mov_b64 exec, s[44:45]
    buffer_load_dwordx2 v[124:125], v6, s[4:7], s35 offen offset:1024 sc1
    s_mov_b64 exec, -1
    s_waitcnt vmcnt(3)
    s_barrier
    ds_read_b128 v[16:19], v2 offset:0
    ds_read_b128 v[20:23], v2 offset:20480
    ds_read_b128 v[24:27], v3 offset:0
    ds_read_b128 v[28:31], v3 offset:20480
    ds_read_b128 v[32:35], v2 offset:1024
    ds_read_b128 v[36:39], v2 offset:21504
    s_waitcnt lgkmcnt(4)
    v_mfma_f32_16x16x32_bf16 v[40:43], a[0:3], v[16:19], 0
    v_mfma_f32_16x16x32_bf16 v[44:47], a[0:3], v[20:23], 0
    v_mfma_f32_16x16x32_bf16 v[48:51], a[80:83], v[16:19], 0
    v_mfma_f32_16x16x32_bf16 v[52:55], a[80:83], v[20:23], 0
    v_mfma_f32_16x16x32_bf16 v[56:59], a[160:163], v[16:19], 0
    v_mfma_f32_16x16x32_bf16 v[60:63], a[160:163], v[20:23], 0
    ds_read_b128 v[16:19], v3 offset:1024
    ds_read_b128 v[20:23], v3 offset:21504
    s_waitcnt lgkmcnt(4)
    v_mfma_f32_16x16x32_bf16 v[40:43], a[4:7], v[24:27], v[40:43]
    v_mfma_f32_16x16x32_bf16 v[44:47], a[4:7], v[28:31], v[44:47]
    v_mfma_f32_16x16x32_bf16 v[48:51], a[84:87], v[24:27], v[48:51]
    v_mfma_f32_16x16x32_bf16 v[52:55], a[84:87], v[28:31], v[52:55]
    v_mfma_f32_16x16x32_bf16 v[56:59], a[164:167], v[24:27], v[56:59]
    v_mfma_f32_16x16x32_bf16 v[60:63], a[164:167], v[28:31], v[60:63]
    ds_read_b128 v[24:27], v2 offset:2048
    ds_read_b128 v[28:31], v2 offset:22528
    s_waitcnt lgkmcnt(4)
    v_mfma_f32_16x16x32_bf16 v[40:43], a[8:11], v[32:35], v[40:43]
    v_mfma_f32_16x16x32_bf16 v[44:47], a[8:11], v[36:39], v[44:47]
    v_mfma_f32_16x16x32_bf16 v[48:51], a[88:91], v[32:35], v[48:51]
    v_mfma_f32_16x16x32_bf16 v[52:55], a[88:91], v[36:39], v[52:55]
    v_mfma_f32_16x16x32_bf16 v[56:59], a[168:171], v[32:35], v[56:59]
    v_mfma_f32_16x16x32_bf16 v[60:63], a[168:171], v[36:39], v[60:63]
    ds_read_b128 v[32:35], v3 offset:2048
    ds_read_b128 v[36:39], v3 offset:22528
    s_waitcnt lgkmcnt(4)
    v_mfma_f32_16x16x32_bf16 v[40:43], a[12:15], v[16:19], v[40:43]
    v_mfma_f32_16x16x32_bf16 v[44:47], a[12:15], v[20:23], v[44:47]
    v_mfma_f32_16x16x32_bf16 v[48:51], a[92:95], v[16:19], v[48:51]
    v_mfma_f32_16x16x32_bf16 v[52:55], a[92:95], v[20:23], v[52:55]
    v_mfma_f32_16x16x32_bf16 v[56:59], a[172:175], v[16:19], v[56:59]
    v_mfma_f32_16x16x32_bf16 v[60:63], a[172:175], v[20:23], v[60:63]
    ds_read_b128 v[16:19], v2 offset:3072
    ds_read_b128 v[20:23], v2 offset:23552
    s_waitcnt lgkmcnt(4)
    v_mfma_f32_16x16x32_bf16 v[40:43], a[16:19], v[24:27], v[40:43]
    v_mfma_f32_16x16x32_bf16 v[44:47], a[16:19], v[28:31], v[44:47]
    v_mfma_f32_16x16x32_bf16 v[48:51], a[96:99], v[24:27], v[48:51]
    v_mfma_f32_16x16x32_bf16 v[52:55], a[96:99], v[28:31], v[52:55]
    v_mfma_f32_16x16x32_bf16 v[56:59], a[176:179], v[24:27], v[56:59]
    v_mfma_f32_16x16x32_bf16 v[60:63], a[176:179], v[28:31], v[60:63]
    ds_read_b128 v[24:27], v3 offset:3072
    ds_read_b128 v[28:31], v3 offset:23552
    s_waitcnt lgkmcnt(4)
    v_mfma_f32_16x16x32_bf16 v[40:43], a[20:23], v[32:35], v[40:43]
    v_mfma_f32_16x16x32_bf16 v[44:47], a[20:23], v[36:39], v[44:47]
    v_mfma_f32_16x16x32_bf16 v[48:51], a[100:103], v[32:35], v[48:51]
    v_mfma_f32_16x16x32_bf16 v[52:55], a[100:103], v[36:39], v[52:55]
    v_mfma_f32_16x16x32_bf16 v[56:59], a[180:183], v[32:35], v[56:59]
    v_mfma_f32_16x16x32_bf16 v[60:63], a[180:183], v[36:39], v[60:63]
    ds_read_b128 v[32:35], v2 offset:4096
    ds_read_b128 v[36:39], v2 offset:24576
    s_waitcnt lgkmcnt(4)
    v_mfma_f32_16x16x32_bf16 v[40:43], a[24:27], v[16:19], v[40:43]
    v_mfma_f32_16x16x32_bf16 v[44:47], a[24:27], v[20:23], v[44:47]
    v_mfma_f32_16x16x32_bf16 v[48:51], a[104:107], v[16:19], v[48:51]
    v_mfma_f32_16x16x32_bf16 v[52:55], a[104:107], v[20:23], v[52:55]
    v_mfma_f32_16x16x32_bf16 v[56:59], a[184:187], v[16:19], v[56:59]
    v_mfma_f32_16x16x32_bf16 v[60:63], a[184:187], v[20:23], v[60:63]
    ds_read_b128 v[16:19], v3 offset:4096
    ds_read_b128 v[20:23], v3 offset:24576
    s_waitcnt lgkmcnt(4)
    v_mfma_f32_16x16x32_bf16 v[40:43], a[28:31], v[24:27], v[40:43]
    v_mfma_f32_16x16x32_bf16 v[44:47], a[28:31], v[28:31], v[44:47]
    v_mfma_f32_16x16x32_bf16 v[48:51], a[108:111], v[24:27], v[48:51]
    v_mfma_f32_16x16x32_bf16 v[52:55], a[108:111], v[28:31], v[52:55]
    v_mfma_f32_16x16x32_bf16 v[56:59], a[188:191], v[24:27], v[56:59]
    v_mfma_f32_16x16x32_bf16 v[60:63], a[188:191], v[28:31], v[60:63]
    ds_read_b128 v[24:27], v2 offset:5120
    ds_read_b128 v[28:31], v2 offset:25600
    s_waitcnt lgkmcnt(4)
    v_mfma_f32_16x16x32_bf16 v[40:43], a[32:35], v[32:35], v[40:43]
    v_mfma_f32_16x16x32_bf16 v[44:47], a[32:35], v[36:39], v[44:47]
    v_mfma_f32_16x16x32_bf16 v[48:51], a[112:115], v[32:35], v[48:51]
    v_mfma_f32_16x16x32_bf16 v[52:55], a[112:115], v[36:39], v[52:55]
    v_mfma_f32_16x16x32_bf16 v[56:59], a[192:195], v[32:35], v[56:59]
    v_mfma_f32_16x16x32_bf16 v[60:63], a[192:195], v[36:39], v[60:63]
    ds_read_b128 v[32:35], v3 offset:5120
    ds_read_b128 v[36:39], v3 offset:25600
    s_waitcnt lgkmcnt(4)
    v_mfma_f32_16x16x32_bf16 v[40:43], a[36:39], v[16:19], v[40:43]
    v_mfma_f32_16x16x32_bf16 v[44:47], a[36:39], v[20:23], v[44:47]
    v_mfma_f32_16x16x32_bf16 v[48:51], a[116:119], v[16:19], v[48:51]
    v_mfma_f32_16x16x32_bf16 v[52:55], a[116:119], v[20:23], v[52:55]
    v_mfma_f32_16x16x32_bf16 v[56:59], a[196:199], v[16:19], v[56:59]
    v_mfma_f32_16x16x32_bf16 v[60:63], a[196:199], v[20:23], v[60:63]
    ds_read_b128 v[16:19], v2 offset:6144
    ds_read_b128 v[20:23], v2 offset:26624
    s_waitcnt lgkmcnt(4)
    v_mfma_f32_16x16x32_bf16 v[40:43], a[40:43], v[24:27], v[40:43]
    v_mfma_f32_16x16x32_bf16 v[44:47], a[40:43], v[28:31], v[44:47]
    v_mfma_f32_16x16x32_bf16 v[48:51], a[120:123], v[24:27], v[48:51]
    v_mfma_f32_16x16x32_bf16 v[52:55], a[120:123], v[28:31], v[52:55]
    v_mfma_f32_16x16x32_bf16 v[56:59], a[200:203], v[24:27], v[56:59]
    v_mfma_f32_16x16x32_bf16 v[60:63], a[200:203], v[28:31], v[60:63]
    ds_read_b128 v[24:27], v3 offset:6144
    ds_read_b128 v[28:31], v3 offset:26624
    s_waitcnt lgkmcnt(4)
    v_mfma_f32_16x16x32_bf16 v[40:43], a[44:47], v[32:35], v[40:43]
    v_mfma_f32_16x16x32_bf16 v[44:47], a[44:47], v[36:39], v[44:47]
    v_mfma_f32_16x16x32_bf16 v[48:51], a[124:127], v[32:35], v[48:51]
    v_mfma_f32_16x16x32_bf16 v[52:55], a[124:127], v[36:39], v[52:55]
    v_mfma_f32_16x16x32_bf16 v[56:59], a[204:207], v[32:35], v[56:59]
    v_mfma_f32_16x16x32_bf16 v[60:63], a[204:207], v[36:39], v[60:63]
    ds_read_b128 v[32:35], v2 offset:7168
    ds_read_b128 v[36:39], v2 offset:27648
    s_waitcnt lgkmcnt(4)
    v_mfma_f32_16x16x32_bf16 v[40:43], a[48:51], v[16:19], v[40:43]
    v_mfma_f32_16x16x32_bf16 v[44:47], a[48:51], v[20:23], v[44:47]
    v_mfma_f32_16x16x32_bf16 v[48:51], a[128:131], v[16:19], v[48:51]
    v_mfma_f32_16x16x32_bf16 v[52:55], a[128:131], v[20:23], v[52:55]
    v_mfma_f32_16x16x32_bf16 v[56:59], a[208:211], v[16:19], v[56:59]
    v_mfma_f32_16x16x32_bf16 v[60:63], a[208:211], v[20:23], v[60:63]
    ds_read_b128 v[16:19], v3 offset:7168
    ds_read_b128 v[20:23], v3 offset:27648
    s_waitcnt lgkmcnt(4)
    v_mfma_f32_16x16x32_bf16 v[40:43], a[52:55], v[24:27], v[40:43]
    v_mfma_f32_16x16x32_bf16 v[44:47], a[52:55], v[28:31], v[44:47]
    v_mfma_f32_16x16x32_bf16 v[48:51], a[132:135], v[24:27], v[48:51]
    v_mfma_f32_16x16x32_bf16 v[52:55], a[132:135], v[28:31], v[52:55]
    v_mfma_f32_16x16x32_bf16 v[56:59], a[212:215], v[24:27], v[56:59]
    v_mfma_f32_16x16x32_bf16 v[60:63], a[212:215], v[28:31], v[60:63]
    ds_read_b128 v[24:27], v2 offset:8192
    ds_read_b128 v[28:31], v2 offset:28672
    s_waitcnt lgkmcnt(4)
    v_mfma_f32_16x16x32_bf16 v[40:43], a[56:59], v[32:35], v[40:43]
    v_mfma_f32_16x16x32_bf16 v[44:47], a[56:59], v[36:39], v[44:47]
    v_mfma_f32_16x16x32_bf16 v[48:51], a[136:139], v[32:35], v[48:51]
    v_mfma_f32_16x16x32_bf16 v[52:55], a[136:139], v[36:39], v[52:55]
    v_mfma_f32_16x16x32_bf16 v[56:59], a[216:219], v[32:35], v[56:59]
    v_mfma_f32_16x16x32_bf16 v[60:63], a[216:219], v[36:39], v[60:63]
    ds_read_b128 v[32:35], v3 offset:8192
    ds_read_b128 v[36:39], v3 offset:28672
    s_waitcnt lgkmcnt(4)
    v_mfma_f32_16x16x32_bf16 v[40:43], a[60:63], v[16:19], v[40:43]
    v_mfma_f32_16x16x32_bf16 v[44:47], a[60:63], v[20:23], v[44:47]
    v_mfma_f32_16x16x32_bf16 v[48:51], a[140:143], v[16:19], v[48:51]
    v_mfma_f32_16x16x32_bf16 v[52:55], a[140:143], v[20:23], v[52:55]
    v_mfma_f32_16x16x32_bf16 v[56:59], a[220:223], v[16:19], v[56:59]
    v_mfma_f32_16x16x32_bf16 v[60:63], a[220:223], v[20:23], v[60:63]
    ds_read_b128 v[16:19], v2 offset:9216
    ds_read_b128 v[20:23], v2 offset:29696
    s_waitcnt lgkmcnt(4)
    v_mfma_f32_16x16x32_bf16 v[40:43], a[64:67], v[24:27], v[40:43]
    v_mfma_f32_16x16x32_bf16 v[44:47], a[64:67], v[28:31], v[44:47]
    v_mfma_f32_16x16x32_bf16 v[48:51], a[144:147], v[24:27], v[48:51]
    v_mfma_f32_16x16x32_bf16 v[52:55], a[144:147], v[28:31], v[52:55]
    v_mfma_f32_16x16x32_bf16 v[56:59], a[224:227], v[24:27], v[56:59]
    v_mfma_f32_16x16x32_bf16 v[60:63], a[224:227], v[28:31], v[60:63]
    ds_read_b128 v[24:27], v3 offset:9216
    ds_read_b128 v[28:31], v3 offset:29696
    s_waitcnt lgkmcnt(4)
    v_mfma_f32_16x16x32_bf16 v[40:43], a[68:71], v[32:35], v[40:43]
    v_mfma_f32_16x16x32_bf16 v[44:47], a[68:71], v[36:39], v[44:47]
    v_mfma_f32_16x16x32_bf16 v[48:51], a[148:151], v[32:35], v[48:51]
    v_mfma_f32_16x16x32_bf16 v[52:55], a[148:151], v[36:39], v[52:55]
    v_mfma_f32_16x16x32_bf16 v[56:59], a[228:231], v[32:35], v[56:59]
    v_mfma_f32_16x16x32_bf16 v[60:63], a[228:231], v[36:39], v[60:63]
    s_waitcnt lgkmcnt(2)
    v_mfma_f32_16x16x32_bf16 v[40:43], a[72:75], v[16:19], v[40:43]
    v_mfma_f32_16x16x32_bf16 v[44:47], a[72:75], v[20:23], v[44:47]
    v_mfma_f32_16x16x32_bf16 v[48:51], a[152:155], v[16:19], v[48:51]
    v_mfma_f32_16x16x32_bf16 v[52:55], a[152:155], v[20:23], v[52:55]
    v_mfma_f32_16x16x32_bf16 v[56:59], a[232:235], v[16:19], v[56:59]
    v_mfma_f32_16x16x32_bf16 v[60:63], a[232:235], v[20:23], v[60:63]
    s_waitcnt lgkmcnt(0)
    v_mfma_f32_16x16x32_bf16 v[40:43], a[76:79], v[24:27], v[40:43]
    v_mfma_f32_16x16x32_bf16 v[44:47], a[76:79], v[28:31], v[44:47]
    v_mfma_f32_16x16x32_bf16 v[48:51], a[156:159], v[24:27], v[48:51]
    v_mfma_f32_16x16x32_bf16 v[52:55], a[156:159], v[28:31], v[52:55]
    v_mfma_f32_16x16x32_bf16 v[56:59], a[236:239], v[24:27], v[56:59]
    v_mfma_f32_16x16x32_bf16 v[60:63], a[236:239], v[28:31], v[60:63]
    s_nop 3
    v_permlane32_swap_b32 v40, v44
    v_permlane32_swap_b32 v41, v45
    v_permlane32_swap_b32 v42, v46
    v_permlane32_swap_b32 v43, v47
    v_permlane32_swap_b32 v48, v52
    v_permlane32_swap_b32 v49, v53
    v_permlane32_swap_b32 v50, v54
    v_permlane32_swap_b32 v51, v55
    v_permlane32_swap_b32 v56, v60
    v_permlane32_swap_b32 v57, v61
    v_permlane32_swap_b32 v58, v62
    v_permlane32_swap_b32 v59, v63
    v_cvt_pk_bf16_f32 v16, v40, v41
    v_cvt_pk_bf16_f32 v17, v42, v43
    v_cvt_pk_bf16_f32 v18, v48, v49
    v_cvt_pk_bf16_f32 v19, v50, v51
    v_cvt_pk_bf16_f32 v20, v56, v57
    v_cvt_pk_bf16_f32 v21, v58, v59
    v_lshlrev_b32 v40, 16, v16
    v_and_b32 v41, 0xffff0000, v16
    v_lshlrev_b32 v42, 16, v17
    v_and_b32 v43, 0xffff0000, v17
    v_lshlrev_b32 v48, 16, v18
    v_and_b32 v49, 0xffff0000, v18
    v_lshlrev_b32 v50, 16, v19
    v_and_b32 v51, 0xffff0000, v19
    v_lshlrev_b32 v56, 16, v20
    v_and_b32 v57, 0xffff0000, v20
    v_lshlrev_b32 v58, 16, v21
    v_and_b32 v59, 0xffff0000, v21
    v_cvt_pk_bf16_f32 v22, v44, v45
    v_cvt_pk_bf16_f32 v23, v46, v47
    v_cvt_pk_bf16_f32 v24, v52, v53
    v_cvt_pk_bf16_f32 v25, v54, v55
    v_cvt_pk_bf16_f32 v26, v60, v61
    v_cvt_pk_bf16_f32 v27, v62, v63
    v_lshlrev_b32 v44, 16, v22
    v_and_b32 v45, 0xffff0000, v22
    v_lshlrev_b32 v46, 16, v23
    v_and_b32 v47, 0xffff0000, v23
    v_lshlrev_b32 v52, 16, v24
    v_and_b32 v53, 0xffff0000, v24
    v_lshlrev_b32 v54, 16, v25
    v_and_b32 v55, 0xffff0000, v25
    v_lshlrev_b32 v60, 16, v26
    v_and_b32 v61, 0xffff0000, v26
    v_lshlrev_b32 v62, 16, v27
    v_and_b32 v63, 0xffff0000, v27
    v_mul_f32 v40, s40, v40
    v_mul_f32 v41, s40, v41
    v_mul_f32 v42, s40, v42
    v_mul_f32 v43, s40, v43
    v_mul_f32 v48, s40, v48
    v_mul_f32 v49, s40, v49
    v_mul_f32 v50, s40, v50
    v_mul_f32 v51, s40, v51
    v_mul_f32 v56, s40, v56
    v_mul_f32 v57, s40, v57
    v_mul_f32 v58, s40, v58
    v_mul_f32 v59, s40, v59
    v_exp_f32 v40, v40
    v_exp_f32 v41, v41
    v_exp_f32 v42, v42
    v_exp_f32 v43, v43
    v_exp_f32 v48, v48
    v_exp_f32 v49, v49
    v_exp_f32 v50, v50
    v_exp_f32 v51, v51
    v_exp_f32 v56, v56
    v_exp_f32 v57, v57
    v_exp_f32 v58, v58
    v_exp_f32 v59, v59
    v_add_f32 v40, 1.0, v40
    v_add_f32 v41, 1.0, v41
    v_add_f32 v42, 1.0, v42
    v_add_f32 v43, 1.0, v43
    v_add_f32 v48, 1.0, v48
    v_add_f32 v49, 1.0, v49
    v_add_f32 v50, 1.0, v50
    v_add_f32 v51, 1.0, v51
    v_add_f32 v56, 1.0, v56
    v_add_f32 v57, 1.0, v57
    v_add_f32 v58, 1.0, v58
    v_add_f32 v59, 1.0, v59
    v_rcp_f32 v40, v40
    v_rcp_f32 v41, v41
    v_rcp_f32 v42, v42
    v_rcp_f32 v43, v43
    v_rcp_f32 v48, v48
    v_rcp_f32 v49, v49
    v_rcp_f32 v50, v50
    v_rcp_f32 v51, v51
    v_rcp_f32 v56, v56
    v_rcp_f32 v57, v57
    v_rcp_f32 v58, v58
    v_rcp_f32 v59, v59
    v_cvt_pk_bf16_f32 v16, v40, v41
    v_cvt_pk_bf16_f32 v17, v42, v43
    v_cvt_pk_bf16_f32 v18, v48, v49
    v_cvt_pk_bf16_f32 v19, v50, v51
    v_cvt_pk_bf16_f32 v20, v56, v57
    v_cvt_pk_bf16_f32 v21, v58, v59
    v_lshlrev_b32 v40, 16, v16
    v_and_b32 v41, 0xffff0000, v16
    v_lshlrev_b32 v42, 16, v17
    v_and_b32 v43, 0xffff0000, v17
    v_lshlrev_b32 v48, 16, v18
    v_and_b32 v49, 0xffff0000, v18
    v_lshlrev_b32 v50, 16, v19
    v_and_b32 v51, 0xffff0000, v19
    v_lshlrev_b32 v56, 16, v20
    v_and_b32 v57, 0xffff0000, v20
    v_lshlrev_b32 v58, 16, v21
    v_and_b32 v59, 0xffff0000, v21
    v_mul_f32 v40, v40, v44
    v_mul_f32 v41, v41, v45
    v_mul_f32 v42, v42, v46
    v_mul_f32 v43, v43, v47
    v_mul_f32 v48, v48, v52
    v_mul_f32 v49, v49, v53
    v_mul_f32 v50, v50, v54
    v_mul_f32 v51, v51, v55
    v_mul_f32 v56, v56, v60
    v_mul_f32 v57, v57, v61
    v_mul_f32 v58, v58, v62
    v_mul_f32 v59, v59, v63
    s_mul_i32 s25, s12, 3
    v_cvt_pk_bf16_f32 v64, v40, v41
    v_cvt_pk_bf16_f32 v65, v42, v43
    s_add_u32 s26, s25, 0
    s_lshr_b32 s27, s26, 2
    s_lshl_b32 s27, s27, 10
    s_bfe_u32 s3, s26, 0x10001
    s_lshl_b32 s3, s3, 3
    s_add_u32 s27, s27, s3
    s_and_b32 s3, s26, 1
    s_lshl_b32 s3, s3, 9
    s_add_u32 s27, s27, s3
    v_add_u32 v12, s27, v13
    ds_write_b64 v12, v[64:65]
    v_cvt_pk_bf16_f32 v66, v48, v49
    v_cvt_pk_bf16_f32 v67, v50, v51
    s_add_u32 s26, s25, 1
    s_lshr_b32 s27, s26, 2
    s_lshl_b32 s27, s27, 10
    s_bfe_u32 s3, s26, 0x10001
    s_lshl_b32 s3, s3, 3
    s_add_u32 s27, s27, s3
    s_and_b32 s3, s26, 1
    s_lshl_b32 s3, s3, 9
    s_add_u32 s27, s27, s3
    v_add_u32 v12, s27, v13
    ds_write_b64 v12, v[66:67]
    v_cvt_pk_bf16_f32 v68, v56, v57
    v_cvt_pk_bf16_f32 v69, v58, v59
    s_add_u32 s26, s25, 2
    s_lshr_b32 s27, s26, 2
    s_lshl_b32 s27, s27, 10
    s_bfe_u32 s3, s26, 0x10001
    s_lshl_b32 s3, s3, 3
    s_add_u32 s27, s27, s3
    s_and_b32 s3, s26, 1
    s_lshl_b32 s3, s3, 9
    s_add_u32 s27, s27, s3
    v_add_u32 v12, s27, v13
    ds_write_b64 v12, v[68:69]
    s_waitcnt lgkmcnt(0)
    s_barrier
    ds_read_b128 v[16:19], v0 offset:40960
    ds_read_b128 v[20:23], v0 offset:41984
    ds_read_b128 v[24:27], v0 offset:43008
    ds_read_b128 v[28:31], v0 offset:44032
    ds_read_b128 v[32:35], v0 offset:45056
    ds_read_b128 v[36:39], v0 offset:46080
    s_waitcnt lgkmcnt(5)
    v_mfma_f32_16x16x32_bf16 v[40:43], v[136:139], v[16:19], 0
    s_waitcnt lgkmcnt(4)
    v_mfma_f32_16x16x32_bf16 v[40:43], v[140:143], v[20:23], v[40:43]
    s_waitcnt lgkmcnt(3)
    v_mfma_f32_16x16x32_bf16 v[40:43], v[144:147], v[24:27], v[40:43]
    v_mfma_f32_16x16x32_bf16 v[44:47], v[148:151], v[16:19], 0
    v_mfma_f32_16x16x32_bf16 v[44:47], v[152:155], v[20:23], v[44:47]
    v_mfma_f32_16x16x32_bf16 v[44:47], v[156:159], v[24:27], v[44:47]
    s_waitcnt lgkmcnt(2)
    v_mfma_f32_16x16x32_bf16 v[48:51], v[136:139], v[28:31], 0
    s_nop 2
    v_cvt_pk_bf16_f32 v56, v40, v41
    s_waitcnt lgkmcnt(1)
    v_mfma_f32_16x16x32_bf16 v[48:51], v[140:143], v[32:35], v[48:51]
    v_cvt_pk_bf16_f32 v57, v42, v43
    s_waitcnt lgkmcnt(0)
    v_mfma_f32_16x16x32_bf16 v[48:51], v[144:147], v[36:39], v[48:51]
    v_and_or_b32 v56, v56, -2, s28
    v_mfma_f32_16x16x32_bf16 v[52:55], v[148:151], v[28:31], 0
    v_cvt_pk_bf16_f32 v58, v44, v45
    v_mfma_f32_16x16x32_bf16 v[52:55], v[152:155], v[32:35], v[52:55]
    v_cvt_pk_bf16_f32 v59, v46, v47
    v_mfma_f32_16x16x32_bf16 v[52:55], v[156:159], v[36:39], v[52:55]
    buffer_store_dwordx4 v[56:59], v4, s[4:7], s30 offen offset:0
    v_mfma_f32_16x16x32_bf16 v[40:43], v[160:163], v[16:19], 0
    v_cvt_pk_bf16_f32 v60, v48, v49
    v_mfma_f32_16x16x32_bf16 v[40:43], v[164:167], v[20:23], v[40:43]
    v_cvt_pk_bf16_f32 v61, v50, v51
    v_mfma_f32_16x16x32_bf16 v[40:43], v[168:171], v[24:27], v[40:43]
    v_and_or_b32 v60, v60, -2, s28
    v_mfma_f32_16x16x32_bf16 v[44:47], v[172:175], v[16:19], 0
    v_cvt_pk_bf16_f32 v62, v52, v53
    v_mfma_f32_16x16x32_bf16 v[44:47], v[176:179], v[20:23], v[44:47]
    v_cvt_pk_bf16_f32 v63, v54, v55
    v_mfma_f32_16x16x32_bf16 v[44:47], v[180:183], v[24:27], v[44:47]
    buffer_store_dwordx4 v[60:63], v4, s[4:7], s31 offen offset:0
    v_mfma_f32_16x16x32_bf16 v[48:51], v[160:163], v[28:31], 0
    v_cvt_pk_bf16_f32 v56, v40, v41
    v_mfma_f32_16x16x32_bf16 v[48:51], v[164:167], v[32:35], v[48:51]
    v_cvt_pk_bf16_f32 v57, v42, v43
    v_mfma_f32_16x16x32_bf16 v[48:51], v[168:171], v[36:39], v[48:51]
    v_and_or_b32 v56, v56, -2, s28
    v_mfma_f32_16x16x32_bf16 v[52:55], v[172:175], v[28:31], 0
    v_cvt_pk_bf16_f32 v58, v44, v45
    v_mfma_f32_16x16x32_bf16 v[52:55], v[176:179], v[32:35], v[52:55]
    v_cvt_pk_bf16_f32 v59, v46, v47
    v_mfma_f32_16x16x32_bf16 v[52:55], v[180:183], v[36:39], v[52:55]
    buffer_store_dwordx4 v[56:59], v4, s[4:7], s30 offen offset:64
    v_mfma_f32_16x16x32_bf16 v[40:43], v[184:187], v[16:19], 0
    v_cvt_pk_bf16_f32 v60, v48, v49
    v_mfma_f32_16x16x32_bf16 v[40:43], v[188:191], v[20:23], v[40:43]
    v_cvt_pk_bf16_f32 v61, v50, v51
    v_mfma_f32_16x16x32_bf16 v[40:43], v[192:195], v[24:27], v[40:43]
    v_and_or_b32 v60, v60, -2, s28
    v_mfma_f32_16x16x32_bf16 v[44:47], v[196:199], v[16:19], 0
    v_cvt_pk_bf16_f32 v62, v52, v53
    v_mfma_f32_16x16x32_bf16 v[44:47], v[200:203], v[20:23], v[44:47]
    v_cvt_pk_bf16_f32 v63, v54, v55
    v_mfma_f32_16x16x32_bf16 v[44:47], v[204:207], v[24:27], v[44:47]
    buffer_store_dwordx4 v[60:63], v4, s[4:7], s31 offen offset:64
    v_mfma_f32_16x16x32_bf16 v[48:51], v[184:187], v[28:31], 0
    v_cvt_pk_bf16_f32 v56, v40, v41
    v_mfma_f32_16x16x32_bf16 v[48:51], v[188:191], v[32:35], v[48:51]
    v_cvt_pk_bf16_f32 v57, v42, v43
    v_mfma_f32_16x16x32_bf16 v[48:51], v[192:195], v[36:39], v[48:51]
    v_and_or_b32 v56, v56, -2, s28
    v_mfma_f32_16x16x32_bf16 v[52:55], v[196:199], v[28:31], 0
    v_cvt_pk_bf16_f32 v58, v44, v45
    v_mfma_f32_16x16x32_bf16 v[52:55], v[200:203], v[32:35], v[52:55]
    v_cvt_pk_bf16_f32 v59, v46, v47
    v_mfma_f32_16x16x32_bf16 v[52:55], v[204:207], v[36:39], v[52:55]
    buffer_store_dwordx4 v[56:59], v4, s[4:7], s30 offen offset:128
    v_mfma_f32_16x16x32_bf16 v[40:43], v[208:211], v[16:19], 0
    v_cvt_pk_bf16_f32 v60, v48, v49
    v_mfma_f32_16x16x32_bf16 v[40:43], v[212:215], v[20:23], v[40:43]
    v_cvt_pk_bf16_f32 v61, v50, v51
    v_mfma_f32_16x16x32_bf16 v[40:43], v[216:219], v[24:27], v[40:43]
    v_and_or_b32 v60, v60, -2, s28
    v_mfma_f32_16x16x32_bf16 v[44:47], v[220:223], v[16:19], 0
    v_cvt_pk_bf16_f32 v62, v52, v53
    v_mfma_f32_16x16x32_bf16 v[44:47], v[224:227], v[20:23], v[44:47]
    v_cvt_pk_bf16_f32 v63, v54, v55
    v_mfma_f32_16x16x32_bf16 v[44:47], v[228:231], v[24:27], v[44:47]
    buffer_store_dwordx4 v[60:63], v4, s[4:7], s31 offen offset:128
    v_mfma_f32_16x16x32_bf16 v[48:51], v[208:211], v[28:31], 0
    v_cvt_pk_bf16_f32 v56, v40, v41
    v_mfma_f32_16x16x32_bf16 v[48:51], v[212:215], v[32:35], v[48:51]
    v_cvt_pk_bf16_f32 v57, v42, v43
    v_mfma_f32_16x16x32_bf16 v[48:51], v[216:219], v[36:39], v[48:51]
    v_and_or_b32 v56, v56, -2, s28
    v_mfma_f32_16x16x32_bf16 v[52:55], v[220:223], v[28:31], 0
    v_cvt_pk_bf16_f32 v58, v44, v45
    v_mfma_f32_16x16x32_bf16 v[52:55], v[224:227], v[32:35], v[52:55]
    v_cvt_pk_bf16_f32 v59, v46, v47
    v_mfma_f32_16x16x32_bf16 v[52:55], v[228:231], v[36:39], v[52:55]
    buffer_store_dwordx4 v[56:59], v4, s[4:7], s30 offen offset:192
    v_mfma_f32_16x16x32_bf16 v[40:43], v[232:235], v[16:19], 0
    v_cvt_pk_bf16_f32 v60, v48, v49
    v_mfma_f32_16x16x32_bf16 v[40:43], v[236:239], v[20:23], v[40:43]
    v_cvt_pk_bf16_f32 v61, v50, v51
    v_mfma_f32_16x16x32_bf16 v[40:43], v[240:243], v[24:27], v[40:43]
    v_and_or_b32 v60, v60, -2, s28
    v_mfma_f32_16x16x32_bf16 v[44:47], v[244:247], v[16:19], 0
    v_cvt_pk_bf16_f32 v62, v52, v53
    v_mfma_f32_16x16x32_bf16 v[44:47], v[248:251], v[20:23], v[44:47]
    v_cvt_pk_bf16_f32 v63, v54, v55
    v_mfma_f32_16x16x32_bf16 v[44:47], v[252:255], v[24:27], v[44:47]
    buffer_store_dwordx4 v[60:63], v4, s[4:7], s31 offen offset:192
    v_mfma_f32_16x16x32_bf16 v[48:51], v[232:235], v[28:31], 0
    v_cvt_pk_bf16_f32 v56, v40, v41
    v_mfma_f32_16x16x32_bf16 v[48:51], v[236:239], v[32:35], v[48:51]
    v_cvt_pk_bf16_f32 v57, v42, v43
    v_mfma_f32_16x16x32_bf16 v[48:51], v[240:243], v[36:39], v[48:51]
    v_and_or_b32 v56, v56, -2, s28
    v_mfma_f32_16x16x32_bf16 v[52:55], v[244:247], v[28:31], 0
    v_cvt_pk_bf16_f32 v58, v44, v45
    v_mfma_f32_16x16x32_bf16 v[52:55], v[248:251], v[32:35], v[52:55]
    v_cvt_pk_bf16_f32 v59, v46, v47
    v_mfma_f32_16x16x32_bf16 v[52:55], v[252:255], v[36:39], v[52:55]
    buffer_store_dwordx4 v[56:59], v4, s[4:7], s30 offen offset:256
    s_nop 0
    v_cvt_pk_bf16_f32 v60, v48, v49
    v_cvt_pk_bf16_f32 v61, v50, v51
    v_and_or_b32 v60, v60, -2, s28
    s_nop 2
    v_cvt_pk_bf16_f32 v62, v52, v53
    v_cvt_pk_bf16_f32 v63, v54, v55
    buffer_store_dwordx4 v[60:63], v4, s[4:7], s31 offen offset:256
    s_waitcnt vmcnt(0)
    buffer_load_dwordx4 v[64:67], v5, s[4:7], s32 offen offset:0 sc1
    buffer_load_dwordx4 v[68:71], v5, s[4:7], s33 offen offset:0 sc1
    buffer_load_dwordx4 v[72:75], v5, s[4:7], s32 offen offset:256 sc1
    buffer_load_dwordx4 v[76:79], v5, s[4:7], s33 offen offset:256 sc1
    buffer_load_dwordx4 v[80:83], v5, s[4:7], s32 offen offset:512 sc1
    buffer_load_dwordx4 v[84:87], v5, s[4:7], s33 offen offset:512 sc1
    buffer_load_dwordx4 v[88:91], v5, s[4:7], s32 offen offset:768 sc1
    buffer_load_dwordx4 v[92:95], v5, s[4:7], s33 offen offset:768 sc1
    buffer_load_dwordx4 v[96:99], v5, s[4:7], s32 offen offset:1024 sc1
    buffer_load_dwordx4 v[100:103], v5, s[4:7], s33 offen offset:1024 sc1
    s_mov_b32 s19, 0
L_Gf_red_4:
    s_waitcnt vmcnt(9)
    v_mfma_f32_16x16x32_bf16 v[104:107], a[240:243], v[64:67], 0
    v_xor_b32 v12, s29, v64
    s_waitcnt vmcnt(8)
    v_mfma_f32_16x16x32_bf16 v[104:107], a[240:243], v[68:71], v[104:107]
    v_bitop3_b32 v12, v12, v68, s29 bitop3:0xf6
    s_waitcnt vmcnt(7)
    v_mfma_f32_16x16x32_bf16 v[104:107], a[244:247], v[72:75], v[104:107]
    v_bitop3_b32 v12, v12, v72, s29 bitop3:0xf6
    s_waitcnt vmcnt(6)
    v_mfma_f32_16x16x32_bf16 v[104:107], a[244:247], v[76:79], v[104:107]
    v_bitop3_b32 v12, v12, v76, s29 bitop3:0xf6
    s_waitcnt vmcnt(5)
    v_mfma_f32_16x16x32_bf16 v[108:111], a[240:243], v[80:83], 0
    v_bitop3_b32 v12, v12, v80, s29 bitop3:0xf6
    s_waitcnt vmcnt(4)
    v_mfma_f32_16x16x32_bf16 v[108:111], a[240:243], v[84:87], v[108:111]
    v_bitop3_b32 v12, v12, v84, s29 bitop3:0xf6
    s_waitcnt vmcnt(3)
    v_mfma_f32_16x16x32_bf16 v[108:111], a[244:247], v[88:91], v[108:111]
    v_bitop3_b32 v12, v12, v88, s29 bitop3:0xf6
    s_waitcnt vmcnt(2)
    v_mfma_f32_16x16x32_bf16 v[108:111], a[244:247], v[92:95], v[108:111]
    v_bitop3_b32 v12, v12, v92, s29 bitop3:0xf6
    s_waitcnt vmcnt(1)
    v_mfma_f32_16x16x32_bf16 v[112:115], a[240:243], v[96:99], 0
    v_bitop3_b32 v12, v12, v96, s29 bitop3:0xf6
    s_waitcnt vmcnt(0)
    v_mfma_f32_16x16x32_bf16 v[112:115], a[240:243], v[100:103], v[112:115]
    v_bitop3_b32 v12, v12, v100, s29 bitop3:0xf6
    v_and_b32 v12, 1, v12
    v_cmp_ne_u32 vcc, 0, v12
    s_nop 0
    s_cbranch_vccnz L_Gf_redfix_5
    ds_write_b128 v14, v[104:107] offset:0
    ds_write_b128 v14, v[108:111] offset:1024
    s_nop 0
    ds_write_b128 v14, v[112:115] offset:2048
    s_add_u32 s32, s32, s39
    s_add_u32 s33, s33, s39
    s_add_u32 s30, s30, s39
    s_add_u32 s31, s31, s39
    s_sub_u32 s39, 0, s39
    s_add_u32 s22, s22, 1
    s_waitcnt lgkmcnt(0)
    s_barrier
    s_bitcmp1_b32 s12, 0
    s_cbranch_scc1 L_Gf_nofin_6
    ds_read_b128 v[16:19], v14 offset:0
    ds_read_b128 v[20:23], v14 offset:1024
    ds_read_b128 v[24:27], v14 offset:2048
    ds_read_b128 v[28:31], v14 offset:3072
    ds_read_b128 v[32:35], v14 offset:4096
    ds_read_b128 v[36:39], v14 offset:5120
    s_waitcnt lgkmcnt(0)
    v_pk_add_f32 v[16:17], v[16:17], v[28:29]
    v_pk_add_f32 v[18:19], v[18:19], v[30:31]
    v_pk_add_f32 v[20:21], v[20:21], v[32:33]
    v_pk_add_f32 v[22:23], v[22:23], v[34:35]
    v_pk_add_f32 v[24:25], v[24:25], v[36:37]
    v_pk_add_f32 v[26:27], v[26:27], v[38:39]
    v_cvt_pk_bf16_f32 v64, v16, v17
    v_cvt_pk_bf16_f32 v65, v18, v19
    v_cvt_pk_bf16_f32 v66, v20, v21
    v_cvt_pk_bf16_f32 v67, v22, v23
    v_cvt_pk_bf16_f32 v68, v24, v25
    v_cvt_pk_bf16_f32 v69, v26, v27
    v_lshlrev_b32 v16, 16, v64
    v_and_b32 v17, 0xffff0000, v64
    v_lshlrev_b32 v18, 16, v65
    v_and_b32 v19, 0xffff0000, v65
    v_lshlrev_b32 v20, 16, v66
    v_and_b32 v21, 0xffff0000, v66
    v_lshlrev_b32 v22, 16, v67
    v_and_b32 v23, 0xffff0000, v67
    v_lshlrev_b32 v24, 16, v68
    v_and_b32 v25, 0xffff0000, v68
    v_lshlrev_b32 v26, 16, v69
    v_and_b32 v27, 0xffff0000, v69
    v_lshlrev_b32 v28, 16, v120
    v_and_b32 v29, 0xffff0000, v120
    v_lshlrev_b32 v30, 16, v121
    v_and_b32 v31, 0xffff0000, v121
    v_lshlrev_b32 v32, 16, v122
    v_and_b32 v33, 0xffff0000, v122
    v_lshlrev_b32 v34, 16, v123
    v_and_b32 v35, 0xffff0000, v123
    v_lshlrev_b32 v36, 16, v124
    v_and_b32 v37, 0xffff0000, v124
    v_lshlrev_b32 v38, 16, v125
    v_and_b32 v39, 0xffff0000, v125
    v_pk_add_f32 v[16:17], v[16:17], v[28:29]
    v_pk_add_f32 v[18:19], v[18:19], v[30:31]
    v_pk_add_f32 v[20:21], v[20:21], v[32:33]
    v_pk_add_f32 v[22:23], v[22:23], v[34:35]
    v_pk_add_f32 v[24:25], v[24:25], v[36:37]
    v_pk_add_f32 v[26:27], v[26:27], v[38:39]
    v_cndmask_b32 v24, 0, v24, s[44:45]
    v_cndmask_b32 v25, 0, v25, s[44:45]
    v_cndmask_b32 v26, 0, v26, s[44:45]
    v_cndmask_b32 v27, 0, v27, s[44:45]
    v_cvt_pk_bf16_f32 v64, v16, v17
    v_cvt_pk_bf16_f32 v65, v18, v19
    v_cvt_pk_bf16_f32 v66, v20, v21
    v_cvt_pk_bf16_f32 v67, v22, v23
    v_cvt_pk_bf16_f32 v68, v24, v25
    v_cvt_pk_bf16_f32 v69, v26, v27
    v_lshlrev_b32 v16, 16, v64
    v_and_b32 v17, 0xffff0000, v64
    v_lshlrev_b32 v18, 16, v65
    v_and_b32 v19, 0xffff0000, v65
    v_lshlrev_b32 v20, 16, v66
    v_and_b32 v21, 0xffff0000, v66
    v_lshlrev_b32 v22, 16, v67
    v_and_b32 v23, 0xffff0000, v67
    v_lshlrev_b32 v24, 16, v68
    v_and_b32 v25, 0xffff0000, v68
    v_lshlrev_b32 v26, 16, v69
    v_and_b32 v27, 0xffff0000, v69
    s_cmp_lg_u32 s20, 0
    s_cbranch_scc1 L_Gf_last_7
    v_mov_b32 v72, v64
    v_mov_b32 v73, v65
    v_mov_b32 v74, v66
    v_mov_b32 v75, v67
    v_mov_b32 v76, v68
    v_mov_b32 v77, v69
    v_mov_b32 v78, v68
    v_mov_b32 v79, v69
    v_permlane16_swap_b32 v72, v74
    v_permlane16_swap_b32 v73, v75
    v_permlane16_swap_b32 v76, v78
    v_permlane16_swap_b32 v77, v79
    buffer_store_dwordx4 v[72:75], v8, s[4:7], s36 offen sc1
    s_mov_b64 exec, 0xffff
    buffer_store_dwordx4 v[76:79], v8, s[4:7], s36 offen offset:1024 sc1
    s_mov_b64 exec, -1
    v_pk_add_f32 v[32:33], v[16:17], v[18:19]
    v_pk_add_f32 v[32:33], v[32:33], v[20:21]
    v_pk_add_f32 v[32:33], v[32:33], v[22:23]
    v_pk_add_f32 v[32:33], v[32:33], v[24:25]
    v_pk_add_f32 v[32:33], v[32:33], v[26:27]
    v_add_f32 v28, v32, v33
    s_nop 1
    v_add_f32_dpp v28, v28, v28 quad_perm:[1,0,3,2] row_mask:0xf bank_mask:0xf
    s_nop 1
    v_add_f32_dpp v28, v28, v28 quad_perm:[2,3,0,1] row_mask:0xf bank_mask:0xf
    s_nop 1
    v_add_f32_dpp v28, v28, v28 row_half_mirror row_mask:0xf bank_mask:0xf
    s_nop 1
    v_add_f32_dpp v28, v28, v28 row_mirror row_mask:0xf bank_mask:0xf
    v_mov_b32 v29, v28
    s_nop 1
    v_permlane16_swap_b32 v28, v29
    v_add_f32 v28, v28, v29
    v_mov_b32 v29, v28
    s_nop 1
    v_permlane32_swap_b32 v28, v29
    v_add_f32 v28, v28, v29
    v_mul_f32 v30, 1.5625000000e-03, v28
    v_sub_f32 v32, v16, v30
    v_sub_f32 v33, v17, v30
    v_sub_f32 v34, v18, v30
    v_sub_f32 v35, v19, v30
    v_sub_f32 v36, v20, v30
    v_sub_f32 v37, v21, v30
    v_sub_f32 v38, v22, v30
    v_sub_f32 v39, v23, v30
    v_sub_f32 v40, v24, v30
    v_sub_f32 v41, v25, v30
    v_sub_f32 v42, v26, v30
    v_sub_f32 v43, v27, v30
    v_cndmask_b32 v40, 0, v40, s[44:45]
    v_cndmask_b32 v41, 0, v41, s[44:45]
    v_cndmask_b32 v42, 0, v42, s[44:45]
    v_cndmask_b32 v43, 0, v43, s[44:45]
    v_mul_f32 v28, v32, v32
    v_fmac_f32 v28, v33, v33
    v_fmac_f32 v28, v34, v34
    v_fmac_f32 v28, v35, v35
    v_fmac_f32 v28, v36, v36
    v_fmac_f32 v28, v37, v37
    v_fmac_f32 v28, v38, v38
    v_fmac_f32 v28, v39, v39
    v_fmac_f32 v28, v40, v40
    v_fmac_f32 v28, v41, v41
    v_fmac_f32 v28, v42, v42
    v_fmac_f32 v28, v43, v43
    s_nop 1
    v_add_f32_dpp v28, v28, v28 quad_perm:[1,0,3,2] row_mask:0xf bank_mask:0xf
    s_nop 1
    v_add_f32_dpp v28, v28, v28 quad_perm:[2,3,0,1] row_mask:0xf bank_mask:0xf
    s_nop 1
    v_add_f32_dpp v28, v28, v28 row_half_mirror row_mask:0xf bank_mask:0xf
    s_nop 1
    v_add_f32_dpp v28, v28, v28 row_mirror row_mask:0xf bank_mask:0xf
    v_mov_b32 v29, v28
    s_nop 1
    v_permlane16_swap_b32 v28, v29
    v_add_f32 v28, v28, v29
    v_mov_b32 v29, v28
    s_nop 1
    v_permlane32_swap_b32 v28, v29
    v_add_f32 v28, v28, v29
    v_mul_f32 v28, 1.5625000000e-03, v28
    v_cvt_pk_bf16_f32 v29, v28, v30
    v_lshlrev_b32 v28, 16, v29
    v_and_b32 v30, 0xffff0000, v29
    v_add_f32 v28, 0x3727c5ac, v28
    v_cvt_pk_bf16_f32 v29, v28, v28
    v_lshlrev_b32 v28, 16, v29
    v_sqrt_f32 v28, v28
    v_sub_f32 v32, v16, v30
    v_sub_f32 v33, v17, v30
    v_sub_f32 v34, v18, v30
    v_sub_f32 v35, v19, v30
    v_sub_f32 v36, v20, v30
    v_sub_f32 v37, v21, v30
    v_sub_f32 v38, v22, v30
    v_sub_f32 v39, v23, v30
    v_sub_f32 v40, v24, v30
    v_sub_f32 v41, v25, v30
    v_sub_f32 v42, v26, v30
    v_sub_f32 v43, v27, v30
    v_cvt_pk_bf16_f32 v29, v28, v28
    v_lshlrev_b32 v28, 16, v29
    v_rcp_f32 v28, v28
    v_cvt_pk_bf16_f32 v64, v32, v33
    v_cvt_pk_bf16_f32 v65, v34, v35
    v_cvt_pk_bf16_f32 v66, v36, v37
    v_cvt_pk_bf16_f32 v67, v38, v39
    v_cvt_pk_bf16_f32 v68, v40, v41
    v_cvt_pk_bf16_f32 v69, v42, v43
    v_lshlrev_b32 v32, 16, v64
    v_and_b32 v33, 0xffff0000, v64
    v_lshlrev_b32 v34, 16, v65
    v_and_b32 v35, 0xffff0000, v65
    v_lshlrev_b32 v36, 16, v66
    v_and_b32 v37, 0xffff0000, v66
    v_lshlrev_b32 v38, 16, v67
    v_and_b32 v39, 0xffff0000, v67
    v_lshlrev_b32 v40, 16, v68
    v_and_b32 v41, 0xffff0000, v68
    v_lshlrev_b32 v42, 16, v69
    v_and_b32 v43, 0xffff0000, v69
    v_mul_f32 v32, v32, v28
    v_mul_f32 v33, v33, v28
    v_mul_f32 v34, v34, v28
    v_mul_f32 v35, v35, v28
    v_mul_f32 v36, v36, v28
    v_mul_f32 v37, v37, v28
    v_mul_f32 v38, v38, v28
    v_mul_f32 v39, v39, v28
    v_mul_f32 v40, v40, v28
    v_mul_f32 v41, v41, v28
    v_mul_f32 v42, v42, v28
    v_mul_f32 v43, v43, v28
    v_cvt_pk_bf16_f32 v64, v32, v33
    v_cvt_pk_bf16_f32 v65, v34, v35
    v_cvt_pk_bf16_f32 v66, v36, v37
    v_cvt_pk_bf16_f32 v67, v38, v39
    v_cvt_pk_bf16_f32 v68, v40, v41
    v_cvt_pk_bf16_f32 v69, v42, v43
    v_mov_b32 v72, v64
    v_mov_b32 v73, v65
    v_mov_b32 v74, v66
    v_mov_b32 v75, v67
    v_mov_b32 v76, v68
    v_mov_b32 v77, v69
    v_mov_b32 v78, v68
    v_mov_b32 v79, v69
    v_permlane16_swap_b32 v72, v74
    v_permlane16_swap_b32 v73, v75
    v_permlane16_swap_b32 v76, v78
    v_permlane16_swap_b32 v77, v79
    buffer_store_dwordx4 v[72:75], v8, s[4:7], s37 offen sc1
    s_mov_b64 exec, 0xffff
    buffer_store_dwordx4 v[76:79], v8, s[4:7], s37 offen offset:1024 sc1
    s_mov_b64 exec, -1
    s_branch L_Gf_nofin_6
L_Gf_last_7:
    buffer_store_dwordx2 v[64:65], v7, s[92:95], s36 offen offset:0
    buffer_store_dwordx2 v[66:67], v7, s[92:95], s36 offen offset:512
    s_mov_b64 exec, s[44:45]
    buffer_store_dwordx2 v[68:69], v7, s[92:95], s36 offen offset:1024
    s_mov_b64 exec, -1
L_Gf_nofin_6:
    s_add_u32 s35, s35, 40960
    s_add_u32 s36, s36, 40960
    s_add_u32 s37, s37, 40960
    s_add_u32 s38, s38, 40960
    s_cmp_lt_u32 s22, 64
    s_cbranch_scc1 L_Gf_top
    s_waitcnt vmcnt(0)
    s_bitcmp1_b32 s12, 0
    s_cbranch_scc1 L_Gf_nofin_6x
    v_mov_b32 v11, s22
    s_mov_b64 exec, 1
    buffer_store_dword v11, v0, s[4:7], s23 offen offset:0 sc1
    s_mov_b64 exec, -1
L_Gf_nofin_6x:
    s_waitcnt vmcnt(0)
    s_endpgm
L_Gf_flspin_3:
    buffer_load_dword v10, v9, s[4:7], s24 offen sc1
    s_add_u32 s19, s19, 1
    s_cmp_ge_u32 s19, 524288
    s_cbranch_scc1 L_fail
    s_waitcnt vmcnt(0)
    v_cmp_gt_u32 vcc, s41, v10
    s_nop 0
    s_cbranch_vccnz L_Gf_flspin_3
    s_branch L_Gf_fl_2
L_Gf_redfix_5:
    buffer_load_dwordx4 v[64:67], v5, s[4:7], s32 offen offset:0 sc1
    buffer_load_dwordx4 v[68:71], v5, s[4:7], s33 offen offset:0 sc1
    buffer_load_dwordx4 v[72:75], v5, s[4:7], s32 offen offset:256 sc1
    buffer_load_dwordx4 v[76:79], v5, s[4:7], s33 offen offset:256 sc1
    buffer_load_dwordx4 v[80:83], v5, s[4:7], s32 offen offset:512 sc1
    buffer_load_dwordx4 v[84:87], v5, s[4:7], s33 offen offset:512 sc1
    buffer_load_dwordx4 v[88:91], v5, s[4:7], s32 offen offset:768 sc1
    buffer_load_dwordx4 v[92:95], v5, s[4:7], s33 offen offset:768 sc1
    buffer_load_dwordx4 v[96:99], v5, s[4:7], s32 offen offset:1024 sc1
    buffer_load_dwordx4 v[100:103], v5, s[4:7], s33 offen offset:1024 sc1
    s_add_u32 s19, s19, 1
    s_cmp_lt_u32 s19, 524288
    s_cbranch_scc1 L_Gf_red_4
    s_branch L_fail
L_G_slow:
L_Gs_top:
    buffer_load_dword v10, v9, s[4:7], s24 offen sc1
    s_lshr_b32 s25, s22, 1
    s_andn2_b32 s28, 1, s25
    s_sub_u32 s29, 0, s28
    s_add_u32 s41, s22, 1
    s_waitcnt vmcnt(0)
    s_bitcmp1_b32 s12, 0
    s_cbranch_scc1 L_Gs_noflag_1
    v_mov_b32 v11, s22
    s_mov_b64 exec, 1
    buffer_store_dword v11, v0, s[4:7], s23 offen offset:0 sc1
    s_mov_b64 exec, -1
L_Gs_noflag_1:
    s_mov_b32 s19, 0
    v_cmp_gt_u32 vcc, s41, v10
    s_nop 0
    s_cbranch_vccnz L_Gs_flspin_3
L_Gs_fl_2:
    s_add_u32 m0, s63, 0
    s_nop 0
    buffer_load_dwordx4 v1, s[4:7], s38 offen offset:0 sc1 lds
    s_add_u32 m0, s63, 896
    s_nop 0
    buffer_load_dwordx4 v1, s[4:7], s38 offen offset:128 sc1 lds
    s_add_u32 m0, s63, 1792
    s_nop 0
    buffer_load_dwordx4 v1, s[4:7], s38 offen offset:256 sc1 lds
    s_add_u32 m0, s63, 2688
    s_nop 0
    buffer_load_dwordx4 v1, s[4:7], s38 offen offset:384 sc1 lds
    s_add_u32 m0, s63, 3584
    s_nop 0
    buffer_load_dwordx4 v1, s[4:7], s38 offen offset:512 sc1 lds
    s_add_u32 m0, s63, 4480
    s_nop 0
    buffer_load_dwordx4 v1, s[4:7], s38 offen offset:640 sc1 lds
    s_add_u32 m0, s63, 5376
    s_nop 0
    buffer_load_dwordx4 v1, s[4:7], s38 offen offset:768 sc1 lds
    s_add_u32 m0, s63, 6272
    s_nop 0
    buffer_load_dwordx4 v1, s[4:7], s38 offen offset:896 sc1 lds
    s_add_u32 m0, s63, 7168
    s_nop 0
    buffer_load_dwordx4 v1, s[4:7], s38 offen offset:1024 sc1 lds
    s_add_u32 m0, s63, 8064
    s_nop 0
    buffer_load_dwordx4 v1, s[4:7], s38 offen offset:1152 sc1 lds
    buffer_load_dwordx2 v[120:121], v6, s[4:7], s35 offen offset:0 sc1
    buffer_load_dwordx2 v[122:123], v6, s[4:7], s35 offen offset:512 sc1
    s_mov_b64 exec, s[44:45]
    buffer_load_dwordx2 v[124:125], v6, s[4:7], s35 offen offset:1024 sc1
    s_mov_b64 exec, -1
    s_waitcnt vmcnt(3)
    s_barrier
    ds_read_b128 v[16:19], v2 offset:0
    ds_read_b128 v[20:23], v2 offset:20480
    ds_read_b128 v[24:27], v3 offset:0
    ds_read_b128 v[28:31], v3 offset:20480
    ds_read_b128 v[32:35], v2 offset:1024
    ds_read_b128 v[36:39], v2 offset:21504
    s_waitcnt lgkmcnt(4)
    v_mfma_f32_16x16x32_bf16 v[40:43], a[0:3], v[16:19], 0
    v_mfma_f32_16x16x32_bf16 v[44:47], a[0:3], v[20:23], 0
    v_mfma_f32_16x16x32_bf16 v[48:51], a[80:83], v[16:19], 0
    v_mfma_f32_16x16x32_bf16 v[52:55], a[80:83], v[20:23], 0
    v_mfma_f32_16x16x32_bf16 v[56:59], a[160:163], v[16:19], 0
    v_mfma_f32_16x16x32_bf16 v[60:63], a[160:163], v[20:23], 0
    ds_read_b128 v[16:19], v3 offset:1024
    ds_read_b128 v[20:23], v3 offset:21504
    s_waitcnt lgkmcnt(4)
    v_mfma_f32_16x16x32_bf16 v[40:43], a[4:7], v[24:27], v[40:43]
    v_mfma_f32_16x16x32_bf16 v[44:47], a[4:7], v[28:31], v[44:47]
    v_mfma_f32_16x16x32_bf16 v[48:51], a[84:87], v[24:27], v[48:51]
    v_mfma_f32_16x16x32_bf16 v[52:55], a[84:87], v[28:31], v[52:55]
    v_mfma_f32_16x16x32_bf16 v[56:59], a[164:167], v[24:27], v[56:59]
    v_mfma_f32_16x16x32_bf16 v[60:63], a[164:167], v[28:31], v[60:63]
    ds_read_b128 v[24:27], v2 offset:2048
    ds_read_b128 v[28:31], v2 offset:22528
    s_waitcnt lgkmcnt(4)
    v_mfma_f32_16x16x32_bf16 v[40:43], a[8:11], v[32:35], v[40:43]
    v_mfma_f32_16x16x32_bf16 v[44:47], a[8:11], v[36:39], v[44:47]
    v_mfma_f32_16x16x32_bf16 v[48:51], a[88:91], v[32:35], v[48:51]
    v_mfma_f32_16x16x32_bf16 v[52:55], a[88:91], v[36:39], v[52:55]
    v_mfma_f32_16x16x32_bf16 v[56:59], a[168:171], v[32:35], v[56:59]
    v_mfma_f32_16x16x32_bf16 v[60:63], a[168:171], v[36:39], v[60:63]
    ds_read_b128 v[32:35], v3 offset:2048
    ds_read_b128 v[36:39], v3 offset:22528
    s_waitcnt lgkmcnt(4)
    v_mfma_f32_16x16x32_bf16 v[40:43], a[12:15], v[16:19], v[40:43]
    v_mfma_f32_16x16x32_bf16 v[44:47], a[12:15], v[20:23], v[44:47]
    v_mfma_f32_16x16x32_bf16 v[48:51], a[92:95], v[16:19], v[48:51]
    v_mfma_f32_16x16x32_bf16 v[52:55], a[92:95], v[20:23], v[52:55]
    v_mfma_f32_16x16x32_bf16 v[56:59], a[172:175], v[16:19], v[56:59]
    v_mfma_f32_16x16x32_bf16 v[60:63], a[172:175], v[20:23], v[60:63]
    ds_read_b128 v[16:19], v2 offset:3072
    ds_read_b128 v[20:23], v2 offset:23552
    s_waitcnt lgkmcnt(4)
    v_mfma_f32_16x16x32_bf16 v[40:43], a[16:19], v[24:27], v[40:43]
    v_mfma_f32_16x16x32_bf16 v[44:47], a[16:19], v[28:31], v[44:47]
    v_mfma_f32_16x16x32_bf16 v[48:51], a[96:99], v[24:27], v[48:51]
    v_mfma_f32_16x16x32_bf16 v[52:55], a[96:99], v[28:31], v[52:55]
    v_mfma_f32_16x16x32_bf16 v[56:59], a[176:179], v[24:27], v[56:59]
    v_mfma_f32_16x16x32_bf16 v[60:63], a[176:179], v[28:31], v[60:63]
    ds_read_b128 v[24:27], v3 offset:3072
    ds_read_b128 v[28:31], v3 offset:23552
    s_waitcnt lgkmcnt(4)
    v_mfma_f32_16x16x32_bf16 v[40:43], a[20:23], v[32:35], v[40:43]
    v_mfma_f32_16x16x32_bf16 v[44:47], a[20:23], v[36:39], v[44:47]
    v_mfma_f32_16x16x32_bf16 v[48:51], a[100:103], v[32:35], v[48:51]
    v_mfma_f32_16x16x32_bf16 v[52:55], a[100:103], v[36:39], v[52:55]
    v_mfma_f32_16x16x32_bf16 v[56:59], a[180:183], v[32:35], v[56:59]
    v_mfma_f32_16x16x32_bf16 v[60:63], a[180:183], v[36:39], v[60:63]
    ds_read_b128 v[32:35], v2 offset:4096
    ds_read_b128 v[36:39], v2 offset:24576
    s_waitcnt lgkmcnt(4)
    v_mfma_f32_16x16x32_bf16 v[40:43], a[24:27], v[16:19], v[40:43]
    v_mfma_f32_16x16x32_bf16 v[44:47], a[24:27], v[20:23], v[44:47]
    v_mfma_f32_16x16x32_bf16 v[48:51], a[104:107], v[16:19], v[48:51]
    v_mfma_f32_16x16x32_bf16 v[52:55], a[104:107], v[20:23], v[52:55]
    v_mfma_f32_16x16x32_bf16 v[56:59], a[184:187], v[16:19], v[56:59]
    v_mfma_f32_16x16x32_bf16 v[60:63], a[184:187], v[20:23], v[60:63]
    ds_read_b128 v[16:19], v3 offset:4096
    ds_read_b128 v[20:23], v3 offset:24576
    s_waitcnt lgkmcnt(4)
    v_mfma_f32_16x16x32_bf16 v[40:43], a[28:31], v[24:27], v[40:43]
    v_mfma_f32_16x16x32_bf16 v[44:47], a[28:31], v[28:31], v[44:47]
    v_mfma_f32_16x16x32_bf16 v[48:51], a[108:111], v[24:27], v[48:51]
    v_mfma_f32_16x16x32_bf16 v[52:55], a[108:111], v[28:31], v[52:55]
    v_mfma_f32_16x16x32_bf16 v[56:59], a[188:191], v[24:27], v[56:59]
    v_mfma_f32_16x16x32_bf16 v[60:63], a[188:191], v[28:31], v[60:63]
    ds_read_b128 v[24:27], v2 offset:5120
    ds_read_b128 v[28:31], v2 offset:25600
    s_waitcnt lgkmcnt(4)
    v_mfma_f32_16x16x32_bf16 v[40:43], a[32:35], v[32:35], v[40:43]
    v_mfma_f32_16x16x32_bf16 v[44:47], a[32:35], v[36:39], v[44:47]
    v_mfma_f32_16x16x32_bf16 v[48:51], a[112:115], v[32:35], v[48:51]
    v_mfma_f32_16x16x32_bf16 v[52:55], a[112:115], v[36:39], v[52:55]
    v_mfma_f32_16x16x32_bf16 v[56:59], a[192:195], v[32:35], v[56:59]
    v_mfma_f32_16x16x32_bf16 v[60:63], a[192:195], v[36:39], v[60:63]
    ds_read_b128 v[32:35], v3 offset:5120
    ds_read_b128 v[36:39], v3 offset:25600
    s_waitcnt lgkmcnt(4)
    v_mfma_f32_16x16x32_bf16 v[40:43], a[36:39], v[16:19], v[40:43]
    v_mfma_f32_16x16x32_bf16 v[44:47], a[36:39], v[20:23], v[44:47]
    v_mfma_f32_16x16x32_bf16 v[48:51], a[116:119], v[16:19], v[48:51]
    v_mfma_f32_16x16x32_bf16 v[52:55], a[116:119], v[20:23], v[52:55]
    v_mfma_f32_16x16x32_bf16 v[56:59], a[196:199], v[16:19], v[56:59]
    v_mfma_f32_16x16x32_bf16 v[60:63], a[196:199], v[20:23], v[60:63]
    ds_read_b128 v[16:19], v2 offset:6144
    ds_read_b128 v[20:23], v2 offset:26624
    s_waitcnt lgkmcnt(4)
    v_mfma_f32_16x16x32_bf16 v[40:43], a[40:43], v[24:27], v[40:43]
    v_mfma_f32_16x16x32_bf16 v[44:47], a[40:43], v[28:31], v[44:47]
    v_mfma_f32_16x16x32_bf16 v[48:51], a[120:123], v[24:27], v[48:51]
    v_mfma_f32_16x16x32_bf16 v[52:55], a[120:123], v[28:31], v[52:55]
    v_mfma_f32_16x16x32_bf16 v[56:59], a[200:203], v[24:27], v[56:59]
    v_mfma_f32_16x16x32_bf16 v[60:63], a[200:203], v[28:31], v[60:63]
    ds_read_b128 v[24:27], v3 offset:6144
    ds_read_b128 v[28:31], v3 offset:26624
    s_waitcnt lgkmcnt(4)
    v_mfma_f32_16x16x32_bf16 v[40:43], a[44:47], v[32:35], v[40:43]
    v_mfma_f32_16x16x32_bf16 v[44:47], a[44:47], v[36:39], v[44:47]
    v_mfma_f32_16x16x32_bf16 v[48:51], a[124:127], v[32:35], v[48:51]
    v_mfma_f32_16x16x32_bf16 v[52:55], a[124:127], v[36:39], v[52:55]
    v_mfma_f32_16x16x32_bf16 v[56:59], a[204:207], v[32:35], v[56:59]
    v_mfma_f32_16x16x32_bf16 v[60:63], a[204:207], v[36:39], v[60:63]
    ds_read_b128 v[32:35], v2 offset:7168
    ds_read_b128 v[36:39], v2 offset:27648
    s_waitcnt lgkmcnt(4)
    v_mfma_f32_16x16x32_bf16 v[40:43], a[48:51], v[16:19], v[40:43]
    v_mfma_f32_16x16x32_bf16 v[44:47], a[48:51], v[20:23], v[44:47]
    v_mfma_f32_16x16x32_bf16 v[48:51], a[128:131], v[16:19], v[48:51]
    v_mfma_f32_16x16x32_bf16 v[52:55], a[128:131], v[20:23], v[52:55]
    v_mfma_f32_16x16x32_bf16 v[56:59], a[208:211], v[16:19], v[56:59]
    v_mfma_f32_16x16x32_bf16 v[60:63], a[208:211], v[20:23], v[60:63]
    ds_read_b128 v[16:19], v3 offset:7168
    ds_read_b128 v[20:23], v3 offset:27648
    s_waitcnt lgkmcnt(4)
    v_mfma_f32_16x16x32_bf16 v[40:43], a[52:55], v[24:27], v[40:43]
    v_mfma_f32_16x16x32_bf16 v[44:47], a[52:55], v[28:31], v[44:47]
    v_mfma_f32_16x16x32_bf16 v[48:51], a[132:135], v[24:27], v[48:51]
    v_mfma_f32_16x16x32_bf16 v[52:55], a[132:135], v[28:31], v[52:55]
    v_mfma_f32_16x16x32_bf16 v[56:59], a[212:215], v[24:27], v[56:59]
    v_mfma_f32_16x16x32_bf16 v[60:63], a[212:215], v[28:31], v[60:63]
    ds_read_b128 v[24:27], v2 offset:8192
    ds_read_b128 v[28:31], v2 offset:28672
    s_waitcnt lgkmcnt(4)
    v_mfma_f32_16x16x32_bf16 v[40:43], a[56:59], v[32:35], v[40:43]
    v_mfma_f32_16x16x32_bf16 v[44:47], a[56:59], v[36:39], v[44:47]
    v_mfma_f32_16x16x32_bf16 v[48:51], a[136:139], v[32:35], v[48:51]
    v_mfma_f32_16x16x32_bf16 v[52:55], a[136:139], v[36:39], v[52:55]
    v_mfma_f32_16x16x32_bf16 v[56:59], a[216:219], v[32:35], v[56:59]
    v_mfma_f32_16x16x32_bf16 v[60:63], a[216:219], v[36:39], v[60:63]
    ds_read_b128 v[32:35], v3 offset:8192
    ds_read_b128 v[36:39], v3 offset:28672
    s_waitcnt lgkmcnt(4)
    v_mfma_f32_16x16x32_bf16 v[40:43], a[60:63], v[16:19], v[40:43]
    v_mfma_f32_16x16x32_bf16 v[44:47], a[60:63], v[20:23], v[44:47]
    v_mfma_f32_16x16x32_bf16 v[48:51], a[140:143], v[16:19], v[48:51]
    v_mfma_f32_16x16x32_bf16 v[52:55], a[140:143], v[20:23], v[52:55]
    v_mfma_f32_16x16x32_bf16 v[56:59], a[220:223], v[16:19], v[56:59]
    v_mfma_f32_16x16x32_bf16 v[60:63], a[220:223], v[20:23], v[60:63]
    ds_read_b128 v[16:19], v2 offset:9216
    ds_read_b128 v[20:23], v2 offset:29696
    s_waitcnt lgkmcnt(4)
    v_mfma_f32_16x16x32_bf16 v[40:43], a[64:67], v[24:27], v[40:43]
    v_mfma_f32_16x16x32_bf16 v[44:47], a[64:67], v[28:31], v[44:47]
    v_mfma_f32_16x16x32_bf16 v[48:51], a[144:147], v[24:27], v[48:51]
    v_mfma_f32_16x16x32_bf16 v[52:55], a[144:147], v[28:31], v[52:55]
    v_mfma_f32_16x16x32_bf16 v[56:59], a[224:227], v[24:27], v[56:59]
    v_mfma_f32_16x16x32_bf16 v[60:63], a[224:227], v[28:31], v[60:63]
    ds_read_b128 v[24:27], v3 offset:9216
    ds_read_b128 v[28:31], v3 offset:29696
    s_waitcnt lgkmcnt(4)
    v_mfma_f32_16x16x32_bf16 v[40:43], a[68:71], v[32:35], v[40:43]
    v_mfma_f32_16x16x32_bf16 v[44:47], a[68:71], v[36:39], v[44:47]
    v_mfma_f32_16x16x32_bf16 v[48:51], a[148:151], v[32:35], v[48:51]
    v_mfma_f32_16x16x32_bf16 v[52:55], a[148:151], v[36:39], v[52:55]
    v_mfma_f32_16x16x32_bf16 v[56:59], a[228:231], v[32:35], v[56:59]
    v_mfma_f32_16x16x32_bf16 v[60:63], a[228:231], v[36:39], v[60:63]
    s_waitcnt lgkmcnt(2)
    v_mfma_f32_16x16x32_bf16 v[40:43], a[72:75], v[16:19], v[40:43]
    v_mfma_f32_16x16x32_bf16 v[44:47], a[72:75], v[20:23], v[44:47]
    v_mfma_f32_16x16x32_bf16 v[48:51], a[152:155], v[16:19], v[48:51]
    v_mfma_f32_16x16x32_bf16 v[52:55], a[152:155], v[20:23], v[52:55]
    v_mfma_f32_16x16x32_bf16 v[56:59], a[232:235], v[16:19], v[56:59]
    v_mfma_f32_16x16x32_bf16 v[60:63], a[232:235], v[20:23], v[60:63]
    s_waitcnt lgkmcnt(0)
    v_mfma_f32_16x16x32_bf16 v[40:43], a[76:79], v[24:27], v[40:43]
    v_mfma_f32_16x16x32_bf16 v[44:47], a[76:79], v[28:31], v[44:47]
    v_mfma_f32_16x16x32_bf16 v[48:51], a[156:159], v[24:27], v[48:51]
    v_mfma_f32_16x16x32_bf16 v[52:55], a[156:159], v[28:31], v[52:55]
    v_mfma_f32_16x16x32_bf16 v[56:59], a[236:239], v[24:27], v[56:59]
    v_mfma_f32_16x16x32_bf16 v[60:63], a[236:239], v[28:31], v[60:63]
    s_nop 3
    v_permlane32_swap_b32 v40, v44
    v_permlane32_swap_b32 v41, v45
    v_permlane32_swap_b32 v42, v46
    v_permlane32_swap_b32 v43, v47
    v_permlane32_swap_b32 v48, v52
    v_permlane32_swap_b32 v49, v53
    v_permlane32_swap_b32 v50, v54
    v_permlane32_swap_b32 v51, v55
    v_permlane32_swap_b32 v56, v60
    v_permlane32_swap_b32 v57, v61
    v_permlane32_swap_b32 v58, v62
    v_permlane32_swap_b32 v59, v63
    v_cvt_pk_bf16_f32 v16, v40, v41
    v_cvt_pk_bf16_f32 v17, v42, v43
    v_cvt_pk_bf16_f32 v18, v48, v49
    v_cvt_pk_bf16_f32 v19, v50, v51
    v_cvt_pk_bf16_f32 v20, v56, v57
    v_cvt_pk_bf16_f32 v21, v58, v59
    v_lshlrev_b32 v40, 16, v16
    v_and_b32 v41, 0xffff0000, v16
    v_lshlrev_b32 v42, 16, v17
    v_and_b32 v43, 0xffff0000, v17
    v_lshlrev_b32 v48, 16, v18
    v_and_b32 v49, 0xffff0000, v18
    v_lshlrev_b32 v50, 16, v19
    v_and_b32 v51, 0xffff0000, v19
    v_lshlrev_b32 v56, 16, v20
    v_and_b32 v57, 0xffff0000, v20
    v_lshlrev_b32 v58, 16, v21
    v_and_b32 v59, 0xffff0000, v21
    v_cvt_pk_bf16_f32 v22, v44, v45
    v_cvt_pk_bf16_f32 v23, v46, v47
    v_cvt_pk_bf16_f32 v24, v52, v53
    v_cvt_pk_bf16_f32 v25, v54, v55
    v_cvt_pk_bf16_f32 v26, v60, v61
    v_cvt_pk_bf16_f32 v27, v62, v63
    v_lshlrev_b32 v44, 16, v22
    v_and_b32 v45, 0xffff0000, v22
    v_lshlrev_b32 v46, 16, v23
    v_and_b32 v47, 0xffff0000, v23
    v_lshlrev_b32 v52, 16, v24
    v_and_b32 v53, 0xffff0000, v24
    v_lshlrev_b32 v54, 16, v25
    v_and_b32 v55, 0xffff0000, v25
    v_lshlrev_b32 v60, 16, v26
    v_and_b32 v61, 0xffff0000, v26
    v_lshlrev_b32 v62, 16, v27
    v_and_b32 v63, 0xffff0000, v27
    v_mul_f32 v40, s40, v40
    v_mul_f32 v41, s40, v41
    v_mul_f32 v42, s40, v42
    v_mul_f32 v43, s40, v43
    v_mul_f32 v48, s40, v48
    v_mul_f32 v49, s40, v49
    v_mul_f32 v50, s40, v50
    v_mul_f32 v51, s40, v51
    v_mul_f32 v56, s40, v56
    v_mul_f32 v57, s40, v57
    v_mul_f32 v58, s40, v58
    v_mul_f32 v59, s40, v59
    v_exp_f32 v40, v40
    v_exp_f32 v41, v41
    v_exp_f32 v42, v42
    v_exp_f32 v43, v43
    v_exp_f32 v48, v48
    v_exp_f32 v49, v49
    v_exp_f32 v50, v50
    v_exp_f32 v51, v51
    v_exp_f32 v56, v56
    v_exp_f32 v57, v57
    v_exp_f32 v58, v58
    v_exp_f32 v59, v59
    v_add_f32 v40, 1.0, v40
    v_add_f32 v41, 1.0, v41
    v_add_f32 v42, 1.0, v42
    v_add_f32 v43, 1.0, v43
    v_add_f32 v48, 1.0, v48
    v_add_f32 v49, 1.0, v49
    v_add_f32 v50, 1.0, v50
    v_add_f32 v51, 1.0, v51
    v_add_f32 v56, 1.0, v56
    v_add_f32 v57, 1.0, v57
    v_add_f32 v58, 1.0, v58
    v_add_f32 v59, 1.0, v59
    v_rcp_f32 v40, v40
    v_rcp_f32 v41, v41
    v_rcp_f32 v42, v42
    v_rcp_f32 v43, v43
    v_rcp_f32 v48, v48
    v_rcp_f32 v49, v49
    v_rcp_f32 v50, v50
    v_rcp_f32 v51, v51
    v_rcp_f32 v56, v56
    v_rcp_f32 v57, v57
    v_rcp_f32 v58, v58
    v_rcp_f32 v59, v59
    v_cvt_pk_bf16_f32 v16, v40, v41
    v_cvt_pk_bf16_f32 v17, v42, v43
    v_cvt_pk_bf16_f32 v18, v48, v49
    v_cvt_pk_bf16_f32 v19, v50, v51
    v_cvt_pk_bf16_f32 v20, v56, v57
    v_cvt_pk_bf16_f32 v21, v58, v59
    v_lshlrev_b32 v40, 16, v16
    v_and_b32 v41, 0xffff0000, v16
    v_lshlrev_b32 v42, 16, v17
    v_and_b32 v43, 0xffff0000, v17
    v_lshlrev_b32 v48, 16, v18
    v_and_b32 v49, 0xffff0000, v18
    v_lshlrev_b32 v50, 16, v19
    v_and_b32 v51, 0xffff0000, v19
    v_lshlrev_b32 v56, 16, v20
    v_and_b32 v57, 0xffff0000, v20
    v_lshlrev_b32 v58, 16, v21
    v_and_b32 v59, 0xffff0000, v21
    v_mul_f32 v40, v40, v44
    v_mul_f32 v41, v41, v45
    v_mul_f32 v42, v42, v46
    v_mul_f32 v43, v43, v47
    v_mul_f32 v48, v48, v52
    v_mul_f32 v49, v49, v53
    v_mul_f32 v50, v50, v54
    v_mul_f32 v51, v51, v55
    v_mul_f32 v56, v56, v60
    v_mul_f32 v57, v57, v61
    v_mul_f32 v58, v58, v62
    v_mul_f32 v59, v59, v63
    s_mul_i32 s25, s12, 3
    v_cvt_pk_bf16_f32 v64, v40, v41
    v_cvt_pk_bf16_f32 v65, v42, v43
    s_add_u32 s26, s25, 0
    s_lshr_b32 s27, s26, 2
    s_lshl_b32 s27, s27, 10
    s_bfe_u32 s3, s26, 0x10001
    s_lshl_b32 s3, s3, 3
    s_add_u32 s27, s27, s3
    s_and_b32 s3, s26, 1
    s_lshl_b32 s3, s3, 9
    s_add_u32 s27, s27, s3
    v_add_u32 v12, s27, v13
    ds_write_b64 v12, v[64:65]
    v_cvt_pk_bf16_f32 v66, v48, v49
    v_cvt_pk_bf16_f32 v67, v50, v51
    s_add_u32 s26, s25, 1
    s_lshr_b32 s27, s26, 2
    s_lshl_b32 s27, s27, 10
    s_bfe_u32 s3, s26, 0x10001
    s_lshl_b32 s3, s3, 3
    s_add_u32 s27, s27, s3
    s_and_b32 s3, s26, 1
    s_lshl_b32 s3, s3, 9
    s_add_u32 s27, s27, s3
    v_add_u32 v12, s27, v13
    ds_write_b64 v12, v[66:67]
    v_cvt_pk_bf16_f32 v68, v56, v57
    v_cvt_pk_bf16_f32 v69, v58, v59
    s_add_u32 s26, s25, 2
    s_lshr_b32 s27, s26, 2
    s_lshl_b32 s27, s27, 10
    s_bfe_u32 s3, s26, 0x10001
    s_lshl_b32 s3, s3, 3
    s_add_u32 s27, s27, s3
    s_and_b32 s3, s26, 1
    s_lshl_b32 s3, s3, 9
    s_add_u32 s27, s27, s3
    v_add_u32 v12, s27, v13
    ds_write_b64 v12, v[68:69]
    s_waitcnt lgkmcnt(0)
    s_barrier
    ds_read_b128 v[16:19], v0 offset:40960
    ds_read_b128 v[20:23], v0 offset:41984
    ds_read_b128 v[24:27], v0 offset:43008
    ds_read_b128 v[28:31], v0 offset:44032
    ds_read_b128 v[32:35], v0 offset:45056
    ds_read_b128 v[36:39], v0 offset:46080
    s_waitcnt lgkmcnt(5)
    v_mfma_f32_16x16x32_bf16 v[40:43], v[136:139], v[16:19], 0
    s_waitcnt lgkmcnt(4)
    v_mfma_f32_16x16x32_bf16 v[40:43], v[140:143], v[20:23], v[40:43]
    s_waitcnt lgkmcnt(3)
    v_mfma_f32_16x16x32_bf16 v[40:43], v[144:147], v[24:27], v[40:43]
    v_mfma_f32_16x16x32_bf16 v[44:47], v[148:151], v[16:19], 0
    v_mfma_f32_16x16x32_bf16 v[44:47], v[152:155], v[20:23], v[44:47]
    v_mfma_f32_16x16x32_bf16 v[44:47], v[156:159], v[24:27], v[44:47]
    s_waitcnt lgkmcnt(2)
    v_mfma_f32_16x16x32_bf16 v[48:51], v[136:139], v[28:31], 0
    s_nop 2
    v_cvt_pk_bf16_f32 v56, v40, v41
    s_waitcnt lgkmcnt(1)
    v_mfma_f32_16x16x32_bf16 v[48:51], v[140:143], v[32:35], v[48:51]
    v_cvt_pk_bf16_f32 v57, v42, v43
    s_waitcnt lgkmcnt(0)
    v_mfma_f32_16x16x32_bf16 v[48:51], v[144:147], v[36:39], v[48:51]
    v_and_or_b32 v56, v56, -2, s28
    v_mfma_f32_16x16x32_bf16 v[52:55], v[148:151], v[28:31], 0
    v_cvt_pk_bf16_f32 v58, v44, v45
    v_mfma_f32_16x16x32_bf16 v[52:55], v[152:155], v[32:35], v[52:55]
    v_cvt_pk_bf16_f32 v59, v46, v47
    v_mfma_f32_16x16x32_bf16 v[52:55], v[156:159], v[36:39], v[52:55]
    buffer_store_dwordx4 v[56:59], v4, s[4:7], s30 offen offset:0 sc1
    v_mfma_f32_16x16x32_bf16 v[40:43], v[160:163], v[16:19], 0
    v_cvt_pk_bf16_f32 v60, v48, v49
    v_mfma_f32_16x16x32_bf16 v[40:43], v[164:167], v[20:23], v[40:43]
    v_cvt_pk_bf16_f32 v61, v50, v51
    v_mfma_f32_16x16x32_bf16 v[40:43], v[168:171], v[24:27], v[40:43]
    v_and_or_b32 v60, v60, -2, s28
    v_mfma_f32_16x16x32_bf16 v[44:47], v[172:175], v[16:19], 0
    v_cvt_pk_bf16_f32 v62, v52, v53
    v_mfma_f32_16x16x32_bf16 v[44:47], v[176:179], v[20:23], v[44:47]
    v_cvt_pk_bf16_f32 v63, v54, v55
    v_mfma_f32_16x16x32_bf16 v[44:47], v[180:183], v[24:27], v[44:47]
    buffer_store_dwordx4 v[60:63], v4, s[4:7], s31 offen offset:0 sc1
    v_mfma_f32_16x16x32_bf16 v[48:51], v[160:163], v[28:31], 0
    v_cvt_pk_bf16_f32 v56, v40, v41
    v_mfma_f32_16x16x32_bf16 v[48:51], v[164:167], v[32:35], v[48:51]
    v_cvt_pk_bf16_f32 v57, v42, v43
    v_mfma_f32_16x16x32_bf16 v[48:51], v[168:171], v[36:39], v[48:51]
    v_and_or_b32 v56, v56, -2, s28
    v_mfma_f32_16x16x32_bf16 v[52:55], v[172:175], v[28:31], 0
    v_cvt_pk_bf16_f32 v58, v44, v45
    v_mfma_f32_16x16x32_bf16 v[52:55], v[176:179], v[32:35], v[52:55]
    v_cvt_pk_bf16_f32 v59, v46, v47
    v_mfma_f32_16x16x32_bf16 v[52:55], v[180:183], v[36:39], v[52:55]
    buffer_store_dwordx4 v[56:59], v4, s[4:7], s30 offen offset:64 sc1
    v_mfma_f32_16x16x32_bf16 v[40:43], v[184:187], v[16:19], 0
    v_cvt_pk_bf16_f32 v60, v48, v49
    v_mfma_f32_16x16x32_bf16 v[40:43], v[188:191], v[20:23], v[40:43]
    v_cvt_pk_bf16_f32 v61, v50, v51
    v_mfma_f32_16x16x32_bf16 v[40:43], v[192:195], v[24:27], v[40:43]
    v_and_or_b32 v60, v60, -2, s28
    v_mfma_f32_16x16x32_bf16 v[44:47], v[196:199], v[16:19], 0
    v_cvt_pk_bf16_f32 v62, v52, v53
    v_mfma_f32_16x16x32_bf16 v[44:47], v[200:203], v[20:23], v[44:47]
    v_cvt_pk_bf16_f32 v63, v54, v55
    v_mfma_f32_16x16x32_bf16 v[44:47], v[204:207], v[24:27], v[44:47]
    buffer_store_dwordx4 v[60:63], v4, s[4:7], s31 offen offset:64 sc1
    v_mfma_f32_16x16x32_bf16 v[48:51], v[184:187], v[28:31], 0
    v_cvt_pk_bf16_f32 v56, v40, v41
    v_mfma_f32_16x16x32_bf16 v[48:51], v[188:191], v[32:35], v[48:51]
    v_cvt_pk_bf16_f32 v57, v42, v43
    v_mfma_f32_16x16x32_bf16 v[48:51], v[192:195], v[36:39], v[48:51]
    v_and_or_b32 v56, v56, -2, s28
    v_mfma_f32_16x16x32_bf16 v[52:55], v[196:199], v[28:31], 0
    v_cvt_pk_bf16_f32 v58, v44, v45
    v_mfma_f32_16x16x32_bf16 v[52:55], v[200:203], v[32:35], v[52:55]
    v_cvt_pk_bf16_f32 v59, v46, v47
    v_mfma_f32_16x16x32_bf16 v[52:55], v[204:207], v[36:39], v[52:55]
    buffer_store_dwordx4 v[56:59], v4, s[4:7], s30 offen offset:128 sc1
    v_mfma_f32_16x16x32_bf16 v[40:43], v[208:211], v[16:19], 0
    v_cvt_pk_bf16_f32 v60, v48, v49
    v_mfma_f32_16x16x32_bf16 v[40:43], v[212:215], v[20:23], v[40:43]
    v_cvt_pk_bf16_f32 v61, v50, v51
    v_mfma_f32_16x16x32_bf16 v[40:43], v[216:219], v[24:27], v[40:43]
    v_and_or_b32 v60, v60, -2, s28
    v_mfma_f32_16x16x32_bf16 v[44:47], v[220:223], v[16:19], 0
    v_cvt_pk_bf16_f32 v62, v52, v53
    v_mfma_f32_16x16x32_bf16 v[44:47], v[224:227], v[20:23], v[44:47]
    v_cvt_pk_bf16_f32 v63, v54, v55
    v_mfma_f32_16x16x32_bf16 v[44:47], v[228:231], v[24:27], v[44:47]
    buffer_store_dwordx4 v[60:63], v4, s[4:7], s31 offen offset:128 sc1
    v_mfma_f32_16x16x32_bf16 v[48:51], v[208:211], v[28:31], 0
    v_cvt_pk_bf16_f32 v56, v40, v41
    v_mfma_f32_16x16x32_bf16 v[48:51], v[212:215], v[32:35], v[48:51]
    v_cvt_pk_bf16_f32 v57, v42, v43
    v_mfma_f32_16x16x32_bf16 v[48:51], v[216:219], v[36:39], v[48:51]
    v_and_or_b32 v56, v56, -2, s28
    v_mfma_f32_16x16x32_bf16 v[52:55], v[220:223], v[28:31], 0
    v_cvt_pk_bf16_f32 v58, v44, v45
    v_mfma_f32_16x16x32_bf16 v[52:55], v[224:227], v[32:35], v[52:55]
    v_cvt_pk_bf16_f32 v59, v46, v47
    v_mfma_f32_16x16x32_bf16 v[52:55], v[228:231], v[36:39], v[52:55]
    buffer_store_dwordx4 v[56:59], v4, s[4:7], s30 offen offset:192 sc1
    v_mfma_f32_16x16x32_bf16 v[40:43], v[232:235], v[16:19], 0
    v_cvt_pk_bf16_f32 v60, v48, v49
    v_mfma_f32_16x16x32_bf16 v[40:43], v[236:239], v[20:23], v[40:43]
    v_cvt_pk_bf16_f32 v61, v50, v51
    v_mfma_f32_16x16x32_bf16 v[40:43], v[240:243], v[24:27], v[40:43]
    v_and_or_b32 v60, v60, -2, s28
    v_mfma_f32_16x16x32_bf16 v[44:47], v[244:247], v[16:19], 0
    v_cvt_pk_bf16_f32 v62, v52, v53
    v_mfma_f32_16x16x32_bf16 v[44:47], v[248:251], v[20:23], v[44:47]
    v_cvt_pk_bf16_f32 v63, v54, v55
    v_mfma_f32_16x16x32_bf16 v[44:47], v[252:255], v[24:27], v[44:47]
    buffer_store_dwordx4 v[60:63], v4, s[4:7], s31 offen offset:192 sc1
    v_mfma_f32_16x16x32_bf16 v[48:51], v[232:235], v[28:31], 0
    v_cvt_pk_bf16_f32 v56, v40, v41
    v_mfma_f32_16x16x32_bf16 v[48:51], v[236:239], v[32:35], v[48:51]
    v_cvt_pk_bf16_f32 v57, v42, v43
    v_mfma_f32_16x16x32_bf16 v[48:51], v[240:243], v[36:39], v[48:51]
    v_and_or_b32 v56, v56, -2, s28
    v_mfma_f32_16x16x32_bf16 v[52:55], v[244:247], v[28:31], 0
    v_cvt_pk_bf16_f32 v58, v44, v45
    v_mfma_f32_16x16x32_bf16 v[52:55], v[248:251], v[32:35], v[52:55]
    v_cvt_pk_bf16_f32 v59, v46, v47
    v_mfma_f32_16x16x32_bf16 v[52:55], v[252:255], v[36:39], v[52:55]
    buffer_store_dwordx4 v[56:59], v4, s[4:7], s30 offen offset:256 sc1
    s_nop 0
    v_cvt_pk_bf16_f32 v60, v48, v49
    v_cvt_pk_bf16_f32 v61, v50, v51
    v_and_or_b32 v60, v60, -2, s28
    s_nop 2
    v_cvt_pk_bf16_f32 v62, v52, v53
    v_cvt_pk_bf16_f32 v63, v54, v55
    buffer_store_dwordx4 v[60:63], v4, s[4:7], s31 offen offset:256 sc1
    s_waitcnt vmcnt(0)
    buffer_load_dwordx4 v[64:67], v5, s[4:7], s32 offen offset:0 sc1
    buffer_load_dwordx4 v[68:71], v5, s[4:7], s33 offen offset:0 sc1
    buffer_load_dwordx4 v[72:75], v5, s[4:7], s32 offen offset:256 sc1
    buffer_load_dwordx4 v[76:79], v5, s[4:7], s33 offen offset:256 sc1
    buffer_load_dwordx4 v[80:83], v5, s[4:7], s32 offen offset:512 sc1
    buffer_load_dwordx4 v[84:87], v5, s[4:7], s33 offen offset:512 sc1
    buffer_load_dwordx4 v[88:91], v5, s[4:7], s32 offen offset:768 sc1
    buffer_load_dwordx4 v[92:95], v5, s[4:7], s33 offen offset:768 sc1
    buffer_load_dwordx4 v[96:99], v5, s[4:7], s32 offen offset:1024 sc1
    buffer_load_dwordx4 v[100:103], v5, s[4:7], s33 offen offset:1024 sc1
    s_mov_b32 s19, 0
L_Gs_red_4:
    s_waitcnt vmcnt(9)
    v_mfma_f32_16x16x32_bf16 v[104:107], a[240:243], v[64:67], 0
    v_xor_b32 v12, s29, v64
    s_waitcnt vmcnt(8)
    v_mfma_f32_16x16x32_bf16 v[104:107], a[240:243], v[68:71], v[104:107]
    v_bitop3_b32 v12, v12, v68, s29 bitop3:0xf6
    s_waitcnt vmcnt(7)
    v_mfma_f32_16x16x32_bf16 v[104:107], a[244:247], v[72:75], v[104:107]
    v_bitop3_b32 v12, v12, v72, s29 bitop3:0xf6
    s_waitcnt vmcnt(6)
    v_mfma_f32_16x16x32_bf16 v[104:107], a[244:247], v[76:79], v[104:107]
    v_bitop3_b32 v12, v12, v76, s29 bitop3:0xf6
    s_waitcnt vmcnt(5)
    v_mfma_f32_16x16x32_bf16 v[108:111], a[240:243], v[80:83], 0
    v_bitop3_b32 v12, v12, v80, s29 bitop3:0xf6
    s_waitcnt vmcnt(4)
    v_mfma_f32_16x16x32_bf16 v[108:111], a[240:243], v[84:87], v[108:111]
    v_bitop3_b32 v12, v12, v84, s29 bitop3:0xf6
    s_waitcnt vmcnt(3)
    v_mfma_f32_16x16x32_bf16 v[108:111], a[244:247], v[88:91], v[108:111]
    v_bitop3_b32 v12, v12, v88, s29 bitop3:0xf6
    s_waitcnt vmcnt(2)
    v_mfma_f32_16x16x32_bf16 v[108:111], a[244:247], v[92:95], v[108:111]
    v_bitop3_b32 v12, v12, v92, s29 bitop3:0xf6
    s_waitcnt vmcnt(1)
    v_mfma_f32_16x16x32_bf16 v[112:115], a[240:243], v[96:99], 0
    v_bitop3_b32 v12, v12, v96, s29 bitop3:0xf6
    s_waitcnt vmcnt(0)
    v_mfma_f32_16x16x32_bf16 v[112:115], a[240:243], v[100:103], v[112:115]
    v_bitop3_b32 v12, v12, v100, s29 bitop3:0xf6
    v_and_b32 v12, 1, v12
    v_cmp_ne_u32 vcc, 0, v12
    s_nop 0
    s_cbranch_vccnz L_Gs_redfix_5
    ds_write_b128 v14, v[104:107] offset:0
    ds_write_b128 v14, v[108:111] offset:1024
    s_nop 0
    ds_write_b128 v14, v[112:115] offset:2048
    s_add_u32 s32, s32, s39
    s_add_u32 s33, s33, s39
    s_add_u32 s30, s30, s39
    s_add_u32 s31, s31, s39
    s_sub_u32 s39, 0, s39
    s_add_u32 s22, s22, 1
    s_waitcnt lgkmcnt(0)
    s_barrier
    s_bitcmp1_b32 s12, 0
    s_cbranch_scc1 L_Gs_nofin_6
    ds_read_b128 v[16:19], v14 offset:0
    ds_read_b128 v[20:23], v14 offset:1024
    ds_read_b128 v[24:27], v14 offset:2048
    ds_read_b128 v[28:31], v14 offset:3072
    ds_read_b128 v[32:35], v14 offset:4096
    ds_read_b128 v[36:39], v14 offset:5120
    s_waitcnt lgkmcnt(0)
    v_pk_add_f32 v[16:17], v[16:17], v[28:29]
    v_pk_add_f32 v[18:19], v[18:19], v[30:31]
    v_pk_add_f32 v[20:21], v[20:21], v[32:33]
    v_pk_add_f32 v[22:23], v[22:23], v[34:35]
    v_pk_add_f32 v[24:25], v[24:25], v[36:37]
    v_pk_add_f32 v[26:27], v[26:27], v[38:39]
    v_cvt_pk_bf16_f32 v64, v16, v17
    v_cvt_pk_bf16_f32 v65, v18, v19
    v_cvt_pk_bf16_f32 v66, v20, v21
    v_cvt_pk_bf16_f32 v67, v22, v23
    v_cvt_pk_bf16_f32 v68, v24, v25
    v_cvt_pk_bf16_f32 v69, v26, v27
    v_lshlrev_b32 v16, 16, v64
    v_and_b32 v17, 0xffff0000, v64
    v_lshlrev_b32 v18, 16, v65
    v_and_b32 v19, 0xffff0000, v65
    v_lshlrev_b32 v20, 16, v66
    v_and_b32 v21, 0xffff0000, v66
    v_lshlrev_b32 v22, 16, v67
    v_and_b32 v23, 0xffff0000, v67
    v_lshlrev_b32 v24, 16, v68
    v_and_b32 v25, 0xffff0000, v68
    v_lshlrev_b32 v26, 16, v69
    v_and_b32 v27, 0xffff0000, v69
    v_lshlrev_b32 v28, 16, v120
    v_and_b32 v29, 0xffff0000, v120
    v_lshlrev_b32 v30, 16, v121
    v_and_b32 v31, 0xffff0000, v121
    v_lshlrev_b32 v32, 16, v122
    v_and_b32 v33, 0xffff0000, v122
    v_lshlrev_b32 v34, 16, v123
    v_and_b32 v35, 0xffff0000, v123
    v_lshlrev_b32 v36, 16, v124
    v_and_b32 v37, 0xffff0000, v124
    v_lshlrev_b32 v38, 16, v125
    v_and_b32 v39, 0xffff0000, v125
    v_pk_add_f32 v[16:17], v[16:17], v[28:29]
    v_pk_add_f32 v[18:19], v[18:19], v[30:31]
    v_pk_add_f32 v[20:21], v[20:21], v[32:33]
    v_pk_add_f32 v[22:23], v[22:23], v[34:35]
    v_pk_add_f32 v[24:25], v[24:25], v[36:37]
    v_pk_add_f32 v[26:27], v[26:27], v[38:39]
    v_cndmask_b32 v24, 0, v24, s[44:45]
    v_cndmask_b32 v25, 0, v25, s[44:45]
    v_cndmask_b32 v26, 0, v26, s[44:45]
    v_cndmask_b32 v27, 0, v27, s[44:45]
    v_cvt_pk_bf16_f32 v64, v16, v17
    v_cvt_pk_bf16_f32 v65, v18, v19
    v_cvt_pk_bf16_f32 v66, v20, v21
    v_cvt_pk_bf16_f32 v67, v22, v23
    v_cvt_pk_bf16_f32 v68, v24, v25
    v_cvt_pk_bf16_f32 v69, v26, v27
    v_lshlrev_b32 v16, 16, v64
    v_and_b32 v17, 0xffff0000, v64
    v_lshlrev_b32 v18, 16, v65
    v_and_b32 v19, 0xffff0000, v65
    v_lshlrev_b32 v20, 16, v66
    v_and_b32 v21, 0xffff0000, v66
    v_lshlrev_b32 v22, 16, v67
    v_and_b32 v23, 0xffff0000, v67
    v_lshlrev_b32 v24, 16, v68
    v_and_b32 v25, 0xffff0000, v68
    v_lshlrev_b32 v26, 16, v69
    v_and_b32 v27, 0xffff0000, v69
    s_cmp_lg_u32 s20, 0
    s_cbranch_scc1 L_Gs_last_7
    v_mov_b32 v72, v64
    v_mov_b32 v73, v65
    v_mov_b32 v74, v66
    v_mov_b32 v75, v67
    v_mov_b32 v76, v68
    v_mov_b32 v77, v69
    v_mov_b32 v78, v68
    v_mov_b32 v79, v69
    v_permlane16_swap_b32 v72, v74
    v_permlane16_swap_b32 v73, v75
    v_permlane16_swap_b32 v76, v78
    v_permlane16_swap_b32 v77, v79
    buffer_store_dwordx4 v[72:75], v8, s[4:7], s36 offen sc1
    s_mov_b64 exec, 0xffff
    buffer_store_dwordx4 v[76:79], v8, s[4:7], s36 offen offset:1024 sc1
    s_mov_b64 exec, -1
    v_pk_add_f32 v[32:33], v[16:17], v[18:19]
    v_pk_add_f32 v[32:33], v[32:33], v[20:21]
    v_pk_add_f32 v[32:33], v[32:33], v[22:23]
    v_pk_add_f32 v[32:33], v[32:33], v[24:25]
    v_pk_add_f32 v[32:33], v[32:33], v[26:27]
    v_add_f32 v28, v32, v33
    s_nop 1
    v_add_f32_dpp v28, v28, v28 quad_perm:[1,0,3,2] row_mask:0xf bank_mask:0xf
    s_nop 1
    v_add_f32_dpp v28, v28, v28 quad_perm:[2,3,0,1] row_mask:0xf bank_mask:0xf
    s_nop 1
    v_add_f32_dpp v28, v28, v28 row_half_mirror row_mask:0xf bank_mask:0xf
    s_nop 1
    v_add_f32_dpp v28, v28, v28 row_mirror row_mask:0xf bank_mask:0xf
    v_mov_b32 v29, v28
    s_nop 1
    v_permlane16_swap_b32 v28, v29
    v_add_f32 v28, v28, v29
    v_mov_b32 v29, v28
    s_nop 1
    v_permlane32_swap_b32 v28, v29
    v_add_f32 v28, v28, v29
    v_mul_f32 v30, 1.5625000000e-03, v28
    v_sub_f32 v32, v16, v30
    v_sub_f32 v33, v17, v30
    v_sub_f32 v34, v18, v30
    v_sub_f32 v35, v19, v30
    v_sub_f32 v36, v20, v30
    v_sub_f32 v37, v21, v30
    v_sub_f32 v38, v22, v30
    v_sub_f32 v39, v23, v30
    v_sub_f32 v40, v24, v30
    v_sub_f32 v41, v25, v30
    v_sub_f32 v42, v26, v30
    v_sub_f32 v43, v27, v30
    v_cndmask_b32 v40, 0, v40, s[44:45]
    v_cndmask_b32 v41, 0, v41, s[44:45]
    v_cndmask_b32 v42, 0, v42, s[44:45]
    v_cndmask_b32 v43, 0, v43, s[44:45]
    v_mul_f32 v28, v32, v32
    v_fmac_f32 v28, v33, v33
    v_fmac_f32 v28, v34, v34
    v_fmac_f32 v28, v35, v35
    v_fmac_f32 v28, v36, v36
    v_fmac_f32 v28, v37, v37
    v_fmac_f32 v28, v38, v38
    v_fmac_f32 v28, v39, v39
    v_fmac_f32 v28, v40, v40
    v_fmac_f32 v28, v41, v41
    v_fmac_f32 v28, v42, v42
    v_fmac_f32 v28, v43, v43
    s_nop 1
    v_add_f32_dpp v28, v28, v28 quad_perm:[1,0,3,2] row_mask:0xf bank_mask:0xf
    s_nop 1
    v_add_f32_dpp v28, v28, v28 quad_perm:[2,3,0,1] row_mask:0xf bank_mask:0xf
    s_nop 1
    v_add_f32_dpp v28, v28, v28 row_half_mirror row_mask:0xf bank_mask:0xf
    s_nop 1
    v_add_f32_dpp v28, v28, v28 row_mirror row_mask:0xf bank_mask:0xf
    v_mov_b32 v29, v28
    s_nop 1
    v_permlane16_swap_b32 v28, v29
    v_add_f32 v28, v28, v29
    v_mov_b32 v29, v28
    s_nop 1
    v_permlane32_swap_b32 v28, v29
    v_add_f32 v28, v28, v29
    v_mul_f32 v28, 1.5625000000e-03, v28
    v_cvt_pk_bf16_f32 v29, v28, v30
    v_lshlrev_b32 v28, 16, v29
    v_and_b32 v30, 0xffff0000, v29
    v_add_f32 v28, 0x3727c5ac, v28
    v_cvt_pk_bf16_f32 v29, v28, v28
    v_lshlrev_b32 v28, 16, v29
    v_sqrt_f32 v28, v28
    v_sub_f32 v32, v16, v30
    v_sub_f32 v33, v17, v30
    v_sub_f32 v34, v18, v30
    v_sub_f32 v35, v19, v30
    v_sub_f32 v36, v20, v30
    v_sub_f32 v37, v21, v30
    v_sub_f32 v38, v22, v30
    v_sub_f32 v39, v23, v30
    v_sub_f32 v40, v24, v30
    v_sub_f32 v41, v25, v30
    v_sub_f32 v42, v26, v30
    v_sub_f32 v43, v27, v30
    v_cvt_pk_bf16_f32 v29, v28, v28
    v_lshlrev_b32 v28, 16, v29
    v_rcp_f32 v28, v28
    v_cvt_pk_bf16_f32 v64, v32, v33
    v_cvt_pk_bf16_f32 v65, v34, v35
    v_cvt_pk_bf16_f32 v66, v36, v37
    v_cvt_pk_bf16_f32 v67, v38, v39
    v_cvt_pk_bf16_f32 v68, v40, v41
    v_cvt_pk_bf16_f32 v69, v42, v43
    v_lshlrev_b32 v32, 16, v64
    v_and_b32 v33, 0xffff0000, v64
    v_lshlrev_b32 v34, 16, v65
    v_and_b32 v35, 0xffff0000, v65
    v_lshlrev_b32 v36, 16, v66
    v_and_b32 v37, 0xffff0000, v66
    v_lshlrev_b32 v38, 16, v67
    v_and_b32 v39, 0xffff0000, v67
    v_lshlrev_b32 v40, 16, v68
    v_and_b32 v41, 0xffff0000, v68
    v_lshlrev_b32 v42, 16, v69
    v_and_b32 v43, 0xffff0000, v69
    v_mul_f32 v32, v32, v28
    v_mul_f32 v33, v33, v28
    v_mul_f32 v34, v34, v28
    v_mul_f32 v35, v35, v28
    v_mul_f32 v36, v36, v28
    v_mul_f32 v37, v37, v28
    v_mul_f32 v38, v38, v28
    v_mul_f32 v39, v39, v28
    v_mul_f32 v40, v40, v28
    v_mul_f32 v41, v41, v28
    v_mul_f32 v42, v42, v28
    v_mul_f32 v43, v43, v28
    v_cvt_pk_bf16_f32 v64, v32, v33
    v_cvt_pk_bf16_f32 v65, v34, v35
    v_cvt_pk_bf16_f32 v66, v36, v37
    v_cvt_pk_bf16_f32 v67, v38, v39
    v_cvt_pk_bf16_f32 v68, v40, v41
    v_cvt_pk_bf16_f32 v69, v42, v43
    v_mov_b32 v72, v64
    v_mov_b32 v73, v65
    v_mov_b32 v74, v66
    v_mov_b32 v75, v67
    v_mov_b32 v76, v68
    v_mov_b32 v77, v69
    v_mov_b32 v78, v68
    v_mov_b32 v79, v69
    v_permlane16_swap_b32 v72, v74
    v_permlane16_swap_b32 v73, v75
    v_permlane16_swap_b32 v76, v78
    v_permlane16_swap_b32 v77, v79
    buffer_store_dwordx4 v[72:75], v8, s[4:7], s37 offen sc1
    s_mov_b64 exec, 0xffff
    buffer_store_dwordx4 v[76:79], v8, s[4:7], s37 offen offset:1024 sc1
    s_mov_b64 exec, -1
    s_branch L_Gs_nofin_6
L_Gs_last_7:
    buffer_store_dwordx2 v[64:65], v7, s[92:95], s36 offen offset:0
    buffer_store_dwordx2 v[66:67], v7, s[92:95], s36 offen offset:512
    s_mov_b64 exec, s[44:45]
    buffer_store_dwordx2 v[68:69], v7, s[92:95], s36 offen offset:1024
    s_mov_b64 exec, -1
L_Gs_nofin_6:
    s_add_u32 s35, s35, 40960
    s_add_u32 s36, s36, 40960
    s_add_u32 s37, s37, 40960
    s_add_u32 s38, s38, 40960
    s_cmp_lt_u32 s22, 64
    s_cbranch_scc1 L_Gs_top
    s_waitcnt vmcnt(0)
    s_bitcmp1_b32 s12, 0
    s_cbranch_scc1 L_Gs_nofin_6x
    v_mov_b32 v11, s22
    s_mov_b64 exec, 1
    buffer_store_dword v11, v0, s[4:7], s23 offen offset:0 sc1
    s_mov_b64 exec, -1
L_Gs_nofin_6x:
    s_waitcnt vmcnt(0)
    s_endpgm
L_Gs_flspin_3:
    buffer_load_dword v10, v9, s[4:7], s24 offen sc1
    s_add_u32 s19, s19, 1
    s_cmp_ge_u32 s19, 524288
    s_cbranch_scc1 L_fail
    s_waitcnt vmcnt(0)
    v_cmp_gt_u32 vcc, s41, v10
    s_nop 0
    s_cbranch_vccnz L_Gs_flspin_3
    s_branch L_Gs_fl_2
L_Gs_redfix_5:
    buffer_load_dwordx4 v[64:67], v5, s[4:7], s32 offen offset:0 sc1
    buffer_load_dwordx4 v[68:71], v5, s[4:7], s33 offen offset:0 sc1
    buffer_load_dwordx4 v[72:75], v5, s[4:7], s32 offen offset:256 sc1
    buffer_load_dwordx4 v[76:79], v5, s[4:7], s33 offen offset:256 sc1
    buffer_load_dwordx4 v[80:83], v5, s[4:7], s32 offen offset:512 sc1
    buffer_load_dwordx4 v[84:87], v5, s[4:7], s33 offen offset:512 sc1
    buffer_load_dwordx4 v[88:91], v5, s[4:7], s32 offen offset:768 sc1
    buffer_load_dwordx4 v[92:95], v5, s[4:7], s33 offen offset:768 sc1
    buffer_load_dwordx4 v[96:99], v5, s[4:7], s32 offen offset:1024 sc1
    buffer_load_dwordx4 v[100:103], v5, s[4:7], s33 offen offset:1024 sc1
    s_add_u32 s19, s19, 1
    s_cmp_lt_u32 s19, 524288
    s_cbranch_scc1 L_Gs_red_4
    s_branch L_fail
.section .rodata,"a"
.p2align 6
.amdhsa_kernel interleave_layers__memory_aug_recurrent_mem_tr__glu_gated_glu__prompt_kernel
  .amdhsa_next_free_vgpr 512
  .amdhsa_next_free_sgpr 102
  .amdhsa_accum_offset 256
  .amdhsa_group_segment_fixed_size 0
  .amdhsa_kernarg_size 112
  .amdhsa_user_sgpr_count 2
  .amdhsa_user_sgpr_kernarg_segment_ptr 1
  .amdhsa_system_sgpr_workgroup_id_x 1
  .amdhsa_float_denorm_mode_32 3
.end_amdhsa_kernel
```

```asm
; @launch grid=(256,1,1) block=(256,1,1) lds=163840
.amdgcn_target "amdgcn-amd-amdhsa--gfx950"
.text
.globl interleave_layers__memory_aug_recurrent_mem_tr__glu_gated_glu__prompt_kernel
.p2align 8
.type interleave_layers__memory_aug_recurrent_mem_tr__glu_gated_glu__prompt_kernel,@function
interleave_layers__memory_aug_recurrent_mem_tr__glu_gated_glu__prompt_kernel:
    s_cmp_ge_u32 s2, 256
    s_cbranch_scc1 L_exit
    s_load_dwordx16 s[64:79], s[0:1], 0
    s_load_dwordx8 s[80:87], s[0:1], 64
    s_load_dwordx4 s[88:91], s[0:1], 96
    s_getreg_b32 s14, hwreg(HW_REG_XCC_ID, 0, 4)
    v_lshrrev_b32 v2, 6, v0
    v_and_b32 v0, 63, v0
    v_readfirstlane_b32 s12, v2
    s_and_b32 s14, s14, 7
    s_mov_b32 s18, 0
    s_waitcnt lgkmcnt(0)
    s_mov_b64 s[16:17], s[88:89]

    s_mov_b32 s4, s90
    s_and_b32 s5, s91, 0xffff
    s_mov_b32 s6, 268435456
    s_mov_b32 s7, 0x20000
    s_mov_b32 s8, s90
    s_and_b32 s9, s91, 0xffff
    s_mov_b32 s10, 268435456
    s_mov_b32 s11, 0x20000
    v_mov_b32 v4, 163824
    s_cmp_lg_u32 s12, 0
    s_cbranch_scc1 L_ticket_done
    v_mov_b32 v3, 1
    s_lshl_b32 s15, s14, 2
    v_mov_b32 v2, s15
    s_mov_b64 exec, 1
    global_atomic_add v5, v2, v3, s[16:17] sc0 sc1
    s_waitcnt vmcnt(0)
    ds_write_b32 v4, v5
    s_waitcnt lgkmcnt(0)
    s_mov_b64 exec, -1
L_ticket_done:
    s_barrier
    ds_read_b32 v5, v4
    s_waitcnt lgkmcnt(0)
    v_readfirstlane_b32 s15, v5
    s_lshl_b32 s13, s14, 5
    s_add_u32 s13, s13, s15
    s_cmp_ge_u32 s15, 32
    s_cbranch_scc1 L_surplus

L_dispatch:
    s_cmp_lt_u32 s13, 64
    s_cbranch_scc1 L_roleR
    s_cmp_lt_u32 s13, 160
    s_cbranch_scc1 L_roleP
    s_cmp_lt_u32 s13, 224
    s_cbranch_scc1 L_roleO
    s_cmp_lt_u32 s13, 256
    s_cbranch_scc1 L_roleG
    s_endpgm
L_surplus:
    s_barrier
    s_cmp_lg_u32 s12, 0
    s_cbranch_scc1 L_E_arr_1
    s_lshl_b32 s3, s18, 2
    s_add_u32 s3, s3, 64
    v_mov_b32 v92, s3
    v_mov_b32 v93, 1
    s_mov_b64 exec, 1
    global_atomic_add v92, v93, s[16:17] sc1
    s_waitcnt vmcnt(0)
    s_mov_b64 exec, -1
L_E_arr_1:
    s_lshl_b32 s3, s18, 2
    s_add_u32 s3, s3, 64
    v_mov_b32 v92, s3
    v_lshlrev_b32 v94, 2, v0
    v_and_b32 v94, 28, v94
    s_mov_b32 s19, 0
L_E_warr_2:
    global_load_dword v93, v92, s[16:17] sc1
    s_add_u32 s19, s19, 1
    s_cmp_ge_u32 s19, 524288
    s_cbranch_scc1 L_fail
    s_waitcnt vmcnt(0)
    v_cmp_gt_u32 vcc, 256, v93
    s_nop 0
    s_cbranch_vccnz L_E_warr_2
L_fallback:
    s_barrier
    s_mov_b32 s18, 1
    s_mov_b32 s13, s2
    s_branch L_dispatch

L_fail:
    s_waitcnt vmcnt(0) lgkmcnt(0)
    s_mov_b64 exec, 1
    v_mov_b32 v2, 128
    v_mov_b32 v3, s13
    v_or_b32 v3, 0x10000, v3
    global_store_dword v2, v3, s[16:17]
    s_waitcnt vmcnt(0)
L_exit:
    s_endpgm

L_roleR:
    s_cmp_eq_u32 s12, 0
    s_cbranch_scc1 L_R0_start
    s_cmp_eq_u32 s12, 1
    s_cbranch_scc1 L_R1_start
    s_cmp_eq_u32 s12, 2
    s_cbranch_scc1 L_R2_start
    s_branch L_R3_start
L_R0_start:
    s_lshr_b32 s14, s13, 5
    s_and_b32 s15, s13, 31
    s_mov_b32 s62, 0
    v_lshlrev_b32 v10, 4, v0
    v_mov_b32 v12, 0
    v_mov_b32 v13, 0
    v_mov_b32 v14, 0
    v_mov_b32 v15, 0
    v_mov_b32 v16, -1
    v_mov_b32 v17, -1
    v_mov_b32 v18, -1
    v_mov_b32 v19, -1
    s_lshl_b32 s60, s13, 12
    s_add_u32 s60, s60, 917504
    buffer_store_dwordx4 v[12:15], v10, s[4:7], s60 offen sc1
    s_mul_i32 s60, s13, 20480
    s_add_u32 s60, s60, 1310720
    buffer_store_dwordx4 v[12:15], v10, s[4:7], s60 offen sc1
    s_add_u32 s60, s60, 1024
    buffer_store_dwordx4 v[12:15], v10, s[4:7], s60 offen sc1
    s_add_u32 s60, s60, 1024
    buffer_store_dwordx4 v[12:15], v10, s[4:7], s60 offen sc1
    s_add_u32 s60, s60, 1024
    buffer_store_dwordx4 v[12:15], v10, s[4:7], s60 offen sc1
    s_add_u32 s60, s60, 1024
    buffer_store_dwordx4 v[12:15], v10, s[4:7], s60 offen sc1
    s_add_u32 s60, s60, 1024
    s_mul_i32 s61, s15, 640
    v_add_u32 v11, s61, v10
    s_mov_b32 exec_hi, 0xff
    s_lshl_b32 s60, s14, 15
    s_add_u32 s60, s60, 1179648
    buffer_store_dwordx4 v[12:15], v11, s[4:7], s60 offen sc1
    s_mul_i32 s60, s14, 20480
    s_add_u32 s60, s60, 2621440
    buffer_store_dwordx4 v[12:15], v11, s[4:7], s60 offen sc1
    s_add_u32 s60, s60, 163840
    buffer_store_dwordx4 v[12:15], v11, s[4:7], s60 offen sc1
    s_add_u32 s60, s60, 163840
    buffer_store_dwordx4 v[12:15], v11, s[4:7], s60 offen sc1
    s_add_u32 s60, s60, 163840
    buffer_store_dwordx4 v[12:15], v11, s[4:7], s60 offen sc1
    s_add_u32 s60, s60, 163840
    buffer_store_dwordx4 v[12:15], v11, s[4:7], s60 offen sc1
    s_add_u32 s60, s60, 163840
    buffer_store_dwordx4 v[12:15], v11, s[4:7], s60 offen sc1
    s_add_u32 s60, s60, 163840
    buffer_store_dwordx4 v[12:15], v11, s[4:7], s60 offen sc1
    s_add_u32 s60, s60, 163840
    buffer_store_dwordx4 v[12:15], v11, s[4:7], s60 offen sc1
    s_add_u32 s60, s60, 163840
    buffer_store_dwordx4 v[12:15], v11, s[4:7], s60 offen sc1
    s_add_u32 s60, s60, 163840
    buffer_store_dwordx4 v[12:15], v11, s[4:7], s60 offen sc1
    s_add_u32 s60, s60, 163840
    buffer_store_dwordx4 v[12:15], v11, s[4:7], s60 offen sc1
    s_add_u32 s60, s60, 163840
    buffer_store_dwordx4 v[12:15], v11, s[4:7], s60 offen sc1
    s_add_u32 s60, s60, 163840
    buffer_store_dwordx4 v[12:15], v11, s[4:7], s60 offen sc1
    s_add_u32 s60, s60, 163840
    buffer_store_dwordx4 v[12:15], v11, s[4:7], s60 offen sc1
    s_add_u32 s60, s60, 163840
    buffer_store_dwordx4 v[12:15], v11, s[4:7], s60 offen sc1
    s_add_u32 s60, s60, 163840
    buffer_store_dwordx4 v[12:15], v11, s[4:7], s60 offen sc1
    s_add_u32 s60, s60, 163840
    buffer_store_dwordx4 v[12:15], v11, s[4:7], s60 offen sc1
    s_add_u32 s60, s60, 163840
    buffer_store_dwordx4 v[12:15], v11, s[4:7], s60 offen sc1
    s_add_u32 s60, s60, 163840
    s_mov_b64 exec, 1
    s_lshl_b32 s54, s13, 9
    s_lshr_b32 s55, s13, 1
    s_mul_i32 s55, s55, 1536
    s_add_u32 s55, s55, 32768
    s_add_u32 s54, s54, 0
    buffer_store_dword v12, v10, s[4:7], s54 offen sc1
    s_mov_b64 exec, -1
    v_add_u32 v38, 0, v0
    v_mul_u32_u24 v39, 10923, v38
    v_lshrrev_b32 v39, 16, v39
    v_mul_u32_u24 v20, 6, v39
    v_sub_u32 v20, v38, v20
    v_lshrrev_b32 v20, 0, v20
    v_lshlrev_b32 v20, 4, v20
    v_mul_u32_u24 v39, 12288, v39
    v_add_u32 v20, v20, v39
    v_add_u32 v38, 64, v0
    v_mul_u32_u24 v39, 10923, v38
    v_lshrrev_b32 v39, 16, v39
    v_mul_u32_u24 v21, 6, v39
    v_sub_u32 v21, v38, v21
    v_lshrrev_b32 v21, 0, v21
    v_lshlrev_b32 v21, 4, v21
    v_mul_u32_u24 v39, 12288, v39
    v_add_u32 v21, v21, v39
    v_add_u32 v38, 128, v0
    v_mul_u32_u24 v39, 10923, v38
    v_lshrrev_b32 v39, 16, v39
    v_mul_u32_u24 v22, 6, v39
    v_sub_u32 v22, v38, v22
    v_lshrrev_b32 v22, 0, v22
    v_lshlrev_b32 v22, 4, v22
    v_mul_u32_u24 v39, 12288, v39
    v_add_u32 v22, v22, v39
    v_add_u32 v38, 0, v0
    v_mul_u32_u24 v39, 16385, v38
    v_lshrrev_b32 v39, 16, v39
    v_mul_u32_u24 v23, 4, v39
    v_sub_u32 v23, v38, v23
    v_lshrrev_b32 v23, 0, v23
    v_lshlrev_b32 v23, 4, v23
    v_mul_u32_u24 v39, 12288, v39
    v_add_u32 v23, v23, v39
    v_add_u32 v38, 64, v0
    v_mul_u32_u24 v39, 16385, v38
    v_lshrrev_b32 v39, 16, v39
    v_mul_u32_u24 v24, 4, v39
    v_sub_u32 v24, v38, v24
    v_lshrrev_b32 v24, 0, v24
    v_lshlrev_b32 v24, 4, v24
    v_mul_u32_u24 v39, 12288, v39
    v_add_u32 v24, v24, v39
    v_add_u32 v38, 0, v0
    v_mul_u32_u24 v39, 3277, v38
    v_lshrrev_b32 v39, 16, v39
    v_mul_u32_u24 v25, 20, v39
    v_sub_u32 v25, v38, v25
    v_lshrrev_b32 v25, 0, v25
    v_lshlrev_b32 v25, 4, v25
    v_mul_u32_u24 v39, 1280, v39
    v_add_u32 v25, v25, v39
    v_add_u32 v38, 64, v0
    v_mul_u32_u24 v39, 3277, v38
    v_lshrrev_b32 v39, 16, v39
    v_mul_u32_u24 v26, 20, v39
    v_sub_u32 v26, v38, v26
    v_lshrrev_b32 v26, 0, v26
    v_lshlrev_b32 v26, 4, v26
    v_mul_u32_u24 v39, 1280, v39
    v_add_u32 v26, v26, v39
    v_add_u32 v38, 128, v0
    v_mul_u32_u24 v39, 3277, v38
    v_lshrrev_b32 v39, 16, v39
    v_mul_u32_u24 v27, 20, v39
    v_sub_u32 v27, v38, v27
    v_lshrrev_b32 v27, 0, v27
    v_lshlrev_b32 v27, 4, v27
    v_mul_u32_u24 v39, 1280, v39
    v_add_u32 v27, v27, v39
    v_add_u32 v38, 192, v0
    v_mul_u32_u24 v39, 3277, v38
    v_lshrrev_b32 v39, 16, v39
    v_mul_u32_u24 v28, 20, v39
    v_sub_u32 v28, v38, v28
    v_lshrrev_b32 v28, 0, v28
    v_lshlrev_b32 v28, 4, v28
    v_mul_u32_u24 v39, 1280, v39
    v_add_u32 v28, v28, v39
    v_add_u32 v38, 256, v0
    v_mul_u32_u24 v39, 3277, v38
    v_lshrrev_b32 v39, 16, v39
    v_mul_u32_u24 v29, 20, v39
    v_sub_u32 v29, v38, v29
    v_lshrrev_b32 v29, 0, v29
    v_lshlrev_b32 v29, 4, v29
    v_mul_u32_u24 v39, 1280, v39
    v_add_u32 v29, v29, v39
    v_add_u32 v38, 320, v0
    v_mul_u32_u24 v39, 3277, v38
    v_lshrrev_b32 v39, 16, v39
    v_mul_u32_u24 v30, 20, v39
    v_sub_u32 v30, v38, v30
    v_lshrrev_b32 v30, 0, v30
    v_lshlrev_b32 v30, 4, v30
    v_mul_u32_u24 v39, 1280, v39
    v_add_u32 v30, v30, v39
    v_add_u32 v38, 384, v0
    v_mul_u32_u24 v39, 3277, v38
    v_lshrrev_b32 v39, 16, v39
    v_mul_u32_u24 v31, 20, v39
    v_sub_u32 v31, v38, v31
    v_lshrrev_b32 v31, 0, v31
    v_lshlrev_b32 v31, 4, v31
    v_mul_u32_u24 v39, 1280, v39
    v_add_u32 v31, v31, v39
    v_add_u32 v38, 448, v0
    v_mul_u32_u24 v39, 3277, v38
    v_lshrrev_b32 v39, 16, v39
    v_mul_u32_u24 v32, 20, v39
    v_sub_u32 v32, v38, v32
    v_lshrrev_b32 v32, 0, v32
    v_lshlrev_b32 v32, 4, v32
    v_mul_u32_u24 v39, 1280, v39
    v_add_u32 v32, v32, v39
    v_add_u32 v38, 512, v0
    v_mul_u32_u24 v39, 3277, v38
    v_lshrrev_b32 v39, 16, v39
    v_mul_u32_u24 v33, 20, v39
    v_sub_u32 v33, v38, v33
    v_lshrrev_b32 v33, 0, v33
    v_lshlrev_b32 v33, 4, v33
    v_mul_u32_u24 v39, 1280, v39
    v_add_u32 v33, v33, v39
    v_add_u32 v38, 576, v0
    v_mul_u32_u24 v39, 3277, v38
    v_lshrrev_b32 v39, 16, v39
    v_mul_u32_u24 v34, 20, v39
    v_sub_u32 v34, v38, v34
    v_lshrrev_b32 v34, 0, v34
    v_lshlrev_b32 v34, 4, v34
    v_mul_u32_u24 v39, 1280, v39
    v_add_u32 v34, v34, v39
    v_lshrrev_b32 v35, 2, v0
    v_mul_u32_u24 v35, 96, v35
    v_and_b32 v38, 3, v0
    v_lshl_add_u32 v35, v38, 3, v35
    v_add_u32 v35, s62, v35
    v_lshrrev_b32 v36, 2, v0
    v_mul_u32_u24 v36, 64, v36
    v_and_b32 v38, 3, v0
    v_lshl_add_u32 v36, v38, 3, v36
    v_add_u32 v36, s62, v36
    v_lshrrev_b32 v37, 2, v0
    v_mul_u32_u24 v37, 320, v37
    v_and_b32 v38, 3, v0
    v_lshl_add_u32 v37, v38, 3, v37
    v_add_u32 v37, s62, v37
    v_add_u32 v2, 71680, v10
    s_mov_b32 s8, s68
    s_and_b32 s9, s69, 0xffff
    s_mov_b32 s10, 7864320
    s_mov_b32 s11, 0x20000
    s_mov_b32 s28, s72
    s_and_b32 s29, s73, 0xffff
    s_mov_b32 s30, 7864320
    s_mov_b32 s31, 0x20000
    s_mov_b32 s32, s74
    s_and_b32 s33, s75, 0xffff
    s_mov_b32 s34, 7864320
    s_mov_b32 s35, 0x20000
    s_mul_i32 s60, s13, 192
    s_add_u32 s25, s60, 0
    s_add_u32 s26, s60, 0
    s_mul_i32 s27, s13, 122880
    s_add_u32 s27, s27, 0
    s_add_u32 m0, s62, 0
    s_nop 0
    buffer_load_dwordx4 v20, s[8:11], s25 offen lds
    s_add_u32 m0, s62, 1024
    s_nop 0
    buffer_load_dwordx4 v21, s[8:11], s25 offen lds
    s_add_u32 m0, s62, 2048
    s_nop 0
    buffer_load_dwordx4 v22, s[8:11], s25 offen lds
    s_add_u32 s25, s25, 393216
    s_add_u32 m0, s62, 3072
    s_nop 0
    buffer_load_dwordx4 v20, s[8:11], s25 offen lds
    s_add_u32 m0, s62, 4096
    s_nop 0
    buffer_load_dwordx4 v21, s[8:11], s25 offen lds
    s_add_u32 m0, s62, 5120
    s_nop 0
    buffer_load_dwordx4 v22, s[8:11], s25 offen lds
    s_add_u32 s25, s25, 393216
    s_add_u32 m0, s62, 6144
    s_nop 0
    buffer_load_dwordx4 v20, s[8:11], s25 offen lds
    s_add_u32 m0, s62, 7168
    s_nop 0
    buffer_load_dwordx4 v21, s[8:11], s25 offen lds
    s_add_u32 m0, s62, 8192
    s_nop 0
    buffer_load_dwordx4 v22, s[8:11], s25 offen lds
    s_add_u32 s25, s25, 393216
    s_add_u32 m0, s62, 9216
    s_nop 0
    buffer_load_dwordx4 v20, s[8:11], s25 offen lds
    s_add_u32 m0, s62, 10240
    s_nop 0
    buffer_load_dwordx4 v21, s[8:11], s25 offen lds
    s_add_u32 m0, s62, 11264
    s_nop 0
    buffer_load_dwordx4 v22, s[8:11], s25 offen lds
    s_add_u32 s25, s25, 393216
    s_add_u32 m0, s62, 12288
    s_nop 0
    buffer_load_dwordx4 v20, s[8:11], s25 offen lds
    s_add_u32 m0, s62, 13312
    s_nop 0
    buffer_load_dwordx4 v21, s[8:11], s25 offen lds
    s_add_u32 m0, s62, 14336
    s_nop 0
    buffer_load_dwordx4 v22, s[8:11], s25 offen lds
    s_waitcnt vmcnt(12)
    s_barrier
    s_cmp_lg_u32 s12, 0
    s_cbranch_scc1 L_R0_arr_1
    s_lshl_b32 s3, s18, 2
    s_add_u32 s3, s3, 64
    v_mov_b32 v92, s3
    v_mov_b32 v93, 1
    s_mov_b64 exec, 1
    global_atomic_add v92, v93, s[16:17] sc1
    s_waitcnt vmcnt(0)
    s_mov_b64 exec, -1
L_R0_arr_1:
    ds_read_b64_tr_b16 a[0:1], v35 offset:0
    ds_read_b64_tr_b16 a[2:3], v35 offset:1536
    ds_read_b64_tr_b16 a[80:81], v35 offset:32
    ds_read_b64_tr_b16 a[82:83], v35 offset:1568
    ds_read_b64_tr_b16 a[160:161], v35 offset:64
    ds_read_b64_tr_b16 a[162:163], v35 offset:1600
    s_waitcnt lgkmcnt(0)
    s_add_u32 s25, s25, 393216
    s_add_u32 m0, s62, 0
    s_nop 0
    buffer_load_dwordx4 v20, s[8:11], s25 offen lds
    s_add_u32 m0, s62, 1024
    s_nop 0
    buffer_load_dwordx4 v21, s[8:11], s25 offen lds
    s_add_u32 m0, s62, 2048
    s_nop 0
    buffer_load_dwordx4 v22, s[8:11], s25 offen lds
    s_waitcnt vmcnt(12)
    ds_read_b64_tr_b16 a[4:5], v35 offset:3072
    ds_read_b64_tr_b16 a[6:7], v35 offset:4608
    ds_read_b64_tr_b16 a[84:85], v35 offset:3104
    ds_read_b64_tr_b16 a[86:87], v35 offset:4640
    ds_read_b64_tr_b16 a[164:165], v35 offset:3136
    ds_read_b64_tr_b16 a[166:167], v35 offset:4672
    s_waitcnt lgkmcnt(0)
    s_add_u32 s25, s25, 393216
    s_add_u32 m0, s62, 3072
    s_nop 0
    buffer_load_dwordx4 v20, s[8:11], s25 offen lds
    s_add_u32 m0, s62, 4096
    s_nop 0
    buffer_load_dwordx4 v21, s[8:11], s25 offen lds
    s_add_u32 m0, s62, 5120
    s_nop 0
    buffer_load_dwordx4 v22, s[8:11], s25 offen lds
    s_waitcnt vmcnt(12)
    ds_read_b64_tr_b16 a[8:9], v35 offset:6144
    ds_read_b64_tr_b16 a[10:11], v35 offset:7680
    ds_read_b64_tr_b16 a[88:89], v35 offset:6176
    ds_read_b64_tr_b16 a[90:91], v35 offset:7712
    ds_read_b64_tr_b16 a[168:169], v35 offset:6208
    ds_read_b64_tr_b16 a[170:171], v35 offset:7744
    s_waitcnt lgkmcnt(0)
    s_add_u32 s25, s25, 393216
    s_add_u32 m0, s62, 6144
    s_nop 0
    buffer_load_dwordx4 v20, s[8:11], s25 offen lds
    s_add_u32 m0, s62, 7168
    s_nop 0
    buffer_load_dwordx4 v21, s[8:11], s25 offen lds
    s_add_u32 m0, s62, 8192
    s_nop 0
    buffer_load_dwordx4 v22, s[8:11], s25 offen lds
    s_waitcnt vmcnt(12)
    ds_read_b64_tr_b16 a[12:13], v35 offset:9216
    ds_read_b64_tr_b16 a[14:15], v35 offset:10752
    ds_read_b64_tr_b16 a[92:93], v35 offset:9248
    ds_read_b64_tr_b16 a[94:95], v35 offset:10784
    ds_read_b64_tr_b16 a[172:173], v35 offset:9280
    ds_read_b64_tr_b16 a[174:175], v35 offset:10816
    s_waitcnt lgkmcnt(0)
    s_add_u32 s25, s25, 393216
    s_add_u32 m0, s62, 9216
    s_nop 0
    buffer_load_dwordx4 v20, s[8:11], s25 offen lds
    s_add_u32 m0, s62, 10240
    s_nop 0
    buffer_load_dwordx4 v21, s[8:11], s25 offen lds
    s_add_u32 m0, s62, 11264
    s_nop 0
    buffer_load_dwordx4 v22, s[8:11], s25 offen lds
    s_waitcnt vmcnt(12)
    ds_read_b64_tr_b16 a[16:17], v35 offset:12288
    ds_read_b64_tr_b16 a[18:19], v35 offset:13824
    ds_read_b64_tr_b16 a[96:97], v35 offset:12320
    ds_read_b64_tr_b16 a[98:99], v35 offset:13856
    ds_read_b64_tr_b16 a[176:177], v35 offset:12352
    ds_read_b64_tr_b16 a[178:179], v35 offset:13888
    s_waitcnt lgkmcnt(0)
    s_add_u32 s25, s25, 393216
    s_add_u32 m0, s62, 12288
    s_nop 0
    buffer_load_dwordx4 v20, s[8:11], s25 offen lds
    s_add_u32 m0, s62, 13312
    s_nop 0
    buffer_load_dwordx4 v21, s[8:11], s25 offen lds
    s_add_u32 m0, s62, 14336
    s_nop 0
    buffer_load_dwordx4 v22, s[8:11], s25 offen lds
    s_waitcnt vmcnt(12)
    ds_read_b64_tr_b16 a[20:21], v35 offset:0
    ds_read_b64_tr_b16 a[22:23], v35 offset:1536
    ds_read_b64_tr_b16 a[100:101], v35 offset:32
    ds_read_b64_tr_b16 a[102:103], v35 offset:1568
    ds_read_b64_tr_b16 a[180:181], v35 offset:64
    ds_read_b64_tr_b16 a[182:183], v35 offset:1600
    s_waitcnt lgkmcnt(0)
    s_add_u32 s25, s25, 393216
    s_add_u32 m0, s62, 0
    s_nop 0
    buffer_load_dwordx4 v20, s[8:11], s25 offen lds
    s_add_u32 m0, s62, 1024
    s_nop 0
    buffer_load_dwordx4 v21, s[8:11], s25 offen lds
    s_add_u32 m0, s62, 2048
    s_nop 0
    buffer_load_dwordx4 v22, s[8:11], s25 offen lds
    s_waitcnt vmcnt(12)
    ds_read_b64_tr_b16 a[24:25], v35 offset:3072
    ds_read_b64_tr_b16 a[26:27], v35 offset:4608
    ds_read_b64_tr_b16 a[104:105], v35 offset:3104
    ds_read_b64_tr_b16 a[106:107], v35 offset:4640
    ds_read_b64_tr_b16 a[184:185], v35 offset:3136
    ds_read_b64_tr_b16 a[186:187], v35 offset:4672
    s_waitcnt lgkmcnt(0)
    s_add_u32 s25, s25, 393216
    s_add_u32 m0, s62, 3072
    s_nop 0
    buffer_load_dwordx4 v20, s[8:11], s25 offen lds
    s_add_u32 m0, s62, 4096
    s_nop 0
    buffer_load_dwordx4 v21, s[8:11], s25 offen lds
    s_add_u32 m0, s62, 5120
    s_nop 0
    buffer_load_dwordx4 v22, s[8:11], s25 offen lds
    s_waitcnt vmcnt(12)
    ds_read_b64_tr_b16 a[28:29], v35 offset:6144
    ds_read_b64_tr_b16 a[30:31], v35 offset:7680
    ds_read_b64_tr_b16 a[108:109], v35 offset:6176
    ds_read_b64_tr_b16 a[110:111], v35 offset:7712
    ds_read_b64_tr_b16 a[188:189], v35 offset:6208
    ds_read_b64_tr_b16 a[190:191], v35 offset:7744
    s_waitcnt lgkmcnt(0)
    s_add_u32 s25, s25, 393216
    s_add_u32 m0, s62, 6144
    s_nop 0
    buffer_load_dwordx4 v20, s[8:11], s25 offen lds
    s_add_u32 m0, s62, 7168
    s_nop 0
    buffer_load_dwordx4 v21, s[8:11], s25 offen lds
    s_add_u32 m0, s62, 8192
    s_nop 0
    buffer_load_dwordx4 v22, s[8:11], s25 offen lds
    s_waitcnt vmcnt(12)
    ds_read_b64_tr_b16 a[32:33], v35 offset:9216
    ds_read_b64_tr_b16 a[34:35], v35 offset:10752
    ds_read_b64_tr_b16 a[112:113], v35 offset:9248
    ds_read_b64_tr_b16 a[114:115], v35 offset:10784
    ds_read_b64_tr_b16 a[192:193], v35 offset:9280
    ds_read_b64_tr_b16 a[194:195], v35 offset:10816
    s_waitcnt lgkmcnt(0)
    s_add_u32 s25, s25, 393216
    s_add_u32 m0, s62, 9216
    s_nop 0
    buffer_load_dwordx4 v20, s[8:11], s25 offen lds
    s_add_u32 m0, s62, 10240
    s_nop 0
    buffer_load_dwordx4 v21, s[8:11], s25 offen lds
    s_add_u32 m0, s62, 11264
    s_nop 0
    buffer_load_dwordx4 v22, s[8:11], s25 offen lds
    s_waitcnt vmcnt(12)
    ds_read_b64_tr_b16 a[36:37], v35 offset:12288
    ds_read_b64_tr_b16 a[38:39], v35 offset:13824
    ds_read_b64_tr_b16 a[116:117], v35 offset:12320
    ds_read_b64_tr_b16 a[118:119], v35 offset:13856
    ds_read_b64_tr_b16 a[196:197], v35 offset:12352
    ds_read_b64_tr_b16 a[198:199], v35 offset:13888
    s_waitcnt lgkmcnt(0)
    s_add_u32 s25, s25, 393216
    s_add_u32 m0, s62, 12288
    s_nop 0
    buffer_load_dwordx4 v20, s[8:11], s25 offen lds
    s_add_u32 m0, s62, 13312
    s_nop 0
    buffer_load_dwordx4 v21, s[8:11], s25 offen lds
    s_add_u32 m0, s62, 14336
    s_nop 0
    buffer_load_dwordx4 v22, s[8:11], s25 offen lds
    s_waitcnt vmcnt(12)
    ds_read_b64_tr_b16 a[40:41], v35 offset:0
    ds_read_b64_tr_b16 a[42:43], v35 offset:1536
    ds_read_b64_tr_b16 a[120:121], v35 offset:32
    ds_read_b64_tr_b16 a[122:123], v35 offset:1568
    ds_read_b64_tr_b16 a[200:201], v35 offset:64
    ds_read_b64_tr_b16 a[202:203], v35 offset:1600
    s_waitcnt lgkmcnt(0)
    s_add_u32 s25, s25, 393216
    s_add_u32 m0, s62, 0
    s_nop 0
    buffer_load_dwordx4 v20, s[8:11], s25 offen lds
    s_add_u32 m0, s62, 1024
    s_nop 0
    buffer_load_dwordx4 v21, s[8:11], s25 offen lds
    s_add_u32 m0, s62, 2048
    s_nop 0
    buffer_load_dwordx4 v22, s[8:11], s25 offen lds
    s_waitcnt vmcnt(12)
    ds_read_b64_tr_b16 a[44:45], v35 offset:3072
    ds_read_b64_tr_b16 a[46:47], v35 offset:4608
    ds_read_b64_tr_b16 a[124:125], v35 offset:3104
    ds_read_b64_tr_b16 a[126:127], v35 offset:4640
    ds_read_b64_tr_b16 a[204:205], v35 offset:3136
    ds_read_b64_tr_b16 a[206:207], v35 offset:4672
    s_waitcnt lgkmcnt(0)
    s_add_u32 s25, s25, 393216
    s_add_u32 m0, s62, 3072
    s_nop 0
    buffer_load_dwordx4 v20, s[8:11], s25 offen lds
    s_add_u32 m0, s62, 4096
    s_nop 0
    buffer_load_dwordx4 v21, s[8:11], s25 offen lds
    s_add_u32 m0, s62, 5120
    s_nop 0
    buffer_load_dwordx4 v22, s[8:11], s25 offen lds
    s_waitcnt vmcnt(12)
    ds_read_b64_tr_b16 a[48:49], v35 offset:6144
    ds_read_b64_tr_b16 a[50:51], v35 offset:7680
    ds_read_b64_tr_b16 a[128:129], v35 offset:6176
    ds_read_b64_tr_b16 a[130:131], v35 offset:7712
    ds_read_b64_tr_b16 a[208:209], v35 offset:6208
    ds_read_b64_tr_b16 a[210:211], v35 offset:7744
    s_waitcnt lgkmcnt(0)
    s_add_u32 s25, s25, 393216
    s_add_u32 m0, s62, 6144
    s_nop 0
    buffer_load_dwordx4 v20, s[8:11], s25 offen lds
    s_add_u32 m0, s62, 7168
    s_nop 0
    buffer_load_dwordx4 v21, s[8:11], s25 offen lds
    s_add_u32 m0, s62, 8192
    s_nop 0
    buffer_load_dwordx4 v22, s[8:11], s25 offen lds
    s_waitcnt vmcnt(12)
    ds_read_b64_tr_b16 a[52:53], v35 offset:9216
    ds_read_b64_tr_b16 a[54:55], v35 offset:10752
    ds_read_b64_tr_b16 a[132:133], v35 offset:9248
    ds_read_b64_tr_b16 a[134:135], v35 offset:10784
    ds_read_b64_tr_b16 a[212:213], v35 offset:9280
    ds_read_b64_tr_b16 a[214:215], v35 offset:10816
    s_waitcnt lgkmcnt(0)
    s_add_u32 s25, s25, 393216
    s_add_u32 m0, s62, 9216
    s_nop 0
    buffer_load_dwordx4 v20, s[8:11], s25 offen lds
    s_add_u32 m0, s62, 10240
    s_nop 0
    buffer_load_dwordx4 v21, s[8:11], s25 offen lds
    s_add_u32 m0, s62, 11264
    s_nop 0
    buffer_load_dwordx4 v22, s[8:11], s25 offen lds
    s_waitcnt vmcnt(12)
    ds_read_b64_tr_b16 a[56:57], v35 offset:12288
    ds_read_b64_tr_b16 a[58:59], v35 offset:13824
    ds_read_b64_tr_b16 a[136:137], v35 offset:12320
    ds_read_b64_tr_b16 a[138:139], v35 offset:13856
    ds_read_b64_tr_b16 a[216:217], v35 offset:12352
    ds_read_b64_tr_b16 a[218:219], v35 offset:13888
    s_waitcnt lgkmcnt(0)
    s_add_u32 s25, s25, 393216
    s_add_u32 m0, s62, 12288
    s_nop 0
    buffer_load_dwordx4 v20, s[8:11], s25 offen lds
    s_add_u32 m0, s62, 13312
    s_nop 0
    buffer_load_dwordx4 v21, s[8:11], s25 offen lds
    s_add_u32 m0, s62, 14336
    s_nop 0
    buffer_load_dwordx4 v22, s[8:11], s25 offen lds
    s_add_u32 m0, s62, 15360
    s_nop 0
    buffer_load_dwordx4 v23, s[28:31], s26 offen lds
    s_add_u32 m0, s62, 16384
    s_nop 0
    buffer_load_dwordx4 v24, s[28:31], s26 offen lds
    s_waitcnt vmcnt(14)
    ds_read_b64_tr_b16 a[60:61], v35 offset:0
    ds_read_b64_tr_b16 a[62:63], v35 offset:1536
    ds_read_b64_tr_b16 a[140:141], v35 offset:32
    ds_read_b64_tr_b16 a[142:143], v35 offset:1568
    ds_read_b64_tr_b16 a[220:221], v35 offset:64
    ds_read_b64_tr_b16 a[222:223], v35 offset:1600
    s_waitcnt lgkmcnt(0)
    s_add_u32 s26, s26, 393216
    s_add_u32 m0, s62, 0
    s_nop 0
    buffer_load_dwordx4 v23, s[28:31], s26 offen lds
    s_add_u32 m0, s62, 1024
    s_nop 0
    buffer_load_dwordx4 v24, s[28:31], s26 offen lds
    s_waitcnt vmcnt(13)
    ds_read_b64_tr_b16 a[64:65], v35 offset:3072
    ds_read_b64_tr_b16 a[66:67], v35 offset:4608
    ds_read_b64_tr_b16 a[144:145], v35 offset:3104
    ds_read_b64_tr_b16 a[146:147], v35 offset:4640
    ds_read_b64_tr_b16 a[224:225], v35 offset:3136
    ds_read_b64_tr_b16 a[226:227], v35 offset:4672
    s_waitcnt lgkmcnt(0)
    s_add_u32 s26, s26, 393216
    s_add_u32 m0, s62, 2048
    s_nop 0
    buffer_load_dwordx4 v23, s[28:31], s26 offen lds
    s_add_u32 m0, s62, 3072
    s_nop 0
    buffer_load_dwordx4 v24, s[28:31], s26 offen lds
    s_add_u32 s26, s26, 393216
    s_add_u32 m0, s62, 4096
    s_nop 0
    buffer_load_dwordx4 v23, s[28:31], s26 offen lds
    s_add_u32 m0, s62, 5120
    s_nop 0
    buffer_load_dwordx4 v24, s[28:31], s26 offen lds
    s_waitcnt vmcnt(14)
    ds_read_b64_tr_b16 a[68:69], v35 offset:6144
    ds_read_b64_tr_b16 a[70:71], v35 offset:7680
    ds_read_b64_tr_b16 a[148:149], v35 offset:6176
    ds_read_b64_tr_b16 a[150:151], v35 offset:7712
    ds_read_b64_tr_b16 a[228:229], v35 offset:6208
    ds_read_b64_tr_b16 a[230:231], v35 offset:7744
    s_waitcnt lgkmcnt(0)
    s_add_u32 s26, s26, 393216
    s_add_u32 m0, s62, 6144
    s_nop 0
    buffer_load_dwordx4 v23, s[28:31], s26 offen lds
    s_add_u32 m0, s62, 7168
    s_nop 0
    buffer_load_dwordx4 v24, s[28:31], s26 offen lds
    s_waitcnt vmcnt(13)
    ds_read_b64_tr_b16 a[72:73], v35 offset:9216
    ds_read_b64_tr_b16 a[74:75], v35 offset:10752
    ds_read_b64_tr_b16 a[152:153], v35 offset:9248
    ds_read_b64_tr_b16 a[154:155], v35 offset:10784
    ds_read_b64_tr_b16 a[232:233], v35 offset:9280
    ds_read_b64_tr_b16 a[234:235], v35 offset:10816
    s_waitcnt lgkmcnt(0)
    s_add_u32 s26, s26, 393216
    s_add_u32 m0, s62, 8192
    s_nop 0
    buffer_load_dwordx4 v23, s[28:31], s26 offen lds
    s_add_u32 m0, s62, 9216
    s_nop 0
    buffer_load_dwordx4 v24, s[28:31], s26 offen lds
    s_add_u32 s26, s26, 393216
    s_add_u32 m0, s62, 10240
    s_nop 0
    buffer_load_dwordx4 v23, s[28:31], s26 offen lds
    s_add_u32 m0, s62, 11264
    s_nop 0
    buffer_load_dwordx4 v24, s[28:31], s26 offen lds
    s_waitcnt vmcnt(14)
    ds_read_b64_tr_b16 a[76:77], v35 offset:12288
    ds_read_b64_tr_b16 a[78:79], v35 offset:13824
    ds_read_b64_tr_b16 a[156:157], v35 offset:12320
    ds_read_b64_tr_b16 a[158:159], v35 offset:13856
    ds_read_b64_tr_b16 a[236:237], v35 offset:12352
    ds_read_b64_tr_b16 a[238:239], v35 offset:13888
    s_waitcnt lgkmcnt(0)
    s_add_u32 s26, s26, 393216
    s_add_u32 m0, s62, 12288
    s_nop 0
    buffer_load_dwordx4 v23, s[28:31], s26 offen lds
    s_add_u32 m0, s62, 13312
    s_nop 0
    buffer_load_dwordx4 v24, s[28:31], s26 offen lds
    s_waitcnt vmcnt(14)
    ds_read_b64_tr_b16 v[96:97], v36 offset:15360
    ds_read_b64_tr_b16 v[98:99], v36 offset:16384
    ds_read_b64_tr_b16 v[176:177], v36 offset:15392
    ds_read_b64_tr_b16 v[178:179], v36 offset:16416
    s_waitcnt lgkmcnt(0)
    s_add_u32 s26, s26, 393216
    s_add_u32 m0, s62, 14336
    s_nop 0
    buffer_load_dwordx4 v23, s[28:31], s26 offen lds
    s_add_u32 m0, s62, 15360
    s_nop 0
    buffer_load_dwordx4 v24, s[28:31], s26 offen lds
    s_waitcnt vmcnt(14)
    ds_read_b64_tr_b16 v[100:101], v36 offset:0
    ds_read_b64_tr_b16 v[102:103], v36 offset:1024
    ds_read_b64_tr_b16 v[180:181], v36 offset:32
    ds_read_b64_tr_b16 v[182:183], v36 offset:1056
    s_waitcnt lgkmcnt(0)
    s_add_u32 s26, s26, 393216
    s_add_u32 m0, s62, 0
    s_nop 0
    buffer_load_dwordx4 v23, s[28:31], s26 offen lds
    s_add_u32 m0, s62, 1024
    s_nop 0
    buffer_load_dwordx4 v24, s[28:31], s26 offen lds
    s_waitcnt vmcnt(14)
    ds_read_b64_tr_b16 v[104:105], v36 offset:2048
    ds_read_b64_tr_b16 v[106:107], v36 offset:3072
    ds_read_b64_tr_b16 v[184:185], v36 offset:2080
    ds_read_b64_tr_b16 v[186:187], v36 offset:3104
    s_waitcnt lgkmcnt(0)
    s_add_u32 s26, s26, 393216
    s_add_u32 m0, s62, 2048
    s_nop 0
    buffer_load_dwordx4 v23, s[28:31], s26 offen lds
    s_add_u32 m0, s62, 3072
    s_nop 0
    buffer_load_dwordx4 v24, s[28:31], s26 offen lds
    s_waitcnt vmcnt(14)
    ds_read_b64_tr_b16 v[108:109], v36 offset:4096
    ds_read_b64_tr_b16 v[110:111], v36 offset:5120
    ds_read_b64_tr_b16 v[188:189], v36 offset:4128
    ds_read_b64_tr_b16 v[190:191], v36 offset:5152
    s_waitcnt lgkmcnt(0)
    s_add_u32 s26, s26, 393216
    s_add_u32 m0, s62, 4096
    s_nop 0
    buffer_load_dwordx4 v23, s[28:31], s26 offen lds
    s_add_u32 m0, s62, 5120
    s_nop 0
    buffer_load_dwordx4 v24, s[28:31], s26 offen lds
    s_waitcnt vmcnt(14)
    ds_read_b64_tr_b16 v[112:113], v36 offset:6144
    ds_read_b64_tr_b16 v[114:115], v36 offset:7168
    ds_read_b64_tr_b16 v[192:193], v36 offset:6176
    ds_read_b64_tr_b16 v[194:195], v36 offset:7200
    s_waitcnt lgkmcnt(0)
    s_add_u32 s26, s26, 393216
    s_add_u32 m0, s62, 6144
    s_nop 0
    buffer_load_dwordx4 v23, s[28:31], s26 offen lds
    s_add_u32 m0, s62, 7168
    s_nop 0
    buffer_load_dwordx4 v24, s[28:31], s26 offen lds
    s_waitcnt vmcnt(14)
    ds_read_b64_tr_b16 v[116:117], v36 offset:8192
    ds_read_b64_tr_b16 v[118:119], v36 offset:9216
    ds_read_b64_tr_b16 v[196:197], v36 offset:8224
    ds_read_b64_tr_b16 v[198:199], v36 offset:9248
    s_waitcnt lgkmcnt(0)
    s_add_u32 s26, s26, 393216
    s_add_u32 m0, s62, 8192
    s_nop 0
    buffer_load_dwordx4 v23, s[28:31], s26 offen lds
    s_add_u32 m0, s62, 9216
    s_nop 0
    buffer_load_dwordx4 v24, s[28:31], s26 offen lds
    s_waitcnt vmcnt(14)
    ds_read_b64_tr_b16 v[120:121], v36 offset:10240
    ds_read_b64_tr_b16 v[122:123], v36 offset:11264
    ds_read_b64_tr_b16 v[200:201], v36 offset:10272
    ds_read_b64_tr_b16 v[202:203], v36 offset:11296
    s_waitcnt lgkmcnt(0)
    s_add_u32 s26, s26, 393216
    s_add_u32 m0, s62, 10240
    s_nop 0
    buffer_load_dwordx4 v23, s[28:31], s26 offen lds
    s_add_u32 m0, s62, 11264
    s_nop 0
    buffer_load_dwordx4 v24, s[28:31], s26 offen lds
    s_waitcnt vmcnt(14)
    ds_read_b64_tr_b16 v[124:125], v36 offset:12288
    ds_read_b64_tr_b16 v[126:127], v36 offset:13312
    ds_read_b64_tr_b16 v[204:205], v36 offset:12320
    ds_read_b64_tr_b16 v[206:207], v36 offset:13344
    s_waitcnt lgkmcnt(0)
    s_add_u32 s26, s26, 393216
    s_add_u32 m0, s62, 12288
    s_nop 0
    buffer_load_dwordx4 v23, s[28:31], s26 offen lds
    s_add_u32 m0, s62, 13312
    s_nop 0
    buffer_load_dwordx4 v24, s[28:31], s26 offen lds
    s_waitcnt vmcnt(14)
    ds_read_b64_tr_b16 v[128:129], v36 offset:14336
    ds_read_b64_tr_b16 v[130:131], v36 offset:15360
    ds_read_b64_tr_b16 v[208:209], v36 offset:14368
    ds_read_b64_tr_b16 v[210:211], v36 offset:15392
    s_waitcnt lgkmcnt(0)
    s_add_u32 s26, s26, 393216
    s_add_u32 m0, s62, 14336
    s_nop 0
    buffer_load_dwordx4 v23, s[28:31], s26 offen lds
    s_add_u32 m0, s62, 15360
    s_nop 0
    buffer_load_dwordx4 v24, s[28:31], s26 offen lds
    s_waitcnt vmcnt(14)
    ds_read_b64_tr_b16 v[132:133], v36 offset:0
    ds_read_b64_tr_b16 v[134:135], v36 offset:1024
    ds_read_b64_tr_b16 v[212:213], v36 offset:32
    ds_read_b64_tr_b16 v[214:215], v36 offset:1056
    s_waitcnt lgkmcnt(0)
    s_add_u32 s26, s26, 393216
    s_add_u32 m0, s62, 0
    s_nop 0
    buffer_load_dwordx4 v23, s[28:31], s26 offen lds
    s_add_u32 m0, s62, 1024
    s_nop 0
    buffer_load_dwordx4 v24, s[28:31], s26 offen lds
    s_waitcnt vmcnt(14)
    ds_read_b64_tr_b16 v[136:137], v36 offset:2048
    ds_read_b64_tr_b16 v[138:139], v36 offset:3072
    ds_read_b64_tr_b16 v[216:217], v36 offset:2080
    ds_read_b64_tr_b16 v[218:219], v36 offset:3104
    s_waitcnt lgkmcnt(0)
    s_add_u32 s26, s26, 393216
    s_add_u32 m0, s62, 2048
    s_nop 0
    buffer_load_dwordx4 v23, s[28:31], s26 offen lds
    s_add_u32 m0, s62, 3072
    s_nop 0
    buffer_load_dwordx4 v24, s[28:31], s26 offen lds
    s_waitcnt vmcnt(14)
    ds_read_b64_tr_b16 v[140:141], v36 offset:4096
    ds_read_b64_tr_b16 v[142:143], v36 offset:5120
    ds_read_b64_tr_b16 v[220:221], v36 offset:4128
    ds_read_b64_tr_b16 v[222:223], v36 offset:5152
    s_waitcnt lgkmcnt(0)
    s_add_u32 s26, s26, 393216
    s_add_u32 m0, s62, 4096
    s_nop 0
    buffer_load_dwordx4 v23, s[28:31], s26 offen lds
    s_add_u32 m0, s62, 5120
    s_nop 0
    buffer_load_dwordx4 v24, s[28:31], s26 offen lds
    s_waitcnt vmcnt(14)
    ds_read_b64_tr_b16 v[144:145], v36 offset:6144
    ds_read_b64_tr_b16 v[146:147], v36 offset:7168
    ds_read_b64_tr_b16 v[224:225], v36 offset:6176
    ds_read_b64_tr_b16 v[226:227], v36 offset:7200
    s_waitcnt lgkmcnt(0)
    s_waitcnt vmcnt(12)
    ds_read_b64_tr_b16 v[148:149], v36 offset:8192
    ds_read_b64_tr_b16 v[150:151], v36 offset:9216
    ds_read_b64_tr_b16 v[228:229], v36 offset:8224
    ds_read_b64_tr_b16 v[230:231], v36 offset:9248
    s_waitcnt lgkmcnt(0)
    s_waitcnt vmcnt(10)
    ds_read_b64_tr_b16 v[152:153], v36 offset:10240
    ds_read_b64_tr_b16 v[154:155], v36 offset:11264
    ds_read_b64_tr_b16 v[232:233], v36 offset:10272
    ds_read_b64_tr_b16 v[234:235], v36 offset:11296
    s_waitcnt lgkmcnt(0)
    s_waitcnt vmcnt(8)
    ds_read_b64_tr_b16 v[156:157], v36 offset:12288
    ds_read_b64_tr_b16 v[158:159], v36 offset:13312
    ds_read_b64_tr_b16 v[236:237], v36 offset:12320
    ds_read_b64_tr_b16 v[238:239], v36 offset:13344
    s_waitcnt lgkmcnt(0)
    s_waitcnt vmcnt(6)
    ds_read_b64_tr_b16 v[160:161], v36 offset:14336
    ds_read_b64_tr_b16 v[162:163], v36 offset:15360
    ds_read_b64_tr_b16 v[240:241], v36 offset:14368
    ds_read_b64_tr_b16 v[242:243], v36 offset:15392
    s_waitcnt lgkmcnt(0)
    s_add_u32 m0, s62, 6144
    s_nop 0
    buffer_load_dwordx4 v25, s[32:35], s27 offen lds
    s_add_u32 m0, s62, 7168
    s_nop 0
    buffer_load_dwordx4 v26, s[32:35], s27 offen lds
    s_add_u32 m0, s62, 8192
    s_nop 0
    buffer_load_dwordx4 v27, s[32:35], s27 offen lds
    s_add_u32 m0, s62, 9216
    s_nop 0
    buffer_load_dwordx4 v28, s[32:35], s27 offen lds
    s_add_u32 m0, s62, 10240
    s_nop 0
    buffer_load_dwordx4 v29, s[32:35], s27 offen lds
    s_add_u32 m0, s62, 11264
    s_nop 0
    buffer_load_dwordx4 v30, s[32:35], s27 offen lds
    s_add_u32 m0, s62, 12288
    s_nop 0
    buffer_load_dwordx4 v31, s[32:35], s27 offen lds
    s_add_u32 m0, s62, 13312
    s_nop 0
    buffer_load_dwordx4 v32, s[32:35], s27 offen lds
    s_add_u32 m0, s62, 14336
    s_nop 0
    buffer_load_dwordx4 v33, s[32:35], s27 offen lds
    s_add_u32 m0, s62, 15360
    s_nop 0
    buffer_load_dwordx4 v34, s[32:35], s27 offen lds
    s_waitcnt vmcnt(14)
    ds_read_b64_tr_b16 v[164:165], v36 offset:0
    ds_read_b64_tr_b16 v[166:167], v36 offset:1024
    ds_read_b64_tr_b16 v[244:245], v36 offset:32
    ds_read_b64_tr_b16 v[246:247], v36 offset:1056
    s_waitcnt lgkmcnt(0)
    s_waitcnt vmcnt(12)
    ds_read_b64_tr_b16 v[168:169], v36 offset:2048
    ds_read_b64_tr_b16 v[170:171], v36 offset:3072
    ds_read_b64_tr_b16 v[248:249], v36 offset:2080
    ds_read_b64_tr_b16 v[250:251], v36 offset:3104
    s_waitcnt lgkmcnt(0)
    s_waitcnt vmcnt(10)
    ds_read_b64_tr_b16 v[172:173], v36 offset:4096
    ds_read_b64_tr_b16 v[174:175], v36 offset:5120
    ds_read_b64_tr_b16 v[252:253], v36 offset:4128
    ds_read_b64_tr_b16 v[254:255], v36 offset:5152
    s_waitcnt lgkmcnt(0)
    s_waitcnt vmcnt(0)
    ds_read_b64_tr_b16 v[40:41], v37 offset:6144
    ds_read_b64_tr_b16 v[42:43], v37 offset:11264
    ds_read_b64_tr_b16 v[44:45], v37 offset:6176
    ds_read_b64_tr_b16 v[46:47], v37 offset:11296
    ds_read_b64_tr_b16 v[48:49], v37 offset:6208
    ds_read_b64_tr_b16 v[50:51], v37 offset:11328
    ds_read_b64_tr_b16 v[52:53], v37 offset:6240
    ds_read_b64_tr_b16 v[54:55], v37 offset:11360
    s_waitcnt lgkmcnt(0)
    ds_write_b128 v2, v[40:43] offset:0
    ds_write_b128 v2, v[44:47] offset:3072
    ds_write_b128 v2, v[48:51] offset:6144
    ds_write_b128 v2, v[52:55] offset:9216
    s_waitcnt lgkmcnt(0)
    ds_read_b64_tr_b16 v[40:41], v37 offset:6272
    ds_read_b64_tr_b16 v[42:43], v37 offset:11392
    ds_read_b64_tr_b16 v[44:45], v37 offset:6304
    ds_read_b64_tr_b16 v[46:47], v37 offset:11424
    ds_read_b64_tr_b16 v[48:49], v37 offset:6336
    ds_read_b64_tr_b16 v[50:51], v37 offset:11456
    ds_read_b64_tr_b16 v[52:53], v37 offset:6368
    ds_read_b64_tr_b16 v[54:55], v37 offset:11488
    s_waitcnt lgkmcnt(0)
    ds_write_b128 v2, v[40:43] offset:12288
    ds_write_b128 v2, v[44:47] offset:15360
    ds_write_b128 v2, v[48:51] offset:18432
    ds_write_b128 v2, v[52:55] offset:21504
    s_waitcnt lgkmcnt(0)
    ds_read_b64_tr_b16 v[40:41], v37 offset:6400
    ds_read_b64_tr_b16 v[42:43], v37 offset:11520
    ds_read_b64_tr_b16 v[44:45], v37 offset:6432
    ds_read_b64_tr_b16 v[46:47], v37 offset:11552
    s_waitcnt lgkmcnt(0)
    ds_write_b128 v2, v[40:43] offset:24576
    ds_write_b128 v2, v[44:47] offset:27648
    s_waitcnt lgkmcnt(0)
    s_add_u32 s27, s27, 40960
    s_add_u32 m0, s62, 0
    s_nop 0
    buffer_load_dwordx4 v25, s[32:35], s27 offen lds
    s_add_u32 m0, s62, 1024
    s_nop 0
    buffer_load_dwordx4 v26, s[32:35], s27 offen lds
    s_add_u32 m0, s62, 2048
    s_nop 0
    buffer_load_dwordx4 v27, s[32:35], s27 offen lds
    s_add_u32 m0, s62, 3072
    s_nop 0
    buffer_load_dwordx4 v28, s[32:35], s27 offen lds
    s_add_u32 m0, s62, 4096
    s_nop 0
    buffer_load_dwordx4 v29, s[32:35], s27 offen lds
    s_add_u32 m0, s62, 5120
    s_nop 0
    buffer_load_dwordx4 v30, s[32:35], s27 offen lds
    s_add_u32 m0, s62, 6144
    s_nop 0
    buffer_load_dwordx4 v31, s[32:35], s27 offen lds
    s_add_u32 m0, s62, 7168
    s_nop 0
    buffer_load_dwordx4 v32, s[32:35], s27 offen lds
    s_add_u32 m0, s62, 8192
    s_nop 0
    buffer_load_dwordx4 v33, s[32:35], s27 offen lds
    s_add_u32 m0, s62, 9216
    s_nop 0
    buffer_load_dwordx4 v34, s[32:35], s27 offen lds
    s_waitcnt vmcnt(0)
    ds_read_b64_tr_b16 v[40:41], v37 offset:0
    ds_read_b64_tr_b16 v[42:43], v37 offset:5120
    ds_read_b64_tr_b16 v[44:45], v37 offset:32
    ds_read_b64_tr_b16 v[46:47], v37 offset:5152
    ds_read_b64_tr_b16 v[48:49], v37 offset:64
    ds_read_b64_tr_b16 v[50:51], v37 offset:5184
    ds_read_b64_tr_b16 v[52:53], v37 offset:96
    ds_read_b64_tr_b16 v[54:55], v37 offset:5216
    s_waitcnt lgkmcnt(0)
    ds_write_b128 v2, v[40:43] offset:1024
    ds_write_b128 v2, v[44:47] offset:4096
    ds_write_b128 v2, v[48:51] offset:7168
    ds_write_b128 v2, v[52:55] offset:10240
    s_waitcnt lgkmcnt(0)
    ds_read_b64_tr_b16 v[40:41], v37 offset:128
    ds_read_b64_tr_b16 v[42:43], v37 offset:5248
    ds_read_b64_tr_b16 v[44:45], v37 offset:160
    ds_read_b64_tr_b16 v[46:47], v37 offset:5280
    ds_read_b64_tr_b16 v[48:49], v37 offset:192
    ds_read_b64_tr_b16 v[50:51], v37 offset:5312
    ds_read_b64_tr_b16 v[52:53], v37 offset:224
    ds_read_b64_tr_b16 v[54:55], v37 offset:5344
    s_waitcnt lgkmcnt(0)
    ds_write_b128 v2, v[40:43] offset:13312
    ds_write_b128 v2, v[44:47] offset:16384
    ds_write_b128 v2, v[48:51] offset:19456
    ds_write_b128 v2, v[52:55] offset:22528
    s_waitcnt lgkmcnt(0)
    ds_read_b64_tr_b16 v[40:41], v37 offset:256
    ds_read_b64_tr_b16 v[42:43], v37 offset:5376
    ds_read_b64_tr_b16 v[44:45], v37 offset:288
    ds_read_b64_tr_b16 v[46:47], v37 offset:5408
    s_waitcnt lgkmcnt(0)
    ds_write_b128 v2, v[40:43] offset:25600
    ds_write_b128 v2, v[44:47] offset:28672
    s_waitcnt lgkmcnt(0)
    s_add_u32 s27, s27, 40960
    s_add_u32 m0, s62, 0
    s_nop 0
    buffer_load_dwordx4 v25, s[32:35], s27 offen lds
    s_add_u32 m0, s62, 1024
    s_nop 0
    buffer_load_dwordx4 v26, s[32:35], s27 offen lds
    s_add_u32 m0, s62, 2048
    s_nop 0
    buffer_load_dwordx4 v27, s[32:35], s27 offen lds
    s_add_u32 m0, s62, 3072
    s_nop 0
    buffer_load_dwordx4 v28, s[32:35], s27 offen lds
    s_add_u32 m0, s62, 4096
    s_nop 0
    buffer_load_dwordx4 v29, s[32:35], s27 offen lds
    s_add_u32 m0, s62, 5120
    s_nop 0
    buffer_load_dwordx4 v30, s[32:35], s27 offen lds
    s_add_u32 m0, s62, 6144
    s_nop 0
    buffer_load_dwordx4 v31, s[32:35], s27 offen lds
    s_add_u32 m0, s62, 7168
    s_nop 0
    buffer_load_dwordx4 v32, s[32:35], s27 offen lds
    s_add_u32 m0, s62, 8192
    s_nop 0
    buffer_load_dwordx4 v33, s[32:35], s27 offen lds
    s_add_u32 m0, s62, 9216
    s_nop 0
    buffer_load_dwordx4 v34, s[32:35], s27 offen lds
    s_waitcnt vmcnt(0)
    ds_read_b64_tr_b16 v[40:41], v37 offset:0
    ds_read_b64_tr_b16 v[42:43], v37 offset:5120
    ds_read_b64_tr_b16 v[44:45], v37 offset:32
    ds_read_b64_tr_b16 v[46:47], v37 offset:5152
    ds_read_b64_tr_b16 v[48:49], v37 offset:64
    ds_read_b64_tr_b16 v[50:51], v37 offset:5184
    ds_read_b64_tr_b16 v[52:53], v37 offset:96
    ds_read_b64_tr_b16 v[54:55], v37 offset:5216
    s_waitcnt lgkmcnt(0)
    ds_write_b128 v2, v[40:43] offset:2048
    ds_write_b128 v2, v[44:47] offset:5120
    ds_write_b128 v2, v[48:51] offset:8192
    ds_write_b128 v2, v[52:55] offset:11264
    s_waitcnt lgkmcnt(0)
    ds_read_b64_tr_b16 v[40:41], v37 offset:128
    ds_read_b64_tr_b16 v[42:43], v37 offset:5248
    ds_read_b64_tr_b16 v[44:45], v37 offset:160
    ds_read_b64_tr_b16 v[46:47], v37 offset:5280
    ds_read_b64_tr_b16 v[48:49], v37 offset:192
    ds_read_b64_tr_b16 v[50:51], v37 offset:5312
    ds_read_b64_tr_b16 v[52:53], v37 offset:224
    ds_read_b64_tr_b16 v[54:55], v37 offset:5344
    s_waitcnt lgkmcnt(0)
    ds_write_b128 v2, v[40:43] offset:14336
    ds_write_b128 v2, v[44:47] offset:17408
    ds_write_b128 v2, v[48:51] offset:20480
    ds_write_b128 v2, v[52:55] offset:23552
    s_waitcnt lgkmcnt(0)
    ds_read_b64_tr_b16 v[40:41], v37 offset:256
    ds_read_b64_tr_b16 v[42:43], v37 offset:5376
    ds_read_b64_tr_b16 v[44:45], v37 offset:288
    ds_read_b64_tr_b16 v[46:47], v37 offset:5408
    s_waitcnt lgkmcnt(0)
    ds_write_b128 v2, v[40:43] offset:26624
    ds_write_b128 v2, v[44:47] offset:29696
    s_waitcnt lgkmcnt(0)
    v_and_b32 v10, 15, v0
    v_lshrrev_b32 v11, 4, v0
    v_and_b32 v12, 7, v0
    v_and_b32 v13, 1, v0
    v_mov_b32 v14, 0x3f80
    v_lshlrev_b32 v13, 4, v13
    v_lshlrev_b32 v14, v13, v14
    v_lshrrev_b32 v12, 1, v12
    v_lshrrev_b32 v13, 2, v10
    v_cmp_eq_u32 s[38:39], v13, v11
    v_bfe_u32 v13, v0, 1, 1
    s_nop 0
    v_cndmask_b32 v17, 0, v14, s[38:39]
    v_cmp_eq_u32 vcc, 0, v12
    s_nop 1
    v_cndmask_b32 v15, 0, v14, vcc
    v_accvgpr_write_b32 a248, v15
    v_cmp_eq_u32 vcc, 0, v13
    s_nop 1
    v_cndmask_b32 v16, 0, v17, vcc
    v_accvgpr_write_b32 a240, v16
    v_accvgpr_write_b32 a244, 0
    v_cmp_eq_u32 vcc, 1, v12
    s_nop 1
    v_cndmask_b32 v15, 0, v14, vcc
    v_accvgpr_write_b32 a249, v15
    v_cmp_eq_u32 vcc, 1, v13
    s_nop 1
    v_cndmask_b32 v16, 0, v17, vcc
    v_accvgpr_write_b32 a241, v16
    v_accvgpr_write_b32 a245, 0
    v_cmp_eq_u32 vcc, 2, v12
    s_nop 1
    v_cndmask_b32 v15, 0, v14, vcc
    v_accvgpr_write_b32 a250, v15
    v_cmp_eq_u32 vcc, 0, v13
    s_nop 1
    v_cndmask_b32 v16, 0, v17, vcc
    v_accvgpr_write_b32 a246, v16
    v_accvgpr_write_b32 a242, 0
    v_cmp_eq_u32 vcc, 3, v12
    s_nop 1
    v_cndmask_b32 v15, 0, v14, vcc
    v_accvgpr_write_b32 a251, v15
    v_cmp_eq_u32 vcc, 1, v13
    s_nop 1
    v_cndmask_b32 v16, 0, v17, vcc
    v_accvgpr_write_b32 a247, v16
    v_accvgpr_write_b32 a243, 0
    v_cmp_gt_u32 s[48:49], 8, v10
    v_cmp_gt_u32 vcc, 2, v11
    s_xnor_b64 s[50:51], vcc, s[48:49]
    s_mul_i32 s60, s15, 640
    s_mov_b32 s61, 20480
    v_add_u32 v12, 0, v0
    v_mul_u32_u24 v13, 52429, v12
    v_lshrrev_b32 v13, 21, v13
    v_mul_u32_u24 v14, 40, v13
    v_sub_u32 v14, v12, v14
    v_mul_lo_u32 v13, v13, s61
    v_lshl_add_u32 v13, v14, 4, v13
    v_add_u32 v3, s60, v13
    v_add_u32 v12, 64, v0
    v_mul_u32_u24 v13, 52429, v12
    v_lshrrev_b32 v13, 21, v13
    v_mul_u32_u24 v14, 40, v13
    v_sub_u32 v14, v12, v14
    v_mul_lo_u32 v13, v13, s61
    v_lshl_add_u32 v13, v14, 4, v13
    v_add_u32 v4, s60, v13
    v_add_u32 v12, 128, v0
    v_mul_u32_u24 v13, 52429, v12
    v_lshrrev_b32 v13, 21, v13
    v_mul_u32_u24 v14, 40, v13
    v_sub_u32 v14, v12, v14
    v_mul_lo_u32 v13, v13, s61
    v_lshl_add_u32 v13, v14, 4, v13
    v_add_u32 v5, s60, v13
    v_add_u32 v12, 192, v0
    v_mul_u32_u24 v13, 52429, v12
    v_lshrrev_b32 v13, 21, v13
    v_mul_u32_u24 v14, 40, v13
    v_sub_u32 v14, v12, v14
    v_mul_lo_u32 v13, v13, s61
    v_lshl_add_u32 v13, v14, 4, v13
    v_add_u32 v6, s60, v13
    v_add_u32 v12, 256, v0
    v_mul_u32_u24 v13, 52429, v12
    v_lshrrev_b32 v13, 21, v13
    v_mul_u32_u24 v14, 40, v13
    v_sub_u32 v14, v12, v14
    v_mul_lo_u32 v13, v13, s61
    v_lshl_add_u32 v13, v14, 4, v13
    v_add_u32 v7, s60, v13
    s_mul_i32 s60, s15, 20480
    s_add_u32 s60, s60, 0
    v_lshrrev_b32 v12, 4, v0
    v_mul_u32_u24 v12, 640, v12
    v_and_b32 v13, 15, v0
    v_lshl_add_u32 v12, v13, 4, v12
    v_add_u32 v8, s60, v12
    s_mul_i32 s60, s15, 40
    s_add_u32 s60, s60, 0
    v_add_u32 v12, s60, v10
    v_lshlrev_b32 v9, 4, v12
    s_mul_i32 s32, s14, 655360
    s_add_u32 s32, s32, 1310720
    s_add_u32 s33, s32, 5120
    s_add_u32 s34, s32, 10240
    s_add_u32 s35, s32, 15360
    s_mov_b32 s52, 1037384597
    s_mov_b32 s53, 1037384597
    s_lshl_b32 s29, s13, 12
    s_add_u32 s29, s29, 917504
    s_xor_b32 s30, s29, 4096
    s_mov_b64 s[46:47], 65535
    s_mov_b32 s8, s66
    s_and_b32 s9, s67, 0xffff
    s_mov_b32 s10, 10240
    s_mov_b32 s11, 0x20000
    v_and_b32 v13, 7, v12
    v_mul_u32_u24 v13, 1280, v13
    v_lshrrev_b32 v14, 6, v12
    v_lshl_add_u32 v13, v14, 6, v13
    v_bfe_u32 v14, v12, 4, 2
    v_lshl_add_u32 v13, v14, 3, v13
    v_and_b32 v14, 8, v12
    v_cmp_eq_u32 s[38:39], 0, v14
    v_cmp_ne_u32 s[40:41], 0, v14
    s_cmp_eq_u32 s14, 0
    s_cselect_b32 s10, 10240, 0
    buffer_load_dwordx2 v[16:17], v13, s[8:11], 0 offen
    buffer_load_dwordx2 v[18:19], v13, s[8:11], 0 offen offset:32
    s_waitcnt vmcnt(0)
    v_accvgpr_write_b32 a252, v16
    v_accvgpr_write_b32 a253, v17
    v_accvgpr_write_b32 a254, v18
    v_accvgpr_write_b32 a255, v19
    s_lshl_b32 s3, s18, 2
    s_add_u32 s3, s3, 64
    v_mov_b32 v92, s3
    v_lshlrev_b32 v94, 2, v0
    v_and_b32 v94, 28, v94
    s_mov_b32 s19, 0
L_R0_warr_2:
    global_load_dword v93, v92, s[16:17] sc1
    s_add_u32 s19, s19, 1
    s_cmp_ge_u32 s19, 524288
    s_cbranch_scc1 L_fail
    s_waitcnt vmcnt(0)
    v_cmp_gt_u32 vcc, 256, v93
    s_nop 0
    s_cbranch_vccnz L_R0_warr_2
    s_cmp_lg_u32 s18, 0
    s_cbranch_scc1 L_R0_placed_3
    global_load_dword v93, v94, s[16:17] sc1
    s_waitcnt vmcnt(0)
    v_cmp_ne_u32 vcc, 32, v93
    s_nop 0
    s_cbranch_vccnz L_fallback
L_R0_placed_3:
    v_lshlrev_b32 v0, 4, v0
    s_mov_b32 s20, 0
    s_barrier
    v_or_b32 v16, 1, v16
    s_lshl_b32 s60, s14, 15
    s_add_u32 s60, s60, 1179648
    s_mul_i32 s61, s14, 20480
    s_add_u32 s61, s61, 2621440
    s_mov_b64 exec, s[46:47]
    buffer_store_dwordx4 v[16:19], v9, s[4:7], s60 offen sc1
    buffer_store_dwordx4 v[16:19], v9, s[4:7], s61 offen sc1
    s_mov_b64 exec, -1
    s_waitcnt vmcnt(0)
    s_add_u32 s60, s20, 1
    s_and_b32 s22, s60, 1
    s_lshl_b32 s21, s22, 31
    s_sub_u32 s44, 0, s22
    s_bfe_u32 s23, s20, 0x10001
    s_sub_u32 s23, s23, 1
    s_lshr_b32 s24, s60, 1
    s_andn2_b32 s24, 1, s24
    s_lshl_b32 s61, s14, 15
    s_add_u32 s61, s61, 1179648
    s_and_b32 s25, s20, 1
    s_lshl_b32 s25, s25, 16
    s_add_u32 s25, s25, s61
    s_add_u32 s25, s25, 0
    s_add_u32 s26, s25, 4096
    s_lshl_b32 s36, s22, 16
    s_add_u32 s36, s36, s61
    s_lshl_b32 s27, s20, 1
    s_add_u32 s37, s27, 2
    s_add_u32 s37, s37, s14
    s_mul_i32 s37, s37, 20480
    s_add_u32 s37, s37, 2621440
    s_add_u32 s27, s27, 1
    s_sub_u32 s27, s27, s14
    s_mul_i32 s27, s27, 20480
    s_add_u32 s27, s27, 2621440
    s_add_u32 s28, s27, 4096
    s_lshl_b32 s31, s20, 6
    s_add_u32 s31, s31, s13
    s_mul_i32 s31, s31, 6144
    s_add_u32 s31, s31, 5898240
    s_min_u32 s56, s20, 63
    s_lshl_b32 s56, s56, 6
    s_add_u32 s56, s56, s13
    s_mul_i32 s56, s56, 12288
    s_add_u32 s56, s56, 37361664
    s_max_u32 s57, s20, 7
    s_sub_u32 s57, s57, 7
    s_lshl_b32 s57, s57, 6
    s_add_u32 s57, s57, s13
    s_mul_i32 s57, s57, 12288
    s_add_u32 s57, s57, 87693312
    s_cmp_lt_u32 s20, 7
    s_cselect_b32 s57, s56, s57
    s_cmp_gt_u32 s60, 63
    s_cselect_b64 s[42:43], s[38:39], 0
    s_cmp_le_u32 s60, 7
    s_cselect_b64 vcc, s[40:41], 0
    s_or_b64 s[42:43], s[42:43], vcc
    s_cmp_lg_u32 s18, 0
    s_cbranch_scc1 L_R0_slow
L_Rf0_top:
    s_barrier
    buffer_load_dwordx4 v[10:13], v0, s[4:7], s25 offen offset:0 sc1
    buffer_load_dwordx4 v[14:17], v0, s[4:7], s25 offen offset:1024 sc1
    buffer_load_dwordx4 v[18:21], v0, s[4:7], s25 offen offset:2048 sc1
    buffer_load_dwordx4 v[22:25], v0, s[4:7], s25 offen offset:3072 sc1
    buffer_load_dwordx4 v[26:29], v0, s[4:7], s26 offen offset:0 sc1
    s_barrier
    buffer_load_dwordx4 v[46:49], v0, s[4:7], s27 offen offset:0 sc1
    buffer_load_dwordx4 v[30:33], v0, s[4:7], s27 offen offset:1024 sc1
    buffer_load_dwordx4 v[34:37], v0, s[4:7], s27 offen offset:2048 sc1
    buffer_load_dwordx4 v[38:41], v0, s[4:7], s27 offen offset:3072 sc1
    buffer_load_dwordx4 v[42:45], v0, s[4:7], s28 offen offset:0 sc1
    s_mov_b32 s19, 0
L_Rf0_gl_1:
    s_waitcnt vmcnt(9)
    v_mfma_f32_16x16x32_bf16 v[50:53], a[240:243], v[10:13], 0
    v_mfma_f32_16x16x32_bf16 v[54:57], a[244:247], v[10:13], 0
    v_xor_b32 v1, s23, v10
    s_waitcnt vmcnt(8)
    v_mfma_f32_16x16x32_bf16 v[58:61], a[240:243], v[14:17], 0
    v_mfma_f32_16x16x32_bf16 v[62:65], a[244:247], v[14:17], 0
    v_bitop3_b32 v1, v1, v14, s23 bitop3:0xf6
    s_waitcnt vmcnt(7)
    v_mfma_f32_16x16x32_bf16 v[66:69], a[240:243], v[18:21], 0
    v_mfma_f32_16x16x32_bf16 v[70:73], a[244:247], v[18:21], 0
    v_bitop3_b32 v1, v1, v18, s23 bitop3:0xf6
    s_waitcnt vmcnt(6)
    v_mfma_f32_16x16x32_bf16 v[74:77], a[240:243], v[22:25], 0
    v_mfma_f32_16x16x32_bf16 v[78:81], a[244:247], v[22:25], 0
    v_bitop3_b32 v1, v1, v22, s23 bitop3:0xf6
    s_waitcnt vmcnt(5)
    v_mfma_f32_16x16x32_bf16 v[82:85], a[240:243], v[26:29], 0
    v_mfma_f32_16x16x32_bf16 v[86:89], a[244:247], v[26:29], 0
    v_bitop3_b32 v1, v1, v26, s23 bitop3:0xf6
    v_and_b32 v1, 1, v1
    v_cmp_ne_u32 vcc, 0, v1
    s_nop 0
    s_cbranch_vccnz L_Rf0_glfix_3
L_Rf0_gr_2:
    s_waitcnt vmcnt(4)
    v_mfma_f32_16x16x32_bf16 v[50:53], a[240:243], v[46:49], v[50:53]
    v_xor_b32 v1, s23, v46
    v_mfma_f32_16x16x32_bf16 v[54:57], a[244:247], v[46:49], v[54:57]
    s_waitcnt vmcnt(3)
    v_mfma_f32_16x16x32_bf16 v[58:61], a[240:243], v[30:33], v[58:61]
    v_bitop3_b32 v1, v1, v30, s23 bitop3:0xf6
    v_mfma_f32_16x16x32_bf16 v[62:65], a[244:247], v[30:33], v[62:65]
    s_nop 1
    v_cvt_pk_bf16_f32 v90, v50, v51
    v_cvt_pk_bf16_f32 v91, v52, v53
    v_cvt_pk_bf16_f32 v92, v54, v55
    v_cvt_pk_bf16_f32 v93, v56, v57
    ds_write_b128 v0, v[90:93] offset:0
    s_waitcnt vmcnt(2)
    v_mfma_f32_16x16x32_bf16 v[66:69], a[240:243], v[34:37], v[66:69]
    v_bitop3_b32 v1, v1, v34, s23 bitop3:0xf6
    v_mfma_f32_16x16x32_bf16 v[70:73], a[244:247], v[34:37], v[70:73]
    v_cvt_pk_bf16_f32 v90, v58, v59
    v_cvt_pk_bf16_f32 v91, v60, v61
    v_cvt_pk_bf16_f32 v92, v62, v63
    v_cvt_pk_bf16_f32 v93, v64, v65
    ds_write_b128 v0, v[90:93] offset:1024
    s_waitcnt vmcnt(1)
    v_mfma_f32_16x16x32_bf16 v[74:77], a[240:243], v[38:41], v[74:77]
    v_bitop3_b32 v1, v1, v38, s23 bitop3:0xf6
    v_mfma_f32_16x16x32_bf16 v[78:81], a[244:247], v[38:41], v[78:81]
    v_cvt_pk_bf16_f32 v90, v66, v67
    v_cvt_pk_bf16_f32 v91, v68, v69
    v_cvt_pk_bf16_f32 v92, v70, v71
    v_cvt_pk_bf16_f32 v93, v72, v73
    ds_write_b128 v0, v[90:93] offset:2048
    s_waitcnt vmcnt(0)
    v_mfma_f32_16x16x32_bf16 v[82:85], a[240:243], v[42:45], v[82:85]
    v_bitop3_b32 v1, v1, v42, s23 bitop3:0xf6
    v_mfma_f32_16x16x32_bf16 v[86:89], a[244:247], v[42:45], v[86:89]
    v_cvt_pk_bf16_f32 v90, v74, v75
    v_cvt_pk_bf16_f32 v91, v76, v77
    v_cvt_pk_bf16_f32 v92, v78, v79
    v_cvt_pk_bf16_f32 v93, v80, v81
    ds_write_b128 v0, v[90:93] offset:3072
    s_nop 0
    v_cvt_pk_bf16_f32 v90, v82, v83
    v_cvt_pk_bf16_f32 v91, v84, v85
    v_cvt_pk_bf16_f32 v92, v86, v87
    v_cvt_pk_bf16_f32 v93, v88, v89
    ds_write_b128 v0, v[90:93] offset:4096
    v_and_b32 v1, 1, v1
    v_cmp_ne_u32 vcc, 0, v1
    s_nop 0
    s_cbranch_vccnz L_Rf0_grfix_5
    s_waitcnt lgkmcnt(0)
    s_barrier
    ds_read_b128 v[10:13], v0 offset:0
    ds_read_b128 v[14:17], v0 offset:1024
    ds_read_b128 v[18:21], v0 offset:2048
    ds_read_b128 v[22:25], v0 offset:3072
    ds_read_b128 v[26:29], v0 offset:4096
    s_waitcnt lgkmcnt(4)
    v_mfma_f32_16x16x32_bf16 v[46:49], a[0:3], v[10:13], 0
    s_mov_b32 m0, 35840
    v_mfma_f32_16x16x32_bf16 v[50:53], a[80:83], v[10:13], 0
    v_mfma_f32_16x16x32_bf16 v[54:57], a[160:163], v[10:13], 0
    ds_read_b128 v[10:13], v0 offset:5120
    s_waitcnt lgkmcnt(4)
    v_mfma_f32_16x16x32_bf16 v[46:49], a[4:7], v[14:17], v[46:49]
    buffer_load_dwordx4 v0, s[4:7], s56 offen offset:0 sc1 lds
    v_mfma_f32_16x16x32_bf16 v[50:53], a[84:87], v[14:17], v[50:53]
    v_mfma_f32_16x16x32_bf16 v[54:57], a[164:167], v[14:17], v[54:57]
    ds_read_b128 v[14:17], v0 offset:6144
    s_waitcnt lgkmcnt(4)
    v_mfma_f32_16x16x32_bf16 v[46:49], a[8:11], v[18:21], v[46:49]
    buffer_load_dwordx4 v0, s[4:7], s56 offen offset:1024 sc1 lds
    v_mfma_f32_16x16x32_bf16 v[50:53], a[88:91], v[18:21], v[50:53]
    v_mfma_f32_16x16x32_bf16 v[54:57], a[168:171], v[18:21], v[54:57]
    ds_read_b128 v[18:21], v0 offset:7168
    s_waitcnt lgkmcnt(4)
    v_mfma_f32_16x16x32_bf16 v[46:49], a[12:15], v[22:25], v[46:49]
    buffer_load_dwordx4 v0, s[4:7], s56 offen offset:2048 sc1 lds
    v_mfma_f32_16x16x32_bf16 v[50:53], a[92:95], v[22:25], v[50:53]
    v_mfma_f32_16x16x32_bf16 v[54:57], a[172:175], v[22:25], v[54:57]
    ds_read_b128 v[22:25], v0 offset:8192
    s_waitcnt lgkmcnt(4)
    v_mfma_f32_16x16x32_bf16 v[46:49], a[16:19], v[26:29], v[46:49]
    v_mfma_f32_16x16x32_bf16 v[50:53], a[96:99], v[26:29], v[50:53]
    v_mfma_f32_16x16x32_bf16 v[54:57], a[176:179], v[26:29], v[54:57]
    ds_read_b128 v[26:29], v0 offset:9216
    s_waitcnt lgkmcnt(4)
    v_mfma_f32_16x16x32_bf16 v[46:49], a[20:23], v[10:13], v[46:49]
    v_mfma_f32_16x16x32_bf16 v[50:53], a[100:103], v[10:13], v[50:53]
    v_mfma_f32_16x16x32_bf16 v[54:57], a[180:183], v[10:13], v[54:57]
    ds_read_b128 v[10:13], v0 offset:10240
    s_waitcnt lgkmcnt(4)
    v_mfma_f32_16x16x32_bf16 v[46:49], a[24:27], v[14:17], v[46:49]
    v_mfma_f32_16x16x32_bf16 v[50:53], a[104:107], v[14:17], v[50:53]
    v_mfma_f32_16x16x32_bf16 v[54:57], a[184:187], v[14:17], v[54:57]
    ds_read_b128 v[14:17], v0 offset:11264
    s_waitcnt lgkmcnt(4)
    v_mfma_f32_16x16x32_bf16 v[46:49], a[28:31], v[18:21], v[46:49]
    v_mfma_f32_16x16x32_bf16 v[50:53], a[108:111], v[18:21], v[50:53]
    v_mfma_f32_16x16x32_bf16 v[54:57], a[188:191], v[18:21], v[54:57]
    ds_read_b128 v[18:21], v0 offset:12288
    s_waitcnt lgkmcnt(4)
    v_mfma_f32_16x16x32_bf16 v[46:49], a[32:35], v[22:25], v[46:49]
    v_mfma_f32_16x16x32_bf16 v[50:53], a[112:115], v[22:25], v[50:53]
    v_mfma_f32_16x16x32_bf16 v[54:57], a[192:195], v[22:25], v[54:57]
    ds_read_b128 v[22:25], v0 offset:13312
    s_waitcnt lgkmcnt(4)
    v_mfma_f32_16x16x32_bf16 v[46:49], a[36:39], v[26:29], v[46:49]
    v_mfma_f32_16x16x32_bf16 v[50:53], a[116:119], v[26:29], v[50:53]
    v_mfma_f32_16x16x32_bf16 v[54:57], a[196:199], v[26:29], v[54:57]
    ds_read_b128 v[26:29], v0 offset:14336
    s_waitcnt lgkmcnt(4)
    v_mfma_f32_16x16x32_bf16 v[46:49], a[40:43], v[10:13], v[46:49]
    v_mfma_f32_16x16x32_bf16 v[50:53], a[120:123], v[10:13], v[50:53]
    v_mfma_f32_16x16x32_bf16 v[54:57], a[200:203], v[10:13], v[54:57]
    ds_read_b128 v[10:13], v0 offset:15360
    s_waitcnt lgkmcnt(4)
    v_mfma_f32_16x16x32_bf16 v[46:49], a[44:47], v[14:17], v[46:49]
    v_mfma_f32_16x16x32_bf16 v[50:53], a[124:127], v[14:17], v[50:53]
    v_mfma_f32_16x16x32_bf16 v[54:57], a[204:207], v[14:17], v[54:57]
    ds_read_b128 v[14:17], v0 offset:16384
    s_waitcnt lgkmcnt(4)
    v_mfma_f32_16x16x32_bf16 v[46:49], a[48:51], v[18:21], v[46:49]
    v_mfma_f32_16x16x32_bf16 v[50:53], a[128:131], v[18:21], v[50:53]
    v_mfma_f32_16x16x32_bf16 v[54:57], a[208:211], v[18:21], v[54:57]
    ds_read_b128 v[18:21], v0 offset:17408
    s_waitcnt lgkmcnt(4)
    v_mfma_f32_16x16x32_bf16 v[46:49], a[52:55], v[22:25], v[46:49]
    v_mfma_f32_16x16x32_bf16 v[50:53], a[132:135], v[22:25], v[50:53]
    v_mfma_f32_16x16x32_bf16 v[54:57], a[212:215], v[22:25], v[54:57]
    ds_read_b128 v[22:25], v0 offset:18432
    s_waitcnt lgkmcnt(4)
    v_mfma_f32_16x16x32_bf16 v[46:49], a[56:59], v[26:29], v[46:49]
    v_mfma_f32_16x16x32_bf16 v[50:53], a[136:139], v[26:29], v[50:53]
    v_mfma_f32_16x16x32_bf16 v[54:57], a[216:219], v[26:29], v[54:57]
    ds_read_b128 v[26:29], v0 offset:19456
    s_waitcnt lgkmcnt(4)
    v_mfma_f32_16x16x32_bf16 v[46:49], a[60:63], v[10:13], v[46:49]
    v_mfma_f32_16x16x32_bf16 v[50:53], a[140:143], v[10:13], v[50:53]
    v_mfma_f32_16x16x32_bf16 v[54:57], a[220:223], v[10:13], v[54:57]
    ds_read_b128 v[10:13], v0 offset:0
    s_waitcnt lgkmcnt(4)
    v_mfma_f32_16x16x32_bf16 v[46:49], a[64:67], v[14:17], v[46:49]
    v_mfma_f32_16x16x32_bf16 v[50:53], a[144:147], v[14:17], v[50:53]
    v_mfma_f32_16x16x32_bf16 v[54:57], a[224:227], v[14:17], v[54:57]
    ds_read_b128 v[14:17], v0 offset:1024
    s_waitcnt lgkmcnt(4)
    v_mfma_f32_16x16x32_bf16 v[46:49], a[68:71], v[18:21], v[46:49]
    v_mfma_f32_16x16x32_bf16 v[50:53], a[148:151], v[18:21], v[50:53]
    v_mfma_f32_16x16x32_bf16 v[54:57], a[228:231], v[18:21], v[54:57]
    ds_read_b128 v[18:21], v0 offset:2048
    s_waitcnt lgkmcnt(4)
    v_mfma_f32_16x16x32_bf16 v[46:49], a[72:75], v[22:25], v[46:49]
    v_mfma_f32_16x16x32_bf16 v[50:53], a[152:155], v[22:25], v[50:53]
    v_mfma_f32_16x16x32_bf16 v[54:57], a[232:235], v[22:25], v[54:57]
    ds_read_b128 v[22:25], v0 offset:3072
    s_waitcnt lgkmcnt(4)
    v_mfma_f32_16x16x32_bf16 v[46:49], a[76:79], v[26:29], v[46:49]
    v_mfma_f32_16x16x32_bf16 v[50:53], a[156:159], v[26:29], v[50:53]
    v_mfma_f32_16x16x32_bf16 v[54:57], a[236:239], v[26:29], v[54:57]
    ds_read_b128 v[26:29], v0 offset:4096
    s_waitcnt lgkmcnt(4)
    v_mfma_f32_16x16x32_bf16 v[30:33], v[10:13], v[96:99], 0
    v_mfma_f32_16x16x32_bf16 v[34:37], v[10:13], v[176:179], 0
    ds_read_b128 v[10:13], v0 offset:5120
    s_nop 0
    v_cvt_pk_bf16_f32 v82, v46, v47
    v_cvt_pk_bf16_f32 v83, v48, v49
    ds_write_b64 v0, v[82:83] offset:20480
    v_cvt_pk_bf16_f32 v84, v50, v51
    v_cvt_pk_bf16_f32 v85, v52, v53
    ds_write_b64 v0, v[84:85] offset:20488
    v_cvt_pk_bf16_f32 v86, v54, v55
    v_cvt_pk_bf16_f32 v87, v56, v57
    ds_write_b64 v0, v[86:87] offset:21504
    s_waitcnt lgkmcnt(7)
    v_mfma_f32_16x16x32_bf16 v[30:33], v[14:17], v[100:103], v[30:33]
    v_mfma_f32_16x16x32_bf16 v[34:37], v[14:17], v[180:183], v[34:37]
    ds_read_b128 v[14:17], v0 offset:6144
    s_waitcnt lgkmcnt(1)
    s_barrier
    ds_read_b128 v[58:61], v0 offset:23552
    ds_read_b128 v[46:49], v0 offset:20480
    ds_read_b128 v[62:65], v0 offset:24576
    ds_read_b128 v[50:53], v0 offset:21504
    ds_read_b128 v[66:69], v0 offset:25600
    ds_read_b128 v[54:57], v0 offset:22528
    v_mfma_f32_16x16x32_bf16 v[30:33], v[18:21], v[104:107], v[30:33]
    v_mfma_f32_16x16x32_bf16 v[34:37], v[18:21], v[184:187], v[34:37]
    ds_read_b128 v[18:21], v0 offset:7168
    v_mfma_f32_16x16x32_bf16 v[30:33], v[22:25], v[108:111], v[30:33]
    v_mfma_f32_16x16x32_bf16 v[34:37], v[22:25], v[188:191], v[34:37]
    ds_read_b128 v[22:25], v0 offset:8192
    s_waitcnt lgkmcnt(6)
    v_mfma_f32_16x16x32_bf16 v[38:41], v[58:61], v[46:49], 0
    s_waitcnt lgkmcnt(4)
    v_mfma_f32_16x16x32_bf16 v[38:41], v[62:65], v[50:53], v[38:41]
    s_waitcnt lgkmcnt(2)
    v_mfma_f32_16x16x32_bf16 v[38:41], v[66:69], v[54:57], v[38:41]
    v_mfma_f32_16x16x32_bf16 v[30:33], v[26:29], v[112:115], v[30:33]
    v_mfma_f32_16x16x32_bf16 v[34:37], v[26:29], v[192:195], v[34:37]
    ds_read_b128 v[26:29], v0 offset:9216
    s_nop 4
    v_and_or_b32 v38, v38, -2, s22
    buffer_store_dwordx4 v[38:41], v0, s[4:7], s29 offen
    v_mfma_f32_16x16x32_bf16 v[30:33], v[10:13], v[116:119], v[30:33]
    v_mfma_f32_16x16x32_bf16 v[34:37], v[10:13], v[196:199], v[34:37]
    ds_read_b128 v[10:13], v0 offset:10240
    v_mfma_f32_16x16x32_bf16 v[30:33], v[14:17], v[120:123], v[30:33]
    v_mfma_f32_16x16x32_bf16 v[34:37], v[14:17], v[200:203], v[34:37]
    ds_read_b128 v[14:17], v0 offset:11264
    s_waitcnt lgkmcnt(4)
    v_mfma_f32_16x16x32_bf16 v[30:33], v[18:21], v[124:127], v[30:33]
    v_mfma_f32_16x16x32_bf16 v[34:37], v[18:21], v[204:207], v[34:37]
    ds_read_b128 v[18:21], v0 offset:12288
    s_waitcnt lgkmcnt(4)
    v_mfma_f32_16x16x32_bf16 v[30:33], v[22:25], v[128:131], v[30:33]
    v_mfma_f32_16x16x32_bf16 v[34:37], v[22:25], v[208:211], v[34:37]
    ds_read_b128 v[22:25], v0 offset:13312
    s_waitcnt lgkmcnt(4)
    v_mfma_f32_16x16x32_bf16 v[30:33], v[26:29], v[132:135], v[30:33]
    v_mfma_f32_16x16x32_bf16 v[34:37], v[26:29], v[212:215], v[34:37]
    ds_read_b128 v[26:29], v0 offset:14336
    s_waitcnt lgkmcnt(4)
    v_mfma_f32_16x16x32_bf16 v[30:33], v[10:13], v[136:139], v[30:33]
    v_mfma_f32_16x16x32_bf16 v[34:37], v[10:13], v[216:219], v[34:37]
    ds_read_b128 v[10:13], v0 offset:15360
    s_waitcnt lgkmcnt(4)
    v_mfma_f32_16x16x32_bf16 v[30:33], v[14:17], v[140:143], v[30:33]
    v_mfma_f32_16x16x32_bf16 v[34:37], v[14:17], v[220:223], v[34:37]
    ds_read_b128 v[14:17], v0 offset:16384
    s_waitcnt lgkmcnt(4)
    v_mfma_f32_16x16x32_bf16 v[30:33], v[18:21], v[144:147], v[30:33]
    v_mfma_f32_16x16x32_bf16 v[34:37], v[18:21], v[224:227], v[34:37]
    ds_read_b128 v[18:21], v0 offset:17408
    s_waitcnt lgkmcnt(4)
    v_mfma_f32_16x16x32_bf16 v[30:33], v[22:25], v[148:151], v[30:33]
    v_mfma_f32_16x16x32_bf16 v[34:37], v[22:25], v[228:231], v[34:37]
    ds_read_b128 v[22:25], v0 offset:18432
    v_pk_mul_f32 v[42:43], v[38:39], s[52:53]
    v_pk_mul_f32 v[44:45], v[40:41], s[52:53]
    v_mov_b32 v1, 0xff800000
    v_cndmask_b32 v42, v1, v42, s[50:51]
    v_cndmask_b32 v43, v1, v43, s[50:51]
    v_cndmask_b32 v44, v1, v44, s[50:51]
    v_cndmask_b32 v45, v1, v45, s[50:51]
    s_waitcnt vmcnt(0)
    buffer_load_dwordx4 v[82:85], v0, s[4:7], s30 offen sc1
    s_mov_b32 s19, 0
    s_waitcnt lgkmcnt(4)
    v_mfma_f32_16x16x32_bf16 v[30:33], v[26:29], v[152:155], v[30:33]
    v_mfma_f32_16x16x32_bf16 v[34:37], v[26:29], v[232:235], v[34:37]
    ds_read_b128 v[26:29], v0 offset:19456
    s_waitcnt lgkmcnt(4)
    v_mfma_f32_16x16x32_bf16 v[30:33], v[10:13], v[156:159], v[30:33]
    v_mfma_f32_16x16x32_bf16 v[34:37], v[10:13], v[236:239], v[34:37]
    s_waitcnt lgkmcnt(3)
    v_mfma_f32_16x16x32_bf16 v[30:33], v[14:17], v[160:163], v[30:33]
    v_mfma_f32_16x16x32_bf16 v[34:37], v[14:17], v[240:243], v[34:37]
    s_waitcnt lgkmcnt(2)
    v_mfma_f32_16x16x32_bf16 v[30:33], v[18:21], v[164:167], v[30:33]
    v_mfma_f32_16x16x32_bf16 v[34:37], v[18:21], v[244:247], v[34:37]
    s_waitcnt lgkmcnt(1)
    v_mfma_f32_16x16x32_bf16 v[30:33], v[22:25], v[168:171], v[30:33]
    v_mfma_f32_16x16x32_bf16 v[34:37], v[22:25], v[248:251], v[34:37]
    s_waitcnt lgkmcnt(0)
    v_mfma_f32_16x16x32_bf16 v[30:33], v[26:29], v[172:175], v[30:33]
    v_mfma_f32_16x16x32_bf16 v[34:37], v[26:29], v[252:255], v[34:37]
    s_nop 6
    v_cvt_pk_bf16_f32 v88, v30, v31
    v_cvt_pk_bf16_f32 v89, v32, v33
    v_cvt_pk_bf16_f32 v90, v34, v35
    v_cvt_pk_bf16_f32 v91, v36, v37
    s_add_u32 s60, s31, 3072
    s_cmp_eq_u32 s20, 70
    s_cbranch_scc1 L_Rf0_tail
L_Rf0_ha_6:
    s_waitcnt vmcnt(0)
    v_lshlrev_b32 v1, 31, v82
    v_pk_fma_f32 v[38:39], v[82:83], s[52:53], v[42:43]
    v_pk_fma_f32 v[40:41], v[84:85], s[52:53], v[44:45]
    ds_write_b128 v0, v[38:41] offset:26624
    v_cmp_ne_u32 vcc, s21, v1
    s_nop 0
    s_cbranch_vccnz L_Rf0_hafix_7
    s_waitcnt vmcnt(0) lgkmcnt(0)
    s_barrier
    ds_read_b128 v[10:13], v0 offset:26624
    ds_read_b128 v[14:17], v0 offset:27648
    ds_read_b128 v[18:21], v0 offset:28672
    ds_read_b128 v[58:61], v0 offset:35840
    ds_read_b128 v[62:65], v0 offset:36864
    ds_read_b128 v[66:69], v0 offset:48128
    ds_read_b128 v[70:73], v0 offset:49152
    buffer_store_dwordx4 v[88:91], v0, s[4:7], s60 offen sc1
    s_waitcnt lgkmcnt(5)
    v_max3_f32 v22, v10, v11, v12
    v_max3_f32 v23, v13, v14, v15
    v_max3_f32 v22, v22, v16, v17
    s_waitcnt lgkmcnt(4)
    v_max3_f32 v23, v23, v18, v19
    v_max3_f32 v22, v22, v20, v21
    v_max_f32 v22, v22, v23
    v_mov_b32 v23, v22
    ds_read_b128 v[30:33], v2 offset:0
    ds_read_b128 v[34:37], v2 offset:1024
    v_permlane32_swap_b32 v22, v23
    v_max_f32 v22, v22, v23
    v_mov_b32 v23, v22
    ds_read_b128 v[38:41], v2 offset:2048
    ds_read_b128 v[42:45], v2 offset:3072
    v_permlane16_swap_b32 v22, v23
    v_max_f32 v22, v22, v23
    v_pk_add_f32 v[10:11], v[10:11], v[22:23] op_sel_hi:[1,0] neg_lo:[0,1] neg_hi:[0,1]
    v_pk_add_f32 v[12:13], v[12:13], v[22:23] op_sel_hi:[1,0] neg_lo:[0,1] neg_hi:[0,1]
    v_pk_add_f32 v[14:15], v[14:15], v[22:23] op_sel_hi:[1,0] neg_lo:[0,1] neg_hi:[0,1]
    v_pk_add_f32 v[16:17], v[16:17], v[22:23] op_sel_hi:[1,0] neg_lo:[0,1] neg_hi:[0,1]
    v_pk_add_f32 v[18:19], v[18:19], v[22:23] op_sel_hi:[1,0] neg_lo:[0,1] neg_hi:[0,1]
    v_pk_add_f32 v[20:21], v[20:21], v[22:23] op_sel_hi:[1,0] neg_lo:[0,1] neg_hi:[0,1]
    v_exp_f32 v10, v10
    v_exp_f32 v11, v11
    v_exp_f32 v12, v12
    v_exp_f32 v13, v13
    v_exp_f32 v14, v14
    v_exp_f32 v15, v15
    v_cvt_pk_bf16_f32 v24, v10, v11
    v_cvt_pk_bf16_f32 v25, v12, v13
    v_exp_f32 v16, v16
    v_exp_f32 v17, v17
    v_mfma_f32_16x16x16_bf16 v[46:49], v[88:89], v[24:25], 0
    v_mfma_f32_16x16x16_bf16 v[82:85], v[90:91], v[24:25], 0
    v_exp_f32 v18, v18
    v_exp_f32 v19, v19
    v_exp_f32 v20, v20
    v_exp_f32 v21, v21
    v_cvt_pk_bf16_f32 v26, v14, v15
    v_cvt_pk_bf16_f32 v27, v16, v17
    v_cvt_pk_bf16_f32 v28, v18, v19
    v_cvt_pk_bf16_f32 v29, v20, v21
    v_pk_add_f32 v[22:23], v[10:11], v[12:13]
    v_pk_add_f32 v[14:15], v[14:15], v[16:17]
    s_waitcnt lgkmcnt(4)
    v_mfma_f32_16x16x32_bf16 v[50:53], v[58:61], v[26:29], v[46:49]
    v_pk_add_f32 v[18:19], v[18:19], v[20:21]
    v_mfma_f32_16x16x32_bf16 v[54:57], v[66:69], v[26:29], v[46:49]
    v_pk_add_f32 v[22:23], v[22:23], v[14:15]
    v_pk_add_f32 v[22:23], v[22:23], v[18:19]
    v_mfma_f32_16x16x32_bf16 v[10:13], v[62:65], v[26:29], v[82:85]
    v_add_f32 v22, v22, v23
    v_mfma_f32_16x16x32_bf16 v[14:17], v[70:73], v[26:29], v[82:85]
    v_mov_b32 v23, v22
    ds_read_b128 v[74:77], v2 offset:4096
    ds_read_b128 v[78:81], v2 offset:5120
    v_permlane32_swap_b32 v22, v23
    v_add_f32 v22, v22, v23
    v_mov_b32 v23, v22
    v_cndmask_b32 v50, v54, v50, s[48:49]
    v_cndmask_b32 v51, v55, v51, s[48:49]
    v_permlane16_swap_b32 v22, v23
    v_add_f32 v22, v22, v23
    v_rcp_f32 v22, v22
    v_cndmask_b32 v52, v56, v52, s[48:49]
    v_cndmask_b32 v53, v57, v53, s[48:49]
    v_cndmask_b32 v10, v14, v10, s[48:49]
    v_cndmask_b32 v11, v15, v11, s[48:49]
    v_cndmask_b32 v12, v16, v12, s[48:49]
    v_cndmask_b32 v13, v17, v13, s[48:49]
    v_pk_mul_f32 v[50:51], v[50:51], v[22:23] op_sel_hi:[1,0]
    v_pk_mul_f32 v[52:53], v[52:53], v[22:23] op_sel_hi:[1,0]
    v_cvt_pk_bf16_f32 v24, v50, v51
    v_cvt_pk_bf16_f32 v25, v52, v53
    v_pk_mul_f32 v[10:11], v[10:11], v[22:23] op_sel_hi:[1,0]
    v_pk_mul_f32 v[12:13], v[12:13], v[22:23] op_sel_hi:[1,0]
    v_cvt_pk_bf16_f32 v26, v10, v11
    v_cvt_pk_bf16_f32 v27, v12, v13
    ds_write_b128 v0, v[24:27] offset:0
    s_waitcnt lgkmcnt(0)
    s_barrier
    ds_read_b128 v[10:13], v0 offset:0
    ds_read_b128 v[14:17], v0 offset:1024
    ds_read_b128 v[18:21], v0 offset:2048
    s_add_u32 s20, s20, 1
    s_waitcnt lgkmcnt(2)
    v_mfma_f32_16x16x32_bf16 v[46:49], v[30:33], v[10:13], 0
    ds_read_b128 v[30:33], v2 offset:6144
    s_waitcnt lgkmcnt(2)
    v_mfma_f32_16x16x32_bf16 v[46:49], v[34:37], v[14:17], v[46:49]
    ds_read_b128 v[34:37], v2 offset:7168
    s_waitcnt lgkmcnt(2)
    v_mfma_f32_16x16x32_bf16 v[46:49], v[38:41], v[18:21], v[46:49]
    ds_read_b128 v[38:41], v2 offset:8192
    v_mfma_f32_16x16x32_bf16 v[50:53], v[42:45], v[10:13], 0
    ds_read_b128 v[42:45], v2 offset:9216
    v_mfma_f32_16x16x32_bf16 v[50:53], v[74:77], v[14:17], v[50:53]
    ds_read_b128 v[74:77], v2 offset:10240
    v_mfma_f32_16x16x32_bf16 v[50:53], v[78:81], v[18:21], v[50:53]
    ds_read_b128 v[78:81], v2 offset:11264
    s_waitcnt lgkmcnt(3)
    v_mfma_f32_16x16x32_bf16 v[54:57], v[30:33], v[10:13], 0
    ds_read_b128 v[30:33], v2 offset:12288
    v_cvt_pk_bf16_f32 v62, v46, v47
    v_mfma_f32_16x16x32_bf16 v[54:57], v[34:37], v[14:17], v[54:57]
    ds_read_b128 v[34:37], v2 offset:13312
    v_cvt_pk_bf16_f32 v63, v48, v49
    v_and_or_b32 v62, v62, -2, s22
    v_mfma_f32_16x16x32_bf16 v[54:57], v[38:41], v[18:21], v[54:57]
    ds_read_b128 v[38:41], v2 offset:14336
    v_cvt_pk_bf16_f32 v64, v50, v51
    s_waitcnt lgkmcnt(3)
    v_mfma_f32_16x16x32_bf16 v[58:61], v[42:45], v[10:13], 0
    ds_read_b128 v[42:45], v2 offset:15360
    v_cvt_pk_bf16_f32 v65, v52, v53
    buffer_store_dwordx4 v[62:65], v3, s[4:7], s32 offen
    v_mfma_f32_16x16x32_bf16 v[58:61], v[74:77], v[14:17], v[58:61]
    ds_read_b128 v[74:77], v2 offset:16384
    v_mfma_f32_16x16x32_bf16 v[58:61], v[78:81], v[18:21], v[58:61]
    ds_read_b128 v[78:81], v2 offset:17408
    s_waitcnt lgkmcnt(3)
    v_mfma_f32_16x16x32_bf16 v[46:49], v[30:33], v[10:13], 0
    ds_read_b128 v[30:33], v2 offset:18432
    v_cvt_pk_bf16_f32 v66, v54, v55
    v_mfma_f32_16x16x32_bf16 v[46:49], v[34:37], v[14:17], v[46:49]
    ds_read_b128 v[34:37], v2 offset:19456
    v_cvt_pk_bf16_f32 v67, v56, v57
    v_and_or_b32 v66, v66, -2, s22
    v_mfma_f32_16x16x32_bf16 v[46:49], v[38:41], v[18:21], v[46:49]
    ds_read_b128 v[38:41], v2 offset:20480
    v_cvt_pk_bf16_f32 v68, v58, v59
    s_waitcnt lgkmcnt(3)
    v_mfma_f32_16x16x32_bf16 v[50:53], v[42:45], v[10:13], 0
    ds_read_b128 v[42:45], v2 offset:21504
    v_cvt_pk_bf16_f32 v69, v60, v61
    buffer_store_dwordx4 v[66:69], v4, s[4:7], s32 offen
    v_mfma_f32_16x16x32_bf16 v[50:53], v[74:77], v[14:17], v[50:53]
    ds_read_b128 v[74:77], v2 offset:22528
    v_mfma_f32_16x16x32_bf16 v[50:53], v[78:81], v[18:21], v[50:53]
    ds_read_b128 v[78:81], v2 offset:23552
    s_waitcnt lgkmcnt(3)
    v_mfma_f32_16x16x32_bf16 v[54:57], v[30:33], v[10:13], 0
    ds_read_b128 v[30:33], v2 offset:24576
    v_cvt_pk_bf16_f32 v62, v46, v47
    v_mfma_f32_16x16x32_bf16 v[54:57], v[34:37], v[14:17], v[54:57]
    ds_read_b128 v[34:37], v2 offset:25600
    v_cvt_pk_bf16_f32 v63, v48, v49
    v_and_or_b32 v62, v62, -2, s22
    v_mfma_f32_16x16x32_bf16 v[54:57], v[38:41], v[18:21], v[54:57]
    ds_read_b128 v[38:41], v2 offset:26624
    v_cvt_pk_bf16_f32 v64, v50, v51
    s_waitcnt lgkmcnt(3)
    v_mfma_f32_16x16x32_bf16 v[58:61], v[42:45], v[10:13], 0
    ds_read_b128 v[42:45], v2 offset:27648
    v_cvt_pk_bf16_f32 v65, v52, v53
    buffer_store_dwordx4 v[62:65], v5, s[4:7], s32 offen
    v_mfma_f32_16x16x32_bf16 v[58:61], v[74:77], v[14:17], v[58:61]
    ds_read_b128 v[74:77], v2 offset:28672
    v_mfma_f32_16x16x32_bf16 v[58:61], v[78:81], v[18:21], v[58:61]
    ds_read_b128 v[78:81], v2 offset:29696
    s_waitcnt lgkmcnt(3)
    v_mfma_f32_16x16x32_bf16 v[46:49], v[30:33], v[10:13], 0
    v_cvt_pk_bf16_f32 v66, v54, v55
    v_mfma_f32_16x16x32_bf16 v[46:49], v[34:37], v[14:17], v[46:49]
    v_cvt_pk_bf16_f32 v67, v56, v57
    v_and_or_b32 v66, v66, -2, s22
    v_mfma_f32_16x16x32_bf16 v[46:49], v[38:41], v[18:21], v[46:49]
    v_cvt_pk_bf16_f32 v68, v58, v59
    s_waitcnt lgkmcnt(0)
    v_mfma_f32_16x16x32_bf16 v[50:53], v[42:45], v[10:13], 0
    v_cvt_pk_bf16_f32 v69, v60, v61
    buffer_store_dwordx4 v[66:69], v6, s[4:7], s32 offen
    v_mfma_f32_16x16x32_bf16 v[50:53], v[74:77], v[14:17], v[50:53]
    v_mfma_f32_16x16x32_bf16 v[50:53], v[78:81], v[18:21], v[50:53]
    s_nop 0
    v_cvt_pk_bf16_f32 v62, v46, v47
    v_cvt_pk_bf16_f32 v63, v48, v49
    v_and_or_b32 v62, v62, -2, s22
    s_nop 3
    v_cvt_pk_bf16_f32 v64, v50, v51
    v_cvt_pk_bf16_f32 v65, v52, v53
    buffer_store_dwordx4 v[62:65], v7, s[4:7], s32 offen
    v_accvgpr_read_b32 v78, a252
    v_accvgpr_read_b32 v79, a253
    v_accvgpr_read_b32 v80, a254
    v_accvgpr_read_b32 v81, a255
    s_mov_b32 s19, 0
    s_waitcnt vmcnt(0)
    buffer_load_dwordx4 v[26:29], v8, s[4:7], s32 offen offset:0 sc1
    buffer_load_dwordx4 v[30:33], v8, s[4:7], s32 offen offset:2560 sc1
    buffer_load_dwordx4 v[34:37], v8, s[4:7], s33 offen offset:0 sc1
    buffer_load_dwordx4 v[38:41], v8, s[4:7], s33 offen offset:2560 sc1
    buffer_load_dwordx4 v[42:45], v8, s[4:7], s34 offen offset:0 sc1
    buffer_load_dwordx4 v[46:49], v8, s[4:7], s34 offen offset:2560 sc1
    buffer_load_dwordx4 v[50:53], v8, s[4:7], s35 offen offset:0 sc1
    buffer_load_dwordx4 v[54:57], v8, s[4:7], s35 offen offset:2560 sc1
L_Rf0_hb_8:
    s_waitcnt vmcnt(7)
    v_mfma_f32_16x16x32_bf16 v[70:73], a[248:251], v[26:29], 0
    v_xor_b32 v1, s44, v26
    s_waitcnt vmcnt(6)
    v_mfma_f32_16x16x32_bf16 v[70:73], a[248:251], v[30:33], v[70:73]
    v_bitop3_b32 v1, v1, v30, s44 bitop3:0xf6
    s_waitcnt vmcnt(5)
    v_mfma_f32_16x16x32_bf16 v[70:73], a[248:251], v[34:37], v[70:73]
    v_bitop3_b32 v1, v1, v34, s44 bitop3:0xf6
    s_waitcnt vmcnt(4)
    v_mfma_f32_16x16x32_bf16 v[70:73], a[248:251], v[38:41], v[70:73]
    v_bitop3_b32 v1, v1, v38, s44 bitop3:0xf6
    s_waitcnt vmcnt(3)
    v_mfma_f32_16x16x32_bf16 v[70:73], a[248:251], v[42:45], v[70:73]
    v_bitop3_b32 v1, v1, v42, s44 bitop3:0xf6
    s_waitcnt vmcnt(2)
    v_mfma_f32_16x16x32_bf16 v[70:73], a[248:251], v[46:49], v[70:73]
    v_bitop3_b32 v1, v1, v46, s44 bitop3:0xf6
    s_waitcnt vmcnt(1)
    v_mfma_f32_16x16x32_bf16 v[70:73], a[248:251], v[50:53], v[70:73]
    v_bitop3_b32 v1, v1, v50, s44 bitop3:0xf6
    s_waitcnt vmcnt(0)
    v_mfma_f32_16x16x32_bf16 v[70:73], a[248:251], v[54:57], v[70:73]
    v_bitop3_b32 v1, v1, v54, s44 bitop3:0xf6
    v_and_b32 v1, 1, v1
    v_cmp_ne_u32 vcc, 0, v1
    s_nop 0
    s_cbranch_vccnz L_Rf0_hbfix_9
    s_nop 2
    v_cvt_pk_bf16_f32 v74, v70, v71
    v_cvt_pk_bf16_f32 v75, v72, v73
    v_mov_b32 v76, v74
    v_mov_b32 v77, v75
    s_nop 0
    v_permlane16_swap_b32 v74, v76
    v_permlane16_swap_b32 v75, v77
    v_cndmask_b32 v74, v74, v78, s[42:43]
    v_cndmask_b32 v75, v75, v79, s[42:43]
    v_cndmask_b32 v76, v76, v80, s[42:43]
    v_cndmask_b32 v77, v77, v81, s[42:43]
    v_and_or_b32 v74, v74, -2, s24
    s_mov_b64 exec, s[46:47]
    buffer_store_dwordx4 v[74:77], v9, s[4:7], s36 offen
    buffer_store_dwordx4 v[74:77], v9, s[4:7], s37 offen sc1
    s_mov_b64 exec, -1
    s_add_u32 s60, s20, 1
    s_and_b32 s22, s60, 1
    s_lshl_b32 s21, s22, 31
    s_sub_u32 s44, 0, s22
    s_bfe_u32 s23, s20, 0x10001
    s_sub_u32 s23, s23, 1
    s_lshr_b32 s24, s60, 1
    s_andn2_b32 s24, 1, s24
    s_lshl_b32 s61, s14, 15
    s_add_u32 s61, s61, 1179648
    s_and_b32 s25, s20, 1
    s_lshl_b32 s25, s25, 16
    s_add_u32 s25, s25, s61
    s_add_u32 s25, s25, 0
    s_add_u32 s26, s25, 4096
    s_lshl_b32 s36, s22, 16
    s_add_u32 s36, s36, s61
    s_lshl_b32 s27, s20, 1
    s_add_u32 s37, s27, 2
    s_add_u32 s37, s37, s14
    s_mul_i32 s37, s37, 20480
    s_add_u32 s37, s37, 2621440
    s_add_u32 s27, s27, 1
    s_sub_u32 s27, s27, s14
    s_mul_i32 s27, s27, 20480
    s_add_u32 s27, s27, 2621440
    s_add_u32 s28, s27, 4096
    s_lshl_b32 s31, s20, 6
    s_add_u32 s31, s31, s13
    s_mul_i32 s31, s31, 6144
    s_add_u32 s31, s31, 5898240
    s_min_u32 s56, s20, 63
    s_lshl_b32 s56, s56, 6
    s_add_u32 s56, s56, s13
    s_mul_i32 s56, s56, 12288
    s_add_u32 s56, s56, 37361664
    s_max_u32 s57, s20, 7
    s_sub_u32 s57, s57, 7
    s_lshl_b32 s57, s57, 6
    s_add_u32 s57, s57, s13
    s_mul_i32 s57, s57, 12288
    s_add_u32 s57, s57, 87693312
    s_cmp_lt_u32 s20, 7
    s_cselect_b32 s57, s56, s57
    s_cmp_gt_u32 s60, 63
    s_cselect_b64 s[42:43], s[38:39], 0
    s_cmp_le_u32 s60, 7
    s_cselect_b64 vcc, s[40:41], 0
    s_or_b64 s[42:43], s[42:43], vcc
    s_waitcnt vmcnt(1)
    s_branch L_Rf0_top
L_Rf0_tail:
    s_waitcnt lgkmcnt(0)
    buffer_store_dwordx4 v[88:91], v0, s[4:7], s60 offen sc1
    s_waitcnt vmcnt(0) lgkmcnt(0)
    s_barrier
    v_mov_b32 v22, 71
    s_mov_b64 exec, 1
    s_mov_b64 exec, -1
    s_waitcnt vmcnt(0)
    s_endpgm
L_Rf0_glfix_3:
    buffer_load_dwordx4 v[10:13], v0, s[4:7], s25 offen offset:0 sc1
    buffer_load_dwordx4 v[14:17], v0, s[4:7], s25 offen offset:1024 sc1
    buffer_load_dwordx4 v[18:21], v0, s[4:7], s25 offen offset:2048 sc1
    buffer_load_dwordx4 v[22:25], v0, s[4:7], s25 offen offset:3072 sc1
    buffer_load_dwordx4 v[26:29], v0, s[4:7], s26 offen offset:0 sc1
    buffer_load_dwordx4 v[46:49], v0, s[4:7], s27 offen offset:0 sc1
    buffer_load_dwordx4 v[30:33], v0, s[4:7], s27 offen offset:1024 sc1
    buffer_load_dwordx4 v[34:37], v0, s[4:7], s27 offen offset:2048 sc1
    buffer_load_dwordx4 v[38:41], v0, s[4:7], s27 offen offset:3072 sc1
    buffer_load_dwordx4 v[42:45], v0, s[4:7], s28 offen offset:0 sc1
    s_add_u32 s19, s19, 1
    s_cmp_lt_u32 s19, 524288
    s_cbranch_scc1 L_Rf0_gl_1
    s_branch L_fail
L_Rf0_grfix_5:
    buffer_load_dwordx4 v[46:49], v0, s[4:7], s27 offen offset:0 sc1
    buffer_load_dwordx4 v[30:33], v0, s[4:7], s27 offen offset:1024 sc1
    buffer_load_dwordx4 v[34:37], v0, s[4:7], s27 offen offset:2048 sc1
    buffer_load_dwordx4 v[38:41], v0, s[4:7], s27 offen offset:3072 sc1
    buffer_load_dwordx4 v[42:45], v0, s[4:7], s28 offen offset:0 sc1
    s_add_u32 s19, s19, 1
    s_cmp_lt_u32 s19, 524288
    s_cbranch_scc1 L_Rf0_gr2_4
    s_branch L_fail
L_Rf0_gr2_4:
    v_mfma_f32_16x16x32_bf16 v[50:53], a[240:243], v[10:13], 0
    v_mfma_f32_16x16x32_bf16 v[54:57], a[244:247], v[10:13], 0
    v_mfma_f32_16x16x32_bf16 v[58:61], a[240:243], v[14:17], 0
    v_mfma_f32_16x16x32_bf16 v[62:65], a[244:247], v[14:17], 0
    v_mfma_f32_16x16x32_bf16 v[66:69], a[240:243], v[18:21], 0
    v_mfma_f32_16x16x32_bf16 v[70:73], a[244:247], v[18:21], 0
    v_mfma_f32_16x16x32_bf16 v[74:77], a[240:243], v[22:25], 0
    v_mfma_f32_16x16x32_bf16 v[78:81], a[244:247], v[22:25], 0
    v_mfma_f32_16x16x32_bf16 v[82:85], a[240:243], v[26:29], 0
    v_mfma_f32_16x16x32_bf16 v[86:89], a[244:247], v[26:29], 0
    s_branch L_Rf0_gr_2
L_Rf0_hafix_7:
    buffer_load_dwordx4 v[82:85], v0, s[4:7], s30 offen sc1
    s_add_u32 s19, s19, 1
    s_cmp_lt_u32 s19, 524288
    s_cbranch_scc1 L_Rf0_ha_6
    s_branch L_fail
L_Rf0_hbfix_9:
    buffer_load_dwordx4 v[26:29], v8, s[4:7], s32 offen offset:0 sc1
    buffer_load_dwordx4 v[30:33], v8, s[4:7], s32 offen offset:2560 sc1
    buffer_load_dwordx4 v[34:37], v8, s[4:7], s33 offen offset:0 sc1
    buffer_load_dwordx4 v[38:41], v8, s[4:7], s33 offen offset:2560 sc1
    buffer_load_dwordx4 v[42:45], v8, s[4:7], s34 offen offset:0 sc1
    buffer_load_dwordx4 v[46:49], v8, s[4:7], s34 offen offset:2560 sc1
    buffer_load_dwordx4 v[50:53], v8, s[4:7], s35 offen offset:0 sc1
    buffer_load_dwordx4 v[54:57], v8, s[4:7], s35 offen offset:2560 sc1
    s_add_u32 s19, s19, 1
    s_cmp_lt_u32 s19, 524288
    s_cbranch_scc1 L_Rf0_hb_8
    s_branch L_fail
L_R0_slow:
L_Rs0_top:
    s_barrier
    buffer_load_dwordx4 v[10:13], v0, s[4:7], s25 offen offset:0 sc1
    buffer_load_dwordx4 v[14:17], v0, s[4:7], s25 offen offset:1024 sc1
    buffer_load_dwordx4 v[18:21], v0, s[4:7], s25 offen offset:2048 sc1
    buffer_load_dwordx4 v[22:25], v0, s[4:7], s25 offen offset:3072 sc1
    buffer_load_dwordx4 v[26:29], v0, s[4:7], s26 offen offset:0 sc1
    s_barrier
    buffer_load_dwordx4 v[46:49], v0, s[4:7], s27 offen offset:0 sc1
    buffer_load_dwordx4 v[30:33], v0, s[4:7], s27 offen offset:1024 sc1
    buffer_load_dwordx4 v[34:37], v0, s[4:7], s27 offen offset:2048 sc1
    buffer_load_dwordx4 v[38:41], v0, s[4:7], s27 offen offset:3072 sc1
    buffer_load_dwordx4 v[42:45], v0, s[4:7], s28 offen offset:0 sc1
    s_mov_b32 s19, 0
L_Rs0_gl_1:
    s_waitcnt vmcnt(9)
    v_mfma_f32_16x16x32_bf16 v[50:53], a[240:243], v[10:13], 0
    v_mfma_f32_16x16x32_bf16 v[54:57], a[244:247], v[10:13], 0
    v_xor_b32 v1, s23, v10
    s_waitcnt vmcnt(8)
    v_mfma_f32_16x16x32_bf16 v[58:61], a[240:243], v[14:17], 0
    v_mfma_f32_16x16x32_bf16 v[62:65], a[244:247], v[14:17], 0
    v_bitop3_b32 v1, v1, v14, s23 bitop3:0xf6
    s_waitcnt vmcnt(7)
    v_mfma_f32_16x16x32_bf16 v[66:69], a[240:243], v[18:21], 0
    v_mfma_f32_16x16x32_bf16 v[70:73], a[244:247], v[18:21], 0
    v_bitop3_b32 v1, v1, v18, s23 bitop3:0xf6
    s_waitcnt vmcnt(6)
    v_mfma_f32_16x16x32_bf16 v[74:77], a[240:243], v[22:25], 0
    v_mfma_f32_16x16x32_bf16 v[78:81], a[244:247], v[22:25], 0
    v_bitop3_b32 v1, v1, v22, s23 bitop3:0xf6
    s_waitcnt vmcnt(5)
    v_mfma_f32_16x16x32_bf16 v[82:85], a[240:243], v[26:29], 0
    v_mfma_f32_16x16x32_bf16 v[86:89], a[244:247], v[26:29], 0
    v_bitop3_b32 v1, v1, v26, s23 bitop3:0xf6
    v_and_b32 v1, 1, v1
    v_cmp_ne_u32 vcc, 0, v1
    s_nop 0
    s_cbranch_vccnz L_Rs0_glfix_3
L_Rs0_gr_2:
    s_waitcnt vmcnt(4)
    v_mfma_f32_16x16x32_bf16 v[50:53], a[240:243], v[46:49], v[50:53]
    v_xor_b32 v1, s23, v46
    v_mfma_f32_16x16x32_bf16 v[54:57], a[244:247], v[46:49], v[54:57]
    s_waitcnt vmcnt(3)
    v_mfma_f32_16x16x32_bf16 v[58:61], a[240:243], v[30:33], v[58:61]
    v_bitop3_b32 v1, v1, v30, s23 bitop3:0xf6
    v_mfma_f32_16x16x32_bf16 v[62:65], a[244:247], v[30:33], v[62:65]
    s_nop 1
    v_cvt_pk_bf16_f32 v90, v50, v51
    v_cvt_pk_bf16_f32 v91, v52, v53
    v_cvt_pk_bf16_f32 v92, v54, v55
    v_cvt_pk_bf16_f32 v93, v56, v57
    ds_write_b128 v0, v[90:93] offset:0
    s_waitcnt vmcnt(2)
    v_mfma_f32_16x16x32_bf16 v[66:69], a[240:243], v[34:37], v[66:69]
    v_bitop3_b32 v1, v1, v34, s23 bitop3:0xf6
    v_mfma_f32_16x16x32_bf16 v[70:73], a[244:247], v[34:37], v[70:73]
    v_cvt_pk_bf16_f32 v90, v58, v59
    v_cvt_pk_bf16_f32 v91, v60, v61
    v_cvt_pk_bf16_f32 v92, v62, v63
    v_cvt_pk_bf16_f32 v93, v64, v65
    ds_write_b128 v0, v[90:93] offset:1024
    s_waitcnt vmcnt(1)
    v_mfma_f32_16x16x32_bf16 v[74:77], a[240:243], v[38:41], v[74:77]
    v_bitop3_b32 v1, v1, v38, s23 bitop3:0xf6
    v_mfma_f32_16x16x32_bf16 v[78:81], a[244:247], v[38:41], v[78:81]
    v_cvt_pk_bf16_f32 v90, v66, v67
    v_cvt_pk_bf16_f32 v91, v68, v69
    v_cvt_pk_bf16_f32 v92, v70, v71
    v_cvt_pk_bf16_f32 v93, v72, v73
    ds_write_b128 v0, v[90:93] offset:2048
    s_waitcnt vmcnt(0)
    v_mfma_f32_16x16x32_bf16 v[82:85], a[240:243], v[42:45], v[82:85]
    v_bitop3_b32 v1, v1, v42, s23 bitop3:0xf6
    v_mfma_f32_16x16x32_bf16 v[86:89], a[244:247], v[42:45], v[86:89]
    v_cvt_pk_bf16_f32 v90, v74, v75
    v_cvt_pk_bf16_f32 v91, v76, v77
    v_cvt_pk_bf16_f32 v92, v78, v79
    v_cvt_pk_bf16_f32 v93, v80, v81
    ds_write_b128 v0, v[90:93] offset:3072
    s_nop 0
    v_cvt_pk_bf16_f32 v90, v82, v83
    v_cvt_pk_bf16_f32 v91, v84, v85
    v_cvt_pk_bf16_f32 v92, v86, v87
    v_cvt_pk_bf16_f32 v93, v88, v89
    ds_write_b128 v0, v[90:93] offset:4096
    v_and_b32 v1, 1, v1
    v_cmp_ne_u32 vcc, 0, v1
    s_nop 0
    s_cbranch_vccnz L_Rs0_grfix_5
    s_waitcnt lgkmcnt(0)
    s_barrier
    ds_read_b128 v[10:13], v0 offset:0
    ds_read_b128 v[14:17], v0 offset:1024
    ds_read_b128 v[18:21], v0 offset:2048
    ds_read_b128 v[22:25], v0 offset:3072
    ds_read_b128 v[26:29], v0 offset:4096
    s_waitcnt lgkmcnt(4)
    v_mfma_f32_16x16x32_bf16 v[46:49], a[0:3], v[10:13], 0
    s_mov_b32 m0, 35840
    v_mfma_f32_16x16x32_bf16 v[50:53], a[80:83], v[10:13], 0
    v_mfma_f32_16x16x32_bf16 v[54:57], a[160:163], v[10:13], 0
    ds_read_b128 v[10:13], v0 offset:5120
    s_waitcnt lgkmcnt(4)
    v_mfma_f32_16x16x32_bf16 v[46:49], a[4:7], v[14:17], v[46:49]
    buffer_load_dwordx4 v0, s[4:7], s56 offen offset:0 sc1 lds
    v_mfma_f32_16x16x32_bf16 v[50:53], a[84:87], v[14:17], v[50:53]
    v_mfma_f32_16x16x32_bf16 v[54:57], a[164:167], v[14:17], v[54:57]
    ds_read_b128 v[14:17], v0 offset:6144
    s_waitcnt lgkmcnt(4)
    v_mfma_f32_16x16x32_bf16 v[46:49], a[8:11], v[18:21], v[46:49]
    buffer_load_dwordx4 v0, s[4:7], s56 offen offset:1024 sc1 lds
    v_mfma_f32_16x16x32_bf16 v[50:53], a[88:91], v[18:21], v[50:53]
    v_mfma_f32_16x16x32_bf16 v[54:57], a[168:171], v[18:21], v[54:57]
    ds_read_b128 v[18:21], v0 offset:7168
    s_waitcnt lgkmcnt(4)
    v_mfma_f32_16x16x32_bf16 v[46:49], a[12:15], v[22:25], v[46:49]
    buffer_load_dwordx4 v0, s[4:7], s56 offen offset:2048 sc1 lds
    v_mfma_f32_16x16x32_bf16 v[50:53], a[92:95], v[22:25], v[50:53]
    v_mfma_f32_16x16x32_bf16 v[54:57], a[172:175], v[22:25], v[54:57]
    ds_read_b128 v[22:25], v0 offset:8192
    s_waitcnt lgkmcnt(4)
    v_mfma_f32_16x16x32_bf16 v[46:49], a[16:19], v[26:29], v[46:49]
    v_mfma_f32_16x16x32_bf16 v[50:53], a[96:99], v[26:29], v[50:53]
    v_mfma_f32_16x16x32_bf16 v[54:57], a[176:179], v[26:29], v[54:57]
    ds_read_b128 v[26:29], v0 offset:9216
    s_waitcnt lgkmcnt(4)
    v_mfma_f32_16x16x32_bf16 v[46:49], a[20:23], v[10:13], v[46:49]
    v_mfma_f32_16x16x32_bf16 v[50:53], a[100:103], v[10:13], v[50:53]
    v_mfma_f32_16x16x32_bf16 v[54:57], a[180:183], v[10:13], v[54:57]
    ds_read_b128 v[10:13], v0 offset:10240
    s_waitcnt lgkmcnt(4)
    v_mfma_f32_16x16x32_bf16 v[46:49], a[24:27], v[14:17], v[46:49]
    v_mfma_f32_16x16x32_bf16 v[50:53], a[104:107], v[14:17], v[50:53]
    v_mfma_f32_16x16x32_bf16 v[54:57], a[184:187], v[14:17], v[54:57]
    ds_read_b128 v[14:17], v0 offset:11264
    s_waitcnt lgkmcnt(4)
    v_mfma_f32_16x16x32_bf16 v[46:49], a[28:31], v[18:21], v[46:49]
    v_mfma_f32_16x16x32_bf16 v[50:53], a[108:111], v[18:21], v[50:53]
    v_mfma_f32_16x16x32_bf16 v[54:57], a[188:191], v[18:21], v[54:57]
    ds_read_b128 v[18:21], v0 offset:12288
    s_waitcnt lgkmcnt(4)
    v_mfma_f32_16x16x32_bf16 v[46:49], a[32:35], v[22:25], v[46:49]
    v_mfma_f32_16x16x32_bf16 v[50:53], a[112:115], v[22:25], v[50:53]
    v_mfma_f32_16x16x32_bf16 v[54:57], a[192:195], v[22:25], v[54:57]
    ds_read_b128 v[22:25], v0 offset:13312
    s_waitcnt lgkmcnt(4)
    v_mfma_f32_16x16x32_bf16 v[46:49], a[36:39], v[26:29], v[46:49]
    v_mfma_f32_16x16x32_bf16 v[50:53], a[116:119], v[26:29], v[50:53]
    v_mfma_f32_16x16x32_bf16 v[54:57], a[196:199], v[26:29], v[54:57]
    ds_read_b128 v[26:29], v0 offset:14336
    s_waitcnt lgkmcnt(4)
    v_mfma_f32_16x16x32_bf16 v[46:49], a[40:43], v[10:13], v[46:49]
    v_mfma_f32_16x16x32_bf16 v[50:53], a[120:123], v[10:13], v[50:53]
    v_mfma_f32_16x16x32_bf16 v[54:57], a[200:203], v[10:13], v[54:57]
    ds_read_b128 v[10:13], v0 offset:15360
    s_waitcnt lgkmcnt(4)
    v_mfma_f32_16x16x32_bf16 v[46:49], a[44:47], v[14:17], v[46:49]
    v_mfma_f32_16x16x32_bf16 v[50:53], a[124:127], v[14:17], v[50:53]
    v_mfma_f32_16x16x32_bf16 v[54:57], a[204:207], v[14:17], v[54:57]
    ds_read_b128 v[14:17], v0 offset:16384
    s_waitcnt lgkmcnt(4)
    v_mfma_f32_16x16x32_bf16 v[46:49], a[48:51], v[18:21], v[46:49]
    v_mfma_f32_16x16x32_bf16 v[50:53], a[128:131], v[18:21], v[50:53]
    v_mfma_f32_16x16x32_bf16 v[54:57], a[208:211], v[18:21], v[54:57]
    ds_read_b128 v[18:21], v0 offset:17408
    s_waitcnt lgkmcnt(4)
    v_mfma_f32_16x16x32_bf16 v[46:49], a[52:55], v[22:25], v[46:49]
    v_mfma_f32_16x16x32_bf16 v[50:53], a[132:135], v[22:25], v[50:53]
    v_mfma_f32_16x16x32_bf16 v[54:57], a[212:215], v[22:25], v[54:57]
    ds_read_b128 v[22:25], v0 offset:18432
    s_waitcnt lgkmcnt(4)
    v_mfma_f32_16x16x32_bf16 v[46:49], a[56:59], v[26:29], v[46:49]
    v_mfma_f32_16x16x32_bf16 v[50:53], a[136:139], v[26:29], v[50:53]
    v_mfma_f32_16x16x32_bf16 v[54:57], a[216:219], v[26:29], v[54:57]
    ds_read_b128 v[26:29], v0 offset:19456
    s_waitcnt lgkmcnt(4)
    v_mfma_f32_16x16x32_bf16 v[46:49], a[60:63], v[10:13], v[46:49]
    v_mfma_f32_16x16x32_bf16 v[50:53], a[140:143], v[10:13], v[50:53]
    v_mfma_f32_16x16x32_bf16 v[54:57], a[220:223], v[10:13], v[54:57]
    ds_read_b128 v[10:13], v0 offset:0
    s_waitcnt lgkmcnt(4)
    v_mfma_f32_16x16x32_bf16 v[46:49], a[64:67], v[14:17], v[46:49]
    v_mfma_f32_16x16x32_bf16 v[50:53], a[144:147], v[14:17], v[50:53]
    v_mfma_f32_16x16x32_bf16 v[54:57], a[224:227], v[14:17], v[54:57]
    ds_read_b128 v[14:17], v0 offset:1024
    s_waitcnt lgkmcnt(4)
    v_mfma_f32_16x16x32_bf16 v[46:49], a[68:71], v[18:21], v[46:49]
    v_mfma_f32_16x16x32_bf16 v[50:53], a[148:151], v[18:21], v[50:53]
    v_mfma_f32_16x16x32_bf16 v[54:57], a[228:231], v[18:21], v[54:57]
    ds_read_b128 v[18:21], v0 offset:2048
    s_waitcnt lgkmcnt(4)
    v_mfma_f32_16x16x32_bf16 v[46:49], a[72:75], v[22:25], v[46:49]
    v_mfma_f32_16x16x32_bf16 v[50:53], a[152:155], v[22:25], v[50:53]
    v_mfma_f32_16x16x32_bf16 v[54:57], a[232:235], v[22:25], v[54:57]
    ds_read_b128 v[22:25], v0 offset:3072
    s_waitcnt lgkmcnt(4)
    v_mfma_f32_16x16x32_bf16 v[46:49], a[76:79], v[26:29], v[46:49]
    v_mfma_f32_16x16x32_bf16 v[50:53], a[156:159], v[26:29], v[50:53]
    v_mfma_f32_16x16x32_bf16 v[54:57], a[236:239], v[26:29], v[54:57]
    ds_read_b128 v[26:29], v0 offset:4096
    s_waitcnt lgkmcnt(4)
    v_mfma_f32_16x16x32_bf16 v[30:33], v[10:13], v[96:99], 0
    v_mfma_f32_16x16x32_bf16 v[34:37], v[10:13], v[176:179], 0
    ds_read_b128 v[10:13], v0 offset:5120
    s_nop 0
    v_cvt_pk_bf16_f32 v82, v46, v47
    v_cvt_pk_bf16_f32 v83, v48, v49
    ds_write_b64 v0, v[82:83] offset:20480
    v_cvt_pk_bf16_f32 v84, v50, v51
    v_cvt_pk_bf16_f32 v85, v52, v53
    ds_write_b64 v0, v[84:85] offset:20488
    v_cvt_pk_bf16_f32 v86, v54, v55
    v_cvt_pk_bf16_f32 v87, v56, v57
    ds_write_b64 v0, v[86:87] offset:21504
    s_waitcnt lgkmcnt(7)
    v_mfma_f32_16x16x32_bf16 v[30:33], v[14:17], v[100:103], v[30:33]
    v_mfma_f32_16x16x32_bf16 v[34:37], v[14:17], v[180:183], v[34:37]
    ds_read_b128 v[14:17], v0 offset:6144
    s_waitcnt lgkmcnt(1)
    s_barrier
    ds_read_b128 v[58:61], v0 offset:23552
    ds_read_b128 v[46:49], v0 offset:20480
    ds_read_b128 v[62:65], v0 offset:24576
    ds_read_b128 v[50:53], v0 offset:21504
    ds_read_b128 v[66:69], v0 offset:25600
    ds_read_b128 v[54:57], v0 offset:22528
    v_mfma_f32_16x16x32_bf16 v[30:33], v[18:21], v[104:107], v[30:33]
    v_mfma_f32_16x16x32_bf16 v[34:37], v[18:21], v[184:187], v[34:37]
    ds_read_b128 v[18:21], v0 offset:7168
    v_mfma_f32_16x16x32_bf16 v[30:33], v[22:25], v[108:111], v[30:33]
    v_mfma_f32_16x16x32_bf16 v[34:37], v[22:25], v[188:191], v[34:37]
    ds_read_b128 v[22:25], v0 offset:8192
    s_waitcnt lgkmcnt(6)
    v_mfma_f32_16x16x32_bf16 v[38:41], v[58:61], v[46:49], 0
    s_waitcnt lgkmcnt(4)
    v_mfma_f32_16x16x32_bf16 v[38:41], v[62:65], v[50:53], v[38:41]
    s_waitcnt lgkmcnt(2)
    v_mfma_f32_16x16x32_bf16 v[38:41], v[66:69], v[54:57], v[38:41]
    v_mfma_f32_16x16x32_bf16 v[30:33], v[26:29], v[112:115], v[30:33]
    v_mfma_f32_16x16x32_bf16 v[34:37], v[26:29], v[192:195], v[34:37]
    ds_read_b128 v[26:29], v0 offset:9216
    s_nop 4
    v_and_or_b32 v38, v38, -2, s22
    buffer_store_dwordx4 v[38:41], v0, s[4:7], s29 offen sc1
    v_mfma_f32_16x16x32_bf16 v[30:33], v[10:13], v[116:119], v[30:33]
    v_mfma_f32_16x16x32_bf16 v[34:37], v[10:13], v[196:199], v[34:37]
    ds_read_b128 v[10:13], v0 offset:10240
    v_mfma_f32_16x16x32_bf16 v[30:33], v[14:17], v[120:123], v[30:33]
    v_mfma_f32_16x16x32_bf16 v[34:37], v[14:17], v[200:203], v[34:37]
    ds_read_b128 v[14:17], v0 offset:11264
    s_waitcnt lgkmcnt(4)
    v_mfma_f32_16x16x32_bf16 v[30:33], v[18:21], v[124:127], v[30:33]
    v_mfma_f32_16x16x32_bf16 v[34:37], v[18:21], v[204:207], v[34:37]
    ds_read_b128 v[18:21], v0 offset:12288
    s_waitcnt lgkmcnt(4)
    v_mfma_f32_16x16x32_bf16 v[30:33], v[22:25], v[128:131], v[30:33]
    v_mfma_f32_16x16x32_bf16 v[34:37], v[22:25], v[208:211], v[34:37]
    ds_read_b128 v[22:25], v0 offset:13312
    s_waitcnt lgkmcnt(4)
    v_mfma_f32_16x16x32_bf16 v[30:33], v[26:29], v[132:135], v[30:33]
    v_mfma_f32_16x16x32_bf16 v[34:37], v[26:29], v[212:215], v[34:37]
    ds_read_b128 v[26:29], v0 offset:14336
    s_waitcnt lgkmcnt(4)
    v_mfma_f32_16x16x32_bf16 v[30:33], v[10:13], v[136:139], v[30:33]
    v_mfma_f32_16x16x32_bf16 v[34:37], v[10:13], v[216:219], v[34:37]
    ds_read_b128 v[10:13], v0 offset:15360
    s_waitcnt lgkmcnt(4)
    v_mfma_f32_16x16x32_bf16 v[30:33], v[14:17], v[140:143], v[30:33]
    v_mfma_f32_16x16x32_bf16 v[34:37], v[14:17], v[220:223], v[34:37]
    ds_read_b128 v[14:17], v0 offset:16384
    s_waitcnt lgkmcnt(4)
    v_mfma_f32_16x16x32_bf16 v[30:33], v[18:21], v[144:147], v[30:33]
    v_mfma_f32_16x16x32_bf16 v[34:37], v[18:21], v[224:227], v[34:37]
    ds_read_b128 v[18:21], v0 offset:17408
    s_waitcnt lgkmcnt(4)
    v_mfma_f32_16x16x32_bf16 v[30:33], v[22:25], v[148:151], v[30:33]
    v_mfma_f32_16x16x32_bf16 v[34:37], v[22:25], v[228:231], v[34:37]
    ds_read_b128 v[22:25], v0 offset:18432
    v_pk_mul_f32 v[42:43], v[38:39], s[52:53]
    v_pk_mul_f32 v[44:45], v[40:41], s[52:53]
    v_mov_b32 v1, 0xff800000
    v_cndmask_b32 v42, v1, v42, s[50:51]
    v_cndmask_b32 v43, v1, v43, s[50:51]
    v_cndmask_b32 v44, v1, v44, s[50:51]
    v_cndmask_b32 v45, v1, v45, s[50:51]
    s_waitcnt vmcnt(0)
    buffer_load_dwordx4 v[82:85], v0, s[4:7], s30 offen sc1
    s_mov_b32 s19, 0
    s_waitcnt lgkmcnt(4)
    v_mfma_f32_16x16x32_bf16 v[30:33], v[26:29], v[152:155], v[30:33]
    v_mfma_f32_16x16x32_bf16 v[34:37], v[26:29], v[232:235], v[34:37]
    ds_read_b128 v[26:29], v0 offset:19456
    s_waitcnt lgkmcnt(4)
    v_mfma_f32_16x16x32_bf16 v[30:33], v[10:13], v[156:159], v[30:33]
    v_mfma_f32_16x16x32_bf16 v[34:37], v[10:13], v[236:239], v[34:37]
    s_waitcnt lgkmcnt(3)
    v_mfma_f32_16x16x32_bf16 v[30:33], v[14:17], v[160:163], v[30:33]
    v_mfma_f32_16x16x32_bf16 v[34:37], v[14:17], v[240:243], v[34:37]
    s_waitcnt lgkmcnt(2)
    v_mfma_f32_16x16x32_bf16 v[30:33], v[18:21], v[164:167], v[30:33]
    v_mfma_f32_16x16x32_bf16 v[34:37], v[18:21], v[244:247], v[34:37]
    s_waitcnt lgkmcnt(1)
    v_mfma_f32_16x16x32_bf16 v[30:33], v[22:25], v[168:171], v[30:33]
    v_mfma_f32_16x16x32_bf16 v[34:37], v[22:25], v[248:251], v[34:37]
    s_waitcnt lgkmcnt(0)
    v_mfma_f32_16x16x32_bf16 v[30:33], v[26:29], v[172:175], v[30:33]
    v_mfma_f32_16x16x32_bf16 v[34:37], v[26:29], v[252:255], v[34:37]
    s_nop 6
    v_cvt_pk_bf16_f32 v88, v30, v31
    v_cvt_pk_bf16_f32 v89, v32, v33
    v_cvt_pk_bf16_f32 v90, v34, v35
    v_cvt_pk_bf16_f32 v91, v36, v37
    s_add_u32 s60, s31, 3072
    s_cmp_eq_u32 s20, 70
    s_cbranch_scc1 L_Rs0_tail
L_Rs0_ha_6:
    s_waitcnt vmcnt(0)
    v_lshlrev_b32 v1, 31, v82
    v_pk_fma_f32 v[38:39], v[82:83], s[52:53], v[42:43]
    v_pk_fma_f32 v[40:41], v[84:85], s[52:53], v[44:45]
    ds_write_b128 v0, v[38:41] offset:26624
    v_cmp_ne_u32 vcc, s21, v1
    s_nop 0
    s_cbranch_vccnz L_Rs0_hafix_7
    s_waitcnt vmcnt(0) lgkmcnt(0)
    s_barrier
    ds_read_b128 v[10:13], v0 offset:26624
    ds_read_b128 v[14:17], v0 offset:27648
    ds_read_b128 v[18:21], v0 offset:28672
    ds_read_b128 v[58:61], v0 offset:35840
    ds_read_b128 v[62:65], v0 offset:36864
    ds_read_b128 v[66:69], v0 offset:48128
    ds_read_b128 v[70:73], v0 offset:49152
    buffer_store_dwordx4 v[88:91], v0, s[4:7], s60 offen sc1
    s_waitcnt lgkmcnt(5)
    v_max3_f32 v22, v10, v11, v12
    v_max3_f32 v23, v13, v14, v15
    v_max3_f32 v22, v22, v16, v17
    s_waitcnt lgkmcnt(4)
    v_max3_f32 v23, v23, v18, v19
    v_max3_f32 v22, v22, v20, v21
    v_max_f32 v22, v22, v23
    v_mov_b32 v23, v22
    ds_read_b128 v[30:33], v2 offset:0
    ds_read_b128 v[34:37], v2 offset:1024
    v_permlane32_swap_b32 v22, v23
    v_max_f32 v22, v22, v23
    v_mov_b32 v23, v22
    ds_read_b128 v[38:41], v2 offset:2048
    ds_read_b128 v[42:45], v2 offset:3072
    v_permlane16_swap_b32 v22, v23
    v_max_f32 v22, v22, v23
    v_pk_add_f32 v[10:11], v[10:11], v[22:23] op_sel_hi:[1,0] neg_lo:[0,1] neg_hi:[0,1]
    v_pk_add_f32 v[12:13], v[12:13], v[22:23] op_sel_hi:[1,0] neg_lo:[0,1] neg_hi:[0,1]
    v_pk_add_f32 v[14:15], v[14:15], v[22:23] op_sel_hi:[1,0] neg_lo:[0,1] neg_hi:[0,1]
    v_pk_add_f32 v[16:17], v[16:17], v[22:23] op_sel_hi:[1,0] neg_lo:[0,1] neg_hi:[0,1]
    v_pk_add_f32 v[18:19], v[18:19], v[22:23] op_sel_hi:[1,0] neg_lo:[0,1] neg_hi:[0,1]
    v_pk_add_f32 v[20:21], v[20:21], v[22:23] op_sel_hi:[1,0] neg_lo:[0,1] neg_hi:[0,1]
    v_exp_f32 v10, v10
    v_exp_f32 v11, v11
    v_exp_f32 v12, v12
    v_exp_f32 v13, v13
    v_exp_f32 v14, v14
    v_exp_f32 v15, v15
    v_cvt_pk_bf16_f32 v24, v10, v11
    v_cvt_pk_bf16_f32 v25, v12, v13
    v_exp_f32 v16, v16
    v_exp_f32 v17, v17
    v_mfma_f32_16x16x16_bf16 v[46:49], v[88:89], v[24:25], 0
    v_mfma_f32_16x16x16_bf16 v[82:85], v[90:91], v[24:25], 0
    v_exp_f32 v18, v18
    v_exp_f32 v19, v19
    v_exp_f32 v20, v20
    v_exp_f32 v21, v21
    v_cvt_pk_bf16_f32 v26, v14, v15
    v_cvt_pk_bf16_f32 v27, v16, v17
    v_cvt_pk_bf16_f32 v28, v18, v19
    v_cvt_pk_bf16_f32 v29, v20, v21
    v_pk_add_f32 v[22:23], v[10:11], v[12:13]
    v_pk_add_f32 v[14:15], v[14:15], v[16:17]
    s_waitcnt lgkmcnt(4)
    v_mfma_f32_16x16x32_bf16 v[50:53], v[58:61], v[26:29], v[46:49]
    v_pk_add_f32 v[18:19], v[18:19], v[20:21]
    v_mfma_f32_16x16x32_bf16 v[54:57], v[66:69], v[26:29], v[46:49]
    v_pk_add_f32 v[22:23], v[22:23], v[14:15]
    v_pk_add_f32 v[22:23], v[22:23], v[18:19]
    v_mfma_f32_16x16x32_bf16 v[10:13], v[62:65], v[26:29], v[82:85]
    v_add_f32 v22, v22, v23
    v_mfma_f32_16x16x32_bf16 v[14:17], v[70:73], v[26:29], v[82:85]
    v_mov_b32 v23, v22
    ds_read_b128 v[74:77], v2 offset:4096
    ds_read_b128 v[78:81], v2 offset:5120
    v_permlane32_swap_b32 v22, v23
    v_add_f32 v22, v22, v23
    v_mov_b32 v23, v22
    v_cndmask_b32 v50, v54, v50, s[48:49]
    v_cndmask_b32 v51, v55, v51, s[48:49]
    v_permlane16_swap_b32 v22, v23
    v_add_f32 v22, v22, v23
    v_rcp_f32 v22, v22
    v_cndmask_b32 v52, v56, v52, s[48:49]
    v_cndmask_b32 v53, v57, v53, s[48:49]
    v_cndmask_b32 v10, v14, v10, s[48:49]
    v_cndmask_b32 v11, v15, v11, s[48:49]
    v_cndmask_b32 v12, v16, v12, s[48:49]
    v_cndmask_b32 v13, v17, v13, s[48:49]
    v_pk_mul_f32 v[50:51], v[50:51], v[22:23] op_sel_hi:[1,0]
    v_pk_mul_f32 v[52:53], v[52:53], v[22:23] op_sel_hi:[1,0]
    v_cvt_pk_bf16_f32 v24, v50, v51
    v_cvt_pk_bf16_f32 v25, v52, v53
    v_pk_mul_f32 v[10:11], v[10:11], v[22:23] op_sel_hi:[1,0]
    v_pk_mul_f32 v[12:13], v[12:13], v[22:23] op_sel_hi:[1,0]
    v_cvt_pk_bf16_f32 v26, v10, v11
    v_cvt_pk_bf16_f32 v27, v12, v13
    ds_write_b128 v0, v[24:27] offset:0
    s_waitcnt lgkmcnt(0)
    s_barrier
    ds_read_b128 v[10:13], v0 offset:0
    ds_read_b128 v[14:17], v0 offset:1024
    ds_read_b128 v[18:21], v0 offset:2048
    s_add_u32 s20, s20, 1
    s_waitcnt lgkmcnt(2)
    v_mfma_f32_16x16x32_bf16 v[46:49], v[30:33], v[10:13], 0
    ds_read_b128 v[30:33], v2 offset:6144
    s_waitcnt lgkmcnt(2)
    v_mfma_f32_16x16x32_bf16 v[46:49], v[34:37], v[14:17], v[46:49]
    ds_read_b128 v[34:37], v2 offset:7168
    s_waitcnt lgkmcnt(2)
    v_mfma_f32_16x16x32_bf16 v[46:49], v[38:41], v[18:21], v[46:49]
    ds_read_b128 v[38:41], v2 offset:8192
    v_mfma_f32_16x16x32_bf16 v[50:53], v[42:45], v[10:13], 0
    ds_read_b128 v[42:45], v2 offset:9216
    v_mfma_f32_16x16x32_bf16 v[50:53], v[74:77], v[14:17], v[50:53]
    ds_read_b128 v[74:77], v2 offset:10240
    v_mfma_f32_16x16x32_bf16 v[50:53], v[78:81], v[18:21], v[50:53]
    ds_read_b128 v[78:81], v2 offset:11264
    s_waitcnt lgkmcnt(3)
    v_mfma_f32_16x16x32_bf16 v[54:57], v[30:33], v[10:13], 0
    ds_read_b128 v[30:33], v2 offset:12288
    v_cvt_pk_bf16_f32 v62, v46, v47
    v_mfma_f32_16x16x32_bf16 v[54:57], v[34:37], v[14:17], v[54:57]
    ds_read_b128 v[34:37], v2 offset:13312
    v_cvt_pk_bf16_f32 v63, v48, v49
    v_and_or_b32 v62, v62, -2, s22
    v_mfma_f32_16x16x32_bf16 v[54:57], v[38:41], v[18:21], v[54:57]
    ds_read_b128 v[38:41], v2 offset:14336
    v_cvt_pk_bf16_f32 v64, v50, v51
    s_waitcnt lgkmcnt(3)
    v_mfma_f32_16x16x32_bf16 v[58:61], v[42:45], v[10:13], 0
    ds_read_b128 v[42:45], v2 offset:15360
    v_cvt_pk_bf16_f32 v65, v52, v53
    buffer_store_dwordx4 v[62:65], v3, s[4:7], s32 offen sc1
    v_mfma_f32_16x16x32_bf16 v[58:61], v[74:77], v[14:17], v[58:61]
    ds_read_b128 v[74:77], v2 offset:16384
    v_mfma_f32_16x16x32_bf16 v[58:61], v[78:81], v[18:21], v[58:61]
    ds_read_b128 v[78:81], v2 offset:17408
    s_waitcnt lgkmcnt(3)
    v_mfma_f32_16x16x32_bf16 v[46:49], v[30:33], v[10:13], 0
    ds_read_b128 v[30:33], v2 offset:18432
    v_cvt_pk_bf16_f32 v66, v54, v55
    v_mfma_f32_16x16x32_bf16 v[46:49], v[34:37], v[14:17], v[46:49]
    ds_read_b128 v[34:37], v2 offset:19456
    v_cvt_pk_bf16_f32 v67, v56, v57
    v_and_or_b32 v66, v66, -2, s22
    v_mfma_f32_16x16x32_bf16 v[46:49], v[38:41], v[18:21], v[46:49]
    ds_read_b128 v[38:41], v2 offset:20480
    v_cvt_pk_bf16_f32 v68, v58, v59
    s_waitcnt lgkmcnt(3)
    v_mfma_f32_16x16x32_bf16 v[50:53], v[42:45], v[10:13], 0
    ds_read_b128 v[42:45], v2 offset:21504
    v_cvt_pk_bf16_f32 v69, v60, v61
    buffer_store_dwordx4 v[66:69], v4, s[4:7], s32 offen sc1
    v_mfma_f32_16x16x32_bf16 v[50:53], v[74:77], v[14:17], v[50:53]
    ds_read_b128 v[74:77], v2 offset:22528
    v_mfma_f32_16x16x32_bf16 v[50:53], v[78:81], v[18:21], v[50:53]
    ds_read_b128 v[78:81], v2 offset:23552
    s_waitcnt lgkmcnt(3)
    v_mfma_f32_16x16x32_bf16 v[54:57], v[30:33], v[10:13], 0
    ds_read_b128 v[30:33], v2 offset:24576
    v_cvt_pk_bf16_f32 v62, v46, v47
    v_mfma_f32_16x16x32_bf16 v[54:57], v[34:37], v[14:17], v[54:57]
    ds_read_b128 v[34:37], v2 offset:25600
    v_cvt_pk_bf16_f32 v63, v48, v49
    v_and_or_b32 v62, v62, -2, s22
    v_mfma_f32_16x16x32_bf16 v[54:57], v[38:41], v[18:21], v[54:57]
    ds_read_b128 v[38:41], v2 offset:26624
    v_cvt_pk_bf16_f32 v64, v50, v51
    s_waitcnt lgkmcnt(3)
    v_mfma_f32_16x16x32_bf16 v[58:61], v[42:45], v[10:13], 0
    ds_read_b128 v[42:45], v2 offset:27648
    v_cvt_pk_bf16_f32 v65, v52, v53
    buffer_store_dwordx4 v[62:65], v5, s[4:7], s32 offen sc1
    v_mfma_f32_16x16x32_bf16 v[58:61], v[74:77], v[14:17], v[58:61]
    ds_read_b128 v[74:77], v2 offset:28672
    v_mfma_f32_16x16x32_bf16 v[58:61], v[78:81], v[18:21], v[58:61]
    ds_read_b128 v[78:81], v2 offset:29696
    s_waitcnt lgkmcnt(3)
    v_mfma_f32_16x16x32_bf16 v[46:49], v[30:33], v[10:13], 0
    v_cvt_pk_bf16_f32 v66, v54, v55
    v_mfma_f32_16x16x32_bf16 v[46:49], v[34:37], v[14:17], v[46:49]
    v_cvt_pk_bf16_f32 v67, v56, v57
    v_and_or_b32 v66, v66, -2, s22
    v_mfma_f32_16x16x32_bf16 v[46:49], v[38:41], v[18:21], v[46:49]
    v_cvt_pk_bf16_f32 v68, v58, v59
    s_waitcnt lgkmcnt(0)
    v_mfma_f32_16x16x32_bf16 v[50:53], v[42:45], v[10:13], 0
    v_cvt_pk_bf16_f32 v69, v60, v61
    buffer_store_dwordx4 v[66:69], v6, s[4:7], s32 offen sc1
    v_mfma_f32_16x16x32_bf16 v[50:53], v[74:77], v[14:17], v[50:53]
    v_mfma_f32_16x16x32_bf16 v[50:53], v[78:81], v[18:21], v[50:53]
    s_nop 0
    v_cvt_pk_bf16_f32 v62, v46, v47
    v_cvt_pk_bf16_f32 v63, v48, v49
    v_and_or_b32 v62, v62, -2, s22
    s_nop 3
    v_cvt_pk_bf16_f32 v64, v50, v51
    v_cvt_pk_bf16_f32 v65, v52, v53
    buffer_store_dwordx4 v[62:65], v7, s[4:7], s32 offen sc1
    v_accvgpr_read_b32 v78, a252
    v_accvgpr_read_b32 v79, a253
    v_accvgpr_read_b32 v80, a254
    v_accvgpr_read_b32 v81, a255
    s_mov_b32 s19, 0
    s_waitcnt vmcnt(0)
    buffer_load_dwordx4 v[26:29], v8, s[4:7], s32 offen offset:0 sc1
    buffer_load_dwordx4 v[30:33], v8, s[4:7], s32 offen offset:2560 sc1
    buffer_load_dwordx4 v[34:37], v8, s[4:7], s33 offen offset:0 sc1
    buffer_load_dwordx4 v[38:41], v8, s[4:7], s33 offen offset:2560 sc1
    buffer_load_dwordx4 v[42:45], v8, s[4:7], s34 offen offset:0 sc1
    buffer_load_dwordx4 v[46:49], v8, s[4:7], s34 offen offset:2560 sc1
    buffer_load_dwordx4 v[50:53], v8, s[4:7], s35 offen offset:0 sc1
    buffer_load_dwordx4 v[54:57], v8, s[4:7], s35 offen offset:2560 sc1
L_Rs0_hb_8:
    s_waitcnt vmcnt(7)
    v_mfma_f32_16x16x32_bf16 v[70:73], a[248:251], v[26:29], 0
    v_xor_b32 v1, s44, v26
    s_waitcnt vmcnt(6)
    v_mfma_f32_16x16x32_bf16 v[70:73], a[248:251], v[30:33], v[70:73]
    v_bitop3_b32 v1, v1, v30, s44 bitop3:0xf6
    s_waitcnt vmcnt(5)
    v_mfma_f32_16x16x32_bf16 v[70:73], a[248:251], v[34:37], v[70:73]
    v_bitop3_b32 v1, v1, v34, s44 bitop3:0xf6
    s_waitcnt vmcnt(4)
    v_mfma_f32_16x16x32_bf16 v[70:73], a[248:251], v[38:41], v[70:73]
    v_bitop3_b32 v1, v1, v38, s44 bitop3:0xf6
    s_waitcnt vmcnt(3)
    v_mfma_f32_16x16x32_bf16 v[70:73], a[248:251], v[42:45], v[70:73]
    v_bitop3_b32 v1, v1, v42, s44 bitop3:0xf6
    s_waitcnt vmcnt(2)
    v_mfma_f32_16x16x32_bf16 v[70:73], a[248:251], v[46:49], v[70:73]
    v_bitop3_b32 v1, v1, v46, s44 bitop3:0xf6
    s_waitcnt vmcnt(1)
    v_mfma_f32_16x16x32_bf16 v[70:73], a[248:251], v[50:53], v[70:73]
    v_bitop3_b32 v1, v1, v50, s44 bitop3:0xf6
    s_waitcnt vmcnt(0)
    v_mfma_f32_16x16x32_bf16 v[70:73], a[248:251], v[54:57], v[70:73]
    v_bitop3_b32 v1, v1, v54, s44 bitop3:0xf6
    v_and_b32 v1, 1, v1
    v_cmp_ne_u32 vcc, 0, v1
    s_nop 0
    s_cbranch_vccnz L_Rs0_hbfix_9
    s_nop 2
    v_cvt_pk_bf16_f32 v74, v70, v71
    v_cvt_pk_bf16_f32 v75, v72, v73
    v_mov_b32 v76, v74
    v_mov_b32 v77, v75
    s_nop 0
    v_permlane16_swap_b32 v74, v76
    v_permlane16_swap_b32 v75, v77
    v_cndmask_b32 v74, v74, v78, s[42:43]
    v_cndmask_b32 v75, v75, v79, s[42:43]
    v_cndmask_b32 v76, v76, v80, s[42:43]
    v_cndmask_b32 v77, v77, v81, s[42:43]
    v_and_or_b32 v74, v74, -2, s24
    s_mov_b64 exec, s[46:47]
    buffer_store_dwordx4 v[74:77], v9, s[4:7], s36 offen sc1
    buffer_store_dwordx4 v[74:77], v9, s[4:7], s37 offen sc1
    s_mov_b64 exec, -1
    s_add_u32 s60, s20, 1
    s_and_b32 s22, s60, 1
    s_lshl_b32 s21, s22, 31
    s_sub_u32 s44, 0, s22
    s_bfe_u32 s23, s20, 0x10001
    s_sub_u32 s23, s23, 1
    s_lshr_b32 s24, s60, 1
    s_andn2_b32 s24, 1, s24
    s_lshl_b32 s61, s14, 15
    s_add_u32 s61, s61, 1179648
    s_and_b32 s25, s20, 1
    s_lshl_b32 s25, s25, 16
    s_add_u32 s25, s25, s61
    s_add_u32 s25, s25, 0
    s_add_u32 s26, s25, 4096
    s_lshl_b32 s36, s22, 16
    s_add_u32 s36, s36, s61
    s_lshl_b32 s27, s20, 1
    s_add_u32 s37, s27, 2
    s_add_u32 s37, s37, s14
    s_mul_i32 s37, s37, 20480
    s_add_u32 s37, s37, 2621440
    s_add_u32 s27, s27, 1
    s_sub_u32 s27, s27, s14
    s_mul_i32 s27, s27, 20480
    s_add_u32 s27, s27, 2621440
    s_add_u32 s28, s27, 4096
    s_lshl_b32 s31, s20, 6
    s_add_u32 s31, s31, s13
    s_mul_i32 s31, s31, 6144
    s_add_u32 s31, s31, 5898240
    s_min_u32 s56, s20, 63
    s_lshl_b32 s56, s56, 6
    s_add_u32 s56, s56, s13
    s_mul_i32 s56, s56, 12288
    s_add_u32 s56, s56, 37361664
    s_max_u32 s57, s20, 7
    s_sub_u32 s57, s57, 7
    s_lshl_b32 s57, s57, 6
    s_add_u32 s57, s57, s13
    s_mul_i32 s57, s57, 12288
    s_add_u32 s57, s57, 87693312
    s_cmp_lt_u32 s20, 7
    s_cselect_b32 s57, s56, s57
    s_cmp_gt_u32 s60, 63
    s_cselect_b64 s[42:43], s[38:39], 0
    s_cmp_le_u32 s60, 7
    s_cselect_b64 vcc, s[40:41], 0
    s_or_b64 s[42:43], s[42:43], vcc
    s_waitcnt vmcnt(1)
    s_branch L_Rs0_top
L_Rs0_tail:
    s_waitcnt lgkmcnt(0)
    buffer_store_dwordx4 v[88:91], v0, s[4:7], s60 offen sc1
    s_waitcnt vmcnt(0) lgkmcnt(0)
    s_barrier
    v_mov_b32 v22, 71
    s_mov_b64 exec, 1
    s_mov_b64 exec, -1
    s_waitcnt vmcnt(0)
    s_endpgm
L_Rs0_glfix_3:
    buffer_load_dwordx4 v[10:13], v0, s[4:7], s25 offen offset:0 sc1
    buffer_load_dwordx4 v[14:17], v0, s[4:7], s25 offen offset:1024 sc1
    buffer_load_dwordx4 v[18:21], v0, s[4:7], s25 offen offset:2048 sc1
    buffer_load_dwordx4 v[22:25], v0, s[4:7], s25 offen offset:3072 sc1
    buffer_load_dwordx4 v[26:29], v0, s[4:7], s26 offen offset:0 sc1
    buffer_load_dwordx4 v[46:49], v0, s[4:7], s27 offen offset:0 sc1
    buffer_load_dwordx4 v[30:33], v0, s[4:7], s27 offen offset:1024 sc1
    buffer_load_dwordx4 v[34:37], v0, s[4:7], s27 offen offset:2048 sc1
    buffer_load_dwordx4 v[38:41], v0, s[4:7], s27 offen offset:3072 sc1
    buffer_load_dwordx4 v[42:45], v0, s[4:7], s28 offen offset:0 sc1
    s_add_u32 s19, s19, 1
    s_cmp_lt_u32 s19, 524288
    s_cbranch_scc1 L_Rs0_gl_1
    s_branch L_fail
L_Rs0_grfix_5:
    buffer_load_dwordx4 v[46:49], v0, s[4:7], s27 offen offset:0 sc1
    buffer_load_dwordx4 v[30:33], v0, s[4:7], s27 offen offset:1024 sc1
    buffer_load_dwordx4 v[34:37], v0, s[4:7], s27 offen offset:2048 sc1
    buffer_load_dwordx4 v[38:41], v0, s[4:7], s27 offen offset:3072 sc1
    buffer_load_dwordx4 v[42:45], v0, s[4:7], s28 offen offset:0 sc1
    s_add_u32 s19, s19, 1
    s_cmp_lt_u32 s19, 524288
    s_cbranch_scc1 L_Rs0_gr2_4
    s_branch L_fail
L_Rs0_gr2_4:
    v_mfma_f32_16x16x32_bf16 v[50:53], a[240:243], v[10:13], 0
    v_mfma_f32_16x16x32_bf16 v[54:57], a[244:247], v[10:13], 0
    v_mfma_f32_16x16x32_bf16 v[58:61], a[240:243], v[14:17], 0
    v_mfma_f32_16x16x32_bf16 v[62:65], a[244:247], v[14:17], 0
    v_mfma_f32_16x16x32_bf16 v[66:69], a[240:243], v[18:21], 0
    v_mfma_f32_16x16x32_bf16 v[70:73], a[244:247], v[18:21], 0
    v_mfma_f32_16x16x32_bf16 v[74:77], a[240:243], v[22:25], 0
    v_mfma_f32_16x16x32_bf16 v[78:81], a[244:247], v[22:25], 0
    v_mfma_f32_16x16x32_bf16 v[82:85], a[240:243], v[26:29], 0
    v_mfma_f32_16x16x32_bf16 v[86:89], a[244:247], v[26:29], 0
    s_branch L_Rs0_gr_2
L_Rs0_hafix_7:
    buffer_load_dwordx4 v[82:85], v0, s[4:7], s30 offen sc1
    s_add_u32 s19, s19, 1
    s_cmp_lt_u32 s19, 524288
    s_cbranch_scc1 L_Rs0_ha_6
    s_branch L_fail
L_Rs0_hbfix_9:
    buffer_load_dwordx4 v[26:29], v8, s[4:7], s32 offen offset:0 sc1
    buffer_load_dwordx4 v[30:33], v8, s[4:7], s32 offen offset:2560 sc1
    buffer_load_dwordx4 v[34:37], v8, s[4:7], s33 offen offset:0 sc1
    buffer_load_dwordx4 v[38:41], v8, s[4:7], s33 offen offset:2560 sc1
    buffer_load_dwordx4 v[42:45], v8, s[4:7], s34 offen offset:0 sc1
    buffer_load_dwordx4 v[46:49], v8, s[4:7], s34 offen offset:2560 sc1
    buffer_load_dwordx4 v[50:53], v8, s[4:7], s35 offen offset:0 sc1
    buffer_load_dwordx4 v[54:57], v8, s[4:7], s35 offen offset:2560 sc1
    s_add_u32 s19, s19, 1
    s_cmp_lt_u32 s19, 524288
    s_cbranch_scc1 L_Rs0_hb_8
    s_branch L_fail
L_R1_start:
    s_lshr_b32 s14, s13, 5
    s_and_b32 s15, s13, 31
    s_mov_b32 s62, 17920
    v_lshlrev_b32 v10, 4, v0
    v_mov_b32 v12, 0
    v_mov_b32 v13, 0
    v_mov_b32 v14, 0
    v_mov_b32 v15, 0
    v_mov_b32 v16, -1
    v_mov_b32 v17, -1
    v_mov_b32 v18, -1
    v_mov_b32 v19, -1
    s_lshl_b32 s60, s13, 12
    s_add_u32 s60, s60, 918528
    buffer_store_dwordx4 v[12:15], v10, s[4:7], s60 offen sc1
    s_mul_i32 s60, s13, 20480
    s_add_u32 s60, s60, 1315840
    buffer_store_dwordx4 v[12:15], v10, s[4:7], s60 offen sc1
    s_add_u32 s60, s60, 1024
    buffer_store_dwordx4 v[12:15], v10, s[4:7], s60 offen sc1
    s_add_u32 s60, s60, 1024
    buffer_store_dwordx4 v[12:15], v10, s[4:7], s60 offen sc1
    s_add_u32 s60, s60, 1024
    buffer_store_dwordx4 v[12:15], v10, s[4:7], s60 offen sc1
    s_add_u32 s60, s60, 1024
    buffer_store_dwordx4 v[12:15], v10, s[4:7], s60 offen sc1
    s_add_u32 s60, s60, 1024
    s_mul_i32 s61, s15, 640
    v_add_u32 v11, s61, v10
    s_mov_b32 exec_hi, 0xff
    s_lshl_b32 s60, s14, 15
    s_add_u32 s60, s60, 1245184
    buffer_store_dwordx4 v[12:15], v11, s[4:7], s60 offen sc1
    s_mul_i32 s60, s14, 20480
    s_add_u32 s60, s60, 2662400
    buffer_store_dwordx4 v[12:15], v11, s[4:7], s60 offen sc1
    s_add_u32 s60, s60, 163840
    buffer_store_dwordx4 v[12:15], v11, s[4:7], s60 offen sc1
    s_add_u32 s60, s60, 163840
    buffer_store_dwordx4 v[12:15], v11, s[4:7], s60 offen sc1
    s_add_u32 s60, s60, 163840
    buffer_store_dwordx4 v[12:15], v11, s[4:7], s60 offen sc1
    s_add_u32 s60, s60, 163840
    buffer_store_dwordx4 v[12:15], v11, s[4:7], s60 offen sc1
    s_add_u32 s60, s60, 163840
    buffer_store_dwordx4 v[12:15], v11, s[4:7], s60 offen sc1
    s_add_u32 s60, s60, 163840
    buffer_store_dwordx4 v[12:15], v11, s[4:7], s60 offen sc1
    s_add_u32 s60, s60, 163840
    buffer_store_dwordx4 v[12:15], v11, s[4:7], s60 offen sc1
    s_add_u32 s60, s60, 163840
    buffer_store_dwordx4 v[12:15], v11, s[4:7], s60 offen sc1
    s_add_u32 s60, s60, 163840
    buffer_store_dwordx4 v[12:15], v11, s[4:7], s60 offen sc1
    s_add_u32 s60, s60, 163840
    buffer_store_dwordx4 v[12:15], v11, s[4:7], s60 offen sc1
    s_add_u32 s60, s60, 163840
    buffer_store_dwordx4 v[12:15], v11, s[4:7], s60 offen sc1
    s_add_u32 s60, s60, 163840
    buffer_store_dwordx4 v[12:15], v11, s[4:7], s60 offen sc1
    s_add_u32 s60, s60, 163840
    buffer_store_dwordx4 v[12:15], v11, s[4:7], s60 offen sc1
    s_add_u32 s60, s60, 163840
    buffer_store_dwordx4 v[12:15], v11, s[4:7], s60 offen sc1
    s_add_u32 s60, s60, 163840
    buffer_store_dwordx4 v[12:15], v11, s[4:7], s60 offen sc1
    s_add_u32 s60, s60, 163840
    buffer_store_dwordx4 v[12:15], v11, s[4:7], s60 offen sc1
    s_add_u32 s60, s60, 163840
    buffer_store_dwordx4 v[12:15], v11, s[4:7], s60 offen sc1
    s_add_u32 s60, s60, 163840
    s_mov_b64 exec, 1
    s_lshl_b32 s54, s13, 9
    s_lshr_b32 s55, s13, 1
    s_mul_i32 s55, s55, 1536
    s_add_u32 s55, s55, 32768
    s_add_u32 s54, s54, 128
    buffer_store_dword v12, v10, s[4:7], s54 offen sc1
    s_mov_b64 exec, -1
    v_add_u32 v38, 0, v0
    v_mul_u32_u24 v39, 10923, v38
    v_lshrrev_b32 v39, 16, v39
    v_mul_u32_u24 v20, 6, v39
    v_sub_u32 v20, v38, v20
    v_lshrrev_b32 v20, 0, v20
    v_lshlrev_b32 v20, 4, v20
    v_mul_u32_u24 v39, 12288, v39
    v_add_u32 v20, v20, v39
    v_add_u32 v38, 64, v0
    v_mul_u32_u24 v39, 10923, v38
    v_lshrrev_b32 v39, 16, v39
    v_mul_u32_u24 v21, 6, v39
    v_sub_u32 v21, v38, v21
    v_lshrrev_b32 v21, 0, v21
    v_lshlrev_b32 v21, 4, v21
    v_mul_u32_u24 v39, 12288, v39
    v_add_u32 v21, v21, v39
    v_add_u32 v38, 128, v0
    v_mul_u32_u24 v39, 10923, v38
    v_lshrrev_b32 v39, 16, v39
    v_mul_u32_u24 v22, 6, v39
    v_sub_u32 v22, v38, v22
    v_lshrrev_b32 v22, 0, v22
    v_lshlrev_b32 v22, 4, v22
    v_mul_u32_u24 v39, 12288, v39
    v_add_u32 v22, v22, v39
    v_add_u32 v38, 0, v0
    v_mul_u32_u24 v39, 16385, v38
    v_lshrrev_b32 v39, 16, v39
    v_mul_u32_u24 v23, 4, v39
    v_sub_u32 v23, v38, v23
    v_lshrrev_b32 v23, 0, v23
    v_lshlrev_b32 v23, 4, v23
    v_mul_u32_u24 v39, 12288, v39
    v_add_u32 v23, v23, v39
    v_add_u32 v38, 64, v0
    v_mul_u32_u24 v39, 16385, v38
    v_lshrrev_b32 v39, 16, v39
    v_mul_u32_u24 v24, 4, v39
    v_sub_u32 v24, v38, v24
    v_lshrrev_b32 v24, 0, v24
    v_lshlrev_b32 v24, 4, v24
    v_mul_u32_u24 v39, 12288, v39
    v_add_u32 v24, v24, v39
    v_add_u32 v38, 0, v0
    v_mul_u32_u24 v39, 3277, v38
    v_lshrrev_b32 v39, 16, v39
    v_mul_u32_u24 v25, 20, v39
    v_sub_u32 v25, v38, v25
    v_lshrrev_b32 v25, 0, v25
    v_lshlrev_b32 v25, 4, v25
    v_mul_u32_u24 v39, 1280, v39
    v_add_u32 v25, v25, v39
    v_add_u32 v38, 64, v0
    v_mul_u32_u24 v39, 3277, v38
    v_lshrrev_b32 v39, 16, v39
    v_mul_u32_u24 v26, 20, v39
    v_sub_u32 v26, v38, v26
    v_lshrrev_b32 v26, 0, v26
    v_lshlrev_b32 v26, 4, v26
    v_mul_u32_u24 v39, 1280, v39
    v_add_u32 v26, v26, v39
    v_add_u32 v38, 128, v0
    v_mul_u32_u24 v39, 3277, v38
    v_lshrrev_b32 v39, 16, v39
    v_mul_u32_u24 v27, 20, v39
    v_sub_u32 v27, v38, v27
    v_lshrrev_b32 v27, 0, v27
    v_lshlrev_b32 v27, 4, v27
    v_mul_u32_u24 v39, 1280, v39
    v_add_u32 v27, v27, v39
    v_add_u32 v38, 192, v0
    v_mul_u32_u24 v39, 3277, v38
    v_lshrrev_b32 v39, 16, v39
    v_mul_u32_u24 v28, 20, v39
    v_sub_u32 v28, v38, v28
    v_lshrrev_b32 v28, 0, v28
    v_lshlrev_b32 v28, 4, v28
    v_mul_u32_u24 v39, 1280, v39
    v_add_u32 v28, v28, v39
    v_add_u32 v38, 256, v0
    v_mul_u32_u24 v39, 3277, v38
    v_lshrrev_b32 v39, 16, v39
    v_mul_u32_u24 v29, 20, v39
    v_sub_u32 v29, v38, v29
    v_lshrrev_b32 v29, 0, v29
    v_lshlrev_b32 v29, 4, v29
    v_mul_u32_u24 v39, 1280, v39
    v_add_u32 v29, v29, v39
    v_add_u32 v38, 320, v0
    v_mul_u32_u24 v39, 3277, v38
    v_lshrrev_b32 v39, 16, v39
    v_mul_u32_u24 v30, 20, v39
    v_sub_u32 v30, v38, v30
    v_lshrrev_b32 v30, 0, v30
    v_lshlrev_b32 v30, 4, v30
    v_mul_u32_u24 v39, 1280, v39
    v_add_u32 v30, v30, v39
    v_add_u32 v38, 384, v0
    v_mul_u32_u24 v39, 3277, v38
    v_lshrrev_b32 v39, 16, v39
    v_mul_u32_u24 v31, 20, v39
    v_sub_u32 v31, v38, v31
    v_lshrrev_b32 v31, 0, v31
    v_lshlrev_b32 v31, 4, v31
    v_mul_u32_u24 v39, 1280, v39
    v_add_u32 v31, v31, v39
    v_add_u32 v38, 448, v0
    v_mul_u32_u24 v39, 3277, v38
    v_lshrrev_b32 v39, 16, v39
    v_mul_u32_u24 v32, 20, v39
    v_sub_u32 v32, v38, v32
    v_lshrrev_b32 v32, 0, v32
    v_lshlrev_b32 v32, 4, v32
    v_mul_u32_u24 v39, 1280, v39
    v_add_u32 v32, v32, v39
    v_add_u32 v38, 512, v0
    v_mul_u32_u24 v39, 3277, v38
    v_lshrrev_b32 v39, 16, v39
    v_mul_u32_u24 v33, 20, v39
    v_sub_u32 v33, v38, v33
    v_lshrrev_b32 v33, 0, v33
    v_lshlrev_b32 v33, 4, v33
    v_mul_u32_u24 v39, 1280, v39
    v_add_u32 v33, v33, v39
    v_add_u32 v38, 576, v0
    v_mul_u32_u24 v39, 3277, v38
    v_lshrrev_b32 v39, 16, v39
    v_mul_u32_u24 v34, 20, v39
    v_sub_u32 v34, v38, v34
    v_lshrrev_b32 v34, 0, v34
    v_lshlrev_b32 v34, 4, v34
    v_mul_u32_u24 v39, 1280, v39
    v_add_u32 v34, v34, v39
    v_lshrrev_b32 v35, 2, v0
    v_mul_u32_u24 v35, 96, v35
    v_and_b32 v38, 3, v0
    v_lshl_add_u32 v35, v38, 3, v35
    v_add_u32 v35, s62, v35
    v_lshrrev_b32 v36, 2, v0
    v_mul_u32_u24 v36, 64, v36
    v_and_b32 v38, 3, v0
    v_lshl_add_u32 v36, v38, 3, v36
    v_add_u32 v36, s62, v36
    v_lshrrev_b32 v37, 2, v0
    v_mul_u32_u24 v37, 320, v37
    v_and_b32 v38, 3, v0
    v_lshl_add_u32 v37, v38, 3, v37
    v_add_u32 v37, s62, v37
    v_add_u32 v2, 102400, v10
    s_mov_b32 s8, s68
    s_and_b32 s9, s69, 0xffff
    s_mov_b32 s10, 7864320
    s_mov_b32 s11, 0x20000
    s_mov_b32 s28, s72
    s_and_b32 s29, s73, 0xffff
    s_mov_b32 s30, 7864320
    s_mov_b32 s31, 0x20000
    s_mov_b32 s32, s74
    s_and_b32 s33, s75, 0xffff
    s_mov_b32 s34, 7864320
    s_mov_b32 s35, 0x20000
    s_mul_i32 s60, s13, 192
    s_add_u32 s25, s60, 96
    s_add_u32 s26, s60, 64
    s_mul_i32 s27, s13, 122880
    s_add_u32 s27, s27, 320
    s_add_u32 m0, s62, 0
    s_nop 0
    buffer_load_dwordx4 v20, s[8:11], s25 offen lds
    s_add_u32 m0, s62, 1024
    s_nop 0
    buffer_load_dwordx4 v21, s[8:11], s25 offen lds
    s_add_u32 m0, s62, 2048
    s_nop 0
    buffer_load_dwordx4 v22, s[8:11], s25 offen lds
    s_add_u32 s25, s25, 393216
    s_add_u32 m0, s62, 3072
    s_nop 0
    buffer_load_dwordx4 v20, s[8:11], s25 offen lds
    s_add_u32 m0, s62, 4096
    s_nop 0
    buffer_load_dwordx4 v21, s[8:11], s25 offen lds
    s_add_u32 m0, s62, 5120
    s_nop 0
    buffer_load_dwordx4 v22, s[8:11], s25 offen lds
    s_add_u32 s25, s25, 393216
    s_add_u32 m0, s62, 6144
    s_nop 0
    buffer_load_dwordx4 v20, s[8:11], s25 offen lds
    s_add_u32 m0, s62, 7168
    s_nop 0
    buffer_load_dwordx4 v21, s[8:11], s25 offen lds
    s_add_u32 m0, s62, 8192
    s_nop 0
    buffer_load_dwordx4 v22, s[8:11], s25 offen lds
    s_add_u32 s25, s25, 393216
    s_add_u32 m0, s62, 9216
    s_nop 0
    buffer_load_dwordx4 v20, s[8:11], s25 offen lds
    s_add_u32 m0, s62, 10240
    s_nop 0
    buffer_load_dwordx4 v21, s[8:11], s25 offen lds
    s_add_u32 m0, s62, 11264
    s_nop 0
    buffer_load_dwordx4 v22, s[8:11], s25 offen lds
    s_add_u32 s25, s25, 393216
    s_add_u32 m0, s62, 12288
    s_nop 0
    buffer_load_dwordx4 v20, s[8:11], s25 offen lds
    s_add_u32 m0, s62, 13312
    s_nop 0
    buffer_load_dwordx4 v21, s[8:11], s25 offen lds
    s_add_u32 m0, s62, 14336
    s_nop 0
    buffer_load_dwordx4 v22, s[8:11], s25 offen lds
    s_waitcnt vmcnt(12)
    s_barrier
    s_cmp_lg_u32 s12, 0
    s_cbranch_scc1 L_R1_arr_1
    s_lshl_b32 s3, s18, 2
    s_add_u32 s3, s3, 64
    v_mov_b32 v92, s3
    v_mov_b32 v93, 1
    s_mov_b64 exec, 1
    global_atomic_add v92, v93, s[16:17] sc1
    s_waitcnt vmcnt(0)
    s_mov_b64 exec, -1
L_R1_arr_1:
    ds_read_b64_tr_b16 a[0:1], v35 offset:0
    ds_read_b64_tr_b16 a[2:3], v35 offset:1536
    ds_read_b64_tr_b16 a[80:81], v35 offset:32
    ds_read_b64_tr_b16 a[82:83], v35 offset:1568
    ds_read_b64_tr_b16 a[160:161], v35 offset:64
    ds_read_b64_tr_b16 a[162:163], v35 offset:1600
    s_waitcnt lgkmcnt(0)
    s_add_u32 s25, s25, 393216
    s_add_u32 m0, s62, 0
    s_nop 0
    buffer_load_dwordx4 v20, s[8:11], s25 offen lds
    s_add_u32 m0, s62, 1024
    s_nop 0
    buffer_load_dwordx4 v21, s[8:11], s25 offen lds
    s_add_u32 m0, s62, 2048
    s_nop 0
    buffer_load_dwordx4 v22, s[8:11], s25 offen lds
    s_waitcnt vmcnt(12)
    ds_read_b64_tr_b16 a[4:5], v35 offset:3072
    ds_read_b64_tr_b16 a[6:7], v35 offset:4608
    ds_read_b64_tr_b16 a[84:85], v35 offset:3104
    ds_read_b64_tr_b16 a[86:87], v35 offset:4640
    ds_read_b64_tr_b16 a[164:165], v35 offset:3136
    ds_read_b64_tr_b16 a[166:167], v35 offset:4672
    s_waitcnt lgkmcnt(0)
    s_add_u32 s25, s25, 393216
    s_add_u32 m0, s62, 3072
    s_nop 0
    buffer_load_dwordx4 v20, s[8:11], s25 offen lds
    s_add_u32 m0, s62, 4096
    s_nop 0
    buffer_load_dwordx4 v21, s[8:11], s25 offen lds
    s_add_u32 m0, s62, 5120
    s_nop 0
    buffer_load_dwordx4 v22, s[8:11], s25 offen lds
    s_waitcnt vmcnt(12)
    ds_read_b64_tr_b16 a[8:9], v35 offset:6144
    ds_read_b64_tr_b16 a[10:11], v35 offset:7680
    ds_read_b64_tr_b16 a[88:89], v35 offset:6176
    ds_read_b64_tr_b16 a[90:91], v35 offset:7712
    ds_read_b64_tr_b16 a[168:169], v35 offset:6208
    ds_read_b64_tr_b16 a[170:171], v35 offset:7744
    s_waitcnt lgkmcnt(0)
    s_add_u32 s25, s25, 393216
    s_add_u32 m0, s62, 6144
    s_nop 0
    buffer_load_dwordx4 v20, s[8:11], s25 offen lds
    s_add_u32 m0, s62, 7168
    s_nop 0
    buffer_load_dwordx4 v21, s[8:11], s25 offen lds
    s_add_u32 m0, s62, 8192
    s_nop 0
    buffer_load_dwordx4 v22, s[8:11], s25 offen lds
    s_waitcnt vmcnt(12)
    ds_read_b64_tr_b16 a[12:13], v35 offset:9216
    ds_read_b64_tr_b16 a[14:15], v35 offset:10752
    ds_read_b64_tr_b16 a[92:93], v35 offset:9248
    ds_read_b64_tr_b16 a[94:95], v35 offset:10784
    ds_read_b64_tr_b16 a[172:173], v35 offset:9280
    ds_read_b64_tr_b16 a[174:175], v35 offset:10816
    s_waitcnt lgkmcnt(0)
    s_add_u32 s25, s25, 393216
    s_add_u32 m0, s62, 9216
    s_nop 0
    buffer_load_dwordx4 v20, s[8:11], s25 offen lds
    s_add_u32 m0, s62, 10240
    s_nop 0
    buffer_load_dwordx4 v21, s[8:11], s25 offen lds
    s_add_u32 m0, s62, 11264
    s_nop 0
    buffer_load_dwordx4 v22, s[8:11], s25 offen lds
    s_waitcnt vmcnt(12)
    ds_read_b64_tr_b16 a[16:17], v35 offset:12288
    ds_read_b64_tr_b16 a[18:19], v35 offset:13824
    ds_read_b64_tr_b16 a[96:97], v35 offset:12320
    ds_read_b64_tr_b16 a[98:99], v35 offset:13856
    ds_read_b64_tr_b16 a[176:177], v35 offset:12352
    ds_read_b64_tr_b16 a[178:179], v35 offset:13888
    s_waitcnt lgkmcnt(0)
    s_add_u32 s25, s25, 393216
    s_add_u32 m0, s62, 12288
    s_nop 0
    buffer_load_dwordx4 v20, s[8:11], s25 offen lds
    s_add_u32 m0, s62, 13312
    s_nop 0
    buffer_load_dwordx4 v21, s[8:11], s25 offen lds
    s_add_u32 m0, s62, 14336
    s_nop 0
    buffer_load_dwordx4 v22, s[8:11], s25 offen lds
    s_waitcnt vmcnt(12)
    ds_read_b64_tr_b16 a[20:21], v35 offset:0
    ds_read_b64_tr_b16 a[22:23], v35 offset:1536
    ds_read_b64_tr_b16 a[100:101], v35 offset:32
    ds_read_b64_tr_b16 a[102:103], v35 offset:1568
    ds_read_b64_tr_b16 a[180:181], v35 offset:64
    ds_read_b64_tr_b16 a[182:183], v35 offset:1600
    s_waitcnt lgkmcnt(0)
    s_add_u32 s25, s25, 393216
    s_add_u32 m0, s62, 0
    s_nop 0
    buffer_load_dwordx4 v20, s[8:11], s25 offen lds
    s_add_u32 m0, s62, 1024
    s_nop 0
    buffer_load_dwordx4 v21, s[8:11], s25 offen lds
    s_add_u32 m0, s62, 2048
    s_nop 0
    buffer_load_dwordx4 v22, s[8:11], s25 offen lds
    s_waitcnt vmcnt(12)
    ds_read_b64_tr_b16 a[24:25], v35 offset:3072
    ds_read_b64_tr_b16 a[26:27], v35 offset:4608
    ds_read_b64_tr_b16 a[104:105], v35 offset:3104
    ds_read_b64_tr_b16 a[106:107], v35 offset:4640
    ds_read_b64_tr_b16 a[184:185], v35 offset:3136
    ds_read_b64_tr_b16 a[186:187], v35 offset:4672
    s_waitcnt lgkmcnt(0)
    s_add_u32 s25, s25, 393216
    s_add_u32 m0, s62, 3072
    s_nop 0
    buffer_load_dwordx4 v20, s[8:11], s25 offen lds
    s_add_u32 m0, s62, 4096
    s_nop 0
    buffer_load_dwordx4 v21, s[8:11], s25 offen lds
    s_add_u32 m0, s62, 5120
    s_nop 0
    buffer_load_dwordx4 v22, s[8:11], s25 offen lds
    s_waitcnt vmcnt(12)
    ds_read_b64_tr_b16 a[28:29], v35 offset:6144
    ds_read_b64_tr_b16 a[30:31], v35 offset:7680
    ds_read_b64_tr_b16 a[108:109], v35 offset:6176
    ds_read_b64_tr_b16 a[110:111], v35 offset:7712
    ds_read_b64_tr_b16 a[188:189], v35 offset:6208
    ds_read_b64_tr_b16 a[190:191], v35 offset:7744
    s_waitcnt lgkmcnt(0)
    s_add_u32 s25, s25, 393216
    s_add_u32 m0, s62, 6144
    s_nop 0
    buffer_load_dwordx4 v20, s[8:11], s25 offen lds
    s_add_u32 m0, s62, 7168
    s_nop 0
    buffer_load_dwordx4 v21, s[8:11], s25 offen lds
    s_add_u32 m0, s62, 8192
    s_nop 0
    buffer_load_dwordx4 v22, s[8:11], s25 offen lds
    s_waitcnt vmcnt(12)
    ds_read_b64_tr_b16 a[32:33], v35 offset:9216
    ds_read_b64_tr_b16 a[34:35], v35 offset:10752
    ds_read_b64_tr_b16 a[112:113], v35 offset:9248
    ds_read_b64_tr_b16 a[114:115], v35 offset:10784
    ds_read_b64_tr_b16 a[192:193], v35 offset:9280
    ds_read_b64_tr_b16 a[194:195], v35 offset:10816
    s_waitcnt lgkmcnt(0)
    s_add_u32 s25, s25, 393216
    s_add_u32 m0, s62, 9216
    s_nop 0
    buffer_load_dwordx4 v20, s[8:11], s25 offen lds
    s_add_u32 m0, s62, 10240
    s_nop 0
    buffer_load_dwordx4 v21, s[8:11], s25 offen lds
    s_add_u32 m0, s62, 11264
    s_nop 0
    buffer_load_dwordx4 v22, s[8:11], s25 offen lds
    s_waitcnt vmcnt(12)
    ds_read_b64_tr_b16 a[36:37], v35 offset:12288
    ds_read_b64_tr_b16 a[38:39], v35 offset:13824
    ds_read_b64_tr_b16 a[116:117], v35 offset:12320
    ds_read_b64_tr_b16 a[118:119], v35 offset:13856
    ds_read_b64_tr_b16 a[196:197], v35 offset:12352
    ds_read_b64_tr_b16 a[198:199], v35 offset:13888
    s_waitcnt lgkmcnt(0)
    s_add_u32 s25, s25, 393216
    s_add_u32 m0, s62, 12288
    s_nop 0
    buffer_load_dwordx4 v20, s[8:11], s25 offen lds
    s_add_u32 m0, s62, 13312
    s_nop 0
    buffer_load_dwordx4 v21, s[8:11], s25 offen lds
    s_add_u32 m0, s62, 14336
    s_nop 0
    buffer_load_dwordx4 v22, s[8:11], s25 offen lds
    s_waitcnt vmcnt(12)
    ds_read_b64_tr_b16 a[40:41], v35 offset:0
    ds_read_b64_tr_b16 a[42:43], v35 offset:1536
    ds_read_b64_tr_b16 a[120:121], v35 offset:32
    ds_read_b64_tr_b16 a[122:123], v35 offset:1568
    ds_read_b64_tr_b16 a[200:201], v35 offset:64
    ds_read_b64_tr_b16 a[202:203], v35 offset:1600
    s_waitcnt lgkmcnt(0)
    s_add_u32 s25, s25, 393216
    s_add_u32 m0, s62, 0
    s_nop 0
    buffer_load_dwordx4 v20, s[8:11], s25 offen lds
    s_add_u32 m0, s62, 1024
    s_nop 0
    buffer_load_dwordx4 v21, s[8:11], s25 offen lds
    s_add_u32 m0, s62, 2048
    s_nop 0
    buffer_load_dwordx4 v22, s[8:11], s25 offen lds
    s_waitcnt vmcnt(12)
    ds_read_b64_tr_b16 a[44:45], v35 offset:3072
    ds_read_b64_tr_b16 a[46:47], v35 offset:4608
    ds_read_b64_tr_b16 a[124:125], v35 offset:3104
    ds_read_b64_tr_b16 a[126:127], v35 offset:4640
    ds_read_b64_tr_b16 a[204:205], v35 offset:3136
    ds_read_b64_tr_b16 a[206:207], v35 offset:4672
    s_waitcnt lgkmcnt(0)
    s_add_u32 s25, s25, 393216
    s_add_u32 m0, s62, 3072
    s_nop 0
    buffer_load_dwordx4 v20, s[8:11], s25 offen lds
    s_add_u32 m0, s62, 4096
    s_nop 0
    buffer_load_dwordx4 v21, s[8:11], s25 offen lds
    s_add_u32 m0, s62, 5120
    s_nop 0
    buffer_load_dwordx4 v22, s[8:11], s25 offen lds
    s_waitcnt vmcnt(12)
    ds_read_b64_tr_b16 a[48:49], v35 offset:6144
    ds_read_b64_tr_b16 a[50:51], v35 offset:7680
    ds_read_b64_tr_b16 a[128:129], v35 offset:6176
    ds_read_b64_tr_b16 a[130:131], v35 offset:7712
    ds_read_b64_tr_b16 a[208:209], v35 offset:6208
    ds_read_b64_tr_b16 a[210:211], v35 offset:7744
    s_waitcnt lgkmcnt(0)
    s_add_u32 s25, s25, 393216
    s_add_u32 m0, s62, 6144
    s_nop 0
    buffer_load_dwordx4 v20, s[8:11], s25 offen lds
    s_add_u32 m0, s62, 7168
    s_nop 0
    buffer_load_dwordx4 v21, s[8:11], s25 offen lds
    s_add_u32 m0, s62, 8192
    s_nop 0
    buffer_load_dwordx4 v22, s[8:11], s25 offen lds
    s_waitcnt vmcnt(12)
    ds_read_b64_tr_b16 a[52:53], v35 offset:9216
    ds_read_b64_tr_b16 a[54:55], v35 offset:10752
    ds_read_b64_tr_b16 a[132:133], v35 offset:9248
    ds_read_b64_tr_b16 a[134:135], v35 offset:10784
    ds_read_b64_tr_b16 a[212:213], v35 offset:9280
    ds_read_b64_tr_b16 a[214:215], v35 offset:10816
    s_waitcnt lgkmcnt(0)
    s_add_u32 s25, s25, 393216
    s_add_u32 m0, s62, 9216
    s_nop 0
    buffer_load_dwordx4 v20, s[8:11], s25 offen lds
    s_add_u32 m0, s62, 10240
    s_nop 0
    buffer_load_dwordx4 v21, s[8:11], s25 offen lds
    s_add_u32 m0, s62, 11264
    s_nop 0
    buffer_load_dwordx4 v22, s[8:11], s25 offen lds
    s_waitcnt vmcnt(12)
    ds_read_b64_tr_b16 a[56:57], v35 offset:12288
    ds_read_b64_tr_b16 a[58:59], v35 offset:13824
    ds_read_b64_tr_b16 a[136:137], v35 offset:12320
    ds_read_b64_tr_b16 a[138:139], v35 offset:13856
    ds_read_b64_tr_b16 a[216:217], v35 offset:12352
    ds_read_b64_tr_b16 a[218:219], v35 offset:13888
    s_waitcnt lgkmcnt(0)
    s_add_u32 s25, s25, 393216
    s_add_u32 m0, s62, 12288
    s_nop 0
    buffer_load_dwordx4 v20, s[8:11], s25 offen lds
    s_add_u32 m0, s62, 13312
    s_nop 0
    buffer_load_dwordx4 v21, s[8:11], s25 offen lds
    s_add_u32 m0, s62, 14336
    s_nop 0
    buffer_load_dwordx4 v22, s[8:11], s25 offen lds
    s_add_u32 m0, s62, 15360
    s_nop 0
    buffer_load_dwordx4 v23, s[28:31], s26 offen lds
    s_add_u32 m0, s62, 16384
    s_nop 0
    buffer_load_dwordx4 v24, s[28:31], s26 offen lds
    s_waitcnt vmcnt(14)
    ds_read_b64_tr_b16 a[60:61], v35 offset:0
    ds_read_b64_tr_b16 a[62:63], v35 offset:1536
    ds_read_b64_tr_b16 a[140:141], v35 offset:32
    ds_read_b64_tr_b16 a[142:143], v35 offset:1568
    ds_read_b64_tr_b16 a[220:221], v35 offset:64
    ds_read_b64_tr_b16 a[222:223], v35 offset:1600
    s_waitcnt lgkmcnt(0)
    s_add_u32 s26, s26, 393216
    s_add_u32 m0, s62, 0
    s_nop 0
    buffer_load_dwordx4 v23, s[28:31], s26 offen lds
    s_add_u32 m0, s62, 1024
    s_nop 0
    buffer_load_dwordx4 v24, s[28:31], s26 offen lds
    s_waitcnt vmcnt(13)
    ds_read_b64_tr_b16 a[64:65], v35 offset:3072
    ds_read_b64_tr_b16 a[66:67], v35 offset:4608
    ds_read_b64_tr_b16 a[144:145], v35 offset:3104
    ds_read_b64_tr_b16 a[146:147], v35 offset:4640
    ds_read_b64_tr_b16 a[224:225], v35 offset:3136
    ds_read_b64_tr_b16 a[226:227], v35 offset:4672
    s_waitcnt lgkmcnt(0)
    s_add_u32 s26, s26, 393216
    s_add_u32 m0, s62, 2048
    s_nop 0
    buffer_load_dwordx4 v23, s[28:31], s26 offen lds
    s_add_u32 m0, s62, 3072
    s_nop 0
    buffer_load_dwordx4 v24, s[28:31], s26 offen lds
    s_add_u32 s26, s26, 393216
    s_add_u32 m0, s62, 4096
    s_nop 0
    buffer_load_dwordx4 v23, s[28:31], s26 offen lds
    s_add_u32 m0, s62, 5120
    s_nop 0
    buffer_load_dwordx4 v24, s[28:31], s26 offen lds
    s_waitcnt vmcnt(14)
    ds_read_b64_tr_b16 a[68:69], v35 offset:6144
    ds_read_b64_tr_b16 a[70:71], v35 offset:7680
    ds_read_b64_tr_b16 a[148:149], v35 offset:6176
    ds_read_b64_tr_b16 a[150:151], v35 offset:7712
    ds_read_b64_tr_b16 a[228:229], v35 offset:6208
    ds_read_b64_tr_b16 a[230:231], v35 offset:7744
    s_waitcnt lgkmcnt(0)
    s_add_u32 s26, s26, 393216
    s_add_u32 m0, s62, 6144
    s_nop 0
    buffer_load_dwordx4 v23, s[28:31], s26 offen lds
    s_add_u32 m0, s62, 7168
    s_nop 0
    buffer_load_dwordx4 v24, s[28:31], s26 offen lds
    s_waitcnt vmcnt(13)
    ds_read_b64_tr_b16 a[72:73], v35 offset:9216
    ds_read_b64_tr_b16 a[74:75], v35 offset:10752
    ds_read_b64_tr_b16 a[152:153], v35 offset:9248
    ds_read_b64_tr_b16 a[154:155], v35 offset:10784
    ds_read_b64_tr_b16 a[232:233], v35 offset:9280
    ds_read_b64_tr_b16 a[234:235], v35 offset:10816
    s_waitcnt lgkmcnt(0)
    s_add_u32 s26, s26, 393216
    s_add_u32 m0, s62, 8192
    s_nop 0
    buffer_load_dwordx4 v23, s[28:31], s26 offen lds
    s_add_u32 m0, s62, 9216
    s_nop 0
    buffer_load_dwordx4 v24, s[28:31], s26 offen lds
    s_add_u32 s26, s26, 393216
    s_add_u32 m0, s62, 10240
    s_nop 0
    buffer_load_dwordx4 v23, s[28:31], s26 offen lds
    s_add_u32 m0, s62, 11264
    s_nop 0
    buffer_load_dwordx4 v24, s[28:31], s26 offen lds
    s_waitcnt vmcnt(14)
    ds_read_b64_tr_b16 a[76:77], v35 offset:12288
    ds_read_b64_tr_b16 a[78:79], v35 offset:13824
    ds_read_b64_tr_b16 a[156:157], v35 offset:12320
    ds_read_b64_tr_b16 a[158:159], v35 offset:13856
    ds_read_b64_tr_b16 a[236:237], v35 offset:12352
    ds_read_b64_tr_b16 a[238:239], v35 offset:13888
    s_waitcnt lgkmcnt(0)
    s_add_u32 s26, s26, 393216
    s_add_u32 m0, s62, 12288
    s_nop 0
    buffer_load_dwordx4 v23, s[28:31], s26 offen lds
    s_add_u32 m0, s62, 13312
    s_nop 0
    buffer_load_dwordx4 v24, s[28:31], s26 offen lds
    s_waitcnt vmcnt(14)
    ds_read_b64_tr_b16 v[96:97], v36 offset:15360
    ds_read_b64_tr_b16 v[98:99], v36 offset:16384
    ds_read_b64_tr_b16 v[176:177], v36 offset:15392
    ds_read_b64_tr_b16 v[178:179], v36 offset:16416
    s_waitcnt lgkmcnt(0)
    s_add_u32 s26, s26, 393216
    s_add_u32 m0, s62, 14336
    s_nop 0
    buffer_load_dwordx4 v23, s[28:31], s26 offen lds
    s_add_u32 m0, s62, 15360
    s_nop 0
    buffer_load_dwordx4 v24, s[28:31], s26 offen lds
    s_waitcnt vmcnt(14)
    ds_read_b64_tr_b16 v[100:101], v36 offset:0
    ds_read_b64_tr_b16 v[102:103], v36 offset:1024
    ds_read_b64_tr_b16 v[180:181], v36 offset:32
    ds_read_b64_tr_b16 v[182:183], v36 offset:1056
    s_waitcnt lgkmcnt(0)
    s_add_u32 s26, s26, 393216
    s_add_u32 m0, s62, 0
    s_nop 0
    buffer_load_dwordx4 v23, s[28:31], s26 offen lds
    s_add_u32 m0, s62, 1024
    s_nop 0
    buffer_load_dwordx4 v24, s[28:31], s26 offen lds
    s_waitcnt vmcnt(14)
    ds_read_b64_tr_b16 v[104:105], v36 offset:2048
    ds_read_b64_tr_b16 v[106:107], v36 offset:3072
    ds_read_b64_tr_b16 v[184:185], v36 offset:2080
    ds_read_b64_tr_b16 v[186:187], v36 offset:3104
    s_waitcnt lgkmcnt(0)
    s_add_u32 s26, s26, 393216
    s_add_u32 m0, s62, 2048
    s_nop 0
    buffer_load_dwordx4 v23, s[28:31], s26 offen lds
    s_add_u32 m0, s62, 3072
    s_nop 0
    buffer_load_dwordx4 v24, s[28:31], s26 offen lds
    s_waitcnt vmcnt(14)
    ds_read_b64_tr_b16 v[108:109], v36 offset:4096
    ds_read_b64_tr_b16 v[110:111], v36 offset:5120
    ds_read_b64_tr_b16 v[188:189], v36 offset:4128
    ds_read_b64_tr_b16 v[190:191], v36 offset:5152
    s_waitcnt lgkmcnt(0)
    s_add_u32 s26, s26, 393216
    s_add_u32 m0, s62, 4096
    s_nop 0
    buffer_load_dwordx4 v23, s[28:31], s26 offen lds
    s_add_u32 m0, s62, 5120
    s_nop 0
    buffer_load_dwordx4 v24, s[28:31], s26 offen lds
    s_waitcnt vmcnt(14)
    ds_read_b64_tr_b16 v[112:113], v36 offset:6144
    ds_read_b64_tr_b16 v[114:115], v36 offset:7168
    ds_read_b64_tr_b16 v[192:193], v36 offset:6176
    ds_read_b64_tr_b16 v[194:195], v36 offset:7200
    s_waitcnt lgkmcnt(0)
    s_add_u32 s26, s26, 393216
    s_add_u32 m0, s62, 6144
    s_nop 0
    buffer_load_dwordx4 v23, s[28:31], s26 offen lds
    s_add_u32 m0, s62, 7168
    s_nop 0
    buffer_load_dwordx4 v24, s[28:31], s26 offen lds
    s_waitcnt vmcnt(14)
    ds_read_b64_tr_b16 v[116:117], v36 offset:8192
    ds_read_b64_tr_b16 v[118:119], v36 offset:9216
    ds_read_b64_tr_b16 v[196:197], v36 offset:8224
    ds_read_b64_tr_b16 v[198:199], v36 offset:9248
    s_waitcnt lgkmcnt(0)
    s_add_u32 s26, s26, 393216
    s_add_u32 m0, s62, 8192
    s_nop 0
    buffer_load_dwordx4 v23, s[28:31], s26 offen lds
    s_add_u32 m0, s62, 9216
    s_nop 0
    buffer_load_dwordx4 v24, s[28:31], s26 offen lds
    s_waitcnt vmcnt(14)
    ds_read_b64_tr_b16 v[120:121], v36 offset:10240
    ds_read_b64_tr_b16 v[122:123], v36 offset:11264
    ds_read_b64_tr_b16 v[200:201], v36 offset:10272
    ds_read_b64_tr_b16 v[202:203], v36 offset:11296
    s_waitcnt lgkmcnt(0)
    s_add_u32 s26, s26, 393216
    s_add_u32 m0, s62, 10240
    s_nop 0
    buffer_load_dwordx4 v23, s[28:31], s26 offen lds
    s_add_u32 m0, s62, 11264
    s_nop 0
    buffer_load_dwordx4 v24, s[28:31], s26 offen lds
    s_waitcnt vmcnt(14)
    ds_read_b64_tr_b16 v[124:125], v36 offset:12288
    ds_read_b64_tr_b16 v[126:127], v36 offset:13312
    ds_read_b64_tr_b16 v[204:205], v36 offset:12320
    ds_read_b64_tr_b16 v[206:207], v36 offset:13344
    s_waitcnt lgkmcnt(0)
    s_add_u32 s26, s26, 393216
    s_add_u32 m0, s62, 12288
    s_nop 0
    buffer_load_dwordx4 v23, s[28:31], s26 offen lds
    s_add_u32 m0, s62, 13312
    s_nop 0
    buffer_load_dwordx4 v24, s[28:31], s26 offen lds
    s_waitcnt vmcnt(14)
    ds_read_b64_tr_b16 v[128:129], v36 offset:14336
    ds_read_b64_tr_b16 v[130:131], v36 offset:15360
    ds_read_b64_tr_b16 v[208:209], v36 offset:14368
    ds_read_b64_tr_b16 v[210:211], v36 offset:15392
    s_waitcnt lgkmcnt(0)
    s_add_u32 s26, s26, 393216
    s_add_u32 m0, s62, 14336
    s_nop 0
    buffer_load_dwordx4 v23, s[28:31], s26 offen lds
    s_add_u32 m0, s62, 15360
    s_nop 0
    buffer_load_dwordx4 v24, s[28:31], s26 offen lds
    s_waitcnt vmcnt(14)
    ds_read_b64_tr_b16 v[132:133], v36 offset:0
    ds_read_b64_tr_b16 v[134:135], v36 offset:1024
    ds_read_b64_tr_b16 v[212:213], v36 offset:32
    ds_read_b64_tr_b16 v[214:215], v36 offset:1056
    s_waitcnt lgkmcnt(0)
    s_add_u32 s26, s26, 393216
    s_add_u32 m0, s62, 0
    s_nop 0
    buffer_load_dwordx4 v23, s[28:31], s26 offen lds
    s_add_u32 m0, s62, 1024
    s_nop 0
    buffer_load_dwordx4 v24, s[28:31], s26 offen lds
    s_waitcnt vmcnt(14)
    ds_read_b64_tr_b16 v[136:137], v36 offset:2048
    ds_read_b64_tr_b16 v[138:139], v36 offset:3072
    ds_read_b64_tr_b16 v[216:217], v36 offset:2080
    ds_read_b64_tr_b16 v[218:219], v36 offset:3104
    s_waitcnt lgkmcnt(0)
    s_add_u32 s26, s26, 393216
    s_add_u32 m0, s62, 2048
    s_nop 0
    buffer_load_dwordx4 v23, s[28:31], s26 offen lds
    s_add_u32 m0, s62, 3072
    s_nop 0
    buffer_load_dwordx4 v24, s[28:31], s26 offen lds
    s_waitcnt vmcnt(14)
    ds_read_b64_tr_b16 v[140:141], v36 offset:4096
    ds_read_b64_tr_b16 v[142:143], v36 offset:5120
    ds_read_b64_tr_b16 v[220:221], v36 offset:4128
    ds_read_b64_tr_b16 v[222:223], v36 offset:5152
    s_waitcnt lgkmcnt(0)
    s_add_u32 s26, s26, 393216
    s_add_u32 m0, s62, 4096
    s_nop 0
    buffer_load_dwordx4 v23, s[28:31], s26 offen lds
    s_add_u32 m0, s62, 5120
    s_nop 0
    buffer_load_dwordx4 v24, s[28:31], s26 offen lds
    s_waitcnt vmcnt(14)
    ds_read_b64_tr_b16 v[144:145], v36 offset:6144
    ds_read_b64_tr_b16 v[146:147], v36 offset:7168
    ds_read_b64_tr_b16 v[224:225], v36 offset:6176
    ds_read_b64_tr_b16 v[226:227], v36 offset:7200
    s_waitcnt lgkmcnt(0)
    s_waitcnt vmcnt(12)
    ds_read_b64_tr_b16 v[148:149], v36 offset:8192
    ds_read_b64_tr_b16 v[150:151], v36 offset:9216
    ds_read_b64_tr_b16 v[228:229], v36 offset:8224
    ds_read_b64_tr_b16 v[230:231], v36 offset:9248
    s_waitcnt lgkmcnt(0)
    s_waitcnt vmcnt(10)
    ds_read_b64_tr_b16 v[152:153], v36 offset:10240
    ds_read_b64_tr_b16 v[154:155], v36 offset:11264
    ds_read_b64_tr_b16 v[232:233], v36 offset:10272
    ds_read_b64_tr_b16 v[234:235], v36 offset:11296
    s_waitcnt lgkmcnt(0)
    s_waitcnt vmcnt(8)
    ds_read_b64_tr_b16 v[156:157], v36 offset:12288
    ds_read_b64_tr_b16 v[158:159], v36 offset:13312
    ds_read_b64_tr_b16 v[236:237], v36 offset:12320
    ds_read_b64_tr_b16 v[238:239], v36 offset:13344
    s_waitcnt lgkmcnt(0)
    s_waitcnt vmcnt(6)
    ds_read_b64_tr_b16 v[160:161], v36 offset:14336
    ds_read_b64_tr_b16 v[162:163], v36 offset:15360
    ds_read_b64_tr_b16 v[240:241], v36 offset:14368
    ds_read_b64_tr_b16 v[242:243], v36 offset:15392
    s_waitcnt lgkmcnt(0)
    s_add_u32 m0, s62, 6144
    s_nop 0
    buffer_load_dwordx4 v25, s[32:35], s27 offen lds
    s_add_u32 m0, s62, 7168
    s_nop 0
    buffer_load_dwordx4 v26, s[32:35], s27 offen lds
    s_add_u32 m0, s62, 8192
    s_nop 0
    buffer_load_dwordx4 v27, s[32:35], s27 offen lds
    s_add_u32 m0, s62, 9216
    s_nop 0
    buffer_load_dwordx4 v28, s[32:35], s27 offen lds
    s_add_u32 m0, s62, 10240
    s_nop 0
    buffer_load_dwordx4 v29, s[32:35], s27 offen lds
    s_add_u32 m0, s62, 11264
    s_nop 0
    buffer_load_dwordx4 v30, s[32:35], s27 offen lds
    s_add_u32 m0, s62, 12288
    s_nop 0
    buffer_load_dwordx4 v31, s[32:35], s27 offen lds
    s_add_u32 m0, s62, 13312
    s_nop 0
    buffer_load_dwordx4 v32, s[32:35], s27 offen lds
    s_add_u32 m0, s62, 14336
    s_nop 0
    buffer_load_dwordx4 v33, s[32:35], s27 offen lds
    s_add_u32 m0, s62, 15360
    s_nop 0
    buffer_load_dwordx4 v34, s[32:35], s27 offen lds
    s_waitcnt vmcnt(14)
    ds_read_b64_tr_b16 v[164:165], v36 offset:0
    ds_read_b64_tr_b16 v[166:167], v36 offset:1024
    ds_read_b64_tr_b16 v[244:245], v36 offset:32
    ds_read_b64_tr_b16 v[246:247], v36 offset:1056
    s_waitcnt lgkmcnt(0)
    s_waitcnt vmcnt(12)
    ds_read_b64_tr_b16 v[168:169], v36 offset:2048
    ds_read_b64_tr_b16 v[170:171], v36 offset:3072
    ds_read_b64_tr_b16 v[248:249], v36 offset:2080
    ds_read_b64_tr_b16 v[250:251], v36 offset:3104
    s_waitcnt lgkmcnt(0)
    s_waitcnt vmcnt(10)
    ds_read_b64_tr_b16 v[172:173], v36 offset:4096
    ds_read_b64_tr_b16 v[174:175], v36 offset:5120
    ds_read_b64_tr_b16 v[252:253], v36 offset:4128
    ds_read_b64_tr_b16 v[254:255], v36 offset:5152
    s_waitcnt lgkmcnt(0)
    s_waitcnt vmcnt(0)
    ds_read_b64_tr_b16 v[40:41], v37 offset:6144
    ds_read_b64_tr_b16 v[42:43], v37 offset:11264
    ds_read_b64_tr_b16 v[44:45], v37 offset:6176
    ds_read_b64_tr_b16 v[46:47], v37 offset:11296
    ds_read_b64_tr_b16 v[48:49], v37 offset:6208
    ds_read_b64_tr_b16 v[50:51], v37 offset:11328
    ds_read_b64_tr_b16 v[52:53], v37 offset:6240
    ds_read_b64_tr_b16 v[54:55], v37 offset:11360
    s_waitcnt lgkmcnt(0)
    ds_write_b128 v2, v[40:43] offset:0
    ds_write_b128 v2, v[44:47] offset:3072
    ds_write_b128 v2, v[48:51] offset:6144
    ds_write_b128 v2, v[52:55] offset:9216
    s_waitcnt lgkmcnt(0)
    ds_read_b64_tr_b16 v[40:41], v37 offset:6272
    ds_read_b64_tr_b16 v[42:43], v37 offset:11392
    ds_read_b64_tr_b16 v[44:45], v37 offset:6304
    ds_read_b64_tr_b16 v[46:47], v37 offset:11424
    ds_read_b64_tr_b16 v[48:49], v37 offset:6336
    ds_read_b64_tr_b16 v[50:51], v37 offset:11456
    ds_read_b64_tr_b16 v[52:53], v37 offset:6368
    ds_read_b64_tr_b16 v[54:55], v37 offset:11488
    s_waitcnt lgkmcnt(0)
    ds_write_b128 v2, v[40:43] offset:12288
    ds_write_b128 v2, v[44:47] offset:15360
    ds_write_b128 v2, v[48:51] offset:18432
    ds_write_b128 v2, v[52:55] offset:21504
    s_waitcnt lgkmcnt(0)
    ds_read_b64_tr_b16 v[40:41], v37 offset:6400
    ds_read_b64_tr_b16 v[42:43], v37 offset:11520
    ds_read_b64_tr_b16 v[44:45], v37 offset:6432
    ds_read_b64_tr_b16 v[46:47], v37 offset:11552
    s_waitcnt lgkmcnt(0)
    ds_write_b128 v2, v[40:43] offset:24576
    ds_write_b128 v2, v[44:47] offset:27648
    s_waitcnt lgkmcnt(0)
    s_add_u32 s27, s27, 40960
    s_add_u32 m0, s62, 0
    s_nop 0
    buffer_load_dwordx4 v25, s[32:35], s27 offen lds
    s_add_u32 m0, s62, 1024
    s_nop 0
    buffer_load_dwordx4 v26, s[32:35], s27 offen lds
    s_add_u32 m0, s62, 2048
    s_nop 0
    buffer_load_dwordx4 v27, s[32:35], s27 offen lds
    s_add_u32 m0, s62, 3072
    s_nop 0
    buffer_load_dwordx4 v28, s[32:35], s27 offen lds
    s_add_u32 m0, s62, 4096
    s_nop 0
    buffer_load_dwordx4 v29, s[32:35], s27 offen lds
    s_add_u32 m0, s62, 5120
    s_nop 0
    buffer_load_dwordx4 v30, s[32:35], s27 offen lds
    s_add_u32 m0, s62, 6144
    s_nop 0
    buffer_load_dwordx4 v31, s[32:35], s27 offen lds
    s_add_u32 m0, s62, 7168
    s_nop 0
    buffer_load_dwordx4 v32, s[32:35], s27 offen lds
    s_add_u32 m0, s62, 8192
    s_nop 0
    buffer_load_dwordx4 v33, s[32:35], s27 offen lds
    s_add_u32 m0, s62, 9216
    s_nop 0
    buffer_load_dwordx4 v34, s[32:35], s27 offen lds
    s_waitcnt vmcnt(0)
    ds_read_b64_tr_b16 v[40:41], v37 offset:0
    ds_read_b64_tr_b16 v[42:43], v37 offset:5120
    ds_read_b64_tr_b16 v[44:45], v37 offset:32
    ds_read_b64_tr_b16 v[46:47], v37 offset:5152
    ds_read_b64_tr_b16 v[48:49], v37 offset:64
    ds_read_b64_tr_b16 v[50:51], v37 offset:5184
    ds_read_b64_tr_b16 v[52:53], v37 offset:96
    ds_read_b64_tr_b16 v[54:55], v37 offset:5216
    s_waitcnt lgkmcnt(0)
    ds_write_b128 v2, v[40:43] offset:1024
    ds_write_b128 v2, v[44:47] offset:4096
    ds_write_b128 v2, v[48:51] offset:7168
    ds_write_b128 v2, v[52:55] offset:10240
    s_waitcnt lgkmcnt(0)
    ds_read_b64_tr_b16 v[40:41], v37 offset:128
    ds_read_b64_tr_b16 v[42:43], v37 offset:5248
    ds_read_b64_tr_b16 v[44:45], v37 offset:160
    ds_read_b64_tr_b16 v[46:47], v37 offset:5280
    ds_read_b64_tr_b16 v[48:49], v37 offset:192
    ds_read_b64_tr_b16 v[50:51], v37 offset:5312
    ds_read_b64_tr_b16 v[52:53], v37 offset:224
    ds_read_b64_tr_b16 v[54:55], v37 offset:5344
    s_waitcnt lgkmcnt(0)
    ds_write_b128 v2, v[40:43] offset:13312
    ds_write_b128 v2, v[44:47] offset:16384
    ds_write_b128 v2, v[48:51] offset:19456
    ds_write_b128 v2, v[52:55] offset:22528
    s_waitcnt lgkmcnt(0)
    ds_read_b64_tr_b16 v[40:41], v37 offset:256
    ds_read_b64_tr_b16 v[42:43], v37 offset:5376
    ds_read_b64_tr_b16 v[44:45], v37 offset:288
    ds_read_b64_tr_b16 v[46:47], v37 offset:5408
    s_waitcnt lgkmcnt(0)
    ds_write_b128 v2, v[40:43] offset:25600
    ds_write_b128 v2, v[44:47] offset:28672
    s_waitcnt lgkmcnt(0)
    s_add_u32 s27, s27, 40960
    s_add_u32 m0, s62, 0
    s_nop 0
    buffer_load_dwordx4 v25, s[32:35], s27 offen lds
    s_add_u32 m0, s62, 1024
    s_nop 0
    buffer_load_dwordx4 v26, s[32:35], s27 offen lds
    s_add_u32 m0, s62, 2048
    s_nop 0
    buffer_load_dwordx4 v27, s[32:35], s27 offen lds
    s_add_u32 m0, s62, 3072
    s_nop 0
    buffer_load_dwordx4 v28, s[32:35], s27 offen lds
    s_add_u32 m0, s62, 4096
    s_nop 0
    buffer_load_dwordx4 v29, s[32:35], s27 offen lds
    s_add_u32 m0, s62, 5120
    s_nop 0
    buffer_load_dwordx4 v30, s[32:35], s27 offen lds
    s_add_u32 m0, s62, 6144
    s_nop 0
    buffer_load_dwordx4 v31, s[32:35], s27 offen lds
    s_add_u32 m0, s62, 7168
    s_nop 0
    buffer_load_dwordx4 v32, s[32:35], s27 offen lds
    s_add_u32 m0, s62, 8192
    s_nop 0
    buffer_load_dwordx4 v33, s[32:35], s27 offen lds
    s_add_u32 m0, s62, 9216
    s_nop 0
    buffer_load_dwordx4 v34, s[32:35], s27 offen lds
    s_waitcnt vmcnt(0)
    ds_read_b64_tr_b16 v[40:41], v37 offset:0
    ds_read_b64_tr_b16 v[42:43], v37 offset:5120
    ds_read_b64_tr_b16 v[44:45], v37 offset:32
    ds_read_b64_tr_b16 v[46:47], v37 offset:5152
    ds_read_b64_tr_b16 v[48:49], v37 offset:64
    ds_read_b64_tr_b16 v[50:51], v37 offset:5184
    ds_read_b64_tr_b16 v[52:53], v37 offset:96
    ds_read_b64_tr_b16 v[54:55], v37 offset:5216
    s_waitcnt lgkmcnt(0)
    ds_write_b128 v2, v[40:43] offset:2048
    ds_write_b128 v2, v[44:47] offset:5120
    ds_write_b128 v2, v[48:51] offset:8192
    ds_write_b128 v2, v[52:55] offset:11264
    s_waitcnt lgkmcnt(0)
    ds_read_b64_tr_b16 v[40:41], v37 offset:128
    ds_read_b64_tr_b16 v[42:43], v37 offset:5248
    ds_read_b64_tr_b16 v[44:45], v37 offset:160
    ds_read_b64_tr_b16 v[46:47], v37 offset:5280
    ds_read_b64_tr_b16 v[48:49], v37 offset:192
    ds_read_b64_tr_b16 v[50:51], v37 offset:5312
    ds_read_b64_tr_b16 v[52:53], v37 offset:224
    ds_read_b64_tr_b16 v[54:55], v37 offset:5344
    s_waitcnt lgkmcnt(0)
    ds_write_b128 v2, v[40:43] offset:14336
    ds_write_b128 v2, v[44:47] offset:17408
    ds_write_b128 v2, v[48:51] offset:20480
    ds_write_b128 v2, v[52:55] offset:23552
    s_waitcnt lgkmcnt(0)
    ds_read_b64_tr_b16 v[40:41], v37 offset:256
    ds_read_b64_tr_b16 v[42:43], v37 offset:5376
    ds_read_b64_tr_b16 v[44:45], v37 offset:288
    ds_read_b64_tr_b16 v[46:47], v37 offset:5408
    s_waitcnt lgkmcnt(0)
    ds_write_b128 v2, v[40:43] offset:26624
    ds_write_b128 v2, v[44:47] offset:29696
    s_waitcnt lgkmcnt(0)
    v_and_b32 v10, 15, v0
    v_lshrrev_b32 v11, 4, v0
    v_and_b32 v12, 7, v0
    v_and_b32 v13, 1, v0
    v_mov_b32 v14, 0x3f80
    v_lshlrev_b32 v13, 4, v13
    v_lshlrev_b32 v14, v13, v14
    v_lshrrev_b32 v12, 1, v12
    v_lshrrev_b32 v13, 2, v10
    v_cmp_eq_u32 s[38:39], v13, v11
    v_bfe_u32 v13, v0, 1, 1
    s_nop 0
    v_cndmask_b32 v17, 0, v14, s[38:39]
    v_cmp_eq_u32 vcc, 0, v12
    s_nop 1
    v_cndmask_b32 v15, 0, v14, vcc
    v_accvgpr_write_b32 a248, v15
    v_cmp_eq_u32 vcc, 0, v13
    s_nop 1
    v_cndmask_b32 v16, 0, v17, vcc
    v_accvgpr_write_b32 a240, v16
    v_accvgpr_write_b32 a244, 0
    v_cmp_eq_u32 vcc, 1, v12
    s_nop 1
    v_cndmask_b32 v15, 0, v14, vcc
    v_accvgpr_write_b32 a249, v15
    v_cmp_eq_u32 vcc, 1, v13
    s_nop 1
    v_cndmask_b32 v16, 0, v17, vcc
    v_accvgpr_write_b32 a241, v16
    v_accvgpr_write_b32 a245, 0
    v_cmp_eq_u32 vcc, 2, v12
    s_nop 1
    v_cndmask_b32 v15, 0, v14, vcc
    v_accvgpr_write_b32 a250, v15
    v_cmp_eq_u32 vcc, 0, v13
    s_nop 1
    v_cndmask_b32 v16, 0, v17, vcc
    v_accvgpr_write_b32 a246, v16
    v_accvgpr_write_b32 a242, 0
    v_cmp_eq_u32 vcc, 3, v12
    s_nop 1
    v_cndmask_b32 v15, 0, v14, vcc
    v_accvgpr_write_b32 a251, v15
    v_cmp_eq_u32 vcc, 1, v13
    s_nop 1
    v_cndmask_b32 v16, 0, v17, vcc
    v_accvgpr_write_b32 a247, v16
    v_accvgpr_write_b32 a243, 0
    v_cmp_gt_u32 s[48:49], 8, v10
    v_cmp_gt_u32 vcc, 2, v11
    s_xnor_b64 s[50:51], vcc, s[48:49]
    s_mul_i32 s60, s15, 640
    s_mov_b32 s61, 20480
    v_add_u32 v12, 320, v0
    v_mul_u32_u24 v13, 52429, v12
    v_lshrrev_b32 v13, 21, v13
    v_mul_u32_u24 v14, 40, v13
    v_sub_u32 v14, v12, v14
    v_mul_lo_u32 v13, v13, s61
    v_lshl_add_u32 v13, v14, 4, v13
    v_add_u32 v3, s60, v13
    v_add_u32 v12, 384, v0
    v_mul_u32_u24 v13, 52429, v12
    v_lshrrev_b32 v13, 21, v13
    v_mul_u32_u24 v14, 40, v13
    v_sub_u32 v14, v12, v14
    v_mul_lo_u32 v13, v13, s61
    v_lshl_add_u32 v13, v14, 4, v13
    v_add_u32 v4, s60, v13
    v_add_u32 v12, 448, v0
    v_mul_u32_u24 v13, 52429, v12
    v_lshrrev_b32 v13, 21, v13
    v_mul_u32_u24 v14, 40, v13
    v_sub_u32 v14, v12, v14
    v_mul_lo_u32 v13, v13, s61
    v_lshl_add_u32 v13, v14, 4, v13
    v_add_u32 v5, s60, v13
    v_add_u32 v12, 512, v0
    v_mul_u32_u24 v13, 52429, v12
    v_lshrrev_b32 v13, 21, v13
    v_mul_u32_u24 v14, 40, v13
    v_sub_u32 v14, v12, v14
    v_mul_lo_u32 v13, v13, s61
    v_lshl_add_u32 v13, v14, 4, v13
    v_add_u32 v6, s60, v13
    v_add_u32 v12, 576, v0
    v_mul_u32_u24 v13, 52429, v12
    v_lshrrev_b32 v13, 21, v13
    v_mul_u32_u24 v14, 40, v13
    v_sub_u32 v14, v12, v14
    v_mul_lo_u32 v13, v13, s61
    v_lshl_add_u32 v13, v14, 4, v13
    v_add_u32 v7, s60, v13
    s_mul_i32 s60, s15, 20480
    s_add_u32 s60, s60, 256
    v_lshrrev_b32 v12, 4, v0
    v_mul_u32_u24 v12, 640, v12
    v_and_b32 v13, 15, v0
    v_lshl_add_u32 v12, v13, 4, v12
    v_add_u32 v8, s60, v12
    s_mul_i32 s60, s15, 40
    s_add_u32 s60, s60, 16
    v_add_u32 v12, s60, v10
    v_lshlrev_b32 v9, 4, v12
    s_mul_i32 s32, s14, 655360
    s_add_u32 s32, s32, 1310720
    s_add_u32 s33, s32, 5120
    s_add_u32 s34, s32, 10240
    s_add_u32 s35, s32, 15360
    s_mov_b32 s52, 1037384597
    s_mov_b32 s53, 1037384597
    s_lshl_b32 s29, s13, 12
    s_add_u32 s29, s29, 918528
    s_xor_b32 s30, s29, 4096
    s_mov_b64 s[46:47], 65535
    s_mov_b32 s8, s66
    s_and_b32 s9, s67, 0xffff
    s_mov_b32 s10, 10240
    s_mov_b32 s11, 0x20000
    v_and_b32 v13, 7, v12
    v_mul_u32_u24 v13, 1280, v13
    v_lshrrev_b32 v14, 6, v12
    v_lshl_add_u32 v13, v14, 6, v13
    v_bfe_u32 v14, v12, 4, 2
    v_lshl_add_u32 v13, v14, 3, v13
    v_and_b32 v14, 8, v12
    v_cmp_eq_u32 s[38:39], 0, v14
    v_cmp_ne_u32 s[40:41], 0, v14
    s_cmp_eq_u32 s14, 0
    s_cselect_b32 s10, 10240, 0
    buffer_load_dwordx2 v[16:17], v13, s[8:11], 0 offen
    buffer_load_dwordx2 v[18:19], v13, s[8:11], 0 offen offset:32
    s_waitcnt vmcnt(0)
    v_accvgpr_write_b32 a252, v16
    v_accvgpr_write_b32 a253, v17
    v_accvgpr_write_b32 a254, v18
    v_accvgpr_write_b32 a255, v19
    s_lshl_b32 s3, s18, 2
    s_add_u32 s3, s3, 64
    v_mov_b32 v92, s3
    v_lshlrev_b32 v94, 2, v0
    v_and_b32 v94, 28, v94
    s_mov_b32 s19, 0
L_R1_warr_2:
    global_load_dword v93, v92, s[16:17] sc1
    s_add_u32 s19, s19, 1
    s_cmp_ge_u32 s19, 524288
    s_cbranch_scc1 L_fail
    s_waitcnt vmcnt(0)
    v_cmp_gt_u32 vcc, 256, v93
    s_nop 0
    s_cbranch_vccnz L_R1_warr_2
    s_cmp_lg_u32 s18, 0
    s_cbranch_scc1 L_R1_placed_3
    global_load_dword v93, v94, s[16:17] sc1
    s_waitcnt vmcnt(0)
    v_cmp_ne_u32 vcc, 32, v93
    s_nop 0
    s_cbranch_vccnz L_fallback
L_R1_placed_3:
    v_lshlrev_b32 v0, 4, v0
    s_mov_b32 s20, 0
    s_barrier
    v_or_b32 v16, 1, v16
    s_lshl_b32 s60, s14, 15
    s_add_u32 s60, s60, 1179648
    s_mul_i32 s61, s14, 20480
    s_add_u32 s61, s61, 2621440
    s_mov_b64 exec, s[46:47]
    buffer_store_dwordx4 v[16:19], v9, s[4:7], s60 offen sc1
    buffer_store_dwordx4 v[16:19], v9, s[4:7], s61 offen sc1
    s_mov_b64 exec, -1
    s_waitcnt vmcnt(0)
    s_add_u32 s60, s20, 1
    s_and_b32 s22, s60, 1
    s_lshl_b32 s21, s22, 31
    s_sub_u32 s44, 0, s22
    s_bfe_u32 s23, s20, 0x10001
    s_sub_u32 s23, s23, 1
    s_lshr_b32 s24, s60, 1
    s_andn2_b32 s24, 1, s24
    s_lshl_b32 s61, s14, 15
    s_add_u32 s61, s61, 1179648
    s_and_b32 s25, s20, 1
    s_lshl_b32 s25, s25, 16
    s_add_u32 s25, s25, s61
    s_add_u32 s25, s25, 5120
    s_add_u32 s26, s25, 4096
    s_lshl_b32 s36, s22, 16
    s_add_u32 s36, s36, s61
    s_lshl_b32 s27, s20, 1
    s_add_u32 s37, s27, 2
    s_add_u32 s37, s37, s14
    s_mul_i32 s37, s37, 20480
    s_add_u32 s37, s37, 2621440
    s_add_u32 s27, s27, 1
    s_sub_u32 s27, s27, s14
    s_mul_i32 s27, s27, 20480
    s_add_u32 s27, s27, 2626560
    s_add_u32 s28, s27, 4096
    s_lshl_b32 s31, s20, 6
    s_add_u32 s31, s31, s13
    s_mul_i32 s31, s31, 6144
    s_add_u32 s31, s31, 5898240
    s_min_u32 s56, s20, 63
    s_lshl_b32 s56, s56, 6
    s_add_u32 s56, s56, s13
    s_mul_i32 s56, s56, 12288
    s_add_u32 s56, s56, 37364736
    s_max_u32 s57, s20, 7
    s_sub_u32 s57, s57, 7
    s_lshl_b32 s57, s57, 6
    s_add_u32 s57, s57, s13
    s_mul_i32 s57, s57, 12288
    s_add_u32 s57, s57, 87696384
    s_cmp_lt_u32 s20, 7
    s_cselect_b32 s57, s56, s57
    s_cmp_gt_u32 s60, 63
    s_cselect_b64 s[42:43], s[38:39], 0
    s_cmp_le_u32 s60, 7
    s_cselect_b64 vcc, s[40:41], 0
    s_or_b64 s[42:43], s[42:43], vcc
    s_cmp_lg_u32 s18, 0
    s_cbranch_scc1 L_R1_slow
L_Rf1_top:
    s_barrier
    buffer_load_dwordx4 v[10:13], v0, s[4:7], s25 offen offset:0 sc1
    buffer_load_dwordx4 v[14:17], v0, s[4:7], s25 offen offset:1024 sc1
    buffer_load_dwordx4 v[18:21], v0, s[4:7], s25 offen offset:2048 sc1
    buffer_load_dwordx4 v[22:25], v0, s[4:7], s25 offen offset:3072 sc1
    buffer_load_dwordx4 v[26:29], v0, s[4:7], s26 offen offset:0 sc1
    s_barrier
    buffer_load_dwordx4 v[46:49], v0, s[4:7], s27 offen offset:0 sc1
    buffer_load_dwordx4 v[30:33], v0, s[4:7], s27 offen offset:1024 sc1
    buffer_load_dwordx4 v[34:37], v0, s[4:7], s27 offen offset:2048 sc1
    buffer_load_dwordx4 v[38:41], v0, s[4:7], s27 offen offset:3072 sc1
    buffer_load_dwordx4 v[42:45], v0, s[4:7], s28 offen offset:0 sc1
    s_mov_b32 s19, 0
L_Rf1_gl_1:
    s_waitcnt vmcnt(9)
    v_mfma_f32_16x16x32_bf16 v[50:53], a[240:243], v[10:13], 0
    v_mfma_f32_16x16x32_bf16 v[54:57], a[244:247], v[10:13], 0
    v_xor_b32 v1, s23, v10
    s_waitcnt vmcnt(8)
    v_mfma_f32_16x16x32_bf16 v[58:61], a[240:243], v[14:17], 0
    v_mfma_f32_16x16x32_bf16 v[62:65], a[244:247], v[14:17], 0
    v_bitop3_b32 v1, v1, v14, s23 bitop3:0xf6
    s_waitcnt vmcnt(7)
    v_mfma_f32_16x16x32_bf16 v[66:69], a[240:243], v[18:21], 0
    v_mfma_f32_16x16x32_bf16 v[70:73], a[244:247], v[18:21], 0
    v_bitop3_b32 v1, v1, v18, s23 bitop3:0xf6
    s_waitcnt vmcnt(6)
    v_mfma_f32_16x16x32_bf16 v[74:77], a[240:243], v[22:25], 0
    v_mfma_f32_16x16x32_bf16 v[78:81], a[244:247], v[22:25], 0
    v_bitop3_b32 v1, v1, v22, s23 bitop3:0xf6
    s_waitcnt vmcnt(5)
    v_mfma_f32_16x16x32_bf16 v[82:85], a[240:243], v[26:29], 0
    v_mfma_f32_16x16x32_bf16 v[86:89], a[244:247], v[26:29], 0
    v_bitop3_b32 v1, v1, v26, s23 bitop3:0xf6
    v_and_b32 v1, 1, v1
    v_cmp_ne_u32 vcc, 0, v1
    s_nop 0
    s_cbranch_vccnz L_Rf1_glfix_3
L_Rf1_gr_2:
    s_waitcnt vmcnt(4)
    v_mfma_f32_16x16x32_bf16 v[50:53], a[240:243], v[46:49], v[50:53]
    v_xor_b32 v1, s23, v46
    v_mfma_f32_16x16x32_bf16 v[54:57], a[244:247], v[46:49], v[54:57]
    s_waitcnt vmcnt(3)
    v_mfma_f32_16x16x32_bf16 v[58:61], a[240:243], v[30:33], v[58:61]
    v_bitop3_b32 v1, v1, v30, s23 bitop3:0xf6
    v_mfma_f32_16x16x32_bf16 v[62:65], a[244:247], v[30:33], v[62:65]
    s_nop 1
    v_cvt_pk_bf16_f32 v90, v50, v51
    v_cvt_pk_bf16_f32 v91, v52, v53
    v_cvt_pk_bf16_f32 v92, v54, v55
    v_cvt_pk_bf16_f32 v93, v56, v57
    ds_write_b128 v0, v[90:93] offset:5120
    s_waitcnt vmcnt(2)
    v_mfma_f32_16x16x32_bf16 v[66:69], a[240:243], v[34:37], v[66:69]
    v_bitop3_b32 v1, v1, v34, s23 bitop3:0xf6
    v_mfma_f32_16x16x32_bf16 v[70:73], a[244:247], v[34:37], v[70:73]
    v_cvt_pk_bf16_f32 v90, v58, v59
    v_cvt_pk_bf16_f32 v91, v60, v61
    v_cvt_pk_bf16_f32 v92, v62, v63
    v_cvt_pk_bf16_f32 v93, v64, v65
    ds_write_b128 v0, v[90:93] offset:6144
    s_waitcnt vmcnt(1)
    v_mfma_f32_16x16x32_bf16 v[74:77], a[240:243], v[38:41], v[74:77]
    v_bitop3_b32 v1, v1, v38, s23 bitop3:0xf6
    v_mfma_f32_16x16x32_bf16 v[78:81], a[244:247], v[38:41], v[78:81]
    v_cvt_pk_bf16_f32 v90, v66, v67
    v_cvt_pk_bf16_f32 v91, v68, v69
    v_cvt_pk_bf16_f32 v92, v70, v71
    v_cvt_pk_bf16_f32 v93, v72, v73
    ds_write_b128 v0, v[90:93] offset:7168
    s_waitcnt vmcnt(0)
    v_mfma_f32_16x16x32_bf16 v[82:85], a[240:243], v[42:45], v[82:85]
    v_bitop3_b32 v1, v1, v42, s23 bitop3:0xf6
    v_mfma_f32_16x16x32_bf16 v[86:89], a[244:247], v[42:45], v[86:89]
    v_cvt_pk_bf16_f32 v90, v74, v75
    v_cvt_pk_bf16_f32 v91, v76, v77
    v_cvt_pk_bf16_f32 v92, v78, v79
    v_cvt_pk_bf16_f32 v93, v80, v81
    ds_write_b128 v0, v[90:93] offset:8192
    s_nop 0
    v_cvt_pk_bf16_f32 v90, v82, v83
    v_cvt_pk_bf16_f32 v91, v84, v85
    v_cvt_pk_bf16_f32 v92, v86, v87
    v_cvt_pk_bf16_f32 v93, v88, v89
    ds_write_b128 v0, v[90:93] offset:9216
    v_and_b32 v1, 1, v1
    v_cmp_ne_u32 vcc, 0, v1
    s_nop 0
    s_cbranch_vccnz L_Rf1_grfix_5
    s_waitcnt lgkmcnt(0)
    s_barrier
    ds_read_b128 v[10:13], v0 offset:0
    ds_read_b128 v[14:17], v0 offset:1024
    ds_read_b128 v[18:21], v0 offset:2048
    ds_read_b128 v[22:25], v0 offset:3072
    ds_read_b128 v[26:29], v0 offset:4096
    s_waitcnt lgkmcnt(4)
    v_mfma_f32_16x16x32_bf16 v[46:49], a[0:3], v[10:13], 0
    s_mov_b32 m0, 38912
    v_mfma_f32_16x16x32_bf16 v[50:53], a[80:83], v[10:13], 0
    v_mfma_f32_16x16x32_bf16 v[54:57], a[160:163], v[10:13], 0
    ds_read_b128 v[10:13], v0 offset:5120
    s_waitcnt lgkmcnt(4)
    v_mfma_f32_16x16x32_bf16 v[46:49], a[4:7], v[14:17], v[46:49]
    buffer_load_dwordx4 v0, s[4:7], s56 offen offset:0 sc1 lds
    v_mfma_f32_16x16x32_bf16 v[50:53], a[84:87], v[14:17], v[50:53]
    v_mfma_f32_16x16x32_bf16 v[54:57], a[164:167], v[14:17], v[54:57]
    ds_read_b128 v[14:17], v0 offset:6144
    s_waitcnt lgkmcnt(4)
    v_mfma_f32_16x16x32_bf16 v[46:49], a[8:11], v[18:21], v[46:49]
    buffer_load_dwordx4 v0, s[4:7], s56 offen offset:1024 sc1 lds
    v_mfma_f32_16x16x32_bf16 v[50:53], a[88:91], v[18:21], v[50:53]
    v_mfma_f32_16x16x32_bf16 v[54:57], a[168:171], v[18:21], v[54:57]
    ds_read_b128 v[18:21], v0 offset:7168
    s_waitcnt lgkmcnt(4)
    v_mfma_f32_16x16x32_bf16 v[46:49], a[12:15], v[22:25], v[46:49]
    buffer_load_dwordx4 v0, s[4:7], s56 offen offset:2048 sc1 lds
    v_mfma_f32_16x16x32_bf16 v[50:53], a[92:95], v[22:25], v[50:53]
    v_mfma_f32_16x16x32_bf16 v[54:57], a[172:175], v[22:25], v[54:57]
    ds_read_b128 v[22:25], v0 offset:8192
    s_waitcnt lgkmcnt(4)
    v_mfma_f32_16x16x32_bf16 v[46:49], a[16:19], v[26:29], v[46:49]
    v_mfma_f32_16x16x32_bf16 v[50:53], a[96:99], v[26:29], v[50:53]
    v_mfma_f32_16x16x32_bf16 v[54:57], a[176:179], v[26:29], v[54:57]
    ds_read_b128 v[26:29], v0 offset:9216
    s_waitcnt lgkmcnt(4)
    v_mfma_f32_16x16x32_bf16 v[46:49], a[20:23], v[10:13], v[46:49]
    v_mfma_f32_16x16x32_bf16 v[50:53], a[100:103], v[10:13], v[50:53]
    v_mfma_f32_16x16x32_bf16 v[54:57], a[180:183], v[10:13], v[54:57]
    ds_read_b128 v[10:13], v0 offset:10240
    s_waitcnt lgkmcnt(4)
    v_mfma_f32_16x16x32_bf16 v[46:49], a[24:27], v[14:17], v[46:49]
    v_mfma_f32_16x16x32_bf16 v[50:53], a[104:107], v[14:17], v[50:53]
    v_mfma_f32_16x16x32_bf16 v[54:57], a[184:187], v[14:17], v[54:57]
    ds_read_b128 v[14:17], v0 offset:11264
    s_waitcnt lgkmcnt(4)
    v_mfma_f32_16x16x32_bf16 v[46:49], a[28:31], v[18:21], v[46:49]
    v_mfma_f32_16x16x32_bf16 v[50:53], a[108:111], v[18:21], v[50:53]
    v_mfma_f32_16x16x32_bf16 v[54:57], a[188:191], v[18:21], v[54:57]
    ds_read_b128 v[18:21], v0 offset:12288
    s_waitcnt lgkmcnt(4)
    v_mfma_f32_16x16x32_bf16 v[46:49], a[32:35], v[22:25], v[46:49]
    v_mfma_f32_16x16x32_bf16 v[50:53], a[112:115], v[22:25], v[50:53]
    v_mfma_f32_16x16x32_bf16 v[54:57], a[192:195], v[22:25], v[54:57]
    ds_read_b128 v[22:25], v0 offset:13312
    s_waitcnt lgkmcnt(4)
    v_mfma_f32_16x16x32_bf16 v[46:49], a[36:39], v[26:29], v[46:49]
    v_mfma_f32_16x16x32_bf16 v[50:53], a[116:119], v[26:29], v[50:53]
    v_mfma_f32_16x16x32_bf16 v[54:57], a[196:199], v[26:29], v[54:57]
    ds_read_b128 v[26:29], v0 offset:14336
    s_waitcnt lgkmcnt(4)
    v_mfma_f32_16x16x32_bf16 v[46:49], a[40:43], v[10:13], v[46:49]
    v_mfma_f32_16x16x32_bf16 v[50:53], a[120:123], v[10:13], v[50:53]
    v_mfma_f32_16x16x32_bf16 v[54:57], a[200:203], v[10:13], v[54:57]
    ds_read_b128 v[10:13], v0 offset:15360
    s_waitcnt lgkmcnt(4)
    v_mfma_f32_16x16x32_bf16 v[46:49], a[44:47], v[14:17], v[46:49]
    ds_read_b128 v[58:61], v0 offset:29696
    v_mfma_f32_16x16x32_bf16 v[50:53], a[124:127], v[14:17], v[50:53]
    v_mfma_f32_16x16x32_bf16 v[54:57], a[204:207], v[14:17], v[54:57]
    ds_read_b128 v[14:17], v0 offset:16384
    s_waitcnt lgkmcnt(5)
    v_mfma_f32_16x16x32_bf16 v[46:49], a[48:51], v[18:21], v[46:49]
    ds_read_b128 v[62:65], v0 offset:30720
    v_mfma_f32_16x16x32_bf16 v[50:53], a[128:131], v[18:21], v[50:53]
    v_mfma_f32_16x16x32_bf16 v[54:57], a[208:211], v[18:21], v[54:57]
    ds_read_b128 v[18:21], v0 offset:17408
    s_waitcnt lgkmcnt(6)
    v_mfma_f32_16x16x32_bf16 v[46:49], a[52:55], v[22:25], v[46:49]
    ds_read_b128 v[66:69], v0 offset:31744
    v_mfma_f32_16x16x32_bf16 v[50:53], a[132:135], v[22:25], v[50:53]
    v_mfma_f32_16x16x32_bf16 v[54:57], a[212:215], v[22:25], v[54:57]
    ds_read_b128 v[22:25], v0 offset:18432
    s_waitcnt lgkmcnt(7)
    v_mfma_f32_16x16x32_bf16 v[46:49], a[56:59], v[26:29], v[46:49]
    ds_read_b128 v[70:73], v0 offset:41984
    v_mfma_f32_16x16x32_bf16 v[50:53], a[136:139], v[26:29], v[50:53]
    v_mfma_f32_16x16x32_bf16 v[54:57], a[216:219], v[26:29], v[54:57]
    ds_read_b128 v[26:29], v0 offset:19456
    s_waitcnt lgkmcnt(8)
    v_mfma_f32_16x16x32_bf16 v[46:49], a[60:63], v[10:13], v[46:49]
    ds_read_b128 v[74:77], v0 offset:43008
    v_mfma_f32_16x16x32_bf16 v[50:53], a[140:143], v[10:13], v[50:53]
    v_mfma_f32_16x16x32_bf16 v[54:57], a[220:223], v[10:13], v[54:57]
    ds_read_b128 v[10:13], v0 offset:0
    s_waitcnt lgkmcnt(8)
    v_mfma_f32_16x16x32_bf16 v[46:49], a[64:67], v[14:17], v[46:49]
    ds_read_b128 v[78:81], v0 offset:44032
    v_mfma_f32_16x16x32_bf16 v[50:53], a[144:147], v[14:17], v[50:53]
    v_mfma_f32_16x16x32_bf16 v[54:57], a[224:227], v[14:17], v[54:57]
    ds_read_b128 v[14:17], v0 offset:1024
    s_waitcnt lgkmcnt(8)
    v_mfma_f32_16x16x32_bf16 v[46:49], a[68:71], v[18:21], v[46:49]
    v_mfma_f32_16x16x32_bf16 v[50:53], a[148:151], v[18:21], v[50:53]
    v_mfma_f32_16x16x32_bf16 v[54:57], a[228:231], v[18:21], v[54:57]
    ds_read_b128 v[18:21], v0 offset:2048
    s_waitcnt lgkmcnt(7)
    v_mfma_f32_16x16x32_bf16 v[46:49], a[72:75], v[22:25], v[46:49]
    v_mfma_f32_16x16x32_bf16 v[50:53], a[152:155], v[22:25], v[50:53]
    v_mfma_f32_16x16x32_bf16 v[54:57], a[232:235], v[22:25], v[54:57]
    ds_read_b128 v[22:25], v0 offset:3072
    s_waitcnt lgkmcnt(6)
    v_mfma_f32_16x16x32_bf16 v[46:49], a[76:79], v[26:29], v[46:49]
    v_mfma_f32_16x16x32_bf16 v[50:53], a[156:159], v[26:29], v[50:53]
    v_mfma_f32_16x16x32_bf16 v[54:57], a[236:239], v[26:29], v[54:57]
    ds_read_b128 v[26:29], v0 offset:4096
    s_waitcnt lgkmcnt(5)
    v_mfma_f32_16x16x32_bf16 v[30:33], v[10:13], v[96:99], 0
    v_mfma_f32_16x16x32_bf16 v[34:37], v[10:13], v[176:179], 0
    ds_read_b128 v[10:13], v0 offset:5120
    s_nop 0
    v_cvt_pk_bf16_f32 v82, v46, v47
    v_cvt_pk_bf16_f32 v83, v48, v49
    ds_write_b64 v0, v[82:83] offset:21512
    v_cvt_pk_bf16_f32 v84, v50, v51
    v_cvt_pk_bf16_f32 v85, v52, v53
    ds_write_b64 v0, v[84:85] offset:22528
    v_cvt_pk_bf16_f32 v86, v54, v55
    v_cvt_pk_bf16_f32 v87, v56, v57
    ds_write_b64 v0, v[86:87] offset:22536
    s_waitcnt lgkmcnt(7)
    v_mfma_f32_16x16x32_bf16 v[30:33], v[14:17], v[100:103], v[30:33]
    v_mfma_f32_16x16x32_bf16 v[34:37], v[14:17], v[180:183], v[34:37]
    ds_read_b128 v[14:17], v0 offset:6144
    s_waitcnt lgkmcnt(1)
    s_barrier
    ds_read_b128 v[46:49], v0 offset:20480
    ds_read_b128 v[50:53], v0 offset:21504
    ds_read_b128 v[54:57], v0 offset:22528
    v_mfma_f32_16x16x32_bf16 v[30:33], v[18:21], v[104:107], v[30:33]
    v_mfma_f32_16x16x32_bf16 v[34:37], v[18:21], v[184:187], v[34:37]
    ds_read_b128 v[18:21], v0 offset:7168
    v_mfma_f32_16x16x32_bf16 v[30:33], v[22:25], v[108:111], v[30:33]
    v_mfma_f32_16x16x32_bf16 v[34:37], v[22:25], v[188:191], v[34:37]
    ds_read_b128 v[22:25], v0 offset:8192
    s_waitcnt lgkmcnt(4)
    v_mfma_f32_16x16x32_bf16 v[38:41], v[58:61], v[46:49], 0
    v_mfma_f32_16x16x32_bf16 v[42:45], v[70:73], v[46:49], 0
    s_waitcnt lgkmcnt(3)
    v_mfma_f32_16x16x32_bf16 v[38:41], v[62:65], v[50:53], v[38:41]
    v_mfma_f32_16x16x32_bf16 v[42:45], v[74:77], v[50:53], v[42:45]
    s_waitcnt lgkmcnt(2)
    v_mfma_f32_16x16x32_bf16 v[38:41], v[66:69], v[54:57], v[38:41]
    v_mfma_f32_16x16x32_bf16 v[42:45], v[78:81], v[54:57], v[42:45]
    v_mfma_f32_16x16x32_bf16 v[30:33], v[26:29], v[112:115], v[30:33]
    v_mfma_f32_16x16x32_bf16 v[34:37], v[26:29], v[192:195], v[34:37]
    ds_read_b128 v[26:29], v0 offset:9216
    s_nop 4
    v_cndmask_b32 v38, v42, v38, s[48:49]
    v_cndmask_b32 v39, v43, v39, s[48:49]
    v_cndmask_b32 v40, v44, v40, s[48:49]
    v_cndmask_b32 v41, v45, v41, s[48:49]
    v_and_or_b32 v38, v38, -2, s22
    buffer_store_dwordx4 v[38:41], v0, s[4:7], s29 offen
    v_mfma_f32_16x16x32_bf16 v[30:33], v[10:13], v[116:119], v[30:33]
    v_mfma_f32_16x16x32_bf16 v[34:37], v[10:13], v[196:199], v[34:37]
    ds_read_b128 v[10:13], v0 offset:10240
    v_mfma_f32_16x16x32_bf16 v[30:33], v[14:17], v[120:123], v[30:33]
    v_mfma_f32_16x16x32_bf16 v[34:37], v[14:17], v[200:203], v[34:37]
    ds_read_b128 v[14:17], v0 offset:11264
    s_waitcnt lgkmcnt(4)
    v_mfma_f32_16x16x32_bf16 v[30:33], v[18:21], v[124:127], v[30:33]
    v_mfma_f32_16x16x32_bf16 v[34:37], v[18:21], v[204:207], v[34:37]
    ds_read_b128 v[18:21], v0 offset:12288
    s_waitcnt lgkmcnt(4)
    v_mfma_f32_16x16x32_bf16 v[30:33], v[22:25], v[128:131], v[30:33]
    v_mfma_f32_16x16x32_bf16 v[34:37], v[22:25], v[208:211], v[34:37]
    ds_read_b128 v[22:25], v0 offset:13312
    s_waitcnt lgkmcnt(4)
    v_mfma_f32_16x16x32_bf16 v[30:33], v[26:29], v[132:135], v[30:33]
    v_mfma_f32_16x16x32_bf16 v[34:37], v[26:29], v[212:215], v[34:37]
    ds_read_b128 v[26:29], v0 offset:14336
    s_waitcnt lgkmcnt(4)
    v_mfma_f32_16x16x32_bf16 v[30:33], v[10:13], v[136:139], v[30:33]
    v_mfma_f32_16x16x32_bf16 v[34:37], v[10:13], v[216:219], v[34:37]
    ds_read_b128 v[10:13], v0 offset:15360
    s_waitcnt lgkmcnt(4)
    v_mfma_f32_16x16x32_bf16 v[30:33], v[14:17], v[140:143], v[30:33]
    v_mfma_f32_16x16x32_bf16 v[34:37], v[14:17], v[220:223], v[34:37]
    ds_read_b128 v[14:17], v0 offset:16384
    s_waitcnt lgkmcnt(4)
    v_mfma_f32_16x16x32_bf16 v[30:33], v[18:21], v[144:147], v[30:33]
    v_mfma_f32_16x16x32_bf16 v[34:37], v[18:21], v[224:227], v[34:37]
    ds_read_b128 v[18:21], v0 offset:17408
    s_waitcnt lgkmcnt(4)
    v_mfma_f32_16x16x32_bf16 v[30:33], v[22:25], v[148:151], v[30:33]
    v_mfma_f32_16x16x32_bf16 v[34:37], v[22:25], v[228:231], v[34:37]
    ds_read_b128 v[22:25], v0 offset:18432
    v_pk_mul_f32 v[42:43], v[38:39], s[52:53]
    v_pk_mul_f32 v[44:45], v[40:41], s[52:53]
    s_waitcnt vmcnt(0)
    buffer_load_dwordx4 v[82:85], v0, s[4:7], s30 offen sc1
    s_mov_b32 s19, 0
    s_waitcnt lgkmcnt(4)
    v_mfma_f32_16x16x32_bf16 v[30:33], v[26:29], v[152:155], v[30:33]
    v_mfma_f32_16x16x32_bf16 v[34:37], v[26:29], v[232:235], v[34:37]
    ds_read_b128 v[26:29], v0 offset:19456
    s_waitcnt lgkmcnt(4)
    v_mfma_f32_16x16x32_bf16 v[30:33], v[10:13], v[156:159], v[30:33]
    v_mfma_f32_16x16x32_bf16 v[34:37], v[10:13], v[236:239], v[34:37]
    s_waitcnt lgkmcnt(3)
    v_mfma_f32_16x16x32_bf16 v[30:33], v[14:17], v[160:163], v[30:33]
    v_mfma_f32_16x16x32_bf16 v[34:37], v[14:17], v[240:243], v[34:37]
    s_waitcnt lgkmcnt(2)
    v_mfma_f32_16x16x32_bf16 v[30:33], v[18:21], v[164:167], v[30:33]
    v_mfma_f32_16x16x32_bf16 v[34:37], v[18:21], v[244:247], v[34:37]
    s_waitcnt lgkmcnt(1)
    v_mfma_f32_16x16x32_bf16 v[30:33], v[22:25], v[168:171], v[30:33]
    v_mfma_f32_16x16x32_bf16 v[34:37], v[22:25], v[248:251], v[34:37]
    s_waitcnt lgkmcnt(0)
    v_mfma_f32_16x16x32_bf16 v[30:33], v[26:29], v[172:175], v[30:33]
    v_mfma_f32_16x16x32_bf16 v[34:37], v[26:29], v[252:255], v[34:37]
    s_nop 6
    v_cvt_pk_bf16_f32 v88, v30, v31
    v_cvt_pk_bf16_f32 v89, v32, v33
    v_cvt_pk_bf16_f32 v90, v34, v35
    v_cvt_pk_bf16_f32 v91, v36, v37
    s_add_u32 s60, s31, 4096
    s_cmp_eq_u32 s20, 70
    s_cbranch_scc1 L_Rf1_tail
L_Rf1_ha_6:
    s_waitcnt vmcnt(0)
    v_lshlrev_b32 v1, 31, v82
    v_pk_fma_f32 v[38:39], v[82:83], s[52:53], v[42:43]
    v_pk_fma_f32 v[40:41], v[84:85], s[52:53], v[44:45]
    ds_write_b128 v0, v[38:41] offset:27648
    v_cmp_ne_u32 vcc, s21, v1
    s_nop 0
    s_cbranch_vccnz L_Rf1_hafix_7
    s_waitcnt vmcnt(0) lgkmcnt(0)
    s_barrier
    ds_read_b128 v[10:13], v0 offset:26624
    ds_read_b128 v[14:17], v0 offset:27648
    ds_read_b128 v[18:21], v0 offset:28672
    ds_read_b128 v[58:61], v0 offset:37888
    ds_read_b128 v[62:65], v0 offset:38912
    ds_read_b128 v[66:69], v0 offset:50176
    ds_read_b128 v[70:73], v0 offset:51200
    buffer_store_dwordx4 v[88:91], v0, s[4:7], s60 offen sc1
    s_waitcnt lgkmcnt(5)
    v_max3_f32 v22, v10, v11, v12
    v_max3_f32 v23, v13, v14, v15
    v_max3_f32 v22, v22, v16, v17
    s_waitcnt lgkmcnt(4)
    v_max3_f32 v23, v23, v18, v19
    v_max3_f32 v22, v22, v20, v21
    v_max_f32 v22, v22, v23
    v_mov_b32 v23, v22
    ds_read_b128 v[30:33], v2 offset:0
    ds_read_b128 v[34:37], v2 offset:1024
    v_permlane32_swap_b32 v22, v23
    v_max_f32 v22, v22, v23
    v_mov_b32 v23, v22
    ds_read_b128 v[38:41], v2 offset:2048
    ds_read_b128 v[42:45], v2 offset:3072
    v_permlane16_swap_b32 v22, v23
    v_max_f32 v22, v22, v23
    v_pk_add_f32 v[10:11], v[10:11], v[22:23] op_sel_hi:[1,0] neg_lo:[0,1] neg_hi:[0,1]
    v_pk_add_f32 v[12:13], v[12:13], v[22:23] op_sel_hi:[1,0] neg_lo:[0,1] neg_hi:[0,1]
    v_pk_add_f32 v[14:15], v[14:15], v[22:23] op_sel_hi:[1,0] neg_lo:[0,1] neg_hi:[0,1]
    v_pk_add_f32 v[16:17], v[16:17], v[22:23] op_sel_hi:[1,0] neg_lo:[0,1] neg_hi:[0,1]
    v_pk_add_f32 v[18:19], v[18:19], v[22:23] op_sel_hi:[1,0] neg_lo:[0,1] neg_hi:[0,1]
    v_pk_add_f32 v[20:21], v[20:21], v[22:23] op_sel_hi:[1,0] neg_lo:[0,1] neg_hi:[0,1]
    v_exp_f32 v10, v10
    v_exp_f32 v11, v11
    v_exp_f32 v12, v12
    v_exp_f32 v13, v13
    v_exp_f32 v14, v14
    v_exp_f32 v15, v15
    v_cvt_pk_bf16_f32 v24, v10, v11
    v_cvt_pk_bf16_f32 v25, v12, v13
    v_exp_f32 v16, v16
    v_exp_f32 v17, v17
    v_mfma_f32_16x16x16_bf16 v[46:49], v[88:89], v[24:25], 0
    v_mfma_f32_16x16x16_bf16 v[82:85], v[90:91], v[24:25], 0
    v_exp_f32 v18, v18
    v_exp_f32 v19, v19
    v_exp_f32 v20, v20
    v_exp_f32 v21, v21
    v_cvt_pk_bf16_f32 v26, v14, v15
    v_cvt_pk_bf16_f32 v27, v16, v17
    v_cvt_pk_bf16_f32 v28, v18, v19
    v_cvt_pk_bf16_f32 v29, v20, v21
    v_pk_add_f32 v[22:23], v[10:11], v[12:13]
    v_pk_add_f32 v[14:15], v[14:15], v[16:17]
    s_waitcnt lgkmcnt(4)
    v_mfma_f32_16x16x32_bf16 v[50:53], v[58:61], v[26:29], v[46:49]
    v_pk_add_f32 v[18:19], v[18:19], v[20:21]
    v_mfma_f32_16x16x32_bf16 v[54:57], v[66:69], v[26:29], v[46:49]
    v_pk_add_f32 v[22:23], v[22:23], v[14:15]
    v_pk_add_f32 v[22:23], v[22:23], v[18:19]
    v_mfma_f32_16x16x32_bf16 v[10:13], v[62:65], v[26:29], v[82:85]
    v_add_f32 v22, v22, v23
    v_mfma_f32_16x16x32_bf16 v[14:17], v[70:73], v[26:29], v[82:85]
    v_mov_b32 v23, v22
    ds_read_b128 v[74:77], v2 offset:4096
    ds_read_b128 v[78:81], v2 offset:5120
    v_permlane32_swap_b32 v22, v23
    v_add_f32 v22, v22, v23
    v_mov_b32 v23, v22
    v_cndmask_b32 v50, v54, v50, s[48:49]
    v_cndmask_b32 v51, v55, v51, s[48:49]
    v_permlane16_swap_b32 v22, v23
    v_add_f32 v22, v22, v23
    v_rcp_f32 v22, v22
    v_cndmask_b32 v52, v56, v52, s[48:49]
    v_cndmask_b32 v53, v57, v53, s[48:49]
    v_cndmask_b32 v10, v14, v10, s[48:49]
    v_cndmask_b32 v11, v15, v11, s[48:49]
    v_cndmask_b32 v12, v16, v12, s[48:49]
    v_cndmask_b32 v13, v17, v13, s[48:49]
    v_pk_mul_f32 v[50:51], v[50:51], v[22:23] op_sel_hi:[1,0]
    v_pk_mul_f32 v[52:53], v[52:53], v[22:23] op_sel_hi:[1,0]
    v_cvt_pk_bf16_f32 v24, v50, v51
    v_cvt_pk_bf16_f32 v25, v52, v53
    v_pk_mul_f32 v[10:11], v[10:11], v[22:23] op_sel_hi:[1,0]
    v_pk_mul_f32 v[12:13], v[12:13], v[22:23] op_sel_hi:[1,0]
    v_cvt_pk_bf16_f32 v26, v10, v11
    v_cvt_pk_bf16_f32 v27, v12, v13
    ds_write_b128 v0, v[24:27] offset:1024
    s_waitcnt lgkmcnt(0)
    s_barrier
    ds_read_b128 v[10:13], v0 offset:0
    ds_read_b128 v[14:17], v0 offset:1024
    ds_read_b128 v[18:21], v0 offset:2048
    s_add_u32 s20, s20, 1
    s_waitcnt lgkmcnt(2)
    v_mfma_f32_16x16x32_bf16 v[46:49], v[30:33], v[10:13], 0
    ds_read_b128 v[30:33], v2 offset:6144
    s_waitcnt lgkmcnt(2)
    v_mfma_f32_16x16x32_bf16 v[46:49], v[34:37], v[14:17], v[46:49]
    ds_read_b128 v[34:37], v2 offset:7168
    s_waitcnt lgkmcnt(2)
    v_mfma_f32_16x16x32_bf16 v[46:49], v[38:41], v[18:21], v[46:49]
    ds_read_b128 v[38:41], v2 offset:8192
    v_mfma_f32_16x16x32_bf16 v[50:53], v[42:45], v[10:13], 0
    ds_read_b128 v[42:45], v2 offset:9216
    v_mfma_f32_16x16x32_bf16 v[50:53], v[74:77], v[14:17], v[50:53]
    ds_read_b128 v[74:77], v2 offset:10240
    v_mfma_f32_16x16x32_bf16 v[50:53], v[78:81], v[18:21], v[50:53]
    ds_read_b128 v[78:81], v2 offset:11264
    s_waitcnt lgkmcnt(3)
    v_mfma_f32_16x16x32_bf16 v[54:57], v[30:33], v[10:13], 0
    ds_read_b128 v[30:33], v2 offset:12288
    v_cvt_pk_bf16_f32 v62, v46, v47
    v_mfma_f32_16x16x32_bf16 v[54:57], v[34:37], v[14:17], v[54:57]
    ds_read_b128 v[34:37], v2 offset:13312
    v_cvt_pk_bf16_f32 v63, v48, v49
    v_and_or_b32 v62, v62, -2, s22
    v_mfma_f32_16x16x32_bf16 v[54:57], v[38:41], v[18:21], v[54:57]
    ds_read_b128 v[38:41], v2 offset:14336
    v_cvt_pk_bf16_f32 v64, v50, v51
    s_waitcnt lgkmcnt(3)
    v_mfma_f32_16x16x32_bf16 v[58:61], v[42:45], v[10:13], 0
    ds_read_b128 v[42:45], v2 offset:15360
    v_cvt_pk_bf16_f32 v65, v52, v53
    v_mfma_f32_16x16x32_bf16 v[58:61], v[74:77], v[14:17], v[58:61]
    ds_read_b128 v[74:77], v2 offset:16384
    buffer_store_dwordx4 v[62:65], v3, s[4:7], s32 offen
    v_mfma_f32_16x16x32_bf16 v[58:61], v[78:81], v[18:21], v[58:61]
    ds_read_b128 v[78:81], v2 offset:17408
    s_waitcnt lgkmcnt(3)
    v_mfma_f32_16x16x32_bf16 v[46:49], v[30:33], v[10:13], 0
    ds_read_b128 v[30:33], v2 offset:18432
    v_cvt_pk_bf16_f32 v66, v54, v55
    v_mfma_f32_16x16x32_bf16 v[46:49], v[34:37], v[14:17], v[46:49]
    ds_read_b128 v[34:37], v2 offset:19456
    v_cvt_pk_bf16_f32 v67, v56, v57
    v_and_or_b32 v66, v66, -2, s22
    v_mfma_f32_16x16x32_bf16 v[46:49], v[38:41], v[18:21], v[46:49]
    ds_read_b128 v[38:41], v2 offset:20480
    v_cvt_pk_bf16_f32 v68, v58, v59
    s_waitcnt lgkmcnt(3)
    v_mfma_f32_16x16x32_bf16 v[50:53], v[42:45], v[10:13], 0
    ds_read_b128 v[42:45], v2 offset:21504
    v_cvt_pk_bf16_f32 v69, v60, v61
    v_mfma_f32_16x16x32_bf16 v[50:53], v[74:77], v[14:17], v[50:53]
    ds_read_b128 v[74:77], v2 offset:22528
    buffer_store_dwordx4 v[66:69], v4, s[4:7], s32 offen
    v_mfma_f32_16x16x32_bf16 v[50:53], v[78:81], v[18:21], v[50:53]
    ds_read_b128 v[78:81], v2 offset:23552
    s_waitcnt lgkmcnt(3)
    v_mfma_f32_16x16x32_bf16 v[54:57], v[30:33], v[10:13], 0
    ds_read_b128 v[30:33], v2 offset:24576
    v_cvt_pk_bf16_f32 v62, v46, v47
    v_mfma_f32_16x16x32_bf16 v[54:57], v[34:37], v[14:17], v[54:57]
    ds_read_b128 v[34:37], v2 offset:25600
    v_cvt_pk_bf16_f32 v63, v48, v49
    v_and_or_b32 v62, v62, -2, s22
    v_mfma_f32_16x16x32_bf16 v[54:57], v[38:41], v[18:21], v[54:57]
    ds_read_b128 v[38:41], v2 offset:26624
    v_cvt_pk_bf16_f32 v64, v50, v51
    s_waitcnt lgkmcnt(3)
    v_mfma_f32_16x16x32_bf16 v[58:61], v[42:45], v[10:13], 0
    ds_read_b128 v[42:45], v2 offset:27648
    v_cvt_pk_bf16_f32 v65, v52, v53
    v_mfma_f32_16x16x32_bf16 v[58:61], v[74:77], v[14:17], v[58:61]
    ds_read_b128 v[74:77], v2 offset:28672
    buffer_store_dwordx4 v[62:65], v5, s[4:7], s32 offen
    v_mfma_f32_16x16x32_bf16 v[58:61], v[78:81], v[18:21], v[58:61]
    ds_read_b128 v[78:81], v2 offset:29696
    s_waitcnt lgkmcnt(3)
    v_mfma_f32_16x16x32_bf16 v[46:49], v[30:33], v[10:13], 0
    v_cvt_pk_bf16_f32 v66, v54, v55
    v_mfma_f32_16x16x32_bf16 v[46:49], v[34:37], v[14:17], v[46:49]
    v_cvt_pk_bf16_f32 v67, v56, v57
    v_and_or_b32 v66, v66, -2, s22
    v_mfma_f32_16x16x32_bf16 v[46:49], v[38:41], v[18:21], v[46:49]
    v_cvt_pk_bf16_f32 v68, v58, v59
    s_waitcnt lgkmcnt(0)
    v_mfma_f32_16x16x32_bf16 v[50:53], v[42:45], v[10:13], 0
    v_cvt_pk_bf16_f32 v69, v60, v61
    v_mfma_f32_16x16x32_bf16 v[50:53], v[74:77], v[14:17], v[50:53]
    buffer_store_dwordx4 v[66:69], v6, s[4:7], s32 offen
    v_mfma_f32_16x16x32_bf16 v[50:53], v[78:81], v[18:21], v[50:53]
    s_nop 0
    v_cvt_pk_bf16_f32 v62, v46, v47
    v_cvt_pk_bf16_f32 v63, v48, v49
    v_and_or_b32 v62, v62, -2, s22
    s_nop 3
    v_cvt_pk_bf16_f32 v64, v50, v51
    v_cvt_pk_bf16_f32 v65, v52, v53
    buffer_store_dwordx4 v[62:65], v7, s[4:7], s32 offen
    v_accvgpr_read_b32 v78, a252
    v_accvgpr_read_b32 v79, a253
    v_accvgpr_read_b32 v80, a254
    v_accvgpr_read_b32 v81, a255
    s_mov_b32 s19, 0
    s_waitcnt vmcnt(0)
    buffer_load_dwordx4 v[26:29], v8, s[4:7], s32 offen offset:0 sc1
    buffer_load_dwordx4 v[30:33], v8, s[4:7], s32 offen offset:2560 sc1
    buffer_load_dwordx4 v[34:37], v8, s[4:7], s33 offen offset:0 sc1
    buffer_load_dwordx4 v[38:41], v8, s[4:7], s33 offen offset:2560 sc1
    buffer_load_dwordx4 v[42:45], v8, s[4:7], s34 offen offset:0 sc1
    buffer_load_dwordx4 v[46:49], v8, s[4:7], s34 offen offset:2560 sc1
    buffer_load_dwordx4 v[50:53], v8, s[4:7], s35 offen offset:0 sc1
    buffer_load_dwordx4 v[54:57], v8, s[4:7], s35 offen offset:2560 sc1
L_Rf1_hb_8:
    s_waitcnt vmcnt(7)
    v_mfma_f32_16x16x32_bf16 v[70:73], a[248:251], v[26:29], 0
    v_xor_b32 v1, s44, v26
    s_waitcnt vmcnt(6)
    v_mfma_f32_16x16x32_bf16 v[70:73], a[248:251], v[30:33], v[70:73]
    v_bitop3_b32 v1, v1, v30, s44 bitop3:0xf6
    s_waitcnt vmcnt(5)
    v_mfma_f32_16x16x32_bf16 v[70:73], a[248:251], v[34:37], v[70:73]
    v_bitop3_b32 v1, v1, v34, s44 bitop3:0xf6
    s_waitcnt vmcnt(4)
    v_mfma_f32_16x16x32_bf16 v[70:73], a[248:251], v[38:41], v[70:73]
    v_bitop3_b32 v1, v1, v38, s44 bitop3:0xf6
    s_waitcnt vmcnt(3)
    v_mfma_f32_16x16x32_bf16 v[70:73], a[248:251], v[42:45], v[70:73]
    v_bitop3_b32 v1, v1, v42, s44 bitop3:0xf6
    s_waitcnt vmcnt(2)
    v_mfma_f32_16x16x32_bf16 v[70:73], a[248:251], v[46:49], v[70:73]
    v_bitop3_b32 v1, v1, v46, s44 bitop3:0xf6
    s_waitcnt vmcnt(1)
    v_mfma_f32_16x16x32_bf16 v[70:73], a[248:251], v[50:53], v[70:73]
    v_bitop3_b32 v1, v1, v50, s44 bitop3:0xf6
    s_waitcnt vmcnt(0)
    v_mfma_f32_16x16x32_bf16 v[70:73], a[248:251], v[54:57], v[70:73]
    v_bitop3_b32 v1, v1, v54, s44 bitop3:0xf6
    v_and_b32 v1, 1, v1
    v_cmp_ne_u32 vcc, 0, v1
    s_nop 0
    s_cbranch_vccnz L_Rf1_hbfix_9
    s_nop 2
    v_cvt_pk_bf16_f32 v74, v70, v71
    v_cvt_pk_bf16_f32 v75, v72, v73
    v_mov_b32 v76, v74
    v_mov_b32 v77, v75
    s_nop 0
    v_permlane16_swap_b32 v74, v76
    v_permlane16_swap_b32 v75, v77
    v_cndmask_b32 v74, v74, v78, s[42:43]
    v_cndmask_b32 v75, v75, v79, s[42:43]
    v_cndmask_b32 v76, v76, v80, s[42:43]
    v_cndmask_b32 v77, v77, v81, s[42:43]
    v_and_or_b32 v74, v74, -2, s24
    s_mov_b64 exec, s[46:47]
    buffer_store_dwordx4 v[74:77], v9, s[4:7], s36 offen
    buffer_store_dwordx4 v[74:77], v9, s[4:7], s37 offen sc1
    s_mov_b64 exec, -1
    s_add_u32 s60, s20, 1
    s_and_b32 s22, s60, 1
    s_lshl_b32 s21, s22, 31
    s_sub_u32 s44, 0, s22
    s_bfe_u32 s23, s20, 0x10001
    s_sub_u32 s23, s23, 1
    s_lshr_b32 s24, s60, 1
    s_andn2_b32 s24, 1, s24
    s_lshl_b32 s61, s14, 15
    s_add_u32 s61, s61, 1179648
    s_and_b32 s25, s20, 1
    s_lshl_b32 s25, s25, 16
    s_add_u32 s25, s25, s61
    s_add_u32 s25, s25, 5120
    s_add_u32 s26, s25, 4096
    s_lshl_b32 s36, s22, 16
    s_add_u32 s36, s36, s61
    s_lshl_b32 s27, s20, 1
    s_add_u32 s37, s27, 2
    s_add_u32 s37, s37, s14
    s_mul_i32 s37, s37, 20480
    s_add_u32 s37, s37, 2621440
    s_add_u32 s27, s27, 1
    s_sub_u32 s27, s27, s14
    s_mul_i32 s27, s27, 20480
    s_add_u32 s27, s27, 2626560
    s_add_u32 s28, s27, 4096
    s_lshl_b32 s31, s20, 6
    s_add_u32 s31, s31, s13
    s_mul_i32 s31, s31, 6144
    s_add_u32 s31, s31, 5898240
    s_min_u32 s56, s20, 63
    s_lshl_b32 s56, s56, 6
    s_add_u32 s56, s56, s13
    s_mul_i32 s56, s56, 12288
    s_add_u32 s56, s56, 37364736
    s_max_u32 s57, s20, 7
    s_sub_u32 s57, s57, 7
    s_lshl_b32 s57, s57, 6
    s_add_u32 s57, s57, s13
    s_mul_i32 s57, s57, 12288
    s_add_u32 s57, s57, 87696384
    s_cmp_lt_u32 s20, 7
    s_cselect_b32 s57, s56, s57
    s_cmp_gt_u32 s60, 63
    s_cselect_b64 s[42:43], s[38:39], 0
    s_cmp_le_u32 s60, 7
    s_cselect_b64 vcc, s[40:41], 0
    s_or_b64 s[42:43], s[42:43], vcc
    s_waitcnt vmcnt(1)
    s_branch L_Rf1_top
L_Rf1_tail:
    s_waitcnt lgkmcnt(0)
    buffer_store_dwordx4 v[88:91], v0, s[4:7], s60 offen sc1
    s_waitcnt vmcnt(0) lgkmcnt(0)
    s_barrier
    v_mov_b32 v22, 71
    s_mov_b64 exec, 1
    s_mov_b64 exec, -1
    s_waitcnt vmcnt(0)
    s_endpgm
L_Rf1_glfix_3:
    buffer_load_dwordx4 v[10:13], v0, s[4:7], s25 offen offset:0 sc1
    buffer_load_dwordx4 v[14:17], v0, s[4:7], s25 offen offset:1024 sc1
    buffer_load_dwordx4 v[18:21], v0, s[4:7], s25 offen offset:2048 sc1
    buffer_load_dwordx4 v[22:25], v0, s[4:7], s25 offen offset:3072 sc1
    buffer_load_dwordx4 v[26:29], v0, s[4:7], s26 offen offset:0 sc1
    buffer_load_dwordx4 v[46:49], v0, s[4:7], s27 offen offset:0 sc1
    buffer_load_dwordx4 v[30:33], v0, s[4:7], s27 offen offset:1024 sc1
    buffer_load_dwordx4 v[34:37], v0, s[4:7], s27 offen offset:2048 sc1
    buffer_load_dwordx4 v[38:41], v0, s[4:7], s27 offen offset:3072 sc1
    buffer_load_dwordx4 v[42:45], v0, s[4:7], s28 offen offset:0 sc1
    s_add_u32 s19, s19, 1
    s_cmp_lt_u32 s19, 524288
    s_cbranch_scc1 L_Rf1_gl_1
    s_branch L_fail
L_Rf1_grfix_5:
    buffer_load_dwordx4 v[46:49], v0, s[4:7], s27 offen offset:0 sc1
    buffer_load_dwordx4 v[30:33], v0, s[4:7], s27 offen offset:1024 sc1
    buffer_load_dwordx4 v[34:37], v0, s[4:7], s27 offen offset:2048 sc1
    buffer_load_dwordx4 v[38:41], v0, s[4:7], s27 offen offset:3072 sc1
    buffer_load_dwordx4 v[42:45], v0, s[4:7], s28 offen offset:0 sc1
    s_add_u32 s19, s19, 1
    s_cmp_lt_u32 s19, 524288
    s_cbranch_scc1 L_Rf1_gr2_4
    s_branch L_fail
L_Rf1_gr2_4:
    v_mfma_f32_16x16x32_bf16 v[50:53], a[240:243], v[10:13], 0
    v_mfma_f32_16x16x32_bf16 v[54:57], a[244:247], v[10:13], 0
    v_mfma_f32_16x16x32_bf16 v[58:61], a[240:243], v[14:17], 0
    v_mfma_f32_16x16x32_bf16 v[62:65], a[244:247], v[14:17], 0
    v_mfma_f32_16x16x32_bf16 v[66:69], a[240:243], v[18:21], 0
    v_mfma_f32_16x16x32_bf16 v[70:73], a[244:247], v[18:21], 0
    v_mfma_f32_16x16x32_bf16 v[74:77], a[240:243], v[22:25], 0
    v_mfma_f32_16x16x32_bf16 v[78:81], a[244:247], v[22:25], 0
    v_mfma_f32_16x16x32_bf16 v[82:85], a[240:243], v[26:29], 0
    v_mfma_f32_16x16x32_bf16 v[86:89], a[244:247], v[26:29], 0
    s_branch L_Rf1_gr_2
L_Rf1_hafix_7:
    buffer_load_dwordx4 v[82:85], v0, s[4:7], s30 offen sc1
    s_add_u32 s19, s19, 1
    s_cmp_lt_u32 s19, 524288
    s_cbranch_scc1 L_Rf1_ha_6
    s_branch L_fail
L_Rf1_hbfix_9:
    buffer_load_dwordx4 v[26:29], v8, s[4:7], s32 offen offset:0 sc1
    buffer_load_dwordx4 v[30:33], v8, s[4:7], s32 offen offset:2560 sc1
    buffer_load_dwordx4 v[34:37], v8, s[4:7], s33 offen offset:0 sc1
    buffer_load_dwordx4 v[38:41], v8, s[4:7], s33 offen offset:2560 sc1
    buffer_load_dwordx4 v[42:45], v8, s[4:7], s34 offen offset:0 sc1
    buffer_load_dwordx4 v[46:49], v8, s[4:7], s34 offen offset:2560 sc1
    buffer_load_dwordx4 v[50:53], v8, s[4:7], s35 offen offset:0 sc1
    buffer_load_dwordx4 v[54:57], v8, s[4:7], s35 offen offset:2560 sc1
    s_add_u32 s19, s19, 1
    s_cmp_lt_u32 s19, 524288
    s_cbranch_scc1 L_Rf1_hb_8
    s_branch L_fail
L_R1_slow:
L_Rs1_top:
    s_barrier
    buffer_load_dwordx4 v[10:13], v0, s[4:7], s25 offen offset:0 sc1
    buffer_load_dwordx4 v[14:17], v0, s[4:7], s25 offen offset:1024 sc1
    buffer_load_dwordx4 v[18:21], v0, s[4:7], s25 offen offset:2048 sc1
    buffer_load_dwordx4 v[22:25], v0, s[4:7], s25 offen offset:3072 sc1
    buffer_load_dwordx4 v[26:29], v0, s[4:7], s26 offen offset:0 sc1
    s_barrier
    buffer_load_dwordx4 v[46:49], v0, s[4:7], s27 offen offset:0 sc1
    buffer_load_dwordx4 v[30:33], v0, s[4:7], s27 offen offset:1024 sc1
    buffer_load_dwordx4 v[34:37], v0, s[4:7], s27 offen offset:2048 sc1
    buffer_load_dwordx4 v[38:41], v0, s[4:7], s27 offen offset:3072 sc1
    buffer_load_dwordx4 v[42:45], v0, s[4:7], s28 offen offset:0 sc1
    s_mov_b32 s19, 0
L_Rs1_gl_1:
    s_waitcnt vmcnt(9)
    v_mfma_f32_16x16x32_bf16 v[50:53], a[240:243], v[10:13], 0
    v_mfma_f32_16x16x32_bf16 v[54:57], a[244:247], v[10:13], 0
    v_xor_b32 v1, s23, v10
    s_waitcnt vmcnt(8)
    v_mfma_f32_16x16x32_bf16 v[58:61], a[240:243], v[14:17], 0
    v_mfma_f32_16x16x32_bf16 v[62:65], a[244:247], v[14:17], 0
    v_bitop3_b32 v1, v1, v14, s23 bitop3:0xf6
    s_waitcnt vmcnt(7)
    v_mfma_f32_16x16x32_bf16 v[66:69], a[240:243], v[18:21], 0
    v_mfma_f32_16x16x32_bf16 v[70:73], a[244:247], v[18:21], 0
    v_bitop3_b32 v1, v1, v18, s23 bitop3:0xf6
    s_waitcnt vmcnt(6)
    v_mfma_f32_16x16x32_bf16 v[74:77], a[240:243], v[22:25], 0
    v_mfma_f32_16x16x32_bf16 v[78:81], a[244:247], v[22:25], 0
    v_bitop3_b32 v1, v1, v22, s23 bitop3:0xf6
    s_waitcnt vmcnt(5)
    v_mfma_f32_16x16x32_bf16 v[82:85], a[240:243], v[26:29], 0
    v_mfma_f32_16x16x32_bf16 v[86:89], a[244:247], v[26:29], 0
    v_bitop3_b32 v1, v1, v26, s23 bitop3:0xf6
    v_and_b32 v1, 1, v1
    v_cmp_ne_u32 vcc, 0, v1
    s_nop 0
    s_cbranch_vccnz L_Rs1_glfix_3
L_Rs1_gr_2:
    s_waitcnt vmcnt(4)
    v_mfma_f32_16x16x32_bf16 v[50:53], a[240:243], v[46:49], v[50:53]
    v_xor_b32 v1, s23, v46
    v_mfma_f32_16x16x32_bf16 v[54:57], a[244:247], v[46:49], v[54:57]
    s_waitcnt vmcnt(3)
    v_mfma_f32_16x16x32_bf16 v[58:61], a[240:243], v[30:33], v[58:61]
    v_bitop3_b32 v1, v1, v30, s23 bitop3:0xf6
    v_mfma_f32_16x16x32_bf16 v[62:65], a[244:247], v[30:33], v[62:65]
    s_nop 1
    v_cvt_pk_bf16_f32 v90, v50, v51
    v_cvt_pk_bf16_f32 v91, v52, v53
    v_cvt_pk_bf16_f32 v92, v54, v55
    v_cvt_pk_bf16_f32 v93, v56, v57
    ds_write_b128 v0, v[90:93] offset:5120
    s_waitcnt vmcnt(2)
    v_mfma_f32_16x16x32_bf16 v[66:69], a[240:243], v[34:37], v[66:69]
    v_bitop3_b32 v1, v1, v34, s23 bitop3:0xf6
    v_mfma_f32_16x16x32_bf16 v[70:73], a[244:247], v[34:37], v[70:73]
    v_cvt_pk_bf16_f32 v90, v58, v59
    v_cvt_pk_bf16_f32 v91, v60, v61
    v_cvt_pk_bf16_f32 v92, v62, v63
    v_cvt_pk_bf16_f32 v93, v64, v65
    ds_write_b128 v0, v[90:93] offset:6144
    s_waitcnt vmcnt(1)
    v_mfma_f32_16x16x32_bf16 v[74:77], a[240:243], v[38:41], v[74:77]
    v_bitop3_b32 v1, v1, v38, s23 bitop3:0xf6
    v_mfma_f32_16x16x32_bf16 v[78:81], a[244:247], v[38:41], v[78:81]
    v_cvt_pk_bf16_f32 v90, v66, v67
    v_cvt_pk_bf16_f32 v91, v68, v69
    v_cvt_pk_bf16_f32 v92, v70, v71
    v_cvt_pk_bf16_f32 v93, v72, v73
    ds_write_b128 v0, v[90:93] offset:7168
    s_waitcnt vmcnt(0)
    v_mfma_f32_16x16x32_bf16 v[82:85], a[240:243], v[42:45], v[82:85]
    v_bitop3_b32 v1, v1, v42, s23 bitop3:0xf6
    v_mfma_f32_16x16x32_bf16 v[86:89], a[244:247], v[42:45], v[86:89]
    v_cvt_pk_bf16_f32 v90, v74, v75
    v_cvt_pk_bf16_f32 v91, v76, v77
    v_cvt_pk_bf16_f32 v92, v78, v79
    v_cvt_pk_bf16_f32 v93, v80, v81
    ds_write_b128 v0, v[90:93] offset:8192
    s_nop 0
    v_cvt_pk_bf16_f32 v90, v82, v83
    v_cvt_pk_bf16_f32 v91, v84, v85
    v_cvt_pk_bf16_f32 v92, v86, v87
    v_cvt_pk_bf16_f32 v93, v88, v89
    ds_write_b128 v0, v[90:93] offset:9216
    v_and_b32 v1, 1, v1
    v_cmp_ne_u32 vcc, 0, v1
    s_nop 0
    s_cbranch_vccnz L_Rs1_grfix_5
    s_waitcnt lgkmcnt(0)
    s_barrier
    ds_read_b128 v[10:13], v0 offset:0
    ds_read_b128 v[14:17], v0 offset:1024
    ds_read_b128 v[18:21], v0 offset:2048
    ds_read_b128 v[22:25], v0 offset:3072
    ds_read_b128 v[26:29], v0 offset:4096
    s_waitcnt lgkmcnt(4)
    v_mfma_f32_16x16x32_bf16 v[46:49], a[0:3], v[10:13], 0
    s_mov_b32 m0, 38912
    v_mfma_f32_16x16x32_bf16 v[50:53], a[80:83], v[10:13], 0
    v_mfma_f32_16x16x32_bf16 v[54:57], a[160:163], v[10:13], 0
    ds_read_b128 v[10:13], v0 offset:5120
    s_waitcnt lgkmcnt(4)
    v_mfma_f32_16x16x32_bf16 v[46:49], a[4:7], v[14:17], v[46:49]
    buffer_load_dwordx4 v0, s[4:7], s56 offen offset:0 sc1 lds
    v_mfma_f32_16x16x32_bf16 v[50:53], a[84:87], v[14:17], v[50:53]
    v_mfma_f32_16x16x32_bf16 v[54:57], a[164:167], v[14:17], v[54:57]
    ds_read_b128 v[14:17], v0 offset:6144
    s_waitcnt lgkmcnt(4)
    v_mfma_f32_16x16x32_bf16 v[46:49], a[8:11], v[18:21], v[46:49]
    buffer_load_dwordx4 v0, s[4:7], s56 offen offset:1024 sc1 lds
    v_mfma_f32_16x16x32_bf16 v[50:53], a[88:91], v[18:21], v[50:53]
    v_mfma_f32_16x16x32_bf16 v[54:57], a[168:171], v[18:21], v[54:57]
    ds_read_b128 v[18:21], v0 offset:7168
    s_waitcnt lgkmcnt(4)
    v_mfma_f32_16x16x32_bf16 v[46:49], a[12:15], v[22:25], v[46:49]
    buffer_load_dwordx4 v0, s[4:7], s56 offen offset:2048 sc1 lds
    v_mfma_f32_16x16x32_bf16 v[50:53], a[92:95], v[22:25], v[50:53]
    v_mfma_f32_16x16x32_bf16 v[54:57], a[172:175], v[22:25], v[54:57]
    ds_read_b128 v[22:25], v0 offset:8192
    s_waitcnt lgkmcnt(4)
    v_mfma_f32_16x16x32_bf16 v[46:49], a[16:19], v[26:29], v[46:49]
    v_mfma_f32_16x16x32_bf16 v[50:53], a[96:99], v[26:29], v[50:53]
    v_mfma_f32_16x16x32_bf16 v[54:57], a[176:179], v[26:29], v[54:57]
    ds_read_b128 v[26:29], v0 offset:9216
    s_waitcnt lgkmcnt(4)
    v_mfma_f32_16x16x32_bf16 v[46:49], a[20:23], v[10:13], v[46:49]
    v_mfma_f32_16x16x32_bf16 v[50:53], a[100:103], v[10:13], v[50:53]
    v_mfma_f32_16x16x32_bf16 v[54:57], a[180:183], v[10:13], v[54:57]
    ds_read_b128 v[10:13], v0 offset:10240
    s_waitcnt lgkmcnt(4)
    v_mfma_f32_16x16x32_bf16 v[46:49], a[24:27], v[14:17], v[46:49]
    v_mfma_f32_16x16x32_bf16 v[50:53], a[104:107], v[14:17], v[50:53]
    v_mfma_f32_16x16x32_bf16 v[54:57], a[184:187], v[14:17], v[54:57]
    ds_read_b128 v[14:17], v0 offset:11264
    s_waitcnt lgkmcnt(4)
    v_mfma_f32_16x16x32_bf16 v[46:49], a[28:31], v[18:21], v[46:49]
    v_mfma_f32_16x16x32_bf16 v[50:53], a[108:111], v[18:21], v[50:53]
    v_mfma_f32_16x16x32_bf16 v[54:57], a[188:191], v[18:21], v[54:57]
    ds_read_b128 v[18:21], v0 offset:12288
    s_waitcnt lgkmcnt(4)
    v_mfma_f32_16x16x32_bf16 v[46:49], a[32:35], v[22:25], v[46:49]
    v_mfma_f32_16x16x32_bf16 v[50:53], a[112:115], v[22:25], v[50:53]
    v_mfma_f32_16x16x32_bf16 v[54:57], a[192:195], v[22:25], v[54:57]
    ds_read_b128 v[22:25], v0 offset:13312
    s_waitcnt lgkmcnt(4)
    v_mfma_f32_16x16x32_bf16 v[46:49], a[36:39], v[26:29], v[46:49]
    v_mfma_f32_16x16x32_bf16 v[50:53], a[116:119], v[26:29], v[50:53]
    v_mfma_f32_16x16x32_bf16 v[54:57], a[196:199], v[26:29], v[54:57]
    ds_read_b128 v[26:29], v0 offset:14336
    s_waitcnt lgkmcnt(4)
    v_mfma_f32_16x16x32_bf16 v[46:49], a[40:43], v[10:13], v[46:49]
    v_mfma_f32_16x16x32_bf16 v[50:53], a[120:123], v[10:13], v[50:53]
    v_mfma_f32_16x16x32_bf16 v[54:57], a[200:203], v[10:13], v[54:57]
    ds_read_b128 v[10:13], v0 offset:15360
    s_waitcnt lgkmcnt(4)
    v_mfma_f32_16x16x32_bf16 v[46:49], a[44:47], v[14:17], v[46:49]
    ds_read_b128 v[58:61], v0 offset:29696
    v_mfma_f32_16x16x32_bf16 v[50:53], a[124:127], v[14:17], v[50:53]
    v_mfma_f32_16x16x32_bf16 v[54:57], a[204:207], v[14:17], v[54:57]
    ds_read_b128 v[14:17], v0 offset:16384
    s_waitcnt lgkmcnt(5)
    v_mfma_f32_16x16x32_bf16 v[46:49], a[48:51], v[18:21], v[46:49]
    ds_read_b128 v[62:65], v0 offset:30720
    v_mfma_f32_16x16x32_bf16 v[50:53], a[128:131], v[18:21], v[50:53]
    v_mfma_f32_16x16x32_bf16 v[54:57], a[208:211], v[18:21], v[54:57]
    ds_read_b128 v[18:21], v0 offset:17408
    s_waitcnt lgkmcnt(6)
    v_mfma_f32_16x16x32_bf16 v[46:49], a[52:55], v[22:25], v[46:49]
    ds_read_b128 v[66:69], v0 offset:31744
    v_mfma_f32_16x16x32_bf16 v[50:53], a[132:135], v[22:25], v[50:53]
    v_mfma_f32_16x16x32_bf16 v[54:57], a[212:215], v[22:25], v[54:57]
    ds_read_b128 v[22:25], v0 offset:18432
    s_waitcnt lgkmcnt(7)
    v_mfma_f32_16x16x32_bf16 v[46:49], a[56:59], v[26:29], v[46:49]
    ds_read_b128 v[70:73], v0 offset:41984
    v_mfma_f32_16x16x32_bf16 v[50:53], a[136:139], v[26:29], v[50:53]
    v_mfma_f32_16x16x32_bf16 v[54:57], a[216:219], v[26:29], v[54:57]
    ds_read_b128 v[26:29], v0 offset:19456
    s_waitcnt lgkmcnt(8)
    v_mfma_f32_16x16x32_bf16 v[46:49], a[60:63], v[10:13], v[46:49]
    ds_read_b128 v[74:77], v0 offset:43008
    v_mfma_f32_16x16x32_bf16 v[50:53], a[140:143], v[10:13], v[50:53]
    v_mfma_f32_16x16x32_bf16 v[54:57], a[220:223], v[10:13], v[54:57]
    ds_read_b128 v[10:13], v0 offset:0
    s_waitcnt lgkmcnt(8)
    v_mfma_f32_16x16x32_bf16 v[46:49], a[64:67], v[14:17], v[46:49]
    ds_read_b128 v[78:81], v0 offset:44032
    v_mfma_f32_16x16x32_bf16 v[50:53], a[144:147], v[14:17], v[50:53]
    v_mfma_f32_16x16x32_bf16 v[54:57], a[224:227], v[14:17], v[54:57]
    ds_read_b128 v[14:17], v0 offset:1024
    s_waitcnt lgkmcnt(8)
    v_mfma_f32_16x16x32_bf16 v[46:49], a[68:71], v[18:21], v[46:49]
    v_mfma_f32_16x16x32_bf16 v[50:53], a[148:151], v[18:21], v[50:53]
    v_mfma_f32_16x16x32_bf16 v[54:57], a[228:231], v[18:21], v[54:57]
    ds_read_b128 v[18:21], v0 offset:2048
    s_waitcnt lgkmcnt(7)
    v_mfma_f32_16x16x32_bf16 v[46:49], a[72:75], v[22:25], v[46:49]
    v_mfma_f32_16x16x32_bf16 v[50:53], a[152:155], v[22:25], v[50:53]
    v_mfma_f32_16x16x32_bf16 v[54:57], a[232:235], v[22:25], v[54:57]
    ds_read_b128 v[22:25], v0 offset:3072
    s_waitcnt lgkmcnt(6)
    v_mfma_f32_16x16x32_bf16 v[46:49], a[76:79], v[26:29], v[46:49]
    v_mfma_f32_16x16x32_bf16 v[50:53], a[156:159], v[26:29], v[50:53]
    v_mfma_f32_16x16x32_bf16 v[54:57], a[236:239], v[26:29], v[54:57]
    ds_read_b128 v[26:29], v0 offset:4096
    s_waitcnt lgkmcnt(5)
    v_mfma_f32_16x16x32_bf16 v[30:33], v[10:13], v[96:99], 0
    v_mfma_f32_16x16x32_bf16 v[34:37], v[10:13], v[176:179], 0
    ds_read_b128 v[10:13], v0 offset:5120
    s_nop 0
    v_cvt_pk_bf16_f32 v82, v46, v47
    v_cvt_pk_bf16_f32 v83, v48, v49
    ds_write_b64 v0, v[82:83] offset:21512
    v_cvt_pk_bf16_f32 v84, v50, v51
    v_cvt_pk_bf16_f32 v85, v52, v53
    ds_write_b64 v0, v[84:85] offset:22528
    v_cvt_pk_bf16_f32 v86, v54, v55
    v_cvt_pk_bf16_f32 v87, v56, v57
    ds_write_b64 v0, v[86:87] offset:22536
    s_waitcnt lgkmcnt(7)
    v_mfma_f32_16x16x32_bf16 v[30:33], v[14:17], v[100:103], v[30:33]
    v_mfma_f32_16x16x32_bf16 v[34:37], v[14:17], v[180:183], v[34:37]
    ds_read_b128 v[14:17], v0 offset:6144
    s_waitcnt lgkmcnt(1)
    s_barrier
    ds_read_b128 v[46:49], v0 offset:20480
    ds_read_b128 v[50:53], v0 offset:21504
    ds_read_b128 v[54:57], v0 offset:22528
    v_mfma_f32_16x16x32_bf16 v[30:33], v[18:21], v[104:107], v[30:33]
    v_mfma_f32_16x16x32_bf16 v[34:37], v[18:21], v[184:187], v[34:37]
    ds_read_b128 v[18:21], v0 offset:7168
    v_mfma_f32_16x16x32_bf16 v[30:33], v[22:25], v[108:111], v[30:33]
    v_mfma_f32_16x16x32_bf16 v[34:37], v[22:25], v[188:191], v[34:37]
    ds_read_b128 v[22:25], v0 offset:8192
    s_waitcnt lgkmcnt(4)
    v_mfma_f32_16x16x32_bf16 v[38:41], v[58:61], v[46:49], 0
    v_mfma_f32_16x16x32_bf16 v[42:45], v[70:73], v[46:49], 0
    s_waitcnt lgkmcnt(3)
    v_mfma_f32_16x16x32_bf16 v[38:41], v[62:65], v[50:53], v[38:41]
    v_mfma_f32_16x16x32_bf16 v[42:45], v[74:77], v[50:53], v[42:45]
    s_waitcnt lgkmcnt(2)
    v_mfma_f32_16x16x32_bf16 v[38:41], v[66:69], v[54:57], v[38:41]
    v_mfma_f32_16x16x32_bf16 v[42:45], v[78:81], v[54:57], v[42:45]
    v_mfma_f32_16x16x32_bf16 v[30:33], v[26:29], v[112:115], v[30:33]
    v_mfma_f32_16x16x32_bf16 v[34:37], v[26:29], v[192:195], v[34:37]
    ds_read_b128 v[26:29], v0 offset:9216
    s_nop 4
    v_cndmask_b32 v38, v42, v38, s[48:49]
    v_cndmask_b32 v39, v43, v39, s[48:49]
    v_cndmask_b32 v40, v44, v40, s[48:49]
    v_cndmask_b32 v41, v45, v41, s[48:49]
    v_and_or_b32 v38, v38, -2, s22
    buffer_store_dwordx4 v[38:41], v0, s[4:7], s29 offen sc1
    v_mfma_f32_16x16x32_bf16 v[30:33], v[10:13], v[116:119], v[30:33]
    v_mfma_f32_16x16x32_bf16 v[34:37], v[10:13], v[196:199], v[34:37]
    ds_read_b128 v[10:13], v0 offset:10240
    v_mfma_f32_16x16x32_bf16 v[30:33], v[14:17], v[120:123], v[30:33]
    v_mfma_f32_16x16x32_bf16 v[34:37], v[14:17], v[200:203], v[34:37]
    ds_read_b128 v[14:17], v0 offset:11264
    s_waitcnt lgkmcnt(4)
    v_mfma_f32_16x16x32_bf16 v[30:33], v[18:21], v[124:127], v[30:33]
    v_mfma_f32_16x16x32_bf16 v[34:37], v[18:21], v[204:207], v[34:37]
    ds_read_b128 v[18:21], v0 offset:12288
    s_waitcnt lgkmcnt(4)
    v_mfma_f32_16x16x32_bf16 v[30:33], v[22:25], v[128:131], v[30:33]
    v_mfma_f32_16x16x32_bf16 v[34:37], v[22:25], v[208:211], v[34:37]
    ds_read_b128 v[22:25], v0 offset:13312
    s_waitcnt lgkmcnt(4)
    v_mfma_f32_16x16x32_bf16 v[30:33], v[26:29], v[132:135], v[30:33]
    v_mfma_f32_16x16x32_bf16 v[34:37], v[26:29], v[212:215], v[34:37]
    ds_read_b128 v[26:29], v0 offset:14336
    s_waitcnt lgkmcnt(4)
    v_mfma_f32_16x16x32_bf16 v[30:33], v[10:13], v[136:139], v[30:33]
    v_mfma_f32_16x16x32_bf16 v[34:37], v[10:13], v[216:219], v[34:37]
    ds_read_b128 v[10:13], v0 offset:15360
    s_waitcnt lgkmcnt(4)
    v_mfma_f32_16x16x32_bf16 v[30:33], v[14:17], v[140:143], v[30:33]
    v_mfma_f32_16x16x32_bf16 v[34:37], v[14:17], v[220:223], v[34:37]
    ds_read_b128 v[14:17], v0 offset:16384
    s_waitcnt lgkmcnt(4)
    v_mfma_f32_16x16x32_bf16 v[30:33], v[18:21], v[144:147], v[30:33]
    v_mfma_f32_16x16x32_bf16 v[34:37], v[18:21], v[224:227], v[34:37]
    ds_read_b128 v[18:21], v0 offset:17408
    s_waitcnt lgkmcnt(4)
    v_mfma_f32_16x16x32_bf16 v[30:33], v[22:25], v[148:151], v[30:33]
    v_mfma_f32_16x16x32_bf16 v[34:37], v[22:25], v[228:231], v[34:37]
    ds_read_b128 v[22:25], v0 offset:18432
    v_pk_mul_f32 v[42:43], v[38:39], s[52:53]
    v_pk_mul_f32 v[44:45], v[40:41], s[52:53]
    s_waitcnt vmcnt(0)
    buffer_load_dwordx4 v[82:85], v0, s[4:7], s30 offen sc1
    s_mov_b32 s19, 0
    s_waitcnt lgkmcnt(4)
    v_mfma_f32_16x16x32_bf16 v[30:33], v[26:29], v[152:155], v[30:33]
    v_mfma_f32_16x16x32_bf16 v[34:37], v[26:29], v[232:235], v[34:37]
    ds_read_b128 v[26:29], v0 offset:19456
    s_waitcnt lgkmcnt(4)
    v_mfma_f32_16x16x32_bf16 v[30:33], v[10:13], v[156:159], v[30:33]
    v_mfma_f32_16x16x32_bf16 v[34:37], v[10:13], v[236:239], v[34:37]
    s_waitcnt lgkmcnt(3)
    v_mfma_f32_16x16x32_bf16 v[30:33], v[14:17], v[160:163], v[30:33]
    v_mfma_f32_16x16x32_bf16 v[34:37], v[14:17], v[240:243], v[34:37]
    s_waitcnt lgkmcnt(2)
    v_mfma_f32_16x16x32_bf16 v[30:33], v[18:21], v[164:167], v[30:33]
    v_mfma_f32_16x16x32_bf16 v[34:37], v[18:21], v[244:247], v[34:37]
    s_waitcnt lgkmcnt(1)
    v_mfma_f32_16x16x32_bf16 v[30:33], v[22:25], v[168:171], v[30:33]
    v_mfma_f32_16x16x32_bf16 v[34:37], v[22:25], v[248:251], v[34:37]
    s_waitcnt lgkmcnt(0)
    v_mfma_f32_16x16x32_bf16 v[30:33], v[26:29], v[172:175], v[30:33]
    v_mfma_f32_16x16x32_bf16 v[34:37], v[26:29], v[252:255], v[34:37]
    s_nop 6
    v_cvt_pk_bf16_f32 v88, v30, v31
    v_cvt_pk_bf16_f32 v89, v32, v33
    v_cvt_pk_bf16_f32 v90, v34, v35
    v_cvt_pk_bf16_f32 v91, v36, v37
    s_add_u32 s60, s31, 4096
    s_cmp_eq_u32 s20, 70
    s_cbranch_scc1 L_Rs1_tail
L_Rs1_ha_6:
    s_waitcnt vmcnt(0)
    v_lshlrev_b32 v1, 31, v82
    v_pk_fma_f32 v[38:39], v[82:83], s[52:53], v[42:43]
    v_pk_fma_f32 v[40:41], v[84:85], s[52:53], v[44:45]
    ds_write_b128 v0, v[38:41] offset:27648
    v_cmp_ne_u32 vcc, s21, v1
    s_nop 0
    s_cbranch_vccnz L_Rs1_hafix_7
    s_waitcnt vmcnt(0) lgkmcnt(0)
    s_barrier
    ds_read_b128 v[10:13], v0 offset:26624
    ds_read_b128 v[14:17], v0 offset:27648
    ds_read_b128 v[18:21], v0 offset:28672
    ds_read_b128 v[58:61], v0 offset:37888
    ds_read_b128 v[62:65], v0 offset:38912
    ds_read_b128 v[66:69], v0 offset:50176
    ds_read_b128 v[70:73], v0 offset:51200
    buffer_store_dwordx4 v[88:91], v0, s[4:7], s60 offen sc1
    s_waitcnt lgkmcnt(5)
    v_max3_f32 v22, v10, v11, v12
    v_max3_f32 v23, v13, v14, v15
    v_max3_f32 v22, v22, v16, v17
    s_waitcnt lgkmcnt(4)
    v_max3_f32 v23, v23, v18, v19
    v_max3_f32 v22, v22, v20, v21
    v_max_f32 v22, v22, v23
    v_mov_b32 v23, v22
    ds_read_b128 v[30:33], v2 offset:0
    ds_read_b128 v[34:37], v2 offset:1024
    v_permlane32_swap_b32 v22, v23
    v_max_f32 v22, v22, v23
    v_mov_b32 v23, v22
    ds_read_b128 v[38:41], v2 offset:2048
    ds_read_b128 v[42:45], v2 offset:3072
    v_permlane16_swap_b32 v22, v23
    v_max_f32 v22, v22, v23
    v_pk_add_f32 v[10:11], v[10:11], v[22:23] op_sel_hi:[1,0] neg_lo:[0,1] neg_hi:[0,1]
    v_pk_add_f32 v[12:13], v[12:13], v[22:23] op_sel_hi:[1,0] neg_lo:[0,1] neg_hi:[0,1]
    v_pk_add_f32 v[14:15], v[14:15], v[22:23] op_sel_hi:[1,0] neg_lo:[0,1] neg_hi:[0,1]
    v_pk_add_f32 v[16:17], v[16:17], v[22:23] op_sel_hi:[1,0] neg_lo:[0,1] neg_hi:[0,1]
    v_pk_add_f32 v[18:19], v[18:19], v[22:23] op_sel_hi:[1,0] neg_lo:[0,1] neg_hi:[0,1]
    v_pk_add_f32 v[20:21], v[20:21], v[22:23] op_sel_hi:[1,0] neg_lo:[0,1] neg_hi:[0,1]
    v_exp_f32 v10, v10
    v_exp_f32 v11, v11
    v_exp_f32 v12, v12
    v_exp_f32 v13, v13
    v_exp_f32 v14, v14
    v_exp_f32 v15, v15
    v_cvt_pk_bf16_f32 v24, v10, v11
    v_cvt_pk_bf16_f32 v25, v12, v13
    v_exp_f32 v16, v16
    v_exp_f32 v17, v17
    v_mfma_f32_16x16x16_bf16 v[46:49], v[88:89], v[24:25], 0
    v_mfma_f32_16x16x16_bf16 v[82:85], v[90:91], v[24:25], 0
    v_exp_f32 v18, v18
    v_exp_f32 v19, v19
    v_exp_f32 v20, v20
    v_exp_f32 v21, v21
    v_cvt_pk_bf16_f32 v26, v14, v15
    v_cvt_pk_bf16_f32 v27, v16, v17
    v_cvt_pk_bf16_f32 v28, v18, v19
    v_cvt_pk_bf16_f32 v29, v20, v21
    v_pk_add_f32 v[22:23], v[10:11], v[12:13]
    v_pk_add_f32 v[14:15], v[14:15], v[16:17]
    s_waitcnt lgkmcnt(4)
    v_mfma_f32_16x16x32_bf16 v[50:53], v[58:61], v[26:29], v[46:49]
    v_pk_add_f32 v[18:19], v[18:19], v[20:21]
    v_mfma_f32_16x16x32_bf16 v[54:57], v[66:69], v[26:29], v[46:49]
    v_pk_add_f32 v[22:23], v[22:23], v[14:15]
    v_pk_add_f32 v[22:23], v[22:23], v[18:19]
    v_mfma_f32_16x16x32_bf16 v[10:13], v[62:65], v[26:29], v[82:85]
    v_add_f32 v22, v22, v23
    v_mfma_f32_16x16x32_bf16 v[14:17], v[70:73], v[26:29], v[82:85]
    v_mov_b32 v23, v22
    ds_read_b128 v[74:77], v2 offset:4096
    ds_read_b128 v[78:81], v2 offset:5120
    v_permlane32_swap_b32 v22, v23
    v_add_f32 v22, v22, v23
    v_mov_b32 v23, v22
    v_cndmask_b32 v50, v54, v50, s[48:49]
    v_cndmask_b32 v51, v55, v51, s[48:49]
    v_permlane16_swap_b32 v22, v23
    v_add_f32 v22, v22, v23
    v_rcp_f32 v22, v22
    v_cndmask_b32 v52, v56, v52, s[48:49]
    v_cndmask_b32 v53, v57, v53, s[48:49]
    v_cndmask_b32 v10, v14, v10, s[48:49]
    v_cndmask_b32 v11, v15, v11, s[48:49]
    v_cndmask_b32 v12, v16, v12, s[48:49]
    v_cndmask_b32 v13, v17, v13, s[48:49]
    v_pk_mul_f32 v[50:51], v[50:51], v[22:23] op_sel_hi:[1,0]
    v_pk_mul_f32 v[52:53], v[52:53], v[22:23] op_sel_hi:[1,0]
    v_cvt_pk_bf16_f32 v24, v50, v51
    v_cvt_pk_bf16_f32 v25, v52, v53
    v_pk_mul_f32 v[10:11], v[10:11], v[22:23] op_sel_hi:[1,0]
    v_pk_mul_f32 v[12:13], v[12:13], v[22:23] op_sel_hi:[1,0]
    v_cvt_pk_bf16_f32 v26, v10, v11
    v_cvt_pk_bf16_f32 v27, v12, v13
    ds_write_b128 v0, v[24:27] offset:1024
    s_waitcnt lgkmcnt(0)
    s_barrier
    ds_read_b128 v[10:13], v0 offset:0
    ds_read_b128 v[14:17], v0 offset:1024
    ds_read_b128 v[18:21], v0 offset:2048
    s_add_u32 s20, s20, 1
    s_waitcnt lgkmcnt(2)
    v_mfma_f32_16x16x32_bf16 v[46:49], v[30:33], v[10:13], 0
    ds_read_b128 v[30:33], v2 offset:6144
    s_waitcnt lgkmcnt(2)
    v_mfma_f32_16x16x32_bf16 v[46:49], v[34:37], v[14:17], v[46:49]
    ds_read_b128 v[34:37], v2 offset:7168
    s_waitcnt lgkmcnt(2)
    v_mfma_f32_16x16x32_bf16 v[46:49], v[38:41], v[18:21], v[46:49]
    ds_read_b128 v[38:41], v2 offset:8192
    v_mfma_f32_16x16x32_bf16 v[50:53], v[42:45], v[10:13], 0
    ds_read_b128 v[42:45], v2 offset:9216
    v_mfma_f32_16x16x32_bf16 v[50:53], v[74:77], v[14:17], v[50:53]
    ds_read_b128 v[74:77], v2 offset:10240
    v_mfma_f32_16x16x32_bf16 v[50:53], v[78:81], v[18:21], v[50:53]
    ds_read_b128 v[78:81], v2 offset:11264
    s_waitcnt lgkmcnt(3)
    v_mfma_f32_16x16x32_bf16 v[54:57], v[30:33], v[10:13], 0
    ds_read_b128 v[30:33], v2 offset:12288
    v_cvt_pk_bf16_f32 v62, v46, v47
    v_mfma_f32_16x16x32_bf16 v[54:57], v[34:37], v[14:17], v[54:57]
    ds_read_b128 v[34:37], v2 offset:13312
    v_cvt_pk_bf16_f32 v63, v48, v49
    v_and_or_b32 v62, v62, -2, s22
    v_mfma_f32_16x16x32_bf16 v[54:57], v[38:41], v[18:21], v[54:57]
    ds_read_b128 v[38:41], v2 offset:14336
    v_cvt_pk_bf16_f32 v64, v50, v51
    s_waitcnt lgkmcnt(3)
    v_mfma_f32_16x16x32_bf16 v[58:61], v[42:45], v[10:13], 0
    ds_read_b128 v[42:45], v2 offset:15360
    v_cvt_pk_bf16_f32 v65, v52, v53
    v_mfma_f32_16x16x32_bf16 v[58:61], v[74:77], v[14:17], v[58:61]
    ds_read_b128 v[74:77], v2 offset:16384
    buffer_store_dwordx4 v[62:65], v3, s[4:7], s32 offen sc1
    v_mfma_f32_16x16x32_bf16 v[58:61], v[78:81], v[18:21], v[58:61]
    ds_read_b128 v[78:81], v2 offset:17408
    s_waitcnt lgkmcnt(3)
    v_mfma_f32_16x16x32_bf16 v[46:49], v[30:33], v[10:13], 0
    ds_read_b128 v[30:33], v2 offset:18432
    v_cvt_pk_bf16_f32 v66, v54, v55
    v_mfma_f32_16x16x32_bf16 v[46:49], v[34:37], v[14:17], v[46:49]
    ds_read_b128 v[34:37], v2 offset:19456
    v_cvt_pk_bf16_f32 v67, v56, v57
    v_and_or_b32 v66, v66, -2, s22
    v_mfma_f32_16x16x32_bf16 v[46:49], v[38:41], v[18:21], v[46:49]
    ds_read_b128 v[38:41], v2 offset:20480
    v_cvt_pk_bf16_f32 v68, v58, v59
    s_waitcnt lgkmcnt(3)
    v_mfma_f32_16x16x32_bf16 v[50:53], v[42:45], v[10:13], 0
    ds_read_b128 v[42:45], v2 offset:21504
    v_cvt_pk_bf16_f32 v69, v60, v61
    v_mfma_f32_16x16x32_bf16 v[50:53], v[74:77], v[14:17], v[50:53]
    ds_read_b128 v[74:77], v2 offset:22528
    buffer_store_dwordx4 v[66:69], v4, s[4:7], s32 offen sc1
    v_mfma_f32_16x16x32_bf16 v[50:53], v[78:81], v[18:21], v[50:53]
    ds_read_b128 v[78:81], v2 offset:23552
    s_waitcnt lgkmcnt(3)
    v_mfma_f32_16x16x32_bf16 v[54:57], v[30:33], v[10:13], 0
    ds_read_b128 v[30:33], v2 offset:24576
    v_cvt_pk_bf16_f32 v62, v46, v47
    v_mfma_f32_16x16x32_bf16 v[54:57], v[34:37], v[14:17], v[54:57]
    ds_read_b128 v[34:37], v2 offset:25600
    v_cvt_pk_bf16_f32 v63, v48, v49
    v_and_or_b32 v62, v62, -2, s22
    v_mfma_f32_16x16x32_bf16 v[54:57], v[38:41], v[18:21], v[54:57]
    ds_read_b128 v[38:41], v2 offset:26624
    v_cvt_pk_bf16_f32 v64, v50, v51
    s_waitcnt lgkmcnt(3)
    v_mfma_f32_16x16x32_bf16 v[58:61], v[42:45], v[10:13], 0
    ds_read_b128 v[42:45], v2 offset:27648
    v_cvt_pk_bf16_f32 v65, v52, v53
    v_mfma_f32_16x16x32_bf16 v[58:61], v[74:77], v[14:17], v[58:61]
    ds_read_b128 v[74:77], v2 offset:28672
    buffer_store_dwordx4 v[62:65], v5, s[4:7], s32 offen sc1
    v_mfma_f32_16x16x32_bf16 v[58:61], v[78:81], v[18:21], v[58:61]
    ds_read_b128 v[78:81], v2 offset:29696
    s_waitcnt lgkmcnt(3)
    v_mfma_f32_16x16x32_bf16 v[46:49], v[30:33], v[10:13], 0
    v_cvt_pk_bf16_f32 v66, v54, v55
    v_mfma_f32_16x16x32_bf16 v[46:49], v[34:37], v[14:17], v[46:49]
    v_cvt_pk_bf16_f32 v67, v56, v57
    v_and_or_b32 v66, v66, -2, s22
    v_mfma_f32_16x16x32_bf16 v[46:49], v[38:41], v[18:21], v[46:49]
    v_cvt_pk_bf16_f32 v68, v58, v59
    s_waitcnt lgkmcnt(0)
    v_mfma_f32_16x16x32_bf16 v[50:53], v[42:45], v[10:13], 0
    v_cvt_pk_bf16_f32 v69, v60, v61
    v_mfma_f32_16x16x32_bf16 v[50:53], v[74:77], v[14:17], v[50:53]
    buffer_store_dwordx4 v[66:69], v6, s[4:7], s32 offen sc1
    v_mfma_f32_16x16x32_bf16 v[50:53], v[78:81], v[18:21], v[50:53]
    s_nop 0
    v_cvt_pk_bf16_f32 v62, v46, v47
    v_cvt_pk_bf16_f32 v63, v48, v49
    v_and_or_b32 v62, v62, -2, s22
    s_nop 3
    v_cvt_pk_bf16_f32 v64, v50, v51
    v_cvt_pk_bf16_f32 v65, v52, v53
    buffer_store_dwordx4 v[62:65], v7, s[4:7], s32 offen sc1
    v_accvgpr_read_b32 v78, a252
    v_accvgpr_read_b32 v79, a253
    v_accvgpr_read_b32 v80, a254
    v_accvgpr_read_b32 v81, a255
    s_mov_b32 s19, 0
    s_waitcnt vmcnt(0)
    buffer_load_dwordx4 v[26:29], v8, s[4:7], s32 offen offset:0 sc1
    buffer_load_dwordx4 v[30:33], v8, s[4:7], s32 offen offset:2560 sc1
    buffer_load_dwordx4 v[34:37], v8, s[4:7], s33 offen offset:0 sc1
    buffer_load_dwordx4 v[38:41], v8, s[4:7], s33 offen offset:2560 sc1
    buffer_load_dwordx4 v[42:45], v8, s[4:7], s34 offen offset:0 sc1
    buffer_load_dwordx4 v[46:49], v8, s[4:7], s34 offen offset:2560 sc1
    buffer_load_dwordx4 v[50:53], v8, s[4:7], s35 offen offset:0 sc1
    buffer_load_dwordx4 v[54:57], v8, s[4:7], s35 offen offset:2560 sc1
L_Rs1_hb_8:
    s_waitcnt vmcnt(7)
    v_mfma_f32_16x16x32_bf16 v[70:73], a[248:251], v[26:29], 0
    v_xor_b32 v1, s44, v26
    s_waitcnt vmcnt(6)
    v_mfma_f32_16x16x32_bf16 v[70:73], a[248:251], v[30:33], v[70:73]
    v_bitop3_b32 v1, v1, v30, s44 bitop3:0xf6
    s_waitcnt vmcnt(5)
    v_mfma_f32_16x16x32_bf16 v[70:73], a[248:251], v[34:37], v[70:73]
    v_bitop3_b32 v1, v1, v34, s44 bitop3:0xf6
    s_waitcnt vmcnt(4)
    v_mfma_f32_16x16x32_bf16 v[70:73], a[248:251], v[38:41], v[70:73]
    v_bitop3_b32 v1, v1, v38, s44 bitop3:0xf6
    s_waitcnt vmcnt(3)
    v_mfma_f32_16x16x32_bf16 v[70:73], a[248:251], v[42:45], v[70:73]
    v_bitop3_b32 v1, v1, v42, s44 bitop3:0xf6
    s_waitcnt vmcnt(2)
    v_mfma_f32_16x16x32_bf16 v[70:73], a[248:251], v[46:49], v[70:73]
    v_bitop3_b32 v1, v1, v46, s44 bitop3:0xf6
    s_waitcnt vmcnt(1)
    v_mfma_f32_16x16x32_bf16 v[70:73], a[248:251], v[50:53], v[70:73]
    v_bitop3_b32 v1, v1, v50, s44 bitop3:0xf6
    s_waitcnt vmcnt(0)
    v_mfma_f32_16x16x32_bf16 v[70:73], a[248:251], v[54:57], v[70:73]
    v_bitop3_b32 v1, v1, v54, s44 bitop3:0xf6
    v_and_b32 v1, 1, v1
    v_cmp_ne_u32 vcc, 0, v1
    s_nop 0
    s_cbranch_vccnz L_Rs1_hbfix_9
    s_nop 2
    v_cvt_pk_bf16_f32 v74, v70, v71
    v_cvt_pk_bf16_f32 v75, v72, v73
    v_mov_b32 v76, v74
    v_mov_b32 v77, v75
    s_nop 0
    v_permlane16_swap_b32 v74, v76
    v_permlane16_swap_b32 v75, v77
    v_cndmask_b32 v74, v74, v78, s[42:43]
    v_cndmask_b32 v75, v75, v79, s[42:43]
    v_cndmask_b32 v76, v76, v80, s[42:43]
    v_cndmask_b32 v77, v77, v81, s[42:43]
    v_and_or_b32 v74, v74, -2, s24
    s_mov_b64 exec, s[46:47]
    buffer_store_dwordx4 v[74:77], v9, s[4:7], s36 offen sc1
    buffer_store_dwordx4 v[74:77], v9, s[4:7], s37 offen sc1
    s_mov_b64 exec, -1
    s_add_u32 s60, s20, 1
    s_and_b32 s22, s60, 1
    s_lshl_b32 s21, s22, 31
    s_sub_u32 s44, 0, s22
    s_bfe_u32 s23, s20, 0x10001
    s_sub_u32 s23, s23, 1
    s_lshr_b32 s24, s60, 1
    s_andn2_b32 s24, 1, s24
    s_lshl_b32 s61, s14, 15
    s_add_u32 s61, s61, 1179648
    s_and_b32 s25, s20, 1
    s_lshl_b32 s25, s25, 16
    s_add_u32 s25, s25, s61
    s_add_u32 s25, s25, 5120
    s_add_u32 s26, s25, 4096
    s_lshl_b32 s36, s22, 16
    s_add_u32 s36, s36, s61
    s_lshl_b32 s27, s20, 1
    s_add_u32 s37, s27, 2
    s_add_u32 s37, s37, s14
    s_mul_i32 s37, s37, 20480
    s_add_u32 s37, s37, 2621440
    s_add_u32 s27, s27, 1
    s_sub_u32 s27, s27, s14
    s_mul_i32 s27, s27, 20480
    s_add_u32 s27, s27, 2626560
    s_add_u32 s28, s27, 4096
    s_lshl_b32 s31, s20, 6
    s_add_u32 s31, s31, s13
    s_mul_i32 s31, s31, 6144
    s_add_u32 s31, s31, 5898240
    s_min_u32 s56, s20, 63
    s_lshl_b32 s56, s56, 6
    s_add_u32 s56, s56, s13
    s_mul_i32 s56, s56, 12288
    s_add_u32 s56, s56, 37364736
    s_max_u32 s57, s20, 7
    s_sub_u32 s57, s57, 7
    s_lshl_b32 s57, s57, 6
    s_add_u32 s57, s57, s13
    s_mul_i32 s57, s57, 12288
    s_add_u32 s57, s57, 87696384
    s_cmp_lt_u32 s20, 7
    s_cselect_b32 s57, s56, s57
    s_cmp_gt_u32 s60, 63
    s_cselect_b64 s[42:43], s[38:39], 0
    s_cmp_le_u32 s60, 7
    s_cselect_b64 vcc, s[40:41], 0
    s_or_b64 s[42:43], s[42:43], vcc
    s_waitcnt vmcnt(1)
    s_branch L_Rs1_top
L_Rs1_tail:
    s_waitcnt lgkmcnt(0)
    buffer_store_dwordx4 v[88:91], v0, s[4:7], s60 offen sc1
    s_waitcnt vmcnt(0) lgkmcnt(0)
    s_barrier
    v_mov_b32 v22, 71
    s_mov_b64 exec, 1
    s_mov_b64 exec, -1
    s_waitcnt vmcnt(0)
    s_endpgm
L_Rs1_glfix_3:
    buffer_load_dwordx4 v[10:13], v0, s[4:7], s25 offen offset:0 sc1
    buffer_load_dwordx4 v[14:17], v0, s[4:7], s25 offen offset:1024 sc1
    buffer_load_dwordx4 v[18:21], v0, s[4:7], s25 offen offset:2048 sc1
    buffer_load_dwordx4 v[22:25], v0, s[4:7], s25 offen offset:3072 sc1
    buffer_load_dwordx4 v[26:29], v0, s[4:7], s26 offen offset:0 sc1
    buffer_load_dwordx4 v[46:49], v0, s[4:7], s27 offen offset:0 sc1
    buffer_load_dwordx4 v[30:33], v0, s[4:7], s27 offen offset:1024 sc1
    buffer_load_dwordx4 v[34:37], v0, s[4:7], s27 offen offset:2048 sc1
    buffer_load_dwordx4 v[38:41], v0, s[4:7], s27 offen offset:3072 sc1
    buffer_load_dwordx4 v[42:45], v0, s[4:7], s28 offen offset:0 sc1
    s_add_u32 s19, s19, 1
    s_cmp_lt_u32 s19, 524288
    s_cbranch_scc1 L_Rs1_gl_1
    s_branch L_fail
L_Rs1_grfix_5:
    buffer_load_dwordx4 v[46:49], v0, s[4:7], s27 offen offset:0 sc1
    buffer_load_dwordx4 v[30:33], v0, s[4:7], s27 offen offset:1024 sc1
    buffer_load_dwordx4 v[34:37], v0, s[4:7], s27 offen offset:2048 sc1
    buffer_load_dwordx4 v[38:41], v0, s[4:7], s27 offen offset:3072 sc1
    buffer_load_dwordx4 v[42:45], v0, s[4:7], s28 offen offset:0 sc1
    s_add_u32 s19, s19, 1
    s_cmp_lt_u32 s19, 524288
    s_cbranch_scc1 L_Rs1_gr2_4
    s_branch L_fail
L_Rs1_gr2_4:
    v_mfma_f32_16x16x32_bf16 v[50:53], a[240:243], v[10:13], 0
    v_mfma_f32_16x16x32_bf16 v[54:57], a[244:247], v[10:13], 0
    v_mfma_f32_16x16x32_bf16 v[58:61], a[240:243], v[14:17], 0
    v_mfma_f32_16x16x32_bf16 v[62:65], a[244:247], v[14:17], 0
    v_mfma_f32_16x16x32_bf16 v[66:69], a[240:243], v[18:21], 0
    v_mfma_f32_16x16x32_bf16 v[70:73], a[244:247], v[18:21], 0
    v_mfma_f32_16x16x32_bf16 v[74:77], a[240:243], v[22:25], 0
    v_mfma_f32_16x16x32_bf16 v[78:81], a[244:247], v[22:25], 0
    v_mfma_f32_16x16x32_bf16 v[82:85], a[240:243], v[26:29], 0
    v_mfma_f32_16x16x32_bf16 v[86:89], a[244:247], v[26:29], 0
    s_branch L_Rs1_gr_2
L_Rs1_hafix_7:
    buffer_load_dwordx4 v[82:85], v0, s[4:7], s30 offen sc1
    s_add_u32 s19, s19, 1
    s_cmp_lt_u32 s19, 524288
    s_cbranch_scc1 L_Rs1_ha_6
    s_branch L_fail
L_Rs1_hbfix_9:
    buffer_load_dwordx4 v[26:29], v8, s[4:7], s32 offen offset:0 sc1
    buffer_load_dwordx4 v[30:33], v8, s[4:7], s32 offen offset:2560 sc1
    buffer_load_dwordx4 v[34:37], v8, s[4:7], s33 offen offset:0 sc1
    buffer_load_dwordx4 v[38:41], v8, s[4:7], s33 offen offset:2560 sc1
    buffer_load_dwordx4 v[42:45], v8, s[4:7], s34 offen offset:0 sc1
    buffer_load_dwordx4 v[46:49], v8, s[4:7], s34 offen offset:2560 sc1
    buffer_load_dwordx4 v[50:53], v8, s[4:7], s35 offen offset:0 sc1
    buffer_load_dwordx4 v[54:57], v8, s[4:7], s35 offen offset:2560 sc1
    s_add_u32 s19, s19, 1
    s_cmp_lt_u32 s19, 524288
    s_cbranch_scc1 L_Rs1_hb_8
    s_branch L_fail
L_R2_start:
    s_lshr_b32 s14, s13, 5
    s_and_b32 s15, s13, 31
    s_mov_b32 s62, 35840
    v_lshlrev_b32 v10, 4, v0
    v_mov_b32 v12, 0
    v_mov_b32 v13, 0
    v_mov_b32 v14, 0
    v_mov_b32 v15, 0
    v_mov_b32 v16, -1
    v_mov_b32 v17, -1
    v_mov_b32 v18, -1
    v_mov_b32 v19, -1
    s_lshl_b32 s60, s13, 12
    s_add_u32 s60, s60, 919552
    buffer_store_dwordx4 v[12:15], v10, s[4:7], s60 offen sc1
    s_mul_i32 s60, s13, 20480
    s_add_u32 s60, s60, 1320960
    buffer_store_dwordx4 v[12:15], v10, s[4:7], s60 offen sc1
    s_add_u32 s60, s60, 1024
    buffer_store_dwordx4 v[12:15], v10, s[4:7], s60 offen sc1
    s_add_u32 s60, s60, 1024
    buffer_store_dwordx4 v[12:15], v10, s[4:7], s60 offen sc1
    s_add_u32 s60, s60, 1024
    buffer_store_dwordx4 v[12:15], v10, s[4:7], s60 offen sc1
    s_add_u32 s60, s60, 1024
    buffer_store_dwordx4 v[12:15], v10, s[4:7], s60 offen sc1
    s_add_u32 s60, s60, 1024
    s_mul_i32 s61, s15, 640
    v_add_u32 v11, s61, v10
    s_mov_b32 exec_hi, 0xff
    s_lshl_b32 s60, s14, 15
    s_mul_i32 s60, s14, 20480
    s_add_u32 s60, s60, 2703360
    buffer_store_dwordx4 v[16:19], v11, s[4:7], s60 offen sc1
    s_add_u32 s60, s60, 163840
    buffer_store_dwordx4 v[16:19], v11, s[4:7], s60 offen sc1
    s_add_u32 s60, s60, 163840
    buffer_store_dwordx4 v[16:19], v11, s[4:7], s60 offen sc1
    s_add_u32 s60, s60, 163840
    buffer_store_dwordx4 v[16:19], v11, s[4:7], s60 offen sc1
    s_add_u32 s60, s60, 163840
    buffer_store_dwordx4 v[16:19], v11, s[4:7], s60 offen sc1
    s_add_u32 s60, s60, 163840
    buffer_store_dwordx4 v[16:19], v11, s[4:7], s60 offen sc1
    s_add_u32 s60, s60, 163840
    buffer_store_dwordx4 v[16:19], v11, s[4:7], s60 offen sc1
    s_add_u32 s60, s60, 163840
    buffer_store_dwordx4 v[16:19], v11, s[4:7], s60 offen sc1
    s_add_u32 s60, s60, 163840
    buffer_store_dwordx4 v[16:19], v11, s[4:7], s60 offen sc1
    s_add_u32 s60, s60, 163840
    buffer_store_dwordx4 v[16:19], v11, s[4:7], s60 offen sc1
    s_add_u32 s60, s60, 163840
    buffer_store_dwordx4 v[16:19], v11, s[4:7], s60 offen sc1
    s_add_u32 s60, s60, 163840
    buffer_store_dwordx4 v[16:19], v11, s[4:7], s60 offen sc1
    s_add_u32 s60, s60, 163840
    buffer_store_dwordx4 v[16:19], v11, s[4:7], s60 offen sc1
    s_add_u32 s60, s60, 163840
    buffer_store_dwordx4 v[16:19], v11, s[4:7], s60 offen sc1
    s_add_u32 s60, s60, 163840
    buffer_store_dwordx4 v[16:19], v11, s[4:7], s60 offen sc1
    s_add_u32 s60, s60, 163840
    buffer_store_dwordx4 v[16:19], v11, s[4:7], s60 offen sc1
    s_add_u32 s60, s60, 163840
    buffer_store_dwordx4 v[16:19], v11, s[4:7], s60 offen sc1
    s_add_u32 s60, s60, 163840
    buffer_store_dwordx4 v[16:19], v11, s[4:7], s60 offen sc1
    s_add_u32 s60, s60, 163840
    s_mov_b64 exec, 1
    s_lshl_b32 s54, s13, 9
    s_lshr_b32 s55, s13, 1
    s_mul_i32 s55, s55, 1536
    s_add_u32 s55, s55, 32768
    s_add_u32 s54, s54, 256
    buffer_store_dword v12, v10, s[4:7], s54 offen sc1
    s_mov_b64 exec, -1
    v_add_u32 v38, 0, v0
    v_mul_u32_u24 v39, 10923, v38
    v_lshrrev_b32 v39, 16, v39
    v_mul_u32_u24 v20, 6, v39
    v_sub_u32 v20, v38, v20
    v_lshrrev_b32 v20, 0, v20
    v_lshlrev_b32 v20, 4, v20
    v_mul_u32_u24 v39, 12288, v39
    v_add_u32 v20, v20, v39
    v_add_u32 v38, 64, v0
    v_mul_u32_u24 v39, 10923, v38
    v_lshrrev_b32 v39, 16, v39
    v_mul_u32_u24 v21, 6, v39
    v_sub_u32 v21, v38, v21
    v_lshrrev_b32 v21, 0, v21
    v_lshlrev_b32 v21, 4, v21
    v_mul_u32_u24 v39, 12288, v39
    v_add_u32 v21, v21, v39
    v_add_u32 v38, 128, v0
    v_mul_u32_u24 v39, 10923, v38
    v_lshrrev_b32 v39, 16, v39
    v_mul_u32_u24 v22, 6, v39
    v_sub_u32 v22, v38, v22
    v_lshrrev_b32 v22, 0, v22
    v_lshlrev_b32 v22, 4, v22
    v_mul_u32_u24 v39, 12288, v39
    v_add_u32 v22, v22, v39
    v_add_u32 v38, 0, v0
    v_mul_u32_u24 v39, 16385, v38
    v_lshrrev_b32 v39, 16, v39
    v_mul_u32_u24 v23, 4, v39
    v_sub_u32 v23, v38, v23
    v_lshrrev_b32 v23, 0, v23
    v_lshlrev_b32 v23, 4, v23
    v_mul_u32_u24 v39, 12288, v39
    v_add_u32 v23, v23, v39
    v_add_u32 v38, 64, v0
    v_mul_u32_u24 v39, 16385, v38
    v_lshrrev_b32 v39, 16, v39
    v_mul_u32_u24 v24, 4, v39
    v_sub_u32 v24, v38, v24
    v_lshrrev_b32 v24, 0, v24
    v_lshlrev_b32 v24, 4, v24
    v_mul_u32_u24 v39, 12288, v39
    v_add_u32 v24, v24, v39
    v_add_u32 v38, 0, v0
    v_mul_u32_u24 v39, 3277, v38
    v_lshrrev_b32 v39, 16, v39
    v_mul_u32_u24 v25, 20, v39
    v_sub_u32 v25, v38, v25
    v_lshrrev_b32 v25, 0, v25
    v_lshlrev_b32 v25, 4, v25
    v_mul_u32_u24 v39, 1280, v39
    v_add_u32 v25, v25, v39
    v_add_u32 v38, 64, v0
    v_mul_u32_u24 v39, 3277, v38
    v_lshrrev_b32 v39, 16, v39
    v_mul_u32_u24 v26, 20, v39
    v_sub_u32 v26, v38, v26
    v_lshrrev_b32 v26, 0, v26
    v_lshlrev_b32 v26, 4, v26
    v_mul_u32_u24 v39, 1280, v39
    v_add_u32 v26, v26, v39
    v_add_u32 v38, 128, v0
    v_mul_u32_u24 v39, 3277, v38
    v_lshrrev_b32 v39, 16, v39
    v_mul_u32_u24 v27, 20, v39
    v_sub_u32 v27, v38, v27
    v_lshrrev_b32 v27, 0, v27
    v_lshlrev_b32 v27, 4, v27
    v_mul_u32_u24 v39, 1280, v39
    v_add_u32 v27, v27, v39
    v_add_u32 v38, 192, v0
    v_mul_u32_u24 v39, 3277, v38
    v_lshrrev_b32 v39, 16, v39
    v_mul_u32_u24 v28, 20, v39
    v_sub_u32 v28, v38, v28
    v_lshrrev_b32 v28, 0, v28
    v_lshlrev_b32 v28, 4, v28
    v_mul_u32_u24 v39, 1280, v39
    v_add_u32 v28, v28, v39
    v_add_u32 v38, 256, v0
    v_mul_u32_u24 v39, 3277, v38
    v_lshrrev_b32 v39, 16, v39
    v_mul_u32_u24 v29, 20, v39
    v_sub_u32 v29, v38, v29
    v_lshrrev_b32 v29, 0, v29
    v_lshlrev_b32 v29, 4, v29
    v_mul_u32_u24 v39, 1280, v39
    v_add_u32 v29, v29, v39
    v_add_u32 v38, 320, v0
    v_mul_u32_u24 v39, 3277, v38
    v_lshrrev_b32 v39, 16, v39
    v_mul_u32_u24 v30, 20, v39
    v_sub_u32 v30, v38, v30
    v_lshrrev_b32 v30, 0, v30
    v_lshlrev_b32 v30, 4, v30
    v_mul_u32_u24 v39, 1280, v39
    v_add_u32 v30, v30, v39
    v_add_u32 v38, 384, v0
    v_mul_u32_u24 v39, 3277, v38
    v_lshrrev_b32 v39, 16, v39
    v_mul_u32_u24 v31, 20, v39
    v_sub_u32 v31, v38, v31
    v_lshrrev_b32 v31, 0, v31
    v_lshlrev_b32 v31, 4, v31
    v_mul_u32_u24 v39, 1280, v39
    v_add_u32 v31, v31, v39
    v_add_u32 v38, 448, v0
    v_mul_u32_u24 v39, 3277, v38
    v_lshrrev_b32 v39, 16, v39
    v_mul_u32_u24 v32, 20, v39
    v_sub_u32 v32, v38, v32
    v_lshrrev_b32 v32, 0, v32
    v_lshlrev_b32 v32, 4, v32
    v_mul_u32_u24 v39, 1280, v39
    v_add_u32 v32, v32, v39
    v_add_u32 v38, 512, v0
    v_mul_u32_u24 v39, 3277, v38
    v_lshrrev_b32 v39, 16, v39
    v_mul_u32_u24 v33, 20, v39
    v_sub_u32 v33, v38, v33
    v_lshrrev_b32 v33, 0, v33
    v_lshlrev_b32 v33, 4, v33
    v_mul_u32_u24 v39, 1280, v39
    v_add_u32 v33, v33, v39
    v_add_u32 v38, 576, v0
    v_mul_u32_u24 v39, 3277, v38
    v_lshrrev_b32 v39, 16, v39
    v_mul_u32_u24 v34, 20, v39
    v_sub_u32 v34, v38, v34
    v_lshrrev_b32 v34, 0, v34
    v_lshlrev_b32 v34, 4, v34
    v_mul_u32_u24 v39, 1280, v39
    v_add_u32 v34, v34, v39
    v_lshrrev_b32 v35, 2, v0
    v_mul_u32_u24 v35, 96, v35
    v_and_b32 v38, 3, v0
    v_lshl_add_u32 v35, v38, 3, v35
    v_add_u32 v35, s62, v35
    v_lshrrev_b32 v36, 2, v0
    v_mul_u32_u24 v36, 64, v36
    v_and_b32 v38, 3, v0
    v_lshl_add_u32 v36, v38, 3, v36
    v_add_u32 v36, s62, v36
    v_lshrrev_b32 v37, 2, v0
    v_mul_u32_u24 v37, 320, v37
    v_and_b32 v38, 3, v0
    v_lshl_add_u32 v37, v38, 3, v37
    v_add_u32 v37, s62, v37
    v_add_u32 v2, 133120, v10
    s_mov_b32 s8, s70
    s_and_b32 s9, s71, 0xffff
    s_mov_b32 s10, 7864320
    s_mov_b32 s11, 0x20000
    s_mov_b32 s28, s72
    s_and_b32 s29, s73, 0xffff
    s_mov_b32 s30, 7864320
    s_mov_b32 s31, 0x20000
    s_mov_b32 s32, s74
    s_and_b32 s33, s75, 0xffff
    s_mov_b32 s34, 7864320
    s_mov_b32 s35, 0x20000
    s_mul_i32 s60, s13, 192
    s_add_u32 s25, s60, 0
    s_add_u32 s26, s60, 128
    s_mul_i32 s27, s13, 122880
    s_add_u32 s27, s27, 640
    s_add_u32 m0, s62, 0
    s_nop 0
    buffer_load_dwordx4 v20, s[8:11], s25 offen lds
    s_add_u32 m0, s62, 1024
    s_nop 0
    buffer_load_dwordx4 v21, s[8:11], s25 offen lds
    s_add_u32 m0, s62, 2048
    s_nop 0
    buffer_load_dwordx4 v22, s[8:11], s25 offen lds
    s_add_u32 s25, s25, 393216
    s_add_u32 m0, s62, 3072
    s_nop 0
    buffer_load_dwordx4 v20, s[8:11], s25 offen lds
    s_add_u32 m0, s62, 4096
    s_nop 0
    buffer_load_dwordx4 v21, s[8:11], s25 offen lds
    s_add_u32 m0, s62, 5120
    s_nop 0
    buffer_load_dwordx4 v22, s[8:11], s25 offen lds
    s_add_u32 s25, s25, 393216
    s_add_u32 m0, s62, 6144
    s_nop 0
    buffer_load_dwordx4 v20, s[8:11], s25 offen lds
    s_add_u32 m0, s62, 7168
    s_nop 0
    buffer_load_dwordx4 v21, s[8:11], s25 offen lds
    s_add_u32 m0, s62, 8192
    s_nop 0
    buffer_load_dwordx4 v22, s[8:11], s25 offen lds
    s_add_u32 s25, s25, 393216
    s_add_u32 m0, s62, 9216
    s_nop 0
    buffer_load_dwordx4 v20, s[8:11], s25 offen lds
    s_add_u32 m0, s62, 10240
    s_nop 0
    buffer_load_dwordx4 v21, s[8:11], s25 offen lds
    s_add_u32 m0, s62, 11264
    s_nop 0
    buffer_load_dwordx4 v22, s[8:11], s25 offen lds
    s_add_u32 s25, s25, 393216
    s_add_u32 m0, s62, 12288
    s_nop 0
    buffer_load_dwordx4 v20, s[8:11], s25 offen lds
    s_add_u32 m0, s62, 13312
    s_nop 0
    buffer_load_dwordx4 v21, s[8:11], s25 offen lds
    s_add_u32 m0, s62, 14336
    s_nop 0
    buffer_load_dwordx4 v22, s[8:11], s25 offen lds
    s_waitcnt vmcnt(12)
    s_barrier
    s_cmp_lg_u32 s12, 0
    s_cbranch_scc1 L_R2_arr_1
    s_lshl_b32 s3, s18, 2
    s_add_u32 s3, s3, 64
    v_mov_b32 v92, s3
    v_mov_b32 v93, 1
    s_mov_b64 exec, 1
    global_atomic_add v92, v93, s[16:17] sc1
    s_waitcnt vmcnt(0)
    s_mov_b64 exec, -1
L_R2_arr_1:
    ds_read_b64_tr_b16 a[0:1], v35 offset:0
    ds_read_b64_tr_b16 a[2:3], v35 offset:1536
    ds_read_b64_tr_b16 a[80:81], v35 offset:32
    ds_read_b64_tr_b16 a[82:83], v35 offset:1568
    ds_read_b64_tr_b16 a[160:161], v35 offset:64
    ds_read_b64_tr_b16 a[162:163], v35 offset:1600
    s_waitcnt lgkmcnt(0)
    s_add_u32 s25, s25, 393216
    s_add_u32 m0, s62, 0
    s_nop 0
    buffer_load_dwordx4 v20, s[8:11], s25 offen lds
    s_add_u32 m0, s62, 1024
    s_nop 0
    buffer_load_dwordx4 v21, s[8:11], s25 offen lds
    s_add_u32 m0, s62, 2048
    s_nop 0
    buffer_load_dwordx4 v22, s[8:11], s25 offen lds
    s_waitcnt vmcnt(12)
    ds_read_b64_tr_b16 a[4:5], v35 offset:3072
    ds_read_b64_tr_b16 a[6:7], v35 offset:4608
    ds_read_b64_tr_b16 a[84:85], v35 offset:3104
    ds_read_b64_tr_b16 a[86:87], v35 offset:4640
    ds_read_b64_tr_b16 a[164:165], v35 offset:3136
    ds_read_b64_tr_b16 a[166:167], v35 offset:4672
    s_waitcnt lgkmcnt(0)
    s_add_u32 s25, s25, 393216
    s_add_u32 m0, s62, 3072
    s_nop 0
    buffer_load_dwordx4 v20, s[8:11], s25 offen lds
    s_add_u32 m0, s62, 4096
    s_nop 0
    buffer_load_dwordx4 v21, s[8:11], s25 offen lds
    s_add_u32 m0, s62, 5120
    s_nop 0
    buffer_load_dwordx4 v22, s[8:11], s25 offen lds
    s_waitcnt vmcnt(12)
    ds_read_b64_tr_b16 a[8:9], v35 offset:6144
    ds_read_b64_tr_b16 a[10:11], v35 offset:7680
    ds_read_b64_tr_b16 a[88:89], v35 offset:6176
    ds_read_b64_tr_b16 a[90:91], v35 offset:7712
    ds_read_b64_tr_b16 a[168:169], v35 offset:6208
    ds_read_b64_tr_b16 a[170:171], v35 offset:7744
    s_waitcnt lgkmcnt(0)
    s_add_u32 s25, s25, 393216
    s_add_u32 m0, s62, 6144
    s_nop 0
    buffer_load_dwordx4 v20, s[8:11], s25 offen lds
    s_add_u32 m0, s62, 7168
    s_nop 0
    buffer_load_dwordx4 v21, s[8:11], s25 offen lds
    s_add_u32 m0, s62, 8192
    s_nop 0
    buffer_load_dwordx4 v22, s[8:11], s25 offen lds
    s_waitcnt vmcnt(12)
    ds_read_b64_tr_b16 a[12:13], v35 offset:9216
    ds_read_b64_tr_b16 a[14:15], v35 offset:10752
    ds_read_b64_tr_b16 a[92:93], v35 offset:9248
    ds_read_b64_tr_b16 a[94:95], v35 offset:10784
    ds_read_b64_tr_b16 a[172:173], v35 offset:9280
    ds_read_b64_tr_b16 a[174:175], v35 offset:10816
    s_waitcnt lgkmcnt(0)
    s_add_u32 s25, s25, 393216
    s_add_u32 m0, s62, 9216
    s_nop 0
    buffer_load_dwordx4 v20, s[8:11], s25 offen lds
    s_add_u32 m0, s62, 10240
    s_nop 0
    buffer_load_dwordx4 v21, s[8:11], s25 offen lds
    s_add_u32 m0, s62, 11264
    s_nop 0
    buffer_load_dwordx4 v22, s[8:11], s25 offen lds
    s_waitcnt vmcnt(12)
    ds_read_b64_tr_b16 a[16:17], v35 offset:12288
    ds_read_b64_tr_b16 a[18:19], v35 offset:13824
    ds_read_b64_tr_b16 a[96:97], v35 offset:12320
    ds_read_b64_tr_b16 a[98:99], v35 offset:13856
    ds_read_b64_tr_b16 a[176:177], v35 offset:12352
    ds_read_b64_tr_b16 a[178:179], v35 offset:13888
    s_waitcnt lgkmcnt(0)
    s_add_u32 s25, s25, 393216
    s_add_u32 m0, s62, 12288
    s_nop 0
    buffer_load_dwordx4 v20, s[8:11], s25 offen lds
    s_add_u32 m0, s62, 13312
    s_nop 0
    buffer_load_dwordx4 v21, s[8:11], s25 offen lds
    s_add_u32 m0, s62, 14336
    s_nop 0
    buffer_load_dwordx4 v22, s[8:11], s25 offen lds
    s_waitcnt vmcnt(12)
    ds_read_b64_tr_b16 a[20:21], v35 offset:0
    ds_read_b64_tr_b16 a[22:23], v35 offset:1536
    ds_read_b64_tr_b16 a[100:101], v35 offset:32
    ds_read_b64_tr_b16 a[102:103], v35 offset:1568
    ds_read_b64_tr_b16 a[180:181], v35 offset:64
    ds_read_b64_tr_b16 a[182:183], v35 offset:1600
    s_waitcnt lgkmcnt(0)
    s_add_u32 s25, s25, 393216
    s_add_u32 m0, s62, 0
    s_nop 0
    buffer_load_dwordx4 v20, s[8:11], s25 offen lds
    s_add_u32 m0, s62, 1024
    s_nop 0
    buffer_load_dwordx4 v21, s[8:11], s25 offen lds
    s_add_u32 m0, s62, 2048
    s_nop 0
    buffer_load_dwordx4 v22, s[8:11], s25 offen lds
    s_waitcnt vmcnt(12)
    ds_read_b64_tr_b16 a[24:25], v35 offset:3072
    ds_read_b64_tr_b16 a[26:27], v35 offset:4608
    ds_read_b64_tr_b16 a[104:105], v35 offset:3104
    ds_read_b64_tr_b16 a[106:107], v35 offset:4640
    ds_read_b64_tr_b16 a[184:185], v35 offset:3136
    ds_read_b64_tr_b16 a[186:187], v35 offset:4672
    s_waitcnt lgkmcnt(0)
    s_add_u32 s25, s25, 393216
    s_add_u32 m0, s62, 3072
    s_nop 0
    buffer_load_dwordx4 v20, s[8:11], s25 offen lds
    s_add_u32 m0, s62, 4096
    s_nop 0
    buffer_load_dwordx4 v21, s[8:11], s25 offen lds
    s_add_u32 m0, s62, 5120
    s_nop 0
    buffer_load_dwordx4 v22, s[8:11], s25 offen lds
    s_waitcnt vmcnt(12)
    ds_read_b64_tr_b16 a[28:29], v35 offset:6144
    ds_read_b64_tr_b16 a[30:31], v35 offset:7680
    ds_read_b64_tr_b16 a[108:109], v35 offset:6176
    ds_read_b64_tr_b16 a[110:111], v35 offset:7712
    ds_read_b64_tr_b16 a[188:189], v35 offset:6208
    ds_read_b64_tr_b16 a[190:191], v35 offset:7744
    s_waitcnt lgkmcnt(0)
    s_add_u32 s25, s25, 393216
    s_add_u32 m0, s62, 6144
    s_nop 0
    buffer_load_dwordx4 v20, s[8:11], s25 offen lds
    s_add_u32 m0, s62, 7168
    s_nop 0
    buffer_load_dwordx4 v21, s[8:11], s25 offen lds
    s_add_u32 m0, s62, 8192
    s_nop 0
    buffer_load_dwordx4 v22, s[8:11], s25 offen lds
    s_waitcnt vmcnt(12)
    ds_read_b64_tr_b16 a[32:33], v35 offset:9216
    ds_read_b64_tr_b16 a[34:35], v35 offset:10752
    ds_read_b64_tr_b16 a[112:113], v35 offset:9248
    ds_read_b64_tr_b16 a[114:115], v35 offset:10784
    ds_read_b64_tr_b16 a[192:193], v35 offset:9280
    ds_read_b64_tr_b16 a[194:195], v35 offset:10816
    s_waitcnt lgkmcnt(0)
    s_add_u32 s25, s25, 393216
    s_add_u32 m0, s62, 9216
    s_nop 0
    buffer_load_dwordx4 v20, s[8:11], s25 offen lds
    s_add_u32 m0, s62, 10240
    s_nop 0
    buffer_load_dwordx4 v21, s[8:11], s25 offen lds
    s_add_u32 m0, s62, 11264
    s_nop 0
    buffer_load_dwordx4 v22, s[8:11], s25 offen lds
    s_waitcnt vmcnt(12)
    ds_read_b64_tr_b16 a[36:37], v35 offset:12288
    ds_read_b64_tr_b16 a[38:39], v35 offset:13824
    ds_read_b64_tr_b16 a[116:117], v35 offset:12320
    ds_read_b64_tr_b16 a[118:119], v35 offset:13856
    ds_read_b64_tr_b16 a[196:197], v35 offset:12352
    ds_read_b64_tr_b16 a[198:199], v35 offset:13888
    s_waitcnt lgkmcnt(0)
    s_add_u32 s25, s25, 393216
    s_add_u32 m0, s62, 12288
    s_nop 0
    buffer_load_dwordx4 v20, s[8:11], s25 offen lds
    s_add_u32 m0, s62, 13312
    s_nop 0
    buffer_load_dwordx4 v21, s[8:11], s25 offen lds
    s_add_u32 m0, s62, 14336
    s_nop 0
    buffer_load_dwordx4 v22, s[8:11], s25 offen lds
    s_waitcnt vmcnt(12)
    ds_read_b64_tr_b16 a[40:41], v35 offset:0
    ds_read_b64_tr_b16 a[42:43], v35 offset:1536
    ds_read_b64_tr_b16 a[120:121], v35 offset:32
    ds_read_b64_tr_b16 a[122:123], v35 offset:1568
    ds_read_b64_tr_b16 a[200:201], v35 offset:64
    ds_read_b64_tr_b16 a[202:203], v35 offset:1600
    s_waitcnt lgkmcnt(0)
    s_add_u32 s25, s25, 393216
    s_add_u32 m0, s62, 0
    s_nop 0
    buffer_load_dwordx4 v20, s[8:11], s25 offen lds
    s_add_u32 m0, s62, 1024
    s_nop 0
    buffer_load_dwordx4 v21, s[8:11], s25 offen lds
    s_add_u32 m0, s62, 2048
    s_nop 0
    buffer_load_dwordx4 v22, s[8:11], s25 offen lds
    s_waitcnt vmcnt(12)
    ds_read_b64_tr_b16 a[44:45], v35 offset:3072
    ds_read_b64_tr_b16 a[46:47], v35 offset:4608
    ds_read_b64_tr_b16 a[124:125], v35 offset:3104
    ds_read_b64_tr_b16 a[126:127], v35 offset:4640
    ds_read_b64_tr_b16 a[204:205], v35 offset:3136
    ds_read_b64_tr_b16 a[206:207], v35 offset:4672
    s_waitcnt lgkmcnt(0)
    s_add_u32 s25, s25, 393216
    s_add_u32 m0, s62, 3072
    s_nop 0
    buffer_load_dwordx4 v20, s[8:11], s25 offen lds
    s_add_u32 m0, s62, 4096
    s_nop 0
    buffer_load_dwordx4 v21, s[8:11], s25 offen lds
    s_add_u32 m0, s62, 5120
    s_nop 0
    buffer_load_dwordx4 v22, s[8:11], s25 offen lds
    s_waitcnt vmcnt(12)
    ds_read_b64_tr_b16 a[48:49], v35 offset:6144
    ds_read_b64_tr_b16 a[50:51], v35 offset:7680
    ds_read_b64_tr_b16 a[128:129], v35 offset:6176
    ds_read_b64_tr_b16 a[130:131], v35 offset:7712
    ds_read_b64_tr_b16 a[208:209], v35 offset:6208
    ds_read_b64_tr_b16 a[210:211], v35 offset:7744
    s_waitcnt lgkmcnt(0)
    s_add_u32 s25, s25, 393216
    s_add_u32 m0, s62, 6144
    s_nop 0
    buffer_load_dwordx4 v20, s[8:11], s25 offen lds
    s_add_u32 m0, s62, 7168
    s_nop 0
    buffer_load_dwordx4 v21, s[8:11], s25 offen lds
    s_add_u32 m0, s62, 8192
    s_nop 0
    buffer_load_dwordx4 v22, s[8:11], s25 offen lds
    s_waitcnt vmcnt(12)
    ds_read_b64_tr_b16 a[52:53], v35 offset:9216
    ds_read_b64_tr_b16 a[54:55], v35 offset:10752
    ds_read_b64_tr_b16 a[132:133], v35 offset:9248
    ds_read_b64_tr_b16 a[134:135], v35 offset:10784
    ds_read_b64_tr_b16 a[212:213], v35 offset:9280
    ds_read_b64_tr_b16 a[214:215], v35 offset:10816
    s_waitcnt lgkmcnt(0)
    s_add_u32 s25, s25, 393216
    s_add_u32 m0, s62, 9216
    s_nop 0
    buffer_load_dwordx4 v20, s[8:11], s25 offen lds
    s_add_u32 m0, s62, 10240
    s_nop 0
    buffer_load_dwordx4 v21, s[8:11], s25 offen lds
    s_add_u32 m0, s62, 11264
    s_nop 0
    buffer_load_dwordx4 v22, s[8:11], s25 offen lds
    s_waitcnt vmcnt(12)
    ds_read_b64_tr_b16 a[56:57], v35 offset:12288
    ds_read_b64_tr_b16 a[58:59], v35 offset:13824
    ds_read_b64_tr_b16 a[136:137], v35 offset:12320
    ds_read_b64_tr_b16 a[138:139], v35 offset:13856
    ds_read_b64_tr_b16 a[216:217], v35 offset:12352
    ds_read_b64_tr_b16 a[218:219], v35 offset:13888
    s_waitcnt lgkmcnt(0)
    s_add_u32 s25, s25, 393216
    s_add_u32 m0, s62, 12288
    s_nop 0
    buffer_load_dwordx4 v20, s[8:11], s25 offen lds
    s_add_u32 m0, s62, 13312
    s_nop 0
    buffer_load_dwordx4 v21, s[8:11], s25 offen lds
    s_add_u32 m0, s62, 14336
    s_nop 0
    buffer_load_dwordx4 v22, s[8:11], s25 offen lds
    s_add_u32 m0, s62, 15360
    s_nop 0
    buffer_load_dwordx4 v23, s[28:31], s26 offen lds
    s_add_u32 m0, s62, 16384
    s_nop 0
    buffer_load_dwordx4 v24, s[28:31], s26 offen lds
    s_waitcnt vmcnt(14)
    ds_read_b64_tr_b16 a[60:61], v35 offset:0
    ds_read_b64_tr_b16 a[62:63], v35 offset:1536
    ds_read_b64_tr_b16 a[140:141], v35 offset:32
    ds_read_b64_tr_b16 a[142:143], v35 offset:1568
    ds_read_b64_tr_b16 a[220:221], v35 offset:64
    ds_read_b64_tr_b16 a[222:223], v35 offset:1600
    s_waitcnt lgkmcnt(0)
    s_add_u32 s26, s26, 393216
    s_add_u32 m0, s62, 0
    s_nop 0
    buffer_load_dwordx4 v23, s[28:31], s26 offen lds
    s_add_u32 m0, s62, 1024
    s_nop 0
    buffer_load_dwordx4 v24, s[28:31], s26 offen lds
    s_waitcnt vmcnt(13)
    ds_read_b64_tr_b16 a[64:65], v35 offset:3072
    ds_read_b64_tr_b16 a[66:67], v35 offset:4608
    ds_read_b64_tr_b16 a[144:145], v35 offset:3104
    ds_read_b64_tr_b16 a[146:147], v35 offset:4640
    ds_read_b64_tr_b16 a[224:225], v35 offset:3136
    ds_read_b64_tr_b16 a[226:227], v35 offset:4672
    s_waitcnt lgkmcnt(0)
    s_add_u32 s26, s26, 393216
    s_add_u32 m0, s62, 2048
    s_nop 0
    buffer_load_dwordx4 v23, s[28:31], s26 offen lds
    s_add_u32 m0, s62, 3072
    s_nop 0
    buffer_load_dwordx4 v24, s[28:31], s26 offen lds
    s_add_u32 s26, s26, 393216
    s_add_u32 m0, s62, 4096
    s_nop 0
    buffer_load_dwordx4 v23, s[28:31], s26 offen lds
    s_add_u32 m0, s62, 5120
    s_nop 0
    buffer_load_dwordx4 v24, s[28:31], s26 offen lds
    s_waitcnt vmcnt(14)
    ds_read_b64_tr_b16 a[68:69], v35 offset:6144
    ds_read_b64_tr_b16 a[70:71], v35 offset:7680
    ds_read_b64_tr_b16 a[148:149], v35 offset:6176
    ds_read_b64_tr_b16 a[150:151], v35 offset:7712
    ds_read_b64_tr_b16 a[228:229], v35 offset:6208
    ds_read_b64_tr_b16 a[230:231], v35 offset:7744
    s_waitcnt lgkmcnt(0)
    s_add_u32 s26, s26, 393216
    s_add_u32 m0, s62, 6144
    s_nop 0
    buffer_load_dwordx4 v23, s[28:31], s26 offen lds
    s_add_u32 m0, s62, 7168
    s_nop 0
    buffer_load_dwordx4 v24, s[28:31], s26 offen lds
    s_waitcnt vmcnt(13)
    ds_read_b64_tr_b16 a[72:73], v35 offset:9216
    ds_read_b64_tr_b16 a[74:75], v35 offset:10752
    ds_read_b64_tr_b16 a[152:153], v35 offset:9248
    ds_read_b64_tr_b16 a[154:155], v35 offset:10784
    ds_read_b64_tr_b16 a[232:233], v35 offset:9280
    ds_read_b64_tr_b16 a[234:235], v35 offset:10816
    s_waitcnt lgkmcnt(0)
    s_add_u32 s26, s26, 393216
    s_add_u32 m0, s62, 8192
    s_nop 0
    buffer_load_dwordx4 v23, s[28:31], s26 offen lds
    s_add_u32 m0, s62, 9216
    s_nop 0
    buffer_load_dwordx4 v24, s[28:31], s26 offen lds
    s_add_u32 s26, s26, 393216
    s_add_u32 m0, s62, 10240
    s_nop 0
    buffer_load_dwordx4 v23, s[28:31], s26 offen lds
    s_add_u32 m0, s62, 11264
    s_nop 0
    buffer_load_dwordx4 v24, s[28:31], s26 offen lds
    s_waitcnt vmcnt(14)
    ds_read_b64_tr_b16 a[76:77], v35 offset:12288
    ds_read_b64_tr_b16 a[78:79], v35 offset:13824
    ds_read_b64_tr_b16 a[156:157], v35 offset:12320
    ds_read_b64_tr_b16 a[158:159], v35 offset:13856
    ds_read_b64_tr_b16 a[236:237], v35 offset:12352
    ds_read_b64_tr_b16 a[238:239], v35 offset:13888
    s_waitcnt lgkmcnt(0)
    s_add_u32 s26, s26, 393216
    s_add_u32 m0, s62, 12288
    s_nop 0
    buffer_load_dwordx4 v23, s[28:31], s26 offen lds
    s_add_u32 m0, s62, 13312
    s_nop 0
    buffer_load_dwordx4 v24, s[28:31], s26 offen lds
    s_waitcnt vmcnt(14)
    ds_read_b64_tr_b16 v[96:97], v36 offset:15360
    ds_read_b64_tr_b16 v[98:99], v36 offset:16384
    ds_read_b64_tr_b16 v[176:177], v36 offset:15392
    ds_read_b64_tr_b16 v[178:179], v36 offset:16416
    s_waitcnt lgkmcnt(0)
    s_add_u32 s26, s26, 393216
    s_add_u32 m0, s62, 14336
    s_nop 0
    buffer_load_dwordx4 v23, s[28:31], s26 offen lds
    s_add_u32 m0, s62, 15360
    s_nop 0
    buffer_load_dwordx4 v24, s[28:31], s26 offen lds
    s_waitcnt vmcnt(14)
    ds_read_b64_tr_b16 v[100:101], v36 offset:0
    ds_read_b64_tr_b16 v[102:103], v36 offset:1024
    ds_read_b64_tr_b16 v[180:181], v36 offset:32
    ds_read_b64_tr_b16 v[182:183], v36 offset:1056
    s_waitcnt lgkmcnt(0)
    s_add_u32 s26, s26, 393216
    s_add_u32 m0, s62, 0
    s_nop 0
    buffer_load_dwordx4 v23, s[28:31], s26 offen lds
    s_add_u32 m0, s62, 1024
    s_nop 0
    buffer_load_dwordx4 v24, s[28:31], s26 offen lds
    s_waitcnt vmcnt(14)
    ds_read_b64_tr_b16 v[104:105], v36 offset:2048
    ds_read_b64_tr_b16 v[106:107], v36 offset:3072
    ds_read_b64_tr_b16 v[184:185], v36 offset:2080
    ds_read_b64_tr_b16 v[186:187], v36 offset:3104
    s_waitcnt lgkmcnt(0)
    s_add_u32 s26, s26, 393216
    s_add_u32 m0, s62, 2048
    s_nop 0
    buffer_load_dwordx4 v23, s[28:31], s26 offen lds
    s_add_u32 m0, s62, 3072
    s_nop 0
    buffer_load_dwordx4 v24, s[28:31], s26 offen lds
    s_waitcnt vmcnt(14)
    ds_read_b64_tr_b16 v[108:109], v36 offset:4096
    ds_read_b64_tr_b16 v[110:111], v36 offset:5120
    ds_read_b64_tr_b16 v[188:189], v36 offset:4128
    ds_read_b64_tr_b16 v[190:191], v36 offset:5152
    s_waitcnt lgkmcnt(0)
    s_add_u32 s26, s26, 393216
    s_add_u32 m0, s62, 4096
    s_nop 0
    buffer_load_dwordx4 v23, s[28:31], s26 offen lds
    s_add_u32 m0, s62, 5120
    s_nop 0
    buffer_load_dwordx4 v24, s[28:31], s26 offen lds
    s_waitcnt vmcnt(14)
    ds_read_b64_tr_b16 v[112:113], v36 offset:6144
    ds_read_b64_tr_b16 v[114:115], v36 offset:7168
    ds_read_b64_tr_b16 v[192:193], v36 offset:6176
    ds_read_b64_tr_b16 v[194:195], v36 offset:7200
    s_waitcnt lgkmcnt(0)
    s_add_u32 s26, s26, 393216
    s_add_u32 m0, s62, 6144
    s_nop 0
    buffer_load_dwordx4 v23, s[28:31], s26 offen lds
    s_add_u32 m0, s62, 7168
    s_nop 0
    buffer_load_dwordx4 v24, s[28:31], s26 offen lds
    s_waitcnt vmcnt(14)
    ds_read_b64_tr_b16 v[116:117], v36 offset:8192
    ds_read_b64_tr_b16 v[118:119], v36 offset:9216
    ds_read_b64_tr_b16 v[196:197], v36 offset:8224
    ds_read_b64_tr_b16 v[198:199], v36 offset:9248
    s_waitcnt lgkmcnt(0)
    s_add_u32 s26, s26, 393216
    s_add_u32 m0, s62, 8192
    s_nop 0
    buffer_load_dwordx4 v23, s[28:31], s26 offen lds
    s_add_u32 m0, s62, 9216
    s_nop 0
    buffer_load_dwordx4 v24, s[28:31], s26 offen lds
    s_waitcnt vmcnt(14)
    ds_read_b64_tr_b16 v[120:121], v36 offset:10240
    ds_read_b64_tr_b16 v[122:123], v36 offset:11264
    ds_read_b64_tr_b16 v[200:201], v36 offset:10272
    ds_read_b64_tr_b16 v[202:203], v36 offset:11296
    s_waitcnt lgkmcnt(0)
    s_add_u32 s26, s26, 393216
    s_add_u32 m0, s62, 10240
    s_nop 0
    buffer_load_dwordx4 v23, s[28:31], s26 offen lds
    s_add_u32 m0, s62, 11264
    s_nop 0
    buffer_load_dwordx4 v24, s[28:31], s26 offen lds
    s_waitcnt vmcnt(14)
    ds_read_b64_tr_b16 v[124:125], v36 offset:12288
    ds_read_b64_tr_b16 v[126:127], v36 offset:13312
    ds_read_b64_tr_b16 v[204:205], v36 offset:12320
    ds_read_b64_tr_b16 v[206:207], v36 offset:13344
    s_waitcnt lgkmcnt(0)
    s_add_u32 s26, s26, 393216
    s_add_u32 m0, s62, 12288
    s_nop 0
    buffer_load_dwordx4 v23, s[28:31], s26 offen lds
    s_add_u32 m0, s62, 13312
    s_nop 0
    buffer_load_dwordx4 v24, s[28:31], s26 offen lds
    s_waitcnt vmcnt(14)
    ds_read_b64_tr_b16 v[128:129], v36 offset:14336
    ds_read_b64_tr_b16 v[130:131], v36 offset:15360
    ds_read_b64_tr_b16 v[208:209], v36 offset:14368
    ds_read_b64_tr_b16 v[210:211], v36 offset:15392
    s_waitcnt lgkmcnt(0)
    s_add_u32 s26, s26, 393216
    s_add_u32 m0, s62, 14336
    s_nop 0
    buffer_load_dwordx4 v23, s[28:31], s26 offen lds
    s_add_u32 m0, s62, 15360
    s_nop 0
    buffer_load_dwordx4 v24, s[28:31], s26 offen lds
    s_waitcnt vmcnt(14)
    ds_read_b64_tr_b16 v[132:133], v36 offset:0
    ds_read_b64_tr_b16 v[134:135], v36 offset:1024
    ds_read_b64_tr_b16 v[212:213], v36 offset:32
    ds_read_b64_tr_b16 v[214:215], v36 offset:1056
    s_waitcnt lgkmcnt(0)
    s_add_u32 s26, s26, 393216
    s_add_u32 m0, s62, 0
    s_nop 0
    buffer_load_dwordx4 v23, s[28:31], s26 offen lds
    s_add_u32 m0, s62, 1024
    s_nop 0
    buffer_load_dwordx4 v24, s[28:31], s26 offen lds
    s_waitcnt vmcnt(14)
    ds_read_b64_tr_b16 v[136:137], v36 offset:2048
    ds_read_b64_tr_b16 v[138:139], v36 offset:3072
    ds_read_b64_tr_b16 v[216:217], v36 offset:2080
    ds_read_b64_tr_b16 v[218:219], v36 offset:3104
    s_waitcnt lgkmcnt(0)
    s_add_u32 s26, s26, 393216
    s_add_u32 m0, s62, 2048
    s_nop 0
    buffer_load_dwordx4 v23, s[28:31], s26 offen lds
    s_add_u32 m0, s62, 3072
    s_nop 0
    buffer_load_dwordx4 v24, s[28:31], s26 offen lds
    s_waitcnt vmcnt(14)
    ds_read_b64_tr_b16 v[140:141], v36 offset:4096
    ds_read_b64_tr_b16 v[142:143], v36 offset:5120
    ds_read_b64_tr_b16 v[220:221], v36 offset:4128
    ds_read_b64_tr_b16 v[222:223], v36 offset:5152
    s_waitcnt lgkmcnt(0)
    s_add_u32 s26, s26, 393216
    s_add_u32 m0, s62, 4096
    s_nop 0
    buffer_load_dwordx4 v23, s[28:31], s26 offen lds
    s_add_u32 m0, s62, 5120
    s_nop 0
    buffer_load_dwordx4 v24, s[28:31], s26 offen lds
    s_waitcnt vmcnt(14)
    ds_read_b64_tr_b16 v[144:145], v36 offset:6144
    ds_read_b64_tr_b16 v[146:147], v36 offset:7168
    ds_read_b64_tr_b16 v[224:225], v36 offset:6176
    ds_read_b64_tr_b16 v[226:227], v36 offset:7200
    s_waitcnt lgkmcnt(0)
    s_waitcnt vmcnt(12)
    ds_read_b64_tr_b16 v[148:149], v36 offset:8192
    ds_read_b64_tr_b16 v[150:151], v36 offset:9216
    ds_read_b64_tr_b16 v[228:229], v36 offset:8224
    ds_read_b64_tr_b16 v[230:231], v36 offset:9248
    s_waitcnt lgkmcnt(0)
    s_waitcnt vmcnt(10)
    ds_read_b64_tr_b16 v[152:153], v36 offset:10240
    ds_read_b64_tr_b16 v[154:155], v36 offset:11264
    ds_read_b64_tr_b16 v[232:233], v36 offset:10272
    ds_read_b64_tr_b16 v[234:235], v36 offset:11296
    s_waitcnt lgkmcnt(0)
    s_waitcnt vmcnt(8)
    ds_read_b64_tr_b16 v[156:157], v36 offset:12288
    ds_read_b64_tr_b16 v[158:159], v36 offset:13312
    ds_read_b64_tr_b16 v[236:237], v36 offset:12320
    ds_read_b64_tr_b16 v[238:239], v36 offset:13344
    s_waitcnt lgkmcnt(0)
    s_waitcnt vmcnt(6)
    ds_read_b64_tr_b16 v[160:161], v36 offset:14336
    ds_read_b64_tr_b16 v[162:163], v36 offset:15360
    ds_read_b64_tr_b16 v[240:241], v36 offset:14368
    ds_read_b64_tr_b16 v[242:243], v36 offset:15392
    s_waitcnt lgkmcnt(0)
    s_add_u32 m0, s62, 6144
    s_nop 0
    buffer_load_dwordx4 v25, s[32:35], s27 offen lds
    s_add_u32 m0, s62, 7168
    s_nop 0
    buffer_load_dwordx4 v26, s[32:35], s27 offen lds
    s_add_u32 m0, s62, 8192
    s_nop 0
    buffer_load_dwordx4 v27, s[32:35], s27 offen lds
    s_add_u32 m0, s62, 9216
    s_nop 0
    buffer_load_dwordx4 v28, s[32:35], s27 offen lds
    s_add_u32 m0, s62, 10240
    s_nop 0
    buffer_load_dwordx4 v29, s[32:35], s27 offen lds
    s_add_u32 m0, s62, 11264
    s_nop 0
    buffer_load_dwordx4 v30, s[32:35], s27 offen lds
    s_add_u32 m0, s62, 12288
    s_nop 0
    buffer_load_dwordx4 v31, s[32:35], s27 offen lds
    s_add_u32 m0, s62, 13312
    s_nop 0
    buffer_load_dwordx4 v32, s[32:35], s27 offen lds
    s_add_u32 m0, s62, 14336
    s_nop 0
    buffer_load_dwordx4 v33, s[32:35], s27 offen lds
    s_add_u32 m0, s62, 15360
    s_nop 0
    buffer_load_dwordx4 v34, s[32:35], s27 offen lds
    s_waitcnt vmcnt(14)
    ds_read_b64_tr_b16 v[164:165], v36 offset:0
    ds_read_b64_tr_b16 v[166:167], v36 offset:1024
    ds_read_b64_tr_b16 v[244:245], v36 offset:32
    ds_read_b64_tr_b16 v[246:247], v36 offset:1056
    s_waitcnt lgkmcnt(0)
    s_waitcnt vmcnt(12)
    ds_read_b64_tr_b16 v[168:169], v36 offset:2048
    ds_read_b64_tr_b16 v[170:171], v36 offset:3072
    ds_read_b64_tr_b16 v[248:249], v36 offset:2080
    ds_read_b64_tr_b16 v[250:251], v36 offset:3104
    s_waitcnt lgkmcnt(0)
    s_waitcnt vmcnt(10)
    ds_read_b64_tr_b16 v[172:173], v36 offset:4096
    ds_read_b64_tr_b16 v[174:175], v36 offset:5120
    ds_read_b64_tr_b16 v[252:253], v36 offset:4128
    ds_read_b64_tr_b16 v[254:255], v36 offset:5152
    s_waitcnt lgkmcnt(0)
    s_waitcnt vmcnt(0)
    ds_read_b64_tr_b16 v[40:41], v37 offset:6144
    ds_read_b64_tr_b16 v[42:43], v37 offset:11264
    ds_read_b64_tr_b16 v[44:45], v37 offset:6176
    ds_read_b64_tr_b16 v[46:47], v37 offset:11296
    ds_read_b64_tr_b16 v[48:49], v37 offset:6208
    ds_read_b64_tr_b16 v[50:51], v37 offset:11328
    ds_read_b64_tr_b16 v[52:53], v37 offset:6240
    ds_read_b64_tr_b16 v[54:55], v37 offset:11360
    s_waitcnt lgkmcnt(0)
    ds_write_b128 v2, v[40:43] offset:0
    ds_write_b128 v2, v[44:47] offset:3072
    ds_write_b128 v2, v[48:51] offset:6144
    ds_write_b128 v2, v[52:55] offset:9216
    s_waitcnt lgkmcnt(0)
    ds_read_b64_tr_b16 v[40:41], v37 offset:6272
    ds_read_b64_tr_b16 v[42:43], v37 offset:11392
    ds_read_b64_tr_b16 v[44:45], v37 offset:6304
    ds_read_b64_tr_b16 v[46:47], v37 offset:11424
    ds_read_b64_tr_b16 v[48:49], v37 offset:6336
    ds_read_b64_tr_b16 v[50:51], v37 offset:11456
    ds_read_b64_tr_b16 v[52:53], v37 offset:6368
    ds_read_b64_tr_b16 v[54:55], v37 offset:11488
    s_waitcnt lgkmcnt(0)
    ds_write_b128 v2, v[40:43] offset:12288
    ds_write_b128 v2, v[44:47] offset:15360
    ds_write_b128 v2, v[48:51] offset:18432
    ds_write_b128 v2, v[52:55] offset:21504
    s_waitcnt lgkmcnt(0)
    ds_read_b64_tr_b16 v[40:41], v37 offset:6400
    ds_read_b64_tr_b16 v[42:43], v37 offset:11520
    ds_read_b64_tr_b16 v[44:45], v37 offset:6432
    ds_read_b64_tr_b16 v[46:47], v37 offset:11552
    s_waitcnt lgkmcnt(0)
    ds_write_b128 v2, v[40:43] offset:24576
    ds_write_b128 v2, v[44:47] offset:27648
    s_waitcnt lgkmcnt(0)
    s_add_u32 s27, s27, 40960
    s_add_u32 m0, s62, 0
    s_nop 0
    buffer_load_dwordx4 v25, s[32:35], s27 offen lds
    s_add_u32 m0, s62, 1024
    s_nop 0
    buffer_load_dwordx4 v26, s[32:35], s27 offen lds
    s_add_u32 m0, s62, 2048
    s_nop 0
    buffer_load_dwordx4 v27, s[32:35], s27 offen lds
    s_add_u32 m0, s62, 3072
    s_nop 0
    buffer_load_dwordx4 v28, s[32:35], s27 offen lds
    s_add_u32 m0, s62, 4096
    s_nop 0
    buffer_load_dwordx4 v29, s[32:35], s27 offen lds
    s_add_u32 m0, s62, 5120
    s_nop 0
    buffer_load_dwordx4 v30, s[32:35], s27 offen lds
    s_add_u32 m0, s62, 6144
    s_nop 0
    buffer_load_dwordx4 v31, s[32:35], s27 offen lds
    s_add_u32 m0, s62, 7168
    s_nop 0
    buffer_load_dwordx4 v32, s[32:35], s27 offen lds
    s_add_u32 m0, s62, 8192
    s_nop 0
    buffer_load_dwordx4 v33, s[32:35], s27 offen lds
    s_add_u32 m0, s62, 9216
    s_nop 0
    buffer_load_dwordx4 v34, s[32:35], s27 offen lds
    s_waitcnt vmcnt(0)
    ds_read_b64_tr_b16 v[40:41], v37 offset:0
    ds_read_b64_tr_b16 v[42:43], v37 offset:5120
    ds_read_b64_tr_b16 v[44:45], v37 offset:32
    ds_read_b64_tr_b16 v[46:47], v37 offset:5152
    ds_read_b64_tr_b16 v[48:49], v37 offset:64
    ds_read_b64_tr_b16 v[50:51], v37 offset:5184
    ds_read_b64_tr_b16 v[52:53], v37 offset:96
    ds_read_b64_tr_b16 v[54:55], v37 offset:5216
    s_waitcnt lgkmcnt(0)
    ds_write_b128 v2, v[40:43] offset:1024
    ds_write_b128 v2, v[44:47] offset:4096
    ds_write_b128 v2, v[48:51] offset:7168
    ds_write_b128 v2, v[52:55] offset:10240
    s_waitcnt lgkmcnt(0)
    ds_read_b64_tr_b16 v[40:41], v37 offset:128
    ds_read_b64_tr_b16 v[42:43], v37 offset:5248
    ds_read_b64_tr_b16 v[44:45], v37 offset:160
    ds_read_b64_tr_b16 v[46:47], v37 offset:5280
    ds_read_b64_tr_b16 v[48:49], v37 offset:192
    ds_read_b64_tr_b16 v[50:51], v37 offset:5312
    ds_read_b64_tr_b16 v[52:53], v37 offset:224
    ds_read_b64_tr_b16 v[54:55], v37 offset:5344
    s_waitcnt lgkmcnt(0)
    ds_write_b128 v2, v[40:43] offset:13312
    ds_write_b128 v2, v[44:47] offset:16384
    ds_write_b128 v2, v[48:51] offset:19456
    ds_write_b128 v2, v[52:55] offset:22528
    s_waitcnt lgkmcnt(0)
    ds_read_b64_tr_b16 v[40:41], v37 offset:256
    ds_read_b64_tr_b16 v[42:43], v37 offset:5376
    ds_read_b64_tr_b16 v[44:45], v37 offset:288
    ds_read_b64_tr_b16 v[46:47], v37 offset:5408
    s_waitcnt lgkmcnt(0)
    ds_write_b128 v2, v[40:43] offset:25600
    ds_write_b128 v2, v[44:47] offset:28672
    s_waitcnt lgkmcnt(0)
    s_add_u32 s27, s27, 40960
    s_add_u32 m0, s62, 0
    s_nop 0
    buffer_load_dwordx4 v25, s[32:35], s27 offen lds
    s_add_u32 m0, s62, 1024
    s_nop 0
    buffer_load_dwordx4 v26, s[32:35], s27 offen lds
    s_add_u32 m0, s62, 2048
    s_nop 0
    buffer_load_dwordx4 v27, s[32:35], s27 offen lds
    s_add_u32 m0, s62, 3072
    s_nop 0
    buffer_load_dwordx4 v28, s[32:35], s27 offen lds
    s_add_u32 m0, s62, 4096
    s_nop 0
    buffer_load_dwordx4 v29, s[32:35], s27 offen lds
    s_add_u32 m0, s62, 5120
    s_nop 0
    buffer_load_dwordx4 v30, s[32:35], s27 offen lds
    s_add_u32 m0, s62, 6144
    s_nop 0
    buffer_load_dwordx4 v31, s[32:35], s27 offen lds
    s_add_u32 m0, s62, 7168
    s_nop 0
    buffer_load_dwordx4 v32, s[32:35], s27 offen lds
    s_add_u32 m0, s62, 8192
    s_nop 0
    buffer_load_dwordx4 v33, s[32:35], s27 offen lds
    s_add_u32 m0, s62, 9216
    s_nop 0
    buffer_load_dwordx4 v34, s[32:35], s27 offen lds
    s_waitcnt vmcnt(0)
    ds_read_b64_tr_b16 v[40:41], v37 offset:0
    ds_read_b64_tr_b16 v[42:43], v37 offset:5120
    ds_read_b64_tr_b16 v[44:45], v37 offset:32
    ds_read_b64_tr_b16 v[46:47], v37 offset:5152
    ds_read_b64_tr_b16 v[48:49], v37 offset:64
    ds_read_b64_tr_b16 v[50:51], v37 offset:5184
    ds_read_b64_tr_b16 v[52:53], v37 offset:96
    ds_read_b64_tr_b16 v[54:55], v37 offset:5216
    s_waitcnt lgkmcnt(0)
    ds_write_b128 v2, v[40:43] offset:2048
    ds_write_b128 v2, v[44:47] offset:5120
    ds_write_b128 v2, v[48:51] offset:8192
    ds_write_b128 v2, v[52:55] offset:11264
    s_waitcnt lgkmcnt(0)
    ds_read_b64_tr_b16 v[40:41], v37 offset:128
    ds_read_b64_tr_b16 v[42:43], v37 offset:5248
    ds_read_b64_tr_b16 v[44:45], v37 offset:160
    ds_read_b64_tr_b16 v[46:47], v37 offset:5280
    ds_read_b64_tr_b16 v[48:49], v37 offset:192
    ds_read_b64_tr_b16 v[50:51], v37 offset:5312
    ds_read_b64_tr_b16 v[52:53], v37 offset:224
    ds_read_b64_tr_b16 v[54:55], v37 offset:5344
    s_waitcnt lgkmcnt(0)
    ds_write_b128 v2, v[40:43] offset:14336
    ds_write_b128 v2, v[44:47] offset:17408
    ds_write_b128 v2, v[48:51] offset:20480
    ds_write_b128 v2, v[52:55] offset:23552
    s_waitcnt lgkmcnt(0)
    ds_read_b64_tr_b16 v[40:41], v37 offset:256
    ds_read_b64_tr_b16 v[42:43], v37 offset:5376
    ds_read_b64_tr_b16 v[44:45], v37 offset:288
    ds_read_b64_tr_b16 v[46:47], v37 offset:5408
    s_waitcnt lgkmcnt(0)
    ds_write_b128 v2, v[40:43] offset:26624
    ds_write_b128 v2, v[44:47] offset:29696
    s_waitcnt lgkmcnt(0)
    v_and_b32 v10, 15, v0
    v_lshrrev_b32 v11, 4, v0
    v_and_b32 v12, 7, v0
    v_and_b32 v13, 1, v0
    v_mov_b32 v14, 0x3f80
    v_lshlrev_b32 v13, 4, v13
    v_lshlrev_b32 v14, v13, v14
    v_lshrrev_b32 v12, 1, v12
    v_lshrrev_b32 v13, 2, v10
    v_cmp_eq_u32 s[38:39], v13, v11
    v_bfe_u32 v13, v0, 1, 1
    s_nop 0
    v_cndmask_b32 v17, 0, v14, s[38:39]
    v_cmp_eq_u32 vcc, 0, v12
    s_nop 1
    v_cndmask_b32 v15, 0, v14, vcc
    v_accvgpr_write_b32 a248, v15
    v_cmp_eq_u32 vcc, 0, v13
    s_nop 1
    v_cndmask_b32 v16, 0, v17, vcc
    v_accvgpr_write_b32 a240, v16
    v_accvgpr_write_b32 a244, 0
    v_cmp_eq_u32 vcc, 1, v12
    s_nop 1
    v_cndmask_b32 v15, 0, v14, vcc
    v_accvgpr_write_b32 a249, v15
    v_cmp_eq_u32 vcc, 1, v13
    s_nop 1
    v_cndmask_b32 v16, 0, v17, vcc
    v_accvgpr_write_b32 a241, v16
    v_accvgpr_write_b32 a245, 0
    v_cmp_eq_u32 vcc, 2, v12
    s_nop 1
    v_cndmask_b32 v15, 0, v14, vcc
    v_accvgpr_write_b32 a250, v15
    v_cmp_eq_u32 vcc, 0, v13
    s_nop 1
    v_cndmask_b32 v16, 0, v17, vcc
    v_accvgpr_write_b32 a246, v16
    v_accvgpr_write_b32 a242, 0
    v_cmp_eq_u32 vcc, 3, v12
    s_nop 1
    v_cndmask_b32 v15, 0, v14, vcc
    v_accvgpr_write_b32 a251, v15
    v_cmp_eq_u32 vcc, 1, v13
    s_nop 1
    v_cndmask_b32 v16, 0, v17, vcc
    v_accvgpr_write_b32 a247, v16
    v_accvgpr_write_b32 a243, 0
    v_cmp_gt_u32 s[48:49], 8, v10
    v_cmp_gt_u32 vcc, 2, v11
    s_xnor_b64 s[50:51], vcc, s[48:49]
    s_mul_i32 s60, s15, 640
    s_mov_b32 s61, 20480
    v_add_u32 v12, 640, v0
    v_mul_u32_u24 v13, 52429, v12
    v_lshrrev_b32 v13, 21, v13
    v_mul_u32_u24 v14, 40, v13
    v_sub_u32 v14, v12, v14
    v_mul_lo_u32 v13, v13, s61
    v_lshl_add_u32 v13, v14, 4, v13
    v_add_u32 v3, s60, v13
    v_add_u32 v12, 704, v0
    v_mul_u32_u24 v13, 52429, v12
    v_lshrrev_b32 v13, 21, v13
    v_mul_u32_u24 v14, 40, v13
    v_sub_u32 v14, v12, v14
    v_mul_lo_u32 v13, v13, s61
    v_lshl_add_u32 v13, v14, 4, v13
    v_add_u32 v4, s60, v13
    v_add_u32 v12, 768, v0
    v_mul_u32_u24 v13, 52429, v12
    v_lshrrev_b32 v13, 21, v13
    v_mul_u32_u24 v14, 40, v13
    v_sub_u32 v14, v12, v14
    v_mul_lo_u32 v13, v13, s61
    v_lshl_add_u32 v13, v14, 4, v13
    v_add_u32 v5, s60, v13
    v_add_u32 v12, 832, v0
    v_mul_u32_u24 v13, 52429, v12
    v_lshrrev_b32 v13, 21, v13
    v_mul_u32_u24 v14, 40, v13
    v_sub_u32 v14, v12, v14
    v_mul_lo_u32 v13, v13, s61
    v_lshl_add_u32 v13, v14, 4, v13
    v_add_u32 v6, s60, v13
    v_add_u32 v12, 896, v0
    v_mul_u32_u24 v13, 52429, v12
    v_lshrrev_b32 v13, 21, v13
    v_mul_u32_u24 v14, 40, v13
    v_sub_u32 v14, v12, v14
    v_mul_lo_u32 v13, v13, s61
    v_lshl_add_u32 v13, v14, 4, v13
    v_add_u32 v7, s60, v13
    s_mul_i32 s60, s15, 20480
    s_add_u32 s60, s60, 512
    v_lshrrev_b32 v12, 3, v0
    v_mul_u32_u24 v12, 640, v12
    v_and_b32 v13, 7, v0
    v_lshl_add_u32 v12, v13, 4, v12
    v_add_u32 v8, s60, v12
    s_mul_i32 s60, s15, 40
    s_add_u32 s60, s60, 32
    v_add_u32 v12, s60, v10
    v_lshlrev_b32 v9, 4, v12
    s_mul_i32 s32, s14, 655360
    s_add_u32 s32, s32, 1310720
    s_add_u32 s33, s32, 5120
    s_add_u32 s34, s32, 10240
    s_add_u32 s35, s32, 15360
    s_mov_b32 s52, 1037384597
    s_mov_b32 s53, 1037384597
    s_lshl_b32 s29, s13, 12
    s_add_u32 s29, s29, 917504
    s_xor_b32 s30, s29, 4096
    s_mov_b64 s[46:47], 255
    s_mov_b32 s8, s66
    s_and_b32 s9, s67, 0xffff
    s_mov_b32 s10, 10240
    s_mov_b32 s11, 0x20000
    v_and_b32 v13, 7, v12
    v_mul_u32_u24 v13, 1280, v13
    v_lshrrev_b32 v14, 6, v12
    v_lshl_add_u32 v13, v14, 6, v13
    v_bfe_u32 v14, v12, 4, 2
    v_lshl_add_u32 v13, v14, 3, v13
    v_and_b32 v14, 8, v12
    v_cmp_eq_u32 s[38:39], 0, v14
    v_cmp_ne_u32 s[40:41], 0, v14
    s_cmp_eq_u32 s14, 0
    s_cselect_b32 s10, 10240, 0
    buffer_load_dwordx2 v[16:17], v13, s[8:11], 0 offen
    buffer_load_dwordx2 v[18:19], v13, s[8:11], 0 offen offset:32
    s_waitcnt vmcnt(0)
    v_accvgpr_write_b32 a252, v16
    v_accvgpr_write_b32 a253, v17
    v_accvgpr_write_b32 a254, v18
    v_accvgpr_write_b32 a255, v19
    s_lshl_b32 s3, s18, 2
    s_add_u32 s3, s3, 64
    v_mov_b32 v92, s3
    v_lshlrev_b32 v94, 2, v0
    v_and_b32 v94, 28, v94
    s_mov_b32 s19, 0
L_R2_warr_2:
    global_load_dword v93, v92, s[16:17] sc1
    s_add_u32 s19, s19, 1
    s_cmp_ge_u32 s19, 524288
    s_cbranch_scc1 L_fail
    s_waitcnt vmcnt(0)
    v_cmp_gt_u32 vcc, 256, v93
    s_nop 0
    s_cbranch_vccnz L_R2_warr_2
    s_cmp_lg_u32 s18, 0
    s_cbranch_scc1 L_R2_placed_3
    global_load_dword v93, v94, s[16:17] sc1
    s_waitcnt vmcnt(0)
    v_cmp_ne_u32 vcc, 32, v93
    s_nop 0
    s_cbranch_vccnz L_fallback
L_R2_placed_3:
    v_lshlrev_b32 v0, 4, v0
    s_mov_b32 s20, 0
    s_barrier
    v_or_b32 v16, 1, v16
    s_lshl_b32 s60, s14, 15
    s_add_u32 s60, s60, 1179648
    s_mul_i32 s61, s14, 20480
    s_add_u32 s61, s61, 2621440
    s_mov_b64 exec, s[46:47]
    buffer_store_dwordx4 v[16:19], v9, s[4:7], s60 offen sc1
    buffer_store_dwordx4 v[16:19], v9, s[4:7], s61 offen sc1
    s_mov_b64 exec, -1
    s_waitcnt vmcnt(0)
    s_add_u32 s60, s20, 1
    s_and_b32 s22, s60, 1
    s_lshl_b32 s21, s22, 31
    s_sub_u32 s44, 0, s22
    s_bfe_u32 s23, s20, 0x10001
    s_sub_u32 s23, s23, 1
    s_lshr_b32 s24, s60, 1
    s_andn2_b32 s24, 1, s24
    s_lshl_b32 s61, s14, 15
    s_add_u32 s61, s61, 1179648
    s_and_b32 s25, s20, 1
    s_lshl_b32 s25, s25, 16
    s_add_u32 s25, s25, s61
    s_add_u32 s25, s25, 10240
    s_add_u32 s26, s25, 4096
    s_lshl_b32 s36, s22, 16
    s_add_u32 s36, s36, s61
    s_lshl_b32 s27, s20, 1
    s_add_u32 s37, s27, 2
    s_add_u32 s37, s37, s14
    s_mul_i32 s37, s37, 20480
    s_add_u32 s37, s37, 2621440
    s_add_u32 s27, s27, 1
    s_sub_u32 s27, s27, s14
    s_mul_i32 s27, s27, 20480
    s_add_u32 s27, s27, 2631680
    s_add_u32 s28, s27, 4096
    s_lshl_b32 s31, s20, 6
    s_add_u32 s31, s31, s13
    s_mul_i32 s31, s31, 6144
    s_add_u32 s31, s31, 5898240
    s_min_u32 s56, s20, 63
    s_lshl_b32 s56, s56, 6
    s_add_u32 s56, s56, s13
    s_mul_i32 s56, s56, 12288
    s_add_u32 s56, s56, 37361664
    s_max_u32 s57, s20, 7
    s_sub_u32 s57, s57, 7
    s_lshl_b32 s57, s57, 6
    s_add_u32 s57, s57, s13
    s_mul_i32 s57, s57, 12288
    s_add_u32 s57, s57, 87693312
    s_cmp_lt_u32 s20, 7
    s_cselect_b32 s57, s56, s57
    s_cmp_gt_u32 s60, 63
    s_cselect_b64 s[42:43], s[38:39], 0
    s_cmp_le_u32 s60, 7
    s_cselect_b64 vcc, s[40:41], 0
    s_or_b64 s[42:43], s[42:43], vcc
    s_cmp_lg_u32 s18, 0
    s_cbranch_scc1 L_R2_slow
L_Rf2_top:
    s_barrier
    buffer_load_dwordx4 v[10:13], v0, s[4:7], s25 offen offset:0 sc1
    buffer_load_dwordx4 v[14:17], v0, s[4:7], s25 offen offset:1024 sc1
    buffer_load_dwordx4 v[18:21], v0, s[4:7], s25 offen offset:2048 sc1
    buffer_load_dwordx4 v[22:25], v0, s[4:7], s25 offen offset:3072 sc1
    buffer_load_dwordx4 v[26:29], v0, s[4:7], s26 offen offset:0 sc1
    s_barrier
    buffer_load_dwordx4 v[46:49], v0, s[4:7], s27 offen offset:0 sc1
    buffer_load_dwordx4 v[30:33], v0, s[4:7], s27 offen offset:1024 sc1
    buffer_load_dwordx4 v[34:37], v0, s[4:7], s27 offen offset:2048 sc1
    buffer_load_dwordx4 v[38:41], v0, s[4:7], s27 offen offset:3072 sc1
    buffer_load_dwordx4 v[42:45], v0, s[4:7], s28 offen offset:0 sc1
    s_mov_b32 s19, 0
L_Rf2_gl_1:
    s_waitcnt vmcnt(9)
    v_mfma_f32_16x16x32_bf16 v[50:53], a[240:243], v[10:13], 0
    v_mfma_f32_16x16x32_bf16 v[54:57], a[244:247], v[10:13], 0
    v_xor_b32 v1, s23, v10
    s_waitcnt vmcnt(8)
    v_mfma_f32_16x16x32_bf16 v[58:61], a[240:243], v[14:17], 0
    v_mfma_f32_16x16x32_bf16 v[62:65], a[244:247], v[14:17], 0
    v_bitop3_b32 v1, v1, v14, s23 bitop3:0xf6
    s_waitcnt vmcnt(7)
    v_mfma_f32_16x16x32_bf16 v[66:69], a[240:243], v[18:21], 0
    v_mfma_f32_16x16x32_bf16 v[70:73], a[244:247], v[18:21], 0
    v_bitop3_b32 v1, v1, v18, s23 bitop3:0xf6
    s_waitcnt vmcnt(6)
    v_mfma_f32_16x16x32_bf16 v[74:77], a[240:243], v[22:25], 0
    v_mfma_f32_16x16x32_bf16 v[78:81], a[244:247], v[22:25], 0
    v_bitop3_b32 v1, v1, v22, s23 bitop3:0xf6
    s_waitcnt vmcnt(5)
    v_mfma_f32_16x16x32_bf16 v[82:85], a[240:243], v[26:29], 0
    v_mfma_f32_16x16x32_bf16 v[86:89], a[244:247], v[26:29], 0
    v_bitop3_b32 v1, v1, v26, s23 bitop3:0xf6
    v_and_b32 v1, 1, v1
    v_cmp_ne_u32 vcc, 0, v1
    s_nop 0
    s_cbranch_vccnz L_Rf2_glfix_3
L_Rf2_gr_2:
    s_waitcnt vmcnt(4)
    v_mfma_f32_16x16x32_bf16 v[50:53], a[240:243], v[46:49], v[50:53]
    v_xor_b32 v1, s23, v46
    v_mfma_f32_16x16x32_bf16 v[54:57], a[244:247], v[46:49], v[54:57]
    s_waitcnt vmcnt(3)
    v_mfma_f32_16x16x32_bf16 v[58:61], a[240:243], v[30:33], v[58:61]
    v_bitop3_b32 v1, v1, v30, s23 bitop3:0xf6
    v_mfma_f32_16x16x32_bf16 v[62:65], a[244:247], v[30:33], v[62:65]
    s_nop 1
    v_cvt_pk_bf16_f32 v90, v50, v51
    v_cvt_pk_bf16_f32 v91, v52, v53
    v_cvt_pk_bf16_f32 v92, v54, v55
    v_cvt_pk_bf16_f32 v93, v56, v57
    ds_write_b128 v0, v[90:93] offset:10240
    s_waitcnt vmcnt(2)
    v_mfma_f32_16x16x32_bf16 v[66:69], a[240:243], v[34:37], v[66:69]
    v_bitop3_b32 v1, v1, v34, s23 bitop3:0xf6
    v_mfma_f32_16x16x32_bf16 v[70:73], a[244:247], v[34:37], v[70:73]
    v_cvt_pk_bf16_f32 v90, v58, v59
    v_cvt_pk_bf16_f32 v91, v60, v61
    v_cvt_pk_bf16_f32 v92, v62, v63
    v_cvt_pk_bf16_f32 v93, v64, v65
    ds_write_b128 v0, v[90:93] offset:11264
    s_waitcnt vmcnt(1)
    v_mfma_f32_16x16x32_bf16 v[74:77], a[240:243], v[38:41], v[74:77]
    v_bitop3_b32 v1, v1, v38, s23 bitop3:0xf6
    v_mfma_f32_16x16x32_bf16 v[78:81], a[244:247], v[38:41], v[78:81]
    v_cvt_pk_bf16_f32 v90, v66, v67
    v_cvt_pk_bf16_f32 v91, v68, v69
    v_cvt_pk_bf16_f32 v92, v70, v71
    v_cvt_pk_bf16_f32 v93, v72, v73
    ds_write_b128 v0, v[90:93] offset:12288
    s_waitcnt vmcnt(0)
    v_mfma_f32_16x16x32_bf16 v[82:85], a[240:243], v[42:45], v[82:85]
    v_bitop3_b32 v1, v1, v42, s23 bitop3:0xf6
    v_mfma_f32_16x16x32_bf16 v[86:89], a[244:247], v[42:45], v[86:89]
    v_cvt_pk_bf16_f32 v90, v74, v75
    v_cvt_pk_bf16_f32 v91, v76, v77
    v_cvt_pk_bf16_f32 v92, v78, v79
    v_cvt_pk_bf16_f32 v93, v80, v81
    ds_write_b128 v0, v[90:93] offset:13312
    s_nop 0
    v_cvt_pk_bf16_f32 v90, v82, v83
    v_cvt_pk_bf16_f32 v91, v84, v85
    v_cvt_pk_bf16_f32 v92, v86, v87
    v_cvt_pk_bf16_f32 v93, v88, v89
    ds_write_b128 v0, v[90:93] offset:14336
    v_and_b32 v1, 1, v1
    v_cmp_ne_u32 vcc, 0, v1
    s_nop 0
    s_cbranch_vccnz L_Rf2_grfix_5
    s_waitcnt lgkmcnt(0)
    s_barrier
    ds_read_b128 v[10:13], v0 offset:0
    ds_read_b128 v[14:17], v0 offset:1024
    ds_read_b128 v[18:21], v0 offset:2048
    ds_read_b128 v[22:25], v0 offset:3072
    ds_read_b128 v[26:29], v0 offset:4096
    s_waitcnt lgkmcnt(4)
    v_mfma_f32_16x16x32_bf16 v[46:49], a[0:3], v[10:13], 0
    s_mov_b32 m0, 48128
    v_mfma_f32_16x16x32_bf16 v[50:53], a[80:83], v[10:13], 0
    v_mfma_f32_16x16x32_bf16 v[54:57], a[160:163], v[10:13], 0
    ds_read_b128 v[10:13], v0 offset:5120
    s_waitcnt lgkmcnt(4)
    v_mfma_f32_16x16x32_bf16 v[46:49], a[4:7], v[14:17], v[46:49]
    buffer_load_dwordx4 v0, s[4:7], s57 offen offset:0 sc1 lds
    v_mfma_f32_16x16x32_bf16 v[50:53], a[84:87], v[14:17], v[50:53]
    v_mfma_f32_16x16x32_bf16 v[54:57], a[164:167], v[14:17], v[54:57]
    ds_read_b128 v[14:17], v0 offset:6144
    s_waitcnt lgkmcnt(4)
    v_mfma_f32_16x16x32_bf16 v[46:49], a[8:11], v[18:21], v[46:49]
    buffer_load_dwordx4 v0, s[4:7], s57 offen offset:1024 sc1 lds
    v_mfma_f32_16x16x32_bf16 v[50:53], a[88:91], v[18:21], v[50:53]
    v_mfma_f32_16x16x32_bf16 v[54:57], a[168:171], v[18:21], v[54:57]
    ds_read_b128 v[18:21], v0 offset:7168
    s_waitcnt lgkmcnt(4)
    v_mfma_f32_16x16x32_bf16 v[46:49], a[12:15], v[22:25], v[46:49]
    buffer_load_dwordx4 v0, s[4:7], s57 offen offset:2048 sc1 lds
    v_mfma_f32_16x16x32_bf16 v[50:53], a[92:95], v[22:25], v[50:53]
    v_mfma_f32_16x16x32_bf16 v[54:57], a[172:175], v[22:25], v[54:57]
    ds_read_b128 v[22:25], v0 offset:8192
    s_waitcnt lgkmcnt(4)
    v_mfma_f32_16x16x32_bf16 v[46:49], a[16:19], v[26:29], v[46:49]
    v_mfma_f32_16x16x32_bf16 v[50:53], a[96:99], v[26:29], v[50:53]
    v_mfma_f32_16x16x32_bf16 v[54:57], a[176:179], v[26:29], v[54:57]
    ds_read_b128 v[26:29], v0 offset:9216
    s_waitcnt lgkmcnt(4)
    v_mfma_f32_16x16x32_bf16 v[46:49], a[20:23], v[10:13], v[46:49]
    v_mfma_f32_16x16x32_bf16 v[50:53], a[100:103], v[10:13], v[50:53]
    v_mfma_f32_16x16x32_bf16 v[54:57], a[180:183], v[10:13], v[54:57]
    ds_read_b128 v[10:13], v0 offset:10240
    s_waitcnt lgkmcnt(4)
    v_mfma_f32_16x16x32_bf16 v[46:49], a[24:27], v[14:17], v[46:49]
    v_mfma_f32_16x16x32_bf16 v[50:53], a[104:107], v[14:17], v[50:53]
    v_mfma_f32_16x16x32_bf16 v[54:57], a[184:187], v[14:17], v[54:57]
    ds_read_b128 v[14:17], v0 offset:11264
    s_waitcnt lgkmcnt(4)
    v_mfma_f32_16x16x32_bf16 v[46:49], a[28:31], v[18:21], v[46:49]
    v_mfma_f32_16x16x32_bf16 v[50:53], a[108:111], v[18:21], v[50:53]
    v_mfma_f32_16x16x32_bf16 v[54:57], a[188:191], v[18:21], v[54:57]
    ds_read_b128 v[18:21], v0 offset:12288
    s_waitcnt lgkmcnt(4)
    v_mfma_f32_16x16x32_bf16 v[46:49], a[32:35], v[22:25], v[46:49]
    v_mfma_f32_16x16x32_bf16 v[50:53], a[112:115], v[22:25], v[50:53]
    v_mfma_f32_16x16x32_bf16 v[54:57], a[192:195], v[22:25], v[54:57]
    ds_read_b128 v[22:25], v0 offset:13312
    s_waitcnt lgkmcnt(4)
    v_mfma_f32_16x16x32_bf16 v[46:49], a[36:39], v[26:29], v[46:49]
    v_mfma_f32_16x16x32_bf16 v[50:53], a[116:119], v[26:29], v[50:53]
    v_mfma_f32_16x16x32_bf16 v[54:57], a[196:199], v[26:29], v[54:57]
    ds_read_b128 v[26:29], v0 offset:14336
    s_waitcnt lgkmcnt(4)
    v_mfma_f32_16x16x32_bf16 v[46:49], a[40:43], v[10:13], v[46:49]
    v_mfma_f32_16x16x32_bf16 v[50:53], a[120:123], v[10:13], v[50:53]
    v_mfma_f32_16x16x32_bf16 v[54:57], a[200:203], v[10:13], v[54:57]
    ds_read_b128 v[10:13], v0 offset:15360
    s_waitcnt lgkmcnt(4)
    v_mfma_f32_16x16x32_bf16 v[46:49], a[44:47], v[14:17], v[46:49]
    v_mfma_f32_16x16x32_bf16 v[50:53], a[124:127], v[14:17], v[50:53]
    v_mfma_f32_16x16x32_bf16 v[54:57], a[204:207], v[14:17], v[54:57]
    ds_read_b128 v[14:17], v0 offset:16384
    s_waitcnt lgkmcnt(4)
    v_mfma_f32_16x16x32_bf16 v[46:49], a[48:51], v[18:21], v[46:49]
    v_mfma_f32_16x16x32_bf16 v[50:53], a[128:131], v[18:21], v[50:53]
    v_mfma_f32_16x16x32_bf16 v[54:57], a[208:211], v[18:21], v[54:57]
    ds_read_b128 v[18:21], v0 offset:17408
    s_waitcnt lgkmcnt(4)
    v_mfma_f32_16x16x32_bf16 v[46:49], a[52:55], v[22:25], v[46:49]
    v_mfma_f32_16x16x32_bf16 v[50:53], a[132:135], v[22:25], v[50:53]
    v_mfma_f32_16x16x32_bf16 v[54:57], a[212:215], v[22:25], v[54:57]
    ds_read_b128 v[22:25], v0 offset:18432
    s_waitcnt lgkmcnt(4)
    v_mfma_f32_16x16x32_bf16 v[46:49], a[56:59], v[26:29], v[46:49]
    v_mfma_f32_16x16x32_bf16 v[50:53], a[136:139], v[26:29], v[50:53]
    v_mfma_f32_16x16x32_bf16 v[54:57], a[216:219], v[26:29], v[54:57]
    ds_read_b128 v[26:29], v0 offset:19456
    s_waitcnt lgkmcnt(4)
    v_mfma_f32_16x16x32_bf16 v[46:49], a[60:63], v[10:13], v[46:49]
    v_mfma_f32_16x16x32_bf16 v[50:53], a[140:143], v[10:13], v[50:53]
    v_mfma_f32_16x16x32_bf16 v[54:57], a[220:223], v[10:13], v[54:57]
    ds_read_b128 v[10:13], v0 offset:0
    s_waitcnt lgkmcnt(4)
    v_mfma_f32_16x16x32_bf16 v[46:49], a[64:67], v[14:17], v[46:49]
    v_mfma_f32_16x16x32_bf16 v[50:53], a[144:147], v[14:17], v[50:53]
    v_mfma_f32_16x16x32_bf16 v[54:57], a[224:227], v[14:17], v[54:57]
    ds_read_b128 v[14:17], v0 offset:1024
    s_waitcnt lgkmcnt(4)
    v_mfma_f32_16x16x32_bf16 v[46:49], a[68:71], v[18:21], v[46:49]
    v_mfma_f32_16x16x32_bf16 v[50:53], a[148:151], v[18:21], v[50:53]
    v_mfma_f32_16x16x32_bf16 v[54:57], a[228:231], v[18:21], v[54:57]
    ds_read_b128 v[18:21], v0 offset:2048
    s_waitcnt lgkmcnt(4)
    v_mfma_f32_16x16x32_bf16 v[46:49], a[72:75], v[22:25], v[46:49]
    v_mfma_f32_16x16x32_bf16 v[50:53], a[152:155], v[22:25], v[50:53]
    v_mfma_f32_16x16x32_bf16 v[54:57], a[232:235], v[22:25], v[54:57]
    ds_read_b128 v[22:25], v0 offset:3072
    s_waitcnt lgkmcnt(4)
    v_mfma_f32_16x16x32_bf16 v[46:49], a[76:79], v[26:29], v[46:49]
    v_mfma_f32_16x16x32_bf16 v[50:53], a[156:159], v[26:29], v[50:53]
    v_mfma_f32_16x16x32_bf16 v[54:57], a[236:239], v[26:29], v[54:57]
    ds_read_b128 v[26:29], v0 offset:4096
    s_waitcnt lgkmcnt(4)
    v_mfma_f32_16x16x32_bf16 v[30:33], v[10:13], v[96:99], 0
    v_mfma_f32_16x16x32_bf16 v[34:37], v[10:13], v[176:179], 0
    ds_read_b128 v[10:13], v0 offset:5120
    s_nop 0
    v_cvt_pk_bf16_f32 v82, v46, v47
    v_cvt_pk_bf16_f32 v83, v48, v49
    ds_write_b64 v0, v[82:83] offset:23552
    v_cvt_pk_bf16_f32 v84, v50, v51
    v_cvt_pk_bf16_f32 v85, v52, v53
    ds_write_b64 v0, v[84:85] offset:23560
    v_cvt_pk_bf16_f32 v86, v54, v55
    v_cvt_pk_bf16_f32 v87, v56, v57
    ds_write_b64 v0, v[86:87] offset:24576
    s_waitcnt lgkmcnt(7)
    v_mfma_f32_16x16x32_bf16 v[30:33], v[14:17], v[100:103], v[30:33]
    v_mfma_f32_16x16x32_bf16 v[34:37], v[14:17], v[180:183], v[34:37]
    ds_read_b128 v[14:17], v0 offset:6144
    s_waitcnt lgkmcnt(1)
    s_barrier
    v_mfma_f32_16x16x32_bf16 v[30:33], v[18:21], v[104:107], v[30:33]
    v_mfma_f32_16x16x32_bf16 v[34:37], v[18:21], v[184:187], v[34:37]
    ds_read_b128 v[18:21], v0 offset:7168
    v_mfma_f32_16x16x32_bf16 v[30:33], v[22:25], v[108:111], v[30:33]
    v_mfma_f32_16x16x32_bf16 v[34:37], v[22:25], v[188:191], v[34:37]
    ds_read_b128 v[22:25], v0 offset:8192
    v_mfma_f32_16x16x32_bf16 v[30:33], v[26:29], v[112:115], v[30:33]
    v_mfma_f32_16x16x32_bf16 v[34:37], v[26:29], v[192:195], v[34:37]
    ds_read_b128 v[26:29], v0 offset:9216
    v_mfma_f32_16x16x32_bf16 v[30:33], v[10:13], v[116:119], v[30:33]
    v_mfma_f32_16x16x32_bf16 v[34:37], v[10:13], v[196:199], v[34:37]
    ds_read_b128 v[10:13], v0 offset:10240
    s_waitcnt lgkmcnt(4)
    v_mfma_f32_16x16x32_bf16 v[30:33], v[14:17], v[120:123], v[30:33]
    v_mfma_f32_16x16x32_bf16 v[34:37], v[14:17], v[200:203], v[34:37]
    ds_read_b128 v[14:17], v0 offset:11264
    s_waitcnt lgkmcnt(4)
    v_mfma_f32_16x16x32_bf16 v[30:33], v[18:21], v[124:127], v[30:33]
    v_mfma_f32_16x16x32_bf16 v[34:37], v[18:21], v[204:207], v[34:37]
    ds_read_b128 v[18:21], v0 offset:12288
    s_waitcnt lgkmcnt(4)
    v_mfma_f32_16x16x32_bf16 v[30:33], v[22:25], v[128:131], v[30:33]
    v_mfma_f32_16x16x32_bf16 v[34:37], v[22:25], v[208:211], v[34:37]
    ds_read_b128 v[22:25], v0 offset:13312
    s_waitcnt lgkmcnt(4)
    v_mfma_f32_16x16x32_bf16 v[30:33], v[26:29], v[132:135], v[30:33]
    v_mfma_f32_16x16x32_bf16 v[34:37], v[26:29], v[212:215], v[34:37]
    ds_read_b128 v[26:29], v0 offset:14336
    s_waitcnt lgkmcnt(4)
    v_mfma_f32_16x16x32_bf16 v[30:33], v[10:13], v[136:139], v[30:33]
    v_mfma_f32_16x16x32_bf16 v[34:37], v[10:13], v[216:219], v[34:37]
    ds_read_b128 v[10:13], v0 offset:15360
    s_waitcnt lgkmcnt(4)
    v_mfma_f32_16x16x32_bf16 v[30:33], v[14:17], v[140:143], v[30:33]
    v_mfma_f32_16x16x32_bf16 v[34:37], v[14:17], v[220:223], v[34:37]
    ds_read_b128 v[14:17], v0 offset:16384
    s_waitcnt lgkmcnt(4)
    v_mfma_f32_16x16x32_bf16 v[30:33], v[18:21], v[144:147], v[30:33]
    v_mfma_f32_16x16x32_bf16 v[34:37], v[18:21], v[224:227], v[34:37]
    ds_read_b128 v[18:21], v0 offset:17408
    s_waitcnt lgkmcnt(4)
    v_mfma_f32_16x16x32_bf16 v[30:33], v[22:25], v[148:151], v[30:33]
    v_mfma_f32_16x16x32_bf16 v[34:37], v[22:25], v[228:231], v[34:37]
    ds_read_b128 v[22:25], v0 offset:18432
    s_waitcnt lgkmcnt(4)
    v_mfma_f32_16x16x32_bf16 v[30:33], v[26:29], v[152:155], v[30:33]
    v_mfma_f32_16x16x32_bf16 v[34:37], v[26:29], v[232:235], v[34:37]
    ds_read_b128 v[26:29], v0 offset:19456
    s_waitcnt lgkmcnt(4)
    v_mfma_f32_16x16x32_bf16 v[30:33], v[10:13], v[156:159], v[30:33]
    v_mfma_f32_16x16x32_bf16 v[34:37], v[10:13], v[236:239], v[34:37]
    s_waitcnt lgkmcnt(3)
    v_mfma_f32_16x16x32_bf16 v[30:33], v[14:17], v[160:163], v[30:33]
    v_mfma_f32_16x16x32_bf16 v[34:37], v[14:17], v[240:243], v[34:37]
    s_waitcnt lgkmcnt(2)
    v_mfma_f32_16x16x32_bf16 v[30:33], v[18:21], v[164:167], v[30:33]
    v_mfma_f32_16x16x32_bf16 v[34:37], v[18:21], v[244:247], v[34:37]
    s_waitcnt lgkmcnt(1)
    v_mfma_f32_16x16x32_bf16 v[30:33], v[22:25], v[168:171], v[30:33]
    v_mfma_f32_16x16x32_bf16 v[34:37], v[22:25], v[248:251], v[34:37]
    s_waitcnt lgkmcnt(0)
    v_mfma_f32_16x16x32_bf16 v[30:33], v[26:29], v[172:175], v[30:33]
    v_mfma_f32_16x16x32_bf16 v[34:37], v[26:29], v[252:255], v[34:37]
    s_nop 6
    v_cvt_pk_bf16_f32 v88, v30, v31
    v_cvt_pk_bf16_f32 v89, v32, v33
    v_cvt_pk_bf16_f32 v90, v34, v35
    v_cvt_pk_bf16_f32 v91, v36, v37
    s_add_u32 s60, s31, 5120
    s_cmp_eq_u32 s20, 70
    s_cbranch_scc1 L_Rf2_tail
    s_waitcnt vmcnt(0) lgkmcnt(0)
    s_barrier
    ds_read_b128 v[10:13], v0 offset:26624
    ds_read_b128 v[14:17], v0 offset:27648
    ds_read_b128 v[18:21], v0 offset:28672
    ds_read_b128 v[58:61], v0 offset:39936
    ds_read_b128 v[62:65], v0 offset:40960
    ds_read_b128 v[66:69], v0 offset:52224
    ds_read_b128 v[70:73], v0 offset:53248
    buffer_store_dwordx4 v[88:91], v0, s[4:7], s60 offen sc1
    s_waitcnt lgkmcnt(5)
    v_max3_f32 v22, v10, v11, v12
    v_max3_f32 v23, v13, v14, v15
    v_max3_f32 v22, v22, v16, v17
    s_waitcnt lgkmcnt(4)
    v_max3_f32 v23, v23, v18, v19
    v_max3_f32 v22, v22, v20, v21
    v_max_f32 v22, v22, v23
    v_mov_b32 v23, v22
    ds_read_b128 v[30:33], v2 offset:0
    ds_read_b128 v[34:37], v2 offset:1024
    v_permlane32_swap_b32 v22, v23
    v_max_f32 v22, v22, v23
    v_mov_b32 v23, v22
    ds_read_b128 v[38:41], v2 offset:2048
    ds_read_b128 v[42:45], v2 offset:3072
    v_permlane16_swap_b32 v22, v23
    v_max_f32 v22, v22, v23
    v_pk_add_f32 v[10:11], v[10:11], v[22:23] op_sel_hi:[1,0] neg_lo:[0,1] neg_hi:[0,1]
    v_pk_add_f32 v[12:13], v[12:13], v[22:23] op_sel_hi:[1,0] neg_lo:[0,1] neg_hi:[0,1]
    v_pk_add_f32 v[14:15], v[14:15], v[22:23] op_sel_hi:[1,0] neg_lo:[0,1] neg_hi:[0,1]
    v_pk_add_f32 v[16:17], v[16:17], v[22:23] op_sel_hi:[1,0] neg_lo:[0,1] neg_hi:[0,1]
    v_pk_add_f32 v[18:19], v[18:19], v[22:23] op_sel_hi:[1,0] neg_lo:[0,1] neg_hi:[0,1]
    v_pk_add_f32 v[20:21], v[20:21], v[22:23] op_sel_hi:[1,0] neg_lo:[0,1] neg_hi:[0,1]
    v_exp_f32 v10, v10
    v_exp_f32 v11, v11
    v_exp_f32 v12, v12
    v_exp_f32 v13, v13
    v_exp_f32 v14, v14
    v_exp_f32 v15, v15
    v_cvt_pk_bf16_f32 v24, v10, v11
    v_cvt_pk_bf16_f32 v25, v12, v13
    v_exp_f32 v16, v16
    v_exp_f32 v17, v17
    v_mfma_f32_16x16x16_bf16 v[46:49], v[88:89], v[24:25], 0
    v_mfma_f32_16x16x16_bf16 v[82:85], v[90:91], v[24:25], 0
    v_exp_f32 v18, v18
    v_exp_f32 v19, v19
    v_exp_f32 v20, v20
    v_exp_f32 v21, v21
    v_cvt_pk_bf16_f32 v26, v14, v15
    v_cvt_pk_bf16_f32 v27, v16, v17
    v_cvt_pk_bf16_f32 v28, v18, v19
    v_cvt_pk_bf16_f32 v29, v20, v21
    v_pk_add_f32 v[22:23], v[10:11], v[12:13]
    v_pk_add_f32 v[14:15], v[14:15], v[16:17]
    s_waitcnt lgkmcnt(4)
    v_mfma_f32_16x16x32_bf16 v[50:53], v[58:61], v[26:29], v[46:49]
    v_pk_add_f32 v[18:19], v[18:19], v[20:21]
    v_mfma_f32_16x16x32_bf16 v[54:57], v[66:69], v[26:29], v[46:49]
    v_pk_add_f32 v[22:23], v[22:23], v[14:15]
    v_pk_add_f32 v[22:23], v[22:23], v[18:19]
    v_mfma_f32_16x16x32_bf16 v[10:13], v[62:65], v[26:29], v[82:85]
    v_add_f32 v22, v22, v23
    v_mfma_f32_16x16x32_bf16 v[14:17], v[70:73], v[26:29], v[82:85]
    v_mov_b32 v23, v22
    ds_read_b128 v[74:77], v2 offset:4096
    ds_read_b128 v[78:81], v2 offset:5120
    v_permlane32_swap_b32 v22, v23
    v_add_f32 v22, v22, v23
    v_mov_b32 v23, v22
    v_cndmask_b32 v50, v54, v50, s[48:49]
    v_cndmask_b32 v51, v55, v51, s[48:49]
    v_permlane16_swap_b32 v22, v23
    v_add_f32 v22, v22, v23
    v_rcp_f32 v22, v22
    v_cndmask_b32 v52, v56, v52, s[48:49]
    v_cndmask_b32 v53, v57, v53, s[48:49]
    v_cndmask_b32 v10, v14, v10, s[48:49]
    v_cndmask_b32 v11, v15, v11, s[48:49]
    v_cndmask_b32 v12, v16, v12, s[48:49]
    v_cndmask_b32 v13, v17, v13, s[48:49]
    v_pk_mul_f32 v[50:51], v[50:51], v[22:23] op_sel_hi:[1,0]
    v_pk_mul_f32 v[52:53], v[52:53], v[22:23] op_sel_hi:[1,0]
    v_cvt_pk_bf16_f32 v24, v50, v51
    v_cvt_pk_bf16_f32 v25, v52, v53
    v_pk_mul_f32 v[10:11], v[10:11], v[22:23] op_sel_hi:[1,0]
    v_pk_mul_f32 v[12:13], v[12:13], v[22:23] op_sel_hi:[1,0]
    v_cvt_pk_bf16_f32 v26, v10, v11
    v_cvt_pk_bf16_f32 v27, v12, v13
    ds_write_b128 v0, v[24:27] offset:2048
    s_waitcnt lgkmcnt(0)
    s_barrier
    ds_read_b128 v[10:13], v0 offset:0
    ds_read_b128 v[14:17], v0 offset:1024
    ds_read_b128 v[18:21], v0 offset:2048
    s_add_u32 s20, s20, 1
    s_waitcnt lgkmcnt(2)
    v_mfma_f32_16x16x32_bf16 v[46:49], v[30:33], v[10:13], 0
    ds_read_b128 v[30:33], v2 offset:6144
    s_waitcnt lgkmcnt(2)
    v_mfma_f32_16x16x32_bf16 v[46:49], v[34:37], v[14:17], v[46:49]
    ds_read_b128 v[34:37], v2 offset:7168
    s_waitcnt lgkmcnt(2)
    v_mfma_f32_16x16x32_bf16 v[46:49], v[38:41], v[18:21], v[46:49]
    ds_read_b128 v[38:41], v2 offset:8192
    v_mfma_f32_16x16x32_bf16 v[50:53], v[42:45], v[10:13], 0
    ds_read_b128 v[42:45], v2 offset:9216
    v_mfma_f32_16x16x32_bf16 v[50:53], v[74:77], v[14:17], v[50:53]
    ds_read_b128 v[74:77], v2 offset:10240
    v_mfma_f32_16x16x32_bf16 v[50:53], v[78:81], v[18:21], v[50:53]
    ds_read_b128 v[78:81], v2 offset:11264
    s_waitcnt lgkmcnt(3)
    v_mfma_f32_16x16x32_bf16 v[54:57], v[30:33], v[10:13], 0
    ds_read_b128 v[30:33], v2 offset:12288
    v_cvt_pk_bf16_f32 v62, v46, v47
    v_mfma_f32_16x16x32_bf16 v[54:57], v[34:37], v[14:17], v[54:57]
    ds_read_b128 v[34:37], v2 offset:13312
    v_cvt_pk_bf16_f32 v63, v48, v49
    v_and_or_b32 v62, v62, -2, s22
    v_mfma_f32_16x16x32_bf16 v[54:57], v[38:41], v[18:21], v[54:57]
    ds_read_b128 v[38:41], v2 offset:14336
    v_cvt_pk_bf16_f32 v64, v50, v51
    s_waitcnt lgkmcnt(3)
    v_mfma_f32_16x16x32_bf16 v[58:61], v[42:45], v[10:13], 0
    ds_read_b128 v[42:45], v2 offset:15360
    v_cvt_pk_bf16_f32 v65, v52, v53
    v_mfma_f32_16x16x32_bf16 v[58:61], v[74:77], v[14:17], v[58:61]
    ds_read_b128 v[74:77], v2 offset:16384
    v_mfma_f32_16x16x32_bf16 v[58:61], v[78:81], v[18:21], v[58:61]
    ds_read_b128 v[78:81], v2 offset:17408
    buffer_store_dwordx4 v[62:65], v3, s[4:7], s32 offen
    s_waitcnt lgkmcnt(3)
    v_mfma_f32_16x16x32_bf16 v[46:49], v[30:33], v[10:13], 0
    ds_read_b128 v[30:33], v2 offset:18432
    v_cvt_pk_bf16_f32 v66, v54, v55
    v_mfma_f32_16x16x32_bf16 v[46:49], v[34:37], v[14:17], v[46:49]
    ds_read_b128 v[34:37], v2 offset:19456
    v_cvt_pk_bf16_f32 v67, v56, v57
    v_and_or_b32 v66, v66, -2, s22
    v_mfma_f32_16x16x32_bf16 v[46:49], v[38:41], v[18:21], v[46:49]
    ds_read_b128 v[38:41], v2 offset:20480
    v_cvt_pk_bf16_f32 v68, v58, v59
    s_waitcnt lgkmcnt(3)
    v_mfma_f32_16x16x32_bf16 v[50:53], v[42:45], v[10:13], 0
    ds_read_b128 v[42:45], v2 offset:21504
    v_cvt_pk_bf16_f32 v69, v60, v61
    v_mfma_f32_16x16x32_bf16 v[50:53], v[74:77], v[14:17], v[50:53]
    ds_read_b128 v[74:77], v2 offset:22528
    v_mfma_f32_16x16x32_bf16 v[50:53], v[78:81], v[18:21], v[50:53]
    ds_read_b128 v[78:81], v2 offset:23552
    buffer_store_dwordx4 v[66:69], v4, s[4:7], s32 offen
    s_waitcnt lgkmcnt(3)
    v_mfma_f32_16x16x32_bf16 v[54:57], v[30:33], v[10:13], 0
    ds_read_b128 v[30:33], v2 offset:24576
    v_cvt_pk_bf16_f32 v62, v46, v47
    v_mfma_f32_16x16x32_bf16 v[54:57], v[34:37], v[14:17], v[54:57]
    ds_read_b128 v[34:37], v2 offset:25600
    v_cvt_pk_bf16_f32 v63, v48, v49
    v_and_or_b32 v62, v62, -2, s22
    v_mfma_f32_16x16x32_bf16 v[54:57], v[38:41], v[18:21], v[54:57]
    ds_read_b128 v[38:41], v2 offset:26624
    v_cvt_pk_bf16_f32 v64, v50, v51
    s_waitcnt lgkmcnt(3)
    v_mfma_f32_16x16x32_bf16 v[58:61], v[42:45], v[10:13], 0
    ds_read_b128 v[42:45], v2 offset:27648
    v_cvt_pk_bf16_f32 v65, v52, v53
    v_mfma_f32_16x16x32_bf16 v[58:61], v[74:77], v[14:17], v[58:61]
    ds_read_b128 v[74:77], v2 offset:28672
    v_mfma_f32_16x16x32_bf16 v[58:61], v[78:81], v[18:21], v[58:61]
    ds_read_b128 v[78:81], v2 offset:29696
    buffer_store_dwordx4 v[62:65], v5, s[4:7], s32 offen
    s_waitcnt lgkmcnt(3)
    v_mfma_f32_16x16x32_bf16 v[46:49], v[30:33], v[10:13], 0
    v_cvt_pk_bf16_f32 v66, v54, v55
    v_mfma_f32_16x16x32_bf16 v[46:49], v[34:37], v[14:17], v[46:49]
    v_cvt_pk_bf16_f32 v67, v56, v57
    v_and_or_b32 v66, v66, -2, s22
    v_mfma_f32_16x16x32_bf16 v[46:49], v[38:41], v[18:21], v[46:49]
    v_cvt_pk_bf16_f32 v68, v58, v59
    s_waitcnt lgkmcnt(0)
    v_mfma_f32_16x16x32_bf16 v[50:53], v[42:45], v[10:13], 0
    v_cvt_pk_bf16_f32 v69, v60, v61
    v_mfma_f32_16x16x32_bf16 v[50:53], v[74:77], v[14:17], v[50:53]
    v_mfma_f32_16x16x32_bf16 v[50:53], v[78:81], v[18:21], v[50:53]
    buffer_store_dwordx4 v[66:69], v6, s[4:7], s32 offen
    s_nop 0
    v_cvt_pk_bf16_f32 v62, v46, v47
    v_cvt_pk_bf16_f32 v63, v48, v49
    v_and_or_b32 v62, v62, -2, s22
    s_nop 2
    v_cvt_pk_bf16_f32 v64, v50, v51
    v_cvt_pk_bf16_f32 v65, v52, v53
    buffer_store_dwordx4 v[62:65], v7, s[4:7], s32 offen
    v_accvgpr_read_b32 v78, a252
    v_accvgpr_read_b32 v79, a253
    v_accvgpr_read_b32 v80, a254
    v_accvgpr_read_b32 v81, a255
    s_mov_b32 s19, 0
    s_waitcnt vmcnt(0)
    buffer_load_dwordx4 v[26:29], v8, s[4:7], s32 offen sc1
    buffer_load_dwordx4 v[30:33], v8, s[4:7], s33 offen sc1
    buffer_load_dwordx4 v[34:37], v8, s[4:7], s34 offen sc1
    buffer_load_dwordx4 v[38:41], v8, s[4:7], s35 offen sc1
L_Rf2_hb_6:
    s_waitcnt vmcnt(3)
    v_mfma_f32_16x16x32_bf16 v[70:73], a[248:251], v[26:29], 0
    v_xor_b32 v1, s44, v26
    s_waitcnt vmcnt(2)
    v_mfma_f32_16x16x32_bf16 v[70:73], a[248:251], v[30:33], v[70:73]
    v_bitop3_b32 v1, v1, v30, s44 bitop3:0xf6
    s_waitcnt vmcnt(1)
    v_mfma_f32_16x16x32_bf16 v[70:73], a[248:251], v[34:37], v[70:73]
    v_bitop3_b32 v1, v1, v34, s44 bitop3:0xf6
    s_waitcnt vmcnt(0)
    v_mfma_f32_16x16x32_bf16 v[70:73], a[248:251], v[38:41], v[70:73]
    v_bitop3_b32 v1, v1, v38, s44 bitop3:0xf6
    v_and_b32 v1, 1, v1
    v_cmp_ne_u32 vcc, 0, v1
    s_nop 0
    s_cbranch_vccnz L_Rf2_hbfix_7
    s_nop 2
    v_add_f32_dpp v70, v70, v70 row_ror:8 row_mask:0xf bank_mask:0xf
    v_add_f32_dpp v71, v71, v71 row_ror:8 row_mask:0xf bank_mask:0xf
    v_add_f32_dpp v72, v72, v72 row_ror:8 row_mask:0xf bank_mask:0xf
    v_add_f32_dpp v73, v73, v73 row_ror:8 row_mask:0xf bank_mask:0xf
    v_cvt_pk_bf16_f32 v74, v70, v71
    v_cvt_pk_bf16_f32 v75, v72, v73
    v_mov_b32 v76, v74
    v_mov_b32 v77, v75
    s_nop 0
    v_permlane16_swap_b32 v74, v76
    v_permlane16_swap_b32 v75, v77
    v_cndmask_b32 v74, v74, v78, s[42:43]
    v_cndmask_b32 v75, v75, v79, s[42:43]
    v_cndmask_b32 v76, v76, v80, s[42:43]
    v_cndmask_b32 v77, v77, v81, s[42:43]
    v_and_or_b32 v74, v74, -2, s24
    s_mov_b64 exec, s[46:47]
    buffer_store_dwordx4 v[74:77], v9, s[4:7], s36 offen
    buffer_store_dwordx4 v[74:77], v9, s[4:7], s37 offen sc1
    s_mov_b64 exec, -1
    s_add_u32 s60, s20, 1
    s_and_b32 s22, s60, 1
    s_lshl_b32 s21, s22, 31
    s_sub_u32 s44, 0, s22
    s_bfe_u32 s23, s20, 0x10001
    s_sub_u32 s23, s23, 1
    s_lshr_b32 s24, s60, 1
    s_andn2_b32 s24, 1, s24
    s_lshl_b32 s61, s14, 15
    s_add_u32 s61, s61, 1179648
    s_and_b32 s25, s20, 1
    s_lshl_b32 s25, s25, 16
    s_add_u32 s25, s25, s61
    s_add_u32 s25, s25, 10240
    s_add_u32 s26, s25, 4096
    s_lshl_b32 s36, s22, 16
    s_add_u32 s36, s36, s61
    s_lshl_b32 s27, s20, 1
    s_add_u32 s37, s27, 2
    s_add_u32 s37, s37, s14
    s_mul_i32 s37, s37, 20480
    s_add_u32 s37, s37, 2621440
    s_add_u32 s27, s27, 1
    s_sub_u32 s27, s27, s14
    s_mul_i32 s27, s27, 20480
    s_add_u32 s27, s27, 2631680
    s_add_u32 s28, s27, 4096
    s_lshl_b32 s31, s20, 6
    s_add_u32 s31, s31, s13
    s_mul_i32 s31, s31, 6144
    s_add_u32 s31, s31, 5898240
    s_min_u32 s56, s20, 63
    s_lshl_b32 s56, s56, 6
    s_add_u32 s56, s56, s13
    s_mul_i32 s56, s56, 12288
    s_add_u32 s56, s56, 37361664
    s_max_u32 s57, s20, 7
    s_sub_u32 s57, s57, 7
    s_lshl_b32 s57, s57, 6
    s_add_u32 s57, s57, s13
    s_mul_i32 s57, s57, 12288
    s_add_u32 s57, s57, 87693312
    s_cmp_lt_u32 s20, 7
    s_cselect_b32 s57, s56, s57
    s_cmp_gt_u32 s60, 63
    s_cselect_b64 s[42:43], s[38:39], 0
    s_cmp_le_u32 s60, 7
    s_cselect_b64 vcc, s[40:41], 0
    s_or_b64 s[42:43], s[42:43], vcc
    s_waitcnt vmcnt(1)
    s_branch L_Rf2_top
L_Rf2_tail:
    s_waitcnt lgkmcnt(0)
    buffer_store_dwordx4 v[88:91], v0, s[4:7], s60 offen sc1
    s_waitcnt vmcnt(0) lgkmcnt(0)
    s_barrier
    v_mov_b32 v22, 71
    s_mov_b64 exec, 1
    s_mov_b64 exec, -1
    s_waitcnt vmcnt(0)
    s_endpgm
L_Rf2_glfix_3:
    buffer_load_dwordx4 v[10:13], v0, s[4:7], s25 offen offset:0 sc1
    buffer_load_dwordx4 v[14:17], v0, s[4:7], s25 offen offset:1024 sc1
    buffer_load_dwordx4 v[18:21], v0, s[4:7], s25 offen offset:2048 sc1
    buffer_load_dwordx4 v[22:25], v0, s[4:7], s25 offen offset:3072 sc1
    buffer_load_dwordx4 v[26:29], v0, s[4:7], s26 offen offset:0 sc1
    buffer_load_dwordx4 v[46:49], v0, s[4:7], s27 offen offset:0 sc1
    buffer_load_dwordx4 v[30:33], v0, s[4:7], s27 offen offset:1024 sc1
    buffer_load_dwordx4 v[34:37], v0, s[4:7], s27 offen offset:2048 sc1
    buffer_load_dwordx4 v[38:41], v0, s[4:7], s27 offen offset:3072 sc1
    buffer_load_dwordx4 v[42:45], v0, s[4:7], s28 offen offset:0 sc1
    s_add_u32 s19, s19, 1
    s_cmp_lt_u32 s19, 524288
    s_cbranch_scc1 L_Rf2_gl_1
    s_branch L_fail
L_Rf2_grfix_5:
    buffer_load_dwordx4 v[46:49], v0, s[4:7], s27 offen offset:0 sc1
    buffer_load_dwordx4 v[30:33], v0, s[4:7], s27 offen offset:1024 sc1
    buffer_load_dwordx4 v[34:37], v0, s[4:7], s27 offen offset:2048 sc1
    buffer_load_dwordx4 v[38:41], v0, s[4:7], s27 offen offset:3072 sc1
    buffer_load_dwordx4 v[42:45], v0, s[4:7], s28 offen offset:0 sc1
    s_add_u32 s19, s19, 1
    s_cmp_lt_u32 s19, 524288
    s_cbranch_scc1 L_Rf2_gr2_4
    s_branch L_fail
L_Rf2_gr2_4:
    v_mfma_f32_16x16x32_bf16 v[50:53], a[240:243], v[10:13], 0
    v_mfma_f32_16x16x32_bf16 v[54:57], a[244:247], v[10:13], 0
    v_mfma_f32_16x16x32_bf16 v[58:61], a[240:243], v[14:17], 0
    v_mfma_f32_16x16x32_bf16 v[62:65], a[244:247], v[14:17], 0
    v_mfma_f32_16x16x32_bf16 v[66:69], a[240:243], v[18:21], 0
    v_mfma_f32_16x16x32_bf16 v[70:73], a[244:247], v[18:21], 0
    v_mfma_f32_16x16x32_bf16 v[74:77], a[240:243], v[22:25], 0
    v_mfma_f32_16x16x32_bf16 v[78:81], a[244:247], v[22:25], 0
    v_mfma_f32_16x16x32_bf16 v[82:85], a[240:243], v[26:29], 0
    v_mfma_f32_16x16x32_bf16 v[86:89], a[244:247], v[26:29], 0
    s_branch L_Rf2_gr_2
L_Rf2_hbfix_7:
    buffer_load_dwordx4 v[26:29], v8, s[4:7], s32 offen sc1
    buffer_load_dwordx4 v[30:33], v8, s[4:7], s33 offen sc1
    buffer_load_dwordx4 v[34:37], v8, s[4:7], s34 offen sc1
    buffer_load_dwordx4 v[38:41], v8, s[4:7], s35 offen sc1
    s_add_u32 s19, s19, 1
    s_cmp_lt_u32 s19, 524288
    s_cbranch_scc1 L_Rf2_hb_6
    s_branch L_fail
L_R2_slow:
L_Rs2_top:
    s_barrier
    buffer_load_dwordx4 v[10:13], v0, s[4:7], s25 offen offset:0 sc1
    buffer_load_dwordx4 v[14:17], v0, s[4:7], s25 offen offset:1024 sc1
    buffer_load_dwordx4 v[18:21], v0, s[4:7], s25 offen offset:2048 sc1
    buffer_load_dwordx4 v[22:25], v0, s[4:7], s25 offen offset:3072 sc1
    buffer_load_dwordx4 v[26:29], v0, s[4:7], s26 offen offset:0 sc1
    s_barrier
    buffer_load_dwordx4 v[46:49], v0, s[4:7], s27 offen offset:0 sc1
    buffer_load_dwordx4 v[30:33], v0, s[4:7], s27 offen offset:1024 sc1
    buffer_load_dwordx4 v[34:37], v0, s[4:7], s27 offen offset:2048 sc1
    buffer_load_dwordx4 v[38:41], v0, s[4:7], s27 offen offset:3072 sc1
    buffer_load_dwordx4 v[42:45], v0, s[4:7], s28 offen offset:0 sc1
    s_mov_b32 s19, 0
L_Rs2_gl_1:
    s_waitcnt vmcnt(9)
    v_mfma_f32_16x16x32_bf16 v[50:53], a[240:243], v[10:13], 0
    v_mfma_f32_16x16x32_bf16 v[54:57], a[244:247], v[10:13], 0
    v_xor_b32 v1, s23, v10
    s_waitcnt vmcnt(8)
    v_mfma_f32_16x16x32_bf16 v[58:61], a[240:243], v[14:17], 0
    v_mfma_f32_16x16x32_bf16 v[62:65], a[244:247], v[14:17], 0
    v_bitop3_b32 v1, v1, v14, s23 bitop3:0xf6
    s_waitcnt vmcnt(7)
    v_mfma_f32_16x16x32_bf16 v[66:69], a[240:243], v[18:21], 0
    v_mfma_f32_16x16x32_bf16 v[70:73], a[244:247], v[18:21], 0
    v_bitop3_b32 v1, v1, v18, s23 bitop3:0xf6
    s_waitcnt vmcnt(6)
    v_mfma_f32_16x16x32_bf16 v[74:77], a[240:243], v[22:25], 0
    v_mfma_f32_16x16x32_bf16 v[78:81], a[244:247], v[22:25], 0
    v_bitop3_b32 v1, v1, v22, s23 bitop3:0xf6
    s_waitcnt vmcnt(5)
    v_mfma_f32_16x16x32_bf16 v[82:85], a[240:243], v[26:29], 0
    v_mfma_f32_16x16x32_bf16 v[86:89], a[244:247], v[26:29], 0
    v_bitop3_b32 v1, v1, v26, s23 bitop3:0xf6
    v_and_b32 v1, 1, v1
    v_cmp_ne_u32 vcc, 0, v1
    s_nop 0
    s_cbranch_vccnz L_Rs2_glfix_3
L_Rs2_gr_2:
    s_waitcnt vmcnt(4)
    v_mfma_f32_16x16x32_bf16 v[50:53], a[240:243], v[46:49], v[50:53]
    v_xor_b32 v1, s23, v46
    v_mfma_f32_16x16x32_bf16 v[54:57], a[244:247], v[46:49], v[54:57]
    s_waitcnt vmcnt(3)
    v_mfma_f32_16x16x32_bf16 v[58:61], a[240:243], v[30:33], v[58:61]
    v_bitop3_b32 v1, v1, v30, s23 bitop3:0xf6
    v_mfma_f32_16x16x32_bf16 v[62:65], a[244:247], v[30:33], v[62:65]
    s_nop 1
    v_cvt_pk_bf16_f32 v90, v50, v51
    v_cvt_pk_bf16_f32 v91, v52, v53
    v_cvt_pk_bf16_f32 v92, v54, v55
    v_cvt_pk_bf16_f32 v93, v56, v57
    ds_write_b128 v0, v[90:93] offset:10240
    s_waitcnt vmcnt(2)
    v_mfma_f32_16x16x32_bf16 v[66:69], a[240:243], v[34:37], v[66:69]
    v_bitop3_b32 v1, v1, v34, s23 bitop3:0xf6
    v_mfma_f32_16x16x32_bf16 v[70:73], a[244:247], v[34:37], v[70:73]
    v_cvt_pk_bf16_f32 v90, v58, v59
    v_cvt_pk_bf16_f32 v91, v60, v61
    v_cvt_pk_bf16_f32 v92, v62, v63
    v_cvt_pk_bf16_f32 v93, v64, v65
    ds_write_b128 v0, v[90:93] offset:11264
    s_waitcnt vmcnt(1)
    v_mfma_f32_16x16x32_bf16 v[74:77], a[240:243], v[38:41], v[74:77]
    v_bitop3_b32 v1, v1, v38, s23 bitop3:0xf6
    v_mfma_f32_16x16x32_bf16 v[78:81], a[244:247], v[38:41], v[78:81]
    v_cvt_pk_bf16_f32 v90, v66, v67
    v_cvt_pk_bf16_f32 v91, v68, v69
    v_cvt_pk_bf16_f32 v92, v70, v71
    v_cvt_pk_bf16_f32 v93, v72, v73
    ds_write_b128 v0, v[90:93] offset:12288
    s_waitcnt vmcnt(0)
    v_mfma_f32_16x16x32_bf16 v[82:85], a[240:243], v[42:45], v[82:85]
    v_bitop3_b32 v1, v1, v42, s23 bitop3:0xf6
    v_mfma_f32_16x16x32_bf16 v[86:89], a[244:247], v[42:45], v[86:89]
    v_cvt_pk_bf16_f32 v90, v74, v75
    v_cvt_pk_bf16_f32 v91, v76, v77
    v_cvt_pk_bf16_f32 v92, v78, v79
    v_cvt_pk_bf16_f32 v93, v80, v81
    ds_write_b128 v0, v[90:93] offset:13312
    s_nop 0
    v_cvt_pk_bf16_f32 v90, v82, v83
    v_cvt_pk_bf16_f32 v91, v84, v85
    v_cvt_pk_bf16_f32 v92, v86, v87
    v_cvt_pk_bf16_f32 v93, v88, v89
    ds_write_b128 v0, v[90:93] offset:14336
    v_and_b32 v1, 1, v1
    v_cmp_ne_u32 vcc, 0, v1
    s_nop 0
    s_cbranch_vccnz L_Rs2_grfix_5
    s_waitcnt lgkmcnt(0)
    s_barrier
    ds_read_b128 v[10:13], v0 offset:0
    ds_read_b128 v[14:17], v0 offset:1024
    ds_read_b128 v[18:21], v0 offset:2048
    ds_read_b128 v[22:25], v0 offset:3072
    ds_read_b128 v[26:29], v0 offset:4096
    s_waitcnt lgkmcnt(4)
    v_mfma_f32_16x16x32_bf16 v[46:49], a[0:3], v[10:13], 0
    s_mov_b32 m0, 48128
    v_mfma_f32_16x16x32_bf16 v[50:53], a[80:83], v[10:13], 0
    v_mfma_f32_16x16x32_bf16 v[54:57], a[160:163], v[10:13], 0
    ds_read_b128 v[10:13], v0 offset:5120
    s_waitcnt lgkmcnt(4)
    v_mfma_f32_16x16x32_bf16 v[46:49], a[4:7], v[14:17], v[46:49]
    buffer_load_dwordx4 v0, s[4:7], s57 offen offset:0 sc1 lds
    v_mfma_f32_16x16x32_bf16 v[50:53], a[84:87], v[14:17], v[50:53]
    v_mfma_f32_16x16x32_bf16 v[54:57], a[164:167], v[14:17], v[54:57]
    ds_read_b128 v[14:17], v0 offset:6144
    s_waitcnt lgkmcnt(4)
    v_mfma_f32_16x16x32_bf16 v[46:49], a[8:11], v[18:21], v[46:49]
    buffer_load_dwordx4 v0, s[4:7], s57 offen offset:1024 sc1 lds
    v_mfma_f32_16x16x32_bf16 v[50:53], a[88:91], v[18:21], v[50:53]
    v_mfma_f32_16x16x32_bf16 v[54:57], a[168:171], v[18:21], v[54:57]
    ds_read_b128 v[18:21], v0 offset:7168
    s_waitcnt lgkmcnt(4)
    v_mfma_f32_16x16x32_bf16 v[46:49], a[12:15], v[22:25], v[46:49]
    buffer_load_dwordx4 v0, s[4:7], s57 offen offset:2048 sc1 lds
    v_mfma_f32_16x16x32_bf16 v[50:53], a[92:95], v[22:25], v[50:53]
    v_mfma_f32_16x16x32_bf16 v[54:57], a[172:175], v[22:25], v[54:57]
    ds_read_b128 v[22:25], v0 offset:8192
    s_waitcnt lgkmcnt(4)
    v_mfma_f32_16x16x32_bf16 v[46:49], a[16:19], v[26:29], v[46:49]
    v_mfma_f32_16x16x32_bf16 v[50:53], a[96:99], v[26:29], v[50:53]
    v_mfma_f32_16x16x32_bf16 v[54:57], a[176:179], v[26:29], v[54:57]
    ds_read_b128 v[26:29], v0 offset:9216
    s_waitcnt lgkmcnt(4)
    v_mfma_f32_16x16x32_bf16 v[46:49], a[20:23], v[10:13], v[46:49]
    v_mfma_f32_16x16x32_bf16 v[50:53], a[100:103], v[10:13], v[50:53]
    v_mfma_f32_16x16x32_bf16 v[54:57], a[180:183], v[10:13], v[54:57]
    ds_read_b128 v[10:13], v0 offset:10240
    s_waitcnt lgkmcnt(4)
    v_mfma_f32_16x16x32_bf16 v[46:49], a[24:27], v[14:17], v[46:49]
    v_mfma_f32_16x16x32_bf16 v[50:53], a[104:107], v[14:17], v[50:53]
    v_mfma_f32_16x16x32_bf16 v[54:57], a[184:187], v[14:17], v[54:57]
    ds_read_b128 v[14:17], v0 offset:11264
    s_waitcnt lgkmcnt(4)
    v_mfma_f32_16x16x32_bf16 v[46:49], a[28:31], v[18:21], v[46:49]
    v_mfma_f32_16x16x32_bf16 v[50:53], a[108:111], v[18:21], v[50:53]
    v_mfma_f32_16x16x32_bf16 v[54:57], a[188:191], v[18:21], v[54:57]
    ds_read_b128 v[18:21], v0 offset:12288
    s_waitcnt lgkmcnt(4)
    v_mfma_f32_16x16x32_bf16 v[46:49], a[32:35], v[22:25], v[46:49]
    v_mfma_f32_16x16x32_bf16 v[50:53], a[112:115], v[22:25], v[50:53]
    v_mfma_f32_16x16x32_bf16 v[54:57], a[192:195], v[22:25], v[54:57]
    ds_read_b128 v[22:25], v0 offset:13312
    s_waitcnt lgkmcnt(4)
    v_mfma_f32_16x16x32_bf16 v[46:49], a[36:39], v[26:29], v[46:49]
    v_mfma_f32_16x16x32_bf16 v[50:53], a[116:119], v[26:29], v[50:53]
    v_mfma_f32_16x16x32_bf16 v[54:57], a[196:199], v[26:29], v[54:57]
    ds_read_b128 v[26:29], v0 offset:14336
    s_waitcnt lgkmcnt(4)
    v_mfma_f32_16x16x32_bf16 v[46:49], a[40:43], v[10:13], v[46:49]
    v_mfma_f32_16x16x32_bf16 v[50:53], a[120:123], v[10:13], v[50:53]
    v_mfma_f32_16x16x32_bf16 v[54:57], a[200:203], v[10:13], v[54:57]
    ds_read_b128 v[10:13], v0 offset:15360
    s_waitcnt lgkmcnt(4)
    v_mfma_f32_16x16x32_bf16 v[46:49], a[44:47], v[14:17], v[46:49]
    v_mfma_f32_16x16x32_bf16 v[50:53], a[124:127], v[14:17], v[50:53]
    v_mfma_f32_16x16x32_bf16 v[54:57], a[204:207], v[14:17], v[54:57]
    ds_read_b128 v[14:17], v0 offset:16384
    s_waitcnt lgkmcnt(4)
    v_mfma_f32_16x16x32_bf16 v[46:49], a[48:51], v[18:21], v[46:49]
    v_mfma_f32_16x16x32_bf16 v[50:53], a[128:131], v[18:21], v[50:53]
    v_mfma_f32_16x16x32_bf16 v[54:57], a[208:211], v[18:21], v[54:57]
    ds_read_b128 v[18:21], v0 offset:17408
    s_waitcnt lgkmcnt(4)
    v_mfma_f32_16x16x32_bf16 v[46:49], a[52:55], v[22:25], v[46:49]
    v_mfma_f32_16x16x32_bf16 v[50:53], a[132:135], v[22:25], v[50:53]
    v_mfma_f32_16x16x32_bf16 v[54:57], a[212:215], v[22:25], v[54:57]
    ds_read_b128 v[22:25], v0 offset:18432
    s_waitcnt lgkmcnt(4)
    v_mfma_f32_16x16x32_bf16 v[46:49], a[56:59], v[26:29], v[46:49]
    v_mfma_f32_16x16x32_bf16 v[50:53], a[136:139], v[26:29], v[50:53]
    v_mfma_f32_16x16x32_bf16 v[54:57], a[216:219], v[26:29], v[54:57]
    ds_read_b128 v[26:29], v0 offset:19456
    s_waitcnt lgkmcnt(4)
    v_mfma_f32_16x16x32_bf16 v[46:49], a[60:63], v[10:13], v[46:49]
    v_mfma_f32_16x16x32_bf16 v[50:53], a[140:143], v[10:13], v[50:53]
    v_mfma_f32_16x16x32_bf16 v[54:57], a[220:223], v[10:13], v[54:57]
    ds_read_b128 v[10:13], v0 offset:0
    s_waitcnt lgkmcnt(4)
    v_mfma_f32_16x16x32_bf16 v[46:49], a[64:67], v[14:17], v[46:49]
    v_mfma_f32_16x16x32_bf16 v[50:53], a[144:147], v[14:17], v[50:53]
    v_mfma_f32_16x16x32_bf16 v[54:57], a[224:227], v[14:17], v[54:57]
    ds_read_b128 v[14:17], v0 offset:1024
    s_waitcnt lgkmcnt(4)
    v_mfma_f32_16x16x32_bf16 v[46:49], a[68:71], v[18:21], v[46:49]
    v_mfma_f32_16x16x32_bf16 v[50:53], a[148:151], v[18:21], v[50:53]
    v_mfma_f32_16x16x32_bf16 v[54:57], a[228:231], v[18:21], v[54:57]
    ds_read_b128 v[18:21], v0 offset:2048
    s_waitcnt lgkmcnt(4)
    v_mfma_f32_16x16x32_bf16 v[46:49], a[72:75], v[22:25], v[46:49]
    v_mfma_f32_16x16x32_bf16 v[50:53], a[152:155], v[22:25], v[50:53]
    v_mfma_f32_16x16x32_bf16 v[54:57], a[232:235], v[22:25], v[54:57]
    ds_read_b128 v[22:25], v0 offset:3072
    s_waitcnt lgkmcnt(4)
    v_mfma_f32_16x16x32_bf16 v[46:49], a[76:79], v[26:29], v[46:49]
    v_mfma_f32_16x16x32_bf16 v[50:53], a[156:159], v[26:29], v[50:53]
    v_mfma_f32_16x16x32_bf16 v[54:57], a[236:239], v[26:29], v[54:57]
    ds_read_b128 v[26:29], v0 offset:4096
    s_waitcnt lgkmcnt(4)
    v_mfma_f32_16x16x32_bf16 v[30:33], v[10:13], v[96:99], 0
    v_mfma_f32_16x16x32_bf16 v[34:37], v[10:13], v[176:179], 0
    ds_read_b128 v[10:13], v0 offset:5120
    s_nop 0
    v_cvt_pk_bf16_f32 v82, v46, v47
    v_cvt_pk_bf16_f32 v83, v48, v49
    ds_write_b64 v0, v[82:83] offset:23552
    v_cvt_pk_bf16_f32 v84, v50, v51
    v_cvt_pk_bf16_f32 v85, v52, v53
    ds_write_b64 v0, v[84:85] offset:23560
    v_cvt_pk_bf16_f32 v86, v54, v55
    v_cvt_pk_bf16_f32 v87, v56, v57
    ds_write_b64 v0, v[86:87] offset:24576
    s_waitcnt lgkmcnt(7)
    v_mfma_f32_16x16x32_bf16 v[30:33], v[14:17], v[100:103], v[30:33]
    v_mfma_f32_16x16x32_bf16 v[34:37], v[14:17], v[180:183], v[34:37]
    ds_read_b128 v[14:17], v0 offset:6144
    s_waitcnt lgkmcnt(1)
    s_barrier
    v_mfma_f32_16x16x32_bf16 v[30:33], v[18:21], v[104:107], v[30:33]
    v_mfma_f32_16x16x32_bf16 v[34:37], v[18:21], v[184:187], v[34:37]
    ds_read_b128 v[18:21], v0 offset:7168
    v_mfma_f32_16x16x32_bf16 v[30:33], v[22:25], v[108:111], v[30:33]
    v_mfma_f32_16x16x32_bf16 v[34:37], v[22:25], v[188:191], v[34:37]
    ds_read_b128 v[22:25], v0 offset:8192
    v_mfma_f32_16x16x32_bf16 v[30:33], v[26:29], v[112:115], v[30:33]
    v_mfma_f32_16x16x32_bf16 v[34:37], v[26:29], v[192:195], v[34:37]
    ds_read_b128 v[26:29], v0 offset:9216
    v_mfma_f32_16x16x32_bf16 v[30:33], v[10:13], v[116:119], v[30:33]
    v_mfma_f32_16x16x32_bf16 v[34:37], v[10:13], v[196:199], v[34:37]
    ds_read_b128 v[10:13], v0 offset:10240
    s_waitcnt lgkmcnt(4)
    v_mfma_f32_16x16x32_bf16 v[30:33], v[14:17], v[120:123], v[30:33]
    v_mfma_f32_16x16x32_bf16 v[34:37], v[14:17], v[200:203], v[34:37]
    ds_read_b128 v[14:17], v0 offset:11264
    s_waitcnt lgkmcnt(4)
    v_mfma_f32_16x16x32_bf16 v[30:33], v[18:21], v[124:127], v[30:33]
    v_mfma_f32_16x16x32_bf16 v[34:37], v[18:21], v[204:207], v[34:37]
    ds_read_b128 v[18:21], v0 offset:12288
    s_waitcnt lgkmcnt(4)
    v_mfma_f32_16x16x32_bf16 v[30:33], v[22:25], v[128:131], v[30:33]
    v_mfma_f32_16x16x32_bf16 v[34:37], v[22:25], v[208:211], v[34:37]
    ds_read_b128 v[22:25], v0 offset:13312
    s_waitcnt lgkmcnt(4)
    v_mfma_f32_16x16x32_bf16 v[30:33], v[26:29], v[132:135], v[30:33]
    v_mfma_f32_16x16x32_bf16 v[34:37], v[26:29], v[212:215], v[34:37]
    ds_read_b128 v[26:29], v0 offset:14336
    s_waitcnt lgkmcnt(4)
    v_mfma_f32_16x16x32_bf16 v[30:33], v[10:13], v[136:139], v[30:33]
    v_mfma_f32_16x16x32_bf16 v[34:37], v[10:13], v[216:219], v[34:37]
    ds_read_b128 v[10:13], v0 offset:15360
    s_waitcnt lgkmcnt(4)
    v_mfma_f32_16x16x32_bf16 v[30:33], v[14:17], v[140:143], v[30:33]
    v_mfma_f32_16x16x32_bf16 v[34:37], v[14:17], v[220:223], v[34:37]
    ds_read_b128 v[14:17], v0 offset:16384
    s_waitcnt lgkmcnt(4)
    v_mfma_f32_16x16x32_bf16 v[30:33], v[18:21], v[144:147], v[30:33]
    v_mfma_f32_16x16x32_bf16 v[34:37], v[18:21], v[224:227], v[34:37]
    ds_read_b128 v[18:21], v0 offset:17408
    s_waitcnt lgkmcnt(4)
    v_mfma_f32_16x16x32_bf16 v[30:33], v[22:25], v[148:151], v[30:33]
    v_mfma_f32_16x16x32_bf16 v[34:37], v[22:25], v[228:231], v[34:37]
    ds_read_b128 v[22:25], v0 offset:18432
    s_waitcnt lgkmcnt(4)
    v_mfma_f32_16x16x32_bf16 v[30:33], v[26:29], v[152:155], v[30:33]
    v_mfma_f32_16x16x32_bf16 v[34:37], v[26:29], v[232:235], v[34:37]
    ds_read_b128 v[26:29], v0 offset:19456
    s_waitcnt lgkmcnt(4)
    v_mfma_f32_16x16x32_bf16 v[30:33], v[10:13], v[156:159], v[30:33]
    v_mfma_f32_16x16x32_bf16 v[34:37], v[10:13], v[236:239], v[34:37]
    s_waitcnt lgkmcnt(3)
    v_mfma_f32_16x16x32_bf16 v[30:33], v[14:17], v[160:163], v[30:33]
    v_mfma_f32_16x16x32_bf16 v[34:37], v[14:17], v[240:243], v[34:37]
    s_waitcnt lgkmcnt(2)
    v_mfma_f32_16x16x32_bf16 v[30:33], v[18:21], v[164:167], v[30:33]
    v_mfma_f32_16x16x32_bf16 v[34:37], v[18:21], v[244:247], v[34:37]
    s_waitcnt lgkmcnt(1)
    v_mfma_f32_16x16x32_bf16 v[30:33], v[22:25], v[168:171], v[30:33]
    v_mfma_f32_16x16x32_bf16 v[34:37], v[22:25], v[248:251], v[34:37]
    s_waitcnt lgkmcnt(0)
    v_mfma_f32_16x16x32_bf16 v[30:33], v[26:29], v[172:175], v[30:33]
    v_mfma_f32_16x16x32_bf16 v[34:37], v[26:29], v[252:255], v[34:37]
    s_nop 6
    v_cvt_pk_bf16_f32 v88, v30, v31
    v_cvt_pk_bf16_f32 v89, v32, v33
    v_cvt_pk_bf16_f32 v90, v34, v35
    v_cvt_pk_bf16_f32 v91, v36, v37
    s_add_u32 s60, s31, 5120
    s_cmp_eq_u32 s20, 70
    s_cbranch_scc1 L_Rs2_tail
    s_waitcnt vmcnt(0) lgkmcnt(0)
    s_barrier
    ds_read_b128 v[10:13], v0 offset:26624
    ds_read_b128 v[14:17], v0 offset:27648
    ds_read_b128 v[18:21], v0 offset:28672
    ds_read_b128 v[58:61], v0 offset:39936
    ds_read_b128 v[62:65], v0 offset:40960
    ds_read_b128 v[66:69], v0 offset:52224
    ds_read_b128 v[70:73], v0 offset:53248
    buffer_store_dwordx4 v[88:91], v0, s[4:7], s60 offen sc1
    s_waitcnt lgkmcnt(5)
    v_max3_f32 v22, v10, v11, v12
    v_max3_f32 v23, v13, v14, v15
    v_max3_f32 v22, v22, v16, v17
    s_waitcnt lgkmcnt(4)
    v_max3_f32 v23, v23, v18, v19
    v_max3_f32 v22, v22, v20, v21
    v_max_f32 v22, v22, v23
    v_mov_b32 v23, v22
    ds_read_b128 v[30:33], v2 offset:0
    ds_read_b128 v[34:37], v2 offset:1024
    v_permlane32_swap_b32 v22, v23
    v_max_f32 v22, v22, v23
    v_mov_b32 v23, v22
    ds_read_b128 v[38:41], v2 offset:2048
    ds_read_b128 v[42:45], v2 offset:3072
    v_permlane16_swap_b32 v22, v23
    v_max_f32 v22, v22, v23
    v_pk_add_f32 v[10:11], v[10:11], v[22:23] op_sel_hi:[1,0] neg_lo:[0,1] neg_hi:[0,1]
    v_pk_add_f32 v[12:13], v[12:13], v[22:23] op_sel_hi:[1,0] neg_lo:[0,1] neg_hi:[0,1]
    v_pk_add_f32 v[14:15], v[14:15], v[22:23] op_sel_hi:[1,0] neg_lo:[0,1] neg_hi:[0,1]
    v_pk_add_f32 v[16:17], v[16:17], v[22:23] op_sel_hi:[1,0] neg_lo:[0,1] neg_hi:[0,1]
    v_pk_add_f32 v[18:19], v[18:19], v[22:23] op_sel_hi:[1,0] neg_lo:[0,1] neg_hi:[0,1]
    v_pk_add_f32 v[20:21], v[20:21], v[22:23] op_sel_hi:[1,0] neg_lo:[0,1] neg_hi:[0,1]
    v_exp_f32 v10, v10
    v_exp_f32 v11, v11
    v_exp_f32 v12, v12
    v_exp_f32 v13, v13
    v_exp_f32 v14, v14
    v_exp_f32 v15, v15
    v_cvt_pk_bf16_f32 v24, v10, v11
    v_cvt_pk_bf16_f32 v25, v12, v13
    v_exp_f32 v16, v16
    v_exp_f32 v17, v17
    v_mfma_f32_16x16x16_bf16 v[46:49], v[88:89], v[24:25], 0
    v_mfma_f32_16x16x16_bf16 v[82:85], v[90:91], v[24:25], 0
    v_exp_f32 v18, v18
    v_exp_f32 v19, v19
    v_exp_f32 v20, v20
    v_exp_f32 v21, v21
    v_cvt_pk_bf16_f32 v26, v14, v15
    v_cvt_pk_bf16_f32 v27, v16, v17
    v_cvt_pk_bf16_f32 v28, v18, v19
    v_cvt_pk_bf16_f32 v29, v20, v21
    v_pk_add_f32 v[22:23], v[10:11], v[12:13]
    v_pk_add_f32 v[14:15], v[14:15], v[16:17]
    s_waitcnt lgkmcnt(4)
    v_mfma_f32_16x16x32_bf16 v[50:53], v[58:61], v[26:29], v[46:49]
    v_pk_add_f32 v[18:19], v[18:19], v[20:21]
    v_mfma_f32_16x16x32_bf16 v[54:57], v[66:69], v[26:29], v[46:49]
    v_pk_add_f32 v[22:23], v[22:23], v[14:15]
    v_pk_add_f32 v[22:23], v[22:23], v[18:19]
    v_mfma_f32_16x16x32_bf16 v[10:13], v[62:65], v[26:29], v[82:85]
    v_add_f32 v22, v22, v23
    v_mfma_f32_16x16x32_bf16 v[14:17], v[70:73], v[26:29], v[82:85]
    v_mov_b32 v23, v22
    ds_read_b128 v[74:77], v2 offset:4096
    ds_read_b128 v[78:81], v2 offset:5120
    v_permlane32_swap_b32 v22, v23
    v_add_f32 v22, v22, v23
    v_mov_b32 v23, v22
    v_cndmask_b32 v50, v54, v50, s[48:49]
    v_cndmask_b32 v51, v55, v51, s[48:49]
    v_permlane16_swap_b32 v22, v23
    v_add_f32 v22, v22, v23
    v_rcp_f32 v22, v22
    v_cndmask_b32 v52, v56, v52, s[48:49]
    v_cndmask_b32 v53, v57, v53, s[48:49]
    v_cndmask_b32 v10, v14, v10, s[48:49]
    v_cndmask_b32 v11, v15, v11, s[48:49]
    v_cndmask_b32 v12, v16, v12, s[48:49]
    v_cndmask_b32 v13, v17, v13, s[48:49]
    v_pk_mul_f32 v[50:51], v[50:51], v[22:23] op_sel_hi:[1,0]
    v_pk_mul_f32 v[52:53], v[52:53], v[22:23] op_sel_hi:[1,0]
    v_cvt_pk_bf16_f32 v24, v50, v51
    v_cvt_pk_bf16_f32 v25, v52, v53
    v_pk_mul_f32 v[10:11], v[10:11], v[22:23] op_sel_hi:[1,0]
    v_pk_mul_f32 v[12:13], v[12:13], v[22:23] op_sel_hi:[1,0]
    v_cvt_pk_bf16_f32 v26, v10, v11
    v_cvt_pk_bf16_f32 v27, v12, v13
    ds_write_b128 v0, v[24:27] offset:2048
    s_waitcnt lgkmcnt(0)
    s_barrier
    ds_read_b128 v[10:13], v0 offset:0
    ds_read_b128 v[14:17], v0 offset:1024
    ds_read_b128 v[18:21], v0 offset:2048
    s_add_u32 s20, s20, 1
    s_waitcnt lgkmcnt(2)
    v_mfma_f32_16x16x32_bf16 v[46:49], v[30:33], v[10:13], 0
    ds_read_b128 v[30:33], v2 offset:6144
    s_waitcnt lgkmcnt(2)
    v_mfma_f32_16x16x32_bf16 v[46:49], v[34:37], v[14:17], v[46:49]
    ds_read_b128 v[34:37], v2 offset:7168
    s_waitcnt lgkmcnt(2)
    v_mfma_f32_16x16x32_bf16 v[46:49], v[38:41], v[18:21], v[46:49]
    ds_read_b128 v[38:41], v2 offset:8192
    v_mfma_f32_16x16x32_bf16 v[50:53], v[42:45], v[10:13], 0
    ds_read_b128 v[42:45], v2 offset:9216
    v_mfma_f32_16x16x32_bf16 v[50:53], v[74:77], v[14:17], v[50:53]
    ds_read_b128 v[74:77], v2 offset:10240
    v_mfma_f32_16x16x32_bf16 v[50:53], v[78:81], v[18:21], v[50:53]
    ds_read_b128 v[78:81], v2 offset:11264
    s_waitcnt lgkmcnt(3)
    v_mfma_f32_16x16x32_bf16 v[54:57], v[30:33], v[10:13], 0
    ds_read_b128 v[30:33], v2 offset:12288
    v_cvt_pk_bf16_f32 v62, v46, v47
    v_mfma_f32_16x16x32_bf16 v[54:57], v[34:37], v[14:17], v[54:57]
    ds_read_b128 v[34:37], v2 offset:13312
    v_cvt_pk_bf16_f32 v63, v48, v49
    v_and_or_b32 v62, v62, -2, s22
    v_mfma_f32_16x16x32_bf16 v[54:57], v[38:41], v[18:21], v[54:57]
    ds_read_b128 v[38:41], v2 offset:14336
    v_cvt_pk_bf16_f32 v64, v50, v51
    s_waitcnt lgkmcnt(3)
    v_mfma_f32_16x16x32_bf16 v[58:61], v[42:45], v[10:13], 0
    ds_read_b128 v[42:45], v2 offset:15360
    v_cvt_pk_bf16_f32 v65, v52, v53
    v_mfma_f32_16x16x32_bf16 v[58:61], v[74:77], v[14:17], v[58:61]
    ds_read_b128 v[74:77], v2 offset:16384
    v_mfma_f32_16x16x32_bf16 v[58:61], v[78:81], v[18:21], v[58:61]
    ds_read_b128 v[78:81], v2 offset:17408
    buffer_store_dwordx4 v[62:65], v3, s[4:7], s32 offen sc1
    s_waitcnt lgkmcnt(3)
    v_mfma_f32_16x16x32_bf16 v[46:49], v[30:33], v[10:13], 0
    ds_read_b128 v[30:33], v2 offset:18432
    v_cvt_pk_bf16_f32 v66, v54, v55
    v_mfma_f32_16x16x32_bf16 v[46:49], v[34:37], v[14:17], v[46:49]
    ds_read_b128 v[34:37], v2 offset:19456
    v_cvt_pk_bf16_f32 v67, v56, v57
    v_and_or_b32 v66, v66, -2, s22
    v_mfma_f32_16x16x32_bf16 v[46:49], v[38:41], v[18:21], v[46:49]
    ds_read_b128 v[38:41], v2 offset:20480
    v_cvt_pk_bf16_f32 v68, v58, v59
    s_waitcnt lgkmcnt(3)
    v_mfma_f32_16x16x32_bf16 v[50:53], v[42:45], v[10:13], 0
    ds_read_b128 v[42:45], v2 offset:21504
    v_cvt_pk_bf16_f32 v69, v60, v61
    v_mfma_f32_16x16x32_bf16 v[50:53], v[74:77], v[14:17], v[50:53]
    ds_read_b128 v[74:77], v2 offset:22528
    v_mfma_f32_16x16x32_bf16 v[50:53], v[78:81], v[18:21], v[50:53]
    ds_read_b128 v[78:81], v2 offset:23552
    buffer_store_dwordx4 v[66:69], v4, s[4:7], s32 offen sc1
    s_waitcnt lgkmcnt(3)
    v_mfma_f32_16x16x32_bf16 v[54:57], v[30:33], v[10:13], 0
    ds_read_b128 v[30:33], v2 offset:24576
    v_cvt_pk_bf16_f32 v62, v46, v47
    v_mfma_f32_16x16x32_bf16 v[54:57], v[34:37], v[14:17], v[54:57]
    ds_read_b128 v[34:37], v2 offset:25600
    v_cvt_pk_bf16_f32 v63, v48, v49
    v_and_or_b32 v62, v62, -2, s22
    v_mfma_f32_16x16x32_bf16 v[54:57], v[38:41], v[18:21], v[54:57]
    ds_read_b128 v[38:41], v2 offset:26624
    v_cvt_pk_bf16_f32 v64, v50, v51
    s_waitcnt lgkmcnt(3)
    v_mfma_f32_16x16x32_bf16 v[58:61], v[42:45], v[10:13], 0
    ds_read_b128 v[42:45], v2 offset:27648
    v_cvt_pk_bf16_f32 v65, v52, v53
    v_mfma_f32_16x16x32_bf16 v[58:61], v[74:77], v[14:17], v[58:61]
    ds_read_b128 v[74:77], v2 offset:28672
    v_mfma_f32_16x16x32_bf16 v[58:61], v[78:81], v[18:21], v[58:61]
    ds_read_b128 v[78:81], v2 offset:29696
    buffer_store_dwordx4 v[62:65], v5, s[4:7], s32 offen sc1
    s_waitcnt lgkmcnt(3)
    v_mfma_f32_16x16x32_bf16 v[46:49], v[30:33], v[10:13], 0
    v_cvt_pk_bf16_f32 v66, v54, v55
    v_mfma_f32_16x16x32_bf16 v[46:49], v[34:37], v[14:17], v[46:49]
    v_cvt_pk_bf16_f32 v67, v56, v57
    v_and_or_b32 v66, v66, -2, s22
    v_mfma_f32_16x16x32_bf16 v[46:49], v[38:41], v[18:21], v[46:49]
    v_cvt_pk_bf16_f32 v68, v58, v59
    s_waitcnt lgkmcnt(0)
    v_mfma_f32_16x16x32_bf16 v[50:53], v[42:45], v[10:13], 0
    v_cvt_pk_bf16_f32 v69, v60, v61
    v_mfma_f32_16x16x32_bf16 v[50:53], v[74:77], v[14:17], v[50:53]
    v_mfma_f32_16x16x32_bf16 v[50:53], v[78:81], v[18:21], v[50:53]
    buffer_store_dwordx4 v[66:69], v6, s[4:7], s32 offen sc1
    s_nop 0
    v_cvt_pk_bf16_f32 v62, v46, v47
    v_cvt_pk_bf16_f32 v63, v48, v49
    v_and_or_b32 v62, v62, -2, s22
    s_nop 2
    v_cvt_pk_bf16_f32 v64, v50, v51
    v_cvt_pk_bf16_f32 v65, v52, v53
    buffer_store_dwordx4 v[62:65], v7, s[4:7], s32 offen sc1
    v_accvgpr_read_b32 v78, a252
    v_accvgpr_read_b32 v79, a253
    v_accvgpr_read_b32 v80, a254
    v_accvgpr_read_b32 v81, a255
    s_mov_b32 s19, 0
    s_waitcnt vmcnt(0)
    buffer_load_dwordx4 v[26:29], v8, s[4:7], s32 offen sc1
    buffer_load_dwordx4 v[30:33], v8, s[4:7], s33 offen sc1
    buffer_load_dwordx4 v[34:37], v8, s[4:7], s34 offen sc1
    buffer_load_dwordx4 v[38:41], v8, s[4:7], s35 offen sc1
L_Rs2_hb_6:
    s_waitcnt vmcnt(3)
    v_mfma_f32_16x16x32_bf16 v[70:73], a[248:251], v[26:29], 0
    v_xor_b32 v1, s44, v26
    s_waitcnt vmcnt(2)
    v_mfma_f32_16x16x32_bf16 v[70:73], a[248:251], v[30:33], v[70:73]
    v_bitop3_b32 v1, v1, v30, s44 bitop3:0xf6
    s_waitcnt vmcnt(1)
    v_mfma_f32_16x16x32_bf16 v[70:73], a[248:251], v[34:37], v[70:73]
    v_bitop3_b32 v1, v1, v34, s44 bitop3:0xf6
    s_waitcnt vmcnt(0)
    v_mfma_f32_16x16x32_bf16 v[70:73], a[248:251], v[38:41], v[70:73]
    v_bitop3_b32 v1, v1, v38, s44 bitop3:0xf6
    v_and_b32 v1, 1, v1
    v_cmp_ne_u32 vcc, 0, v1
    s_nop 0
    s_cbranch_vccnz L_Rs2_hbfix_7
    s_nop 2
    v_add_f32_dpp v70, v70, v70 row_ror:8 row_mask:0xf bank_mask:0xf
    v_add_f32_dpp v71, v71, v71 row_ror:8 row_mask:0xf bank_mask:0xf
    v_add_f32_dpp v72, v72, v72 row_ror:8 row_mask:0xf bank_mask:0xf
    v_add_f32_dpp v73, v73, v73 row_ror:8 row_mask:0xf bank_mask:0xf
    v_cvt_pk_bf16_f32 v74, v70, v71
    v_cvt_pk_bf16_f32 v75, v72, v73
    v_mov_b32 v76, v74
    v_mov_b32 v77, v75
    s_nop 0
    v_permlane16_swap_b32 v74, v76
    v_permlane16_swap_b32 v75, v77
    v_cndmask_b32 v74, v74, v78, s[42:43]
    v_cndmask_b32 v75, v75, v79, s[42:43]
    v_cndmask_b32 v76, v76, v80, s[42:43]
    v_cndmask_b32 v77, v77, v81, s[42:43]
    v_and_or_b32 v74, v74, -2, s24
    s_mov_b64 exec, s[46:47]
    buffer_store_dwordx4 v[74:77], v9, s[4:7], s36 offen sc1
    buffer_store_dwordx4 v[74:77], v9, s[4:7], s37 offen sc1
    s_mov_b64 exec, -1
    s_add_u32 s60, s20, 1
    s_and_b32 s22, s60, 1
    s_lshl_b32 s21, s22, 31
    s_sub_u32 s44, 0, s22
    s_bfe_u32 s23, s20, 0x10001
    s_sub_u32 s23, s23, 1
    s_lshr_b32 s24, s60, 1
    s_andn2_b32 s24, 1, s24
    s_lshl_b32 s61, s14, 15
    s_add_u32 s61, s61, 1179648
    s_and_b32 s25, s20, 1
    s_lshl_b32 s25, s25, 16
    s_add_u32 s25, s25, s61
    s_add_u32 s25, s25, 10240
    s_add_u32 s26, s25, 4096
    s_lshl_b32 s36, s22, 16
    s_add_u32 s36, s36, s61
    s_lshl_b32 s27, s20, 1
    s_add_u32 s37, s27, 2
    s_add_u32 s37, s37, s14
    s_mul_i32 s37, s37, 20480
    s_add_u32 s37, s37, 2621440
    s_add_u32 s27, s27, 1
    s_sub_u32 s27, s27, s14
    s_mul_i32 s27, s27, 20480
    s_add_u32 s27, s27, 2631680
    s_add_u32 s28, s27, 4096
    s_lshl_b32 s31, s20, 6
    s_add_u32 s31, s31, s13
    s_mul_i32 s31, s31, 6144
    s_add_u32 s31, s31, 5898240
    s_min_u32 s56, s20, 63
    s_lshl_b32 s56, s56, 6
    s_add_u32 s56, s56, s13
    s_mul_i32 s56, s56, 12288
    s_add_u32 s56, s56, 37361664
    s_max_u32 s57, s20, 7
    s_sub_u32 s57, s57, 7
    s_lshl_b32 s57, s57, 6
    s_add_u32 s57, s57, s13
    s_mul_i32 s57, s57, 12288
    s_add_u32 s57, s57, 87693312
    s_cmp_lt_u32 s20, 7
    s_cselect_b32 s57, s56, s57
    s_cmp_gt_u32 s60, 63
    s_cselect_b64 s[42:43], s[38:39], 0
    s_cmp_le_u32 s60, 7
    s_cselect_b64 vcc, s[40:41], 0
    s_or_b64 s[42:43], s[42:43], vcc
    s_waitcnt vmcnt(1)
    s_branch L_Rs2_top
L_Rs2_tail:
    s_waitcnt lgkmcnt(0)
    buffer_store_dwordx4 v[88:91], v0, s[4:7], s60 offen sc1
    s_waitcnt vmcnt(0) lgkmcnt(0)
    s_barrier
    v_mov_b32 v22, 71
    s_mov_b64 exec, 1
    s_mov_b64 exec, -1
    s_waitcnt vmcnt(0)
    s_endpgm
L_Rs2_glfix_3:
    buffer_load_dwordx4 v[10:13], v0, s[4:7], s25 offen offset:0 sc1
    buffer_load_dwordx4 v[14:17], v0, s[4:7], s25 offen offset:1024 sc1
    buffer_load_dwordx4 v[18:21], v0, s[4:7], s25 offen offset:2048 sc1
    buffer_load_dwordx4 v[22:25], v0, s[4:7], s25 offen offset:3072 sc1
    buffer_load_dwordx4 v[26:29], v0, s[4:7], s26 offen offset:0 sc1
    buffer_load_dwordx4 v[46:49], v0, s[4:7], s27 offen offset:0 sc1
    buffer_load_dwordx4 v[30:33], v0, s[4:7], s27 offen offset:1024 sc1
    buffer_load_dwordx4 v[34:37], v0, s[4:7], s27 offen offset:2048 sc1
    buffer_load_dwordx4 v[38:41], v0, s[4:7], s27 offen offset:3072 sc1
    buffer_load_dwordx4 v[42:45], v0, s[4:7], s28 offen offset:0 sc1
    s_add_u32 s19, s19, 1
    s_cmp_lt_u32 s19, 524288
    s_cbranch_scc1 L_Rs2_gl_1
    s_branch L_fail
L_Rs2_grfix_5:
    buffer_load_dwordx4 v[46:49], v0, s[4:7], s27 offen offset:0 sc1
    buffer_load_dwordx4 v[30:33], v0, s[4:7], s27 offen offset:1024 sc1
    buffer_load_dwordx4 v[34:37], v0, s[4:7], s27 offen offset:2048 sc1
    buffer_load_dwordx4 v[38:41], v0, s[4:7], s27 offen offset:3072 sc1
    buffer_load_dwordx4 v[42:45], v0, s[4:7], s28 offen offset:0 sc1
    s_add_u32 s19, s19, 1
    s_cmp_lt_u32 s19, 524288
    s_cbranch_scc1 L_Rs2_gr2_4
    s_branch L_fail
L_Rs2_gr2_4:
    v_mfma_f32_16x16x32_bf16 v[50:53], a[240:243], v[10:13], 0
    v_mfma_f32_16x16x32_bf16 v[54:57], a[244:247], v[10:13], 0
    v_mfma_f32_16x16x32_bf16 v[58:61], a[240:243], v[14:17], 0
    v_mfma_f32_16x16x32_bf16 v[62:65], a[244:247], v[14:17], 0
    v_mfma_f32_16x16x32_bf16 v[66:69], a[240:243], v[18:21], 0
    v_mfma_f32_16x16x32_bf16 v[70:73], a[244:247], v[18:21], 0
    v_mfma_f32_16x16x32_bf16 v[74:77], a[240:243], v[22:25], 0
    v_mfma_f32_16x16x32_bf16 v[78:81], a[244:247], v[22:25], 0
    v_mfma_f32_16x16x32_bf16 v[82:85], a[240:243], v[26:29], 0
    v_mfma_f32_16x16x32_bf16 v[86:89], a[244:247], v[26:29], 0
    s_branch L_Rs2_gr_2
L_Rs2_hbfix_7:
    buffer_load_dwordx4 v[26:29], v8, s[4:7], s32 offen sc1
    buffer_load_dwordx4 v[30:33], v8, s[4:7], s33 offen sc1
    buffer_load_dwordx4 v[34:37], v8, s[4:7], s34 offen sc1
    buffer_load_dwordx4 v[38:41], v8, s[4:7], s35 offen sc1
    s_add_u32 s19, s19, 1
    s_cmp_lt_u32 s19, 524288
    s_cbranch_scc1 L_Rs2_hb_6
    s_branch L_fail
L_R3_start:
    s_lshr_b32 s14, s13, 5
    s_and_b32 s15, s13, 31
    s_mov_b32 s62, 53760
    v_lshlrev_b32 v10, 4, v0
    v_mov_b32 v12, 0
    v_mov_b32 v13, 0
    v_mov_b32 v14, 0
    v_mov_b32 v15, 0
    v_mov_b32 v16, -1
    v_mov_b32 v17, -1
    v_mov_b32 v18, -1
    v_mov_b32 v19, -1
    s_lshl_b32 s60, s13, 12
    s_add_u32 s60, s60, 920576
    buffer_store_dwordx4 v[12:15], v10, s[4:7], s60 offen sc1
    s_mul_i32 s60, s13, 20480
    s_add_u32 s60, s60, 1326080
    buffer_store_dwordx4 v[12:15], v10, s[4:7], s60 offen sc1
    s_add_u32 s60, s60, 1024
    buffer_store_dwordx4 v[12:15], v10, s[4:7], s60 offen sc1
    s_add_u32 s60, s60, 1024
    buffer_store_dwordx4 v[12:15], v10, s[4:7], s60 offen sc1
    s_add_u32 s60, s60, 1024
    buffer_store_dwordx4 v[12:15], v10, s[4:7], s60 offen sc1
    s_add_u32 s60, s60, 1024
    buffer_store_dwordx4 v[12:15], v10, s[4:7], s60 offen sc1
    s_add_u32 s60, s60, 1024
    s_mul_i32 s61, s15, 640
    v_add_u32 v11, s61, v10
    s_mov_b32 exec_hi, 0xff
    s_lshl_b32 s60, s14, 15
    s_mul_i32 s60, s14, 20480
    s_add_u32 s60, s60, 2744320
    buffer_store_dwordx4 v[16:19], v11, s[4:7], s60 offen sc1
    s_add_u32 s60, s60, 163840
    buffer_store_dwordx4 v[16:19], v11, s[4:7], s60 offen sc1
    s_add_u32 s60, s60, 163840
    buffer_store_dwordx4 v[16:19], v11, s[4:7], s60 offen sc1
    s_add_u32 s60, s60, 163840
    buffer_store_dwordx4 v[16:19], v11, s[4:7], s60 offen sc1
    s_add_u32 s60, s60, 163840
    buffer_store_dwordx4 v[16:19], v11, s[4:7], s60 offen sc1
    s_add_u32 s60, s60, 163840
    buffer_store_dwordx4 v[16:19], v11, s[4:7], s60 offen sc1
    s_add_u32 s60, s60, 163840
    buffer_store_dwordx4 v[16:19], v11, s[4:7], s60 offen sc1
    s_add_u32 s60, s60, 163840
    buffer_store_dwordx4 v[16:19], v11, s[4:7], s60 offen sc1
    s_add_u32 s60, s60, 163840
    buffer_store_dwordx4 v[16:19], v11, s[4:7], s60 offen sc1
    s_add_u32 s60, s60, 163840
    buffer_store_dwordx4 v[16:19], v11, s[4:7], s60 offen sc1
    s_add_u32 s60, s60, 163840
    buffer_store_dwordx4 v[16:19], v11, s[4:7], s60 offen sc1
    s_add_u32 s60, s60, 163840
    buffer_store_dwordx4 v[16:19], v11, s[4:7], s60 offen sc1
    s_add_u32 s60, s60, 163840
    buffer_store_dwordx4 v[16:19], v11, s[4:7], s60 offen sc1
    s_add_u32 s60, s60, 163840
    buffer_store_dwordx4 v[16:19], v11, s[4:7], s60 offen sc1
    s_add_u32 s60, s60, 163840
    buffer_store_dwordx4 v[16:19], v11, s[4:7], s60 offen sc1
    s_add_u32 s60, s60, 163840
    buffer_store_dwordx4 v[16:19], v11, s[4:7], s60 offen sc1
    s_add_u32 s60, s60, 163840
    buffer_store_dwordx4 v[16:19], v11, s[4:7], s60 offen sc1
    s_add_u32 s60, s60, 163840
    s_mov_b64 exec, 1
    s_lshl_b32 s54, s13, 9
    s_lshr_b32 s55, s13, 1
    s_mul_i32 s55, s55, 1536
    s_add_u32 s55, s55, 32768
    s_add_u32 s54, s54, 384
    buffer_store_dword v12, v10, s[4:7], s54 offen sc1
    s_mov_b64 exec, -1
    v_add_u32 v38, 0, v0
    v_mul_u32_u24 v39, 10923, v38
    v_lshrrev_b32 v39, 16, v39
    v_mul_u32_u24 v20, 6, v39
    v_sub_u32 v20, v38, v20
    v_lshrrev_b32 v20, 0, v20
    v_lshlrev_b32 v20, 4, v20
    v_mul_u32_u24 v39, 12288, v39
    v_add_u32 v20, v20, v39
    v_add_u32 v38, 64, v0
    v_mul_u32_u24 v39, 10923, v38
    v_lshrrev_b32 v39, 16, v39
    v_mul_u32_u24 v21, 6, v39
    v_sub_u32 v21, v38, v21
    v_lshrrev_b32 v21, 0, v21
    v_lshlrev_b32 v21, 4, v21
    v_mul_u32_u24 v39, 12288, v39
    v_add_u32 v21, v21, v39
    v_add_u32 v38, 128, v0
    v_mul_u32_u24 v39, 10923, v38
    v_lshrrev_b32 v39, 16, v39
    v_mul_u32_u24 v22, 6, v39
    v_sub_u32 v22, v38, v22
    v_lshrrev_b32 v22, 0, v22
    v_lshlrev_b32 v22, 4, v22
    v_mul_u32_u24 v39, 12288, v39
    v_add_u32 v22, v22, v39
    v_add_u32 v38, 0, v0
    v_mul_u32_u24 v39, 16385, v38
    v_lshrrev_b32 v39, 16, v39
    v_mul_u32_u24 v23, 4, v39
    v_sub_u32 v23, v38, v23
    v_lshrrev_b32 v23, 0, v23
    v_lshlrev_b32 v23, 4, v23
    v_mul_u32_u24 v39, 12288, v39
    v_add_u32 v23, v23, v39
    v_add_u32 v38, 64, v0
    v_mul_u32_u24 v39, 16385, v38
    v_lshrrev_b32 v39, 16, v39
    v_mul_u32_u24 v24, 4, v39
    v_sub_u32 v24, v38, v24
    v_lshrrev_b32 v24, 0, v24
    v_lshlrev_b32 v24, 4, v24
    v_mul_u32_u24 v39, 12288, v39
    v_add_u32 v24, v24, v39
    v_add_u32 v38, 0, v0
    v_mul_u32_u24 v39, 3277, v38
    v_lshrrev_b32 v39, 16, v39
    v_mul_u32_u24 v25, 20, v39
    v_sub_u32 v25, v38, v25
    v_lshrrev_b32 v25, 0, v25
    v_lshlrev_b32 v25, 4, v25
    v_mul_u32_u24 v39, 1280, v39
    v_add_u32 v25, v25, v39
    v_add_u32 v38, 64, v0
    v_mul_u32_u24 v39, 3277, v38
    v_lshrrev_b32 v39, 16, v39
    v_mul_u32_u24 v26, 20, v39
    v_sub_u32 v26, v38, v26
    v_lshrrev_b32 v26, 0, v26
    v_lshlrev_b32 v26, 4, v26
    v_mul_u32_u24 v39, 1280, v39
    v_add_u32 v26, v26, v39
    v_add_u32 v38, 128, v0
    v_mul_u32_u24 v39, 3277, v38
    v_lshrrev_b32 v39, 16, v39
    v_mul_u32_u24 v27, 20, v39
    v_sub_u32 v27, v38, v27
    v_lshrrev_b32 v27, 0, v27
    v_lshlrev_b32 v27, 4, v27
    v_mul_u32_u24 v39, 1280, v39
    v_add_u32 v27, v27, v39
    v_add_u32 v38, 192, v0
    v_mul_u32_u24 v39, 3277, v38
    v_lshrrev_b32 v39, 16, v39
    v_mul_u32_u24 v28, 20, v39
    v_sub_u32 v28, v38, v28
    v_lshrrev_b32 v28, 0, v28
    v_lshlrev_b32 v28, 4, v28
    v_mul_u32_u24 v39, 1280, v39
    v_add_u32 v28, v28, v39
    v_add_u32 v38, 256, v0
    v_mul_u32_u24 v39, 3277, v38
    v_lshrrev_b32 v39, 16, v39
    v_mul_u32_u24 v29, 20, v39
    v_sub_u32 v29, v38, v29
    v_lshrrev_b32 v29, 0, v29
    v_lshlrev_b32 v29, 4, v29
    v_mul_u32_u24 v39, 1280, v39
    v_add_u32 v29, v29, v39
    v_add_u32 v38, 320, v0
    v_mul_u32_u24 v39, 3277, v38
    v_lshrrev_b32 v39, 16, v39
    v_mul_u32_u24 v30, 20, v39
    v_sub_u32 v30, v38, v30
    v_lshrrev_b32 v30, 0, v30
    v_lshlrev_b32 v30, 4, v30
    v_mul_u32_u24 v39, 1280, v39
    v_add_u32 v30, v30, v39
    v_add_u32 v38, 384, v0
    v_mul_u32_u24 v39, 3277, v38
    v_lshrrev_b32 v39, 16, v39
    v_mul_u32_u24 v31, 20, v39
    v_sub_u32 v31, v38, v31
    v_lshrrev_b32 v31, 0, v31
    v_lshlrev_b32 v31, 4, v31
    v_mul_u32_u24 v39, 1280, v39
    v_add_u32 v31, v31, v39
    v_add_u32 v38, 448, v0
    v_mul_u32_u24 v39, 3277, v38
    v_lshrrev_b32 v39, 16, v39
    v_mul_u32_u24 v32, 20, v39
    v_sub_u32 v32, v38, v32
    v_lshrrev_b32 v32, 0, v32
    v_lshlrev_b32 v32, 4, v32
    v_mul_u32_u24 v39, 1280, v39
    v_add_u32 v32, v32, v39
    v_add_u32 v38, 512, v0
    v_mul_u32_u24 v39, 3277, v38
    v_lshrrev_b32 v39, 16, v39
    v_mul_u32_u24 v33, 20, v39
    v_sub_u32 v33, v38, v33
    v_lshrrev_b32 v33, 0, v33
    v_lshlrev_b32 v33, 4, v33
    v_mul_u32_u24 v39, 1280, v39
    v_add_u32 v33, v33, v39
    v_add_u32 v38, 576, v0
    v_mul_u32_u24 v39, 3277, v38
    v_lshrrev_b32 v39, 16, v39
    v_mul_u32_u24 v34, 20, v39
    v_sub_u32 v34, v38, v34
    v_lshrrev_b32 v34, 0, v34
    v_lshlrev_b32 v34, 4, v34
    v_mul_u32_u24 v39, 1280, v39
    v_add_u32 v34, v34, v39
    v_lshrrev_b32 v35, 2, v0
    v_mul_u32_u24 v35, 96, v35
    v_and_b32 v38, 3, v0
    v_lshl_add_u32 v35, v38, 3, v35
    v_add_u32 v35, s62, v35
    v_lshrrev_b32 v36, 2, v0
    v_mul_u32_u24 v36, 64, v36
    v_and_b32 v38, 3, v0
    v_lshl_add_u32 v36, v38, 3, v36
    v_add_u32 v36, s62, v36
    v_lshrrev_b32 v37, 2, v0
    v_mul_u32_u24 v37, 320, v37
    v_and_b32 v38, 3, v0
    v_lshl_add_u32 v37, v38, 3, v37
    v_add_u32 v37, s62, v37
    v_add_u32 v2, 133120, v10
    s_mov_b32 s8, s70
    s_and_b32 s9, s71, 0xffff
    s_mov_b32 s10, 7864320
    s_mov_b32 s11, 0x20000
    s_mov_b32 s28, s72
    s_and_b32 s29, s73, 0xffff
    s_mov_b32 s30, 7864320
    s_mov_b32 s31, 0x20000
    s_mov_b32 s32, s74
    s_and_b32 s33, s75, 0xffff
    s_mov_b32 s34, 7864320
    s_mov_b32 s35, 0x20000
    s_mul_i32 s60, s13, 192
    s_add_u32 s25, s60, 96
    s_add_u32 s26, s60, 192
    s_mul_i32 s27, s13, 122880
    s_add_u32 s27, s27, 960
    s_add_u32 m0, s62, 0
    s_nop 0
    buffer_load_dwordx4 v20, s[8:11], s25 offen lds
    s_add_u32 m0, s62, 1024
    s_nop 0
    buffer_load_dwordx4 v21, s[8:11], s25 offen lds
    s_add_u32 m0, s62, 2048
    s_nop 0
    buffer_load_dwordx4 v22, s[8:11], s25 offen lds
    s_add_u32 s25, s25, 393216
    s_add_u32 m0, s62, 3072
    s_nop 0
    buffer_load_dwordx4 v20, s[8:11], s25 offen lds
    s_add_u32 m0, s62, 4096
    s_nop 0
    buffer_load_dwordx4 v21, s[8:11], s25 offen lds
    s_add_u32 m0, s62, 5120
    s_nop 0
    buffer_load_dwordx4 v22, s[8:11], s25 offen lds
    s_add_u32 s25, s25, 393216
    s_add_u32 m0, s62, 6144
    s_nop 0
    buffer_load_dwordx4 v20, s[8:11], s25 offen lds
    s_add_u32 m0, s62, 7168
    s_nop 0
    buffer_load_dwordx4 v21, s[8:11], s25 offen lds
    s_add_u32 m0, s62, 8192
    s_nop 0
    buffer_load_dwordx4 v22, s[8:11], s25 offen lds
    s_add_u32 s25, s25, 393216
    s_add_u32 m0, s62, 9216
    s_nop 0
    buffer_load_dwordx4 v20, s[8:11], s25 offen lds
    s_add_u32 m0, s62, 10240
    s_nop 0
    buffer_load_dwordx4 v21, s[8:11], s25 offen lds
    s_add_u32 m0, s62, 11264
    s_nop 0
    buffer_load_dwordx4 v22, s[8:11], s25 offen lds
    s_add_u32 s25, s25, 393216
    s_add_u32 m0, s62, 12288
    s_nop 0
    buffer_load_dwordx4 v20, s[8:11], s25 offen lds
    s_add_u32 m0, s62, 13312
    s_nop 0
    buffer_load_dwordx4 v21, s[8:11], s25 offen lds
    s_add_u32 m0, s62, 14336
    s_nop 0
    buffer_load_dwordx4 v22, s[8:11], s25 offen lds
    s_waitcnt vmcnt(12)
    s_barrier
    s_cmp_lg_u32 s12, 0
    s_cbranch_scc1 L_R3_arr_1
    s_lshl_b32 s3, s18, 2
    s_add_u32 s3, s3, 64
    v_mov_b32 v92, s3
    v_mov_b32 v93, 1
    s_mov_b64 exec, 1
    global_atomic_add v92, v93, s[16:17] sc1
    s_waitcnt vmcnt(0)
    s_mov_b64 exec, -1
L_R3_arr_1:
    ds_read_b64_tr_b16 a[0:1], v35 offset:0
    ds_read_b64_tr_b16 a[2:3], v35 offset:1536
    ds_read_b64_tr_b16 a[80:81], v35 offset:32
    ds_read_b64_tr_b16 a[82:83], v35 offset:1568
    ds_read_b64_tr_b16 a[160:161], v35 offset:64
    ds_read_b64_tr_b16 a[162:163], v35 offset:1600
    s_waitcnt lgkmcnt(0)
    s_add_u32 s25, s25, 393216
    s_add_u32 m0, s62, 0
    s_nop 0
    buffer_load_dwordx4 v20, s[8:11], s25 offen lds
    s_add_u32 m0, s62, 1024
    s_nop 0
    buffer_load_dwordx4 v21, s[8:11], s25 offen lds
    s_add_u32 m0, s62, 2048
    s_nop 0
    buffer_load_dwordx4 v22, s[8:11], s25 offen lds
    s_waitcnt vmcnt(12)
    ds_read_b64_tr_b16 a[4:5], v35 offset:3072
    ds_read_b64_tr_b16 a[6:7], v35 offset:4608
    ds_read_b64_tr_b16 a[84:85], v35 offset:3104
    ds_read_b64_tr_b16 a[86:87], v35 offset:4640
    ds_read_b64_tr_b16 a[164:165], v35 offset:3136
    ds_read_b64_tr_b16 a[166:167], v35 offset:4672
    s_waitcnt lgkmcnt(0)
    s_add_u32 s25, s25, 393216
    s_add_u32 m0, s62, 3072
    s_nop 0
    buffer_load_dwordx4 v20, s[8:11], s25 offen lds
    s_add_u32 m0, s62, 4096
    s_nop 0
    buffer_load_dwordx4 v21, s[8:11], s25 offen lds
    s_add_u32 m0, s62, 5120
    s_nop 0
    buffer_load_dwordx4 v22, s[8:11], s25 offen lds
    s_waitcnt vmcnt(12)
    ds_read_b64_tr_b16 a[8:9], v35 offset:6144
    ds_read_b64_tr_b16 a[10:11], v35 offset:7680
    ds_read_b64_tr_b16 a[88:89], v35 offset:6176
    ds_read_b64_tr_b16 a[90:91], v35 offset:7712
    ds_read_b64_tr_b16 a[168:169], v35 offset:6208
    ds_read_b64_tr_b16 a[170:171], v35 offset:7744
    s_waitcnt lgkmcnt(0)
    s_add_u32 s25, s25, 393216
    s_add_u32 m0, s62, 6144
    s_nop 0
    buffer_load_dwordx4 v20, s[8:11], s25 offen lds
    s_add_u32 m0, s62, 7168
    s_nop 0
    buffer_load_dwordx4 v21, s[8:11], s25 offen lds
    s_add_u32 m0, s62, 8192
    s_nop 0
    buffer_load_dwordx4 v22, s[8:11], s25 offen lds
    s_waitcnt vmcnt(12)
    ds_read_b64_tr_b16 a[12:13], v35 offset:9216
    ds_read_b64_tr_b16 a[14:15], v35 offset:10752
    ds_read_b64_tr_b16 a[92:93], v35 offset:9248
    ds_read_b64_tr_b16 a[94:95], v35 offset:10784
    ds_read_b64_tr_b16 a[172:173], v35 offset:9280
    ds_read_b64_tr_b16 a[174:175], v35 offset:10816
    s_waitcnt lgkmcnt(0)
    s_add_u32 s25, s25, 393216
    s_add_u32 m0, s62, 9216
    s_nop 0
    buffer_load_dwordx4 v20, s[8:11], s25 offen lds
    s_add_u32 m0, s62, 10240
    s_nop 0
    buffer_load_dwordx4 v21, s[8:11], s25 offen lds
    s_add_u32 m0, s62, 11264
    s_nop 0
    buffer_load_dwordx4 v22, s[8:11], s25 offen lds
    s_waitcnt vmcnt(12)
    ds_read_b64_tr_b16 a[16:17], v35 offset:12288
    ds_read_b64_tr_b16 a[18:19], v35 offset:13824
    ds_read_b64_tr_b16 a[96:97], v35 offset:12320
    ds_read_b64_tr_b16 a[98:99], v35 offset:13856
    ds_read_b64_tr_b16 a[176:177], v35 offset:12352
    ds_read_b64_tr_b16 a[178:179], v35 offset:13888
    s_waitcnt lgkmcnt(0)
    s_add_u32 s25, s25, 393216
    s_add_u32 m0, s62, 12288
    s_nop 0
    buffer_load_dwordx4 v20, s[8:11], s25 offen lds
    s_add_u32 m0, s62, 13312
    s_nop 0
    buffer_load_dwordx4 v21, s[8:11], s25 offen lds
    s_add_u32 m0, s62, 14336
    s_nop 0
    buffer_load_dwordx4 v22, s[8:11], s25 offen lds
    s_waitcnt vmcnt(12)
    ds_read_b64_tr_b16 a[20:21], v35 offset:0
    ds_read_b64_tr_b16 a[22:23], v35 offset:1536
    ds_read_b64_tr_b16 a[100:101], v35 offset:32
    ds_read_b64_tr_b16 a[102:103], v35 offset:1568
    ds_read_b64_tr_b16 a[180:181], v35 offset:64
    ds_read_b64_tr_b16 a[182:183], v35 offset:1600
    s_waitcnt lgkmcnt(0)
    s_add_u32 s25, s25, 393216
    s_add_u32 m0, s62, 0
    s_nop 0
    buffer_load_dwordx4 v20, s[8:11], s25 offen lds
    s_add_u32 m0, s62, 1024
    s_nop 0
    buffer_load_dwordx4 v21, s[8:11], s25 offen lds
    s_add_u32 m0, s62, 2048
    s_nop 0
    buffer_load_dwordx4 v22, s[8:11], s25 offen lds
    s_waitcnt vmcnt(12)
    ds_read_b64_tr_b16 a[24:25], v35 offset:3072
    ds_read_b64_tr_b16 a[26:27], v35 offset:4608
    ds_read_b64_tr_b16 a[104:105], v35 offset:3104
    ds_read_b64_tr_b16 a[106:107], v35 offset:4640
    ds_read_b64_tr_b16 a[184:185], v35 offset:3136
    ds_read_b64_tr_b16 a[186:187], v35 offset:4672
    s_waitcnt lgkmcnt(0)
    s_add_u32 s25, s25, 393216
    s_add_u32 m0, s62, 3072
    s_nop 0
    buffer_load_dwordx4 v20, s[8:11], s25 offen lds
    s_add_u32 m0, s62, 4096
    s_nop 0
    buffer_load_dwordx4 v21, s[8:11], s25 offen lds
    s_add_u32 m0, s62, 5120
    s_nop 0
    buffer_load_dwordx4 v22, s[8:11], s25 offen lds
    s_waitcnt vmcnt(12)
    ds_read_b64_tr_b16 a[28:29], v35 offset:6144
    ds_read_b64_tr_b16 a[30:31], v35 offset:7680
    ds_read_b64_tr_b16 a[108:109], v35 offset:6176
    ds_read_b64_tr_b16 a[110:111], v35 offset:7712
    ds_read_b64_tr_b16 a[188:189], v35 offset:6208
    ds_read_b64_tr_b16 a[190:191], v35 offset:7744
    s_waitcnt lgkmcnt(0)
    s_add_u32 s25, s25, 393216
    s_add_u32 m0, s62, 6144
    s_nop 0
    buffer_load_dwordx4 v20, s[8:11], s25 offen lds
    s_add_u32 m0, s62, 7168
    s_nop 0
    buffer_load_dwordx4 v21, s[8:11], s25 offen lds
    s_add_u32 m0, s62, 8192
    s_nop 0
    buffer_load_dwordx4 v22, s[8:11], s25 offen lds
    s_waitcnt vmcnt(12)
    ds_read_b64_tr_b16 a[32:33], v35 offset:9216
    ds_read_b64_tr_b16 a[34:35], v35 offset:10752
    ds_read_b64_tr_b16 a[112:113], v35 offset:9248
    ds_read_b64_tr_b16 a[114:115], v35 offset:10784
    ds_read_b64_tr_b16 a[192:193], v35 offset:9280
    ds_read_b64_tr_b16 a[194:195], v35 offset:10816
    s_waitcnt lgkmcnt(0)
    s_add_u32 s25, s25, 393216
    s_add_u32 m0, s62, 9216
    s_nop 0
    buffer_load_dwordx4 v20, s[8:11], s25 offen lds
    s_add_u32 m0, s62, 10240
    s_nop 0
    buffer_load_dwordx4 v21, s[8:11], s25 offen lds
    s_add_u32 m0, s62, 11264
    s_nop 0
    buffer_load_dwordx4 v22, s[8:11], s25 offen lds
    s_waitcnt vmcnt(12)
    ds_read_b64_tr_b16 a[36:37], v35 offset:12288
    ds_read_b64_tr_b16 a[38:39], v35 offset:13824
    ds_read_b64_tr_b16 a[116:117], v35 offset:12320
    ds_read_b64_tr_b16 a[118:119], v35 offset:13856
    ds_read_b64_tr_b16 a[196:197], v35 offset:12352
    ds_read_b64_tr_b16 a[198:199], v35 offset:13888
    s_waitcnt lgkmcnt(0)
    s_add_u32 s25, s25, 393216
    s_add_u32 m0, s62, 12288
    s_nop 0
    buffer_load_dwordx4 v20, s[8:11], s25 offen lds
    s_add_u32 m0, s62, 13312
    s_nop 0
    buffer_load_dwordx4 v21, s[8:11], s25 offen lds
    s_add_u32 m0, s62, 14336
    s_nop 0
    buffer_load_dwordx4 v22, s[8:11], s25 offen lds
    s_waitcnt vmcnt(12)
    ds_read_b64_tr_b16 a[40:41], v35 offset:0
    ds_read_b64_tr_b16 a[42:43], v35 offset:1536
    ds_read_b64_tr_b16 a[120:121], v35 offset:32
    ds_read_b64_tr_b16 a[122:123], v35 offset:1568
    ds_read_b64_tr_b16 a[200:201], v35 offset:64
    ds_read_b64_tr_b16 a[202:203], v35 offset:1600
    s_waitcnt lgkmcnt(0)
    s_add_u32 s25, s25, 393216
    s_add_u32 m0, s62, 0
    s_nop 0
    buffer_load_dwordx4 v20, s[8:11], s25 offen lds
    s_add_u32 m0, s62, 1024
    s_nop 0
    buffer_load_dwordx4 v21, s[8:11], s25 offen lds
    s_add_u32 m0, s62, 2048
    s_nop 0
    buffer_load_dwordx4 v22, s[8:11], s25 offen lds
    s_waitcnt vmcnt(12)
    ds_read_b64_tr_b16 a[44:45], v35 offset:3072
    ds_read_b64_tr_b16 a[46:47], v35 offset:4608
    ds_read_b64_tr_b16 a[124:125], v35 offset:3104
    ds_read_b64_tr_b16 a[126:127], v35 offset:4640
    ds_read_b64_tr_b16 a[204:205], v35 offset:3136
    ds_read_b64_tr_b16 a[206:207], v35 offset:4672
    s_waitcnt lgkmcnt(0)
    s_add_u32 s25, s25, 393216
    s_add_u32 m0, s62, 3072
    s_nop 0
    buffer_load_dwordx4 v20, s[8:11], s25 offen lds
    s_add_u32 m0, s62, 4096
    s_nop 0
    buffer_load_dwordx4 v21, s[8:11], s25 offen lds
    s_add_u32 m0, s62, 5120
    s_nop 0
    buffer_load_dwordx4 v22, s[8:11], s25 offen lds
    s_waitcnt vmcnt(12)
    ds_read_b64_tr_b16 a[48:49], v35 offset:6144
    ds_read_b64_tr_b16 a[50:51], v35 offset:7680
    ds_read_b64_tr_b16 a[128:129], v35 offset:6176
    ds_read_b64_tr_b16 a[130:131], v35 offset:7712
    ds_read_b64_tr_b16 a[208:209], v35 offset:6208
    ds_read_b64_tr_b16 a[210:211], v35 offset:7744
    s_waitcnt lgkmcnt(0)
    s_add_u32 s25, s25, 393216
    s_add_u32 m0, s62, 6144
    s_nop 0
    buffer_load_dwordx4 v20, s[8:11], s25 offen lds
    s_add_u32 m0, s62, 7168
    s_nop 0
    buffer_load_dwordx4 v21, s[8:11], s25 offen lds
    s_add_u32 m0, s62, 8192
    s_nop 0
    buffer_load_dwordx4 v22, s[8:11], s25 offen lds
    s_waitcnt vmcnt(12)
    ds_read_b64_tr_b16 a[52:53], v35 offset:9216
    ds_read_b64_tr_b16 a[54:55], v35 offset:10752
    ds_read_b64_tr_b16 a[132:133], v35 offset:9248
    ds_read_b64_tr_b16 a[134:135], v35 offset:10784
    ds_read_b64_tr_b16 a[212:213], v35 offset:9280
    ds_read_b64_tr_b16 a[214:215], v35 offset:10816
    s_waitcnt lgkmcnt(0)
    s_add_u32 s25, s25, 393216
    s_add_u32 m0, s62, 9216
    s_nop 0
    buffer_load_dwordx4 v20, s[8:11], s25 offen lds
    s_add_u32 m0, s62, 10240
    s_nop 0
    buffer_load_dwordx4 v21, s[8:11], s25 offen lds
    s_add_u32 m0, s62, 11264
    s_nop 0
    buffer_load_dwordx4 v22, s[8:11], s25 offen lds
    s_waitcnt vmcnt(12)
    ds_read_b64_tr_b16 a[56:57], v35 offset:12288
    ds_read_b64_tr_b16 a[58:59], v35 offset:13824
    ds_read_b64_tr_b16 a[136:137], v35 offset:12320
    ds_read_b64_tr_b16 a[138:139], v35 offset:13856
    ds_read_b64_tr_b16 a[216:217], v35 offset:12352
    ds_read_b64_tr_b16 a[218:219], v35 offset:13888
    s_waitcnt lgkmcnt(0)
    s_add_u32 s25, s25, 393216
    s_add_u32 m0, s62, 12288
    s_nop 0
    buffer_load_dwordx4 v20, s[8:11], s25 offen lds
    s_add_u32 m0, s62, 13312
    s_nop 0
    buffer_load_dwordx4 v21, s[8:11], s25 offen lds
    s_add_u32 m0, s62, 14336
    s_nop 0
    buffer_load_dwordx4 v22, s[8:11], s25 offen lds
    s_waitcnt vmcnt(12)
    ds_read_b64_tr_b16 a[60:61], v35 offset:0
    ds_read_b64_tr_b16 a[62:63], v35 offset:1536
    ds_read_b64_tr_b16 a[140:141], v35 offset:32
    ds_read_b64_tr_b16 a[142:143], v35 offset:1568
    ds_read_b64_tr_b16 a[220:221], v35 offset:64
    ds_read_b64_tr_b16 a[222:223], v35 offset:1600
    s_waitcnt lgkmcnt(0)
    s_waitcnt vmcnt(9)
    ds_read_b64_tr_b16 a[64:65], v35 offset:3072
    ds_read_b64_tr_b16 a[66:67], v35 offset:4608
    ds_read_b64_tr_b16 a[144:145], v35 offset:3104
    ds_read_b64_tr_b16 a[146:147], v35 offset:4640
    ds_read_b64_tr_b16 a[224:225], v35 offset:3136
    ds_read_b64_tr_b16 a[226:227], v35 offset:4672
    s_waitcnt lgkmcnt(0)
    s_waitcnt vmcnt(6)
    ds_read_b64_tr_b16 a[68:69], v35 offset:6144
    ds_read_b64_tr_b16 a[70:71], v35 offset:7680
    ds_read_b64_tr_b16 a[148:149], v35 offset:6176
    ds_read_b64_tr_b16 a[150:151], v35 offset:7712
    ds_read_b64_tr_b16 a[228:229], v35 offset:6208
    ds_read_b64_tr_b16 a[230:231], v35 offset:7744
    s_waitcnt lgkmcnt(0)
    s_waitcnt vmcnt(3)
    ds_read_b64_tr_b16 a[72:73], v35 offset:9216
    ds_read_b64_tr_b16 a[74:75], v35 offset:10752
    ds_read_b64_tr_b16 a[152:153], v35 offset:9248
    ds_read_b64_tr_b16 a[154:155], v35 offset:10784
    ds_read_b64_tr_b16 a[232:233], v35 offset:9280
    ds_read_b64_tr_b16 a[234:235], v35 offset:10816
    s_waitcnt lgkmcnt(0)
    s_add_u32 m0, s62, 0
    s_nop 0
    buffer_load_dwordx4 v25, s[32:35], s27 offen lds
    s_add_u32 m0, s62, 1024
    s_nop 0
    buffer_load_dwordx4 v26, s[32:35], s27 offen lds
    s_add_u32 m0, s62, 2048
    s_nop 0
    buffer_load_dwordx4 v27, s[32:35], s27 offen lds
    s_add_u32 m0, s62, 3072
    s_nop 0
    buffer_load_dwordx4 v28, s[32:35], s27 offen lds
    s_add_u32 m0, s62, 4096
    s_nop 0
    buffer_load_dwordx4 v29, s[32:35], s27 offen lds
    s_add_u32 m0, s62, 5120
    s_nop 0
    buffer_load_dwordx4 v30, s[32:35], s27 offen lds
    s_add_u32 m0, s62, 6144
    s_nop 0
    buffer_load_dwordx4 v31, s[32:35], s27 offen lds
    s_add_u32 m0, s62, 7168
    s_nop 0
    buffer_load_dwordx4 v32, s[32:35], s27 offen lds
    s_add_u32 m0, s62, 8192
    s_nop 0
    buffer_load_dwordx4 v33, s[32:35], s27 offen lds
    s_add_u32 m0, s62, 9216
    s_nop 0
    buffer_load_dwordx4 v34, s[32:35], s27 offen lds
    s_waitcnt vmcnt(10)
    ds_read_b64_tr_b16 a[76:77], v35 offset:12288
    ds_read_b64_tr_b16 a[78:79], v35 offset:13824
    ds_read_b64_tr_b16 a[156:157], v35 offset:12320
    ds_read_b64_tr_b16 a[158:159], v35 offset:13856
    ds_read_b64_tr_b16 a[236:237], v35 offset:12352
    ds_read_b64_tr_b16 a[238:239], v35 offset:13888
    s_waitcnt lgkmcnt(0)
    s_waitcnt vmcnt(0)
    ds_read_b64_tr_b16 v[96:97], v37 offset:0
    ds_read_b64_tr_b16 v[98:99], v37 offset:5120
    ds_read_b64_tr_b16 v[108:109], v37 offset:32
    ds_read_b64_tr_b16 v[110:111], v37 offset:5152
    ds_read_b64_tr_b16 v[120:121], v37 offset:64
    ds_read_b64_tr_b16 v[122:123], v37 offset:5184
    ds_read_b64_tr_b16 v[132:133], v37 offset:96
    ds_read_b64_tr_b16 v[134:135], v37 offset:5216
    ds_read_b64_tr_b16 v[144:145], v37 offset:128
    ds_read_b64_tr_b16 v[146:147], v37 offset:5248
    ds_read_b64_tr_b16 v[156:157], v37 offset:160
    ds_read_b64_tr_b16 v[158:159], v37 offset:5280
    ds_read_b64_tr_b16 v[168:169], v37 offset:192
    ds_read_b64_tr_b16 v[170:171], v37 offset:5312
    ds_read_b64_tr_b16 v[180:181], v37 offset:224
    ds_read_b64_tr_b16 v[182:183], v37 offset:5344
    ds_read_b64_tr_b16 v[192:193], v37 offset:256
    ds_read_b64_tr_b16 v[194:195], v37 offset:5376
    ds_read_b64_tr_b16 v[204:205], v37 offset:288
    ds_read_b64_tr_b16 v[206:207], v37 offset:5408
    s_waitcnt lgkmcnt(0)
    s_add_u32 s27, s27, 40960
    s_add_u32 m0, s62, 0
    s_nop 0
    buffer_load_dwordx4 v25, s[32:35], s27 offen lds
    s_add_u32 m0, s62, 1024
    s_nop 0
    buffer_load_dwordx4 v26, s[32:35], s27 offen lds
    s_add_u32 m0, s62, 2048
    s_nop 0
    buffer_load_dwordx4 v27, s[32:35], s27 offen lds
    s_add_u32 m0, s62, 3072
    s_nop 0
    buffer_load_dwordx4 v28, s[32:35], s27 offen lds
    s_add_u32 m0, s62, 4096
    s_nop 0
    buffer_load_dwordx4 v29, s[32:35], s27 offen lds
    s_add_u32 m0, s62, 5120
    s_nop 0
    buffer_load_dwordx4 v30, s[32:35], s27 offen lds
    s_add_u32 m0, s62, 6144
    s_nop 0
    buffer_load_dwordx4 v31, s[32:35], s27 offen lds
    s_add_u32 m0, s62, 7168
    s_nop 0
    buffer_load_dwordx4 v32, s[32:35], s27 offen lds
    s_add_u32 m0, s62, 8192
    s_nop 0
    buffer_load_dwordx4 v33, s[32:35], s27 offen lds
    s_add_u32 m0, s62, 9216
    s_nop 0
    buffer_load_dwordx4 v34, s[32:35], s27 offen lds
    s_waitcnt vmcnt(0)
    ds_read_b64_tr_b16 v[100:101], v37 offset:0
    ds_read_b64_tr_b16 v[102:103], v37 offset:5120
    ds_read_b64_tr_b16 v[112:113], v37 offset:32
    ds_read_b64_tr_b16 v[114:115], v37 offset:5152
    ds_read_b64_tr_b16 v[124:125], v37 offset:64
    ds_read_b64_tr_b16 v[126:127], v37 offset:5184
    ds_read_b64_tr_b16 v[136:137], v37 offset:96
    ds_read_b64_tr_b16 v[138:139], v37 offset:5216
    ds_read_b64_tr_b16 v[148:149], v37 offset:128
    ds_read_b64_tr_b16 v[150:151], v37 offset:5248
    ds_read_b64_tr_b16 v[160:161], v37 offset:160
    ds_read_b64_tr_b16 v[162:163], v37 offset:5280
    ds_read_b64_tr_b16 v[172:173], v37 offset:192
    ds_read_b64_tr_b16 v[174:175], v37 offset:5312
    ds_read_b64_tr_b16 v[184:185], v37 offset:224
    ds_read_b64_tr_b16 v[186:187], v37 offset:5344
    ds_read_b64_tr_b16 v[196:197], v37 offset:256
    ds_read_b64_tr_b16 v[198:199], v37 offset:5376
    ds_read_b64_tr_b16 v[208:209], v37 offset:288
    ds_read_b64_tr_b16 v[210:211], v37 offset:5408
    s_waitcnt lgkmcnt(0)
    s_add_u32 s27, s27, 40960
    s_add_u32 m0, s62, 0
    s_nop 0
    buffer_load_dwordx4 v25, s[32:35], s27 offen lds
    s_add_u32 m0, s62, 1024
    s_nop 0
    buffer_load_dwordx4 v26, s[32:35], s27 offen lds
    s_add_u32 m0, s62, 2048
    s_nop 0
    buffer_load_dwordx4 v27, s[32:35], s27 offen lds
    s_add_u32 m0, s62, 3072
    s_nop 0
    buffer_load_dwordx4 v28, s[32:35], s27 offen lds
    s_add_u32 m0, s62, 4096
    s_nop 0
    buffer_load_dwordx4 v29, s[32:35], s27 offen lds
    s_add_u32 m0, s62, 5120
    s_nop 0
    buffer_load_dwordx4 v30, s[32:35], s27 offen lds
    s_add_u32 m0, s62, 6144
    s_nop 0
    buffer_load_dwordx4 v31, s[32:35], s27 offen lds
    s_add_u32 m0, s62, 7168
    s_nop 0
    buffer_load_dwordx4 v32, s[32:35], s27 offen lds
    s_add_u32 m0, s62, 8192
    s_nop 0
    buffer_load_dwordx4 v33, s[32:35], s27 offen lds
    s_add_u32 m0, s62, 9216
    s_nop 0
    buffer_load_dwordx4 v34, s[32:35], s27 offen lds
    s_waitcnt vmcnt(0)
    ds_read_b64_tr_b16 v[104:105], v37 offset:0
    ds_read_b64_tr_b16 v[106:107], v37 offset:5120
    ds_read_b64_tr_b16 v[116:117], v37 offset:32
    ds_read_b64_tr_b16 v[118:119], v37 offset:5152
    ds_read_b64_tr_b16 v[128:129], v37 offset:64
    ds_read_b64_tr_b16 v[130:131], v37 offset:5184
    ds_read_b64_tr_b16 v[140:141], v37 offset:96
    ds_read_b64_tr_b16 v[142:143], v37 offset:5216
    ds_read_b64_tr_b16 v[152:153], v37 offset:128
    ds_read_b64_tr_b16 v[154:155], v37 offset:5248
    ds_read_b64_tr_b16 v[164:165], v37 offset:160
    ds_read_b64_tr_b16 v[166:167], v37 offset:5280
    ds_read_b64_tr_b16 v[176:177], v37 offset:192
    ds_read_b64_tr_b16 v[178:179], v37 offset:5312
    ds_read_b64_tr_b16 v[188:189], v37 offset:224
    ds_read_b64_tr_b16 v[190:191], v37 offset:5344
    ds_read_b64_tr_b16 v[200:201], v37 offset:256
    ds_read_b64_tr_b16 v[202:203], v37 offset:5376
    ds_read_b64_tr_b16 v[212:213], v37 offset:288
    ds_read_b64_tr_b16 v[214:215], v37 offset:5408
    s_waitcnt lgkmcnt(0)
    v_and_b32 v10, 15, v0
    v_lshrrev_b32 v11, 4, v0
    v_and_b32 v12, 7, v0
    v_and_b32 v13, 1, v0
    v_mov_b32 v14, 0x3f80
    v_lshlrev_b32 v13, 4, v13
    v_lshlrev_b32 v14, v13, v14
    v_lshrrev_b32 v12, 1, v12
    v_lshrrev_b32 v13, 2, v10
    v_cmp_eq_u32 s[38:39], v13, v11
    v_bfe_u32 v13, v0, 1, 1
    s_nop 0
    v_cndmask_b32 v17, 0, v14, s[38:39]
    v_cmp_eq_u32 vcc, 0, v12
    s_nop 1
    v_cndmask_b32 v15, 0, v14, vcc
    v_accvgpr_write_b32 a248, v15
    v_cmp_eq_u32 vcc, 0, v13
    s_nop 1
    v_cndmask_b32 v16, 0, v17, vcc
    v_accvgpr_write_b32 a240, v16
    v_accvgpr_write_b32 a244, 0
    v_cmp_eq_u32 vcc, 1, v12
    s_nop 1
    v_cndmask_b32 v15, 0, v14, vcc
    v_accvgpr_write_b32 a249, v15
    v_cmp_eq_u32 vcc, 1, v13
    s_nop 1
    v_cndmask_b32 v16, 0, v17, vcc
    v_accvgpr_write_b32 a241, v16
    v_accvgpr_write_b32 a245, 0
    v_cmp_eq_u32 vcc, 2, v12
    s_nop 1
    v_cndmask_b32 v15, 0, v14, vcc
    v_accvgpr_write_b32 a250, v15
    v_cmp_eq_u32 vcc, 0, v13
    s_nop 1
    v_cndmask_b32 v16, 0, v17, vcc
    v_accvgpr_write_b32 a246, v16
    v_accvgpr_write_b32 a242, 0
    v_cmp_eq_u32 vcc, 3, v12
    s_nop 1
    v_cndmask_b32 v15, 0, v14, vcc
    v_accvgpr_write_b32 a251, v15
    v_cmp_eq_u32 vcc, 1, v13
    s_nop 1
    v_cndmask_b32 v16, 0, v17, vcc
    v_accvgpr_write_b32 a247, v16
    v_accvgpr_write_b32 a243, 0
    v_cmp_gt_u32 s[48:49], 8, v10
    v_cmp_gt_u32 vcc, 2, v11
    s_xnor_b64 s[50:51], vcc, s[48:49]
    s_mul_i32 s60, s15, 640
    s_mov_b32 s61, 20480
    v_add_u32 v12, 960, v0
    v_mul_u32_u24 v13, 52429, v12
    v_lshrrev_b32 v13, 21, v13
    v_mul_u32_u24 v14, 40, v13
    v_sub_u32 v14, v12, v14
    v_mul_lo_u32 v13, v13, s61
    v_lshl_add_u32 v13, v14, 4, v13
    v_add_u32 v3, s60, v13
    v_add_u32 v12, 1024, v0
    v_mul_u32_u24 v13, 52429, v12
    v_lshrrev_b32 v13, 21, v13
    v_mul_u32_u24 v14, 40, v13
    v_sub_u32 v14, v12, v14
    v_mul_lo_u32 v13, v13, s61
    v_lshl_add_u32 v13, v14, 4, v13
    v_add_u32 v4, s60, v13
    v_add_u32 v12, 1088, v0
    v_mul_u32_u24 v13, 52429, v12
    v_lshrrev_b32 v13, 21, v13
    v_mul_u32_u24 v14, 40, v13
    v_sub_u32 v14, v12, v14
    v_mul_lo_u32 v13, v13, s61
    v_lshl_add_u32 v13, v14, 4, v13
    v_add_u32 v5, s60, v13
    v_add_u32 v12, 1152, v0
    v_mul_u32_u24 v13, 52429, v12
    v_lshrrev_b32 v13, 21, v13
    v_mul_u32_u24 v14, 40, v13
    v_sub_u32 v14, v12, v14
    v_mul_lo_u32 v13, v13, s61
    v_lshl_add_u32 v13, v14, 4, v13
    v_add_u32 v6, s60, v13
    v_add_u32 v12, 1216, v0
    v_mul_u32_u24 v13, 52429, v12
    v_lshrrev_b32 v13, 21, v13
    v_mul_u32_u24 v14, 40, v13
    v_sub_u32 v14, v12, v14
    v_mul_lo_u32 v13, v13, s61
    v_lshl_add_u32 v13, v14, 4, v13
    v_add_u32 v7, s60, v13
    s_mul_i32 s60, s15, 20480
    s_add_u32 s60, s60, 512
    v_lshrrev_b32 v12, 4, v0
    v_mul_u32_u24 v12, 640, v12
    v_and_b32 v13, 15, v0
    v_lshl_add_u32 v12, v13, 4, v12
    v_add_u32 v8, s60, v12
    s_mul_i32 s60, s15, 40
    s_add_u32 s60, s60, 32
    v_add_u32 v12, s60, v10
    v_lshlrev_b32 v9, 4, v12
    s_mul_i32 s32, s14, 655360
    s_add_u32 s32, s32, 1310720
    s_add_u32 s33, s32, 5120
    s_add_u32 s34, s32, 10240
    s_add_u32 s35, s32, 15360
    s_mov_b32 s52, 1037384597
    s_mov_b32 s53, 1037384597
    s_lshl_b32 s29, s13, 12
    s_add_u32 s29, s29, 919552
    s_xor_b32 s30, s29, 4096
    s_mov_b64 s[46:47], 65535
    s_mov_b32 s8, s66
    s_and_b32 s9, s67, 0xffff
    s_mov_b32 s10, 10240
    s_mov_b32 s11, 0x20000
    v_and_b32 v13, 7, v12
    v_mul_u32_u24 v13, 1280, v13
    v_lshrrev_b32 v14, 6, v12
    v_lshl_add_u32 v13, v14, 6, v13
    v_bfe_u32 v14, v12, 4, 2
    v_lshl_add_u32 v13, v14, 3, v13
    v_and_b32 v14, 8, v12
    v_cmp_eq_u32 s[38:39], 0, v14
    v_cmp_ne_u32 s[40:41], 0, v14
    s_cmp_eq_u32 s14, 0
    s_cselect_b32 s10, 10240, 0
    buffer_load_dwordx2 v[16:17], v13, s[8:11], 0 offen
    buffer_load_dwordx2 v[18:19], v13, s[8:11], 0 offen offset:32
    s_waitcnt vmcnt(0)
    v_accvgpr_write_b32 a252, v16
    v_accvgpr_write_b32 a253, v17
    v_accvgpr_write_b32 a254, v18
    v_accvgpr_write_b32 a255, v19
    s_lshl_b32 s3, s18, 2
    s_add_u32 s3, s3, 64
    v_mov_b32 v92, s3
    v_lshlrev_b32 v94, 2, v0
    v_and_b32 v94, 28, v94
    s_mov_b32 s19, 0
L_R3_warr_2:
    global_load_dword v93, v92, s[16:17] sc1
    s_add_u32 s19, s19, 1
    s_cmp_ge_u32 s19, 524288
    s_cbranch_scc1 L_fail
    s_waitcnt vmcnt(0)
    v_cmp_gt_u32 vcc, 256, v93
    s_nop 0
    s_cbranch_vccnz L_R3_warr_2
    s_cmp_lg_u32 s18, 0
    s_cbranch_scc1 L_R3_placed_3
    global_load_dword v93, v94, s[16:17] sc1
    s_waitcnt vmcnt(0)
    v_cmp_ne_u32 vcc, 32, v93
    s_nop 0
    s_cbranch_vccnz L_fallback
L_R3_placed_3:
    v_lshlrev_b32 v0, 4, v0
    s_mov_b32 s20, 0
    s_barrier
    v_lshlrev_b32 v217, 3, v0
    v_and_b32 v217, 0x780, v217
    v_bfe_u32 v218, v0, 8, 1
    v_lshl_add_u32 v217, v218, 2, v217
    s_add_u32 s60, s20, 0
    s_add_u32 s58, s60, 1
    s_cmp_gt_u32 s60, 63
    s_cselect_b32 s58, 0, s58
    s_sub_u32 s59, s60, 6
    s_cmp_lt_u32 s60, 7
    s_cselect_b32 s59, 0, s59
    v_mov_b32 v216, s58
    v_mov_b32 v218, s59
    v_cmp_gt_u32 vcc, 256, v0
    s_nop 1
    v_cndmask_b32 v216, v218, v216, vcc
    buffer_load_dword v218, v217, s[4:7], s55 offen sc1
    s_waitcnt vmcnt(0)
    s_mov_b32 s19, 0
L_R3_kvchk_4:
    v_cmp_lt_u32 vcc, v218, v216
    s_and_b64 vcc, vcc, 0x0fff0fff
    s_cbranch_vccnz L_R3_kvretry_5
    s_cmp_eq_u32 s58, 0
    s_cbranch_scc1 L_R3_kv1_6
    s_sub_u32 s60, s58, 1
    s_lshl_b32 s60, s60, 6
    s_add_u32 s60, s60, s13
    s_mul_i32 s60, s60, 12288
    s_add_u32 s60, s60, 37355520
    s_mov_b32 m0, 29696
    s_nop 0
    buffer_load_dwordx4 v0, s[4:7], s60 offen offset:0 sc1 lds
    buffer_load_dwordx4 v0, s[4:7], s60 offen offset:1024 sc1 lds
    buffer_load_dwordx4 v0, s[4:7], s60 offen offset:2048 sc1 lds
    s_add_u32 s60, s60, 3072
    s_mov_b32 m0, 32768
    s_nop 0
    buffer_load_dwordx4 v0, s[4:7], s60 offen offset:0 sc1 lds
    buffer_load_dwordx4 v0, s[4:7], s60 offen offset:1024 sc1 lds
    buffer_load_dwordx4 v0, s[4:7], s60 offen offset:2048 sc1 lds
L_R3_kv1_6:
    s_cmp_eq_u32 s59, 0
    s_cbranch_scc1 L_R3_kv2_7
    s_sub_u32 s60, s59, 1
    s_lshl_b32 s60, s60, 6
    s_add_u32 s60, s60, s13
    s_mul_i32 s60, s60, 12288
    s_add_u32 s60, s60, 87687168
    s_mov_b32 m0, 41984
    s_nop 0
    buffer_load_dwordx4 v0, s[4:7], s60 offen offset:0 sc1 lds
    buffer_load_dwordx4 v0, s[4:7], s60 offen offset:1024 sc1 lds
    buffer_load_dwordx4 v0, s[4:7], s60 offen offset:2048 sc1 lds
    s_add_u32 s60, s60, 3072
    s_mov_b32 m0, 45056
    s_nop 0
    buffer_load_dwordx4 v0, s[4:7], s60 offen offset:0 sc1 lds
    buffer_load_dwordx4 v0, s[4:7], s60 offen offset:1024 sc1 lds
    buffer_load_dwordx4 v0, s[4:7], s60 offen offset:2048 sc1 lds
L_R3_kv2_7:
    s_branch L_R3_go_8
L_R3_kvretry_5:
    s_add_u32 s19, s19, 1
    s_cmp_ge_u32 s19, 524288
    s_cbranch_scc1 L_fail
    s_waitcnt vmcnt(0) lgkmcnt(0)
    buffer_load_dword v218, v217, s[4:7], s55 offen sc1
    s_waitcnt vmcnt(0)
    s_branch L_R3_kvchk_4
L_R3_go_8:
    s_add_u32 s60, s20, 1
    s_add_u32 s58, s60, 1
    s_cmp_gt_u32 s60, 63
    s_cselect_b32 s58, 0, s58
    s_sub_u32 s59, s60, 6
    s_cmp_lt_u32 s60, 7
    s_cselect_b32 s59, 0, s59
    v_mov_b32 v216, s58
    v_mov_b32 v218, s59
    v_cmp_gt_u32 vcc, 256, v0
    s_nop 1
    v_cndmask_b32 v216, v218, v216, vcc
    s_add_u32 s60, s20, 1
    s_and_b32 s22, s60, 1
    s_lshl_b32 s21, s22, 31
    s_sub_u32 s44, 0, s22
    s_bfe_u32 s23, s20, 0x10001
    s_sub_u32 s23, s23, 1
    s_lshr_b32 s24, s60, 1
    s_andn2_b32 s24, 1, s24
    s_lshl_b32 s61, s14, 15
    s_add_u32 s61, s61, 1179648
    s_and_b32 s25, s20, 1
    s_lshl_b32 s25, s25, 16
    s_add_u32 s25, s25, s61
    s_add_u32 s25, s25, 15360
    s_add_u32 s26, s25, 4096
    s_lshl_b32 s36, s22, 16
    s_add_u32 s36, s36, s61
    s_lshl_b32 s27, s20, 1
    s_add_u32 s37, s27, 2
    s_add_u32 s37, s37, s14
    s_mul_i32 s37, s37, 20480
    s_add_u32 s37, s37, 2621440
    s_add_u32 s27, s27, 1
    s_sub_u32 s27, s27, s14
    s_mul_i32 s27, s27, 20480
    s_add_u32 s27, s27, 2636800
    s_add_u32 s28, s27, 4096
    s_lshl_b32 s31, s20, 6
    s_add_u32 s31, s31, s13
    s_mul_i32 s31, s31, 6144
    s_add_u32 s31, s31, 5898240
    s_min_u32 s56, s20, 63
    s_lshl_b32 s56, s56, 6
    s_add_u32 s56, s56, s13
    s_mul_i32 s56, s56, 12288
    s_add_u32 s56, s56, 37364736
    s_max_u32 s57, s20, 7
    s_sub_u32 s57, s57, 7
    s_lshl_b32 s57, s57, 6
    s_add_u32 s57, s57, s13
    s_mul_i32 s57, s57, 12288
    s_add_u32 s57, s57, 87696384
    s_cmp_lt_u32 s20, 7
    s_cselect_b32 s57, s56, s57
    s_cmp_gt_u32 s60, 63
    s_cselect_b64 s[42:43], s[38:39], 0
    s_cmp_le_u32 s60, 7
    s_cselect_b64 vcc, s[40:41], 0
    s_or_b64 s[42:43], s[42:43], vcc
    s_cmp_lg_u32 s18, 0
    s_cbranch_scc1 L_R3_slow
L_Rf3_top:
    s_barrier
    buffer_load_dwordx4 v[10:13], v0, s[4:7], s25 offen offset:0 sc1
    buffer_load_dwordx4 v[14:17], v0, s[4:7], s25 offen offset:1024 sc1
    buffer_load_dwordx4 v[18:21], v0, s[4:7], s25 offen offset:2048 sc1
    buffer_load_dwordx4 v[22:25], v0, s[4:7], s25 offen offset:3072 sc1
    buffer_load_dwordx4 v[26:29], v0, s[4:7], s26 offen offset:0 sc1
    s_barrier
    buffer_load_dwordx4 v[46:49], v0, s[4:7], s27 offen offset:0 sc1
    buffer_load_dwordx4 v[30:33], v0, s[4:7], s27 offen offset:1024 sc1
    buffer_load_dwordx4 v[34:37], v0, s[4:7], s27 offen offset:2048 sc1
    buffer_load_dwordx4 v[38:41], v0, s[4:7], s27 offen offset:3072 sc1
    buffer_load_dwordx4 v[42:45], v0, s[4:7], s28 offen offset:0 sc1
    s_mov_b32 s19, 0
L_Rf3_gl_1:
    s_waitcnt vmcnt(9)
    v_mfma_f32_16x16x32_bf16 v[50:53], a[240:243], v[10:13], 0
    v_mfma_f32_16x16x32_bf16 v[54:57], a[244:247], v[10:13], 0
    v_xor_b32 v1, s23, v10
    s_waitcnt vmcnt(8)
    v_mfma_f32_16x16x32_bf16 v[58:61], a[240:243], v[14:17], 0
    v_mfma_f32_16x16x32_bf16 v[62:65], a[244:247], v[14:17], 0
    v_bitop3_b32 v1, v1, v14, s23 bitop3:0xf6
    s_waitcnt vmcnt(7)
    v_mfma_f32_16x16x32_bf16 v[66:69], a[240:243], v[18:21], 0
    v_mfma_f32_16x16x32_bf16 v[70:73], a[244:247], v[18:21], 0
    v_bitop3_b32 v1, v1, v18, s23 bitop3:0xf6
    s_waitcnt vmcnt(6)
    v_mfma_f32_16x16x32_bf16 v[74:77], a[240:243], v[22:25], 0
    v_mfma_f32_16x16x32_bf16 v[78:81], a[244:247], v[22:25], 0
    v_bitop3_b32 v1, v1, v22, s23 bitop3:0xf6
    s_waitcnt vmcnt(5)
    v_mfma_f32_16x16x32_bf16 v[82:85], a[240:243], v[26:29], 0
    v_mfma_f32_16x16x32_bf16 v[86:89], a[244:247], v[26:29], 0
    v_bitop3_b32 v1, v1, v26, s23 bitop3:0xf6
    v_and_b32 v1, 1, v1
    v_cmp_ne_u32 vcc, 0, v1
    s_nop 0
    s_cbranch_vccnz L_Rf3_glfix_3
L_Rf3_gr_2:
    s_waitcnt vmcnt(4)
    v_mfma_f32_16x16x32_bf16 v[50:53], a[240:243], v[46:49], v[50:53]
    v_xor_b32 v1, s23, v46
    v_mfma_f32_16x16x32_bf16 v[54:57], a[244:247], v[46:49], v[54:57]
    s_waitcnt vmcnt(3)
    v_mfma_f32_16x16x32_bf16 v[58:61], a[240:243], v[30:33], v[58:61]
    v_bitop3_b32 v1, v1, v30, s23 bitop3:0xf6
    v_mfma_f32_16x16x32_bf16 v[62:65], a[244:247], v[30:33], v[62:65]
    s_nop 1
    v_cvt_pk_bf16_f32 v90, v50, v51
    v_cvt_pk_bf16_f32 v91, v52, v53
    v_cvt_pk_bf16_f32 v92, v54, v55
    v_cvt_pk_bf16_f32 v93, v56, v57
    ds_write_b128 v0, v[90:93] offset:15360
    s_waitcnt vmcnt(2)
    v_mfma_f32_16x16x32_bf16 v[66:69], a[240:243], v[34:37], v[66:69]
    v_bitop3_b32 v1, v1, v34, s23 bitop3:0xf6
    v_mfma_f32_16x16x32_bf16 v[70:73], a[244:247], v[34:37], v[70:73]
    v_cvt_pk_bf16_f32 v90, v58, v59
    v_cvt_pk_bf16_f32 v91, v60, v61
    v_cvt_pk_bf16_f32 v92, v62, v63
    v_cvt_pk_bf16_f32 v93, v64, v65
    ds_write_b128 v0, v[90:93] offset:16384
    s_waitcnt vmcnt(1)
    v_mfma_f32_16x16x32_bf16 v[74:77], a[240:243], v[38:41], v[74:77]
    v_bitop3_b32 v1, v1, v38, s23 bitop3:0xf6
    v_mfma_f32_16x16x32_bf16 v[78:81], a[244:247], v[38:41], v[78:81]
    v_cvt_pk_bf16_f32 v90, v66, v67
    v_cvt_pk_bf16_f32 v91, v68, v69
    v_cvt_pk_bf16_f32 v92, v70, v71
    v_cvt_pk_bf16_f32 v93, v72, v73
    ds_write_b128 v0, v[90:93] offset:17408
    s_waitcnt vmcnt(0)
    v_mfma_f32_16x16x32_bf16 v[82:85], a[240:243], v[42:45], v[82:85]
    v_bitop3_b32 v1, v1, v42, s23 bitop3:0xf6
    v_mfma_f32_16x16x32_bf16 v[86:89], a[244:247], v[42:45], v[86:89]
    v_cvt_pk_bf16_f32 v90, v74, v75
    v_cvt_pk_bf16_f32 v91, v76, v77
    v_cvt_pk_bf16_f32 v92, v78, v79
    v_cvt_pk_bf16_f32 v93, v80, v81
    ds_write_b128 v0, v[90:93] offset:18432
    s_nop 0
    v_cvt_pk_bf16_f32 v90, v82, v83
    v_cvt_pk_bf16_f32 v91, v84, v85
    v_cvt_pk_bf16_f32 v92, v86, v87
    v_cvt_pk_bf16_f32 v93, v88, v89
    ds_write_b128 v0, v[90:93] offset:19456
    v_and_b32 v1, 1, v1
    v_cmp_ne_u32 vcc, 0, v1
    s_nop 0
    s_cbranch_vccnz L_Rf3_grfix_5
    s_waitcnt lgkmcnt(0)
    s_barrier
    ds_read_b128 v[10:13], v0 offset:0
    ds_read_b128 v[14:17], v0 offset:1024
    ds_read_b128 v[18:21], v0 offset:2048
    ds_read_b128 v[22:25], v0 offset:3072
    ds_read_b128 v[26:29], v0 offset:4096
    s_waitcnt lgkmcnt(4)
    v_mfma_f32_16x16x32_bf16 v[46:49], a[0:3], v[10:13], 0
    s_mov_b32 m0, 51200
    v_mfma_f32_16x16x32_bf16 v[50:53], a[80:83], v[10:13], 0
    buffer_load_dword v218, v217, s[4:7], s55 offen sc1
    v_mfma_f32_16x16x32_bf16 v[54:57], a[160:163], v[10:13], 0
    v_mov_b32 v1, s20
    s_mov_b64 exec, 1
    buffer_store_dword v1, v0, s[4:7], s54 offen sc1
    s_mov_b64 exec, -1
    ds_read_b128 v[10:13], v0 offset:5120
    s_waitcnt lgkmcnt(4)
    v_mfma_f32_16x16x32_bf16 v[46:49], a[4:7], v[14:17], v[46:49]
    buffer_load_dwordx4 v0, s[4:7], s57 offen offset:0 sc1 lds
    v_mfma_f32_16x16x32_bf16 v[50:53], a[84:87], v[14:17], v[50:53]
    v_mfma_f32_16x16x32_bf16 v[54:57], a[164:167], v[14:17], v[54:57]
    ds_read_b128 v[14:17], v0 offset:6144
    s_waitcnt lgkmcnt(4)
    v_mfma_f32_16x16x32_bf16 v[46:49], a[8:11], v[18:21], v[46:49]
    buffer_load_dwordx4 v0, s[4:7], s57 offen offset:1024 sc1 lds
    v_mfma_f32_16x16x32_bf16 v[50:53], a[88:91], v[18:21], v[50:53]
    v_mfma_f32_16x16x32_bf16 v[54:57], a[168:171], v[18:21], v[54:57]
    ds_read_b128 v[18:21], v0 offset:7168
    s_waitcnt lgkmcnt(4)
    v_mfma_f32_16x16x32_bf16 v[46:49], a[12:15], v[22:25], v[46:49]
    buffer_load_dwordx4 v0, s[4:7], s57 offen offset:2048 sc1 lds
    v_mfma_f32_16x16x32_bf16 v[50:53], a[92:95], v[22:25], v[50:53]
    v_mfma_f32_16x16x32_bf16 v[54:57], a[172:175], v[22:25], v[54:57]
    ds_read_b128 v[22:25], v0 offset:8192
    s_waitcnt lgkmcnt(4)
    v_mfma_f32_16x16x32_bf16 v[46:49], a[16:19], v[26:29], v[46:49]
    v_mfma_f32_16x16x32_bf16 v[50:53], a[96:99], v[26:29], v[50:53]
    v_mfma_f32_16x16x32_bf16 v[54:57], a[176:179], v[26:29], v[54:57]
    ds_read_b128 v[26:29], v0 offset:9216
    s_waitcnt lgkmcnt(4)
    v_mfma_f32_16x16x32_bf16 v[46:49], a[20:23], v[10:13], v[46:49]
    v_mfma_f32_16x16x32_bf16 v[50:53], a[100:103], v[10:13], v[50:53]
    v_mfma_f32_16x16x32_bf16 v[54:57], a[180:183], v[10:13], v[54:57]
    ds_read_b128 v[10:13], v0 offset:10240
    s_waitcnt lgkmcnt(4)
    v_mfma_f32_16x16x32_bf16 v[46:49], a[24:27], v[14:17], v[46:49]
    v_mfma_f32_16x16x32_bf16 v[50:53], a[104:107], v[14:17], v[50:53]
    v_mfma_f32_16x16x32_bf16 v[54:57], a[184:187], v[14:17], v[54:57]
    ds_read_b128 v[14:17], v0 offset:11264
    s_waitcnt lgkmcnt(4)
    v_mfma_f32_16x16x32_bf16 v[46:49], a[28:31], v[18:21], v[46:49]
    v_mfma_f32_16x16x32_bf16 v[50:53], a[108:111], v[18:21], v[50:53]
    v_mfma_f32_16x16x32_bf16 v[54:57], a[188:191], v[18:21], v[54:57]
    ds_read_b128 v[18:21], v0 offset:12288
    s_waitcnt lgkmcnt(4)
    v_mfma_f32_16x16x32_bf16 v[46:49], a[32:35], v[22:25], v[46:49]
    v_mfma_f32_16x16x32_bf16 v[50:53], a[112:115], v[22:25], v[50:53]
    v_mfma_f32_16x16x32_bf16 v[54:57], a[192:195], v[22:25], v[54:57]
    ds_read_b128 v[22:25], v0 offset:13312
    s_waitcnt lgkmcnt(4)
    v_mfma_f32_16x16x32_bf16 v[46:49], a[36:39], v[26:29], v[46:49]
    v_mfma_f32_16x16x32_bf16 v[50:53], a[116:119], v[26:29], v[50:53]
    v_mfma_f32_16x16x32_bf16 v[54:57], a[196:199], v[26:29], v[54:57]
    ds_read_b128 v[26:29], v0 offset:14336
    s_waitcnt lgkmcnt(4)
    v_mfma_f32_16x16x32_bf16 v[46:49], a[40:43], v[10:13], v[46:49]
    v_mfma_f32_16x16x32_bf16 v[50:53], a[120:123], v[10:13], v[50:53]
    v_mfma_f32_16x16x32_bf16 v[54:57], a[200:203], v[10:13], v[54:57]
    ds_read_b128 v[10:13], v0 offset:15360
    s_waitcnt lgkmcnt(4)
    v_mfma_f32_16x16x32_bf16 v[46:49], a[44:47], v[14:17], v[46:49]
    ds_read_b128 v[58:61], v0 offset:32768
    v_mfma_f32_16x16x32_bf16 v[50:53], a[124:127], v[14:17], v[50:53]
    v_mfma_f32_16x16x32_bf16 v[54:57], a[204:207], v[14:17], v[54:57]
    ds_read_b128 v[14:17], v0 offset:16384
    s_waitcnt lgkmcnt(5)
    v_mfma_f32_16x16x32_bf16 v[46:49], a[48:51], v[18:21], v[46:49]
    ds_read_b128 v[62:65], v0 offset:33792
    v_mfma_f32_16x16x32_bf16 v[50:53], a[128:131], v[18:21], v[50:53]
    v_mfma_f32_16x16x32_bf16 v[54:57], a[208:211], v[18:21], v[54:57]
    ds_read_b128 v[18:21], v0 offset:17408
    s_waitcnt lgkmcnt(6)
    v_mfma_f32_16x16x32_bf16 v[46:49], a[52:55], v[22:25], v[46:49]
    ds_read_b128 v[66:69], v0 offset:34816
    v_mfma_f32_16x16x32_bf16 v[50:53], a[132:135], v[22:25], v[50:53]
    v_mfma_f32_16x16x32_bf16 v[54:57], a[212:215], v[22:25], v[54:57]
    ds_read_b128 v[22:25], v0 offset:18432
    s_waitcnt lgkmcnt(7)
    v_mfma_f32_16x16x32_bf16 v[46:49], a[56:59], v[26:29], v[46:49]
    ds_read_b128 v[70:73], v0 offset:45056
    v_mfma_f32_16x16x32_bf16 v[50:53], a[136:139], v[26:29], v[50:53]
    v_mfma_f32_16x16x32_bf16 v[54:57], a[216:219], v[26:29], v[54:57]
    ds_read_b128 v[26:29], v0 offset:19456
    s_waitcnt lgkmcnt(8)
    v_mfma_f32_16x16x32_bf16 v[46:49], a[60:63], v[10:13], v[46:49]
    ds_read_b128 v[74:77], v0 offset:46080
    v_mfma_f32_16x16x32_bf16 v[50:53], a[140:143], v[10:13], v[50:53]
    v_mfma_f32_16x16x32_bf16 v[54:57], a[220:223], v[10:13], v[54:57]
    s_waitcnt lgkmcnt(7)
    v_mfma_f32_16x16x32_bf16 v[46:49], a[64:67], v[14:17], v[46:49]
    ds_read_b128 v[78:81], v0 offset:47104
    v_mfma_f32_16x16x32_bf16 v[50:53], a[144:147], v[14:17], v[50:53]
    v_mfma_f32_16x16x32_bf16 v[54:57], a[224:227], v[14:17], v[54:57]
    s_waitcnt lgkmcnt(6)
    v_mfma_f32_16x16x32_bf16 v[46:49], a[68:71], v[18:21], v[46:49]
    v_mfma_f32_16x16x32_bf16 v[50:53], a[148:151], v[18:21], v[50:53]
    v_mfma_f32_16x16x32_bf16 v[54:57], a[228:231], v[18:21], v[54:57]
    s_waitcnt lgkmcnt(4)
    v_mfma_f32_16x16x32_bf16 v[46:49], a[72:75], v[22:25], v[46:49]
    v_mfma_f32_16x16x32_bf16 v[50:53], a[152:155], v[22:25], v[50:53]
    v_mfma_f32_16x16x32_bf16 v[54:57], a[232:235], v[22:25], v[54:57]
    s_waitcnt lgkmcnt(2)
    v_mfma_f32_16x16x32_bf16 v[46:49], a[76:79], v[26:29], v[46:49]
    v_mfma_f32_16x16x32_bf16 v[50:53], a[156:159], v[26:29], v[50:53]
    v_mfma_f32_16x16x32_bf16 v[54:57], a[236:239], v[26:29], v[54:57]
    s_nop 5
    v_cvt_pk_bf16_f32 v82, v46, v47
    v_cvt_pk_bf16_f32 v83, v48, v49
    ds_write_b64 v0, v[82:83] offset:24584
    v_cvt_pk_bf16_f32 v84, v50, v51
    v_cvt_pk_bf16_f32 v85, v52, v53
    ds_write_b64 v0, v[84:85] offset:25600
    v_cvt_pk_bf16_f32 v86, v54, v55
    v_cvt_pk_bf16_f32 v87, v56, v57
    ds_write_b64 v0, v[86:87] offset:25608
    s_waitcnt lgkmcnt(0)
    s_barrier
    ds_read_b128 v[46:49], v0 offset:20480
    ds_read_b128 v[50:53], v0 offset:21504
    ds_read_b128 v[54:57], v0 offset:22528
    s_waitcnt lgkmcnt(2)
    v_mfma_f32_16x16x32_bf16 v[38:41], v[58:61], v[46:49], 0
    v_mfma_f32_16x16x32_bf16 v[42:45], v[70:73], v[46:49], 0
    s_waitcnt lgkmcnt(1)
    v_mfma_f32_16x16x32_bf16 v[38:41], v[62:65], v[50:53], v[38:41]
    v_mfma_f32_16x16x32_bf16 v[42:45], v[74:77], v[50:53], v[42:45]
    s_waitcnt lgkmcnt(0)
    v_mfma_f32_16x16x32_bf16 v[38:41], v[66:69], v[54:57], v[38:41]
    v_mfma_f32_16x16x32_bf16 v[42:45], v[78:81], v[54:57], v[42:45]
    s_nop 7
    v_cndmask_b32 v38, v42, v38, s[48:49]
    v_cndmask_b32 v39, v43, v39, s[48:49]
    v_cndmask_b32 v40, v44, v40, s[48:49]
    v_cndmask_b32 v41, v45, v41, s[48:49]
    v_and_or_b32 v38, v38, -2, s22
    buffer_store_dwordx4 v[38:41], v0, s[4:7], s29 offen
    v_pk_mul_f32 v[42:43], v[38:39], s[52:53]
    v_pk_mul_f32 v[44:45], v[40:41], s[52:53]
    s_waitcnt vmcnt(0)
    buffer_load_dwordx4 v[82:85], v0, s[4:7], s30 offen sc1
    s_mov_b32 s19, 0
    ds_read_b128 v[58:61], v0 offset:23552
    ds_read_b128 v[62:65], v0 offset:24576
    ds_read_b128 v[66:69], v0 offset:25600
    s_add_u32 s60, s31, 5120
    s_cmp_eq_u32 s20, 70
    s_cbranch_scc1 L_Rf3_tail
L_Rf3_ha_6:
    s_waitcnt vmcnt(0)
    v_lshlrev_b32 v1, 31, v82
    v_pk_fma_f32 v[38:39], v[82:83], s[52:53], v[42:43]
    v_pk_fma_f32 v[40:41], v[84:85], s[52:53], v[44:45]
    ds_write_b128 v0, v[38:41] offset:28672
    v_cmp_ne_u32 vcc, s21, v1
    s_nop 0
    s_cbranch_vccnz L_Rf3_hafix_7
    s_waitcnt vmcnt(0) lgkmcnt(0)
    s_barrier
    buffer_store_dwordx4 v[58:61], v0, s[4:7], s31 offen offset:0 sc1
    buffer_store_dwordx4 v[62:65], v0, s[4:7], s31 offen offset:1024 sc1
    buffer_store_dwordx4 v[66:69], v0, s[4:7], s31 offen offset:2048 sc1
    s_mov_b32 s19, 0
L_Rf3_kvchk_8:
    v_cmp_lt_u32 vcc, v218, v216
    s_and_b64 vcc, vcc, 0x0fff0fff
    s_cbranch_vccnz L_Rf3_kvretry_9
    s_cmp_eq_u32 s58, 0
    s_cbranch_scc1 L_Rf3_kv1_10
    s_sub_u32 s60, s58, 1
    s_lshl_b32 s60, s60, 6
    s_add_u32 s60, s60, s13
    s_mul_i32 s60, s60, 12288
    s_add_u32 s60, s60, 37355520
    s_mov_b32 m0, 29696
    s_nop 0
    buffer_load_dwordx4 v0, s[4:7], s60 offen offset:0 sc1 lds
    buffer_load_dwordx4 v0, s[4:7], s60 offen offset:1024 sc1 lds
    buffer_load_dwordx4 v0, s[4:7], s60 offen offset:2048 sc1 lds
    s_add_u32 s60, s60, 3072
    s_mov_b32 m0, 32768
    s_nop 0
    buffer_load_dwordx4 v0, s[4:7], s60 offen offset:0 sc1 lds
    buffer_load_dwordx4 v0, s[4:7], s60 offen offset:1024 sc1 lds
    buffer_load_dwordx4 v0, s[4:7], s60 offen offset:2048 sc1 lds
L_Rf3_kv1_10:
    s_cmp_eq_u32 s59, 0
    s_cbranch_scc1 L_Rf3_kv2_11
    s_sub_u32 s60, s59, 1
    s_lshl_b32 s60, s60, 6
    s_add_u32 s60, s60, s13
    s_mul_i32 s60, s60, 12288
    s_add_u32 s60, s60, 87687168
    s_mov_b32 m0, 41984
    s_nop 0
    buffer_load_dwordx4 v0, s[4:7], s60 offen offset:0 sc1 lds
    buffer_load_dwordx4 v0, s[4:7], s60 offen offset:1024 sc1 lds
    buffer_load_dwordx4 v0, s[4:7], s60 offen offset:2048 sc1 lds
    s_add_u32 s60, s60, 3072
    s_mov_b32 m0, 45056
    s_nop 0
    buffer_load_dwordx4 v0, s[4:7], s60 offen offset:0 sc1 lds
    buffer_load_dwordx4 v0, s[4:7], s60 offen offset:1024 sc1 lds
    buffer_load_dwordx4 v0, s[4:7], s60 offen offset:2048 sc1 lds
L_Rf3_kv2_11:
    s_barrier
    ds_read_b128 v[10:13], v0 offset:0
    ds_read_b128 v[14:17], v0 offset:1024
    ds_read_b128 v[18:21], v0 offset:2048
    s_add_u32 s20, s20, 1
    s_waitcnt lgkmcnt(2)
    v_mfma_f32_16x16x32_bf16 v[46:49], v[96:99], v[10:13], 0
    s_waitcnt lgkmcnt(1)
    v_mfma_f32_16x16x32_bf16 v[46:49], v[100:103], v[14:17], v[46:49]
    s_waitcnt lgkmcnt(0)
    v_mfma_f32_16x16x32_bf16 v[46:49], v[104:107], v[18:21], v[46:49]
    v_mfma_f32_16x16x32_bf16 v[50:53], v[108:111], v[10:13], 0
    v_mfma_f32_16x16x32_bf16 v[50:53], v[112:115], v[14:17], v[50:53]
    v_mfma_f32_16x16x32_bf16 v[50:53], v[116:119], v[18:21], v[50:53]
    v_mfma_f32_16x16x32_bf16 v[54:57], v[120:123], v[10:13], 0
    s_nop 3
    v_cvt_pk_bf16_f32 v62, v46, v47
    v_mfma_f32_16x16x32_bf16 v[54:57], v[124:127], v[14:17], v[54:57]
    v_cvt_pk_bf16_f32 v63, v48, v49
    v_and_or_b32 v62, v62, -2, s22
    v_mfma_f32_16x16x32_bf16 v[54:57], v[128:131], v[18:21], v[54:57]
    v_cvt_pk_bf16_f32 v64, v50, v51
    v_mfma_f32_16x16x32_bf16 v[58:61], v[132:135], v[10:13], 0
    v_cvt_pk_bf16_f32 v65, v52, v53
    v_mfma_f32_16x16x32_bf16 v[58:61], v[136:139], v[14:17], v[58:61]
    v_mfma_f32_16x16x32_bf16 v[58:61], v[140:143], v[18:21], v[58:61]
    v_mfma_f32_16x16x32_bf16 v[46:49], v[144:147], v[10:13], 0
    buffer_store_dwordx4 v[62:65], v3, s[4:7], s32 offen
    s_nop 0
    v_cvt_pk_bf16_f32 v66, v54, v55
    v_mfma_f32_16x16x32_bf16 v[46:49], v[148:151], v[14:17], v[46:49]
    v_cvt_pk_bf16_f32 v67, v56, v57
    v_and_or_b32 v66, v66, -2, s22
    v_mfma_f32_16x16x32_bf16 v[46:49], v[152:155], v[18:21], v[46:49]
    v_cvt_pk_bf16_f32 v68, v58, v59
    v_mfma_f32_16x16x32_bf16 v[50:53], v[156:159], v[10:13], 0
    v_cvt_pk_bf16_f32 v69, v60, v61
    v_mfma_f32_16x16x32_bf16 v[50:53], v[160:163], v[14:17], v[50:53]
    v_mfma_f32_16x16x32_bf16 v[50:53], v[164:167], v[18:21], v[50:53]
    v_mfma_f32_16x16x32_bf16 v[54:57], v[168:171], v[10:13], 0
    buffer_store_dwordx4 v[66:69], v4, s[4:7], s32 offen
    s_nop 0
    v_cvt_pk_bf16_f32 v62, v46, v47
    v_mfma_f32_16x16x32_bf16 v[54:57], v[172:175], v[14:17], v[54:57]
    v_cvt_pk_bf16_f32 v63, v48, v49
    v_and_or_b32 v62, v62, -2, s22
    v_mfma_f32_16x16x32_bf16 v[54:57], v[176:179], v[18:21], v[54:57]
    v_cvt_pk_bf16_f32 v64, v50, v51
    v_mfma_f32_16x16x32_bf16 v[58:61], v[180:183], v[10:13], 0
    v_cvt_pk_bf16_f32 v65, v52, v53
    v_mfma_f32_16x16x32_bf16 v[58:61], v[184:187], v[14:17], v[58:61]
    v_mfma_f32_16x16x32_bf16 v[58:61], v[188:191], v[18:21], v[58:61]
    v_mfma_f32_16x16x32_bf16 v[46:49], v[192:195], v[10:13], 0
    buffer_store_dwordx4 v[62:65], v5, s[4:7], s32 offen
    s_nop 0
    v_cvt_pk_bf16_f32 v66, v54, v55
    v_mfma_f32_16x16x32_bf16 v[46:49], v[196:199], v[14:17], v[46:49]
    v_cvt_pk_bf16_f32 v67, v56, v57
    v_and_or_b32 v66, v66, -2, s22
    v_mfma_f32_16x16x32_bf16 v[46:49], v[200:203], v[18:21], v[46:49]
    v_cvt_pk_bf16_f32 v68, v58, v59
    v_mfma_f32_16x16x32_bf16 v[50:53], v[204:207], v[10:13], 0
    v_cvt_pk_bf16_f32 v69, v60, v61
    v_mfma_f32_16x16x32_bf16 v[50:53], v[208:211], v[14:17], v[50:53]
    v_mfma_f32_16x16x32_bf16 v[50:53], v[212:215], v[18:21], v[50:53]
    buffer_store_dwordx4 v[66:69], v6, s[4:7], s32 offen
    s_nop 1
    v_cvt_pk_bf16_f32 v62, v46, v47
    v_cvt_pk_bf16_f32 v63, v48, v49
    v_and_or_b32 v62, v62, -2, s22
    s_nop 1
    v_cvt_pk_bf16_f32 v64, v50, v51
    v_cvt_pk_bf16_f32 v65, v52, v53
    buffer_store_dwordx4 v[62:65], v7, s[4:7], s32 offen
    s_add_u32 s60, s20, 1
    s_and_b32 s22, s60, 1
    s_lshl_b32 s21, s22, 31
    s_sub_u32 s44, 0, s22
    s_bfe_u32 s23, s20, 0x10001
    s_sub_u32 s23, s23, 1
    s_lshr_b32 s24, s60, 1
    s_andn2_b32 s24, 1, s24
    s_lshl_b32 s61, s14, 15
    s_add_u32 s61, s61, 1179648
    s_and_b32 s25, s20, 1
    s_lshl_b32 s25, s25, 16
    s_add_u32 s25, s25, s61
    s_add_u32 s25, s25, 15360
    s_add_u32 s26, s25, 4096
    s_lshl_b32 s36, s22, 16
    s_add_u32 s36, s36, s61
    s_lshl_b32 s27, s20, 1
    s_add_u32 s37, s27, 2
    s_add_u32 s37, s37, s14
    s_mul_i32 s37, s37, 20480
    s_add_u32 s37, s37, 2621440
    s_add_u32 s27, s27, 1
    s_sub_u32 s27, s27, s14
    s_mul_i32 s27, s27, 20480
    s_add_u32 s27, s27, 2636800
    s_add_u32 s28, s27, 4096
    s_lshl_b32 s31, s20, 6
    s_add_u32 s31, s31, s13
    s_mul_i32 s31, s31, 6144
    s_add_u32 s31, s31, 5898240
    s_min_u32 s56, s20, 63
    s_lshl_b32 s56, s56, 6
    s_add_u32 s56, s56, s13
    s_mul_i32 s56, s56, 12288
    s_add_u32 s56, s56, 37364736
    s_max_u32 s57, s20, 7
    s_sub_u32 s57, s57, 7
    s_lshl_b32 s57, s57, 6
    s_add_u32 s57, s57, s13
    s_mul_i32 s57, s57, 12288
    s_add_u32 s57, s57, 87696384
    s_cmp_lt_u32 s20, 7
    s_cselect_b32 s57, s56, s57
    s_cmp_gt_u32 s60, 63
    s_cselect_b64 s[42:43], s[38:39], 0
    s_cmp_le_u32 s60, 7
    s_cselect_b64 vcc, s[40:41], 0
    s_or_b64 s[42:43], s[42:43], vcc
    s_add_u32 s60, s20, 1
    s_add_u32 s58, s60, 1
    s_cmp_gt_u32 s60, 63
    s_cselect_b32 s58, 0, s58
    s_sub_u32 s59, s60, 6
    s_cmp_lt_u32 s60, 7
    s_cselect_b32 s59, 0, s59
    v_mov_b32 v216, s58
    v_mov_b32 v218, s59
    v_cmp_gt_u32 vcc, 256, v0
    s_nop 1
    v_cndmask_b32 v216, v218, v216, vcc
    s_branch L_Rf3_top
L_Rf3_tail:
    s_waitcnt lgkmcnt(0)
    buffer_store_dwordx4 v[58:61], v0, s[4:7], s31 offen offset:0 sc1
    buffer_store_dwordx4 v[62:65], v0, s[4:7], s31 offen offset:1024 sc1
    buffer_store_dwordx4 v[66:69], v0, s[4:7], s31 offen offset:2048 sc1
    s_waitcnt vmcnt(0) lgkmcnt(0)
    s_barrier
    v_mov_b32 v22, 71
    s_mov_b64 exec, 1
    buffer_store_dword v22, v0, s[4:7], s54 offen sc1
    s_mov_b64 exec, -1
    s_waitcnt vmcnt(0)
    s_endpgm
L_Rf3_glfix_3:
    buffer_load_dwordx4 v[10:13], v0, s[4:7], s25 offen offset:0 sc1
    buffer_load_dwordx4 v[14:17], v0, s[4:7], s25 offen offset:1024 sc1
    buffer_load_dwordx4 v[18:21], v0, s[4:7], s25 offen offset:2048 sc1
    buffer_load_dwordx4 v[22:25], v0, s[4:7], s25 offen offset:3072 sc1
    buffer_load_dwordx4 v[26:29], v0, s[4:7], s26 offen offset:0 sc1
    buffer_load_dwordx4 v[46:49], v0, s[4:7], s27 offen offset:0 sc1
    buffer_load_dwordx4 v[30:33], v0, s[4:7], s27 offen offset:1024 sc1
    buffer_load_dwordx4 v[34:37], v0, s[4:7], s27 offen offset:2048 sc1
    buffer_load_dwordx4 v[38:41], v0, s[4:7], s27 offen offset:3072 sc1
    buffer_load_dwordx4 v[42:45], v0, s[4:7], s28 offen offset:0 sc1
    s_add_u32 s19, s19, 1
    s_cmp_lt_u32 s19, 524288
    s_cbranch_scc1 L_Rf3_gl_1
    s_branch L_fail
L_Rf3_grfix_5:
    buffer_load_dwordx4 v[46:49], v0, s[4:7], s27 offen offset:0 sc1
    buffer_load_dwordx4 v[30:33], v0, s[4:7], s27 offen offset:1024 sc1
    buffer_load_dwordx4 v[34:37], v0, s[4:7], s27 offen offset:2048 sc1
    buffer_load_dwordx4 v[38:41], v0, s[4:7], s27 offen offset:3072 sc1
    buffer_load_dwordx4 v[42:45], v0, s[4:7], s28 offen offset:0 sc1
    s_add_u32 s19, s19, 1
    s_cmp_lt_u32 s19, 524288
    s_cbranch_scc1 L_Rf3_gr2_4
    s_branch L_fail
L_Rf3_gr2_4:
    v_mfma_f32_16x16x32_bf16 v[50:53], a[240:243], v[10:13], 0
    v_mfma_f32_16x16x32_bf16 v[54:57], a[244:247], v[10:13], 0
    v_mfma_f32_16x16x32_bf16 v[58:61], a[240:243], v[14:17], 0
    v_mfma_f32_16x16x32_bf16 v[62:65], a[244:247], v[14:17], 0
    v_mfma_f32_16x16x32_bf16 v[66:69], a[240:243], v[18:21], 0
    v_mfma_f32_16x16x32_bf16 v[70:73], a[244:247], v[18:21], 0
    v_mfma_f32_16x16x32_bf16 v[74:77], a[240:243], v[22:25], 0
    v_mfma_f32_16x16x32_bf16 v[78:81], a[244:247], v[22:25], 0
    v_mfma_f32_16x16x32_bf16 v[82:85], a[240:243], v[26:29], 0
    v_mfma_f32_16x16x32_bf16 v[86:89], a[244:247], v[26:29], 0
    s_branch L_Rf3_gr_2
L_Rf3_hafix_7:
    buffer_load_dwordx4 v[82:85], v0, s[4:7], s30 offen sc1
    s_add_u32 s19, s19, 1
    s_cmp_lt_u32 s19, 524288
    s_cbranch_scc1 L_Rf3_ha_6
    s_branch L_fail
L_Rf3_kvretry_9:
    s_add_u32 s19, s19, 1
    s_cmp_ge_u32 s19, 524288
    s_cbranch_scc1 L_fail
    s_waitcnt vmcnt(0) lgkmcnt(0)
    buffer_load_dword v218, v217, s[4:7], s55 offen sc1
    s_waitcnt vmcnt(0)
    s_branch L_Rf3_kvchk_8
L_R3_slow:
L_Rs3_top:
    s_barrier
    buffer_load_dwordx4 v[10:13], v0, s[4:7], s25 offen offset:0 sc1
    buffer_load_dwordx4 v[14:17], v0, s[4:7], s25 offen offset:1024 sc1
    buffer_load_dwordx4 v[18:21], v0, s[4:7], s25 offen offset:2048 sc1
    buffer_load_dwordx4 v[22:25], v0, s[4:7], s25 offen offset:3072 sc1
    buffer_load_dwordx4 v[26:29], v0, s[4:7], s26 offen offset:0 sc1
    s_barrier
    buffer_load_dwordx4 v[46:49], v0, s[4:7], s27 offen offset:0 sc1
    buffer_load_dwordx4 v[30:33], v0, s[4:7], s27 offen offset:1024 sc1
    buffer_load_dwordx4 v[34:37], v0, s[4:7], s27 offen offset:2048 sc1
    buffer_load_dwordx4 v[38:41], v0, s[4:7], s27 offen offset:3072 sc1
    buffer_load_dwordx4 v[42:45], v0, s[4:7], s28 offen offset:0 sc1
    s_mov_b32 s19, 0
L_Rs3_gl_1:
    s_waitcnt vmcnt(9)
    v_mfma_f32_16x16x32_bf16 v[50:53], a[240:243], v[10:13], 0
    v_mfma_f32_16x16x32_bf16 v[54:57], a[244:247], v[10:13], 0
    v_xor_b32 v1, s23, v10
    s_waitcnt vmcnt(8)
    v_mfma_f32_16x16x32_bf16 v[58:61], a[240:243], v[14:17], 0
    v_mfma_f32_16x16x32_bf16 v[62:65], a[244:247], v[14:17], 0
    v_bitop3_b32 v1, v1, v14, s23 bitop3:0xf6
    s_waitcnt vmcnt(7)
    v_mfma_f32_16x16x32_bf16 v[66:69], a[240:243], v[18:21], 0
    v_mfma_f32_16x16x32_bf16 v[70:73], a[244:247], v[18:21], 0
    v_bitop3_b32 v1, v1, v18, s23 bitop3:0xf6
    s_waitcnt vmcnt(6)
    v_mfma_f32_16x16x32_bf16 v[74:77], a[240:243], v[22:25], 0
    v_mfma_f32_16x16x32_bf16 v[78:81], a[244:247], v[22:25], 0
    v_bitop3_b32 v1, v1, v22, s23 bitop3:0xf6
    s_waitcnt vmcnt(5)
    v_mfma_f32_16x16x32_bf16 v[82:85], a[240:243], v[26:29], 0
    v_mfma_f32_16x16x32_bf16 v[86:89], a[244:247], v[26:29], 0
    v_bitop3_b32 v1, v1, v26, s23 bitop3:0xf6
    v_and_b32 v1, 1, v1
    v_cmp_ne_u32 vcc, 0, v1
    s_nop 0
    s_cbranch_vccnz L_Rs3_glfix_3
L_Rs3_gr_2:
    s_waitcnt vmcnt(4)
    v_mfma_f32_16x16x32_bf16 v[50:53], a[240:243], v[46:49], v[50:53]
    v_xor_b32 v1, s23, v46
    v_mfma_f32_16x16x32_bf16 v[54:57], a[244:247], v[46:49], v[54:57]
    s_waitcnt vmcnt(3)
    v_mfma_f32_16x16x32_bf16 v[58:61], a[240:243], v[30:33], v[58:61]
    v_bitop3_b32 v1, v1, v30, s23 bitop3:0xf6
    v_mfma_f32_16x16x32_bf16 v[62:65], a[244:247], v[30:33], v[62:65]
    s_nop 1
    v_cvt_pk_bf16_f32 v90, v50, v51
    v_cvt_pk_bf16_f32 v91, v52, v53
    v_cvt_pk_bf16_f32 v92, v54, v55
    v_cvt_pk_bf16_f32 v93, v56, v57
    ds_write_b128 v0, v[90:93] offset:15360
    s_waitcnt vmcnt(2)
    v_mfma_f32_16x16x32_bf16 v[66:69], a[240:243], v[34:37], v[66:69]
    v_bitop3_b32 v1, v1, v34, s23 bitop3:0xf6
    v_mfma_f32_16x16x32_bf16 v[70:73], a[244:247], v[34:37], v[70:73]
    v_cvt_pk_bf16_f32 v90, v58, v59
    v_cvt_pk_bf16_f32 v91, v60, v61
    v_cvt_pk_bf16_f32 v92, v62, v63
    v_cvt_pk_bf16_f32 v93, v64, v65
    ds_write_b128 v0, v[90:93] offset:16384
    s_waitcnt vmcnt(1)
    v_mfma_f32_16x16x32_bf16 v[74:77], a[240:243], v[38:41], v[74:77]
    v_bitop3_b32 v1, v1, v38, s23 bitop3:0xf6
    v_mfma_f32_16x16x32_bf16 v[78:81], a[244:247], v[38:41], v[78:81]
    v_cvt_pk_bf16_f32 v90, v66, v67
    v_cvt_pk_bf16_f32 v91, v68, v69
    v_cvt_pk_bf16_f32 v92, v70, v71
    v_cvt_pk_bf16_f32 v93, v72, v73
    ds_write_b128 v0, v[90:93] offset:17408
    s_waitcnt vmcnt(0)
    v_mfma_f32_16x16x32_bf16 v[82:85], a[240:243], v[42:45], v[82:85]
    v_bitop3_b32 v1, v1, v42, s23 bitop3:0xf6
    v_mfma_f32_16x16x32_bf16 v[86:89], a[244:247], v[42:45], v[86:89]
    v_cvt_pk_bf16_f32 v90, v74, v75
    v_cvt_pk_bf16_f32 v91, v76, v77
    v_cvt_pk_bf16_f32 v92, v78, v79
    v_cvt_pk_bf16_f32 v93, v80, v81
    ds_write_b128 v0, v[90:93] offset:18432
    s_nop 0
    v_cvt_pk_bf16_f32 v90, v82, v83
    v_cvt_pk_bf16_f32 v91, v84, v85
    v_cvt_pk_bf16_f32 v92, v86, v87
    v_cvt_pk_bf16_f32 v93, v88, v89
    ds_write_b128 v0, v[90:93] offset:19456
    v_and_b32 v1, 1, v1
    v_cmp_ne_u32 vcc, 0, v1
    s_nop 0
    s_cbranch_vccnz L_Rs3_grfix_5
    s_waitcnt lgkmcnt(0)
    s_barrier
    ds_read_b128 v[10:13], v0 offset:0
    ds_read_b128 v[14:17], v0 offset:1024
    ds_read_b128 v[18:21], v0 offset:2048
    ds_read_b128 v[22:25], v0 offset:3072
    ds_read_b128 v[26:29], v0 offset:4096
    s_waitcnt lgkmcnt(4)
    v_mfma_f32_16x16x32_bf16 v[46:49], a[0:3], v[10:13], 0
    s_mov_b32 m0, 51200
    v_mfma_f32_16x16x32_bf16 v[50:53], a[80:83], v[10:13], 0
    buffer_load_dword v218, v217, s[4:7], s55 offen sc1
    v_mfma_f32_16x16x32_bf16 v[54:57], a[160:163], v[10:13], 0
    v_mov_b32 v1, s20
    s_mov_b64 exec, 1
    buffer_store_dword v1, v0, s[4:7], s54 offen sc1
    s_mov_b64 exec, -1
    ds_read_b128 v[10:13], v0 offset:5120
    s_waitcnt lgkmcnt(4)
    v_mfma_f32_16x16x32_bf16 v[46:49], a[4:7], v[14:17], v[46:49]
    buffer_load_dwordx4 v0, s[4:7], s57 offen offset:0 sc1 lds
    v_mfma_f32_16x16x32_bf16 v[50:53], a[84:87], v[14:17], v[50:53]
    v_mfma_f32_16x16x32_bf16 v[54:57], a[164:167], v[14:17], v[54:57]
    ds_read_b128 v[14:17], v0 offset:6144
    s_waitcnt lgkmcnt(4)
    v_mfma_f32_16x16x32_bf16 v[46:49], a[8:11], v[18:21], v[46:49]
    buffer_load_dwordx4 v0, s[4:7], s57 offen offset:1024 sc1 lds
    v_mfma_f32_16x16x32_bf16 v[50:53], a[88:91], v[18:21], v[50:53]
    v_mfma_f32_16x16x32_bf16 v[54:57], a[168:171], v[18:21], v[54:57]
    ds_read_b128 v[18:21], v0 offset:7168
    s_waitcnt lgkmcnt(4)
    v_mfma_f32_16x16x32_bf16 v[46:49], a[12:15], v[22:25], v[46:49]
    buffer_load_dwordx4 v0, s[4:7], s57 offen offset:2048 sc1 lds
    v_mfma_f32_16x16x32_bf16 v[50:53], a[92:95], v[22:25], v[50:53]
    v_mfma_f32_16x16x32_bf16 v[54:57], a[172:175], v[22:25], v[54:57]
    ds_read_b128 v[22:25], v0 offset:8192
    s_waitcnt lgkmcnt(4)
    v_mfma_f32_16x16x32_bf16 v[46:49], a[16:19], v[26:29], v[46:49]
    v_mfma_f32_16x16x32_bf16 v[50:53], a[96:99], v[26:29], v[50:53]
    v_mfma_f32_16x16x32_bf16 v[54:57], a[176:179], v[26:29], v[54:57]
    ds_read_b128 v[26:29], v0 offset:9216
    s_waitcnt lgkmcnt(4)
    v_mfma_f32_16x16x32_bf16 v[46:49], a[20:23], v[10:13], v[46:49]
    v_mfma_f32_16x16x32_bf16 v[50:53], a[100:103], v[10:13], v[50:53]
    v_mfma_f32_16x16x32_bf16 v[54:57], a[180:183], v[10:13], v[54:57]
    ds_read_b128 v[10:13], v0 offset:10240
    s_waitcnt lgkmcnt(4)
    v_mfma_f32_16x16x32_bf16 v[46:49], a[24:27], v[14:17], v[46:49]
    v_mfma_f32_16x16x32_bf16 v[50:53], a[104:107], v[14:17], v[50:53]
    v_mfma_f32_16x16x32_bf16 v[54:57], a[184:187], v[14:17], v[54:57]
    ds_read_b128 v[14:17], v0 offset:11264
    s_waitcnt lgkmcnt(4)
    v_mfma_f32_16x16x32_bf16 v[46:49], a[28:31], v[18:21], v[46:49]
    v_mfma_f32_16x16x32_bf16 v[50:53], a[108:111], v[18:21], v[50:53]
    v_mfma_f32_16x16x32_bf16 v[54:57], a[188:191], v[18:21], v[54:57]
    ds_read_b128 v[18:21], v0 offset:12288
    s_waitcnt lgkmcnt(4)
    v_mfma_f32_16x16x32_bf16 v[46:49], a[32:35], v[22:25], v[46:49]
    v_mfma_f32_16x16x32_bf16 v[50:53], a[112:115], v[22:25], v[50:53]
    v_mfma_f32_16x16x32_bf16 v[54:57], a[192:195], v[22:25], v[54:57]
    ds_read_b128 v[22:25], v0 offset:13312
    s_waitcnt lgkmcnt(4)
    v_mfma_f32_16x16x32_bf16 v[46:49], a[36:39], v[26:29], v[46:49]
    v_mfma_f32_16x16x32_bf16 v[50:53], a[116:119], v[26:29], v[50:53]
    v_mfma_f32_16x16x32_bf16 v[54:57], a[196:199], v[26:29], v[54:57]
    ds_read_b128 v[26:29], v0 offset:14336
    s_waitcnt lgkmcnt(4)
    v_mfma_f32_16x16x32_bf16 v[46:49], a[40:43], v[10:13], v[46:49]
    v_mfma_f32_16x16x32_bf16 v[50:53], a[120:123], v[10:13], v[50:53]
    v_mfma_f32_16x16x32_bf16 v[54:57], a[200:203], v[10:13], v[54:57]
    ds_read_b128 v[10:13], v0 offset:15360
    s_waitcnt lgkmcnt(4)
    v_mfma_f32_16x16x32_bf16 v[46:49], a[44:47], v[14:17], v[46:49]
    ds_read_b128 v[58:61], v0 offset:32768
    v_mfma_f32_16x16x32_bf16 v[50:53], a[124:127], v[14:17], v[50:53]
    v_mfma_f32_16x16x32_bf16 v[54:57], a[204:207], v[14:17], v[54:57]
    ds_read_b128 v[14:17], v0 offset:16384
    s_waitcnt lgkmcnt(5)
    v_mfma_f32_16x16x32_bf16 v[46:49], a[48:51], v[18:21], v[46:49]
    ds_read_b128 v[62:65], v0 offset:33792
    v_mfma_f32_16x16x32_bf16 v[50:53], a[128:131], v[18:21], v[50:53]
    v_mfma_f32_16x16x32_bf16 v[54:57], a[208:211], v[18:21], v[54:57]
    ds_read_b128 v[18:21], v0 offset:17408
    s_waitcnt lgkmcnt(6)
    v_mfma_f32_16x16x32_bf16 v[46:49], a[52:55], v[22:25], v[46:49]
    ds_read_b128 v[66:69], v0 offset:34816
    v_mfma_f32_16x16x32_bf16 v[50:53], a[132:135], v[22:25], v[50:53]
    v_mfma_f32_16x16x32_bf16 v[54:57], a[212:215], v[22:25], v[54:57]
    ds_read_b128 v[22:25], v0 offset:18432
    s_waitcnt lgkmcnt(7)
    v_mfma_f32_16x16x32_bf16 v[46:49], a[56:59], v[26:29], v[46:49]
    ds_read_b128 v[70:73], v0 offset:45056
    v_mfma_f32_16x16x32_bf16 v[50:53], a[136:139], v[26:29], v[50:53]
    v_mfma_f32_16x16x32_bf16 v[54:57], a[216:219], v[26:29], v[54:57]
    ds_read_b128 v[26:29], v0 offset:19456
    s_waitcnt lgkmcnt(8)
    v_mfma_f32_16x16x32_bf16 v[46:49], a[60:63], v[10:13], v[46:49]
    ds_read_b128 v[74:77], v0 offset:46080
    v_mfma_f32_16x16x32_bf16 v[50:53], a[140:143], v[10:13], v[50:53]
    v_mfma_f32_16x16x32_bf16 v[54:57], a[220:223], v[10:13], v[54:57]
    s_waitcnt lgkmcnt(7)
    v_mfma_f32_16x16x32_bf16 v[46:49], a[64:67], v[14:17], v[46:49]
    ds_read_b128 v[78:81], v0 offset:47104
    v_mfma_f32_16x16x32_bf16 v[50:53], a[144:147], v[14:17], v[50:53]
    v_mfma_f32_16x16x32_bf16 v[54:57], a[224:227], v[14:17], v[54:57]
    s_waitcnt lgkmcnt(6)
    v_mfma_f32_16x16x32_bf16 v[46:49], a[68:71], v[18:21], v[46:49]
    v_mfma_f32_16x16x32_bf16 v[50:53], a[148:151], v[18:21], v[50:53]
    v_mfma_f32_16x16x32_bf16 v[54:57], a[228:231], v[18:21], v[54:57]
    s_waitcnt lgkmcnt(4)
    v_mfma_f32_16x16x32_bf16 v[46:49], a[72:75], v[22:25], v[46:49]
    v_mfma_f32_16x16x32_bf16 v[50:53], a[152:155], v[22:25], v[50:53]
    v_mfma_f32_16x16x32_bf16 v[54:57], a[232:235], v[22:25], v[54:57]
    s_waitcnt lgkmcnt(2)
    v_mfma_f32_16x16x32_bf16 v[46:49], a[76:79], v[26:29], v[46:49]
    v_mfma_f32_16x16x32_bf16 v[50:53], a[156:159], v[26:29], v[50:53]
    v_mfma_f32_16x16x32_bf16 v[54:57], a[236:239], v[26:29], v[54:57]
    s_nop 5
    v_cvt_pk_bf16_f32 v82, v46, v47
    v_cvt_pk_bf16_f32 v83, v48, v49
    ds_write_b64 v0, v[82:83] offset:24584
    v_cvt_pk_bf16_f32 v84, v50, v51
    v_cvt_pk_bf16_f32 v85, v52, v53
    ds_write_b64 v0, v[84:85] offset:25600
    v_cvt_pk_bf16_f32 v86, v54, v55
    v_cvt_pk_bf16_f32 v87, v56, v57
    ds_write_b64 v0, v[86:87] offset:25608
    s_waitcnt lgkmcnt(0)
    s_barrier
    ds_read_b128 v[46:49], v0 offset:20480
    ds_read_b128 v[50:53], v0 offset:21504
    ds_read_b128 v[54:57], v0 offset:22528
    s_waitcnt lgkmcnt(2)
    v_mfma_f32_16x16x32_bf16 v[38:41], v[58:61], v[46:49], 0
    v_mfma_f32_16x16x32_bf16 v[42:45], v[70:73], v[46:49], 0
    s_waitcnt lgkmcnt(1)
    v_mfma_f32_16x16x32_bf16 v[38:41], v[62:65], v[50:53], v[38:41]
    v_mfma_f32_16x16x32_bf16 v[42:45], v[74:77], v[50:53], v[42:45]
    s_waitcnt lgkmcnt(0)
    v_mfma_f32_16x16x32_bf16 v[38:41], v[66:69], v[54:57], v[38:41]
    v_mfma_f32_16x16x32_bf16 v[42:45], v[78:81], v[54:57], v[42:45]
    s_nop 7
    v_cndmask_b32 v38, v42, v38, s[48:49]
    v_cndmask_b32 v39, v43, v39, s[48:49]
    v_cndmask_b32 v40, v44, v40, s[48:49]
    v_cndmask_b32 v41, v45, v41, s[48:49]
    v_and_or_b32 v38, v38, -2, s22
    buffer_store_dwordx4 v[38:41], v0, s[4:7], s29 offen sc1
    v_pk_mul_f32 v[42:43], v[38:39], s[52:53]
    v_pk_mul_f32 v[44:45], v[40:41], s[52:53]
    s_waitcnt vmcnt(0)
    buffer_load_dwordx4 v[82:85], v0, s[4:7], s30 offen sc1
    s_mov_b32 s19, 0
    ds_read_b128 v[58:61], v0 offset:23552
    ds_read_b128 v[62:65], v0 offset:24576
    ds_read_b128 v[66:69], v0 offset:25600
    s_add_u32 s60, s31, 5120
    s_cmp_eq_u32 s20, 70
    s_cbranch_scc1 L_Rs3_tail
L_Rs3_ha_6:
    s_waitcnt vmcnt(0)
    v_lshlrev_b32 v1, 31, v82
    v_pk_fma_f32 v[38:39], v[82:83], s[52:53], v[42:43]
    v_pk_fma_f32 v[40:41], v[84:85], s[52:53], v[44:45]
    ds_write_b128 v0, v[38:41] offset:28672
    v_cmp_ne_u32 vcc, s21, v1
    s_nop 0
    s_cbranch_vccnz L_Rs3_hafix_7
    s_waitcnt vmcnt(0) lgkmcnt(0)
    s_barrier
    buffer_store_dwordx4 v[58:61], v0, s[4:7], s31 offen offset:0 sc1
    buffer_store_dwordx4 v[62:65], v0, s[4:7], s31 offen offset:1024 sc1
    buffer_store_dwordx4 v[66:69], v0, s[4:7], s31 offen offset:2048 sc1
    s_mov_b32 s19, 0
L_Rs3_kvchk_8:
    v_cmp_lt_u32 vcc, v218, v216
    s_and_b64 vcc, vcc, 0x0fff0fff
    s_cbranch_vccnz L_Rs3_kvretry_9
    s_cmp_eq_u32 s58, 0
    s_cbranch_scc1 L_Rs3_kv1_10
    s_sub_u32 s60, s58, 1
    s_lshl_b32 s60, s60, 6
    s_add_u32 s60, s60, s13
    s_mul_i32 s60, s60, 12288
    s_add_u32 s60, s60, 37355520
    s_mov_b32 m0, 29696
    s_nop 0
    buffer_load_dwordx4 v0, s[4:7], s60 offen offset:0 sc1 lds
    buffer_load_dwordx4 v0, s[4:7], s60 offen offset:1024 sc1 lds
    buffer_load_dwordx4 v0, s[4:7], s60 offen offset:2048 sc1 lds
    s_add_u32 s60, s60, 3072
    s_mov_b32 m0, 32768
    s_nop 0
    buffer_load_dwordx4 v0, s[4:7], s60 offen offset:0 sc1 lds
    buffer_load_dwordx4 v0, s[4:7], s60 offen offset:1024 sc1 lds
    buffer_load_dwordx4 v0, s[4:7], s60 offen offset:2048 sc1 lds
L_Rs3_kv1_10:
    s_cmp_eq_u32 s59, 0
    s_cbranch_scc1 L_Rs3_kv2_11
    s_sub_u32 s60, s59, 1
    s_lshl_b32 s60, s60, 6
    s_add_u32 s60, s60, s13
    s_mul_i32 s60, s60, 12288
    s_add_u32 s60, s60, 87687168
    s_mov_b32 m0, 41984
    s_nop 0
    buffer_load_dwordx4 v0, s[4:7], s60 offen offset:0 sc1 lds
    buffer_load_dwordx4 v0, s[4:7], s60 offen offset:1024 sc1 lds
    buffer_load_dwordx4 v0, s[4:7], s60 offen offset:2048 sc1 lds
    s_add_u32 s60, s60, 3072
    s_mov_b32 m0, 45056
    s_nop 0
    buffer_load_dwordx4 v0, s[4:7], s60 offen offset:0 sc1 lds
    buffer_load_dwordx4 v0, s[4:7], s60 offen offset:1024 sc1 lds
    buffer_load_dwordx4 v0, s[4:7], s60 offen offset:2048 sc1 lds
L_Rs3_kv2_11:
    s_barrier
    ds_read_b128 v[10:13], v0 offset:0
    ds_read_b128 v[14:17], v0 offset:1024
    ds_read_b128 v[18:21], v0 offset:2048
    s_add_u32 s20, s20, 1
    s_waitcnt lgkmcnt(2)
    v_mfma_f32_16x16x32_bf16 v[46:49], v[96:99], v[10:13], 0
    s_waitcnt lgkmcnt(1)
    v_mfma_f32_16x16x32_bf16 v[46:49], v[100:103], v[14:17], v[46:49]
    s_waitcnt lgkmcnt(0)
    v_mfma_f32_16x16x32_bf16 v[46:49], v[104:107], v[18:21], v[46:49]
    v_mfma_f32_16x16x32_bf16 v[50:53], v[108:111], v[10:13], 0
    v_mfma_f32_16x16x32_bf16 v[50:53], v[112:115], v[14:17], v[50:53]
    v_mfma_f32_16x16x32_bf16 v[50:53], v[116:119], v[18:21], v[50:53]
    v_mfma_f32_16x16x32_bf16 v[54:57], v[120:123], v[10:13], 0
    s_nop 3
    v_cvt_pk_bf16_f32 v62, v46, v47
    v_mfma_f32_16x16x32_bf16 v[54:57], v[124:127], v[14:17], v[54:57]
    v_cvt_pk_bf16_f32 v63, v48, v49
    v_and_or_b32 v62, v62, -2, s22
    v_mfma_f32_16x16x32_bf16 v[54:57], v[128:131], v[18:21], v[54:57]
    v_cvt_pk_bf16_f32 v64, v50, v51
    v_mfma_f32_16x16x32_bf16 v[58:61], v[132:135], v[10:13], 0
    v_cvt_pk_bf16_f32 v65, v52, v53
    v_mfma_f32_16x16x32_bf16 v[58:61], v[136:139], v[14:17], v[58:61]
    v_mfma_f32_16x16x32_bf16 v[58:61], v[140:143], v[18:21], v[58:61]
    v_mfma_f32_16x16x32_bf16 v[46:49], v[144:147], v[10:13], 0
    buffer_store_dwordx4 v[62:65], v3, s[4:7], s32 offen sc1
    s_nop 0
    v_cvt_pk_bf16_f32 v66, v54, v55
    v_mfma_f32_16x16x32_bf16 v[46:49], v[148:151], v[14:17], v[46:49]
    v_cvt_pk_bf16_f32 v67, v56, v57
    v_and_or_b32 v66, v66, -2, s22
    v_mfma_f32_16x16x32_bf16 v[46:49], v[152:155], v[18:21], v[46:49]
    v_cvt_pk_bf16_f32 v68, v58, v59
    v_mfma_f32_16x16x32_bf16 v[50:53], v[156:159], v[10:13], 0
    v_cvt_pk_bf16_f32 v69, v60, v61
    v_mfma_f32_16x16x32_bf16 v[50:53], v[160:163], v[14:17], v[50:53]
    v_mfma_f32_16x16x32_bf16 v[50:53], v[164:167], v[18:21], v[50:53]
    v_mfma_f32_16x16x32_bf16 v[54:57], v[168:171], v[10:13], 0
    buffer_store_dwordx4 v[66:69], v4, s[4:7], s32 offen sc1
    s_nop 0
    v_cvt_pk_bf16_f32 v62, v46, v47
    v_mfma_f32_16x16x32_bf16 v[54:57], v[172:175], v[14:17], v[54:57]
    v_cvt_pk_bf16_f32 v63, v48, v49
    v_and_or_b32 v62, v62, -2, s22
    v_mfma_f32_16x16x32_bf16 v[54:57], v[176:179], v[18:21], v[54:57]
    v_cvt_pk_bf16_f32 v64, v50, v51
    v_mfma_f32_16x16x32_bf16 v[58:61], v[180:183], v[10:13], 0
    v_cvt_pk_bf16_f32 v65, v52, v53
    v_mfma_f32_16x16x32_bf16 v[58:61], v[184:187], v[14:17], v[58:61]
    v_mfma_f32_16x16x32_bf16 v[58:61], v[188:191], v[18:21], v[58:61]
    v_mfma_f32_16x16x32_bf16 v[46:49], v[192:195], v[10:13], 0
    buffer_store_dwordx4 v[62:65], v5, s[4:7], s32 offen sc1
    s_nop 0
    v_cvt_pk_bf16_f32 v66, v54, v55
    v_mfma_f32_16x16x32_bf16 v[46:49], v[196:199], v[14:17], v[46:49]
    v_cvt_pk_bf16_f32 v67, v56, v57
    v_and_or_b32 v66, v66, -2, s22
    v_mfma_f32_16x16x32_bf16 v[46:49], v[200:203], v[18:21], v[46:49]
    v_cvt_pk_bf16_f32 v68, v58, v59
    v_mfma_f32_16x16x32_bf16 v[50:53], v[204:207], v[10:13], 0
    v_cvt_pk_bf16_f32 v69, v60, v61
    v_mfma_f32_16x16x32_bf16 v[50:53], v[208:211], v[14:17], v[50:53]
    v_mfma_f32_16x16x32_bf16 v[50:53], v[212:215], v[18:21], v[50:53]
    buffer_store_dwordx4 v[66:69], v6, s[4:7], s32 offen sc1
    s_nop 1
    v_cvt_pk_bf16_f32 v62, v46, v47
    v_cvt_pk_bf16_f32 v63, v48, v49
    v_and_or_b32 v62, v62, -2, s22
    s_nop 1
    v_cvt_pk_bf16_f32 v64, v50, v51
    v_cvt_pk_bf16_f32 v65, v52, v53
    buffer_store_dwordx4 v[62:65], v7, s[4:7], s32 offen sc1
    s_add_u32 s60, s20, 1
    s_and_b32 s22, s60, 1
    s_lshl_b32 s21, s22, 31
    s_sub_u32 s44, 0, s22
    s_bfe_u32 s23, s20, 0x10001
    s_sub_u32 s23, s23, 1
    s_lshr_b32 s24, s60, 1
    s_andn2_b32 s24, 1, s24
    s_lshl_b32 s61, s14, 15
    s_add_u32 s61, s61, 1179648
    s_and_b32 s25, s20, 1
    s_lshl_b32 s25, s25, 16
    s_add_u32 s25, s25, s61
    s_add_u32 s25, s25, 15360
    s_add_u32 s26, s25, 4096
    s_lshl_b32 s36, s22, 16
    s_add_u32 s36, s36, s61
    s_lshl_b32 s27, s20, 1
    s_add_u32 s37, s27, 2
    s_add_u32 s37, s37, s14
    s_mul_i32 s37, s37, 20480
    s_add_u32 s37, s37, 2621440
    s_add_u32 s27, s27, 1
    s_sub_u32 s27, s27, s14
    s_mul_i32 s27, s27, 20480
    s_add_u32 s27, s27, 2636800
    s_add_u32 s28, s27, 4096
    s_lshl_b32 s31, s20, 6
    s_add_u32 s31, s31, s13
    s_mul_i32 s31, s31, 6144
    s_add_u32 s31, s31, 5898240
    s_min_u32 s56, s20, 63
    s_lshl_b32 s56, s56, 6
    s_add_u32 s56, s56, s13
    s_mul_i32 s56, s56, 12288
    s_add_u32 s56, s56, 37364736
    s_max_u32 s57, s20, 7
    s_sub_u32 s57, s57, 7
    s_lshl_b32 s57, s57, 6
    s_add_u32 s57, s57, s13
    s_mul_i32 s57, s57, 12288
    s_add_u32 s57, s57, 87696384
    s_cmp_lt_u32 s20, 7
    s_cselect_b32 s57, s56, s57
    s_cmp_gt_u32 s60, 63
    s_cselect_b64 s[42:43], s[38:39], 0
    s_cmp_le_u32 s60, 7
    s_cselect_b64 vcc, s[40:41], 0
    s_or_b64 s[42:43], s[42:43], vcc
    s_add_u32 s60, s20, 1
    s_add_u32 s58, s60, 1
    s_cmp_gt_u32 s60, 63
    s_cselect_b32 s58, 0, s58
    s_sub_u32 s59, s60, 6
    s_cmp_lt_u32 s60, 7
    s_cselect_b32 s59, 0, s59
    v_mov_b32 v216, s58
    v_mov_b32 v218, s59
    v_cmp_gt_u32 vcc, 256, v0
    s_nop 1
    v_cndmask_b32 v216, v218, v216, vcc
    s_branch L_Rs3_top
L_Rs3_tail:
    s_waitcnt lgkmcnt(0)
    buffer_store_dwordx4 v[58:61], v0, s[4:7], s31 offen offset:0 sc1
    buffer_store_dwordx4 v[62:65], v0, s[4:7], s31 offen offset:1024 sc1
    buffer_store_dwordx4 v[66:69], v0, s[4:7], s31 offen offset:2048 sc1
    s_waitcnt vmcnt(0) lgkmcnt(0)
    s_barrier
    v_mov_b32 v22, 71
    s_mov_b64 exec, 1
    buffer_store_dword v22, v0, s[4:7], s54 offen sc1
    s_mov_b64 exec, -1
    s_waitcnt vmcnt(0)
    s_endpgm
L_Rs3_glfix_3:
    buffer_load_dwordx4 v[10:13], v0, s[4:7], s25 offen offset:0 sc1
    buffer_load_dwordx4 v[14:17], v0, s[4:7], s25 offen offset:1024 sc1
    buffer_load_dwordx4 v[18:21], v0, s[4:7], s25 offen offset:2048 sc1
    buffer_load_dwordx4 v[22:25], v0, s[4:7], s25 offen offset:3072 sc1
    buffer_load_dwordx4 v[26:29], v0, s[4:7], s26 offen offset:0 sc1
    buffer_load_dwordx4 v[46:49], v0, s[4:7], s27 offen offset:0 sc1
    buffer_load_dwordx4 v[30:33], v0, s[4:7], s27 offen offset:1024 sc1
    buffer_load_dwordx4 v[34:37], v0, s[4:7], s27 offen offset:2048 sc1
    buffer_load_dwordx4 v[38:41], v0, s[4:7], s27 offen offset:3072 sc1
    buffer_load_dwordx4 v[42:45], v0, s[4:7], s28 offen offset:0 sc1
    s_add_u32 s19, s19, 1
    s_cmp_lt_u32 s19, 524288
    s_cbranch_scc1 L_Rs3_gl_1
    s_branch L_fail
L_Rs3_grfix_5:
    buffer_load_dwordx4 v[46:49], v0, s[4:7], s27 offen offset:0 sc1
    buffer_load_dwordx4 v[30:33], v0, s[4:7], s27 offen offset:1024 sc1
    buffer_load_dwordx4 v[34:37], v0, s[4:7], s27 offen offset:2048 sc1
    buffer_load_dwordx4 v[38:41], v0, s[4:7], s27 offen offset:3072 sc1
    buffer_load_dwordx4 v[42:45], v0, s[4:7], s28 offen offset:0 sc1
    s_add_u32 s19, s19, 1
    s_cmp_lt_u32 s19, 524288
    s_cbranch_scc1 L_Rs3_gr2_4
    s_branch L_fail
L_Rs3_gr2_4:
    v_mfma_f32_16x16x32_bf16 v[50:53], a[240:243], v[10:13], 0
    v_mfma_f32_16x16x32_bf16 v[54:57], a[244:247], v[10:13], 0
    v_mfma_f32_16x16x32_bf16 v[58:61], a[240:243], v[14:17], 0
    v_mfma_f32_16x16x32_bf16 v[62:65], a[244:247], v[14:17], 0
    v_mfma_f32_16x16x32_bf16 v[66:69], a[240:243], v[18:21], 0
    v_mfma_f32_16x16x32_bf16 v[70:73], a[244:247], v[18:21], 0
    v_mfma_f32_16x16x32_bf16 v[74:77], a[240:243], v[22:25], 0
    v_mfma_f32_16x16x32_bf16 v[78:81], a[244:247], v[22:25], 0
    v_mfma_f32_16x16x32_bf16 v[82:85], a[240:243], v[26:29], 0
    v_mfma_f32_16x16x32_bf16 v[86:89], a[244:247], v[26:29], 0
    s_branch L_Rs3_gr_2
L_Rs3_hafix_7:
    buffer_load_dwordx4 v[82:85], v0, s[4:7], s30 offen sc1
    s_add_u32 s19, s19, 1
    s_cmp_lt_u32 s19, 524288
    s_cbranch_scc1 L_Rs3_ha_6
    s_branch L_fail
L_Rs3_kvretry_9:
    s_add_u32 s19, s19, 1
    s_cmp_ge_u32 s19, 524288
    s_cbranch_scc1 L_fail
    s_waitcnt vmcnt(0) lgkmcnt(0)
    buffer_load_dword v218, v217, s[4:7], s55 offen sc1
    s_waitcnt vmcnt(0)
    s_branch L_Rs3_kvchk_8
L_roleP:
    v_lshlrev_b32 v10, 4, v0
    s_lshl_b32 s34, s13, 2
    s_add_u32 s34, s34, s12
    s_lshl_b32 s34, s34, 7
    s_add_u32 s34, s34, 0
    v_mov_b32 v12, 0
    v_mov_b32 v13, 0
    v_mov_b32 v14, 0
    v_mov_b32 v15, 0
    s_mov_b64 exec, 1
    buffer_store_dwordx4 v[12:15], v10, s[4:7], s34 offen sc1
    s_mov_b64 exec, -1
    s_sub_u32 s40, s13, 64
    s_mul_i32 s20, s40, 21846
    s_lshr_b32 s20, s20, 16
    s_mul_i32 s41, s20, 3
    s_sub_u32 s21, s40, s41
    s_lshl_b32 s21, s21, 2
    s_add_u32 s21, s21, s12
    s_mul_i32 s43, s12, 40960
    s_mov_b32 s8, s70
    s_and_b32 s9, s71, 0xffff
    s_mov_b32 s10, 7864320
    s_mov_b32 s11, 0x20000
    s_mov_b32 s48, s72
    s_and_b32 s49, s73, 0xffff
    s_mov_b32 s50, 7864320
    s_mov_b32 s51, 0x20000
    s_cmp_ge_u32 s21, 6
    s_cselect_b32 s8, s68, s70
    s_cselect_b32 s9, s69, s71
    s_cselect_b32 s40, 6, 0
    s_and_b32 s9, s9, 0xffff
    s_sub_u32 s40, s21, s40
    s_mul_i32 s41, s20, 384
    s_lshl_b32 s52, s40, 6
    s_add_u32 s52, s52, s41
    s_lshl_b32 s53, s21, 5
    s_add_u32 s53, s53, s41
    s_cmp_ge_u32 s40, 3
    s_cselect_b32 s41, 9216, 0
    s_lshl_b32 s42, s40, 10
    s_add_u32 s41, s41, s42
    s_mul_i32 s30, s20, 24576
    s_add_u32 s41, s41, s30
    s_add_u32 s41, s41, 37355520
    s_mul_i32 s27, s20, 12288
    s_add_u32 s27, s27, s42
    s_add_u32 s27, s27, 138018816
    s_cmp_ge_u32 s21, 6
    s_cselect_b32 s27, s27, s41
    s_cselect_b32 s28, 32, 64
    s_cselect_b32 s29, 6, 3
    s_cselect_b32 s41, 6144, 0
    s_mul_i32 s28, s28, 12288
    s_lshl_b32 s29, s29, 10
    s_lshl_b32 s42, s21, 10
    s_add_u32 s30, s30, s42
    s_add_u32 s30, s30, s41
    s_add_u32 s30, s30, 37361664
    v_add_u32 v26, 0, v0
    v_mul_u32_u24 v27, 16385, v26
    v_lshrrev_b32 v27, 16, v27
    v_mul_u32_u24 v20, 4, v27
    v_sub_u32 v20, v26, v20
    v_lshrrev_b32 v20, 0, v20
    v_lshlrev_b32 v20, 4, v20
    v_mul_u32_u24 v27, 12288, v27
    v_add_u32 v20, v20, v27
    v_add_u32 v26, 64, v0
    v_mul_u32_u24 v27, 16385, v26
    v_lshrrev_b32 v27, 16, v27
    v_mul_u32_u24 v21, 4, v27
    v_sub_u32 v21, v26, v21
    v_lshrrev_b32 v21, 0, v21
    v_lshlrev_b32 v21, 4, v21
    v_mul_u32_u24 v27, 12288, v27
    v_add_u32 v21, v21, v27
    v_add_u32 v26, 0, v0
    v_mul_u32_u24 v27, 32769, v26
    v_lshrrev_b32 v27, 16, v27
    v_mul_u32_u24 v22, 2, v27
    v_sub_u32 v22, v26, v22
    v_lshrrev_b32 v22, 0, v22
    v_lshlrev_b32 v22, 4, v22
    v_mul_u32_u24 v27, 12288, v27
    v_add_u32 v22, v22, v27
    v_lshrrev_b32 v23, 2, v0
    v_mul_u32_u24 v23, 64, v23
    v_and_b32 v26, 3, v0
    v_lshl_add_u32 v23, v26, 3, v23
    v_add_u32 v23, s43, v23
    v_lshrrev_b32 v24, 2, v0
    v_mul_u32_u24 v24, 32, v24
    v_and_b32 v26, 3, v0
    v_lshl_add_u32 v24, v26, 3, v24
    v_add_u32 v24, s43, v24
    s_add_u32 m0, s43, 0
    s_nop 0
    buffer_load_dwordx4 v20, s[8:11], s52 offen lds
    s_add_u32 m0, s43, 1024
    s_nop 0
    buffer_load_dwordx4 v21, s[8:11], s52 offen lds
    s_add_u32 m0, s43, 2048
    s_nop 0
    buffer_load_dwordx4 v22, s[48:51], s53 offen lds
    s_add_u32 s52, s52, 393216
    s_add_u32 m0, s43, 3072
    s_nop 0
    buffer_load_dwordx4 v20, s[8:11], s52 offen lds
    s_add_u32 m0, s43, 4096
    s_nop 0
    buffer_load_dwordx4 v21, s[8:11], s52 offen lds
    s_add_u32 s53, s53, 393216
    s_add_u32 m0, s43, 5120
    s_nop 0
    buffer_load_dwordx4 v22, s[48:51], s53 offen lds
    s_add_u32 s52, s52, 393216
    s_add_u32 m0, s43, 6144
    s_nop 0
    buffer_load_dwordx4 v20, s[8:11], s52 offen lds
    s_add_u32 m0, s43, 7168
    s_nop 0
    buffer_load_dwordx4 v21, s[8:11], s52 offen lds
    s_add_u32 s53, s53, 393216
    s_add_u32 m0, s43, 8192
    s_nop 0
    buffer_load_dwordx4 v22, s[48:51], s53 offen lds
    s_add_u32 s52, s52, 393216
    s_add_u32 m0, s43, 9216
    s_nop 0
    buffer_load_dwordx4 v20, s[8:11], s52 offen lds
    s_add_u32 m0, s43, 10240
    s_nop 0
    buffer_load_dwordx4 v21, s[8:11], s52 offen lds
    s_add_u32 s53, s53, 393216
    s_add_u32 m0, s43, 11264
    s_nop 0
    buffer_load_dwordx4 v22, s[48:51], s53 offen lds
    s_add_u32 s52, s52, 393216
    s_add_u32 m0, s43, 12288
    s_nop 0
    buffer_load_dwordx4 v20, s[8:11], s52 offen lds
    s_add_u32 m0, s43, 13312
    s_nop 0
    buffer_load_dwordx4 v21, s[8:11], s52 offen lds
    s_add_u32 s53, s53, 393216
    s_add_u32 m0, s43, 14336
    s_nop 0
    buffer_load_dwordx4 v22, s[48:51], s53 offen lds
    s_add_u32 s52, s52, 393216
    s_add_u32 m0, s43, 15360
    s_nop 0
    buffer_load_dwordx4 v20, s[8:11], s52 offen lds
    s_add_u32 m0, s43, 16384
    s_nop 0
    buffer_load_dwordx4 v21, s[8:11], s52 offen lds
    s_add_u32 s53, s53, 393216
    s_add_u32 m0, s43, 17408
    s_nop 0
    buffer_load_dwordx4 v22, s[48:51], s53 offen lds
    s_add_u32 s52, s52, 393216
    s_add_u32 m0, s43, 18432
    s_nop 0
    buffer_load_dwordx4 v20, s[8:11], s52 offen lds
    s_add_u32 m0, s43, 19456
    s_nop 0
    buffer_load_dwordx4 v21, s[8:11], s52 offen lds
    s_add_u32 s53, s53, 393216
    s_add_u32 m0, s43, 20480
    s_nop 0
    buffer_load_dwordx4 v22, s[48:51], s53 offen lds
    s_add_u32 s52, s52, 393216
    s_add_u32 m0, s43, 21504
    s_nop 0
    buffer_load_dwordx4 v20, s[8:11], s52 offen lds
    s_add_u32 m0, s43, 22528
    s_nop 0
    buffer_load_dwordx4 v21, s[8:11], s52 offen lds
    s_add_u32 s53, s53, 393216
    s_add_u32 m0, s43, 23552
    s_nop 0
    buffer_load_dwordx4 v22, s[48:51], s53 offen lds
    s_add_u32 s52, s52, 393216
    s_add_u32 m0, s43, 24576
    s_nop 0
    buffer_load_dwordx4 v20, s[8:11], s52 offen lds
    s_add_u32 m0, s43, 25600
    s_nop 0
    buffer_load_dwordx4 v21, s[8:11], s52 offen lds
    s_add_u32 s53, s53, 393216
    s_add_u32 m0, s43, 26624
    s_nop 0
    buffer_load_dwordx4 v22, s[48:51], s53 offen lds
    s_add_u32 s52, s52, 393216
    s_add_u32 m0, s43, 27648
    s_nop 0
    buffer_load_dwordx4 v20, s[8:11], s52 offen lds
    s_add_u32 m0, s43, 28672
    s_nop 0
    buffer_load_dwordx4 v21, s[8:11], s52 offen lds
    s_add_u32 s53, s53, 393216
    s_add_u32 m0, s43, 29696
    s_nop 0
    buffer_load_dwordx4 v22, s[48:51], s53 offen lds
    s_add_u32 s52, s52, 393216
    s_add_u32 m0, s43, 30720
    s_nop 0
    buffer_load_dwordx4 v20, s[8:11], s52 offen lds
    s_add_u32 m0, s43, 31744
    s_nop 0
    buffer_load_dwordx4 v21, s[8:11], s52 offen lds
    s_add_u32 s53, s53, 393216
    s_add_u32 m0, s43, 32768
    s_nop 0
    buffer_load_dwordx4 v22, s[48:51], s53 offen lds
    s_add_u32 s52, s52, 393216
    s_add_u32 m0, s43, 33792
    s_nop 0
    buffer_load_dwordx4 v20, s[8:11], s52 offen lds
    s_add_u32 m0, s43, 34816
    s_nop 0
    buffer_load_dwordx4 v21, s[8:11], s52 offen lds
    s_add_u32 s53, s53, 393216
    s_add_u32 m0, s43, 35840
    s_nop 0
    buffer_load_dwordx4 v22, s[48:51], s53 offen lds
    s_waitcnt vmcnt(34)
    s_barrier
    s_cmp_lg_u32 s12, 0
    s_cbranch_scc1 L_P_arr_1
    s_lshl_b32 s3, s18, 2
    s_add_u32 s3, s3, 64
    v_mov_b32 v92, s3
    v_mov_b32 v93, 1
    s_mov_b64 exec, 1
    global_atomic_add v92, v93, s[16:17] sc1
    s_waitcnt vmcnt(0)
    s_mov_b64 exec, -1
L_P_arr_1:
    ds_read_b64_tr_b16 a[0:1], v23 offset:0
    ds_read_b64_tr_b16 a[2:3], v23 offset:1024
    ds_read_b64_tr_b16 a[80:81], v23 offset:32
    ds_read_b64_tr_b16 a[82:83], v23 offset:1056
    s_waitcnt lgkmcnt(0)
    s_add_u32 s52, s52, 393216
    s_add_u32 m0, s43, 0
    s_nop 0
    buffer_load_dwordx4 v20, s[8:11], s52 offen lds
    s_add_u32 m0, s43, 1024
    s_nop 0
    buffer_load_dwordx4 v21, s[8:11], s52 offen lds
    s_waitcnt vmcnt(35)
    ds_read_b64_tr_b16 a[160:161], v24 offset:2048
    ds_read_b64_tr_b16 a[162:163], v24 offset:2560
    s_waitcnt lgkmcnt(0)
    s_add_u32 s53, s53, 393216
    s_add_u32 m0, s43, 2048
    s_nop 0
    buffer_load_dwordx4 v22, s[48:51], s53 offen lds
    s_waitcnt vmcnt(34)
    ds_read_b64_tr_b16 a[4:5], v23 offset:3072
    ds_read_b64_tr_b16 a[6:7], v23 offset:4096
    ds_read_b64_tr_b16 a[84:85], v23 offset:3104
    ds_read_b64_tr_b16 a[86:87], v23 offset:4128
    s_waitcnt lgkmcnt(0)
    s_add_u32 s52, s52, 393216
    s_add_u32 m0, s43, 3072
    s_nop 0
    buffer_load_dwordx4 v20, s[8:11], s52 offen lds
    s_add_u32 m0, s43, 4096
    s_nop 0
    buffer_load_dwordx4 v21, s[8:11], s52 offen lds
    s_waitcnt vmcnt(35)
    ds_read_b64_tr_b16 a[164:165], v24 offset:5120
    ds_read_b64_tr_b16 a[166:167], v24 offset:5632
    s_waitcnt lgkmcnt(0)
    s_add_u32 s53, s53, 393216
    s_add_u32 m0, s43, 5120
    s_nop 0
    buffer_load_dwordx4 v22, s[48:51], s53 offen lds
    s_waitcnt vmcnt(34)
    ds_read_b64_tr_b16 a[8:9], v23 offset:6144
    ds_read_b64_tr_b16 a[10:11], v23 offset:7168
    ds_read_b64_tr_b16 a[88:89], v23 offset:6176
    ds_read_b64_tr_b16 a[90:91], v23 offset:7200
    s_waitcnt lgkmcnt(0)
    s_add_u32 s52, s52, 393216
    s_add_u32 m0, s43, 6144
    s_nop 0
    buffer_load_dwordx4 v20, s[8:11], s52 offen lds
    s_add_u32 m0, s43, 7168
    s_nop 0
    buffer_load_dwordx4 v21, s[8:11], s52 offen lds
    s_waitcnt vmcnt(35)
    ds_read_b64_tr_b16 a[168:169], v24 offset:8192
    ds_read_b64_tr_b16 a[170:171], v24 offset:8704
    s_waitcnt lgkmcnt(0)
    s_add_u32 s53, s53, 393216
    s_add_u32 m0, s43, 8192
    s_nop 0
    buffer_load_dwordx4 v22, s[48:51], s53 offen lds
    s_waitcnt vmcnt(34)
    ds_read_b64_tr_b16 a[12:13], v23 offset:9216
    ds_read_b64_tr_b16 a[14:15], v23 offset:10240
    ds_read_b64_tr_b16 a[92:93], v23 offset:9248
    ds_read_b64_tr_b16 a[94:95], v23 offset:10272
    s_waitcnt lgkmcnt(0)
    s_add_u32 s52, s52, 393216
    s_add_u32 m0, s43, 9216
    s_nop 0
    buffer_load_dwordx4 v20, s[8:11], s52 offen lds
    s_add_u32 m0, s43, 10240
    s_nop 0
    buffer_load_dwordx4 v21, s[8:11], s52 offen lds
    s_waitcnt vmcnt(35)
    ds_read_b64_tr_b16 a[172:173], v24 offset:11264
    ds_read_b64_tr_b16 a[174:175], v24 offset:11776
    s_waitcnt lgkmcnt(0)
    s_add_u32 s53, s53, 393216
    s_add_u32 m0, s43, 11264
    s_nop 0
    buffer_load_dwordx4 v22, s[48:51], s53 offen lds
    s_waitcnt vmcnt(34)
    ds_read_b64_tr_b16 a[16:17], v23 offset:12288
    ds_read_b64_tr_b16 a[18:19], v23 offset:13312
    ds_read_b64_tr_b16 a[96:97], v23 offset:12320
    ds_read_b64_tr_b16 a[98:99], v23 offset:13344
    s_waitcnt lgkmcnt(0)
    s_add_u32 s52, s52, 393216
    s_add_u32 m0, s43, 12288
    s_nop 0
    buffer_load_dwordx4 v20, s[8:11], s52 offen lds
    s_add_u32 m0, s43, 13312
    s_nop 0
    buffer_load_dwordx4 v21, s[8:11], s52 offen lds
    s_waitcnt vmcnt(35)
    ds_read_b64_tr_b16 a[176:177], v24 offset:14336
    ds_read_b64_tr_b16 a[178:179], v24 offset:14848
    s_waitcnt lgkmcnt(0)
    s_add_u32 s53, s53, 393216
    s_add_u32 m0, s43, 14336
    s_nop 0
    buffer_load_dwordx4 v22, s[48:51], s53 offen lds
    s_waitcnt vmcnt(34)
    ds_read_b64_tr_b16 a[20:21], v23 offset:15360
    ds_read_b64_tr_b16 a[22:23], v23 offset:16384
    ds_read_b64_tr_b16 a[100:101], v23 offset:15392
    ds_read_b64_tr_b16 a[102:103], v23 offset:16416
    s_waitcnt lgkmcnt(0)
    s_add_u32 s52, s52, 393216
    s_add_u32 m0, s43, 15360
    s_nop 0
    buffer_load_dwordx4 v20, s[8:11], s52 offen lds
    s_add_u32 m0, s43, 16384
    s_nop 0
    buffer_load_dwordx4 v21, s[8:11], s52 offen lds
    s_waitcnt vmcnt(35)
    ds_read_b64_tr_b16 a[180:181], v24 offset:17408
    ds_read_b64_tr_b16 a[182:183], v24 offset:17920
    s_waitcnt lgkmcnt(0)
    s_add_u32 s53, s53, 393216
    s_add_u32 m0, s43, 17408
    s_nop 0
    buffer_load_dwordx4 v22, s[48:51], s53 offen lds
    s_waitcnt vmcnt(34)
    ds_read_b64_tr_b16 a[24:25], v23 offset:18432
    ds_read_b64_tr_b16 a[26:27], v23 offset:19456
    ds_read_b64_tr_b16 a[104:105], v23 offset:18464
    ds_read_b64_tr_b16 a[106:107], v23 offset:19488
    s_waitcnt lgkmcnt(0)
    s_add_u32 s52, s52, 393216
    s_add_u32 m0, s43, 18432
    s_nop 0
    buffer_load_dwordx4 v20, s[8:11], s52 offen lds
    s_add_u32 m0, s43, 19456
    s_nop 0
    buffer_load_dwordx4 v21, s[8:11], s52 offen lds
    s_waitcnt vmcnt(35)
    ds_read_b64_tr_b16 a[184:185], v24 offset:20480
    ds_read_b64_tr_b16 a[186:187], v24 offset:20992
    s_waitcnt lgkmcnt(0)
    s_add_u32 s53, s53, 393216
    s_add_u32 m0, s43, 20480
    s_nop 0
    buffer_load_dwordx4 v22, s[48:51], s53 offen lds
    s_waitcnt vmcnt(34)
    ds_read_b64_tr_b16 a[28:29], v23 offset:21504
    ds_read_b64_tr_b16 a[30:31], v23 offset:22528
    ds_read_b64_tr_b16 a[108:109], v23 offset:21536
    ds_read_b64_tr_b16 a[110:111], v23 offset:22560
    s_waitcnt lgkmcnt(0)
    s_add_u32 s52, s52, 393216
    s_add_u32 m0, s43, 21504
    s_nop 0
    buffer_load_dwordx4 v20, s[8:11], s52 offen lds
    s_add_u32 m0, s43, 22528
    s_nop 0
    buffer_load_dwordx4 v21, s[8:11], s52 offen lds
    s_waitcnt vmcnt(35)
    ds_read_b64_tr_b16 a[188:189], v24 offset:23552
    ds_read_b64_tr_b16 a[190:191], v24 offset:24064
    s_waitcnt lgkmcnt(0)
    s_add_u32 s53, s53, 393216
    s_add_u32 m0, s43, 23552
    s_nop 0
    buffer_load_dwordx4 v22, s[48:51], s53 offen lds
    s_waitcnt vmcnt(34)
    ds_read_b64_tr_b16 a[32:33], v23 offset:24576
    ds_read_b64_tr_b16 a[34:35], v23 offset:25600
    ds_read_b64_tr_b16 a[112:113], v23 offset:24608
    ds_read_b64_tr_b16 a[114:115], v23 offset:25632
    s_waitcnt lgkmcnt(0)
    s_waitcnt vmcnt(33)
    ds_read_b64_tr_b16 a[192:193], v24 offset:26624
    ds_read_b64_tr_b16 a[194:195], v24 offset:27136
    s_waitcnt lgkmcnt(0)
    s_waitcnt vmcnt(31)
    ds_read_b64_tr_b16 a[36:37], v23 offset:27648
    ds_read_b64_tr_b16 a[38:39], v23 offset:28672
    ds_read_b64_tr_b16 a[116:117], v23 offset:27680
    ds_read_b64_tr_b16 a[118:119], v23 offset:28704
    s_waitcnt lgkmcnt(0)
    s_waitcnt vmcnt(30)
    ds_read_b64_tr_b16 a[196:197], v24 offset:29696
    ds_read_b64_tr_b16 a[198:199], v24 offset:30208
    s_waitcnt lgkmcnt(0)
    s_waitcnt vmcnt(28)
    ds_read_b64_tr_b16 a[40:41], v23 offset:30720
    ds_read_b64_tr_b16 a[42:43], v23 offset:31744
    ds_read_b64_tr_b16 a[120:121], v23 offset:30752
    ds_read_b64_tr_b16 a[122:123], v23 offset:31776
    s_waitcnt lgkmcnt(0)
    s_waitcnt vmcnt(27)
    ds_read_b64_tr_b16 a[200:201], v24 offset:32768
    ds_read_b64_tr_b16 a[202:203], v24 offset:33280
    s_waitcnt lgkmcnt(0)
    s_waitcnt vmcnt(25)
    ds_read_b64_tr_b16 a[44:45], v23 offset:33792
    ds_read_b64_tr_b16 a[46:47], v23 offset:34816
    ds_read_b64_tr_b16 a[124:125], v23 offset:33824
    ds_read_b64_tr_b16 a[126:127], v23 offset:34848
    s_waitcnt lgkmcnt(0)
    s_waitcnt vmcnt(24)
    ds_read_b64_tr_b16 a[204:205], v24 offset:35840
    ds_read_b64_tr_b16 a[206:207], v24 offset:36352
    s_waitcnt lgkmcnt(0)
    s_waitcnt vmcnt(22)
    ds_read_b64_tr_b16 a[48:49], v23 offset:0
    ds_read_b64_tr_b16 a[50:51], v23 offset:1024
    ds_read_b64_tr_b16 a[128:129], v23 offset:32
    ds_read_b64_tr_b16 a[130:131], v23 offset:1056
    s_waitcnt lgkmcnt(0)
    s_waitcnt vmcnt(21)
    ds_read_b64_tr_b16 a[208:209], v24 offset:2048
    ds_read_b64_tr_b16 a[210:211], v24 offset:2560
    s_waitcnt lgkmcnt(0)
    s_waitcnt vmcnt(19)
    ds_read_b64_tr_b16 a[52:53], v23 offset:3072
    ds_read_b64_tr_b16 a[54:55], v23 offset:4096
    ds_read_b64_tr_b16 a[132:133], v23 offset:3104
    ds_read_b64_tr_b16 a[134:135], v23 offset:4128
    s_waitcnt lgkmcnt(0)
    s_waitcnt vmcnt(18)
    ds_read_b64_tr_b16 a[212:213], v24 offset:5120
    ds_read_b64_tr_b16 a[214:215], v24 offset:5632
    s_waitcnt lgkmcnt(0)
    s_waitcnt vmcnt(16)
    ds_read_b64_tr_b16 a[56:57], v23 offset:6144
    ds_read_b64_tr_b16 a[58:59], v23 offset:7168
    ds_read_b64_tr_b16 a[136:137], v23 offset:6176
    ds_read_b64_tr_b16 a[138:139], v23 offset:7200
    s_waitcnt lgkmcnt(0)
    s_waitcnt vmcnt(15)
    ds_read_b64_tr_b16 a[216:217], v24 offset:8192
    ds_read_b64_tr_b16 a[218:219], v24 offset:8704
    s_waitcnt lgkmcnt(0)
    s_waitcnt vmcnt(13)
    ds_read_b64_tr_b16 a[60:61], v23 offset:9216
    ds_read_b64_tr_b16 a[62:63], v23 offset:10240
    ds_read_b64_tr_b16 a[140:141], v23 offset:9248
    ds_read_b64_tr_b16 a[142:143], v23 offset:10272
    s_waitcnt lgkmcnt(0)
    s_waitcnt vmcnt(12)
    ds_read_b64_tr_b16 a[220:221], v24 offset:11264
    ds_read_b64_tr_b16 a[222:223], v24 offset:11776
    s_waitcnt lgkmcnt(0)
    s_waitcnt vmcnt(10)
    ds_read_b64_tr_b16 a[64:65], v23 offset:12288
    ds_read_b64_tr_b16 a[66:67], v23 offset:13312
    ds_read_b64_tr_b16 a[144:145], v23 offset:12320
    ds_read_b64_tr_b16 a[146:147], v23 offset:13344
    s_waitcnt lgkmcnt(0)
    s_waitcnt vmcnt(9)
    ds_read_b64_tr_b16 a[224:225], v24 offset:14336
    ds_read_b64_tr_b16 a[226:227], v24 offset:14848
    s_waitcnt lgkmcnt(0)
    s_waitcnt vmcnt(7)
    ds_read_b64_tr_b16 a[68:69], v23 offset:15360
    ds_read_b64_tr_b16 a[70:71], v23 offset:16384
    ds_read_b64_tr_b16 a[148:149], v23 offset:15392
    ds_read_b64_tr_b16 a[150:151], v23 offset:16416
    s_waitcnt lgkmcnt(0)
    s_waitcnt vmcnt(6)
    ds_read_b64_tr_b16 a[228:229], v24 offset:17408
    ds_read_b64_tr_b16 a[230:231], v24 offset:17920
    s_waitcnt lgkmcnt(0)
    s_waitcnt vmcnt(4)
    ds_read_b64_tr_b16 a[72:73], v23 offset:18432
    ds_read_b64_tr_b16 a[74:75], v23 offset:19456
    ds_read_b64_tr_b16 a[152:153], v23 offset:18464
    ds_read_b64_tr_b16 a[154:155], v23 offset:19488
    s_waitcnt lgkmcnt(0)
    s_waitcnt vmcnt(3)
    ds_read_b64_tr_b16 a[232:233], v24 offset:20480
    ds_read_b64_tr_b16 a[234:235], v24 offset:20992
    s_waitcnt lgkmcnt(0)
    s_waitcnt vmcnt(1)
    ds_read_b64_tr_b16 a[76:77], v23 offset:21504
    ds_read_b64_tr_b16 a[78:79], v23 offset:22528
    ds_read_b64_tr_b16 a[156:157], v23 offset:21536
    ds_read_b64_tr_b16 a[158:159], v23 offset:22560
    s_waitcnt lgkmcnt(0)
    s_waitcnt vmcnt(0)
    ds_read_b64_tr_b16 a[236:237], v24 offset:23552
    ds_read_b64_tr_b16 a[238:239], v24 offset:24064
    s_waitcnt lgkmcnt(0)
    s_mul_i32 s63, s12, 10240
    s_and_b32 s3, s12, 1
    s_lshl_b32 s3, s3, 2
    v_lshrrev_b32 v10, 3, v0
    v_mul_u32_u24 v1, 1280, v10
    v_lshrrev_b32 v10, 4, v0
    v_add_u32 v10, s3, v10
    v_and_b32 v11, 7, v0
    v_xor_b32 v10, v10, v11
    v_lshl_add_u32 v1, v10, 4, v1
    v_add_u32 v1, s63, v1
    v_bfe_u32 v10, v0, 3, 1
    v_mul_u32_u24 v2, 10240, v10
    v_lshl_add_u32 v2, v11, 7, v2
    v_bfe_u32 v10, v0, 1, 3
    v_lshrrev_b32 v11, 4, v0
    v_xor_b32 v10, v10, v11
    v_lshl_add_u32 v2, v10, 4, v2
    v_xor_b32 v3, 64, v2
    v_lshlrev_b32 v4, 9, v0
    v_and_b32 v5, 15, v0
    v_lshlrev_b32 v5, 9, v5
    s_lshl_b32 s3, s18, 2
    s_add_u32 s3, s3, 64
    v_mov_b32 v92, s3
    v_lshlrev_b32 v94, 2, v0
    v_and_b32 v94, 28, v94
    s_mov_b32 s19, 0
L_P_warr_2:
    global_load_dword v93, v92, s[16:17] sc1
    s_add_u32 s19, s19, 1
    s_cmp_ge_u32 s19, 524288
    s_cbranch_scc1 L_fail
    s_waitcnt vmcnt(0)
    v_cmp_gt_u32 vcc, 256, v93
    s_nop 0
    s_cbranch_vccnz L_P_warr_2
    s_cmp_lg_u32 s18, 0
    s_cbranch_scc1 L_P_placed_3
    global_load_dword v93, v94, s[16:17] sc1
    s_waitcnt vmcnt(0)
    v_cmp_ne_u32 vcc, 32, v93
    s_nop 0
    s_cbranch_vccnz L_fallback
L_P_placed_3:
    v_lshlrev_b32 v0, 4, v0
    s_mov_b32 s22, 0
    s_mov_b32 s23, 0
    s_add_u32 s31, s63, 40960
    s_mov_b32 s32, s63
    s_mov_b32 s33, 40960
    s_mov_b32 s44, 0
    s_mov_b32 s45, 0
    v_add_u32 v2, s33, v2
    v_add_u32 v3, s33, v3
    s_barrier
    s_mov_b32 s39, 81920
    buffer_load_dword v7, v4, s[4:7], s39 offen offset:8 sc1
    s_waitcnt vmcnt(0)
    s_mov_b32 s19, 0
    v_cmp_gt_u32 vcc, 1, v7
    s_nop 0
    s_cbranch_vccnz L_P_flspin_5
L_P_fl_4:
    s_mov_b32 s39, 114688
    s_sub_u32 s40, s22, s23
    s_cmp_ge_u32 s40, 9
    s_cselect_b32 s25, 1, 0
    s_cmp_eq_u32 s22, 64
    s_cselect_b32 s25, 1, s25
    s_cmp_eq_u32 s25, 1
    s_cselect_b32 s26, s23, s22
    s_add_u32 s23, s23, s25
    s_add_u32 s22, s22, 1
    s_sub_u32 s22, s22, s25
    s_add_u32 s38, s26, 1
    s_lshl_b32 s41, s25, 6
    s_add_u32 s40, s26, s41
    s_mul_i32 s35, s40, 40960
    s_add_u32 s35, s35, 188350464
    s_add_u32 m0, s32, 0
    s_nop 0
    buffer_load_dwordx4 v1, s[4:7], s35 offen offset:0 sc1 lds
    s_add_u32 m0, s32, 896
    s_nop 0
    buffer_load_dwordx4 v1, s[4:7], s35 offen offset:128 sc1 lds
    s_add_u32 m0, s32, 1792
    s_nop 0
    buffer_load_dwordx4 v1, s[4:7], s35 offen offset:256 sc1 lds
    s_add_u32 m0, s32, 2688
    s_nop 0
    buffer_load_dwordx4 v1, s[4:7], s35 offen offset:384 sc1 lds
    s_add_u32 m0, s32, 3584
    s_nop 0
    buffer_load_dwordx4 v1, s[4:7], s35 offen offset:512 sc1 lds
    s_add_u32 m0, s32, 4480
    s_nop 0
    buffer_load_dwordx4 v1, s[4:7], s35 offen offset:640 sc1 lds
    s_add_u32 m0, s32, 5376
    s_nop 0
    buffer_load_dwordx4 v1, s[4:7], s35 offen offset:768 sc1 lds
    s_add_u32 m0, s32, 6272
    s_nop 0
    buffer_load_dwordx4 v1, s[4:7], s35 offen offset:896 sc1 lds
    s_add_u32 m0, s32, 7168
    s_nop 0
    buffer_load_dwordx4 v1, s[4:7], s35 offen offset:1024 sc1 lds
    s_add_u32 m0, s32, 8064
    s_nop 0
    buffer_load_dwordx4 v1, s[4:7], s35 offen offset:1152 sc1 lds
L_P_top:
    s_mov_b32 s36, s44
    s_mov_b32 s37, s45
    s_lshl_b32 s44, s25, 2
    s_add_u32 s44, s44, s34
    s_add_u32 s45, s26, 1
    s_lshl_b32 s24, s25, 6
    s_add_u32 s24, s24, s26
    s_sub_u32 s33, 0, s33
    s_mov_b32 s40, s31
    s_mov_b32 s31, s32
    s_mov_b32 s32, s40
    v_add_u32 v2, s33, v2
    v_add_u32 v3, s33, v3
    s_sub_u32 s40, s22, s23
    s_cmp_ge_u32 s40, 9
    s_cselect_b32 s25, 1, 0
    s_cmp_eq_u32 s22, 64
    s_cselect_b32 s25, 1, s25
    s_cmp_eq_u32 s25, 1
    s_cselect_b32 s26, s23, s22
    s_add_u32 s23, s23, s25
    s_add_u32 s22, s22, 1
    s_sub_u32 s22, s22, s25
    s_add_u32 s38, s26, 1
    s_lshl_b32 s41, s25, 6
    s_add_u32 s40, s26, s41
    s_mul_i32 s35, s40, 40960
    s_add_u32 s35, s35, 188350464
    s_cmp_eq_u32 s25, 1
    s_cbranch_scc1 L_P_late
    s_waitcnt vmcnt(8)
    s_barrier
    ds_read_b128 v[12:15], v2 offset:0
    ds_read_b128 v[16:19], v2 offset:20480
    ds_read_b128 v[20:23], v3 offset:0
    ds_read_b128 v[24:27], v3 offset:20480
    ds_read_b128 v[28:31], v2 offset:1024
    ds_read_b128 v[32:35], v2 offset:21504
    s_waitcnt lgkmcnt(4)
    v_mfma_f32_16x16x32_bf16 v[36:39], a[0:3], v[12:15], 0
    s_add_u32 m0, s32, 0
    s_nop 0
    buffer_load_dwordx4 v1, s[4:7], s35 offen offset:0 sc1 lds
    v_mfma_f32_16x16x32_bf16 v[40:43], a[80:83], v[12:15], 0
    v_mfma_f32_16x16x32_bf16 v[52:55], v[12:15], a[160:163], 0
    s_add_u32 m0, s32, 896
    s_nop 0
    buffer_load_dwordx4 v1, s[4:7], s35 offen offset:128 sc1 lds
    v_mfma_f32_16x16x32_bf16 v[44:47], a[0:3], v[16:19], 0
    v_mfma_f32_16x16x32_bf16 v[48:51], a[80:83], v[16:19], 0
    v_mfma_f32_16x16x32_bf16 v[56:59], v[16:19], a[160:163], 0
    ds_read_b128 v[12:15], v3 offset:1024
    ds_read_b128 v[16:19], v3 offset:21504
    s_waitcnt lgkmcnt(4)
    v_mfma_f32_16x16x32_bf16 v[36:39], a[4:7], v[20:23], v[36:39]
    s_add_u32 m0, s32, 1792
    s_nop 0
    buffer_load_dwordx4 v1, s[4:7], s35 offen offset:256 sc1 lds
    v_mfma_f32_16x16x32_bf16 v[40:43], a[84:87], v[20:23], v[40:43]
    v_mfma_f32_16x16x32_bf16 v[52:55], v[20:23], a[164:167], v[52:55]
    s_add_u32 m0, s32, 2688
    s_nop 0
    buffer_load_dwordx4 v1, s[4:7], s35 offen offset:384 sc1 lds
    v_mfma_f32_16x16x32_bf16 v[44:47], a[4:7], v[24:27], v[44:47]
    v_mfma_f32_16x16x32_bf16 v[48:51], a[84:87], v[24:27], v[48:51]
    v_mfma_f32_16x16x32_bf16 v[56:59], v[24:27], a[164:167], v[56:59]
    s_waitcnt vmcnt(10)
    s_barrier
    ds_read_b128 v[20:23], v2 offset:2048
    ds_read_b128 v[24:27], v2 offset:22528
    s_waitcnt lgkmcnt(4)
    v_mfma_f32_16x16x32_bf16 v[36:39], a[8:11], v[28:31], v[36:39]
    s_add_u32 m0, s32, 3584
    s_nop 0
    buffer_load_dwordx4 v1, s[4:7], s35 offen offset:512 sc1 lds
    v_mfma_f32_16x16x32_bf16 v[40:43], a[88:91], v[28:31], v[40:43]
    v_mfma_f32_16x16x32_bf16 v[52:55], v[28:31], a[168:171], v[52:55]
    s_add_u32 m0, s32, 4480
    s_nop 0
    buffer_load_dwordx4 v1, s[4:7], s35 offen offset:640 sc1 lds
    v_mfma_f32_16x16x32_bf16 v[44:47], a[8:11], v[32:35], v[44:47]
    v_mfma_f32_16x16x32_bf16 v[48:51], a[88:91], v[32:35], v[48:51]
    v_mfma_f32_16x16x32_bf16 v[56:59], v[32:35], a[168:171], v[56:59]
    ds_read_b128 v[28:31], v3 offset:2048
    ds_read_b128 v[32:35], v3 offset:22528
    s_waitcnt lgkmcnt(4)
    v_mfma_f32_16x16x32_bf16 v[36:39], a[12:15], v[12:15], v[36:39]
    s_add_u32 m0, s32, 5376
    s_nop 0
    buffer_load_dwordx4 v1, s[4:7], s35 offen offset:768 sc1 lds
    v_mfma_f32_16x16x32_bf16 v[40:43], a[92:95], v[12:15], v[40:43]
    v_mfma_f32_16x16x32_bf16 v[52:55], v[12:15], a[172:175], v[52:55]
    s_add_u32 m0, s32, 6272
    s_nop 0
    buffer_load_dwordx4 v1, s[4:7], s35 offen offset:896 sc1 lds
    v_mfma_f32_16x16x32_bf16 v[44:47], a[12:15], v[16:19], v[44:47]
    v_mfma_f32_16x16x32_bf16 v[48:51], a[92:95], v[16:19], v[48:51]
    v_mfma_f32_16x16x32_bf16 v[56:59], v[16:19], a[172:175], v[56:59]
    ds_read_b128 v[12:15], v2 offset:3072
    ds_read_b128 v[16:19], v2 offset:23552
    s_waitcnt lgkmcnt(4)
    v_mfma_f32_16x16x32_bf16 v[36:39], a[16:19], v[20:23], v[36:39]
    s_add_u32 m0, s32, 7168
    s_nop 0
    buffer_load_dwordx4 v1, s[4:7], s35 offen offset:1024 sc1 lds
    v_mfma_f32_16x16x32_bf16 v[40:43], a[96:99], v[20:23], v[40:43]
    v_mfma_f32_16x16x32_bf16 v[52:55], v[20:23], a[176:179], v[52:55]
    s_add_u32 m0, s32, 8064
    s_nop 0
    buffer_load_dwordx4 v1, s[4:7], s35 offen offset:1152 sc1 lds
    v_mfma_f32_16x16x32_bf16 v[44:47], a[16:19], v[24:27], v[44:47]
    v_mfma_f32_16x16x32_bf16 v[48:51], a[96:99], v[24:27], v[48:51]
    v_mfma_f32_16x16x32_bf16 v[56:59], v[24:27], a[176:179], v[56:59]
    ds_read_b128 v[20:23], v3 offset:3072
    ds_read_b128 v[24:27], v3 offset:23552
    s_waitcnt lgkmcnt(4)
    v_mfma_f32_16x16x32_bf16 v[36:39], a[20:23], v[28:31], v[36:39]
    v_mfma_f32_16x16x32_bf16 v[40:43], a[100:103], v[28:31], v[40:43]
    v_mfma_f32_16x16x32_bf16 v[52:55], v[28:31], a[180:183], v[52:55]
    v_mfma_f32_16x16x32_bf16 v[44:47], a[20:23], v[32:35], v[44:47]
    v_mfma_f32_16x16x32_bf16 v[48:51], a[100:103], v[32:35], v[48:51]
    v_mfma_f32_16x16x32_bf16 v[56:59], v[32:35], a[180:183], v[56:59]
    s_waitcnt vmcnt(13)
    s_barrier
    ds_read_b128 v[28:31], v2 offset:4096
    ds_read_b128 v[32:35], v2 offset:24576
    s_waitcnt lgkmcnt(4)
    v_mfma_f32_16x16x32_bf16 v[36:39], a[24:27], v[12:15], v[36:39]
    v_mfma_f32_16x16x32_bf16 v[40:43], a[104:107], v[12:15], v[40:43]
    v_mfma_f32_16x16x32_bf16 v[52:55], v[12:15], a[184:187], v[52:55]
    v_mfma_f32_16x16x32_bf16 v[44:47], a[24:27], v[16:19], v[44:47]
    v_mfma_f32_16x16x32_bf16 v[48:51], a[104:107], v[16:19], v[48:51]
    v_mfma_f32_16x16x32_bf16 v[56:59], v[16:19], a[184:187], v[56:59]
    ds_read_b128 v[12:15], v3 offset:4096
    ds_read_b128 v[16:19], v3 offset:24576
    s_waitcnt lgkmcnt(4)
    v_mfma_f32_16x16x32_bf16 v[36:39], a[28:31], v[20:23], v[36:39]
    v_mfma_f32_16x16x32_bf16 v[40:43], a[108:111], v[20:23], v[40:43]
    v_mfma_f32_16x16x32_bf16 v[52:55], v[20:23], a[188:191], v[52:55]
    v_mfma_f32_16x16x32_bf16 v[44:47], a[28:31], v[24:27], v[44:47]
    v_mfma_f32_16x16x32_bf16 v[48:51], a[108:111], v[24:27], v[48:51]
    v_mfma_f32_16x16x32_bf16 v[56:59], v[24:27], a[188:191], v[56:59]
    ds_read_b128 v[20:23], v2 offset:5120
    ds_read_b128 v[24:27], v2 offset:25600
    s_waitcnt lgkmcnt(4)
    v_mfma_f32_16x16x32_bf16 v[36:39], a[32:35], v[28:31], v[36:39]
    v_mfma_f32_16x16x32_bf16 v[40:43], a[112:115], v[28:31], v[40:43]
    v_mfma_f32_16x16x32_bf16 v[52:55], v[28:31], a[192:195], v[52:55]
    v_mfma_f32_16x16x32_bf16 v[44:47], a[32:35], v[32:35], v[44:47]
    v_mfma_f32_16x16x32_bf16 v[48:51], a[112:115], v[32:35], v[48:51]
    v_mfma_f32_16x16x32_bf16 v[56:59], v[32:35], a[192:195], v[56:59]
    ds_read_b128 v[28:31], v3 offset:5120
    ds_read_b128 v[32:35], v3 offset:25600
    s_waitcnt lgkmcnt(4)
    v_mfma_f32_16x16x32_bf16 v[36:39], a[36:39], v[12:15], v[36:39]
    v_mfma_f32_16x16x32_bf16 v[40:43], a[116:119], v[12:15], v[40:43]
    v_mfma_f32_16x16x32_bf16 v[52:55], v[12:15], a[196:199], v[52:55]
    v_mfma_f32_16x16x32_bf16 v[44:47], a[36:39], v[16:19], v[44:47]
    v_mfma_f32_16x16x32_bf16 v[48:51], a[116:119], v[16:19], v[48:51]
    v_mfma_f32_16x16x32_bf16 v[56:59], v[16:19], a[196:199], v[56:59]
    ds_read_b128 v[12:15], v2 offset:6144
    ds_read_b128 v[16:19], v2 offset:26624
    s_waitcnt lgkmcnt(4)
    v_mfma_f32_16x16x32_bf16 v[36:39], a[40:43], v[20:23], v[36:39]
    v_mfma_f32_16x16x32_bf16 v[40:43], a[120:123], v[20:23], v[40:43]
    v_mfma_f32_16x16x32_bf16 v[52:55], v[20:23], a[200:203], v[52:55]
    v_mfma_f32_16x16x32_bf16 v[44:47], a[40:43], v[24:27], v[44:47]
    v_mfma_f32_16x16x32_bf16 v[48:51], a[120:123], v[24:27], v[48:51]
    v_mfma_f32_16x16x32_bf16 v[56:59], v[24:27], a[200:203], v[56:59]
    ds_read_b128 v[20:23], v3 offset:6144
    ds_read_b128 v[24:27], v3 offset:26624
    s_waitcnt lgkmcnt(4)
    v_mfma_f32_16x16x32_bf16 v[36:39], a[44:47], v[28:31], v[36:39]
    v_mfma_f32_16x16x32_bf16 v[40:43], a[124:127], v[28:31], v[40:43]
    v_mfma_f32_16x16x32_bf16 v[52:55], v[28:31], a[204:207], v[52:55]
    v_mfma_f32_16x16x32_bf16 v[44:47], a[44:47], v[32:35], v[44:47]
    v_mfma_f32_16x16x32_bf16 v[48:51], a[124:127], v[32:35], v[48:51]
    v_mfma_f32_16x16x32_bf16 v[56:59], v[32:35], a[204:207], v[56:59]
    s_waitcnt vmcnt(10)
    s_barrier
    ds_read_b128 v[28:31], v2 offset:7168
    ds_read_b128 v[32:35], v2 offset:27648
    s_cmp_eq_u32 s37, 0
    s_cbranch_scc1 L_P_nofl_6
    v_mov_b32 v8, s37
    s_mov_b64 exec, 1
    buffer_store_dword v8, v0, s[4:7], s36 offen offset:0 sc1
    s_mov_b64 exec, -1
L_P_nofl_6:
    s_waitcnt lgkmcnt(4)
    v_mfma_f32_16x16x32_bf16 v[36:39], a[48:51], v[12:15], v[36:39]
    v_mfma_f32_16x16x32_bf16 v[40:43], a[128:131], v[12:15], v[40:43]
    v_mfma_f32_16x16x32_bf16 v[52:55], v[12:15], a[208:211], v[52:55]
    v_mfma_f32_16x16x32_bf16 v[44:47], a[48:51], v[16:19], v[44:47]
    v_mfma_f32_16x16x32_bf16 v[48:51], a[128:131], v[16:19], v[48:51]
    v_mfma_f32_16x16x32_bf16 v[56:59], v[16:19], a[208:211], v[56:59]
    ds_read_b128 v[12:15], v3 offset:7168
    ds_read_b128 v[16:19], v3 offset:27648
    s_waitcnt lgkmcnt(4)
    v_mfma_f32_16x16x32_bf16 v[36:39], a[52:55], v[20:23], v[36:39]
    v_mfma_f32_16x16x32_bf16 v[40:43], a[132:135], v[20:23], v[40:43]
    v_mfma_f32_16x16x32_bf16 v[52:55], v[20:23], a[212:215], v[52:55]
    v_mfma_f32_16x16x32_bf16 v[44:47], a[52:55], v[24:27], v[44:47]
    v_mfma_f32_16x16x32_bf16 v[48:51], a[132:135], v[24:27], v[48:51]
    v_mfma_f32_16x16x32_bf16 v[56:59], v[24:27], a[212:215], v[56:59]
    ds_read_b128 v[20:23], v2 offset:8192
    ds_read_b128 v[24:27], v2 offset:28672
    s_waitcnt lgkmcnt(4)
    v_mfma_f32_16x16x32_bf16 v[36:39], a[56:59], v[28:31], v[36:39]
    v_mfma_f32_16x16x32_bf16 v[40:43], a[136:139], v[28:31], v[40:43]
    v_mfma_f32_16x16x32_bf16 v[52:55], v[28:31], a[216:219], v[52:55]
    v_mfma_f32_16x16x32_bf16 v[44:47], a[56:59], v[32:35], v[44:47]
    v_mfma_f32_16x16x32_bf16 v[48:51], a[136:139], v[32:35], v[48:51]
    v_mfma_f32_16x16x32_bf16 v[56:59], v[32:35], a[216:219], v[56:59]
    ds_read_b128 v[28:31], v3 offset:8192
    ds_read_b128 v[32:35], v3 offset:28672
    s_waitcnt lgkmcnt(4)
    v_mfma_f32_16x16x32_bf16 v[36:39], a[60:63], v[12:15], v[36:39]
    v_mfma_f32_16x16x32_bf16 v[40:43], a[140:143], v[12:15], v[40:43]
    v_mfma_f32_16x16x32_bf16 v[52:55], v[12:15], a[220:223], v[52:55]
    v_mfma_f32_16x16x32_bf16 v[44:47], a[60:63], v[16:19], v[44:47]
    v_mfma_f32_16x16x32_bf16 v[48:51], a[140:143], v[16:19], v[48:51]
    v_mfma_f32_16x16x32_bf16 v[56:59], v[16:19], a[220:223], v[56:59]
    ds_read_b128 v[12:15], v2 offset:9216
    ds_read_b128 v[16:19], v2 offset:29696
    s_waitcnt lgkmcnt(4)
    v_mfma_f32_16x16x32_bf16 v[36:39], a[64:67], v[20:23], v[36:39]
    v_mfma_f32_16x16x32_bf16 v[40:43], a[144:147], v[20:23], v[40:43]
    v_mfma_f32_16x16x32_bf16 v[52:55], v[20:23], a[224:227], v[52:55]
    v_mfma_f32_16x16x32_bf16 v[44:47], a[64:67], v[24:27], v[44:47]
    v_mfma_f32_16x16x32_bf16 v[48:51], a[144:147], v[24:27], v[48:51]
    v_mfma_f32_16x16x32_bf16 v[56:59], v[24:27], a[224:227], v[56:59]
    ds_read_b128 v[20:23], v3 offset:9216
    ds_read_b128 v[24:27], v3 offset:29696
    s_waitcnt lgkmcnt(4)
    v_mfma_f32_16x16x32_bf16 v[36:39], a[68:71], v[28:31], v[36:39]
    v_mfma_f32_16x16x32_bf16 v[40:43], a[148:151], v[28:31], v[40:43]
    v_mfma_f32_16x16x32_bf16 v[52:55], v[28:31], a[228:231], v[52:55]
    v_mfma_f32_16x16x32_bf16 v[44:47], a[68:71], v[32:35], v[44:47]
    v_mfma_f32_16x16x32_bf16 v[48:51], a[148:151], v[32:35], v[48:51]
    v_mfma_f32_16x16x32_bf16 v[56:59], v[32:35], a[228:231], v[56:59]
    s_waitcnt lgkmcnt(2)
    v_mfma_f32_16x16x32_bf16 v[36:39], a[72:75], v[12:15], v[36:39]
    v_mfma_f32_16x16x32_bf16 v[40:43], a[152:155], v[12:15], v[40:43]
    v_mfma_f32_16x16x32_bf16 v[52:55], v[12:15], a[232:235], v[52:55]
    v_mfma_f32_16x16x32_bf16 v[44:47], a[72:75], v[16:19], v[44:47]
    v_mfma_f32_16x16x32_bf16 v[48:51], a[152:155], v[16:19], v[48:51]
    v_mfma_f32_16x16x32_bf16 v[56:59], v[16:19], a[232:235], v[56:59]
    s_waitcnt lgkmcnt(0)
    v_mfma_f32_16x16x32_bf16 v[36:39], a[76:79], v[20:23], v[36:39]
    v_mfma_f32_16x16x32_bf16 v[40:43], a[156:159], v[20:23], v[40:43]
    v_mfma_f32_16x16x32_bf16 v[52:55], v[20:23], a[236:239], v[52:55]
    v_mfma_f32_16x16x32_bf16 v[44:47], a[76:79], v[24:27], v[44:47]
    v_mfma_f32_16x16x32_bf16 v[48:51], a[156:159], v[24:27], v[48:51]
    v_mfma_f32_16x16x32_bf16 v[56:59], v[24:27], a[236:239], v[56:59]
    s_mul_i32 s40, s24, s28
    s_add_u32 s40, s40, s27
    s_add_u32 s41, s40, s29
    s_mul_i32 s42, s24, 786432
    s_add_u32 s42, s42, s30
    v_cvt_pk_bf16_f32 v60, v36, v37
    v_cvt_pk_bf16_f32 v61, v38, v39
    v_cvt_pk_bf16_f32 v62, v40, v41
    v_cvt_pk_bf16_f32 v63, v42, v43
    buffer_store_dwordx4 v[60:63], v0, s[4:7], s40 offen sc1
    v_cvt_pk_bf16_f32 v64, v44, v45
    v_cvt_pk_bf16_f32 v65, v46, v47
    v_cvt_pk_bf16_f32 v66, v48, v49
    v_cvt_pk_bf16_f32 v67, v50, v51
    buffer_store_dwordx4 v[64:67], v0, s[4:7], s41 offen sc1
    v_cvt_pk_bf16_f32 v68, v52, v53
    v_cvt_pk_bf16_f32 v69, v54, v55
    v_cvt_pk_bf16_f32 v70, v56, v57
    v_cvt_pk_bf16_f32 v71, v58, v59
    buffer_store_dwordx4 v[68:71], v0, s[4:7], s42 offen sc1
    s_branch L_P_top
L_P_late:
    s_waitcnt vmcnt(8)
    s_barrier
    ds_read_b128 v[12:15], v2 offset:0
    ds_read_b128 v[16:19], v2 offset:20480
    ds_read_b128 v[20:23], v3 offset:0
    ds_read_b128 v[24:27], v3 offset:20480
    ds_read_b128 v[28:31], v2 offset:1024
    ds_read_b128 v[32:35], v2 offset:21504
    s_waitcnt lgkmcnt(4)
    v_mfma_f32_16x16x32_bf16 v[36:39], a[0:3], v[12:15], 0
    v_mfma_f32_16x16x32_bf16 v[40:43], a[80:83], v[12:15], 0
    v_mfma_f32_16x16x32_bf16 v[52:55], v[12:15], a[160:163], 0
    v_mfma_f32_16x16x32_bf16 v[44:47], a[0:3], v[16:19], 0
    v_mfma_f32_16x16x32_bf16 v[48:51], a[80:83], v[16:19], 0
    v_mfma_f32_16x16x32_bf16 v[56:59], v[16:19], a[160:163], 0
    ds_read_b128 v[12:15], v3 offset:1024
    ds_read_b128 v[16:19], v3 offset:21504
    s_waitcnt lgkmcnt(4)
    v_mfma_f32_16x16x32_bf16 v[36:39], a[4:7], v[20:23], v[36:39]
    v_mfma_f32_16x16x32_bf16 v[40:43], a[84:87], v[20:23], v[40:43]
    v_mfma_f32_16x16x32_bf16 v[52:55], v[20:23], a[164:167], v[52:55]
    v_mfma_f32_16x16x32_bf16 v[44:47], a[4:7], v[24:27], v[44:47]
    v_mfma_f32_16x16x32_bf16 v[48:51], a[84:87], v[24:27], v[48:51]
    v_mfma_f32_16x16x32_bf16 v[56:59], v[24:27], a[164:167], v[56:59]
    s_waitcnt vmcnt(6)
    s_barrier
    ds_read_b128 v[20:23], v2 offset:2048
    ds_read_b128 v[24:27], v2 offset:22528
    s_waitcnt lgkmcnt(4)
    v_mfma_f32_16x16x32_bf16 v[36:39], a[8:11], v[28:31], v[36:39]
    v_mfma_f32_16x16x32_bf16 v[40:43], a[88:91], v[28:31], v[40:43]
    v_mfma_f32_16x16x32_bf16 v[52:55], v[28:31], a[168:171], v[52:55]
    v_mfma_f32_16x16x32_bf16 v[44:47], a[8:11], v[32:35], v[44:47]
    v_mfma_f32_16x16x32_bf16 v[48:51], a[88:91], v[32:35], v[48:51]
    v_mfma_f32_16x16x32_bf16 v[56:59], v[32:35], a[168:171], v[56:59]
    ds_read_b128 v[28:31], v3 offset:2048
    ds_read_b128 v[32:35], v3 offset:22528
    s_waitcnt lgkmcnt(4)
    v_mfma_f32_16x16x32_bf16 v[36:39], a[12:15], v[12:15], v[36:39]
    v_mfma_f32_16x16x32_bf16 v[40:43], a[92:95], v[12:15], v[40:43]
    v_mfma_f32_16x16x32_bf16 v[52:55], v[12:15], a[172:175], v[52:55]
    v_mfma_f32_16x16x32_bf16 v[44:47], a[12:15], v[16:19], v[44:47]
    v_mfma_f32_16x16x32_bf16 v[48:51], a[92:95], v[16:19], v[48:51]
    v_mfma_f32_16x16x32_bf16 v[56:59], v[16:19], a[172:175], v[56:59]
    ds_read_b128 v[12:15], v2 offset:3072
    ds_read_b128 v[16:19], v2 offset:23552
    s_waitcnt lgkmcnt(4)
    v_mfma_f32_16x16x32_bf16 v[36:39], a[16:19], v[20:23], v[36:39]
    v_mfma_f32_16x16x32_bf16 v[40:43], a[96:99], v[20:23], v[40:43]
    v_mfma_f32_16x16x32_bf16 v[52:55], v[20:23], a[176:179], v[52:55]
    v_mfma_f32_16x16x32_bf16 v[44:47], a[16:19], v[24:27], v[44:47]
    v_mfma_f32_16x16x32_bf16 v[48:51], a[96:99], v[24:27], v[48:51]
    v_mfma_f32_16x16x32_bf16 v[56:59], v[24:27], a[176:179], v[56:59]
    ds_read_b128 v[20:23], v3 offset:3072
    ds_read_b128 v[24:27], v3 offset:23552
    s_waitcnt lgkmcnt(4)
    v_mfma_f32_16x16x32_bf16 v[36:39], a[20:23], v[28:31], v[36:39]
    v_mfma_f32_16x16x32_bf16 v[40:43], a[100:103], v[28:31], v[40:43]
    v_mfma_f32_16x16x32_bf16 v[52:55], v[28:31], a[180:183], v[52:55]
    v_mfma_f32_16x16x32_bf16 v[44:47], a[20:23], v[32:35], v[44:47]
    v_mfma_f32_16x16x32_bf16 v[48:51], a[100:103], v[32:35], v[48:51]
    v_mfma_f32_16x16x32_bf16 v[56:59], v[32:35], a[180:183], v[56:59]
    s_waitcnt vmcnt(3)
    s_barrier
    ds_read_b128 v[28:31], v2 offset:4096
    ds_read_b128 v[32:35], v2 offset:24576
    s_waitcnt lgkmcnt(4)
    v_mfma_f32_16x16x32_bf16 v[36:39], a[24:27], v[12:15], v[36:39]
    v_mfma_f32_16x16x32_bf16 v[40:43], a[104:107], v[12:15], v[40:43]
    v_mfma_f32_16x16x32_bf16 v[52:55], v[12:15], a[184:187], v[52:55]
    v_mfma_f32_16x16x32_bf16 v[44:47], a[24:27], v[16:19], v[44:47]
    v_mfma_f32_16x16x32_bf16 v[48:51], a[104:107], v[16:19], v[48:51]
    v_mfma_f32_16x16x32_bf16 v[56:59], v[16:19], a[184:187], v[56:59]
    ds_read_b128 v[12:15], v3 offset:4096
    ds_read_b128 v[16:19], v3 offset:24576
    s_waitcnt lgkmcnt(4)
    v_mfma_f32_16x16x32_bf16 v[36:39], a[28:31], v[20:23], v[36:39]
    v_mfma_f32_16x16x32_bf16 v[40:43], a[108:111], v[20:23], v[40:43]
    v_mfma_f32_16x16x32_bf16 v[52:55], v[20:23], a[188:191], v[52:55]
    v_mfma_f32_16x16x32_bf16 v[44:47], a[28:31], v[24:27], v[44:47]
    v_mfma_f32_16x16x32_bf16 v[48:51], a[108:111], v[24:27], v[48:51]
    v_mfma_f32_16x16x32_bf16 v[56:59], v[24:27], a[188:191], v[56:59]
    ds_read_b128 v[20:23], v2 offset:5120
    ds_read_b128 v[24:27], v2 offset:25600
    s_waitcnt lgkmcnt(4)
    v_mfma_f32_16x16x32_bf16 v[36:39], a[32:35], v[28:31], v[36:39]
    v_mfma_f32_16x16x32_bf16 v[40:43], a[112:115], v[28:31], v[40:43]
    v_mfma_f32_16x16x32_bf16 v[52:55], v[28:31], a[192:195], v[52:55]
    v_mfma_f32_16x16x32_bf16 v[44:47], a[32:35], v[32:35], v[44:47]
    v_mfma_f32_16x16x32_bf16 v[48:51], a[112:115], v[32:35], v[48:51]
    v_mfma_f32_16x16x32_bf16 v[56:59], v[32:35], a[192:195], v[56:59]
    ds_read_b128 v[28:31], v3 offset:5120
    ds_read_b128 v[32:35], v3 offset:25600
    s_waitcnt lgkmcnt(4)
    v_mfma_f32_16x16x32_bf16 v[36:39], a[36:39], v[12:15], v[36:39]
    v_mfma_f32_16x16x32_bf16 v[40:43], a[116:119], v[12:15], v[40:43]
    v_mfma_f32_16x16x32_bf16 v[52:55], v[12:15], a[196:199], v[52:55]
    v_mfma_f32_16x16x32_bf16 v[44:47], a[36:39], v[16:19], v[44:47]
    v_mfma_f32_16x16x32_bf16 v[48:51], a[116:119], v[16:19], v[48:51]
    v_mfma_f32_16x16x32_bf16 v[56:59], v[16:19], a[196:199], v[56:59]
    ds_read_b128 v[12:15], v2 offset:6144
    ds_read_b128 v[16:19], v2 offset:26624
    s_waitcnt lgkmcnt(4)
    v_mfma_f32_16x16x32_bf16 v[36:39], a[40:43], v[20:23], v[36:39]
    v_mfma_f32_16x16x32_bf16 v[40:43], a[120:123], v[20:23], v[40:43]
    v_mfma_f32_16x16x32_bf16 v[52:55], v[20:23], a[200:203], v[52:55]
    v_mfma_f32_16x16x32_bf16 v[44:47], a[40:43], v[24:27], v[44:47]
    v_mfma_f32_16x16x32_bf16 v[48:51], a[120:123], v[24:27], v[48:51]
    v_mfma_f32_16x16x32_bf16 v[56:59], v[24:27], a[200:203], v[56:59]
    ds_read_b128 v[20:23], v3 offset:6144
    ds_read_b128 v[24:27], v3 offset:26624
    s_waitcnt lgkmcnt(4)
    v_mfma_f32_16x16x32_bf16 v[36:39], a[44:47], v[28:31], v[36:39]
    v_mfma_f32_16x16x32_bf16 v[40:43], a[124:127], v[28:31], v[40:43]
    v_mfma_f32_16x16x32_bf16 v[52:55], v[28:31], a[204:207], v[52:55]
    v_mfma_f32_16x16x32_bf16 v[44:47], a[44:47], v[32:35], v[44:47]
    v_mfma_f32_16x16x32_bf16 v[48:51], a[124:127], v[32:35], v[48:51]
    v_mfma_f32_16x16x32_bf16 v[56:59], v[32:35], a[204:207], v[56:59]
    s_waitcnt vmcnt(0)
    s_barrier
    ds_read_b128 v[28:31], v2 offset:7168
    ds_read_b128 v[32:35], v2 offset:27648
    s_cmp_eq_u32 s37, 0
    s_cbranch_scc1 L_P_nofl_7
    v_mov_b32 v8, s37
    s_mov_b64 exec, 1
    buffer_store_dword v8, v0, s[4:7], s36 offen offset:0 sc1
    s_mov_b64 exec, -1
L_P_nofl_7:
    s_waitcnt lgkmcnt(4)
    v_mfma_f32_16x16x32_bf16 v[36:39], a[48:51], v[12:15], v[36:39]
    v_mfma_f32_16x16x32_bf16 v[40:43], a[128:131], v[12:15], v[40:43]
    v_mfma_f32_16x16x32_bf16 v[52:55], v[12:15], a[208:211], v[52:55]
    v_mfma_f32_16x16x32_bf16 v[44:47], a[48:51], v[16:19], v[44:47]
    v_mfma_f32_16x16x32_bf16 v[48:51], a[128:131], v[16:19], v[48:51]
    v_mfma_f32_16x16x32_bf16 v[56:59], v[16:19], a[208:211], v[56:59]
    ds_read_b128 v[12:15], v3 offset:7168
    ds_read_b128 v[16:19], v3 offset:27648
    s_waitcnt lgkmcnt(4)
    v_mfma_f32_16x16x32_bf16 v[36:39], a[52:55], v[20:23], v[36:39]
    v_mfma_f32_16x16x32_bf16 v[40:43], a[132:135], v[20:23], v[40:43]
    v_mfma_f32_16x16x32_bf16 v[52:55], v[20:23], a[212:215], v[52:55]
    v_mfma_f32_16x16x32_bf16 v[44:47], a[52:55], v[24:27], v[44:47]
    v_mfma_f32_16x16x32_bf16 v[48:51], a[132:135], v[24:27], v[48:51]
    v_mfma_f32_16x16x32_bf16 v[56:59], v[24:27], a[212:215], v[56:59]
    ds_read_b128 v[20:23], v2 offset:8192
    ds_read_b128 v[24:27], v2 offset:28672
    s_waitcnt lgkmcnt(4)
    v_mfma_f32_16x16x32_bf16 v[36:39], a[56:59], v[28:31], v[36:39]
    v_mfma_f32_16x16x32_bf16 v[40:43], a[136:139], v[28:31], v[40:43]
    v_mfma_f32_16x16x32_bf16 v[52:55], v[28:31], a[216:219], v[52:55]
    v_mfma_f32_16x16x32_bf16 v[44:47], a[56:59], v[32:35], v[44:47]
    v_mfma_f32_16x16x32_bf16 v[48:51], a[136:139], v[32:35], v[48:51]
    v_mfma_f32_16x16x32_bf16 v[56:59], v[32:35], a[216:219], v[56:59]
    ds_read_b128 v[28:31], v3 offset:8192
    ds_read_b128 v[32:35], v3 offset:28672
    s_waitcnt lgkmcnt(4)
    v_mfma_f32_16x16x32_bf16 v[36:39], a[60:63], v[12:15], v[36:39]
    v_mfma_f32_16x16x32_bf16 v[40:43], a[140:143], v[12:15], v[40:43]
    v_mfma_f32_16x16x32_bf16 v[52:55], v[12:15], a[220:223], v[52:55]
    v_mfma_f32_16x16x32_bf16 v[44:47], a[60:63], v[16:19], v[44:47]
    v_mfma_f32_16x16x32_bf16 v[48:51], a[140:143], v[16:19], v[48:51]
    v_mfma_f32_16x16x32_bf16 v[56:59], v[16:19], a[220:223], v[56:59]
    ds_read_b128 v[12:15], v2 offset:9216
    ds_read_b128 v[16:19], v2 offset:29696
    s_waitcnt lgkmcnt(4)
    v_mfma_f32_16x16x32_bf16 v[36:39], a[64:67], v[20:23], v[36:39]
    v_mfma_f32_16x16x32_bf16 v[40:43], a[144:147], v[20:23], v[40:43]
    v_mfma_f32_16x16x32_bf16 v[52:55], v[20:23], a[224:227], v[52:55]
    v_mfma_f32_16x16x32_bf16 v[44:47], a[64:67], v[24:27], v[44:47]
    v_mfma_f32_16x16x32_bf16 v[48:51], a[144:147], v[24:27], v[48:51]
    v_mfma_f32_16x16x32_bf16 v[56:59], v[24:27], a[224:227], v[56:59]
    ds_read_b128 v[20:23], v3 offset:9216
    ds_read_b128 v[24:27], v3 offset:29696
    s_waitcnt lgkmcnt(4)
    v_mfma_f32_16x16x32_bf16 v[36:39], a[68:71], v[28:31], v[36:39]
    v_mfma_f32_16x16x32_bf16 v[40:43], a[148:151], v[28:31], v[40:43]
    v_mfma_f32_16x16x32_bf16 v[52:55], v[28:31], a[228:231], v[52:55]
    v_mfma_f32_16x16x32_bf16 v[44:47], a[68:71], v[32:35], v[44:47]
    v_mfma_f32_16x16x32_bf16 v[48:51], a[148:151], v[32:35], v[48:51]
    v_mfma_f32_16x16x32_bf16 v[56:59], v[32:35], a[228:231], v[56:59]
    s_waitcnt lgkmcnt(2)
    v_mfma_f32_16x16x32_bf16 v[36:39], a[72:75], v[12:15], v[36:39]
    v_mfma_f32_16x16x32_bf16 v[40:43], a[152:155], v[12:15], v[40:43]
    v_mfma_f32_16x16x32_bf16 v[52:55], v[12:15], a[232:235], v[52:55]
    v_mfma_f32_16x16x32_bf16 v[44:47], a[72:75], v[16:19], v[44:47]
    v_mfma_f32_16x16x32_bf16 v[48:51], a[152:155], v[16:19], v[48:51]
    v_mfma_f32_16x16x32_bf16 v[56:59], v[16:19], a[232:235], v[56:59]
    s_waitcnt lgkmcnt(0)
    v_mfma_f32_16x16x32_bf16 v[36:39], a[76:79], v[20:23], v[36:39]
    v_mfma_f32_16x16x32_bf16 v[40:43], a[156:159], v[20:23], v[40:43]
    v_mfma_f32_16x16x32_bf16 v[52:55], v[20:23], a[236:239], v[52:55]
    v_mfma_f32_16x16x32_bf16 v[44:47], a[76:79], v[24:27], v[44:47]
    v_mfma_f32_16x16x32_bf16 v[48:51], a[156:159], v[24:27], v[48:51]
    v_mfma_f32_16x16x32_bf16 v[56:59], v[24:27], a[236:239], v[56:59]
    s_mul_i32 s40, s24, s28
    s_add_u32 s40, s40, s27
    s_add_u32 s41, s40, s29
    s_mul_i32 s42, s24, 786432
    s_add_u32 s42, s42, s30
    v_cvt_pk_bf16_f32 v60, v36, v37
    v_cvt_pk_bf16_f32 v61, v38, v39
    v_cvt_pk_bf16_f32 v62, v40, v41
    v_cvt_pk_bf16_f32 v63, v42, v43
    buffer_store_dwordx4 v[60:63], v0, s[4:7], s40 offen sc1
    v_cvt_pk_bf16_f32 v64, v44, v45
    v_cvt_pk_bf16_f32 v65, v46, v47
    v_cvt_pk_bf16_f32 v66, v48, v49
    v_cvt_pk_bf16_f32 v67, v50, v51
    buffer_store_dwordx4 v[64:67], v0, s[4:7], s41 offen sc1
    v_cvt_pk_bf16_f32 v68, v52, v53
    v_cvt_pk_bf16_f32 v69, v54, v55
    v_cvt_pk_bf16_f32 v70, v56, v57
    v_cvt_pk_bf16_f32 v71, v58, v59
    buffer_store_dwordx4 v[68:71], v0, s[4:7], s42 offen sc1
    buffer_load_dword v7, v5, s[4:7], s39 offen sc1
    s_waitcnt vmcnt(0)
    v_mov_b32 v8, s45
    s_mov_b64 exec, 1
    buffer_store_dword v8, v0, s[4:7], s44 offen offset:0 sc1
    s_mov_b64 exec, -1
    s_mov_b32 s45, 0
    s_cmp_ge_u32 s26, 64
    s_cbranch_scc1 L_P_end
    s_mov_b32 s19, 0
    v_cmp_gt_u32 vcc, s38, v7
    s_nop 0
    s_cbranch_vccnz L_P_flspin_9
L_P_fl_8:
    s_add_u32 m0, s32, 0
    s_nop 0
    buffer_load_dwordx4 v1, s[4:7], s35 offen offset:0 sc1 lds
    s_add_u32 m0, s32, 896
    s_nop 0
    buffer_load_dwordx4 v1, s[4:7], s35 offen offset:128 sc1 lds
    s_add_u32 m0, s32, 1792
    s_nop 0
    buffer_load_dwordx4 v1, s[4:7], s35 offen offset:256 sc1 lds
    s_add_u32 m0, s32, 2688
    s_nop 0
    buffer_load_dwordx4 v1, s[4:7], s35 offen offset:384 sc1 lds
    s_add_u32 m0, s32, 3584
    s_nop 0
    buffer_load_dwordx4 v1, s[4:7], s35 offen offset:512 sc1 lds
    s_add_u32 m0, s32, 4480
    s_nop 0
    buffer_load_dwordx4 v1, s[4:7], s35 offen offset:640 sc1 lds
    s_add_u32 m0, s32, 5376
    s_nop 0
    buffer_load_dwordx4 v1, s[4:7], s35 offen offset:768 sc1 lds
    s_add_u32 m0, s32, 6272
    s_nop 0
    buffer_load_dwordx4 v1, s[4:7], s35 offen offset:896 sc1 lds
    s_add_u32 m0, s32, 7168
    s_nop 0
    buffer_load_dwordx4 v1, s[4:7], s35 offen offset:1024 sc1 lds
    s_add_u32 m0, s32, 8064
    s_nop 0
    buffer_load_dwordx4 v1, s[4:7], s35 offen offset:1152 sc1 lds
    s_branch L_P_top
L_P_end:
    s_waitcnt vmcnt(0)
    s_endpgm
L_P_flspin_5:
    buffer_load_dword v7, v4, s[4:7], s39 offen offset:8 sc1
    s_add_u32 s19, s19, 1
    s_cmp_ge_u32 s19, 524288
    s_cbranch_scc1 L_fail
    s_waitcnt vmcnt(0)
    v_cmp_gt_u32 vcc, 1, v7
    s_nop 0
    s_cbranch_vccnz L_P_flspin_5
    s_branch L_P_fl_4
L_P_flspin_9:
    buffer_load_dword v7, v5, s[4:7], s39 offen sc1
    s_add_u32 s19, s19, 1
    s_cmp_ge_u32 s19, 524288
    s_cbranch_scc1 L_fail
    s_waitcnt vmcnt(0)
    v_cmp_gt_u32 vcc, s38, v7
    s_nop 0
    s_cbranch_vccnz L_P_flspin_9
    s_branch L_P_fl_8
L_roleO:
    v_lshlrev_b32 v16, 4, v0
    s_sub_u32 s27, s13, 160
    s_lshr_b32 s20, s27, 5
    s_and_b32 s21, s27, 31
    s_lshl_b32 s24, s13, 2
    s_add_u32 s24, s24, s12
    s_lshl_b32 s24, s24, 7
    s_add_u32 s24, s24, 0
    v_mov_b32 v20, 0
    v_mov_b32 v21, 0
    v_mov_b32 v22, 0
    v_mov_b32 v23, 0
    s_mov_b64 exec, 1
    buffer_store_dwordx4 v[20:23], v16, s[4:7], s24 offen sc1
    s_lshl_b32 s14, s13, 7
    s_add_u32 s14, s14, 139264
    buffer_store_dwordx4 v[20:23], v16, s[4:7], s14 offen sc1
    s_mov_b64 exec, -1
    s_mul_i32 s36, s27, 40960
    s_add_u32 s36, s36, 209321984
    s_mul_i32 s28, s12, 10240
    s_add_u32 s28, s28, s36
    buffer_store_dwordx4 v[20:23], v16, s[4:7], s28 offen sc1
    s_add_u32 s28, s28, 1024
    buffer_store_dwordx4 v[20:23], v16, s[4:7], s28 offen sc1
    s_add_u32 s28, s28, 1024
    buffer_store_dwordx4 v[20:23], v16, s[4:7], s28 offen sc1
    s_add_u32 s28, s28, 1024
    buffer_store_dwordx4 v[20:23], v16, s[4:7], s28 offen sc1
    s_add_u32 s28, s28, 1024
    buffer_store_dwordx4 v[20:23], v16, s[4:7], s28 offen sc1
    s_add_u32 s28, s28, 1024
    buffer_store_dwordx4 v[20:23], v16, s[4:7], s28 offen sc1
    s_add_u32 s28, s28, 1024
    buffer_store_dwordx4 v[20:23], v16, s[4:7], s28 offen sc1
    s_add_u32 s28, s28, 1024
    buffer_store_dwordx4 v[20:23], v16, s[4:7], s28 offen sc1
    s_add_u32 s28, s28, 1024
    buffer_store_dwordx4 v[20:23], v16, s[4:7], s28 offen sc1
    s_add_u32 s28, s28, 1024
    buffer_store_dwordx4 v[20:23], v16, s[4:7], s28 offen sc1
    s_add_u32 s28, s28, 2612224
    buffer_store_dwordx4 v[20:23], v16, s[4:7], s28 offen sc1
    s_add_u32 s28, s28, 1024
    buffer_store_dwordx4 v[20:23], v16, s[4:7], s28 offen sc1
    s_add_u32 s28, s28, 1024
    buffer_store_dwordx4 v[20:23], v16, s[4:7], s28 offen sc1
    s_add_u32 s28, s28, 1024
    buffer_store_dwordx4 v[20:23], v16, s[4:7], s28 offen sc1
    s_add_u32 s28, s28, 1024
    buffer_store_dwordx4 v[20:23], v16, s[4:7], s28 offen sc1
    s_add_u32 s28, s28, 1024
    buffer_store_dwordx4 v[20:23], v16, s[4:7], s28 offen sc1
    s_add_u32 s28, s28, 1024
    buffer_store_dwordx4 v[20:23], v16, s[4:7], s28 offen sc1
    s_add_u32 s28, s28, 1024
    buffer_store_dwordx4 v[20:23], v16, s[4:7], s28 offen sc1
    s_add_u32 s28, s28, 1024
    buffer_store_dwordx4 v[20:23], v16, s[4:7], s28 offen sc1
    s_add_u32 s28, s28, 1024
    buffer_store_dwordx4 v[20:23], v16, s[4:7], s28 offen sc1
    s_add_u32 s28, s28, 1024
    s_mul_i32 s3, s12, 20
    v_and_b32 v24, 15, v0
    v_lshrrev_b32 v25, 4, v0
    v_add_u32 v26, s3, v24
    v_mul_u32_u24 v6, 1280, v25
    v_lshl_add_u32 v6, v26, 4, v6
    v_and_b32 v27, 3, v0
    v_add3_u32 v27, v27, s3, 16
    v_lshrrev_b32 v7, 2, v0
    v_mul_u32_u24 v7, 1280, v7
    v_lshl_add_u32 v7, v27, 4, v7
    v_mov_b32 v28, 2147483632
    v_cmp_gt_u32 vcc, 16, v0
    s_nop 1
    v_cndmask_b32 v210, v28, v6, vcc
    v_cmp_gt_u32 vcc, 4, v0
    s_nop 1
    v_cndmask_b32 v209, v28, v7, vcc
    v_cmp_gt_u32 vcc, 32, v0
    s_nop 1
    v_cndmask_b32 v26, v27, v26, vcc
    v_cmp_gt_u32 s[90:91], 4, v24
    s_or_b64 s[90:91], s[90:91], vcc
    v_and_b32 v25, 1, v25
    v_lshlrev_b32 v8, 4, v26
    v_lshrrev_b32 v9, 2, v26
    v_lshlrev_b32 v9, 6, v9
    v_lshl_add_u32 v9, v25, 5, v9
    v_and_b32 v26, 3, v26
    v_lshl_add_u32 v9, v26, 3, v9
    s_mov_b32 s3, 15728640
    v_mul_lo_u32 v17, v25, s3
    v_add_u32 v17, v17, v8
    s_mov_b32 s3, 5242880
    v_mul_lo_u32 v25, v25, s3
    v_add_u32 v8, v25, v8
    s_mov_b32 s92, s64
    s_and_b32 s93, s65, 0xffff
    s_mov_b32 s94, 2621440
    s_mov_b32 s95, 0x20000
    s_lshl_b32 s3, s12, 3
    s_add_u32 s3, s3, 106496
    v_mov_b32 v11, s3
    v_mov_b32 v213, 106496
    s_waitcnt vmcnt(0)
    s_barrier
    s_cmp_lg_u32 s12, 0
    s_cbranch_scc1 L_O_arr_1
    s_lshl_b32 s3, s18, 2
    s_add_u32 s3, s3, 64
    v_mov_b32 v92, s3
    v_mov_b32 v93, 1
    s_mov_b64 exec, 1
    global_atomic_add v92, v93, s[16:17] sc1
    s_waitcnt vmcnt(0)
    s_mov_b64 exec, -1
L_O_arr_1:
    s_lshl_b32 s3, s18, 2
    s_add_u32 s3, s3, 64
    v_mov_b32 v92, s3
    v_lshlrev_b32 v94, 2, v0
    v_and_b32 v94, 28, v94
    s_mov_b32 s19, 0
L_O_warr_2:
    global_load_dword v93, v92, s[16:17] sc1
    s_add_u32 s19, s19, 1
    s_cmp_ge_u32 s19, 524288
    s_cbranch_scc1 L_fail
    s_waitcnt vmcnt(0)
    v_cmp_gt_u32 vcc, 256, v93
    s_nop 0
    s_cbranch_vccnz L_O_warr_2
    s_cmp_lg_u32 s18, 0
    s_cbranch_scc1 L_O_placed_3
    global_load_dword v93, v94, s[16:17] sc1
    s_waitcnt vmcnt(0)
    v_cmp_ne_u32 vcc, 32, v93
    s_nop 0
    s_cbranch_vccnz L_fallback
L_O_placed_3:
    s_mul_i32 s27, s27, 40960
    s_add_u32 s28, s27, 188350464
    s_mov_b32 s29, 0
    buffer_load_dwordx2 v[128:129], v9, s[92:95], s27 offen offset:0
    buffer_load_dwordx2 v[130:131], v9, s[92:95], s27 offen offset:1280
    buffer_load_dwordx2 v[132:133], v9, s[92:95], s27 offen offset:2560
    buffer_load_dwordx2 v[134:135], v9, s[92:95], s27 offen offset:3840
    s_waitcnt vmcnt(0)
L_O_ln0:
    s_waitcnt vmcnt(4)
    v_lshlrev_b32 v24, 16, v128
    v_and_b32 v25, 0xffff0000, v128
    v_lshlrev_b32 v26, 16, v129
    v_and_b32 v27, 0xffff0000, v129
    v_lshlrev_b32 v28, 16, v130
    v_and_b32 v29, 0xffff0000, v130
    v_lshlrev_b32 v30, 16, v131
    v_and_b32 v31, 0xffff0000, v131
    v_lshlrev_b32 v32, 16, v132
    v_and_b32 v33, 0xffff0000, v132
    v_lshlrev_b32 v34, 16, v133
    v_and_b32 v35, 0xffff0000, v133
    v_lshlrev_b32 v36, 16, v134
    v_and_b32 v37, 0xffff0000, v134
    v_lshlrev_b32 v38, 16, v135
    v_and_b32 v39, 0xffff0000, v135
    v_mov_b32 v114, v128
    v_mov_b32 v115, v129
    v_mov_b32 v118, v130
    v_mov_b32 v119, v131
    v_mov_b32 v122, v132
    v_mov_b32 v123, v133
    v_mov_b32 v126, v134
    v_mov_b32 v127, v135
    s_add_u32 s27, s27, 5120
    s_barrier
    buffer_load_dwordx2 v[128:129], v9, s[92:95], s27 offen offset:0
    buffer_load_dwordx2 v[130:131], v9, s[92:95], s27 offen offset:1280
    buffer_load_dwordx2 v[132:133], v9, s[92:95], s27 offen offset:2560
    buffer_load_dwordx2 v[134:135], v9, s[92:95], s27 offen offset:3840
    v_readfirstlane_b32 s80, v24
    v_readfirstlane_b32 s82, v28
    v_readfirstlane_b32 s84, v32
    v_readfirstlane_b32 s86, v36
    v_pk_add_f32 v[56:57], v[24:25], s[80:81] op_sel_hi:[1,0] neg_lo:[0,1] neg_hi:[0,1]
    v_pk_add_f32 v[58:59], v[26:27], s[80:81] op_sel_hi:[1,0] neg_lo:[0,1] neg_hi:[0,1]
    v_pk_add_f32 v[48:49], v[56:57], v[58:59]
    v_pk_mul_f32 v[50:51], v[56:57], v[56:57]
    v_pk_fma_f32 v[50:51], v[58:59], v[58:59], v[50:51]
    v_add_f32 v40, v48, v49
    v_add_f32 v41, v50, v51
    v_cndmask_b32 v40, 0, v40, s[90:91]
    v_cndmask_b32 v41, 0, v41, s[90:91]
    v_pk_add_f32 v[60:61], v[28:29], s[82:83] op_sel_hi:[1,0] neg_lo:[0,1] neg_hi:[0,1]
    v_pk_add_f32 v[62:63], v[30:31], s[82:83] op_sel_hi:[1,0] neg_lo:[0,1] neg_hi:[0,1]
    v_pk_add_f32 v[48:49], v[60:61], v[62:63]
    v_pk_mul_f32 v[50:51], v[60:61], v[60:61]
    v_pk_fma_f32 v[50:51], v[62:63], v[62:63], v[50:51]
    v_add_f32 v42, v48, v49
    v_add_f32 v43, v50, v51
    v_cndmask_b32 v42, 0, v42, s[90:91]
    v_cndmask_b32 v43, 0, v43, s[90:91]
    v_pk_add_f32 v[64:65], v[32:33], s[84:85] op_sel_hi:[1,0] neg_lo:[0,1] neg_hi:[0,1]
    v_pk_add_f32 v[66:67], v[34:35], s[84:85] op_sel_hi:[1,0] neg_lo:[0,1] neg_hi:[0,1]
    v_pk_add_f32 v[48:49], v[64:65], v[66:67]
    v_pk_mul_f32 v[50:51], v[64:65], v[64:65]
    v_pk_fma_f32 v[50:51], v[66:67], v[66:67], v[50:51]
    v_add_f32 v44, v48, v49
    v_add_f32 v45, v50, v51
    v_cndmask_b32 v44, 0, v44, s[90:91]
    v_cndmask_b32 v45, 0, v45, s[90:91]
    v_pk_add_f32 v[68:69], v[36:37], s[86:87] op_sel_hi:[1,0] neg_lo:[0,1] neg_hi:[0,1]
    v_pk_add_f32 v[70:71], v[38:39], s[86:87] op_sel_hi:[1,0] neg_lo:[0,1] neg_hi:[0,1]
    v_pk_add_f32 v[48:49], v[68:69], v[70:71]
    v_pk_mul_f32 v[50:51], v[68:69], v[68:69]
    v_pk_fma_f32 v[50:51], v[70:71], v[70:71], v[50:51]
    v_add_f32 v46, v48, v49
    v_add_f32 v47, v50, v51
    v_cndmask_b32 v46, 0, v46, s[90:91]
    v_cndmask_b32 v47, 0, v47, s[90:91]
    v_add_f32_dpp v40, v40, v40 quad_perm:[1,0,3,2] row_mask:0xf bank_mask:0xf
    v_add_f32_dpp v41, v41, v41 quad_perm:[1,0,3,2] row_mask:0xf bank_mask:0xf
    v_add_f32_dpp v42, v42, v42 quad_perm:[1,0,3,2] row_mask:0xf bank_mask:0xf
    v_add_f32_dpp v43, v43, v43 quad_perm:[1,0,3,2] row_mask:0xf bank_mask:0xf
    v_add_f32_dpp v44, v44, v44 quad_perm:[1,0,3,2] row_mask:0xf bank_mask:0xf
    v_add_f32_dpp v45, v45, v45 quad_perm:[1,0,3,2] row_mask:0xf bank_mask:0xf
    v_add_f32_dpp v46, v46, v46 quad_perm:[1,0,3,2] row_mask:0xf bank_mask:0xf
    v_add_f32_dpp v47, v47, v47 quad_perm:[1,0,3,2] row_mask:0xf bank_mask:0xf
    v_add_f32_dpp v40, v40, v40 quad_perm:[2,3,0,1] row_mask:0xf bank_mask:0xf
    v_add_f32_dpp v41, v41, v41 quad_perm:[2,3,0,1] row_mask:0xf bank_mask:0xf
    v_add_f32_dpp v42, v42, v42 quad_perm:[2,3,0,1] row_mask:0xf bank_mask:0xf
    v_add_f32_dpp v43, v43, v43 quad_perm:[2,3,0,1] row_mask:0xf bank_mask:0xf
    v_add_f32_dpp v44, v44, v44 quad_perm:[2,3,0,1] row_mask:0xf bank_mask:0xf
    v_add_f32_dpp v45, v45, v45 quad_perm:[2,3,0,1] row_mask:0xf bank_mask:0xf
    v_add_f32_dpp v46, v46, v46 quad_perm:[2,3,0,1] row_mask:0xf bank_mask:0xf
    v_add_f32_dpp v47, v47, v47 quad_perm:[2,3,0,1] row_mask:0xf bank_mask:0xf
    v_add_f32_dpp v40, v40, v40 row_half_mirror row_mask:0xf bank_mask:0xf
    v_add_f32_dpp v41, v41, v41 row_half_mirror row_mask:0xf bank_mask:0xf
    v_add_f32_dpp v42, v42, v42 row_half_mirror row_mask:0xf bank_mask:0xf
    v_add_f32_dpp v43, v43, v43 row_half_mirror row_mask:0xf bank_mask:0xf
    v_add_f32_dpp v44, v44, v44 row_half_mirror row_mask:0xf bank_mask:0xf
    v_add_f32_dpp v45, v45, v45 row_half_mirror row_mask:0xf bank_mask:0xf
    v_add_f32_dpp v46, v46, v46 row_half_mirror row_mask:0xf bank_mask:0xf
    v_add_f32_dpp v47, v47, v47 row_half_mirror row_mask:0xf bank_mask:0xf
    v_add_f32_dpp v40, v40, v40 row_mirror row_mask:0xf bank_mask:0xf
    v_add_f32_dpp v41, v41, v41 row_mirror row_mask:0xf bank_mask:0xf
    v_add_f32_dpp v42, v42, v42 row_mirror row_mask:0xf bank_mask:0xf
    v_add_f32_dpp v43, v43, v43 row_mirror row_mask:0xf bank_mask:0xf
    v_add_f32_dpp v44, v44, v44 row_mirror row_mask:0xf bank_mask:0xf
    v_add_f32_dpp v45, v45, v45 row_mirror row_mask:0xf bank_mask:0xf
    v_add_f32_dpp v46, v46, v46 row_mirror row_mask:0xf bank_mask:0xf
    v_add_f32_dpp v47, v47, v47 row_mirror row_mask:0xf bank_mask:0xf
    v_mov_b32 v48, v40
    v_mov_b32 v49, v41
    v_mov_b32 v50, v42
    v_mov_b32 v51, v43
    v_mov_b32 v52, v44
    v_mov_b32 v53, v45
    v_mov_b32 v54, v46
    v_mov_b32 v55, v47
    v_permlane16_swap_b32 v40, v48
    v_permlane16_swap_b32 v41, v49
    v_permlane16_swap_b32 v42, v50
    v_permlane16_swap_b32 v43, v51
    v_permlane16_swap_b32 v44, v52
    v_permlane16_swap_b32 v45, v53
    v_permlane16_swap_b32 v46, v54
    v_permlane16_swap_b32 v47, v55
    v_add_f32 v40, v40, v48
    v_add_f32 v41, v41, v49
    v_add_f32 v42, v42, v50
    v_add_f32 v43, v43, v51
    v_add_f32 v44, v44, v52
    v_add_f32 v45, v45, v53
    v_add_f32 v46, v46, v54
    v_add_f32 v47, v47, v55
    v_mov_b32 v48, v40
    v_mov_b32 v49, v41
    v_mov_b32 v50, v42
    v_mov_b32 v51, v43
    v_mov_b32 v52, v44
    v_mov_b32 v53, v45
    v_mov_b32 v54, v46
    v_mov_b32 v55, v47
    v_permlane32_swap_b32 v40, v48
    v_permlane32_swap_b32 v41, v49
    v_permlane32_swap_b32 v42, v50
    v_permlane32_swap_b32 v43, v51
    v_permlane32_swap_b32 v44, v52
    v_permlane32_swap_b32 v45, v53
    v_permlane32_swap_b32 v46, v54
    v_permlane32_swap_b32 v47, v55
    v_add_f32 v40, v40, v48
    v_add_f32 v41, v41, v49
    v_add_f32 v42, v42, v50
    v_add_f32 v43, v43, v51
    v_add_f32 v44, v44, v52
    v_add_f32 v45, v45, v53
    v_add_f32 v46, v46, v54
    v_add_f32 v47, v47, v55
    v_mul_f32 v48, 6.2500000000e-03, v40
    v_fma_f32 v41, -v48, v40, v41
    v_add_f32 v40, s80, v48
    v_mul_f32 v48, 6.2500000000e-03, v42
    v_fma_f32 v43, -v48, v42, v43
    v_add_f32 v42, s82, v48
    v_mul_f32 v48, 6.2500000000e-03, v44
    v_fma_f32 v45, -v48, v44, v45
    v_add_f32 v44, s84, v48
    v_mul_f32 v48, 6.2500000000e-03, v46
    v_fma_f32 v47, -v48, v46, v47
    v_add_f32 v46, s86, v48
    s_mov_b64 exec, 1
    ds_write_b64 v11, v[40:41] offset:0
    ds_write_b64 v11, v[42:43] offset:32
    ds_write_b64 v11, v[44:45] offset:64
    ds_write_b64 v11, v[46:47] offset:96
    s_mov_b64 exec, -1
    s_waitcnt lgkmcnt(0)
    s_barrier
    ds_read_b128 v[72:75], v213 offset:0
    ds_read_b128 v[76:79], v213 offset:16
    ds_read_b128 v[80:83], v213 offset:32
    ds_read_b128 v[84:87], v213 offset:48
    ds_read_b128 v[88:91], v213 offset:64
    ds_read_b128 v[92:95], v213 offset:80
    ds_read_b128 v[96:99], v213 offset:96
    ds_read_b128 v[100:103], v213 offset:112
    s_waitcnt lgkmcnt(6)
    v_pk_add_f32 v[40:41], v[72:73], v[74:75]
    v_pk_add_f32 v[48:49], v[76:77], v[78:79]
    v_pk_add_f32 v[40:41], v[40:41], v[48:49]
    v_mul_f32 v40, 0.25, v40
    v_sub_f32 v72, v72, v40
    v_sub_f32 v74, v74, v40
    v_sub_f32 v76, v76, v40
    v_sub_f32 v78, v78, v40
    v_mul_f32 v48, v72, v72
    v_fmac_f32 v48, v74, v74
    v_fmac_f32 v48, v76, v76
    v_fmac_f32 v48, v78, v78
    v_mul_f32 v41, 1.5625000000e-03, v41
    v_fmac_f32 v41, 0.25, v48
    v_max_f32 v41, 0, v41
    v_cvt_pk_bf16_f32 v48, v41, v40
    v_lshlrev_b32 v41, 16, v48
    v_and_b32 v40, 0xffff0000, v48
    v_add_f32 v41, 0x3727c5ac, v41
    v_pk_add_f32 v[56:57], v[24:25], v[40:41] op_sel_hi:[1,0] neg_lo:[0,1] neg_hi:[0,1]
    v_cvt_pk_bf16_f32 v48, v41, v41
    v_pk_add_f32 v[58:59], v[26:27], v[40:41] op_sel_hi:[1,0] neg_lo:[0,1] neg_hi:[0,1]
    v_lshlrev_b32 v48, 16, v48
    v_sqrt_f32 v48, v48
    v_cvt_pk_bf16_f32 v112, v56, v57
    v_cvt_pk_bf16_f32 v113, v58, v59
    v_cvt_pk_bf16_f32 v48, v48, v48
    v_lshlrev_b32 v48, 16, v48
    v_rcp_f32 v48, v48
    v_lshlrev_b32 v56, 16, v112
    v_and_b32 v57, 0xffff0000, v112
    v_lshlrev_b32 v58, 16, v113
    v_and_b32 v59, 0xffff0000, v113
    v_pk_mul_f32 v[56:57], v[56:57], v[48:49] op_sel_hi:[1,0]
    v_pk_mul_f32 v[58:59], v[58:59], v[48:49] op_sel_hi:[1,0]
    v_cvt_pk_bf16_f32 v112, v56, v57
    v_cvt_pk_bf16_f32 v113, v58, v59
    s_waitcnt lgkmcnt(4)
    v_pk_add_f32 v[42:43], v[80:81], v[82:83]
    v_pk_add_f32 v[48:49], v[84:85], v[86:87]
    v_pk_add_f32 v[42:43], v[42:43], v[48:49]
    v_mul_f32 v42, 0.25, v42
    v_sub_f32 v80, v80, v42
    v_sub_f32 v82, v82, v42
    v_sub_f32 v84, v84, v42
    v_sub_f32 v86, v86, v42
    v_mul_f32 v48, v80, v80
    v_fmac_f32 v48, v82, v82
    v_fmac_f32 v48, v84, v84
    v_fmac_f32 v48, v86, v86
    v_mul_f32 v43, 1.5625000000e-03, v43
    v_fmac_f32 v43, 0.25, v48
    v_max_f32 v43, 0, v43
    v_cvt_pk_bf16_f32 v48, v43, v42
    v_lshlrev_b32 v43, 16, v48
    v_and_b32 v42, 0xffff0000, v48
    v_add_f32 v43, 0x3727c5ac, v43
    v_pk_add_f32 v[60:61], v[28:29], v[42:43] op_sel_hi:[1,0] neg_lo:[0,1] neg_hi:[0,1]
    v_cvt_pk_bf16_f32 v48, v43, v43
    v_pk_add_f32 v[62:63], v[30:31], v[42:43] op_sel_hi:[1,0] neg_lo:[0,1] neg_hi:[0,1]
    v_lshlrev_b32 v48, 16, v48
    v_sqrt_f32 v48, v48
    v_cvt_pk_bf16_f32 v116, v60, v61
    v_cvt_pk_bf16_f32 v117, v62, v63
    v_cvt_pk_bf16_f32 v48, v48, v48
    v_lshlrev_b32 v48, 16, v48
    v_rcp_f32 v48, v48
    v_lshlrev_b32 v60, 16, v116
    v_and_b32 v61, 0xffff0000, v116
    v_lshlrev_b32 v62, 16, v117
    v_and_b32 v63, 0xffff0000, v117
    v_pk_mul_f32 v[60:61], v[60:61], v[48:49] op_sel_hi:[1,0]
    v_pk_mul_f32 v[62:63], v[62:63], v[48:49] op_sel_hi:[1,0]
    v_cvt_pk_bf16_f32 v116, v60, v61
    v_cvt_pk_bf16_f32 v117, v62, v63
    s_waitcnt lgkmcnt(2)
    v_pk_add_f32 v[44:45], v[88:89], v[90:91]
    v_pk_add_f32 v[48:49], v[92:93], v[94:95]
    v_pk_add_f32 v[44:45], v[44:45], v[48:49]
    v_mul_f32 v44, 0.25, v44
    v_sub_f32 v88, v88, v44
    v_sub_f32 v90, v90, v44
    v_sub_f32 v92, v92, v44
    v_sub_f32 v94, v94, v44
    v_mul_f32 v48, v88, v88
    v_fmac_f32 v48, v90, v90
    v_fmac_f32 v48, v92, v92
    v_fmac_f32 v48, v94, v94
    v_mul_f32 v45, 1.5625000000e-03, v45
    v_fmac_f32 v45, 0.25, v48
    v_max_f32 v45, 0, v45
    v_cvt_pk_bf16_f32 v48, v45, v44
    v_lshlrev_b32 v45, 16, v48
    v_and_b32 v44, 0xffff0000, v48
    v_add_f32 v45, 0x3727c5ac, v45
    v_pk_add_f32 v[64:65], v[32:33], v[44:45] op_sel_hi:[1,0] neg_lo:[0,1] neg_hi:[0,1]
    v_cvt_pk_bf16_f32 v48, v45, v45
    v_pk_add_f32 v[66:67], v[34:35], v[44:45] op_sel_hi:[1,0] neg_lo:[0,1] neg_hi:[0,1]
    v_lshlrev_b32 v48, 16, v48
    v_sqrt_f32 v48, v48
    v_cvt_pk_bf16_f32 v120, v64, v65
    v_cvt_pk_bf16_f32 v121, v66, v67
    v_cvt_pk_bf16_f32 v48, v48, v48
    v_lshlrev_b32 v48, 16, v48
    v_rcp_f32 v48, v48
    v_lshlrev_b32 v64, 16, v120
    v_and_b32 v65, 0xffff0000, v120
    v_lshlrev_b32 v66, 16, v121
    v_and_b32 v67, 0xffff0000, v121
    v_pk_mul_f32 v[64:65], v[64:65], v[48:49] op_sel_hi:[1,0]
    v_pk_mul_f32 v[66:67], v[66:67], v[48:49] op_sel_hi:[1,0]
    v_cvt_pk_bf16_f32 v120, v64, v65
    v_cvt_pk_bf16_f32 v121, v66, v67
    s_waitcnt lgkmcnt(0)
    v_pk_add_f32 v[46:47], v[96:97], v[98:99]
    v_pk_add_f32 v[48:49], v[100:101], v[102:103]
    v_pk_add_f32 v[46:47], v[46:47], v[48:49]
    v_mul_f32 v46, 0.25, v46
    v_sub_f32 v96, v96, v46
    v_sub_f32 v98, v98, v46
    v_sub_f32 v100, v100, v46
    v_sub_f32 v102, v102, v46
    v_mul_f32 v48, v96, v96
    v_fmac_f32 v48, v98, v98
    v_fmac_f32 v48, v100, v100
    v_fmac_f32 v48, v102, v102
    v_mul_f32 v47, 1.5625000000e-03, v47
    v_fmac_f32 v47, 0.25, v48
    v_max_f32 v47, 0, v47
    v_cvt_pk_bf16_f32 v48, v47, v46
    v_lshlrev_b32 v47, 16, v48
    v_and_b32 v46, 0xffff0000, v48
    v_add_f32 v47, 0x3727c5ac, v47
    v_pk_add_f32 v[68:69], v[36:37], v[46:47] op_sel_hi:[1,0] neg_lo:[0,1] neg_hi:[0,1]
    v_cvt_pk_bf16_f32 v48, v47, v47
    v_pk_add_f32 v[70:71], v[38:39], v[46:47] op_sel_hi:[1,0] neg_lo:[0,1] neg_hi:[0,1]
    v_lshlrev_b32 v48, 16, v48
    v_sqrt_f32 v48, v48
    v_cvt_pk_bf16_f32 v124, v68, v69
    v_cvt_pk_bf16_f32 v125, v70, v71
    v_cvt_pk_bf16_f32 v48, v48, v48
    v_lshlrev_b32 v48, 16, v48
    v_rcp_f32 v48, v48
    v_lshlrev_b32 v68, 16, v124
    v_and_b32 v69, 0xffff0000, v124
    v_lshlrev_b32 v70, 16, v125
    v_and_b32 v71, 0xffff0000, v125
    v_pk_mul_f32 v[68:69], v[68:69], v[48:49] op_sel_hi:[1,0]
    v_pk_mul_f32 v[70:71], v[70:71], v[48:49] op_sel_hi:[1,0]
    v_cvt_pk_bf16_f32 v124, v68, v69
    v_cvt_pk_bf16_f32 v125, v70, v71
    v_permlane16_swap_b32 v112, v114
    v_permlane16_swap_b32 v113, v115
    v_permlane16_swap_b32 v116, v118
    v_permlane16_swap_b32 v117, v119
    v_permlane16_swap_b32 v120, v122
    v_permlane16_swap_b32 v121, v123
    v_permlane16_swap_b32 v124, v126
    v_permlane16_swap_b32 v125, v127
    s_mov_b32 exec_lo, 4294967295
    s_mov_b32 exec_hi, 983055
    buffer_store_dwordx4 v[112:115], v17, s[4:7], s28 offen offset:0 sc1
    buffer_store_dwordx4 v[116:119], v17, s[4:7], s28 offen offset:1280 sc1
    buffer_store_dwordx4 v[120:123], v17, s[4:7], s28 offen offset:2560 sc1
    buffer_store_dwordx4 v[124:127], v17, s[4:7], s28 offen offset:3840 sc1
    s_mov_b64 exec, -1
    s_add_u32 s28, s28, 5120
    s_add_u32 s29, s29, 1
    s_cmp_lt_u32 s29, 8
    s_cbranch_scc1 L_O_ln0
    s_waitcnt vmcnt(0)
    s_barrier
    s_cmp_lg_u32 s12, 0
    s_cbranch_scc1 L_O_noln0
    v_mov_b32 v24, 1
    s_mov_b64 exec, 1
    buffer_store_dword v24, v16, s[4:7], s24 offen offset:8 sc1
    s_mov_b64 exec, -1
L_O_noln0:
    s_mul_i32 s38, s12, 40960
    v_add_u32 v36, 0, v0
    v_mul_u32_u24 v37, 3277, v36
    v_lshrrev_b32 v37, 16, v37
    v_mul_u32_u24 v24, 20, v37
    v_sub_u32 v24, v36, v24
    v_lshrrev_b32 v24, 0, v24
    v_lshlrev_b32 v24, 4, v24
    v_mul_u32_u24 v37, 1280, v37
    v_add_u32 v24, v24, v37
    v_add_u32 v36, 64, v0
    v_mul_u32_u24 v37, 3277, v36
    v_lshrrev_b32 v37, 16, v37
    v_mul_u32_u24 v25, 20, v37
    v_sub_u32 v25, v36, v25
    v_lshrrev_b32 v25, 0, v25
    v_lshlrev_b32 v25, 4, v25
    v_mul_u32_u24 v37, 1280, v37
    v_add_u32 v25, v25, v37
    v_add_u32 v36, 128, v0
    v_mul_u32_u24 v37, 3277, v36
    v_lshrrev_b32 v37, 16, v37
    v_mul_u32_u24 v26, 20, v37
    v_sub_u32 v26, v36, v26
    v_lshrrev_b32 v26, 0, v26
    v_lshlrev_b32 v26, 4, v26
    v_mul_u32_u24 v37, 1280, v37
    v_add_u32 v26, v26, v37
    v_add_u32 v36, 192, v0
    v_mul_u32_u24 v37, 3277, v36
    v_lshrrev_b32 v37, 16, v37
    v_mul_u32_u24 v27, 20, v37
    v_sub_u32 v27, v36, v27
    v_lshrrev_b32 v27, 0, v27
    v_lshlrev_b32 v27, 4, v27
    v_mul_u32_u24 v37, 1280, v37
    v_add_u32 v27, v27, v37
    v_add_u32 v36, 256, v0
    v_mul_u32_u24 v37, 3277, v36
    v_lshrrev_b32 v37, 16, v37
    v_mul_u32_u24 v28, 20, v37
    v_sub_u32 v28, v36, v28
    v_lshrrev_b32 v28, 0, v28
    v_lshlrev_b32 v28, 4, v28
    v_mul_u32_u24 v37, 1280, v37
    v_add_u32 v28, v28, v37
    v_add_u32 v36, 320, v0
    v_mul_u32_u24 v37, 3277, v36
    v_lshrrev_b32 v37, 16, v37
    v_mul_u32_u24 v29, 20, v37
    v_sub_u32 v29, v36, v29
    v_lshrrev_b32 v29, 0, v29
    v_lshlrev_b32 v29, 4, v29
    v_mul_u32_u24 v37, 1280, v37
    v_add_u32 v29, v29, v37
    v_add_u32 v36, 384, v0
    v_mul_u32_u24 v37, 3277, v36
    v_lshrrev_b32 v37, 16, v37
    v_mul_u32_u24 v30, 20, v37
    v_sub_u32 v30, v36, v30
    v_lshrrev_b32 v30, 0, v30
    v_lshlrev_b32 v30, 4, v30
    v_mul_u32_u24 v37, 1280, v37
    v_add_u32 v30, v30, v37
    v_add_u32 v36, 448, v0
    v_mul_u32_u24 v37, 3277, v36
    v_lshrrev_b32 v37, 16, v37
    v_mul_u32_u24 v31, 20, v37
    v_sub_u32 v31, v36, v31
    v_lshrrev_b32 v31, 0, v31
    v_lshlrev_b32 v31, 4, v31
    v_mul_u32_u24 v37, 1280, v37
    v_add_u32 v31, v31, v37
    v_add_u32 v36, 512, v0
    v_mul_u32_u24 v37, 3277, v36
    v_lshrrev_b32 v37, 16, v37
    v_mul_u32_u24 v32, 20, v37
    v_sub_u32 v32, v36, v32
    v_lshrrev_b32 v32, 0, v32
    v_lshlrev_b32 v32, 4, v32
    v_mul_u32_u24 v37, 1280, v37
    v_add_u32 v32, v32, v37
    v_add_u32 v36, 576, v0
    v_mul_u32_u24 v37, 3277, v36
    v_lshrrev_b32 v37, 16, v37
    v_mul_u32_u24 v33, 20, v37
    v_sub_u32 v33, v36, v33
    v_lshrrev_b32 v33, 0, v33
    v_lshlrev_b32 v33, 4, v33
    v_mul_u32_u24 v37, 1280, v37
    v_add_u32 v33, v33, v37
    v_lshrrev_b32 v34, 2, v0
    v_mul_u32_u24 v34, 320, v34
    v_and_b32 v36, 3, v0
    v_lshl_add_u32 v34, v36, 3, v34
    v_add_u32 v34, s38, v34
    s_mov_b32 s8, s74
    s_and_b32 s9, s75, 0xffff
    s_mov_b32 s10, 7864320
    s_mov_b32 s11, 0x20000
    s_mul_i32 s98, s21, 245760
    s_mul_i32 s27, s12, 320
    s_add_u32 s98, s98, s27
    s_add_u32 m0, s38, 0
    s_nop 0
    buffer_load_dwordx4 v24, s[8:11], s98 offen lds
    s_add_u32 m0, s38, 1024
    s_nop 0
    buffer_load_dwordx4 v25, s[8:11], s98 offen lds
    s_add_u32 m0, s38, 2048
    s_nop 0
    buffer_load_dwordx4 v26, s[8:11], s98 offen lds
    s_add_u32 m0, s38, 3072
    s_nop 0
    buffer_load_dwordx4 v27, s[8:11], s98 offen lds
    s_add_u32 m0, s38, 4096
    s_nop 0
    buffer_load_dwordx4 v28, s[8:11], s98 offen lds
    s_add_u32 m0, s38, 5120
    s_nop 0
    buffer_load_dwordx4 v29, s[8:11], s98 offen lds
    s_add_u32 m0, s38, 6144
    s_nop 0
    buffer_load_dwordx4 v30, s[8:11], s98 offen lds
    s_add_u32 m0, s38, 7168
    s_nop 0
    buffer_load_dwordx4 v31, s[8:11], s98 offen lds
    s_add_u32 m0, s38, 8192
    s_nop 0
    buffer_load_dwordx4 v32, s[8:11], s98 offen lds
    s_add_u32 m0, s38, 9216
    s_nop 0
    buffer_load_dwordx4 v33, s[8:11], s98 offen lds
    s_add_u32 s98, s98, 40960
    s_add_u32 m0, s38, 10240
    s_nop 0
    buffer_load_dwordx4 v24, s[8:11], s98 offen lds
    s_add_u32 m0, s38, 11264
    s_nop 0
    buffer_load_dwordx4 v25, s[8:11], s98 offen lds
    s_add_u32 m0, s38, 12288
    s_nop 0
    buffer_load_dwordx4 v26, s[8:11], s98 offen lds
    s_add_u32 m0, s38, 13312
    s_nop 0
    buffer_load_dwordx4 v27, s[8:11], s98 offen lds
    s_add_u32 m0, s38, 14336
    s_nop 0
    buffer_load_dwordx4 v28, s[8:11], s98 offen lds
    s_add_u32 m0, s38, 15360
    s_nop 0
    buffer_load_dwordx4 v29, s[8:11], s98 offen lds
    s_add_u32 m0, s38, 16384
    s_nop 0
    buffer_load_dwordx4 v30, s[8:11], s98 offen lds
    s_add_u32 m0, s38, 17408
    s_nop 0
    buffer_load_dwordx4 v31, s[8:11], s98 offen lds
    s_add_u32 m0, s38, 18432
    s_nop 0
    buffer_load_dwordx4 v32, s[8:11], s98 offen lds
    s_add_u32 m0, s38, 19456
    s_nop 0
    buffer_load_dwordx4 v33, s[8:11], s98 offen lds
    s_add_u32 s98, s98, 40960
    s_add_u32 m0, s38, 20480
    s_nop 0
    buffer_load_dwordx4 v24, s[8:11], s98 offen lds
    s_add_u32 m0, s38, 21504
    s_nop 0
    buffer_load_dwordx4 v25, s[8:11], s98 offen lds
    s_add_u32 m0, s38, 22528
    s_nop 0
    buffer_load_dwordx4 v26, s[8:11], s98 offen lds
    s_add_u32 m0, s38, 23552
    s_nop 0
    buffer_load_dwordx4 v27, s[8:11], s98 offen lds
    s_add_u32 m0, s38, 24576
    s_nop 0
    buffer_load_dwordx4 v28, s[8:11], s98 offen lds
    s_add_u32 m0, s38, 25600
    s_nop 0
    buffer_load_dwordx4 v29, s[8:11], s98 offen lds
    s_add_u32 m0, s38, 26624
    s_nop 0
    buffer_load_dwordx4 v30, s[8:11], s98 offen lds
    s_add_u32 m0, s38, 27648
    s_nop 0
    buffer_load_dwordx4 v31, s[8:11], s98 offen lds
    s_add_u32 m0, s38, 28672
    s_nop 0
    buffer_load_dwordx4 v32, s[8:11], s98 offen lds
    s_add_u32 m0, s38, 29696
    s_nop 0
    buffer_load_dwordx4 v33, s[8:11], s98 offen lds
    s_waitcnt vmcnt(20)
    ds_read_b64_tr_b16 a[0:1], v34 offset:0
    ds_read_b64_tr_b16 a[2:3], v34 offset:5120
    ds_read_b64_tr_b16 a[24:25], v34 offset:32
    ds_read_b64_tr_b16 a[26:27], v34 offset:5152
    ds_read_b64_tr_b16 a[48:49], v34 offset:64
    ds_read_b64_tr_b16 a[50:51], v34 offset:5184
    ds_read_b64_tr_b16 a[72:73], v34 offset:96
    ds_read_b64_tr_b16 a[74:75], v34 offset:5216
    ds_read_b64_tr_b16 a[96:97], v34 offset:128
    ds_read_b64_tr_b16 a[98:99], v34 offset:5248
    ds_read_b64_tr_b16 a[120:121], v34 offset:160
    ds_read_b64_tr_b16 a[122:123], v34 offset:5280
    ds_read_b64_tr_b16 a[144:145], v34 offset:192
    ds_read_b64_tr_b16 a[146:147], v34 offset:5312
    ds_read_b64_tr_b16 a[168:169], v34 offset:224
    ds_read_b64_tr_b16 a[170:171], v34 offset:5344
    ds_read_b64_tr_b16 a[192:193], v34 offset:256
    ds_read_b64_tr_b16 a[194:195], v34 offset:5376
    ds_read_b64_tr_b16 a[216:217], v34 offset:288
    ds_read_b64_tr_b16 a[218:219], v34 offset:5408
    s_waitcnt lgkmcnt(0)
    s_add_u32 s98, s98, 40960
    s_add_u32 m0, s38, 0
    s_nop 0
    buffer_load_dwordx4 v24, s[8:11], s98 offen lds
    s_add_u32 m0, s38, 1024
    s_nop 0
    buffer_load_dwordx4 v25, s[8:11], s98 offen lds
    s_add_u32 m0, s38, 2048
    s_nop 0
    buffer_load_dwordx4 v26, s[8:11], s98 offen lds
    s_add_u32 m0, s38, 3072
    s_nop 0
    buffer_load_dwordx4 v27, s[8:11], s98 offen lds
    s_add_u32 m0, s38, 4096
    s_nop 0
    buffer_load_dwordx4 v28, s[8:11], s98 offen lds
    s_add_u32 m0, s38, 5120
    s_nop 0
    buffer_load_dwordx4 v29, s[8:11], s98 offen lds
    s_add_u32 m0, s38, 6144
    s_nop 0
    buffer_load_dwordx4 v30, s[8:11], s98 offen lds
    s_add_u32 m0, s38, 7168
    s_nop 0
    buffer_load_dwordx4 v31, s[8:11], s98 offen lds
    s_add_u32 m0, s38, 8192
    s_nop 0
    buffer_load_dwordx4 v32, s[8:11], s98 offen lds
    s_add_u32 m0, s38, 9216
    s_nop 0
    buffer_load_dwordx4 v33, s[8:11], s98 offen lds
    s_waitcnt vmcnt(20)
    ds_read_b64_tr_b16 a[4:5], v34 offset:10240
    ds_read_b64_tr_b16 a[6:7], v34 offset:15360
    ds_read_b64_tr_b16 a[28:29], v34 offset:10272
    ds_read_b64_tr_b16 a[30:31], v34 offset:15392
    ds_read_b64_tr_b16 a[52:53], v34 offset:10304
    ds_read_b64_tr_b16 a[54:55], v34 offset:15424
    ds_read_b64_tr_b16 a[76:77], v34 offset:10336
    ds_read_b64_tr_b16 a[78:79], v34 offset:15456
    ds_read_b64_tr_b16 a[100:101], v34 offset:10368
    ds_read_b64_tr_b16 a[102:103], v34 offset:15488
    ds_read_b64_tr_b16 a[124:125], v34 offset:10400
    ds_read_b64_tr_b16 a[126:127], v34 offset:15520
    ds_read_b64_tr_b16 a[148:149], v34 offset:10432
    ds_read_b64_tr_b16 a[150:151], v34 offset:15552
    ds_read_b64_tr_b16 a[172:173], v34 offset:10464
    ds_read_b64_tr_b16 a[174:175], v34 offset:15584
    ds_read_b64_tr_b16 a[196:197], v34 offset:10496
    ds_read_b64_tr_b16 a[198:199], v34 offset:15616
    ds_read_b64_tr_b16 a[220:221], v34 offset:10528
    ds_read_b64_tr_b16 a[222:223], v34 offset:15648
    s_waitcnt lgkmcnt(0)
    s_add_u32 s98, s98, 40960
    s_add_u32 m0, s38, 10240
    s_nop 0
    buffer_load_dwordx4 v24, s[8:11], s98 offen lds
    s_add_u32 m0, s38, 11264
    s_nop 0
    buffer_load_dwordx4 v25, s[8:11], s98 offen lds
    s_add_u32 m0, s38, 12288
    s_nop 0
    buffer_load_dwordx4 v26, s[8:11], s98 offen lds
    s_add_u32 m0, s38, 13312
    s_nop 0
    buffer_load_dwordx4 v27, s[8:11], s98 offen lds
    s_add_u32 m0, s38, 14336
    s_nop 0
    buffer_load_dwordx4 v28, s[8:11], s98 offen lds
    s_add_u32 m0, s38, 15360
    s_nop 0
    buffer_load_dwordx4 v29, s[8:11], s98 offen lds
    s_add_u32 m0, s38, 16384
    s_nop 0
    buffer_load_dwordx4 v30, s[8:11], s98 offen lds
    s_add_u32 m0, s38, 17408
    s_nop 0
    buffer_load_dwordx4 v31, s[8:11], s98 offen lds
    s_add_u32 m0, s38, 18432
    s_nop 0
    buffer_load_dwordx4 v32, s[8:11], s98 offen lds
    s_add_u32 m0, s38, 19456
    s_nop 0
    buffer_load_dwordx4 v33, s[8:11], s98 offen lds
    s_waitcnt vmcnt(20)
    ds_read_b64_tr_b16 a[8:9], v34 offset:20480
    ds_read_b64_tr_b16 a[10:11], v34 offset:25600
    ds_read_b64_tr_b16 a[32:33], v34 offset:20512
    ds_read_b64_tr_b16 a[34:35], v34 offset:25632
    ds_read_b64_tr_b16 a[56:57], v34 offset:20544
    ds_read_b64_tr_b16 a[58:59], v34 offset:25664
    ds_read_b64_tr_b16 a[80:81], v34 offset:20576
    ds_read_b64_tr_b16 a[82:83], v34 offset:25696
    ds_read_b64_tr_b16 a[104:105], v34 offset:20608
    ds_read_b64_tr_b16 a[106:107], v34 offset:25728
    ds_read_b64_tr_b16 a[128:129], v34 offset:20640
    ds_read_b64_tr_b16 a[130:131], v34 offset:25760
    ds_read_b64_tr_b16 a[152:153], v34 offset:20672
    ds_read_b64_tr_b16 a[154:155], v34 offset:25792
    ds_read_b64_tr_b16 a[176:177], v34 offset:20704
    ds_read_b64_tr_b16 a[178:179], v34 offset:25824
    ds_read_b64_tr_b16 a[200:201], v34 offset:20736
    ds_read_b64_tr_b16 a[202:203], v34 offset:25856
    ds_read_b64_tr_b16 a[224:225], v34 offset:20768
    ds_read_b64_tr_b16 a[226:227], v34 offset:25888
    s_waitcnt lgkmcnt(0)
    s_add_u32 s98, s98, 40960
    s_add_u32 m0, s38, 20480
    s_nop 0
    buffer_load_dwordx4 v24, s[8:11], s98 offen lds
    s_add_u32 m0, s38, 21504
    s_nop 0
    buffer_load_dwordx4 v25, s[8:11], s98 offen lds
    s_add_u32 m0, s38, 22528
    s_nop 0
    buffer_load_dwordx4 v26, s[8:11], s98 offen lds
    s_add_u32 m0, s38, 23552
    s_nop 0
    buffer_load_dwordx4 v27, s[8:11], s98 offen lds
    s_add_u32 m0, s38, 24576
    s_nop 0
    buffer_load_dwordx4 v28, s[8:11], s98 offen lds
    s_add_u32 m0, s38, 25600
    s_nop 0
    buffer_load_dwordx4 v29, s[8:11], s98 offen lds
    s_add_u32 m0, s38, 26624
    s_nop 0
    buffer_load_dwordx4 v30, s[8:11], s98 offen lds
    s_add_u32 m0, s38, 27648
    s_nop 0
    buffer_load_dwordx4 v31, s[8:11], s98 offen lds
    s_add_u32 m0, s38, 28672
    s_nop 0
    buffer_load_dwordx4 v32, s[8:11], s98 offen lds
    s_add_u32 m0, s38, 29696
    s_nop 0
    buffer_load_dwordx4 v33, s[8:11], s98 offen lds
    s_waitcnt vmcnt(20)
    ds_read_b64_tr_b16 a[12:13], v34 offset:0
    ds_read_b64_tr_b16 a[14:15], v34 offset:5120
    ds_read_b64_tr_b16 a[36:37], v34 offset:32
    ds_read_b64_tr_b16 a[38:39], v34 offset:5152
    ds_read_b64_tr_b16 a[60:61], v34 offset:64
    ds_read_b64_tr_b16 a[62:63], v34 offset:5184
    ds_read_b64_tr_b16 a[84:85], v34 offset:96
    ds_read_b64_tr_b16 a[86:87], v34 offset:5216
    ds_read_b64_tr_b16 a[108:109], v34 offset:128
    ds_read_b64_tr_b16 a[110:111], v34 offset:5248
    ds_read_b64_tr_b16 a[132:133], v34 offset:160
    ds_read_b64_tr_b16 a[134:135], v34 offset:5280
    ds_read_b64_tr_b16 a[156:157], v34 offset:192
    ds_read_b64_tr_b16 a[158:159], v34 offset:5312
    ds_read_b64_tr_b16 a[180:181], v34 offset:224
    ds_read_b64_tr_b16 a[182:183], v34 offset:5344
    ds_read_b64_tr_b16 a[204:205], v34 offset:256
    ds_read_b64_tr_b16 a[206:207], v34 offset:5376
    ds_read_b64_tr_b16 a[228:229], v34 offset:288
    ds_read_b64_tr_b16 a[230:231], v34 offset:5408
    s_waitcnt lgkmcnt(0)
    s_waitcnt vmcnt(10)
    ds_read_b64_tr_b16 a[16:17], v34 offset:10240
    ds_read_b64_tr_b16 a[18:19], v34 offset:15360
    ds_read_b64_tr_b16 a[40:41], v34 offset:10272
    ds_read_b64_tr_b16 a[42:43], v34 offset:15392
    ds_read_b64_tr_b16 a[64:65], v34 offset:10304
    ds_read_b64_tr_b16 a[66:67], v34 offset:15424
    ds_read_b64_tr_b16 a[88:89], v34 offset:10336
    ds_read_b64_tr_b16 a[90:91], v34 offset:15456
    ds_read_b64_tr_b16 a[112:113], v34 offset:10368
    ds_read_b64_tr_b16 a[114:115], v34 offset:15488
    ds_read_b64_tr_b16 a[136:137], v34 offset:10400
    ds_read_b64_tr_b16 a[138:139], v34 offset:15520
    ds_read_b64_tr_b16 a[160:161], v34 offset:10432
    ds_read_b64_tr_b16 a[162:163], v34 offset:15552
    ds_read_b64_tr_b16 a[184:185], v34 offset:10464
    ds_read_b64_tr_b16 a[186:187], v34 offset:15584
    ds_read_b64_tr_b16 a[208:209], v34 offset:10496
    ds_read_b64_tr_b16 a[210:211], v34 offset:15616
    ds_read_b64_tr_b16 a[232:233], v34 offset:10528
    ds_read_b64_tr_b16 a[234:235], v34 offset:15648
    s_waitcnt lgkmcnt(0)
    s_waitcnt vmcnt(0)
    ds_read_b64_tr_b16 a[20:21], v34 offset:20480
    ds_read_b64_tr_b16 a[22:23], v34 offset:25600
    ds_read_b64_tr_b16 a[44:45], v34 offset:20512
    ds_read_b64_tr_b16 a[46:47], v34 offset:25632
    ds_read_b64_tr_b16 a[68:69], v34 offset:20544
    ds_read_b64_tr_b16 a[70:71], v34 offset:25664
    ds_read_b64_tr_b16 a[92:93], v34 offset:20576
    ds_read_b64_tr_b16 a[94:95], v34 offset:25696
    ds_read_b64_tr_b16 a[116:117], v34 offset:20608
    ds_read_b64_tr_b16 a[118:119], v34 offset:25728
    ds_read_b64_tr_b16 a[140:141], v34 offset:20640
    ds_read_b64_tr_b16 a[142:143], v34 offset:25760
    ds_read_b64_tr_b16 a[164:165], v34 offset:20672
    ds_read_b64_tr_b16 a[166:167], v34 offset:25792
    ds_read_b64_tr_b16 a[188:189], v34 offset:20704
    ds_read_b64_tr_b16 a[190:191], v34 offset:25824
    ds_read_b64_tr_b16 a[212:213], v34 offset:20736
    ds_read_b64_tr_b16 a[214:215], v34 offset:25856
    ds_read_b64_tr_b16 a[236:237], v34 offset:20768
    ds_read_b64_tr_b16 a[238:239], v34 offset:25888
    s_waitcnt lgkmcnt(0)
    v_and_b32 v24, 1, v0
    v_lshlrev_b32 v24, 4, v24
    v_mov_b32 v25, 0x3f80
    v_lshlrev_b32 v25, v24, v25
    v_bfe_u32 v24, v0, 1, 3
    v_cmp_eq_u32 vcc, 0, v24
    s_nop 1
    v_cndmask_b32 v26, 0, v25, vcc
    v_accvgpr_write_b32 a240, v26
    v_cmp_eq_u32 vcc, 4, v24
    s_nop 1
    v_cndmask_b32 v26, 0, v25, vcc
    v_accvgpr_write_b32 a244, v26
    v_cmp_eq_u32 vcc, 1, v24
    s_nop 1
    v_cndmask_b32 v26, 0, v25, vcc
    v_accvgpr_write_b32 a241, v26
    v_cmp_eq_u32 vcc, 5, v24
    s_nop 1
    v_cndmask_b32 v26, 0, v25, vcc
    v_accvgpr_write_b32 a245, v26
    v_cmp_eq_u32 vcc, 2, v24
    s_nop 1
    v_cndmask_b32 v26, 0, v25, vcc
    v_accvgpr_write_b32 a242, v26
    v_cmp_eq_u32 vcc, 6, v24
    s_nop 1
    v_cndmask_b32 v26, 0, v25, vcc
    v_accvgpr_write_b32 a246, v26
    v_cmp_eq_u32 vcc, 3, v24
    s_nop 1
    v_cndmask_b32 v26, 0, v25, vcc
    v_accvgpr_write_b32 a243, v26
    v_cmp_eq_u32 vcc, 7, v24
    s_nop 1
    v_cndmask_b32 v26, 0, v25, vcc
    v_accvgpr_write_b32 a247, v26
    v_and_b32 v24, 15, v0
    v_lshrrev_b32 v25, 4, v0
    s_and_b32 s28, s12, 1
    s_lshr_b32 s29, s12, 1
    v_lshrrev_b32 v26, 1, v25
    v_cmp_eq_u32 s[44:45], s20, v26
    s_lshl_b32 s3, s28, 4
    v_add_u32 v26, s3, v24
    v_lshlrev_b32 v27, 2, v25
    v_sub_u32 v26, v26, v27
    v_cmp_le_i32 s[46:47], 0, v26
    v_cmp_le_i32 s[48:49], 1, v26
    v_cmp_le_i32 s[50:51], 2, v26
    v_cmp_le_i32 s[52:53], 3, v26
    v_cmp_le_i32 s[54:55], 16, v26
    v_cmp_le_i32 s[56:57], 17, v26
    v_cmp_le_i32 s[58:59], 18, v26
    v_cmp_le_i32 s[60:61], 19, v26
    s_lshl_b32 s3, s12, 11
    s_add_u32 s3, s3, 98304
    v_bfe_u32 v26, v0, 1, 2
    v_lshrrev_b32 v27, 4, v0
    v_xor_b32 v26, v26, v27
    v_and_b32 v27, 15, v0
    v_lshl_add_u32 v26, v27, 2, v26
    v_lshl_add_u32 v214, v26, 4, s3
    v_lshl_add_u32 v215, v0, 4, s3
    v_bfe_u32 v26, v0, 3, 2
    v_and_b32 v27, 3, v0
    v_xor_b32 v26, v26, v27
    v_lshrrev_b32 v27, 2, v0
    s_mov_b32 s3, 40960
    v_mul_lo_u32 v5, v27, s3
    v_lshl_add_u32 v5, v26, 4, v5
    s_mul_i32 s3, s12, 320
    v_add_u32 v5, s3, v5
    s_mul_i32 s34, s20, 1310720
    s_mul_i32 s3, s21, 1280
    s_add_u32 s34, s34, s3
    s_add_u32 s34, s34, 209321984
    s_add_u32 s35, s34, 655360
    v_and_b32 v10, 1, v0
    v_lshlrev_b32 v10, 9, v10
    s_lshl_b32 s25, s21, 10
    s_add_u32 s25, s25, 384
    s_mov_b32 s26, 2621440
    s_mul_i32 s3, s28, 6144
    v_add_u32 v1, s3, v16
    v_add_u32 v2, 12288, v16
    s_mul_i32 s3, s29, 12288
    s_add_u32 s3, s3, 18432
    v_add_u32 v3, s3, v16
    v_add_u32 v4, 73728, v16
    s_mul_i32 s3, s29, 6144
    v_add_u32 v15, s3, v4
    s_mul_i32 s3, s29, 3072
    v_add_u32 v212, s3, v4
    s_mul_i32 s3, s28, 6144
    v_add_u32 v212, s3, v212
    s_mov_b32 s63, 0
    v_and_b32 v211, 31, v0
    v_lshlrev_b32 v211, 7, v211
    s_and_b32 s15, s14, 0xfffff000
    s_mov_b32 s42, 1033096506
    s_mov_b32 s43, 1069066811
    s_mul_i32 s23, s20, 7
    s_add_u32 s29, s23, 1
    s_mov_b32 s22, 0
    s_mov_b32 s30, 0
    s_mov_b32 s31, 36864
    s_mul_i32 s39, s21, 1280
    s_mul_i32 s3, s20, 2621440
    s_add_u32 s3, s3, s39
    s_add_u32 s39, s3, 204079104
    s_add_u32 s41, s3, 193593344
    v_mov_b32 v0, v16
    s_barrier
    buffer_load_dword v12, v10, s[4:7], s25 offen sc1
    s_waitcnt vmcnt(0)
    s_mov_b32 s19, 0
    v_cmp_gt_u32 vcc, s29, v12
    s_nop 0
    s_cbranch_vccnz L_O_flspin_5
L_O_fl_4:
    s_add_u32 s98, s22, 0
    s_min_u32 s98, s98, 63
    s_lshl_b32 s96, s20, 6
    s_add_u32 s98, s98, s96
    s_lshl_b32 s98, s98, 5
    s_add_u32 s98, s98, s21
    s_lshl_b32 s98, s98, 2
    s_add_u32 s98, s98, s12
    s_mul_i32 s96, s98, 3072
    s_add_u32 s96, s96, 138018816
    s_mul_i32 s98, s98, 6144
    s_add_u32 s98, s98, 37355520
    s_mul_i32 s62, s12, 3072
    s_add_u32 m0, s62, s30
    s_nop 0
    buffer_load_dwordx4 v0, s[4:7], s96 offen offset:0 sc1 nt lds
    buffer_load_dwordx4 v0, s[4:7], s96 offen offset:1024 sc1 nt lds
    buffer_load_dwordx4 v0, s[4:7], s96 offen offset:2048 sc1 nt lds
    s_lshl_b32 s62, s62, 1
    s_add_u32 s62, s62, s30
    s_add_u32 m0, s62, 12288
    s_nop 0
    buffer_load_dwordx4 v0, s[4:7], s98 offen offset:0 sc1 nt lds
    buffer_load_dwordx4 v0, s[4:7], s98 offen offset:1024 sc1 nt lds
    buffer_load_dwordx4 v0, s[4:7], s98 offen offset:2048 sc1 nt lds
    s_add_u32 s98, s98, 3072
    s_add_u32 m0, s62, 15360
    s_nop 0
    buffer_load_dwordx4 v0, s[4:7], s98 offen offset:0 sc1 nt lds
    buffer_load_dwordx4 v0, s[4:7], s98 offen offset:1024 sc1 nt lds
    buffer_load_dwordx4 v0, s[4:7], s98 offen offset:2048 sc1 nt lds
    s_lshl_b32 s37, s23, 5
    s_add_u32 s37, s37, s21
    s_lshl_b32 s37, s37, 2
    s_add_u32 s37, s37, s12
    s_mul_i32 s37, s37, 3072
    s_add_u32 s37, s37, 5898240
    s_mul_i32 s28, s12, 3072
    s_add_u32 m0, s28, 73728
    s_nop 0
    buffer_load_dwordx4 v0, s[4:7], s37 offen offset:0 sc1 lds
    buffer_load_dwordx4 v0, s[4:7], s37 offen offset:1024 sc1 lds
    buffer_load_dwordx4 v0, s[4:7], s37 offen offset:2048 sc1 lds
    s_waitcnt vmcnt(0)
    s_mov_b32 s30, 36864
    s_add_u32 s23, s23, 1
    s_barrier
    ds_read_b128 v[16:19], v1 offset:0
    ds_read_b128 v[40:43], v2 offset:0
    ds_read_b128 v[64:67], v2 offset:3072
    ds_read_b128 v[20:23], v1 offset:1024
    ds_read_b128 v[44:47], v2 offset:1024
    ds_read_b128 v[68:71], v2 offset:4096
    ds_read_b128 v[24:27], v1 offset:2048
    ds_read_b128 v[48:51], v2 offset:2048
    ds_read_b128 v[72:75], v2 offset:5120
    ds_read_b128 v[28:31], v1 offset:3072
    ds_read_b128 v[52:55], v2 offset:12288
    ds_read_b128 v[76:79], v2 offset:15360
    ds_read_b128 v[32:35], v1 offset:4096
    ds_read_b128 v[56:59], v2 offset:13312
    ds_read_b128 v[80:83], v2 offset:16384
    ds_read_b128 v[36:39], v1 offset:5120
    ds_read_b128 v[60:63], v2 offset:14336
    ds_read_b128 v[84:87], v2 offset:17408
    s_waitcnt lgkmcnt(15)
    v_mfma_f32_16x16x32_bf16 v[152:155], v[40:43], v[16:19], 0
    v_mfma_f32_16x16x32_bf16 v[156:159], v[64:67], v[16:19], 0
    s_waitcnt lgkmcnt(12)
    v_mfma_f32_16x16x32_bf16 v[152:155], v[44:47], v[20:23], v[152:155]
    v_mfma_f32_16x16x32_bf16 v[156:159], v[68:71], v[20:23], v[156:159]
    s_waitcnt lgkmcnt(9)
    v_mfma_f32_16x16x32_bf16 v[152:155], v[48:51], v[24:27], v[152:155]
    v_mfma_f32_16x16x32_bf16 v[156:159], v[72:75], v[24:27], v[156:159]
    s_waitcnt lgkmcnt(6)
    v_mfma_f32_16x16x32_bf16 v[152:155], v[52:55], v[28:31], v[152:155]
    v_mfma_f32_16x16x32_bf16 v[156:159], v[76:79], v[28:31], v[156:159]
    s_waitcnt lgkmcnt(3)
    v_mfma_f32_16x16x32_bf16 v[152:155], v[56:59], v[32:35], v[152:155]
    v_mfma_f32_16x16x32_bf16 v[156:159], v[80:83], v[32:35], v[156:159]
    s_waitcnt lgkmcnt(0)
    v_mfma_f32_16x16x32_bf16 v[152:155], v[60:63], v[36:39], v[152:155]
    v_mfma_f32_16x16x32_bf16 v[156:159], v[84:87], v[36:39], v[156:159]
    ds_read_b128 v[112:115], v3 offset:0
    ds_read_b128 v[116:119], v3 offset:1024
    ds_read_b128 v[120:123], v3 offset:2048
    ds_read_b128 v[124:127], v3 offset:3072
    ds_read_b128 v[128:131], v3 offset:4096
    ds_read_b128 v[132:135], v3 offset:5120
    s_nop 0
    v_cvt_pk_bf16_f32 v162, v152, v153
    v_cvt_pk_bf16_f32 v163, v154, v155
    v_cvt_pk_bf16_f32 v164, v156, v157
    v_cvt_pk_bf16_f32 v165, v158, v159
    v_lshlrev_b32 v152, 16, v162
    v_and_b32 v153, 0xffff0000, v162
    v_lshlrev_b32 v154, 16, v163
    v_and_b32 v155, 0xffff0000, v163
    v_lshlrev_b32 v156, 16, v164
    v_and_b32 v157, 0xffff0000, v164
    v_lshlrev_b32 v158, 16, v165
    v_and_b32 v159, 0xffff0000, v165
    v_mul_f32 v152, s42, v152
    v_mul_f32 v153, s42, v153
    v_mul_f32 v154, s42, v154
    v_mul_f32 v155, s42, v155
    v_mul_f32 v156, s42, v156
    v_mul_f32 v157, s42, v157
    v_mul_f32 v158, s42, v158
    v_mul_f32 v159, s42, v159
    v_cvt_pk_bf16_f32 v162, v152, v153
    v_cvt_pk_bf16_f32 v163, v154, v155
    v_cvt_pk_bf16_f32 v164, v156, v157
    v_cvt_pk_bf16_f32 v165, v158, v159
    v_lshlrev_b32 v152, 16, v162
    v_and_b32 v153, 0xffff0000, v162
    v_lshlrev_b32 v154, 16, v163
    v_and_b32 v155, 0xffff0000, v163
    v_lshlrev_b32 v156, 16, v164
    v_and_b32 v157, 0xffff0000, v164
    v_lshlrev_b32 v158, 16, v165
    v_and_b32 v159, 0xffff0000, v165
    v_mov_b32 v160, 0xff800000
    v_cndmask_b32 v152, v160, v152, s[46:47]
    v_cndmask_b32 v153, v160, v153, s[48:49]
    v_cndmask_b32 v154, v160, v154, s[50:51]
    v_cndmask_b32 v155, v160, v155, s[52:53]
    v_cndmask_b32 v156, v160, v156, s[54:55]
    v_cndmask_b32 v157, v160, v157, s[56:57]
    v_cndmask_b32 v158, v160, v158, s[58:59]
    v_cndmask_b32 v159, v160, v159, s[60:61]
    s_waitcnt lgkmcnt(0)
    s_cmp_lg_u32 s18, 0
    s_cbranch_scc1 L_O_slow
    s_branch L_O_fast
L_O_flspin_5:
    buffer_load_dword v12, v10, s[4:7], s25 offen sc1
    s_add_u32 s19, s19, 1
    s_cmp_ge_u32 s19, 524288
    s_cbranch_scc1 L_fail
    s_waitcnt vmcnt(0)
    v_cmp_gt_u32 vcc, s29, v12
    s_nop 0
    s_cbranch_vccnz L_O_flspin_5
    s_branch L_O_fl_4
L_O_fast:
L_Of_top:
    ds_read_b128 v[88:91], v4 offset:0
    ds_read_b128 v[92:95], v4 offset:1024
    ds_read_b128 v[96:99], v4 offset:2048
    ds_read_b128 v[100:103], v4 offset:6144
    ds_read_b128 v[104:107], v4 offset:7168
    ds_read_b128 v[108:111], v4 offset:8192
    ds_read_b128 v[136:139], v15 offset:3072
    ds_read_b128 v[140:143], v15 offset:4096
    ds_read_b128 v[144:147], v15 offset:5120
    buffer_load_dword v12, v10, s[4:7], s25 offen sc1
    buffer_load_dwordx4 v[220:223], v210, s[4:7], s39 offen sc1
    buffer_load_dwordx4 v[224:227], v209, s[4:7], s39 offen sc1
    s_add_u32 s98, s22, 1
    s_min_u32 s98, s98, 63
    s_lshl_b32 s96, s20, 6
    s_add_u32 s98, s98, s96
    s_lshl_b32 s98, s98, 5
    s_add_u32 s98, s98, s21
    s_lshl_b32 s98, s98, 2
    s_add_u32 s98, s98, s12
    s_mul_i32 s96, s98, 3072
    s_add_u32 s96, s96, 138018816
    s_mul_i32 s98, s98, 6144
    s_add_u32 s98, s98, 37355520
    s_mul_i32 s62, s12, 3072
    v_mov_b32 v14, 0xff800000
    s_lshr_b32 s27, s22, 1
    s_andn2_b32 s32, 1, s27
    s_sub_u32 s33, 0, s32
    s_add_u32 s29, s23, 1
    s_cmp_eq_u32 s22, 63
    s_cselect_b32 s29, -1, s29
    s_waitcnt lgkmcnt(8)
    v_mfma_f32_16x16x32_bf16 v[148:151], v[88:91], v[16:19], 0
    s_waitcnt lgkmcnt(7)
    v_mfma_f32_16x16x32_bf16 v[148:151], v[92:95], v[20:23], v[148:151]
    s_waitcnt lgkmcnt(6)
    v_mfma_f32_16x16x32_bf16 v[148:151], v[96:99], v[24:27], v[148:151]
    s_waitcnt lgkmcnt(5)
    v_mfma_f32_16x16x32_bf16 v[148:151], v[100:103], v[28:31], v[148:151]
    s_waitcnt lgkmcnt(4)
    s_add_u32 m0, s62, s30
    v_mfma_f32_16x16x32_bf16 v[148:151], v[104:107], v[32:35], v[148:151]
    s_waitcnt lgkmcnt(3)
    v_mfma_f32_16x16x32_bf16 v[148:151], v[108:111], v[36:39], v[148:151]
    v_max3_f32 v161, v152, v153, v154
    v_max3_f32 v161, v161, v155, v156
    v_max3_f32 v161, v161, v157, v158
    v_max_f32 v161, v161, v159
    s_nop 3
    v_cvt_pk_bf16_f32 v162, v148, v149
    v_cvt_pk_bf16_f32 v163, v150, v151
    buffer_load_dwordx4 v0, s[4:7], s96 offen offset:0 sc1 nt lds
    v_lshlrev_b32 v148, 16, v162
    v_and_b32 v149, 0xffff0000, v162
    v_lshlrev_b32 v150, 16, v163
    v_and_b32 v151, 0xffff0000, v163
    v_mul_f32 v148, s42, v148
    v_mul_f32 v149, s42, v149
    v_mul_f32 v150, s42, v150
    v_mul_f32 v151, s42, v151
    v_cvt_pk_bf16_f32 v162, v148, v149
    buffer_load_dwordx4 v0, s[4:7], s96 offen offset:1024 sc1 nt lds
    v_cvt_pk_bf16_f32 v163, v150, v151
    v_lshlrev_b32 v148, 16, v162
    v_and_b32 v149, 0xffff0000, v162
    v_lshlrev_b32 v150, 16, v163
    v_and_b32 v151, 0xffff0000, v163
    v_cndmask_b32 v148, v14, v148, s[44:45]
    v_cndmask_b32 v149, v14, v149, s[44:45]
    v_cndmask_b32 v150, v14, v150, s[44:45]
    v_cndmask_b32 v151, v14, v151, s[44:45]
    buffer_load_dwordx4 v0, s[4:7], s96 offen offset:2048 sc1 nt lds
    v_max3_f32 v160, v148, v149, v161
    v_max3_f32 v160, v150, v151, v160
    v_mov_b32 v161, v160
    s_nop 1
    v_permlane32_swap_b32 v160, v161
    v_max_f32 v160, v160, v161
    v_mov_b32 v161, v160
    s_nop 1
    v_permlane16_swap_b32 v160, v161
    v_max_f32 v160, v160, v161
    v_mul_f32 v160, s43, v160
    s_lshl_b32 s62, s62, 1
    s_add_u32 s62, s62, s30
    s_add_u32 m0, s62, 12288
    v_fma_f32 v148, v148, s43, -v160
    v_fma_f32 v149, v149, s43, -v160
    v_fma_f32 v150, v150, s43, -v160
    v_fma_f32 v151, v151, s43, -v160
    v_fma_f32 v152, v152, s43, -v160
    v_fma_f32 v153, v153, s43, -v160
    v_fma_f32 v154, v154, s43, -v160
    v_fma_f32 v155, v155, s43, -v160
    v_fma_f32 v156, v156, s43, -v160
    buffer_load_dwordx4 v0, s[4:7], s98 offen offset:0 sc1 nt lds
    v_fma_f32 v157, v157, s43, -v160
    v_fma_f32 v158, v158, s43, -v160
    v_fma_f32 v159, v159, s43, -v160
    v_exp_f32 v148, v148
    v_exp_f32 v149, v149
    v_exp_f32 v150, v150
    v_exp_f32 v151, v151
    v_exp_f32 v152, v152
    v_exp_f32 v153, v153
    buffer_load_dwordx4 v0, s[4:7], s98 offen offset:1024 sc1 nt lds
    v_exp_f32 v154, v154
    v_exp_f32 v155, v155
    v_exp_f32 v156, v156
    v_exp_f32 v157, v157
    v_exp_f32 v158, v158
    v_exp_f32 v159, v159
    v_pk_add_f32 v[160:161], v[148:149], v[150:151]
    v_pk_add_f32 v[160:161], v[160:161], v[152:153]
    v_pk_add_f32 v[160:161], v[160:161], v[154:155]
    buffer_load_dwordx4 v0, s[4:7], s98 offen offset:2048 sc1 nt lds
    v_pk_add_f32 v[160:161], v[160:161], v[156:157]
    v_pk_add_f32 v[160:161], v[160:161], v[158:159]
    v_add_f32 v160, v160, v161
    v_mov_b32 v161, v160
    s_nop 1
    v_permlane32_swap_b32 v160, v161
    v_add_f32 v160, v160, v161
    v_mov_b32 v161, v160
    s_nop 1
    v_permlane16_swap_b32 v160, v161
    v_add_f32 v160, v160, v161
    s_add_u32 s98, s98, 3072
    s_add_u32 m0, s62, 15360
    v_rcp_f32 v160, v160
    s_nop 0
    v_pk_mul_f32 v[148:149], v[148:149], v[160:161] op_sel_hi:[1,0]
    v_pk_mul_f32 v[150:151], v[150:151], v[160:161] op_sel_hi:[1,0]
    v_pk_mul_f32 v[152:153], v[152:153], v[160:161] op_sel_hi:[1,0]
    v_pk_mul_f32 v[154:155], v[154:155], v[160:161] op_sel_hi:[1,0]
    v_pk_mul_f32 v[156:157], v[156:157], v[160:161] op_sel_hi:[1,0]
    v_pk_mul_f32 v[158:159], v[158:159], v[160:161] op_sel_hi:[1,0]
    v_cvt_pk_bf16_f32 v164, v148, v149
    v_cvt_pk_bf16_f32 v165, v150, v151
    buffer_load_dwordx4 v0, s[4:7], s98 offen offset:0 sc1 nt lds
    v_cvt_pk_bf16_f32 v166, v152, v153
    v_cvt_pk_bf16_f32 v167, v154, v155
    v_cvt_pk_bf16_f32 v168, v156, v157
    v_cvt_pk_bf16_f32 v169, v158, v159
    buffer_load_dwordx4 v0, s[4:7], s98 offen offset:1024 sc1 nt lds
    buffer_load_dwordx4 v0, s[4:7], s98 offen offset:2048 sc1 nt lds
    s_waitcnt lgkmcnt(0)
    v_mfma_f32_16x16x16_bf16 v[170:173], v[136:137], v[164:165], 0
    v_mfma_f32_16x16x16_bf16 v[174:177], v[138:139], v[164:165], 0
    v_mfma_f32_16x16x16_bf16 v[178:181], v[140:141], v[164:165], 0
    v_mfma_f32_16x16x16_bf16 v[182:185], v[142:143], v[164:165], 0
    v_mfma_f32_16x16x16_bf16 v[186:189], v[144:145], v[164:165], 0
    v_mfma_f32_16x16x16_bf16 v[190:193], v[146:147], v[164:165], 0
    s_nop 0
    v_mfma_f32_16x16x32_bf16 v[170:173], v[112:115], v[166:169], v[170:173]
    v_mfma_f32_16x16x32_bf16 v[174:177], v[116:119], v[166:169], v[174:177]
    v_mfma_f32_16x16x32_bf16 v[178:181], v[120:123], v[166:169], v[178:181]
    v_mfma_f32_16x16x32_bf16 v[182:185], v[124:127], v[166:169], v[182:185]
    v_mfma_f32_16x16x32_bf16 v[186:189], v[128:131], v[166:169], v[186:189]
    v_mfma_f32_16x16x32_bf16 v[190:193], v[132:135], v[166:169], v[190:193]
    s_waitcnt vmcnt(11)
    v_cmp_gt_u32 vcc, s29, v12
    s_cmp_eq_u64 vcc, 0
    s_cselect_b32 s3, 1, 0
    v_mov_b32 v13, s3
    s_cmp_eq_u32 s12, 0
    s_cselect_b64 exec, 1, 0
    ds_write_b32 v213, v13 offset:64
    s_mov_b64 exec, -1
    v_cvt_pk_bf16_f32 v194, v170, v171
    v_cvt_pk_bf16_f32 v195, v172, v173
    v_cvt_pk_bf16_f32 v196, v174, v175
    v_cvt_pk_bf16_f32 v197, v176, v177
    ds_write_b128 v212, v[194:197] offset:12288
    v_cvt_pk_bf16_f32 v198, v178, v179
    v_cvt_pk_bf16_f32 v199, v180, v181
    v_cvt_pk_bf16_f32 v200, v182, v183
    v_cvt_pk_bf16_f32 v201, v184, v185
    ds_write_b128 v212, v[198:201] offset:13312
    v_cvt_pk_bf16_f32 v202, v186, v187
    v_cvt_pk_bf16_f32 v203, v188, v189
    v_cvt_pk_bf16_f32 v204, v190, v191
    v_cvt_pk_bf16_f32 v205, v192, v193
    ds_write_b128 v212, v[202:205] offset:14336
    s_waitcnt lgkmcnt(0)
    s_barrier
    ds_read_b32 v12, v213 offset:64
    ds_read_b128 v[16:19], v4 offset:12288
    ds_read_b128 v[20:23], v4 offset:13312
    ds_read_b128 v[24:27], v4 offset:14336
    ds_read_b128 v[28:31], v4 offset:15360
    ds_read_b128 v[32:35], v4 offset:16384
    ds_read_b128 v[36:39], v4 offset:17408
    ds_read_b128 v[40:43], v4 offset:18432
    ds_read_b128 v[44:47], v4 offset:19456
    ds_read_b128 v[48:51], v4 offset:20480
    ds_read_b128 v[52:55], v4 offset:21504
    ds_read_b128 v[56:59], v4 offset:22528
    ds_read_b128 v[60:63], v4 offset:23552
    s_cmp_eq_u32 s63, 0
    s_cbranch_scc1 L_Of_nopend_1
    v_mov_b32 v13, s22
    s_mov_b64 exec, 1
    buffer_store_dword v13, v0, s[4:7], s24 offen offset:0 sc1
    s_mov_b64 exec, -1
L_Of_nopend_1:
    s_waitcnt lgkmcnt(12)
    v_readfirstlane_b32 s97, v12
    s_waitcnt lgkmcnt(11)
    v_mfma_f32_16x16x32_bf16 v[64:67], a[0:3], v[16:19], 0
    s_waitcnt lgkmcnt(10)
    v_mfma_f32_16x16x32_bf16 v[64:67], a[4:7], v[20:23], v[64:67]
    s_waitcnt lgkmcnt(9)
    v_mfma_f32_16x16x32_bf16 v[64:67], a[8:11], v[24:27], v[64:67]
    s_waitcnt lgkmcnt(8)
    v_mfma_f32_16x16x32_bf16 v[64:67], a[12:15], v[28:31], v[64:67]
    s_waitcnt lgkmcnt(7)
    v_mfma_f32_16x16x32_bf16 v[64:67], a[16:19], v[32:35], v[64:67]
    s_waitcnt lgkmcnt(6)
    v_mfma_f32_16x16x32_bf16 v[64:67], a[20:23], v[36:39], v[64:67]
    v_mfma_f32_16x16x32_bf16 v[68:71], a[24:27], v[16:19], 0
    v_mfma_f32_16x16x32_bf16 v[68:71], a[28:31], v[20:23], v[68:71]
    v_mfma_f32_16x16x32_bf16 v[68:71], a[32:35], v[24:27], v[68:71]
    v_mfma_f32_16x16x32_bf16 v[68:71], a[36:39], v[28:31], v[68:71]
    v_mfma_f32_16x16x32_bf16 v[68:71], a[40:43], v[32:35], v[68:71]
    v_mfma_f32_16x16x32_bf16 v[68:71], a[44:47], v[36:39], v[68:71]
    s_waitcnt lgkmcnt(5)
    v_mfma_f32_16x16x32_bf16 v[72:75], a[0:3], v[40:43], 0
    s_waitcnt lgkmcnt(4)
    v_mfma_f32_16x16x32_bf16 v[72:75], a[4:7], v[44:47], v[72:75]
    s_waitcnt lgkmcnt(3)
    v_mfma_f32_16x16x32_bf16 v[72:75], a[8:11], v[48:51], v[72:75]
    v_cvt_pk_bf16_f32 v80, v64, v65
    s_waitcnt lgkmcnt(2)
    v_mfma_f32_16x16x32_bf16 v[72:75], a[12:15], v[52:55], v[72:75]
    v_cvt_pk_bf16_f32 v81, v66, v67
    v_and_or_b32 v80, v80, -2, s32
    s_waitcnt lgkmcnt(1)
    v_mfma_f32_16x16x32_bf16 v[72:75], a[16:19], v[56:59], v[72:75]
    v_cvt_pk_bf16_f32 v82, v68, v69
    s_waitcnt lgkmcnt(0)
    v_mfma_f32_16x16x32_bf16 v[72:75], a[20:23], v[60:63], v[72:75]
    v_cvt_pk_bf16_f32 v83, v70, v71
    v_mfma_f32_16x16x32_bf16 v[76:79], a[24:27], v[40:43], 0
    ds_write_b128 v214, v[80:83] offset:0
    v_mfma_f32_16x16x32_bf16 v[76:79], a[28:31], v[44:47], v[76:79]
    ds_read_b128 v[88:91], v215 offset:0
    v_mfma_f32_16x16x32_bf16 v[76:79], a[32:35], v[48:51], v[76:79]
    v_mfma_f32_16x16x32_bf16 v[76:79], a[36:39], v[52:55], v[76:79]
    v_mfma_f32_16x16x32_bf16 v[76:79], a[40:43], v[56:59], v[76:79]
    v_mfma_f32_16x16x32_bf16 v[76:79], a[44:47], v[60:63], v[76:79]
    v_mfma_f32_16x16x32_bf16 v[64:67], a[48:51], v[16:19], 0
    v_mfma_f32_16x16x32_bf16 v[64:67], a[52:55], v[20:23], v[64:67]
    v_mfma_f32_16x16x32_bf16 v[64:67], a[56:59], v[24:27], v[64:67]
    v_cvt_pk_bf16_f32 v84, v72, v73
    v_mfma_f32_16x16x32_bf16 v[64:67], a[60:63], v[28:31], v[64:67]
    v_cvt_pk_bf16_f32 v85, v74, v75
    v_and_or_b32 v84, v84, -2, s32
    v_mfma_f32_16x16x32_bf16 v[64:67], a[64:67], v[32:35], v[64:67]
    v_cvt_pk_bf16_f32 v86, v76, v77
    v_mfma_f32_16x16x32_bf16 v[64:67], a[68:71], v[36:39], v[64:67]
    s_waitcnt lgkmcnt(0)
    buffer_store_dwordx4 v[88:91], v5, s[4:7], s34 offen offset:0
    v_cvt_pk_bf16_f32 v87, v78, v79
    v_mfma_f32_16x16x32_bf16 v[68:71], a[72:75], v[16:19], 0
    ds_write_b128 v214, v[84:87] offset:1024
    v_mfma_f32_16x16x32_bf16 v[68:71], a[76:79], v[20:23], v[68:71]
    ds_read_b128 v[92:95], v215 offset:1024
    v_mfma_f32_16x16x32_bf16 v[68:71], a[80:83], v[24:27], v[68:71]
    v_mfma_f32_16x16x32_bf16 v[68:71], a[84:87], v[28:31], v[68:71]
    v_mfma_f32_16x16x32_bf16 v[68:71], a[88:91], v[32:35], v[68:71]
    v_mfma_f32_16x16x32_bf16 v[68:71], a[92:95], v[36:39], v[68:71]
    v_mfma_f32_16x16x32_bf16 v[72:75], a[48:51], v[40:43], 0
    v_mfma_f32_16x16x32_bf16 v[72:75], a[52:55], v[44:47], v[72:75]
    v_mfma_f32_16x16x32_bf16 v[72:75], a[56:59], v[48:51], v[72:75]
    v_cvt_pk_bf16_f32 v80, v64, v65
    v_mfma_f32_16x16x32_bf16 v[72:75], a[60:63], v[52:55], v[72:75]
    v_cvt_pk_bf16_f32 v81, v66, v67
    v_and_or_b32 v80, v80, -2, s32
    v_mfma_f32_16x16x32_bf16 v[72:75], a[64:67], v[56:59], v[72:75]
    v_cvt_pk_bf16_f32 v82, v68, v69
    v_mfma_f32_16x16x32_bf16 v[72:75], a[68:71], v[60:63], v[72:75]
    s_waitcnt lgkmcnt(0)
    buffer_store_dwordx4 v[92:95], v5, s[4:7], s35 offen offset:0
    v_cvt_pk_bf16_f32 v83, v70, v71
    v_mfma_f32_16x16x32_bf16 v[76:79], a[72:75], v[40:43], 0
    ds_write_b128 v214, v[80:83] offset:0
    v_mfma_f32_16x16x32_bf16 v[76:79], a[76:79], v[44:47], v[76:79]
    ds_read_b128 v[88:91], v215 offset:0
    v_mfma_f32_16x16x32_bf16 v[76:79], a[80:83], v[48:51], v[76:79]
    v_mfma_f32_16x16x32_bf16 v[76:79], a[84:87], v[52:55], v[76:79]
    v_mfma_f32_16x16x32_bf16 v[76:79], a[88:91], v[56:59], v[76:79]
    v_mfma_f32_16x16x32_bf16 v[76:79], a[92:95], v[60:63], v[76:79]
    v_mfma_f32_16x16x32_bf16 v[64:67], a[96:99], v[16:19], 0
    v_mfma_f32_16x16x32_bf16 v[64:67], a[100:103], v[20:23], v[64:67]
    v_mfma_f32_16x16x32_bf16 v[64:67], a[104:107], v[24:27], v[64:67]
    v_cvt_pk_bf16_f32 v84, v72, v73
    v_mfma_f32_16x16x32_bf16 v[64:67], a[108:111], v[28:31], v[64:67]
    v_cvt_pk_bf16_f32 v85, v74, v75
    v_and_or_b32 v84, v84, -2, s32
    v_mfma_f32_16x16x32_bf16 v[64:67], a[112:115], v[32:35], v[64:67]
    v_cvt_pk_bf16_f32 v86, v76, v77
    v_mfma_f32_16x16x32_bf16 v[64:67], a[116:119], v[36:39], v[64:67]
    s_waitcnt lgkmcnt(0)
    buffer_store_dwordx4 v[88:91], v5, s[4:7], s34 offen offset:64
    v_cvt_pk_bf16_f32 v87, v78, v79
    v_mfma_f32_16x16x32_bf16 v[68:71], a[120:123], v[16:19], 0
    ds_write_b128 v214, v[84:87] offset:1024
    v_mfma_f32_16x16x32_bf16 v[68:71], a[124:127], v[20:23], v[68:71]
    ds_read_b128 v[92:95], v215 offset:1024
    v_mfma_f32_16x16x32_bf16 v[68:71], a[128:131], v[24:27], v[68:71]
    v_mfma_f32_16x16x32_bf16 v[68:71], a[132:135], v[28:31], v[68:71]
    v_mfma_f32_16x16x32_bf16 v[68:71], a[136:139], v[32:35], v[68:71]
    v_mfma_f32_16x16x32_bf16 v[68:71], a[140:143], v[36:39], v[68:71]
    v_mfma_f32_16x16x32_bf16 v[72:75], a[96:99], v[40:43], 0
    v_mfma_f32_16x16x32_bf16 v[72:75], a[100:103], v[44:47], v[72:75]
    v_mfma_f32_16x16x32_bf16 v[72:75], a[104:107], v[48:51], v[72:75]
    v_cvt_pk_bf16_f32 v80, v64, v65
    v_mfma_f32_16x16x32_bf16 v[72:75], a[108:111], v[52:55], v[72:75]
    v_cvt_pk_bf16_f32 v81, v66, v67
    v_and_or_b32 v80, v80, -2, s32
    v_mfma_f32_16x16x32_bf16 v[72:75], a[112:115], v[56:59], v[72:75]
    v_cvt_pk_bf16_f32 v82, v68, v69
    v_mfma_f32_16x16x32_bf16 v[72:75], a[116:119], v[60:63], v[72:75]
    s_waitcnt lgkmcnt(0)
    buffer_store_dwordx4 v[92:95], v5, s[4:7], s35 offen offset:64
    v_cvt_pk_bf16_f32 v83, v70, v71
    v_mfma_f32_16x16x32_bf16 v[76:79], a[120:123], v[40:43], 0
    ds_write_b128 v214, v[80:83] offset:0
    v_mfma_f32_16x16x32_bf16 v[76:79], a[124:127], v[44:47], v[76:79]
    ds_read_b128 v[88:91], v215 offset:0
    v_mfma_f32_16x16x32_bf16 v[76:79], a[128:131], v[48:51], v[76:79]
    v_mfma_f32_16x16x32_bf16 v[76:79], a[132:135], v[52:55], v[76:79]
    v_mfma_f32_16x16x32_bf16 v[76:79], a[136:139], v[56:59], v[76:79]
    v_mfma_f32_16x16x32_bf16 v[76:79], a[140:143], v[60:63], v[76:79]
    v_mfma_f32_16x16x32_bf16 v[64:67], a[144:147], v[16:19], 0
    v_mfma_f32_16x16x32_bf16 v[64:67], a[148:151], v[20:23], v[64:67]
    v_mfma_f32_16x16x32_bf16 v[64:67], a[152:155], v[24:27], v[64:67]
    v_cvt_pk_bf16_f32 v84, v72, v73
    v_mfma_f32_16x16x32_bf16 v[64:67], a[156:159], v[28:31], v[64:67]
    v_cvt_pk_bf16_f32 v85, v74, v75
    v_and_or_b32 v84, v84, -2, s32
    v_mfma_f32_16x16x32_bf16 v[64:67], a[160:163], v[32:35], v[64:67]
    v_cvt_pk_bf16_f32 v86, v76, v77
    v_mfma_f32_16x16x32_bf16 v[64:67], a[164:167], v[36:39], v[64:67]
    s_waitcnt lgkmcnt(0)
    buffer_store_dwordx4 v[88:91], v5, s[4:7], s34 offen offset:128
    v_cvt_pk_bf16_f32 v87, v78, v79
    v_mfma_f32_16x16x32_bf16 v[68:71], a[168:171], v[16:19], 0
    ds_write_b128 v214, v[84:87] offset:1024
    v_mfma_f32_16x16x32_bf16 v[68:71], a[172:175], v[20:23], v[68:71]
    ds_read_b128 v[92:95], v215 offset:1024
    v_mfma_f32_16x16x32_bf16 v[68:71], a[176:179], v[24:27], v[68:71]
    v_mfma_f32_16x16x32_bf16 v[68:71], a[180:183], v[28:31], v[68:71]
    v_mfma_f32_16x16x32_bf16 v[68:71], a[184:187], v[32:35], v[68:71]
    v_mfma_f32_16x16x32_bf16 v[68:71], a[188:191], v[36:39], v[68:71]
    v_mfma_f32_16x16x32_bf16 v[72:75], a[144:147], v[40:43], 0
    v_mfma_f32_16x16x32_bf16 v[72:75], a[148:151], v[44:47], v[72:75]
    v_mfma_f32_16x16x32_bf16 v[72:75], a[152:155], v[48:51], v[72:75]
    v_cvt_pk_bf16_f32 v80, v64, v65
    v_mfma_f32_16x16x32_bf16 v[72:75], a[156:159], v[52:55], v[72:75]
    v_cvt_pk_bf16_f32 v81, v66, v67
    v_and_or_b32 v80, v80, -2, s32
    v_mfma_f32_16x16x32_bf16 v[72:75], a[160:163], v[56:59], v[72:75]
    v_cvt_pk_bf16_f32 v82, v68, v69
    v_mfma_f32_16x16x32_bf16 v[72:75], a[164:167], v[60:63], v[72:75]
    s_waitcnt lgkmcnt(0)
    buffer_store_dwordx4 v[92:95], v5, s[4:7], s35 offen offset:128
    v_cvt_pk_bf16_f32 v83, v70, v71
    v_mfma_f32_16x16x32_bf16 v[76:79], a[168:171], v[40:43], 0
    ds_write_b128 v214, v[80:83] offset:0
    v_mfma_f32_16x16x32_bf16 v[76:79], a[172:175], v[44:47], v[76:79]
    ds_read_b128 v[88:91], v215 offset:0
    v_mfma_f32_16x16x32_bf16 v[76:79], a[176:179], v[48:51], v[76:79]
    v_mfma_f32_16x16x32_bf16 v[76:79], a[180:183], v[52:55], v[76:79]
    v_mfma_f32_16x16x32_bf16 v[76:79], a[184:187], v[56:59], v[76:79]
    v_mfma_f32_16x16x32_bf16 v[76:79], a[188:191], v[60:63], v[76:79]
    v_mfma_f32_16x16x32_bf16 v[64:67], a[192:195], v[16:19], 0
    v_mfma_f32_16x16x32_bf16 v[64:67], a[196:199], v[20:23], v[64:67]
    v_mfma_f32_16x16x32_bf16 v[64:67], a[200:203], v[24:27], v[64:67]
    v_cvt_pk_bf16_f32 v84, v72, v73
    v_mfma_f32_16x16x32_bf16 v[64:67], a[204:207], v[28:31], v[64:67]
    v_cvt_pk_bf16_f32 v85, v74, v75
    v_and_or_b32 v84, v84, -2, s32
    v_mfma_f32_16x16x32_bf16 v[64:67], a[208:211], v[32:35], v[64:67]
    v_cvt_pk_bf16_f32 v86, v76, v77
    v_mfma_f32_16x16x32_bf16 v[64:67], a[212:215], v[36:39], v[64:67]
    s_waitcnt lgkmcnt(0)
    buffer_store_dwordx4 v[88:91], v5, s[4:7], s34 offen offset:192
    v_cvt_pk_bf16_f32 v87, v78, v79
    v_mfma_f32_16x16x32_bf16 v[68:71], a[216:219], v[16:19], 0
    ds_write_b128 v214, v[84:87] offset:1024
    v_mfma_f32_16x16x32_bf16 v[68:71], a[220:223], v[20:23], v[68:71]
    ds_read_b128 v[92:95], v215 offset:1024
    v_mfma_f32_16x16x32_bf16 v[68:71], a[224:227], v[24:27], v[68:71]
    v_mfma_f32_16x16x32_bf16 v[68:71], a[228:231], v[28:31], v[68:71]
    v_mfma_f32_16x16x32_bf16 v[68:71], a[232:235], v[32:35], v[68:71]
    v_mfma_f32_16x16x32_bf16 v[68:71], a[236:239], v[36:39], v[68:71]
    v_mfma_f32_16x16x32_bf16 v[72:75], a[192:195], v[40:43], 0
    v_mfma_f32_16x16x32_bf16 v[72:75], a[196:199], v[44:47], v[72:75]
    v_mfma_f32_16x16x32_bf16 v[72:75], a[200:203], v[48:51], v[72:75]
    v_cvt_pk_bf16_f32 v80, v64, v65
    v_mfma_f32_16x16x32_bf16 v[72:75], a[204:207], v[52:55], v[72:75]
    v_cvt_pk_bf16_f32 v81, v66, v67
    v_and_or_b32 v80, v80, -2, s32
    v_mfma_f32_16x16x32_bf16 v[72:75], a[208:211], v[56:59], v[72:75]
    v_cvt_pk_bf16_f32 v82, v68, v69
    v_mfma_f32_16x16x32_bf16 v[72:75], a[212:215], v[60:63], v[72:75]
    s_waitcnt lgkmcnt(0)
    buffer_store_dwordx4 v[92:95], v5, s[4:7], s35 offen offset:192
    v_cvt_pk_bf16_f32 v83, v70, v71
    v_mfma_f32_16x16x32_bf16 v[76:79], a[216:219], v[40:43], 0
    ds_write_b128 v214, v[80:83] offset:0
    v_mfma_f32_16x16x32_bf16 v[76:79], a[220:223], v[44:47], v[76:79]
    ds_read_b128 v[88:91], v215 offset:0
    v_mfma_f32_16x16x32_bf16 v[76:79], a[224:227], v[48:51], v[76:79]
    v_mfma_f32_16x16x32_bf16 v[76:79], a[228:231], v[52:55], v[76:79]
    v_mfma_f32_16x16x32_bf16 v[76:79], a[232:235], v[56:59], v[76:79]
    v_mfma_f32_16x16x32_bf16 v[76:79], a[236:239], v[60:63], v[76:79]
    v_cvt_pk_bf16_f32 v84, v72, v73
    v_cvt_pk_bf16_f32 v85, v74, v75
    v_and_or_b32 v84, v84, -2, s32
    s_nop 4
    v_cvt_pk_bf16_f32 v86, v76, v77
    s_waitcnt lgkmcnt(0)
    buffer_store_dwordx4 v[88:91], v5, s[4:7], s34 offen offset:256
    v_cvt_pk_bf16_f32 v87, v78, v79
    ds_write_b128 v214, v[84:87] offset:1024
    ds_read_b128 v[92:95], v215 offset:1024
    s_waitcnt lgkmcnt(0)
    buffer_store_dwordx4 v[92:95], v5, s[4:7], s35 offen offset:256
    v_add_u32 v1, s31, v1
    v_add_u32 v2, s31, v2
    v_add_u32 v3, s31, v3
    s_sub_u32 s31, 0, s31
    s_add_u32 s34, s34, s26
    s_add_u32 s35, s35, s26
    s_cmp_eq_u32 s12, 0
    s_cselect_b32 s63, s97, 0
    s_waitcnt vmcnt(10)
    s_barrier
    ds_read_b128 v[16:19], v1 offset:0
    ds_read_b128 v[40:43], v2 offset:0
    ds_read_b128 v[64:67], v2 offset:3072
    ds_read_b128 v[20:23], v1 offset:1024
    ds_read_b128 v[44:47], v2 offset:1024
    ds_read_b128 v[68:71], v2 offset:4096
    ds_read_b128 v[24:27], v1 offset:2048
    ds_read_b128 v[48:51], v2 offset:2048
    ds_read_b128 v[72:75], v2 offset:5120
    ds_read_b128 v[28:31], v1 offset:3072
    ds_read_b128 v[52:55], v2 offset:12288
    ds_read_b128 v[76:79], v2 offset:15360
    ds_read_b128 v[32:35], v1 offset:4096
    ds_read_b128 v[56:59], v2 offset:13312
    ds_read_b128 v[80:83], v2 offset:16384
    ds_read_b128 v[36:39], v1 offset:5120
    ds_read_b128 v[60:63], v2 offset:14336
    ds_read_b128 v[84:87], v2 offset:17408
    s_waitcnt lgkmcnt(15)
    v_mfma_f32_16x16x32_bf16 v[152:155], v[40:43], v[16:19], 0
    v_mfma_f32_16x16x32_bf16 v[156:159], v[64:67], v[16:19], 0
    s_waitcnt lgkmcnt(12)
    v_mfma_f32_16x16x32_bf16 v[152:155], v[44:47], v[20:23], v[152:155]
    v_mfma_f32_16x16x32_bf16 v[156:159], v[68:71], v[20:23], v[156:159]
    s_waitcnt lgkmcnt(9)
    v_mfma_f32_16x16x32_bf16 v[152:155], v[48:51], v[24:27], v[152:155]
    v_mfma_f32_16x16x32_bf16 v[156:159], v[72:75], v[24:27], v[156:159]
    s_waitcnt lgkmcnt(6)
    v_mfma_f32_16x16x32_bf16 v[152:155], v[52:55], v[28:31], v[152:155]
    v_mfma_f32_16x16x32_bf16 v[156:159], v[76:79], v[28:31], v[156:159]
    s_waitcnt lgkmcnt(3)
    v_mfma_f32_16x16x32_bf16 v[152:155], v[56:59], v[32:35], v[152:155]
    v_mfma_f32_16x16x32_bf16 v[156:159], v[80:83], v[32:35], v[156:159]
    s_waitcnt lgkmcnt(0)
    v_mfma_f32_16x16x32_bf16 v[152:155], v[60:63], v[36:39], v[152:155]
    v_mfma_f32_16x16x32_bf16 v[156:159], v[84:87], v[36:39], v[156:159]
    ds_read_b128 v[112:115], v3 offset:0
    ds_read_b128 v[116:119], v3 offset:1024
    ds_read_b128 v[120:123], v3 offset:2048
    ds_read_b128 v[124:127], v3 offset:3072
    ds_read_b128 v[128:131], v3 offset:4096
    ds_read_b128 v[132:135], v3 offset:5120
    s_nop 0
    v_cvt_pk_bf16_f32 v162, v152, v153
    v_cvt_pk_bf16_f32 v163, v154, v155
    v_cvt_pk_bf16_f32 v164, v156, v157
    v_cvt_pk_bf16_f32 v165, v158, v159
    v_lshlrev_b32 v152, 16, v162
    v_and_b32 v153, 0xffff0000, v162
    v_lshlrev_b32 v154, 16, v163
    v_and_b32 v155, 0xffff0000, v163
    v_lshlrev_b32 v156, 16, v164
    v_and_b32 v157, 0xffff0000, v164
    v_lshlrev_b32 v158, 16, v165
    v_and_b32 v159, 0xffff0000, v165
    v_mul_f32 v152, s42, v152
    v_mul_f32 v153, s42, v153
    v_mul_f32 v154, s42, v154
    v_mul_f32 v155, s42, v155
    v_mul_f32 v156, s42, v156
    v_mul_f32 v157, s42, v157
    v_mul_f32 v158, s42, v158
    v_mul_f32 v159, s42, v159
    v_cvt_pk_bf16_f32 v162, v152, v153
    v_cvt_pk_bf16_f32 v163, v154, v155
    v_cvt_pk_bf16_f32 v164, v156, v157
    v_cvt_pk_bf16_f32 v165, v158, v159
    v_lshlrev_b32 v152, 16, v162
    v_and_b32 v153, 0xffff0000, v162
    v_lshlrev_b32 v154, 16, v163
    v_and_b32 v155, 0xffff0000, v163
    v_lshlrev_b32 v156, 16, v164
    v_and_b32 v157, 0xffff0000, v164
    v_lshlrev_b32 v158, 16, v165
    v_and_b32 v159, 0xffff0000, v165
    v_mov_b32 v160, 0xff800000
    v_cndmask_b32 v152, v160, v152, s[46:47]
    v_cndmask_b32 v153, v160, v153, s[48:49]
    v_cndmask_b32 v154, v160, v154, s[50:51]
    v_cndmask_b32 v155, v160, v155, s[52:53]
    v_cndmask_b32 v156, v160, v156, s[54:55]
    v_cndmask_b32 v157, v160, v157, s[56:57]
    v_cndmask_b32 v158, v160, v158, s[58:59]
    v_cndmask_b32 v159, v160, v159, s[60:61]
    s_waitcnt vmcnt(0)
    s_cmp_eq_u32 s97, 0
    s_cbranch_scc1 L_Of_wait_2
    s_add_u32 s27, s36, 0
    buffer_load_dwordx4 v[168:171], v6, s[4:7], s27 offen sc1
    s_add_u32 s27, s36, 5120
    buffer_load_dwordx4 v[172:175], v6, s[4:7], s27 offen sc1
    s_add_u32 s27, s36, 10240
    buffer_load_dwordx4 v[176:179], v6, s[4:7], s27 offen sc1
    s_add_u32 s27, s36, 15360
    buffer_load_dwordx4 v[180:183], v6, s[4:7], s27 offen sc1
    s_add_u32 s27, s36, 20480
    buffer_load_dwordx4 v[184:187], v6, s[4:7], s27 offen sc1
    s_add_u32 s27, s36, 25600
    buffer_load_dwordx4 v[188:191], v6, s[4:7], s27 offen sc1
    s_add_u32 s27, s36, 30720
    buffer_load_dwordx4 v[192:195], v6, s[4:7], s27 offen sc1
    s_add_u32 s27, s36, 35840
    buffer_load_dwordx4 v[196:199], v6, s[4:7], s27 offen sc1
    s_add_u32 s27, s36, 0
    buffer_load_dwordx4 v[200:203], v7, s[4:7], s27 offen sc1
    s_add_u32 s27, s36, 20480
    buffer_load_dwordx4 v[204:207], v7, s[4:7], s27 offen sc1
    s_lshl_b32 s37, s23, 5
    s_add_u32 s37, s37, s21
    s_lshl_b32 s37, s37, 2
    s_add_u32 s37, s37, s12
    s_mul_i32 s37, s37, 3072
    s_add_u32 s37, s37, 5898240
    s_mul_i32 s28, s12, 3072
    s_add_u32 m0, s28, 73728
    s_nop 0
    buffer_load_dwordx4 v0, s[4:7], s37 offen offset:0 sc1 lds
    buffer_load_dwordx4 v0, s[4:7], s37 offen offset:1024 sc1 lds
    buffer_load_dwordx4 v0, s[4:7], s37 offen offset:2048 sc1 lds
    s_mov_b32 s19, 0
L_Of_red_3:
    v_mfma_f32_16x16x32_bf16 v[216:219], a[240:243], v[220:223], 0
    v_mfma_f32_16x16x32_bf16 v[216:219], a[244:247], v[224:227], v[216:219]
    s_waitcnt vmcnt(12)
    v_mfma_f32_16x16x32_bf16 v[216:219], a[240:243], v[168:171], v[216:219]
    v_xor_b32 v14, s33, v168
    s_waitcnt vmcnt(11)
    v_mfma_f32_16x16x32_bf16 v[216:219], a[240:243], v[172:175], v[216:219]
    v_bitop3_b32 v14, v14, v172, s33 bitop3:0xf6
    s_waitcnt vmcnt(10)
    v_mfma_f32_16x16x32_bf16 v[216:219], a[240:243], v[176:179], v[216:219]
    v_bitop3_b32 v14, v14, v176, s33 bitop3:0xf6
    s_waitcnt vmcnt(9)
    v_mfma_f32_16x16x32_bf16 v[216:219], a[240:243], v[180:183], v[216:219]
    v_bitop3_b32 v14, v14, v180, s33 bitop3:0xf6
    s_waitcnt vmcnt(8)
    v_mfma_f32_16x16x32_bf16 v[216:219], a[240:243], v[184:187], v[216:219]
    v_bitop3_b32 v14, v14, v184, s33 bitop3:0xf6
    s_waitcnt vmcnt(7)
    v_mfma_f32_16x16x32_bf16 v[216:219], a[240:243], v[188:191], v[216:219]
    v_bitop3_b32 v14, v14, v188, s33 bitop3:0xf6
    s_waitcnt vmcnt(6)
    v_mfma_f32_16x16x32_bf16 v[216:219], a[240:243], v[192:195], v[216:219]
    v_bitop3_b32 v14, v14, v192, s33 bitop3:0xf6
    s_waitcnt vmcnt(5)
    v_mfma_f32_16x16x32_bf16 v[216:219], a[240:243], v[196:199], v[216:219]
    v_bitop3_b32 v14, v14, v196, s33 bitop3:0xf6
    s_waitcnt vmcnt(4)
    v_mfma_f32_16x16x32_bf16 v[216:219], a[244:247], v[200:203], v[216:219]
    v_bitop3_b32 v14, v14, v200, s33 bitop3:0xf6
    s_waitcnt vmcnt(3)
    v_mfma_f32_16x16x32_bf16 v[216:219], a[244:247], v[204:207], v[216:219]
    v_bitop3_b32 v14, v14, v204, s33 bitop3:0xf6
    v_and_b32 v14, 1, v14
    v_cmp_ne_u32 vcc, 0, v14
    s_nop 0
    s_cbranch_vccnz L_Of_redfix_4
    s_nop 2
    v_add_f32_dpp v216, v216, v216 row_ror:4 row_mask:0xc bank_mask:0xf
    v_add_f32_dpp v217, v217, v217 row_ror:4 row_mask:0xc bank_mask:0xf
    v_add_f32_dpp v218, v218, v218 row_ror:4 row_mask:0xc bank_mask:0xf
    v_add_f32_dpp v219, v219, v219 row_ror:4 row_mask:0xc bank_mask:0xf
    v_add_f32_dpp v216, v216, v216 row_ror:8 row_mask:0xc bank_mask:0xf
    v_add_f32_dpp v217, v217, v217 row_ror:8 row_mask:0xc bank_mask:0xf
    v_add_f32_dpp v218, v218, v218 row_ror:8 row_mask:0xc bank_mask:0xf
    v_add_f32_dpp v219, v219, v219 row_ror:8 row_mask:0xc bank_mask:0xf
    v_cvt_pk_bf16_f32 v202, v216, v217
    v_cvt_pk_bf16_f32 v203, v218, v219
    v_lshlrev_b32 v216, 16, v202
    v_and_b32 v217, 0xffff0000, v202
    v_lshlrev_b32 v218, 16, v203
    v_and_b32 v219, 0xffff0000, v203
    v_readfirstlane_b32 s86, v216
    s_nop 1
    v_pk_add_f32 v[176:177], v[216:217], s[86:87] op_sel_hi:[1,0] neg_lo:[0,1] neg_hi:[0,1]
    v_pk_add_f32 v[178:179], v[218:219], s[86:87] op_sel_hi:[1,0] neg_lo:[0,1] neg_hi:[0,1]
    v_pk_add_f32 v[170:171], v[176:177], v[178:179]
    v_pk_mul_f32 v[172:173], v[176:177], v[176:177]
    v_pk_fma_f32 v[172:173], v[178:179], v[178:179], v[172:173]
    v_add_f32 v168, v170, v171
    v_add_f32 v169, v172, v173
    v_cndmask_b32 v168, 0, v168, s[90:91]
    v_cndmask_b32 v169, 0, v169, s[90:91]
    s_nop 0
    v_add_f32_dpp v168, v168, v168 quad_perm:[1,0,3,2] row_mask:0xf bank_mask:0xf
    v_add_f32_dpp v169, v169, v169 quad_perm:[1,0,3,2] row_mask:0xf bank_mask:0xf
    s_nop 0
    v_add_f32_dpp v168, v168, v168 quad_perm:[2,3,0,1] row_mask:0xf bank_mask:0xf
    v_add_f32_dpp v169, v169, v169 quad_perm:[2,3,0,1] row_mask:0xf bank_mask:0xf
    s_nop 0
    v_add_f32_dpp v168, v168, v168 row_half_mirror row_mask:0xf bank_mask:0xf
    v_add_f32_dpp v169, v169, v169 row_half_mirror row_mask:0xf bank_mask:0xf
    s_nop 0
    v_add_f32_dpp v168, v168, v168 row_mirror row_mask:0xf bank_mask:0xf
    v_add_f32_dpp v169, v169, v169 row_mirror row_mask:0xf bank_mask:0xf
    v_mov_b32 v170, v168
    v_mov_b32 v171, v169
    s_nop 0
    v_permlane16_swap_b32 v168, v170
    v_permlane16_swap_b32 v169, v171
    v_add_f32 v168, v168, v170
    v_add_f32 v169, v169, v171
    v_mov_b32 v170, v168
    v_mov_b32 v171, v169
    s_nop 0
    v_permlane32_swap_b32 v168, v170
    v_permlane32_swap_b32 v169, v171
    v_add_f32 v168, v168, v170
    v_add_f32 v169, v169, v171
    v_mul_f32 v170, 6.2500000000e-03, v168
    v_fma_f32 v169, -v170, v168, v169
    v_add_f32 v168, s86, v170
    s_mov_b64 exec, 1
    ds_write_b64 v11, v[168:169] offset:0
    s_mov_b64 exec, -1
    s_waitcnt vmcnt(0) lgkmcnt(0)
    s_barrier
    ds_read_b128 v[180:183], v213 offset:0
    ds_read_b128 v[184:187], v213 offset:16
    s_waitcnt lgkmcnt(0)
    v_pk_add_f32 v[168:169], v[180:181], v[182:183]
    v_pk_add_f32 v[170:171], v[184:185], v[186:187]
    v_pk_add_f32 v[168:169], v[168:169], v[170:171]
    v_mul_f32 v168, 0.25, v168
    v_sub_f32 v180, v180, v168
    v_sub_f32 v182, v182, v168
    v_sub_f32 v184, v184, v168
    v_sub_f32 v186, v186, v168
    v_mul_f32 v170, v180, v180
    v_fmac_f32 v170, v182, v182
    v_fmac_f32 v170, v184, v184
    v_fmac_f32 v170, v186, v186
    v_mul_f32 v169, 1.5625000000e-03, v169
    v_fmac_f32 v169, 0.25, v170
    v_max_f32 v169, 0, v169
    v_cvt_pk_bf16_f32 v170, v169, v168
    v_lshlrev_b32 v169, 16, v170
    v_and_b32 v168, 0xffff0000, v170
    v_add_f32 v169, 0x3727c5ac, v169
    v_pk_add_f32 v[176:177], v[216:217], v[168:169] op_sel_hi:[1,0] neg_lo:[0,1] neg_hi:[0,1]
    v_cvt_pk_bf16_f32 v170, v169, v169
    v_pk_add_f32 v[178:179], v[218:219], v[168:169] op_sel_hi:[1,0] neg_lo:[0,1] neg_hi:[0,1]
    v_lshlrev_b32 v170, 16, v170
    v_sqrt_f32 v170, v170
    v_cvt_pk_bf16_f32 v200, v176, v177
    v_cvt_pk_bf16_f32 v201, v178, v179
    v_cvt_pk_bf16_f32 v170, v170, v170
    v_lshlrev_b32 v170, 16, v170
    v_rcp_f32 v170, v170
    v_lshlrev_b32 v176, 16, v200
    v_and_b32 v177, 0xffff0000, v200
    v_lshlrev_b32 v178, 16, v201
    v_and_b32 v179, 0xffff0000, v201
    v_pk_mul_f32 v[176:177], v[176:177], v[170:171] op_sel_hi:[1,0]
    v_pk_mul_f32 v[178:179], v[178:179], v[170:171] op_sel_hi:[1,0]
    v_cvt_pk_bf16_f32 v200, v176, v177
    v_cvt_pk_bf16_f32 v201, v178, v179
    s_nop 0
    v_permlane16_swap_b32 v200, v202
    v_permlane16_swap_b32 v201, v203
    s_mov_b32 exec_lo, 4294967295
    s_mov_b32 exec_hi, 983055
    buffer_store_dwordx4 v[200:203], v8, s[4:7], s41 offen offset:0 sc1
    s_mov_b64 exec, -1
    s_add_u32 s36, s36, s26
    s_sub_u32 s26, 0, s26
    s_add_u32 s22, s22, 1
    s_add_u32 s39, s39, 40960
    s_add_u32 s41, s41, 40960
    s_add_u32 s23, s23, 1
    s_sub_u32 s30, 36864, s30
    s_branch L_Of_top
L_Of_wait_2:
    s_add_u32 s27, s36, 0
    buffer_load_dwordx4 v[168:171], v6, s[4:7], s27 offen sc1
    s_add_u32 s27, s36, 5120
    buffer_load_dwordx4 v[172:175], v6, s[4:7], s27 offen sc1
    s_add_u32 s27, s36, 10240
    buffer_load_dwordx4 v[176:179], v6, s[4:7], s27 offen sc1
    s_add_u32 s27, s36, 15360
    buffer_load_dwordx4 v[180:183], v6, s[4:7], s27 offen sc1
    s_add_u32 s27, s36, 20480
    buffer_load_dwordx4 v[184:187], v6, s[4:7], s27 offen sc1
    s_add_u32 s27, s36, 25600
    buffer_load_dwordx4 v[188:191], v6, s[4:7], s27 offen sc1
    s_add_u32 s27, s36, 30720
    buffer_load_dwordx4 v[192:195], v6, s[4:7], s27 offen sc1
    s_add_u32 s27, s36, 35840
    buffer_load_dwordx4 v[196:199], v6, s[4:7], s27 offen sc1
    s_add_u32 s27, s36, 0
    buffer_load_dwordx4 v[200:203], v7, s[4:7], s27 offen sc1
    s_add_u32 s27, s36, 20480
    buffer_load_dwordx4 v[204:207], v7, s[4:7], s27 offen sc1
    s_mov_b32 s19, 0
L_Of_red_5:
    v_mfma_f32_16x16x32_bf16 v[216:219], a[240:243], v[220:223], 0
    v_mfma_f32_16x16x32_bf16 v[216:219], a[244:247], v[224:227], v[216:219]
    s_waitcnt vmcnt(9)
    v_mfma_f32_16x16x32_bf16 v[216:219], a[240:243], v[168:171], v[216:219]
    v_xor_b32 v14, s33, v168
    s_waitcnt vmcnt(8)
    v_mfma_f32_16x16x32_bf16 v[216:219], a[240:243], v[172:175], v[216:219]
    v_bitop3_b32 v14, v14, v172, s33 bitop3:0xf6
    s_waitcnt vmcnt(7)
    v_mfma_f32_16x16x32_bf16 v[216:219], a[240:243], v[176:179], v[216:219]
    v_bitop3_b32 v14, v14, v176, s33 bitop3:0xf6
    s_waitcnt vmcnt(6)
    v_mfma_f32_16x16x32_bf16 v[216:219], a[240:243], v[180:183], v[216:219]
    v_bitop3_b32 v14, v14, v180, s33 bitop3:0xf6
    s_waitcnt vmcnt(5)
    v_mfma_f32_16x16x32_bf16 v[216:219], a[240:243], v[184:187], v[216:219]
    v_bitop3_b32 v14, v14, v184, s33 bitop3:0xf6
    s_waitcnt vmcnt(4)
    v_mfma_f32_16x16x32_bf16 v[216:219], a[240:243], v[188:191], v[216:219]
    v_bitop3_b32 v14, v14, v188, s33 bitop3:0xf6
    s_waitcnt vmcnt(3)
    v_mfma_f32_16x16x32_bf16 v[216:219], a[240:243], v[192:195], v[216:219]
    v_bitop3_b32 v14, v14, v192, s33 bitop3:0xf6
    s_waitcnt vmcnt(2)
    v_mfma_f32_16x16x32_bf16 v[216:219], a[240:243], v[196:199], v[216:219]
    v_bitop3_b32 v14, v14, v196, s33 bitop3:0xf6
    s_waitcnt vmcnt(1)
    v_mfma_f32_16x16x32_bf16 v[216:219], a[244:247], v[200:203], v[216:219]
    v_bitop3_b32 v14, v14, v200, s33 bitop3:0xf6
    s_waitcnt vmcnt(0)
    v_mfma_f32_16x16x32_bf16 v[216:219], a[244:247], v[204:207], v[216:219]
    v_bitop3_b32 v14, v14, v204, s33 bitop3:0xf6
    v_and_b32 v14, 1, v14
    v_cmp_ne_u32 vcc, 0, v14
    s_nop 0
    s_cbranch_vccnz L_Of_redfix_6
    s_nop 2
    v_add_f32_dpp v216, v216, v216 row_ror:4 row_mask:0xc bank_mask:0xf
    v_add_f32_dpp v217, v217, v217 row_ror:4 row_mask:0xc bank_mask:0xf
    v_add_f32_dpp v218, v218, v218 row_ror:4 row_mask:0xc bank_mask:0xf
    v_add_f32_dpp v219, v219, v219 row_ror:4 row_mask:0xc bank_mask:0xf
    v_add_f32_dpp v216, v216, v216 row_ror:8 row_mask:0xc bank_mask:0xf
    v_add_f32_dpp v217, v217, v217 row_ror:8 row_mask:0xc bank_mask:0xf
    v_add_f32_dpp v218, v218, v218 row_ror:8 row_mask:0xc bank_mask:0xf
    v_add_f32_dpp v219, v219, v219 row_ror:8 row_mask:0xc bank_mask:0xf
    buffer_load_dword v12, v10, s[4:7], s25 offen sc1
    v_cvt_pk_bf16_f32 v202, v216, v217
    v_cvt_pk_bf16_f32 v203, v218, v219
    v_lshlrev_b32 v216, 16, v202
    v_and_b32 v217, 0xffff0000, v202
    v_lshlrev_b32 v218, 16, v203
    v_and_b32 v219, 0xffff0000, v203
    v_readfirstlane_b32 s86, v216
    s_nop 1
    v_pk_add_f32 v[176:177], v[216:217], s[86:87] op_sel_hi:[1,0] neg_lo:[0,1] neg_hi:[0,1]
    v_pk_add_f32 v[178:179], v[218:219], s[86:87] op_sel_hi:[1,0] neg_lo:[0,1] neg_hi:[0,1]
    v_pk_add_f32 v[170:171], v[176:177], v[178:179]
    v_pk_mul_f32 v[172:173], v[176:177], v[176:177]
    v_pk_fma_f32 v[172:173], v[178:179], v[178:179], v[172:173]
    v_add_f32 v168, v170, v171
    v_add_f32 v169, v172, v173
    v_cndmask_b32 v168, 0, v168, s[90:91]
    v_cndmask_b32 v169, 0, v169, s[90:91]
    s_nop 0
    v_add_f32_dpp v168, v168, v168 quad_perm:[1,0,3,2] row_mask:0xf bank_mask:0xf
    v_add_f32_dpp v169, v169, v169 quad_perm:[1,0,3,2] row_mask:0xf bank_mask:0xf
    s_nop 0
    v_add_f32_dpp v168, v168, v168 quad_perm:[2,3,0,1] row_mask:0xf bank_mask:0xf
    v_add_f32_dpp v169, v169, v169 quad_perm:[2,3,0,1] row_mask:0xf bank_mask:0xf
    s_nop 0
    v_add_f32_dpp v168, v168, v168 row_half_mirror row_mask:0xf bank_mask:0xf
    v_add_f32_dpp v169, v169, v169 row_half_mirror row_mask:0xf bank_mask:0xf
    s_nop 0
    v_add_f32_dpp v168, v168, v168 row_mirror row_mask:0xf bank_mask:0xf
    v_add_f32_dpp v169, v169, v169 row_mirror row_mask:0xf bank_mask:0xf
    v_mov_b32 v170, v168
    v_mov_b32 v171, v169
    s_nop 0
    v_permlane16_swap_b32 v168, v170
    v_permlane16_swap_b32 v169, v171
    v_add_f32 v168, v168, v170
    v_add_f32 v169, v169, v171
    v_mov_b32 v170, v168
    v_mov_b32 v171, v169
    s_nop 0
    v_permlane32_swap_b32 v168, v170
    v_permlane32_swap_b32 v169, v171
    v_add_f32 v168, v168, v170
    v_add_f32 v169, v169, v171
    v_mul_f32 v170, 6.2500000000e-03, v168
    v_fma_f32 v169, -v170, v168, v169
    v_add_f32 v168, s86, v170
    s_mov_b64 exec, 1
    ds_write_b64 v11, v[168:169] offset:0
    s_mov_b64 exec, -1
    s_waitcnt lgkmcnt(0)
    s_barrier
    ds_read_b128 v[180:183], v213 offset:0
    ds_read_b128 v[184:187], v213 offset:16
    s_waitcnt lgkmcnt(0)
    v_pk_add_f32 v[168:169], v[180:181], v[182:183]
    v_pk_add_f32 v[170:171], v[184:185], v[186:187]
    v_pk_add_f32 v[168:169], v[168:169], v[170:171]
    v_mul_f32 v168, 0.25, v168
    v_sub_f32 v180, v180, v168
    v_sub_f32 v182, v182, v168
    v_sub_f32 v184, v184, v168
    v_sub_f32 v186, v186, v168
    v_mul_f32 v170, v180, v180
    v_fmac_f32 v170, v182, v182
    v_fmac_f32 v170, v184, v184
    v_fmac_f32 v170, v186, v186
    v_mul_f32 v169, 1.5625000000e-03, v169
    v_fmac_f32 v169, 0.25, v170
    v_max_f32 v169, 0, v169
    v_cvt_pk_bf16_f32 v170, v169, v168
    v_lshlrev_b32 v169, 16, v170
    v_and_b32 v168, 0xffff0000, v170
    v_add_f32 v169, 0x3727c5ac, v169
    v_pk_add_f32 v[176:177], v[216:217], v[168:169] op_sel_hi:[1,0] neg_lo:[0,1] neg_hi:[0,1]
    v_cvt_pk_bf16_f32 v170, v169, v169
    v_pk_add_f32 v[178:179], v[218:219], v[168:169] op_sel_hi:[1,0] neg_lo:[0,1] neg_hi:[0,1]
    v_lshlrev_b32 v170, 16, v170
    v_sqrt_f32 v170, v170
    v_cvt_pk_bf16_f32 v200, v176, v177
    v_cvt_pk_bf16_f32 v201, v178, v179
    v_cvt_pk_bf16_f32 v170, v170, v170
    v_lshlrev_b32 v170, 16, v170
    v_rcp_f32 v170, v170
    v_lshlrev_b32 v176, 16, v200
    v_and_b32 v177, 0xffff0000, v200
    v_lshlrev_b32 v178, 16, v201
    v_and_b32 v179, 0xffff0000, v201
    v_pk_mul_f32 v[176:177], v[176:177], v[170:171] op_sel_hi:[1,0]
    v_pk_mul_f32 v[178:179], v[178:179], v[170:171] op_sel_hi:[1,0]
    v_cvt_pk_bf16_f32 v200, v176, v177
    v_cvt_pk_bf16_f32 v201, v178, v179
    s_nop 0
    v_permlane16_swap_b32 v200, v202
    v_permlane16_swap_b32 v201, v203
    s_mov_b32 exec_lo, 4294967295
    s_mov_b32 exec_hi, 983055
    buffer_store_dwordx4 v[200:203], v8, s[4:7], s41 offen offset:0 sc1
    s_mov_b64 exec, -1
    s_add_u32 s36, s36, s26
    s_sub_u32 s26, 0, s26
    s_add_u32 s22, s22, 1
    s_add_u32 s39, s39, 40960
    s_add_u32 s41, s41, 40960
    s_waitcnt vmcnt(1)
    s_mov_b32 s97, 0
    v_cmp_gt_u32 vcc, s29, v12
    s_nop 0
    s_cbranch_vccnz L_Of_notyet_7
    s_mov_b32 s97, 1
    s_lshl_b32 s37, s23, 5
    s_add_u32 s37, s37, s21
    s_lshl_b32 s37, s37, 2
    s_add_u32 s37, s37, s12
    s_mul_i32 s37, s37, 3072
    s_add_u32 s37, s37, 5898240
    s_mul_i32 s28, s12, 3072
    s_add_u32 m0, s28, 73728
    s_nop 0
    buffer_load_dwordx4 v0, s[4:7], s37 offen offset:0 sc1 lds
    buffer_load_dwordx4 v0, s[4:7], s37 offen offset:1024 sc1 lds
    buffer_load_dwordx4 v0, s[4:7], s37 offen offset:2048 sc1 lds
    s_waitcnt vmcnt(0)
    s_branch L_Of_notyet_7b
L_Of_notyet_7:
    buffer_load_dword v12, v10, s[4:7], s25 offen sc1
    s_waitcnt vmcnt(0)
L_Of_notyet_7b:
    s_barrier
    s_cmp_lg_u32 s12, 0
    s_cbranch_scc1 L_Of_nofl_8
    v_mov_b32 v13, s22
    s_mov_b64 exec, 1
    buffer_store_dword v13, v0, s[4:7], s24 offen offset:0 sc1
    s_mov_b64 exec, -1
L_Of_nofl_8:
    s_cmp_eq_u32 s22, 64
    s_cbranch_scc1 L_Of_top_end
    s_cmp_lg_u32 s97, 0
    s_cbranch_scc1 L_Of_have_9
    s_mov_b32 s19, 0
    v_cmp_gt_u32 vcc, s29, v12
    s_nop 0
    s_cbranch_vccnz L_Of_flspin_11
L_Of_fl_10:
    s_lshl_b32 s37, s23, 5
    s_add_u32 s37, s37, s21
    s_lshl_b32 s37, s37, 2
    s_add_u32 s37, s37, s12
    s_mul_i32 s37, s37, 3072
    s_add_u32 s37, s37, 5898240
    s_mul_i32 s28, s12, 3072
    s_add_u32 m0, s28, 73728
    s_nop 0
    buffer_load_dwordx4 v0, s[4:7], s37 offen offset:0 sc1 lds
    buffer_load_dwordx4 v0, s[4:7], s37 offen offset:1024 sc1 lds
    buffer_load_dwordx4 v0, s[4:7], s37 offen offset:2048 sc1 lds
    s_waitcnt vmcnt(0)
L_Of_have_9:
    s_waitcnt lgkmcnt(0)
    s_barrier
    s_add_u32 s23, s23, 1
    s_sub_u32 s30, 36864, s30
    s_branch L_Of_top
L_Of_top_end:
    s_waitcnt vmcnt(0)
    s_endpgm
L_Of_redfix_4:
    s_add_u32 s27, s36, 0
    buffer_load_dwordx4 v[168:171], v6, s[4:7], s27 offen sc1
    s_add_u32 s27, s36, 5120
    buffer_load_dwordx4 v[172:175], v6, s[4:7], s27 offen sc1
    s_add_u32 s27, s36, 10240
    buffer_load_dwordx4 v[176:179], v6, s[4:7], s27 offen sc1
    s_add_u32 s27, s36, 15360
    buffer_load_dwordx4 v[180:183], v6, s[4:7], s27 offen sc1
    s_add_u32 s27, s36, 20480
    buffer_load_dwordx4 v[184:187], v6, s[4:7], s27 offen sc1
    s_add_u32 s27, s36, 25600
    buffer_load_dwordx4 v[188:191], v6, s[4:7], s27 offen sc1
    s_add_u32 s27, s36, 30720
    buffer_load_dwordx4 v[192:195], v6, s[4:7], s27 offen sc1
    s_add_u32 s27, s36, 35840
    buffer_load_dwordx4 v[196:199], v6, s[4:7], s27 offen sc1
    s_add_u32 s27, s36, 0
    buffer_load_dwordx4 v[200:203], v7, s[4:7], s27 offen sc1
    s_add_u32 s27, s36, 20480
    buffer_load_dwordx4 v[204:207], v7, s[4:7], s27 offen sc1
    s_waitcnt vmcnt(0)
    s_add_u32 s19, s19, 1
    s_cmp_lt_u32 s19, 524288
    s_cbranch_scc1 L_Of_red_3
    s_branch L_fail
L_Of_redfix_6:
    s_add_u32 s27, s36, 0
    buffer_load_dwordx4 v[168:171], v6, s[4:7], s27 offen sc1
    s_add_u32 s27, s36, 5120
    buffer_load_dwordx4 v[172:175], v6, s[4:7], s27 offen sc1
    s_add_u32 s27, s36, 10240
    buffer_load_dwordx4 v[176:179], v6, s[4:7], s27 offen sc1
    s_add_u32 s27, s36, 15360
    buffer_load_dwordx4 v[180:183], v6, s[4:7], s27 offen sc1
    s_add_u32 s27, s36, 20480
    buffer_load_dwordx4 v[184:187], v6, s[4:7], s27 offen sc1
    s_add_u32 s27, s36, 25600
    buffer_load_dwordx4 v[188:191], v6, s[4:7], s27 offen sc1
    s_add_u32 s27, s36, 30720
    buffer_load_dwordx4 v[192:195], v6, s[4:7], s27 offen sc1
    s_add_u32 s27, s36, 35840
    buffer_load_dwordx4 v[196:199], v6, s[4:7], s27 offen sc1
    s_add_u32 s27, s36, 0
    buffer_load_dwordx4 v[200:203], v7, s[4:7], s27 offen sc1
    s_add_u32 s27, s36, 20480
    buffer_load_dwordx4 v[204:207], v7, s[4:7], s27 offen sc1
    s_add_u32 s19, s19, 1
    s_cmp_lt_u32 s19, 524288
    s_cbranch_scc1 L_Of_red_5
    s_branch L_fail
L_Of_flspin_11:
    buffer_load_dword v12, v10, s[4:7], s25 offen sc1
    s_add_u32 s19, s19, 1
    s_cmp_ge_u32 s19, 524288
    s_cbranch_scc1 L_fail
    s_waitcnt vmcnt(0)
    v_cmp_gt_u32 vcc, s29, v12
    s_nop 0
    s_cbranch_vccnz L_Of_flspin_11
    s_branch L_Of_fl_10
L_O_slow:
L_Os_top:
    ds_read_b128 v[88:91], v4 offset:0
    ds_read_b128 v[92:95], v4 offset:1024
    ds_read_b128 v[96:99], v4 offset:2048
    ds_read_b128 v[100:103], v4 offset:6144
    ds_read_b128 v[104:107], v4 offset:7168
    ds_read_b128 v[108:111], v4 offset:8192
    ds_read_b128 v[136:139], v15 offset:3072
    ds_read_b128 v[140:143], v15 offset:4096
    ds_read_b128 v[144:147], v15 offset:5120
    buffer_load_dword v12, v10, s[4:7], s25 offen sc1
    buffer_load_dwordx4 v[220:223], v210, s[4:7], s39 offen sc1
    buffer_load_dwordx4 v[224:227], v209, s[4:7], s39 offen sc1
    s_add_u32 s98, s22, 1
    s_min_u32 s98, s98, 63
    s_lshl_b32 s96, s20, 6
    s_add_u32 s98, s98, s96
    s_lshl_b32 s98, s98, 5
    s_add_u32 s98, s98, s21
    s_lshl_b32 s98, s98, 2
    s_add_u32 s98, s98, s12
    s_mul_i32 s96, s98, 3072
    s_add_u32 s96, s96, 138018816
    s_mul_i32 s98, s98, 6144
    s_add_u32 s98, s98, 37355520
    s_mul_i32 s62, s12, 3072
    v_mov_b32 v14, 0xff800000
    s_lshr_b32 s27, s22, 1
    s_andn2_b32 s32, 1, s27
    s_sub_u32 s33, 0, s32
    s_add_u32 s29, s23, 1
    s_cmp_eq_u32 s22, 63
    s_cselect_b32 s29, -1, s29
    s_waitcnt lgkmcnt(8)
    v_mfma_f32_16x16x32_bf16 v[148:151], v[88:91], v[16:19], 0
    s_waitcnt lgkmcnt(7)
    v_mfma_f32_16x16x32_bf16 v[148:151], v[92:95], v[20:23], v[148:151]
    s_waitcnt lgkmcnt(6)
    v_mfma_f32_16x16x32_bf16 v[148:151], v[96:99], v[24:27], v[148:151]
    s_waitcnt lgkmcnt(5)
    v_mfma_f32_16x16x32_bf16 v[148:151], v[100:103], v[28:31], v[148:151]
    s_waitcnt lgkmcnt(4)
    s_add_u32 m0, s62, s30
    v_mfma_f32_16x16x32_bf16 v[148:151], v[104:107], v[32:35], v[148:151]
    s_waitcnt lgkmcnt(3)
    v_mfma_f32_16x16x32_bf16 v[148:151], v[108:111], v[36:39], v[148:151]
    v_max3_f32 v161, v152, v153, v154
    v_max3_f32 v161, v161, v155, v156
    v_max3_f32 v161, v161, v157, v158
    v_max_f32 v161, v161, v159
    s_nop 3
    v_cvt_pk_bf16_f32 v162, v148, v149
    v_cvt_pk_bf16_f32 v163, v150, v151
    buffer_load_dwordx4 v0, s[4:7], s96 offen offset:0 sc1 nt lds
    v_lshlrev_b32 v148, 16, v162
    v_and_b32 v149, 0xffff0000, v162
    v_lshlrev_b32 v150, 16, v163
    v_and_b32 v151, 0xffff0000, v163
    v_mul_f32 v148, s42, v148
    v_mul_f32 v149, s42, v149
    v_mul_f32 v150, s42, v150
    v_mul_f32 v151, s42, v151
    v_cvt_pk_bf16_f32 v162, v148, v149
    buffer_load_dwordx4 v0, s[4:7], s96 offen offset:1024 sc1 nt lds
    v_cvt_pk_bf16_f32 v163, v150, v151
    v_lshlrev_b32 v148, 16, v162
    v_and_b32 v149, 0xffff0000, v162
    v_lshlrev_b32 v150, 16, v163
    v_and_b32 v151, 0xffff0000, v163
    v_cndmask_b32 v148, v14, v148, s[44:45]
    v_cndmask_b32 v149, v14, v149, s[44:45]
    v_cndmask_b32 v150, v14, v150, s[44:45]
    v_cndmask_b32 v151, v14, v151, s[44:45]
    buffer_load_dwordx4 v0, s[4:7], s96 offen offset:2048 sc1 nt lds
    v_max3_f32 v160, v148, v149, v161
    v_max3_f32 v160, v150, v151, v160
    v_mov_b32 v161, v160
    s_nop 1
    v_permlane32_swap_b32 v160, v161
    v_max_f32 v160, v160, v161
    v_mov_b32 v161, v160
    s_nop 1
    v_permlane16_swap_b32 v160, v161
    v_max_f32 v160, v160, v161
    v_mul_f32 v160, s43, v160
    s_lshl_b32 s62, s62, 1
    s_add_u32 s62, s62, s30
    s_add_u32 m0, s62, 12288
    v_fma_f32 v148, v148, s43, -v160
    v_fma_f32 v149, v149, s43, -v160
    v_fma_f32 v150, v150, s43, -v160
    v_fma_f32 v151, v151, s43, -v160
    v_fma_f32 v152, v152, s43, -v160
    v_fma_f32 v153, v153, s43, -v160
    v_fma_f32 v154, v154, s43, -v160
    v_fma_f32 v155, v155, s43, -v160
    v_fma_f32 v156, v156, s43, -v160
    buffer_load_dwordx4 v0, s[4:7], s98 offen offset:0 sc1 nt lds
    v_fma_f32 v157, v157, s43, -v160
    v_fma_f32 v158, v158, s43, -v160
    v_fma_f32 v159, v159, s43, -v160
    v_exp_f32 v148, v148
    v_exp_f32 v149, v149
    v_exp_f32 v150, v150
    v_exp_f32 v151, v151
    v_exp_f32 v152, v152
    v_exp_f32 v153, v153
    buffer_load_dwordx4 v0, s[4:7], s98 offen offset:1024 sc1 nt lds
    v_exp_f32 v154, v154
    v_exp_f32 v155, v155
    v_exp_f32 v156, v156
    v_exp_f32 v157, v157
    v_exp_f32 v158, v158
    v_exp_f32 v159, v159
    v_pk_add_f32 v[160:161], v[148:149], v[150:151]
    v_pk_add_f32 v[160:161], v[160:161], v[152:153]
    v_pk_add_f32 v[160:161], v[160:161], v[154:155]
    buffer_load_dwordx4 v0, s[4:7], s98 offen offset:2048 sc1 nt lds
    v_pk_add_f32 v[160:161], v[160:161], v[156:157]
    v_pk_add_f32 v[160:161], v[160:161], v[158:159]
    v_add_f32 v160, v160, v161
    v_mov_b32 v161, v160
    s_nop 1
    v_permlane32_swap_b32 v160, v161
    v_add_f32 v160, v160, v161
    v_mov_b32 v161, v160
    s_nop 1
    v_permlane16_swap_b32 v160, v161
    v_add_f32 v160, v160, v161
    s_add_u32 s98, s98, 3072
    s_add_u32 m0, s62, 15360
    v_rcp_f32 v160, v160
    s_nop 0
    v_pk_mul_f32 v[148:149], v[148:149], v[160:161] op_sel_hi:[1,0]
    v_pk_mul_f32 v[150:151], v[150:151], v[160:161] op_sel_hi:[1,0]
    v_pk_mul_f32 v[152:153], v[152:153], v[160:161] op_sel_hi:[1,0]
    v_pk_mul_f32 v[154:155], v[154:155], v[160:161] op_sel_hi:[1,0]
    v_pk_mul_f32 v[156:157], v[156:157], v[160:161] op_sel_hi:[1,0]
    v_pk_mul_f32 v[158:159], v[158:159], v[160:161] op_sel_hi:[1,0]
    v_cvt_pk_bf16_f32 v164, v148, v149
    v_cvt_pk_bf16_f32 v165, v150, v151
    buffer_load_dwordx4 v0, s[4:7], s98 offen offset:0 sc1 nt lds
    v_cvt_pk_bf16_f32 v166, v152, v153
    v_cvt_pk_bf16_f32 v167, v154, v155
    v_cvt_pk_bf16_f32 v168, v156, v157
    v_cvt_pk_bf16_f32 v169, v158, v159
    buffer_load_dwordx4 v0, s[4:7], s98 offen offset:1024 sc1 nt lds
    buffer_load_dwordx4 v0, s[4:7], s98 offen offset:2048 sc1 nt lds
    s_waitcnt lgkmcnt(0)
    v_mfma_f32_16x16x16_bf16 v[170:173], v[136:137], v[164:165], 0
    v_mfma_f32_16x16x16_bf16 v[174:177], v[138:139], v[164:165], 0
    v_mfma_f32_16x16x16_bf16 v[178:181], v[140:141], v[164:165], 0
    v_mfma_f32_16x16x16_bf16 v[182:185], v[142:143], v[164:165], 0
    v_mfma_f32_16x16x16_bf16 v[186:189], v[144:145], v[164:165], 0
    v_mfma_f32_16x16x16_bf16 v[190:193], v[146:147], v[164:165], 0
    s_nop 0
    v_mfma_f32_16x16x32_bf16 v[170:173], v[112:115], v[166:169], v[170:173]
    v_mfma_f32_16x16x32_bf16 v[174:177], v[116:119], v[166:169], v[174:177]
    v_mfma_f32_16x16x32_bf16 v[178:181], v[120:123], v[166:169], v[178:181]
    v_mfma_f32_16x16x32_bf16 v[182:185], v[124:127], v[166:169], v[182:185]
    v_mfma_f32_16x16x32_bf16 v[186:189], v[128:131], v[166:169], v[186:189]
    v_mfma_f32_16x16x32_bf16 v[190:193], v[132:135], v[166:169], v[190:193]
    s_waitcnt vmcnt(11)
    v_cmp_gt_u32 vcc, s29, v12
    s_cmp_eq_u64 vcc, 0
    s_cselect_b32 s3, 1, 0
    v_mov_b32 v13, s3
    s_cmp_eq_u32 s12, 0
    s_cselect_b64 exec, 1, 0
    ds_write_b32 v213, v13 offset:64
    s_mov_b64 exec, -1
    v_cvt_pk_bf16_f32 v194, v170, v171
    v_cvt_pk_bf16_f32 v195, v172, v173
    v_cvt_pk_bf16_f32 v196, v174, v175
    v_cvt_pk_bf16_f32 v197, v176, v177
    ds_write_b128 v212, v[194:197] offset:12288
    v_cvt_pk_bf16_f32 v198, v178, v179
    v_cvt_pk_bf16_f32 v199, v180, v181
    v_cvt_pk_bf16_f32 v200, v182, v183
    v_cvt_pk_bf16_f32 v201, v184, v185
    ds_write_b128 v212, v[198:201] offset:13312
    v_cvt_pk_bf16_f32 v202, v186, v187
    v_cvt_pk_bf16_f32 v203, v188, v189
    v_cvt_pk_bf16_f32 v204, v190, v191
    v_cvt_pk_bf16_f32 v205, v192, v193
    ds_write_b128 v212, v[202:205] offset:14336
    s_waitcnt lgkmcnt(0)
    s_barrier
    ds_read_b32 v12, v213 offset:64
    ds_read_b128 v[16:19], v4 offset:12288
    ds_read_b128 v[20:23], v4 offset:13312
    ds_read_b128 v[24:27], v4 offset:14336
    ds_read_b128 v[28:31], v4 offset:15360
    ds_read_b128 v[32:35], v4 offset:16384
    ds_read_b128 v[36:39], v4 offset:17408
    ds_read_b128 v[40:43], v4 offset:18432
    ds_read_b128 v[44:47], v4 offset:19456
    ds_read_b128 v[48:51], v4 offset:20480
    ds_read_b128 v[52:55], v4 offset:21504
    ds_read_b128 v[56:59], v4 offset:22528
    ds_read_b128 v[60:63], v4 offset:23552
    s_cmp_eq_u32 s63, 0
    s_cbranch_scc1 L_Os_nopend_1
    v_mov_b32 v13, s22
    s_mov_b64 exec, 1
    buffer_store_dword v13, v0, s[4:7], s24 offen offset:0 sc1
    s_mov_b64 exec, -1
L_Os_nopend_1:
    s_waitcnt lgkmcnt(12)
    v_readfirstlane_b32 s97, v12
    s_waitcnt lgkmcnt(11)
    v_mfma_f32_16x16x32_bf16 v[64:67], a[0:3], v[16:19], 0
    s_waitcnt lgkmcnt(10)
    v_mfma_f32_16x16x32_bf16 v[64:67], a[4:7], v[20:23], v[64:67]
    s_waitcnt lgkmcnt(9)
    v_mfma_f32_16x16x32_bf16 v[64:67], a[8:11], v[24:27], v[64:67]
    s_waitcnt lgkmcnt(8)
    v_mfma_f32_16x16x32_bf16 v[64:67], a[12:15], v[28:31], v[64:67]
    s_waitcnt lgkmcnt(7)
    v_mfma_f32_16x16x32_bf16 v[64:67], a[16:19], v[32:35], v[64:67]
    s_waitcnt lgkmcnt(6)
    v_mfma_f32_16x16x32_bf16 v[64:67], a[20:23], v[36:39], v[64:67]
    v_mfma_f32_16x16x32_bf16 v[68:71], a[24:27], v[16:19], 0
    v_mfma_f32_16x16x32_bf16 v[68:71], a[28:31], v[20:23], v[68:71]
    v_mfma_f32_16x16x32_bf16 v[68:71], a[32:35], v[24:27], v[68:71]
    v_mfma_f32_16x16x32_bf16 v[68:71], a[36:39], v[28:31], v[68:71]
    v_mfma_f32_16x16x32_bf16 v[68:71], a[40:43], v[32:35], v[68:71]
    v_mfma_f32_16x16x32_bf16 v[68:71], a[44:47], v[36:39], v[68:71]
    s_waitcnt lgkmcnt(5)
    v_mfma_f32_16x16x32_bf16 v[72:75], a[0:3], v[40:43], 0
    s_waitcnt lgkmcnt(4)
    v_mfma_f32_16x16x32_bf16 v[72:75], a[4:7], v[44:47], v[72:75]
    s_waitcnt lgkmcnt(3)
    v_mfma_f32_16x16x32_bf16 v[72:75], a[8:11], v[48:51], v[72:75]
    v_cvt_pk_bf16_f32 v80, v64, v65
    s_waitcnt lgkmcnt(2)
    v_mfma_f32_16x16x32_bf16 v[72:75], a[12:15], v[52:55], v[72:75]
    v_cvt_pk_bf16_f32 v81, v66, v67
    v_and_or_b32 v80, v80, -2, s32
    s_waitcnt lgkmcnt(1)
    v_mfma_f32_16x16x32_bf16 v[72:75], a[16:19], v[56:59], v[72:75]
    v_cvt_pk_bf16_f32 v82, v68, v69
    s_waitcnt lgkmcnt(0)
    v_mfma_f32_16x16x32_bf16 v[72:75], a[20:23], v[60:63], v[72:75]
    v_cvt_pk_bf16_f32 v83, v70, v71
    v_mfma_f32_16x16x32_bf16 v[76:79], a[24:27], v[40:43], 0
    ds_write_b128 v214, v[80:83] offset:0
    v_mfma_f32_16x16x32_bf16 v[76:79], a[28:31], v[44:47], v[76:79]
    ds_read_b128 v[88:91], v215 offset:0
    v_mfma_f32_16x16x32_bf16 v[76:79], a[32:35], v[48:51], v[76:79]
    v_mfma_f32_16x16x32_bf16 v[76:79], a[36:39], v[52:55], v[76:79]
    v_mfma_f32_16x16x32_bf16 v[76:79], a[40:43], v[56:59], v[76:79]
    v_mfma_f32_16x16x32_bf16 v[76:79], a[44:47], v[60:63], v[76:79]
    v_mfma_f32_16x16x32_bf16 v[64:67], a[48:51], v[16:19], 0
    v_mfma_f32_16x16x32_bf16 v[64:67], a[52:55], v[20:23], v[64:67]
    v_mfma_f32_16x16x32_bf16 v[64:67], a[56:59], v[24:27], v[64:67]
    v_cvt_pk_bf16_f32 v84, v72, v73
    v_mfma_f32_16x16x32_bf16 v[64:67], a[60:63], v[28:31], v[64:67]
    v_cvt_pk_bf16_f32 v85, v74, v75
    v_and_or_b32 v84, v84, -2, s32
    v_mfma_f32_16x16x32_bf16 v[64:67], a[64:67], v[32:35], v[64:67]
    v_cvt_pk_bf16_f32 v86, v76, v77
    v_mfma_f32_16x16x32_bf16 v[64:67], a[68:71], v[36:39], v[64:67]
    s_waitcnt lgkmcnt(0)
    buffer_store_dwordx4 v[88:91], v5, s[4:7], s34 offen offset:0 sc1
    v_cvt_pk_bf16_f32 v87, v78, v79
    v_mfma_f32_16x16x32_bf16 v[68:71], a[72:75], v[16:19], 0
    ds_write_b128 v214, v[84:87] offset:1024
    v_mfma_f32_16x16x32_bf16 v[68:71], a[76:79], v[20:23], v[68:71]
    ds_read_b128 v[92:95], v215 offset:1024
    v_mfma_f32_16x16x32_bf16 v[68:71], a[80:83], v[24:27], v[68:71]
    v_mfma_f32_16x16x32_bf16 v[68:71], a[84:87], v[28:31], v[68:71]
    v_mfma_f32_16x16x32_bf16 v[68:71], a[88:91], v[32:35], v[68:71]
    v_mfma_f32_16x16x32_bf16 v[68:71], a[92:95], v[36:39], v[68:71]
    v_mfma_f32_16x16x32_bf16 v[72:75], a[48:51], v[40:43], 0
    v_mfma_f32_16x16x32_bf16 v[72:75], a[52:55], v[44:47], v[72:75]
    v_mfma_f32_16x16x32_bf16 v[72:75], a[56:59], v[48:51], v[72:75]
    v_cvt_pk_bf16_f32 v80, v64, v65
    v_mfma_f32_16x16x32_bf16 v[72:75], a[60:63], v[52:55], v[72:75]
    v_cvt_pk_bf16_f32 v81, v66, v67
    v_and_or_b32 v80, v80, -2, s32
    v_mfma_f32_16x16x32_bf16 v[72:75], a[64:67], v[56:59], v[72:75]
    v_cvt_pk_bf16_f32 v82, v68, v69
    v_mfma_f32_16x16x32_bf16 v[72:75], a[68:71], v[60:63], v[72:75]
    s_waitcnt lgkmcnt(0)
    buffer_store_dwordx4 v[92:95], v5, s[4:7], s35 offen offset:0 sc1
    v_cvt_pk_bf16_f32 v83, v70, v71
    v_mfma_f32_16x16x32_bf16 v[76:79], a[72:75], v[40:43], 0
    ds_write_b128 v214, v[80:83] offset:0
    v_mfma_f32_16x16x32_bf16 v[76:79], a[76:79], v[44:47], v[76:79]
    ds_read_b128 v[88:91], v215 offset:0
    v_mfma_f32_16x16x32_bf16 v[76:79], a[80:83], v[48:51], v[76:79]
    v_mfma_f32_16x16x32_bf16 v[76:79], a[84:87], v[52:55], v[76:79]
    v_mfma_f32_16x16x32_bf16 v[76:79], a[88:91], v[56:59], v[76:79]
    v_mfma_f32_16x16x32_bf16 v[76:79], a[92:95], v[60:63], v[76:79]
    v_mfma_f32_16x16x32_bf16 v[64:67], a[96:99], v[16:19], 0
    v_mfma_f32_16x16x32_bf16 v[64:67], a[100:103], v[20:23], v[64:67]
    v_mfma_f32_16x16x32_bf16 v[64:67], a[104:107], v[24:27], v[64:67]
    v_cvt_pk_bf16_f32 v84, v72, v73
    v_mfma_f32_16x16x32_bf16 v[64:67], a[108:111], v[28:31], v[64:67]
    v_cvt_pk_bf16_f32 v85, v74, v75
    v_and_or_b32 v84, v84, -2, s32
    v_mfma_f32_16x16x32_bf16 v[64:67], a[112:115], v[32:35], v[64:67]
    v_cvt_pk_bf16_f32 v86, v76, v77
    v_mfma_f32_16x16x32_bf16 v[64:67], a[116:119], v[36:39], v[64:67]
    s_waitcnt lgkmcnt(0)
    buffer_store_dwordx4 v[88:91], v5, s[4:7], s34 offen offset:64 sc1
    v_cvt_pk_bf16_f32 v87, v78, v79
    v_mfma_f32_16x16x32_bf16 v[68:71], a[120:123], v[16:19], 0
    ds_write_b128 v214, v[84:87] offset:1024
    v_mfma_f32_16x16x32_bf16 v[68:71], a[124:127], v[20:23], v[68:71]
    ds_read_b128 v[92:95], v215 offset:1024
    v_mfma_f32_16x16x32_bf16 v[68:71], a[128:131], v[24:27], v[68:71]
    v_mfma_f32_16x16x32_bf16 v[68:71], a[132:135], v[28:31], v[68:71]
    v_mfma_f32_16x16x32_bf16 v[68:71], a[136:139], v[32:35], v[68:71]
    v_mfma_f32_16x16x32_bf16 v[68:71], a[140:143], v[36:39], v[68:71]
    v_mfma_f32_16x16x32_bf16 v[72:75], a[96:99], v[40:43], 0
    v_mfma_f32_16x16x32_bf16 v[72:75], a[100:103], v[44:47], v[72:75]
    v_mfma_f32_16x16x32_bf16 v[72:75], a[104:107], v[48:51], v[72:75]
    v_cvt_pk_bf16_f32 v80, v64, v65
    v_mfma_f32_16x16x32_bf16 v[72:75], a[108:111], v[52:55], v[72:75]
    v_cvt_pk_bf16_f32 v81, v66, v67
    v_and_or_b32 v80, v80, -2, s32
    v_mfma_f32_16x16x32_bf16 v[72:75], a[112:115], v[56:59], v[72:75]
    v_cvt_pk_bf16_f32 v82, v68, v69
    v_mfma_f32_16x16x32_bf16 v[72:75], a[116:119], v[60:63], v[72:75]
    s_waitcnt lgkmcnt(0)
    buffer_store_dwordx4 v[92:95], v5, s[4:7], s35 offen offset:64 sc1
    v_cvt_pk_bf16_f32 v83, v70, v71
    v_mfma_f32_16x16x32_bf16 v[76:79], a[120:123], v[40:43], 0
    ds_write_b128 v214, v[80:83] offset:0
    v_mfma_f32_16x16x32_bf16 v[76:79], a[124:127], v[44:47], v[76:79]
    ds_read_b128 v[88:91], v215 offset:0
    v_mfma_f32_16x16x32_bf16 v[76:79], a[128:131], v[48:51], v[76:79]
    v_mfma_f32_16x16x32_bf16 v[76:79], a[132:135], v[52:55], v[76:79]
    v_mfma_f32_16x16x32_bf16 v[76:79], a[136:139], v[56:59], v[76:79]
    v_mfma_f32_16x16x32_bf16 v[76:79], a[140:143], v[60:63], v[76:79]
    v_mfma_f32_16x16x32_bf16 v[64:67], a[144:147], v[16:19], 0
    v_mfma_f32_16x16x32_bf16 v[64:67], a[148:151], v[20:23], v[64:67]
    v_mfma_f32_16x16x32_bf16 v[64:67], a[152:155], v[24:27], v[64:67]
    v_cvt_pk_bf16_f32 v84, v72, v73
    v_mfma_f32_16x16x32_bf16 v[64:67], a[156:159], v[28:31], v[64:67]
    v_cvt_pk_bf16_f32 v85, v74, v75
    v_and_or_b32 v84, v84, -2, s32
    v_mfma_f32_16x16x32_bf16 v[64:67], a[160:163], v[32:35], v[64:67]
    v_cvt_pk_bf16_f32 v86, v76, v77
    v_mfma_f32_16x16x32_bf16 v[64:67], a[164:167], v[36:39], v[64:67]
    s_waitcnt lgkmcnt(0)
    buffer_store_dwordx4 v[88:91], v5, s[4:7], s34 offen offset:128 sc1
    v_cvt_pk_bf16_f32 v87, v78, v79
    v_mfma_f32_16x16x32_bf16 v[68:71], a[168:171], v[16:19], 0
    ds_write_b128 v214, v[84:87] offset:1024
    v_mfma_f32_16x16x32_bf16 v[68:71], a[172:175], v[20:23], v[68:71]
    ds_read_b128 v[92:95], v215 offset:1024
    v_mfma_f32_16x16x32_bf16 v[68:71], a[176:179], v[24:27], v[68:71]
    v_mfma_f32_16x16x32_bf16 v[68:71], a[180:183], v[28:31], v[68:71]
    v_mfma_f32_16x16x32_bf16 v[68:71], a[184:187], v[32:35], v[68:71]
    v_mfma_f32_16x16x32_bf16 v[68:71], a[188:191], v[36:39], v[68:71]
    v_mfma_f32_16x16x32_bf16 v[72:75], a[144:147], v[40:43], 0
    v_mfma_f32_16x16x32_bf16 v[72:75], a[148:151], v[44:47], v[72:75]
    v_mfma_f32_16x16x32_bf16 v[72:75], a[152:155], v[48:51], v[72:75]
    v_cvt_pk_bf16_f32 v80, v64, v65
    v_mfma_f32_16x16x32_bf16 v[72:75], a[156:159], v[52:55], v[72:75]
    v_cvt_pk_bf16_f32 v81, v66, v67
    v_and_or_b32 v80, v80, -2, s32
    v_mfma_f32_16x16x32_bf16 v[72:75], a[160:163], v[56:59], v[72:75]
    v_cvt_pk_bf16_f32 v82, v68, v69
    v_mfma_f32_16x16x32_bf16 v[72:75], a[164:167], v[60:63], v[72:75]
    s_waitcnt lgkmcnt(0)
    buffer_store_dwordx4 v[92:95], v5, s[4:7], s35 offen offset:128 sc1
    v_cvt_pk_bf16_f32 v83, v70, v71
    v_mfma_f32_16x16x32_bf16 v[76:79], a[168:171], v[40:43], 0
    ds_write_b128 v214, v[80:83] offset:0
    v_mfma_f32_16x16x32_bf16 v[76:79], a[172:175], v[44:47], v[76:79]
    ds_read_b128 v[88:91], v215 offset:0
    v_mfma_f32_16x16x32_bf16 v[76:79], a[176:179], v[48:51], v[76:79]
    v_mfma_f32_16x16x32_bf16 v[76:79], a[180:183], v[52:55], v[76:79]
    v_mfma_f32_16x16x32_bf16 v[76:79], a[184:187], v[56:59], v[76:79]
    v_mfma_f32_16x16x32_bf16 v[76:79], a[188:191], v[60:63], v[76:79]
    v_mfma_f32_16x16x32_bf16 v[64:67], a[192:195], v[16:19], 0
    v_mfma_f32_16x16x32_bf16 v[64:67], a[196:199], v[20:23], v[64:67]
    v_mfma_f32_16x16x32_bf16 v[64:67], a[200:203], v[24:27], v[64:67]
    v_cvt_pk_bf16_f32 v84, v72, v73
    v_mfma_f32_16x16x32_bf16 v[64:67], a[204:207], v[28:31], v[64:67]
    v_cvt_pk_bf16_f32 v85, v74, v75
    v_and_or_b32 v84, v84, -2, s32
    v_mfma_f32_16x16x32_bf16 v[64:67], a[208:211], v[32:35], v[64:67]
    v_cvt_pk_bf16_f32 v86, v76, v77
    v_mfma_f32_16x16x32_bf16 v[64:67], a[212:215], v[36:39], v[64:67]
    s_waitcnt lgkmcnt(0)
    buffer_store_dwordx4 v[88:91], v5, s[4:7], s34 offen offset:192 sc1
    v_cvt_pk_bf16_f32 v87, v78, v79
    v_mfma_f32_16x16x32_bf16 v[68:71], a[216:219], v[16:19], 0
    ds_write_b128 v214, v[84:87] offset:1024
    v_mfma_f32_16x16x32_bf16 v[68:71], a[220:223], v[20:23], v[68:71]
    ds_read_b128 v[92:95], v215 offset:1024
    v_mfma_f32_16x16x32_bf16 v[68:71], a[224:227], v[24:27], v[68:71]
    v_mfma_f32_16x16x32_bf16 v[68:71], a[228:231], v[28:31], v[68:71]
    v_mfma_f32_16x16x32_bf16 v[68:71], a[232:235], v[32:35], v[68:71]
    v_mfma_f32_16x16x32_bf16 v[68:71], a[236:239], v[36:39], v[68:71]
    v_mfma_f32_16x16x32_bf16 v[72:75], a[192:195], v[40:43], 0
    v_mfma_f32_16x16x32_bf16 v[72:75], a[196:199], v[44:47], v[72:75]
    v_mfma_f32_16x16x32_bf16 v[72:75], a[200:203], v[48:51], v[72:75]
    v_cvt_pk_bf16_f32 v80, v64, v65
    v_mfma_f32_16x16x32_bf16 v[72:75], a[204:207], v[52:55], v[72:75]
    v_cvt_pk_bf16_f32 v81, v66, v67
    v_and_or_b32 v80, v80, -2, s32
    v_mfma_f32_16x16x32_bf16 v[72:75], a[208:211], v[56:59], v[72:75]
    v_cvt_pk_bf16_f32 v82, v68, v69
    v_mfma_f32_16x16x32_bf16 v[72:75], a[212:215], v[60:63], v[72:75]
    s_waitcnt lgkmcnt(0)
    buffer_store_dwordx4 v[92:95], v5, s[4:7], s35 offen offset:192 sc1
    v_cvt_pk_bf16_f32 v83, v70, v71
    v_mfma_f32_16x16x32_bf16 v[76:79], a[216:219], v[40:43], 0
    ds_write_b128 v214, v[80:83] offset:0
    v_mfma_f32_16x16x32_bf16 v[76:79], a[220:223], v[44:47], v[76:79]
    ds_read_b128 v[88:91], v215 offset:0
    v_mfma_f32_16x16x32_bf16 v[76:79], a[224:227], v[48:51], v[76:79]
    v_mfma_f32_16x16x32_bf16 v[76:79], a[228:231], v[52:55], v[76:79]
    v_mfma_f32_16x16x32_bf16 v[76:79], a[232:235], v[56:59], v[76:79]
    v_mfma_f32_16x16x32_bf16 v[76:79], a[236:239], v[60:63], v[76:79]
    v_cvt_pk_bf16_f32 v84, v72, v73
    v_cvt_pk_bf16_f32 v85, v74, v75
    v_and_or_b32 v84, v84, -2, s32
    s_nop 4
    v_cvt_pk_bf16_f32 v86, v76, v77
    s_waitcnt lgkmcnt(0)
    buffer_store_dwordx4 v[88:91], v5, s[4:7], s34 offen offset:256 sc1
    v_cvt_pk_bf16_f32 v87, v78, v79
    ds_write_b128 v214, v[84:87] offset:1024
    ds_read_b128 v[92:95], v215 offset:1024
    s_waitcnt lgkmcnt(0)
    buffer_store_dwordx4 v[92:95], v5, s[4:7], s35 offen offset:256 sc1
    v_add_u32 v1, s31, v1
    v_add_u32 v2, s31, v2
    v_add_u32 v3, s31, v3
    s_sub_u32 s31, 0, s31
    s_add_u32 s34, s34, s26
    s_add_u32 s35, s35, s26
    s_cmp_eq_u32 s12, 0
    s_cselect_b32 s63, s97, 0
    s_waitcnt vmcnt(10)
    s_barrier
    ds_read_b128 v[16:19], v1 offset:0
    ds_read_b128 v[40:43], v2 offset:0
    ds_read_b128 v[64:67], v2 offset:3072
    ds_read_b128 v[20:23], v1 offset:1024
    ds_read_b128 v[44:47], v2 offset:1024
    ds_read_b128 v[68:71], v2 offset:4096
    ds_read_b128 v[24:27], v1 offset:2048
    ds_read_b128 v[48:51], v2 offset:2048
    ds_read_b128 v[72:75], v2 offset:5120
    ds_read_b128 v[28:31], v1 offset:3072
    ds_read_b128 v[52:55], v2 offset:12288
    ds_read_b128 v[76:79], v2 offset:15360
    ds_read_b128 v[32:35], v1 offset:4096
    ds_read_b128 v[56:59], v2 offset:13312
    ds_read_b128 v[80:83], v2 offset:16384
    ds_read_b128 v[36:39], v1 offset:5120
    ds_read_b128 v[60:63], v2 offset:14336
    ds_read_b128 v[84:87], v2 offset:17408
    s_waitcnt lgkmcnt(15)
    v_mfma_f32_16x16x32_bf16 v[152:155], v[40:43], v[16:19], 0
    v_mfma_f32_16x16x32_bf16 v[156:159], v[64:67], v[16:19], 0
    s_waitcnt lgkmcnt(12)
    v_mfma_f32_16x16x32_bf16 v[152:155], v[44:47], v[20:23], v[152:155]
    v_mfma_f32_16x16x32_bf16 v[156:159], v[68:71], v[20:23], v[156:159]
    s_waitcnt lgkmcnt(9)
    v_mfma_f32_16x16x32_bf16 v[152:155], v[48:51], v[24:27], v[152:155]
    v_mfma_f32_16x16x32_bf16 v[156:159], v[72:75], v[24:27], v[156:159]
    s_waitcnt lgkmcnt(6)
    v_mfma_f32_16x16x32_bf16 v[152:155], v[52:55], v[28:31], v[152:155]
    v_mfma_f32_16x16x32_bf16 v[156:159], v[76:79], v[28:31], v[156:159]
    s_waitcnt lgkmcnt(3)
    v_mfma_f32_16x16x32_bf16 v[152:155], v[56:59], v[32:35], v[152:155]
    v_mfma_f32_16x16x32_bf16 v[156:159], v[80:83], v[32:35], v[156:159]
    s_waitcnt lgkmcnt(0)
    v_mfma_f32_16x16x32_bf16 v[152:155], v[60:63], v[36:39], v[152:155]
    v_mfma_f32_16x16x32_bf16 v[156:159], v[84:87], v[36:39], v[156:159]
    ds_read_b128 v[112:115], v3 offset:0
    ds_read_b128 v[116:119], v3 offset:1024
    ds_read_b128 v[120:123], v3 offset:2048
    ds_read_b128 v[124:127], v3 offset:3072
    ds_read_b128 v[128:131], v3 offset:4096
    ds_read_b128 v[132:135], v3 offset:5120
    s_nop 0
    v_cvt_pk_bf16_f32 v162, v152, v153
    v_cvt_pk_bf16_f32 v163, v154, v155
    v_cvt_pk_bf16_f32 v164, v156, v157
    v_cvt_pk_bf16_f32 v165, v158, v159
    v_lshlrev_b32 v152, 16, v162
    v_and_b32 v153, 0xffff0000, v162
    v_lshlrev_b32 v154, 16, v163
    v_and_b32 v155, 0xffff0000, v163
    v_lshlrev_b32 v156, 16, v164
    v_and_b32 v157, 0xffff0000, v164
    v_lshlrev_b32 v158, 16, v165
    v_and_b32 v159, 0xffff0000, v165
    v_mul_f32 v152, s42, v152
    v_mul_f32 v153, s42, v153
    v_mul_f32 v154, s42, v154
    v_mul_f32 v155, s42, v155
    v_mul_f32 v156, s42, v156
    v_mul_f32 v157, s42, v157
    v_mul_f32 v158, s42, v158
    v_mul_f32 v159, s42, v159
    v_cvt_pk_bf16_f32 v162, v152, v153
    v_cvt_pk_bf16_f32 v163, v154, v155
    v_cvt_pk_bf16_f32 v164, v156, v157
    v_cvt_pk_bf16_f32 v165, v158, v159
    v_lshlrev_b32 v152, 16, v162
    v_and_b32 v153, 0xffff0000, v162
    v_lshlrev_b32 v154, 16, v163
    v_and_b32 v155, 0xffff0000, v163
    v_lshlrev_b32 v156, 16, v164
    v_and_b32 v157, 0xffff0000, v164
    v_lshlrev_b32 v158, 16, v165
    v_and_b32 v159, 0xffff0000, v165
    v_mov_b32 v160, 0xff800000
    v_cndmask_b32 v152, v160, v152, s[46:47]
    v_cndmask_b32 v153, v160, v153, s[48:49]
    v_cndmask_b32 v154, v160, v154, s[50:51]
    v_cndmask_b32 v155, v160, v155, s[52:53]
    v_cndmask_b32 v156, v160, v156, s[54:55]
    v_cndmask_b32 v157, v160, v157, s[56:57]
    v_cndmask_b32 v158, v160, v158, s[58:59]
    v_cndmask_b32 v159, v160, v159, s[60:61]
    s_waitcnt vmcnt(0)
    s_cmp_eq_u32 s97, 0
    s_cbranch_scc1 L_Os_wait_2
    s_add_u32 s27, s36, 0
    buffer_load_dwordx4 v[168:171], v6, s[4:7], s27 offen sc1
    s_add_u32 s27, s36, 5120
    buffer_load_dwordx4 v[172:175], v6, s[4:7], s27 offen sc1
    s_add_u32 s27, s36, 10240
    buffer_load_dwordx4 v[176:179], v6, s[4:7], s27 offen sc1
    s_add_u32 s27, s36, 15360
    buffer_load_dwordx4 v[180:183], v6, s[4:7], s27 offen sc1
    s_add_u32 s27, s36, 20480
    buffer_load_dwordx4 v[184:187], v6, s[4:7], s27 offen sc1
    s_add_u32 s27, s36, 25600
    buffer_load_dwordx4 v[188:191], v6, s[4:7], s27 offen sc1
    s_add_u32 s27, s36, 30720
    buffer_load_dwordx4 v[192:195], v6, s[4:7], s27 offen sc1
    s_add_u32 s27, s36, 35840
    buffer_load_dwordx4 v[196:199], v6, s[4:7], s27 offen sc1
    s_add_u32 s27, s36, 0
    buffer_load_dwordx4 v[200:203], v7, s[4:7], s27 offen sc1
    s_add_u32 s27, s36, 20480
    buffer_load_dwordx4 v[204:207], v7, s[4:7], s27 offen sc1
    s_lshl_b32 s37, s23, 5
    s_add_u32 s37, s37, s21
    s_lshl_b32 s37, s37, 2
    s_add_u32 s37, s37, s12
    s_mul_i32 s37, s37, 3072
    s_add_u32 s37, s37, 5898240
    s_mul_i32 s28, s12, 3072
    s_add_u32 m0, s28, 73728
    s_nop 0
    buffer_load_dwordx4 v0, s[4:7], s37 offen offset:0 sc1 lds
    buffer_load_dwordx4 v0, s[4:7], s37 offen offset:1024 sc1 lds
    buffer_load_dwordx4 v0, s[4:7], s37 offen offset:2048 sc1 lds
    s_mov_b32 s19, 0
L_Os_red_3:
    v_mfma_f32_16x16x32_bf16 v[216:219], a[240:243], v[220:223], 0
    v_mfma_f32_16x16x32_bf16 v[216:219], a[244:247], v[224:227], v[216:219]
    s_waitcnt vmcnt(12)
    v_mfma_f32_16x16x32_bf16 v[216:219], a[240:243], v[168:171], v[216:219]
    v_xor_b32 v14, s33, v168
    s_waitcnt vmcnt(11)
    v_mfma_f32_16x16x32_bf16 v[216:219], a[240:243], v[172:175], v[216:219]
    v_bitop3_b32 v14, v14, v172, s33 bitop3:0xf6
    s_waitcnt vmcnt(10)
    v_mfma_f32_16x16x32_bf16 v[216:219], a[240:243], v[176:179], v[216:219]
    v_bitop3_b32 v14, v14, v176, s33 bitop3:0xf6
    s_waitcnt vmcnt(9)
    v_mfma_f32_16x16x32_bf16 v[216:219], a[240:243], v[180:183], v[216:219]
    v_bitop3_b32 v14, v14, v180, s33 bitop3:0xf6
    s_waitcnt vmcnt(8)
    v_mfma_f32_16x16x32_bf16 v[216:219], a[240:243], v[184:187], v[216:219]
    v_bitop3_b32 v14, v14, v184, s33 bitop3:0xf6
    s_waitcnt vmcnt(7)
    v_mfma_f32_16x16x32_bf16 v[216:219], a[240:243], v[188:191], v[216:219]
    v_bitop3_b32 v14, v14, v188, s33 bitop3:0xf6
    s_waitcnt vmcnt(6)
    v_mfma_f32_16x16x32_bf16 v[216:219], a[240:243], v[192:195], v[216:219]
    v_bitop3_b32 v14, v14, v192, s33 bitop3:0xf6
    s_waitcnt vmcnt(5)
    v_mfma_f32_16x16x32_bf16 v[216:219], a[240:243], v[196:199], v[216:219]
    v_bitop3_b32 v14, v14, v196, s33 bitop3:0xf6
    s_waitcnt vmcnt(4)
    v_mfma_f32_16x16x32_bf16 v[216:219], a[244:247], v[200:203], v[216:219]
    v_bitop3_b32 v14, v14, v200, s33 bitop3:0xf6
    s_waitcnt vmcnt(3)
    v_mfma_f32_16x16x32_bf16 v[216:219], a[244:247], v[204:207], v[216:219]
    v_bitop3_b32 v14, v14, v204, s33 bitop3:0xf6
    v_and_b32 v14, 1, v14
    v_cmp_ne_u32 vcc, 0, v14
    s_nop 0
    s_cbranch_vccnz L_Os_redfix_4
    s_nop 2
    v_add_f32_dpp v216, v216, v216 row_ror:4 row_mask:0xc bank_mask:0xf
    v_add_f32_dpp v217, v217, v217 row_ror:4 row_mask:0xc bank_mask:0xf
    v_add_f32_dpp v218, v218, v218 row_ror:4 row_mask:0xc bank_mask:0xf
    v_add_f32_dpp v219, v219, v219 row_ror:4 row_mask:0xc bank_mask:0xf
    v_add_f32_dpp v216, v216, v216 row_ror:8 row_mask:0xc bank_mask:0xf
    v_add_f32_dpp v217, v217, v217 row_ror:8 row_mask:0xc bank_mask:0xf
    v_add_f32_dpp v218, v218, v218 row_ror:8 row_mask:0xc bank_mask:0xf
    v_add_f32_dpp v219, v219, v219 row_ror:8 row_mask:0xc bank_mask:0xf
    v_cvt_pk_bf16_f32 v202, v216, v217
    v_cvt_pk_bf16_f32 v203, v218, v219
    v_lshlrev_b32 v216, 16, v202
    v_and_b32 v217, 0xffff0000, v202
    v_lshlrev_b32 v218, 16, v203
    v_and_b32 v219, 0xffff0000, v203
    v_readfirstlane_b32 s86, v216
    s_nop 1
    v_pk_add_f32 v[176:177], v[216:217], s[86:87] op_sel_hi:[1,0] neg_lo:[0,1] neg_hi:[0,1]
    v_pk_add_f32 v[178:179], v[218:219], s[86:87] op_sel_hi:[1,0] neg_lo:[0,1] neg_hi:[0,1]
    v_pk_add_f32 v[170:171], v[176:177], v[178:179]
    v_pk_mul_f32 v[172:173], v[176:177], v[176:177]
    v_pk_fma_f32 v[172:173], v[178:179], v[178:179], v[172:173]
    v_add_f32 v168, v170, v171
    v_add_f32 v169, v172, v173
    v_cndmask_b32 v168, 0, v168, s[90:91]
    v_cndmask_b32 v169, 0, v169, s[90:91]
    s_nop 0
    v_add_f32_dpp v168, v168, v168 quad_perm:[1,0,3,2] row_mask:0xf bank_mask:0xf
    v_add_f32_dpp v169, v169, v169 quad_perm:[1,0,3,2] row_mask:0xf bank_mask:0xf
    s_nop 0
    v_add_f32_dpp v168, v168, v168 quad_perm:[2,3,0,1] row_mask:0xf bank_mask:0xf
    v_add_f32_dpp v169, v169, v169 quad_perm:[2,3,0,1] row_mask:0xf bank_mask:0xf
    s_nop 0
    v_add_f32_dpp v168, v168, v168 row_half_mirror row_mask:0xf bank_mask:0xf
    v_add_f32_dpp v169, v169, v169 row_half_mirror row_mask:0xf bank_mask:0xf
    s_nop 0
    v_add_f32_dpp v168, v168, v168 row_mirror row_mask:0xf bank_mask:0xf
    v_add_f32_dpp v169, v169, v169 row_mirror row_mask:0xf bank_mask:0xf
    v_mov_b32 v170, v168
    v_mov_b32 v171, v169
    s_nop 0
    v_permlane16_swap_b32 v168, v170
    v_permlane16_swap_b32 v169, v171
    v_add_f32 v168, v168, v170
    v_add_f32 v169, v169, v171
    v_mov_b32 v170, v168
    v_mov_b32 v171, v169
    s_nop 0
    v_permlane32_swap_b32 v168, v170
    v_permlane32_swap_b32 v169, v171
    v_add_f32 v168, v168, v170
    v_add_f32 v169, v169, v171
    v_mul_f32 v170, 6.2500000000e-03, v168
    v_fma_f32 v169, -v170, v168, v169
    v_add_f32 v168, s86, v170
    s_mov_b64 exec, 1
    ds_write_b64 v11, v[168:169] offset:0
    s_mov_b64 exec, -1
    s_waitcnt vmcnt(0) lgkmcnt(0)
    s_barrier
    ds_read_b128 v[180:183], v213 offset:0
    ds_read_b128 v[184:187], v213 offset:16
    s_waitcnt lgkmcnt(0)
    v_pk_add_f32 v[168:169], v[180:181], v[182:183]
    v_pk_add_f32 v[170:171], v[184:185], v[186:187]
    v_pk_add_f32 v[168:169], v[168:169], v[170:171]
    v_mul_f32 v168, 0.25, v168
    v_sub_f32 v180, v180, v168
    v_sub_f32 v182, v182, v168
    v_sub_f32 v184, v184, v168
    v_sub_f32 v186, v186, v168
    v_mul_f32 v170, v180, v180
    v_fmac_f32 v170, v182, v182
    v_fmac_f32 v170, v184, v184
    v_fmac_f32 v170, v186, v186
    v_mul_f32 v169, 1.5625000000e-03, v169
    v_fmac_f32 v169, 0.25, v170
    v_max_f32 v169, 0, v169
    v_cvt_pk_bf16_f32 v170, v169, v168
    v_lshlrev_b32 v169, 16, v170
    v_and_b32 v168, 0xffff0000, v170
    v_add_f32 v169, 0x3727c5ac, v169
    v_pk_add_f32 v[176:177], v[216:217], v[168:169] op_sel_hi:[1,0] neg_lo:[0,1] neg_hi:[0,1]
    v_cvt_pk_bf16_f32 v170, v169, v169
    v_pk_add_f32 v[178:179], v[218:219], v[168:169] op_sel_hi:[1,0] neg_lo:[0,1] neg_hi:[0,1]
    v_lshlrev_b32 v170, 16, v170
    v_sqrt_f32 v170, v170
    v_cvt_pk_bf16_f32 v200, v176, v177
    v_cvt_pk_bf16_f32 v201, v178, v179
    v_cvt_pk_bf16_f32 v170, v170, v170
    v_lshlrev_b32 v170, 16, v170
    v_rcp_f32 v170, v170
    v_lshlrev_b32 v176, 16, v200
    v_and_b32 v177, 0xffff0000, v200
    v_lshlrev_b32 v178, 16, v201
    v_and_b32 v179, 0xffff0000, v201
    v_pk_mul_f32 v[176:177], v[176:177], v[170:171] op_sel_hi:[1,0]
    v_pk_mul_f32 v[178:179], v[178:179], v[170:171] op_sel_hi:[1,0]
    v_cvt_pk_bf16_f32 v200, v176, v177
    v_cvt_pk_bf16_f32 v201, v178, v179
    s_nop 0
    v_permlane16_swap_b32 v200, v202
    v_permlane16_swap_b32 v201, v203
    s_mov_b32 exec_lo, 4294967295
    s_mov_b32 exec_hi, 983055
    buffer_store_dwordx4 v[200:203], v8, s[4:7], s41 offen offset:0 sc1
    s_mov_b64 exec, -1
    s_add_u32 s36, s36, s26
    s_sub_u32 s26, 0, s26
    s_add_u32 s22, s22, 1
    s_add_u32 s39, s39, 40960
    s_add_u32 s41, s41, 40960
    s_add_u32 s23, s23, 1
    s_sub_u32 s30, 36864, s30
    s_branch L_Os_top
L_Os_wait_2:
    s_add_u32 s27, s36, 0
    buffer_load_dwordx4 v[168:171], v6, s[4:7], s27 offen sc1
    s_add_u32 s27, s36, 5120
    buffer_load_dwordx4 v[172:175], v6, s[4:7], s27 offen sc1
    s_add_u32 s27, s36, 10240
    buffer_load_dwordx4 v[176:179], v6, s[4:7], s27 offen sc1
    s_add_u32 s27, s36, 15360
    buffer_load_dwordx4 v[180:183], v6, s[4:7], s27 offen sc1
    s_add_u32 s27, s36, 20480
    buffer_load_dwordx4 v[184:187], v6, s[4:7], s27 offen sc1
    s_add_u32 s27, s36, 25600
    buffer_load_dwordx4 v[188:191], v6, s[4:7], s27 offen sc1
    s_add_u32 s27, s36, 30720
    buffer_load_dwordx4 v[192:195], v6, s[4:7], s27 offen sc1
    s_add_u32 s27, s36, 35840
    buffer_load_dwordx4 v[196:199], v6, s[4:7], s27 offen sc1
    s_add_u32 s27, s36, 0
    buffer_load_dwordx4 v[200:203], v7, s[4:7], s27 offen sc1
    s_add_u32 s27, s36, 20480
    buffer_load_dwordx4 v[204:207], v7, s[4:7], s27 offen sc1
    s_mov_b32 s19, 0
L_Os_red_5:
    v_mfma_f32_16x16x32_bf16 v[216:219], a[240:243], v[220:223], 0
    v_mfma_f32_16x16x32_bf16 v[216:219], a[244:247], v[224:227], v[216:219]
    s_waitcnt vmcnt(9)
    v_mfma_f32_16x16x32_bf16 v[216:219], a[240:243], v[168:171], v[216:219]
    v_xor_b32 v14, s33, v168
    s_waitcnt vmcnt(8)
    v_mfma_f32_16x16x32_bf16 v[216:219], a[240:243], v[172:175], v[216:219]
    v_bitop3_b32 v14, v14, v172, s33 bitop3:0xf6
    s_waitcnt vmcnt(7)
    v_mfma_f32_16x16x32_bf16 v[216:219], a[240:243], v[176:179], v[216:219]
    v_bitop3_b32 v14, v14, v176, s33 bitop3:0xf6
    s_waitcnt vmcnt(6)
    v_mfma_f32_16x16x32_bf16 v[216:219], a[240:243], v[180:183], v[216:219]
    v_bitop3_b32 v14, v14, v180, s33 bitop3:0xf6
    s_waitcnt vmcnt(5)
    v_mfma_f32_16x16x32_bf16 v[216:219], a[240:243], v[184:187], v[216:219]
    v_bitop3_b32 v14, v14, v184, s33 bitop3:0xf6
    s_waitcnt vmcnt(4)
    v_mfma_f32_16x16x32_bf16 v[216:219], a[240:243], v[188:191], v[216:219]
    v_bitop3_b32 v14, v14, v188, s33 bitop3:0xf6
    s_waitcnt vmcnt(3)
    v_mfma_f32_16x16x32_bf16 v[216:219], a[240:243], v[192:195], v[216:219]
    v_bitop3_b32 v14, v14, v192, s33 bitop3:0xf6
    s_waitcnt vmcnt(2)
    v_mfma_f32_16x16x32_bf16 v[216:219], a[240:243], v[196:199], v[216:219]
    v_bitop3_b32 v14, v14, v196, s33 bitop3:0xf6
    s_waitcnt vmcnt(1)
    v_mfma_f32_16x16x32_bf16 v[216:219], a[244:247], v[200:203], v[216:219]
    v_bitop3_b32 v14, v14, v200, s33 bitop3:0xf6
    s_waitcnt vmcnt(0)
    v_mfma_f32_16x16x32_bf16 v[216:219], a[244:247], v[204:207], v[216:219]
    v_bitop3_b32 v14, v14, v204, s33 bitop3:0xf6
    v_and_b32 v14, 1, v14
    v_cmp_ne_u32 vcc, 0, v14
    s_nop 0
    s_cbranch_vccnz L_Os_redfix_6
    s_nop 2
    v_add_f32_dpp v216, v216, v216 row_ror:4 row_mask:0xc bank_mask:0xf
    v_add_f32_dpp v217, v217, v217 row_ror:4 row_mask:0xc bank_mask:0xf
    v_add_f32_dpp v218, v218, v218 row_ror:4 row_mask:0xc bank_mask:0xf
    v_add_f32_dpp v219, v219, v219 row_ror:4 row_mask:0xc bank_mask:0xf
    v_add_f32_dpp v216, v216, v216 row_ror:8 row_mask:0xc bank_mask:0xf
    v_add_f32_dpp v217, v217, v217 row_ror:8 row_mask:0xc bank_mask:0xf
    v_add_f32_dpp v218, v218, v218 row_ror:8 row_mask:0xc bank_mask:0xf
    v_add_f32_dpp v219, v219, v219 row_ror:8 row_mask:0xc bank_mask:0xf
    buffer_load_dword v12, v10, s[4:7], s25 offen sc1
    v_cvt_pk_bf16_f32 v202, v216, v217
    v_cvt_pk_bf16_f32 v203, v218, v219
    v_lshlrev_b32 v216, 16, v202
    v_and_b32 v217, 0xffff0000, v202
    v_lshlrev_b32 v218, 16, v203
    v_and_b32 v219, 0xffff0000, v203
    v_readfirstlane_b32 s86, v216
    s_nop 1
    v_pk_add_f32 v[176:177], v[216:217], s[86:87] op_sel_hi:[1,0] neg_lo:[0,1] neg_hi:[0,1]
    v_pk_add_f32 v[178:179], v[218:219], s[86:87] op_sel_hi:[1,0] neg_lo:[0,1] neg_hi:[0,1]
    v_pk_add_f32 v[170:171], v[176:177], v[178:179]
    v_pk_mul_f32 v[172:173], v[176:177], v[176:177]
    v_pk_fma_f32 v[172:173], v[178:179], v[178:179], v[172:173]
    v_add_f32 v168, v170, v171
    v_add_f32 v169, v172, v173
    v_cndmask_b32 v168, 0, v168, s[90:91]
    v_cndmask_b32 v169, 0, v169, s[90:91]
    s_nop 0
    v_add_f32_dpp v168, v168, v168 quad_perm:[1,0,3,2] row_mask:0xf bank_mask:0xf
    v_add_f32_dpp v169, v169, v169 quad_perm:[1,0,3,2] row_mask:0xf bank_mask:0xf
    s_nop 0
    v_add_f32_dpp v168, v168, v168 quad_perm:[2,3,0,1] row_mask:0xf bank_mask:0xf
    v_add_f32_dpp v169, v169, v169 quad_perm:[2,3,0,1] row_mask:0xf bank_mask:0xf
    s_nop 0
    v_add_f32_dpp v168, v168, v168 row_half_mirror row_mask:0xf bank_mask:0xf
    v_add_f32_dpp v169, v169, v169 row_half_mirror row_mask:0xf bank_mask:0xf
    s_nop 0
    v_add_f32_dpp v168, v168, v168 row_mirror row_mask:0xf bank_mask:0xf
    v_add_f32_dpp v169, v169, v169 row_mirror row_mask:0xf bank_mask:0xf
    v_mov_b32 v170, v168
    v_mov_b32 v171, v169
    s_nop 0
    v_permlane16_swap_b32 v168, v170
    v_permlane16_swap_b32 v169, v171
    v_add_f32 v168, v168, v170
    v_add_f32 v169, v169, v171
    v_mov_b32 v170, v168
    v_mov_b32 v171, v169
    s_nop 0
    v_permlane32_swap_b32 v168, v170
    v_permlane32_swap_b32 v169, v171
    v_add_f32 v168, v168, v170
    v_add_f32 v169, v169, v171
    v_mul_f32 v170, 6.2500000000e-03, v168
    v_fma_f32 v169, -v170, v168, v169
    v_add_f32 v168, s86, v170
    s_mov_b64 exec, 1
    ds_write_b64 v11, v[168:169] offset:0
    s_mov_b64 exec, -1
    s_waitcnt lgkmcnt(0)
    s_barrier
    ds_read_b128 v[180:183], v213 offset:0
    ds_read_b128 v[184:187], v213 offset:16
    s_waitcnt lgkmcnt(0)
    v_pk_add_f32 v[168:169], v[180:181], v[182:183]
    v_pk_add_f32 v[170:171], v[184:185], v[186:187]
    v_pk_add_f32 v[168:169], v[168:169], v[170:171]
    v_mul_f32 v168, 0.25, v168
    v_sub_f32 v180, v180, v168
    v_sub_f32 v182, v182, v168
    v_sub_f32 v184, v184, v168
    v_sub_f32 v186, v186, v168
    v_mul_f32 v170, v180, v180
    v_fmac_f32 v170, v182, v182
    v_fmac_f32 v170, v184, v184
    v_fmac_f32 v170, v186, v186
    v_mul_f32 v169, 1.5625000000e-03, v169
    v_fmac_f32 v169, 0.25, v170
    v_max_f32 v169, 0, v169
    v_cvt_pk_bf16_f32 v170, v169, v168
    v_lshlrev_b32 v169, 16, v170
    v_and_b32 v168, 0xffff0000, v170
    v_add_f32 v169, 0x3727c5ac, v169
    v_pk_add_f32 v[176:177], v[216:217], v[168:169] op_sel_hi:[1,0] neg_lo:[0,1] neg_hi:[0,1]
    v_cvt_pk_bf16_f32 v170, v169, v169
    v_pk_add_f32 v[178:179], v[218:219], v[168:169] op_sel_hi:[1,0] neg_lo:[0,1] neg_hi:[0,1]
    v_lshlrev_b32 v170, 16, v170
    v_sqrt_f32 v170, v170
    v_cvt_pk_bf16_f32 v200, v176, v177
    v_cvt_pk_bf16_f32 v201, v178, v179
    v_cvt_pk_bf16_f32 v170, v170, v170
    v_lshlrev_b32 v170, 16, v170
    v_rcp_f32 v170, v170
    v_lshlrev_b32 v176, 16, v200
    v_and_b32 v177, 0xffff0000, v200
    v_lshlrev_b32 v178, 16, v201
    v_and_b32 v179, 0xffff0000, v201
    v_pk_mul_f32 v[176:177], v[176:177], v[170:171] op_sel_hi:[1,0]
    v_pk_mul_f32 v[178:179], v[178:179], v[170:171] op_sel_hi:[1,0]
    v_cvt_pk_bf16_f32 v200, v176, v177
    v_cvt_pk_bf16_f32 v201, v178, v179
    s_nop 0
    v_permlane16_swap_b32 v200, v202
    v_permlane16_swap_b32 v201, v203
    s_mov_b32 exec_lo, 4294967295
    s_mov_b32 exec_hi, 983055
    buffer_store_dwordx4 v[200:203], v8, s[4:7], s41 offen offset:0 sc1
    s_mov_b64 exec, -1
    s_add_u32 s36, s36, s26
    s_sub_u32 s26, 0, s26
    s_add_u32 s22, s22, 1
    s_add_u32 s39, s39, 40960
    s_add_u32 s41, s41, 40960
    s_waitcnt vmcnt(1)
    s_mov_b32 s97, 0
    v_cmp_gt_u32 vcc, s29, v12
    s_nop 0
    s_cbranch_vccnz L_Os_notyet_7
    s_mov_b32 s97, 1
    s_lshl_b32 s37, s23, 5
    s_add_u32 s37, s37, s21
    s_lshl_b32 s37, s37, 2
    s_add_u32 s37, s37, s12
    s_mul_i32 s37, s37, 3072
    s_add_u32 s37, s37, 5898240
    s_mul_i32 s28, s12, 3072
    s_add_u32 m0, s28, 73728
    s_nop 0
    buffer_load_dwordx4 v0, s[4:7], s37 offen offset:0 sc1 lds
    buffer_load_dwordx4 v0, s[4:7], s37 offen offset:1024 sc1 lds
    buffer_load_dwordx4 v0, s[4:7], s37 offen offset:2048 sc1 lds
    s_waitcnt vmcnt(0)
    s_branch L_Os_notyet_7b
L_Os_notyet_7:
    buffer_load_dword v12, v10, s[4:7], s25 offen sc1
    s_waitcnt vmcnt(0)
L_Os_notyet_7b:
    s_barrier
    s_cmp_lg_u32 s12, 0
    s_cbranch_scc1 L_Os_nofl_8
    v_mov_b32 v13, s22
    s_mov_b64 exec, 1
    buffer_store_dword v13, v0, s[4:7], s24 offen offset:0 sc1
    s_mov_b64 exec, -1
L_Os_nofl_8:
    s_cmp_eq_u32 s22, 64
    s_cbranch_scc1 L_Os_top_end
    s_cmp_lg_u32 s97, 0
    s_cbranch_scc1 L_Os_have_9
    s_mov_b32 s19, 0
    v_cmp_gt_u32 vcc, s29, v12
    s_nop 0
    s_cbranch_vccnz L_Os_flspin_11
L_Os_fl_10:
    s_lshl_b32 s37, s23, 5
    s_add_u32 s37, s37, s21
    s_lshl_b32 s37, s37, 2
    s_add_u32 s37, s37, s12
    s_mul_i32 s37, s37, 3072
    s_add_u32 s37, s37, 5898240
    s_mul_i32 s28, s12, 3072
    s_add_u32 m0, s28, 73728
    s_nop 0
    buffer_load_dwordx4 v0, s[4:7], s37 offen offset:0 sc1 lds
    buffer_load_dwordx4 v0, s[4:7], s37 offen offset:1024 sc1 lds
    buffer_load_dwordx4 v0, s[4:7], s37 offen offset:2048 sc1 lds
    s_waitcnt vmcnt(0)
L_Os_have_9:
    s_waitcnt lgkmcnt(0)
    s_barrier
    s_add_u32 s23, s23, 1
    s_sub_u32 s30, 36864, s30
    s_branch L_Os_top
L_Os_top_end:
    s_waitcnt vmcnt(0)
    s_endpgm
L_Os_redfix_4:
    s_add_u32 s27, s36, 0
    buffer_load_dwordx4 v[168:171], v6, s[4:7], s27 offen sc1
    s_add_u32 s27, s36, 5120
    buffer_load_dwordx4 v[172:175], v6, s[4:7], s27 offen sc1
    s_add_u32 s27, s36, 10240
    buffer_load_dwordx4 v[176:179], v6, s[4:7], s27 offen sc1
    s_add_u32 s27, s36, 15360
    buffer_load_dwordx4 v[180:183], v6, s[4:7], s27 offen sc1
    s_add_u32 s27, s36, 20480
    buffer_load_dwordx4 v[184:187], v6, s[4:7], s27 offen sc1
    s_add_u32 s27, s36, 25600
    buffer_load_dwordx4 v[188:191], v6, s[4:7], s27 offen sc1
    s_add_u32 s27, s36, 30720
    buffer_load_dwordx4 v[192:195], v6, s[4:7], s27 offen sc1
    s_add_u32 s27, s36, 35840
    buffer_load_dwordx4 v[196:199], v6, s[4:7], s27 offen sc1
    s_add_u32 s27, s36, 0
    buffer_load_dwordx4 v[200:203], v7, s[4:7], s27 offen sc1
    s_add_u32 s27, s36, 20480
    buffer_load_dwordx4 v[204:207], v7, s[4:7], s27 offen sc1
    s_waitcnt vmcnt(0)
    s_add_u32 s19, s19, 1
    s_cmp_lt_u32 s19, 524288
    s_cbranch_scc1 L_Os_red_3
    s_branch L_fail
L_Os_redfix_6:
    s_add_u32 s27, s36, 0
    buffer_load_dwordx4 v[168:171], v6, s[4:7], s27 offen sc1
    s_add_u32 s27, s36, 5120
    buffer_load_dwordx4 v[172:175], v6, s[4:7], s27 offen sc1
    s_add_u32 s27, s36, 10240
    buffer_load_dwordx4 v[176:179], v6, s[4:7], s27 offen sc1
    s_add_u32 s27, s36, 15360
    buffer_load_dwordx4 v[180:183], v6, s[4:7], s27 offen sc1
    s_add_u32 s27, s36, 20480
    buffer_load_dwordx4 v[184:187], v6, s[4:7], s27 offen sc1
    s_add_u32 s27, s36, 25600
    buffer_load_dwordx4 v[188:191], v6, s[4:7], s27 offen sc1
    s_add_u32 s27, s36, 30720
    buffer_load_dwordx4 v[192:195], v6, s[4:7], s27 offen sc1
    s_add_u32 s27, s36, 35840
    buffer_load_dwordx4 v[196:199], v6, s[4:7], s27 offen sc1
    s_add_u32 s27, s36, 0
    buffer_load_dwordx4 v[200:203], v7, s[4:7], s27 offen sc1
    s_add_u32 s27, s36, 20480
    buffer_load_dwordx4 v[204:207], v7, s[4:7], s27 offen sc1
    s_add_u32 s19, s19, 1
    s_cmp_lt_u32 s19, 524288
    s_cbranch_scc1 L_Os_red_5
    s_branch L_fail
L_Os_flspin_11:
    buffer_load_dword v12, v10, s[4:7], s25 offen sc1
    s_add_u32 s19, s19, 1
    s_cmp_ge_u32 s19, 524288
    s_cbranch_scc1 L_fail
    s_waitcnt vmcnt(0)
    v_cmp_gt_u32 vcc, s29, v12
    s_nop 0
    s_cbranch_vccnz L_Os_flspin_11
    s_branch L_Os_fl_10
L_roleG:
    v_lshlrev_b32 v16, 4, v0
    s_sub_u32 s25, s13, 224
    s_lshr_b32 s20, s25, 4
    s_and_b32 s21, s25, 15
    s_lshl_b32 s23, s13, 2
    s_add_u32 s23, s23, s12
    s_lshl_b32 s23, s23, 7
    s_add_u32 s23, s23, 0
    v_mov_b32 v20, 0
    v_mov_b32 v21, 0
    v_mov_b32 v22, 0
    v_mov_b32 v23, 0
    s_mov_b64 exec, 1
    buffer_store_dwordx4 v[20:23], v16, s[4:7], s23 offen sc1
    s_lshl_b32 s14, s13, 7
    s_add_u32 s14, s14, 139264
    buffer_store_dwordx4 v[20:23], v16, s[4:7], s14 offen sc1
    s_mov_b64 exec, -1
    s_mul_i32 s32, s25, 40960
    s_add_u32 s32, s32, 214564864
    s_mul_i32 s26, s12, 10240
    s_add_u32 s26, s26, s32
    buffer_store_dwordx4 v[20:23], v16, s[4:7], s26 offen sc1
    s_add_u32 s26, s26, 1024
    buffer_store_dwordx4 v[20:23], v16, s[4:7], s26 offen sc1
    s_add_u32 s26, s26, 1024
    buffer_store_dwordx4 v[20:23], v16, s[4:7], s26 offen sc1
    s_add_u32 s26, s26, 1024
    buffer_store_dwordx4 v[20:23], v16, s[4:7], s26 offen sc1
    s_add_u32 s26, s26, 1024
    buffer_store_dwordx4 v[20:23], v16, s[4:7], s26 offen sc1
    s_add_u32 s26, s26, 1024
    buffer_store_dwordx4 v[20:23], v16, s[4:7], s26 offen sc1
    s_add_u32 s26, s26, 1024
    buffer_store_dwordx4 v[20:23], v16, s[4:7], s26 offen sc1
    s_add_u32 s26, s26, 1024
    buffer_store_dwordx4 v[20:23], v16, s[4:7], s26 offen sc1
    s_add_u32 s26, s26, 1024
    buffer_store_dwordx4 v[20:23], v16, s[4:7], s26 offen sc1
    s_add_u32 s26, s26, 1024
    buffer_store_dwordx4 v[20:23], v16, s[4:7], s26 offen sc1
    s_add_u32 s26, s26, 1301504
    buffer_store_dwordx4 v[20:23], v16, s[4:7], s26 offen sc1
    s_add_u32 s26, s26, 1024
    buffer_store_dwordx4 v[20:23], v16, s[4:7], s26 offen sc1
    s_add_u32 s26, s26, 1024
    buffer_store_dwordx4 v[20:23], v16, s[4:7], s26 offen sc1
    s_add_u32 s26, s26, 1024
    buffer_store_dwordx4 v[20:23], v16, s[4:7], s26 offen sc1
    s_add_u32 s26, s26, 1024
    buffer_store_dwordx4 v[20:23], v16, s[4:7], s26 offen sc1
    s_add_u32 s26, s26, 1024
    buffer_store_dwordx4 v[20:23], v16, s[4:7], s26 offen sc1
    s_add_u32 s26, s26, 1024
    buffer_store_dwordx4 v[20:23], v16, s[4:7], s26 offen sc1
    s_add_u32 s26, s26, 1024
    buffer_store_dwordx4 v[20:23], v16, s[4:7], s26 offen sc1
    s_add_u32 s26, s26, 1024
    buffer_store_dwordx4 v[20:23], v16, s[4:7], s26 offen sc1
    s_add_u32 s26, s26, 1024
    buffer_store_dwordx4 v[20:23], v16, s[4:7], s26 offen sc1
    s_add_u32 s26, s26, 1024
    s_and_b32 s3, s12, 1
    s_mul_i32 s3, s3, 40
    v_and_b32 v24, 15, v0
    v_lshrrev_b32 v25, 4, v0
    v_add_u32 v26, s3, v24
    v_mul_u32_u24 v5, 1280, v25
    v_lshl_add_u32 v5, v26, 4, v5
    v_and_b32 v27, 7, v0
    v_add3_u32 v27, v27, s3, 32
    v_lshrrev_b32 v6, 3, v0
    v_mul_u32_u24 v6, 1280, v6
    v_lshl_add_u32 v6, v27, 4, v6
    v_mov_b32 v28, 2147483632
    v_cmp_gt_u32 vcc, 16, v0
    s_nop 1
    v_cndmask_b32 v131, v28, v5, vcc
    v_cmp_gt_u32 vcc, 8, v0
    s_nop 1
    v_cndmask_b32 v124, v28, v6, vcc
    v_cmp_gt_u32 vcc, 32, v0
    v_cmp_gt_u32 s[44:45], 8, v24
    s_and_b64 s[44:45], s[44:45], vcc
    v_lshrrev_b32 v28, 5, v0
    v_lshl_add_u32 v26, v28, 4, v26
    v_and_b32 v25, 1, v25
    v_cmp_eq_u32 vcc, 0, v25
    s_nop 1
    v_cndmask_b32 v7, v27, v26, vcc
    v_lshlrev_b32 v7, 4, v7
    v_lshrrev_b32 v8, 2, v26
    v_lshlrev_b32 v8, 6, v8
    v_lshl_add_u32 v8, v25, 5, v8
    v_and_b32 v26, 3, v26
    v_lshl_add_u32 v8, v26, 3, v8
    v_lshrrev_b32 v125, 2, v27
    v_lshlrev_b32 v125, 6, v125
    v_lshl_add_u32 v125, v25, 5, v125
    v_and_b32 v27, 3, v27
    v_lshl_add_u32 v125, v27, 3, v125
    s_lshr_b32 s3, s12, 1
    s_mul_i32 s3, s3, 20480
    s_add_u32 s32, s32, s3
    s_mul_i32 s34, s12, 40960
    v_add_u32 v40, 0, v0
    v_mul_u32_u24 v41, 10923, v40
    v_lshrrev_b32 v41, 16, v41
    v_mul_u32_u24 v24, 6, v41
    v_sub_u32 v24, v40, v24
    v_lshrrev_b32 v24, 1, v24
    v_lshlrev_b32 v24, 4, v24
    v_mul_u32_u24 v41, 3072, v41
    v_add_u32 v24, v24, v41
    v_add_u32 v40, 64, v0
    v_mul_u32_u24 v41, 10923, v40
    v_lshrrev_b32 v41, 16, v41
    v_mul_u32_u24 v25, 6, v41
    v_sub_u32 v25, v40, v25
    v_lshrrev_b32 v25, 1, v25
    v_lshlrev_b32 v25, 4, v25
    v_mul_u32_u24 v41, 3072, v41
    v_add_u32 v25, v25, v41
    v_add_u32 v40, 128, v0
    v_mul_u32_u24 v41, 10923, v40
    v_lshrrev_b32 v41, 16, v41
    v_mul_u32_u24 v26, 6, v41
    v_sub_u32 v26, v40, v26
    v_lshrrev_b32 v26, 1, v26
    v_lshlrev_b32 v26, 4, v26
    v_mul_u32_u24 v41, 3072, v41
    v_add_u32 v26, v26, v41
    v_lshrrev_b32 v27, 2, v0
    v_mul_u32_u24 v27, 96, v27
    v_and_b32 v40, 3, v0
    v_lshl_add_u32 v27, v40, 3, v27
    v_add_u32 v27, s34, v27
    v_add_u32 v40, 0, v0
    v_mul_u32_u24 v41, 3277, v40
    v_lshrrev_b32 v41, 16, v41
    v_mul_u32_u24 v28, 20, v41
    v_sub_u32 v28, v40, v28
    v_lshrrev_b32 v28, 0, v28
    v_lshlrev_b32 v28, 4, v28
    v_mul_u32_u24 v41, 1280, v41
    v_add_u32 v28, v28, v41
    v_add_u32 v40, 64, v0
    v_mul_u32_u24 v41, 3277, v40
    v_lshrrev_b32 v41, 16, v41
    v_mul_u32_u24 v29, 20, v41
    v_sub_u32 v29, v40, v29
    v_lshrrev_b32 v29, 0, v29
    v_lshlrev_b32 v29, 4, v29
    v_mul_u32_u24 v41, 1280, v41
    v_add_u32 v29, v29, v41
    v_add_u32 v40, 128, v0
    v_mul_u32_u24 v41, 3277, v40
    v_lshrrev_b32 v41, 16, v41
    v_mul_u32_u24 v30, 20, v41
    v_sub_u32 v30, v40, v30
    v_lshrrev_b32 v30, 0, v30
    v_lshlrev_b32 v30, 4, v30
    v_mul_u32_u24 v41, 1280, v41
    v_add_u32 v30, v30, v41
    v_add_u32 v40, 192, v0
    v_mul_u32_u24 v41, 3277, v40
    v_lshrrev_b32 v41, 16, v41
    v_mul_u32_u24 v31, 20, v41
    v_sub_u32 v31, v40, v31
    v_lshrrev_b32 v31, 0, v31
    v_lshlrev_b32 v31, 4, v31
    v_mul_u32_u24 v41, 1280, v41
    v_add_u32 v31, v31, v41
    v_add_u32 v40, 256, v0
    v_mul_u32_u24 v41, 3277, v40
    v_lshrrev_b32 v41, 16, v41
    v_mul_u32_u24 v32, 20, v41
    v_sub_u32 v32, v40, v32
    v_lshrrev_b32 v32, 0, v32
    v_lshlrev_b32 v32, 4, v32
    v_mul_u32_u24 v41, 1280, v41
    v_add_u32 v32, v32, v41
    v_add_u32 v40, 320, v0
    v_mul_u32_u24 v41, 3277, v40
    v_lshrrev_b32 v41, 16, v41
    v_mul_u32_u24 v33, 20, v41
    v_sub_u32 v33, v40, v33
    v_lshrrev_b32 v33, 0, v33
    v_lshlrev_b32 v33, 4, v33
    v_mul_u32_u24 v41, 1280, v41
    v_add_u32 v33, v33, v41
    v_add_u32 v40, 384, v0
    v_mul_u32_u24 v41, 3277, v40
    v_lshrrev_b32 v41, 16, v41
    v_mul_u32_u24 v34, 20, v41
    v_sub_u32 v34, v40, v34
    v_lshrrev_b32 v34, 0, v34
    v_lshlrev_b32 v34, 4, v34
    v_mul_u32_u24 v41, 1280, v41
    v_add_u32 v34, v34, v41
    v_add_u32 v40, 448, v0
    v_mul_u32_u24 v41, 3277, v40
    v_lshrrev_b32 v41, 16, v41
    v_mul_u32_u24 v35, 20, v41
    v_sub_u32 v35, v40, v35
    v_lshrrev_b32 v35, 0, v35
    v_lshlrev_b32 v35, 4, v35
    v_mul_u32_u24 v41, 1280, v41
    v_add_u32 v35, v35, v41
    v_add_u32 v40, 512, v0
    v_mul_u32_u24 v41, 3277, v40
    v_lshrrev_b32 v41, 16, v41
    v_mul_u32_u24 v36, 20, v41
    v_sub_u32 v36, v40, v36
    v_lshrrev_b32 v36, 0, v36
    v_lshlrev_b32 v36, 4, v36
    v_mul_u32_u24 v41, 1280, v41
    v_add_u32 v36, v36, v41
    v_add_u32 v40, 576, v0
    v_mul_u32_u24 v41, 3277, v40
    v_lshrrev_b32 v41, 16, v41
    v_mul_u32_u24 v37, 20, v41
    v_sub_u32 v37, v40, v37
    v_lshrrev_b32 v37, 0, v37
    v_lshlrev_b32 v37, 4, v37
    v_mul_u32_u24 v41, 1280, v41
    v_add_u32 v37, v37, v41
    v_lshrrev_b32 v38, 2, v0
    v_mul_u32_u24 v38, 320, v38
    v_and_b32 v40, 3, v0
    v_lshl_add_u32 v38, v40, 3, v38
    v_add_u32 v38, s34, v38
    s_mov_b32 s8, s80
    s_and_b32 s9, s81, 0xffff
    s_mov_b32 s10, 1966080
    s_mov_b32 s11, 0x20000
    s_mov_b32 s48, s82
    s_and_b32 s49, s83, 0xffff
    s_mov_b32 s50, 1966080
    s_mov_b32 s51, 0x20000
    s_mov_b32 s92, s84
    s_and_b32 s93, s85, 0xffff
    s_mov_b32 s94, 1966080
    s_mov_b32 s95, 0x20000
    s_mul_i32 s96, s21, 192
    s_mul_i32 s26, s12, 48
    s_add_u32 s96, s96, s26
    s_mul_i32 s97, s21, 122880
    s_mul_i32 s25, s12, 320
    s_add_u32 s97, s97, s25
    s_add_u32 m0, s34, 0
    s_mov_b32 exec_lo, 1431655765
    s_mov_b32 exec_hi, 1431655765
    buffer_load_dwordx4 v24, s[8:11], s96 offen lds
    s_mov_b32 exec_lo, 2863311530
    s_mov_b32 exec_hi, 2863311530
    buffer_load_dwordx4 v24, s[48:51], s96 offen lds
    s_mov_b64 exec, -1
    s_add_u32 m0, s34, 1024
    s_mov_b32 exec_lo, 1431655765
    s_mov_b32 exec_hi, 1431655765
    buffer_load_dwordx4 v25, s[8:11], s96 offen lds
    s_mov_b32 exec_lo, 2863311530
    s_mov_b32 exec_hi, 2863311530
    buffer_load_dwordx4 v25, s[48:51], s96 offen lds
    s_mov_b64 exec, -1
    s_add_u32 m0, s34, 2048
    s_mov_b32 exec_lo, 1431655765
    s_mov_b32 exec_hi, 1431655765
    buffer_load_dwordx4 v26, s[8:11], s96 offen lds
    s_mov_b32 exec_lo, 2863311530
    s_mov_b32 exec_hi, 2863311530
    buffer_load_dwordx4 v26, s[48:51], s96 offen lds
    s_mov_b64 exec, -1
    s_add_u32 s96, s96, 98304
    s_add_u32 m0, s34, 3072
    s_mov_b32 exec_lo, 1431655765
    s_mov_b32 exec_hi, 1431655765
    buffer_load_dwordx4 v24, s[8:11], s96 offen lds
    s_mov_b32 exec_lo, 2863311530
    s_mov_b32 exec_hi, 2863311530
    buffer_load_dwordx4 v24, s[48:51], s96 offen lds
    s_mov_b64 exec, -1
    s_add_u32 m0, s34, 4096
    s_mov_b32 exec_lo, 1431655765
    s_mov_b32 exec_hi, 1431655765
    buffer_load_dwordx4 v25, s[8:11], s96 offen lds
    s_mov_b32 exec_lo, 2863311530
    s_mov_b32 exec_hi, 2863311530
    buffer_load_dwordx4 v25, s[48:51], s96 offen lds
    s_mov_b64 exec, -1
    s_add_u32 m0, s34, 5120
    s_mov_b32 exec_lo, 1431655765
    s_mov_b32 exec_hi, 1431655765
    buffer_load_dwordx4 v26, s[8:11], s96 offen lds
    s_mov_b32 exec_lo, 2863311530
    s_mov_b32 exec_hi, 2863311530
    buffer_load_dwordx4 v26, s[48:51], s96 offen lds
    s_mov_b64 exec, -1
    s_add_u32 s96, s96, 98304
    s_add_u32 m0, s34, 6144
    s_mov_b32 exec_lo, 1431655765
    s_mov_b32 exec_hi, 1431655765
    buffer_load_dwordx4 v24, s[8:11], s96 offen lds
    s_mov_b32 exec_lo, 2863311530
    s_mov_b32 exec_hi, 2863311530
    buffer_load_dwordx4 v24, s[48:51], s96 offen lds
    s_mov_b64 exec, -1
    s_add_u32 m0, s34, 7168
    s_mov_b32 exec_lo, 1431655765
    s_mov_b32 exec_hi, 1431655765
    buffer_load_dwordx4 v25, s[8:11], s96 offen lds
    s_mov_b32 exec_lo, 2863311530
    s_mov_b32 exec_hi, 2863311530
    buffer_load_dwordx4 v25, s[48:51], s96 offen lds
    s_mov_b64 exec, -1
    s_add_u32 m0, s34, 8192
    s_mov_b32 exec_lo, 1431655765
    s_mov_b32 exec_hi, 1431655765
    buffer_load_dwordx4 v26, s[8:11], s96 offen lds
    s_mov_b32 exec_lo, 2863311530
    s_mov_b32 exec_hi, 2863311530
    buffer_load_dwordx4 v26, s[48:51], s96 offen lds
    s_mov_b64 exec, -1
    s_add_u32 s96, s96, 98304
    s_add_u32 m0, s34, 9216
    s_mov_b32 exec_lo, 1431655765
    s_mov_b32 exec_hi, 1431655765
    buffer_load_dwordx4 v24, s[8:11], s96 offen lds
    s_mov_b32 exec_lo, 2863311530
    s_mov_b32 exec_hi, 2863311530
    buffer_load_dwordx4 v24, s[48:51], s96 offen lds
    s_mov_b64 exec, -1
    s_add_u32 m0, s34, 10240
    s_mov_b32 exec_lo, 1431655765
    s_mov_b32 exec_hi, 1431655765
    buffer_load_dwordx4 v25, s[8:11], s96 offen lds
    s_mov_b32 exec_lo, 2863311530
    s_mov_b32 exec_hi, 2863311530
    buffer_load_dwordx4 v25, s[48:51], s96 offen lds
    s_mov_b64 exec, -1
    s_add_u32 m0, s34, 11264
    s_mov_b32 exec_lo, 1431655765
    s_mov_b32 exec_hi, 1431655765
    buffer_load_dwordx4 v26, s[8:11], s96 offen lds
    s_mov_b32 exec_lo, 2863311530
    s_mov_b32 exec_hi, 2863311530
    buffer_load_dwordx4 v26, s[48:51], s96 offen lds
    s_mov_b64 exec, -1
    s_add_u32 s96, s96, 98304
    s_add_u32 m0, s34, 12288
    s_mov_b32 exec_lo, 1431655765
    s_mov_b32 exec_hi, 1431655765
    buffer_load_dwordx4 v24, s[8:11], s96 offen lds
    s_mov_b32 exec_lo, 2863311530
    s_mov_b32 exec_hi, 2863311530
    buffer_load_dwordx4 v24, s[48:51], s96 offen lds
    s_mov_b64 exec, -1
    s_add_u32 m0, s34, 13312
    s_mov_b32 exec_lo, 1431655765
    s_mov_b32 exec_hi, 1431655765
    buffer_load_dwordx4 v25, s[8:11], s96 offen lds
    s_mov_b32 exec_lo, 2863311530
    s_mov_b32 exec_hi, 2863311530
    buffer_load_dwordx4 v25, s[48:51], s96 offen lds
    s_mov_b64 exec, -1
    s_add_u32 m0, s34, 14336
    s_mov_b32 exec_lo, 1431655765
    s_mov_b32 exec_hi, 1431655765
    buffer_load_dwordx4 v26, s[8:11], s96 offen lds
    s_mov_b32 exec_lo, 2863311530
    s_mov_b32 exec_hi, 2863311530
    buffer_load_dwordx4 v26, s[48:51], s96 offen lds
    s_mov_b64 exec, -1
    s_add_u32 s96, s96, 98304
    s_add_u32 m0, s34, 15360
    s_mov_b32 exec_lo, 1431655765
    s_mov_b32 exec_hi, 1431655765
    buffer_load_dwordx4 v24, s[8:11], s96 offen lds
    s_mov_b32 exec_lo, 2863311530
    s_mov_b32 exec_hi, 2863311530
    buffer_load_dwordx4 v24, s[48:51], s96 offen lds
    s_mov_b64 exec, -1
    s_add_u32 m0, s34, 16384
    s_mov_b32 exec_lo, 1431655765
    s_mov_b32 exec_hi, 1431655765
    buffer_load_dwordx4 v25, s[8:11], s96 offen lds
    s_mov_b32 exec_lo, 2863311530
    s_mov_b32 exec_hi, 2863311530
    buffer_load_dwordx4 v25, s[48:51], s96 offen lds
    s_mov_b64 exec, -1
    s_add_u32 m0, s34, 17408
    s_mov_b32 exec_lo, 1431655765
    s_mov_b32 exec_hi, 1431655765
    buffer_load_dwordx4 v26, s[8:11], s96 offen lds
    s_mov_b32 exec_lo, 2863311530
    s_mov_b32 exec_hi, 2863311530
    buffer_load_dwordx4 v26, s[48:51], s96 offen lds
    s_mov_b64 exec, -1
    s_waitcnt vmcnt(30)
    s_barrier
    s_cmp_lg_u32 s12, 0
    s_cbranch_scc1 L_G_arr_1
    s_lshl_b32 s3, s18, 2
    s_add_u32 s3, s3, 64
    v_mov_b32 v92, s3
    v_mov_b32 v93, 1
    s_mov_b64 exec, 1
    global_atomic_add v92, v93, s[16:17] sc1
    s_waitcnt vmcnt(0)
    s_mov_b64 exec, -1
L_G_arr_1:
    ds_read_b64_tr_b16 a[0:1], v27 offset:0
    ds_read_b64_tr_b16 a[2:3], v27 offset:1536
    ds_read_b64_tr_b16 a[80:81], v27 offset:32
    ds_read_b64_tr_b16 a[82:83], v27 offset:1568
    ds_read_b64_tr_b16 a[160:161], v27 offset:64
    ds_read_b64_tr_b16 a[162:163], v27 offset:1600
    s_waitcnt lgkmcnt(0)
    s_add_u32 s96, s96, 98304
    s_add_u32 m0, s34, 18432
    s_mov_b32 exec_lo, 1431655765
    s_mov_b32 exec_hi, 1431655765
    buffer_load_dwordx4 v24, s[8:11], s96 offen lds
    s_mov_b32 exec_lo, 2863311530
    s_mov_b32 exec_hi, 2863311530
    buffer_load_dwordx4 v24, s[48:51], s96 offen lds
    s_mov_b64 exec, -1
    s_add_u32 m0, s34, 19456
    s_mov_b32 exec_lo, 1431655765
    s_mov_b32 exec_hi, 1431655765
    buffer_load_dwordx4 v25, s[8:11], s96 offen lds
    s_mov_b32 exec_lo, 2863311530
    s_mov_b32 exec_hi, 2863311530
    buffer_load_dwordx4 v25, s[48:51], s96 offen lds
    s_mov_b64 exec, -1
    s_add_u32 m0, s34, 20480
    s_mov_b32 exec_lo, 1431655765
    s_mov_b32 exec_hi, 1431655765
    buffer_load_dwordx4 v26, s[8:11], s96 offen lds
    s_mov_b32 exec_lo, 2863311530
    s_mov_b32 exec_hi, 2863311530
    buffer_load_dwordx4 v26, s[48:51], s96 offen lds
    s_mov_b64 exec, -1
    s_add_u32 s96, s96, 98304
    s_add_u32 m0, s34, 21504
    s_mov_b32 exec_lo, 1431655765
    s_mov_b32 exec_hi, 1431655765
    buffer_load_dwordx4 v24, s[8:11], s96 offen lds
    s_mov_b32 exec_lo, 2863311530
    s_mov_b32 exec_hi, 2863311530
    buffer_load_dwordx4 v24, s[48:51], s96 offen lds
    s_mov_b64 exec, -1
    s_add_u32 m0, s34, 22528
    s_mov_b32 exec_lo, 1431655765
    s_mov_b32 exec_hi, 1431655765
    buffer_load_dwordx4 v25, s[8:11], s96 offen lds
    s_mov_b32 exec_lo, 2863311530
    s_mov_b32 exec_hi, 2863311530
    buffer_load_dwordx4 v25, s[48:51], s96 offen lds
    s_mov_b64 exec, -1
    s_add_u32 m0, s34, 23552
    s_mov_b32 exec_lo, 1431655765
    s_mov_b32 exec_hi, 1431655765
    buffer_load_dwordx4 v26, s[8:11], s96 offen lds
    s_mov_b32 exec_lo, 2863311530
    s_mov_b32 exec_hi, 2863311530
    buffer_load_dwordx4 v26, s[48:51], s96 offen lds
    s_mov_b64 exec, -1
    s_add_u32 s96, s96, 98304
    s_add_u32 m0, s34, 24576
    s_mov_b32 exec_lo, 1431655765
    s_mov_b32 exec_hi, 1431655765
    buffer_load_dwordx4 v24, s[8:11], s96 offen lds
    s_mov_b32 exec_lo, 2863311530
    s_mov_b32 exec_hi, 2863311530
    buffer_load_dwordx4 v24, s[48:51], s96 offen lds
    s_mov_b64 exec, -1
    s_add_u32 m0, s34, 25600
    s_mov_b32 exec_lo, 1431655765
    s_mov_b32 exec_hi, 1431655765
    buffer_load_dwordx4 v25, s[8:11], s96 offen lds
    s_mov_b32 exec_lo, 2863311530
    s_mov_b32 exec_hi, 2863311530
    buffer_load_dwordx4 v25, s[48:51], s96 offen lds
    s_mov_b64 exec, -1
    s_add_u32 m0, s34, 26624
    s_mov_b32 exec_lo, 1431655765
    s_mov_b32 exec_hi, 1431655765
    buffer_load_dwordx4 v26, s[8:11], s96 offen lds
    s_mov_b32 exec_lo, 2863311530
    s_mov_b32 exec_hi, 2863311530
    buffer_load_dwordx4 v26, s[48:51], s96 offen lds
    s_mov_b64 exec, -1
    s_add_u32 s96, s96, 98304
    s_add_u32 m0, s34, 27648
    s_mov_b32 exec_lo, 1431655765
    s_mov_b32 exec_hi, 1431655765
    buffer_load_dwordx4 v24, s[8:11], s96 offen lds
    s_mov_b32 exec_lo, 2863311530
    s_mov_b32 exec_hi, 2863311530
    buffer_load_dwordx4 v24, s[48:51], s96 offen lds
    s_mov_b64 exec, -1
    s_add_u32 m0, s34, 28672
    s_mov_b32 exec_lo, 1431655765
    s_mov_b32 exec_hi, 1431655765
    buffer_load_dwordx4 v25, s[8:11], s96 offen lds
    s_mov_b32 exec_lo, 2863311530
    s_mov_b32 exec_hi, 2863311530
    buffer_load_dwordx4 v25, s[48:51], s96 offen lds
    s_mov_b64 exec, -1
    s_add_u32 m0, s34, 29696
    s_mov_b32 exec_lo, 1431655765
    s_mov_b32 exec_hi, 1431655765
    buffer_load_dwordx4 v26, s[8:11], s96 offen lds
    s_mov_b32 exec_lo, 2863311530
    s_mov_b32 exec_hi, 2863311530
    buffer_load_dwordx4 v26, s[48:51], s96 offen lds
    s_mov_b64 exec, -1
    s_add_u32 s96, s96, 98304
    s_add_u32 m0, s34, 0
    s_mov_b32 exec_lo, 1431655765
    s_mov_b32 exec_hi, 1431655765
    buffer_load_dwordx4 v24, s[8:11], s96 offen lds
    s_mov_b32 exec_lo, 2863311530
    s_mov_b32 exec_hi, 2863311530
    buffer_load_dwordx4 v24, s[48:51], s96 offen lds
    s_mov_b64 exec, -1
    s_add_u32 m0, s34, 1024
    s_mov_b32 exec_lo, 1431655765
    s_mov_b32 exec_hi, 1431655765
    buffer_load_dwordx4 v25, s[8:11], s96 offen lds
    s_mov_b32 exec_lo, 2863311530
    s_mov_b32 exec_hi, 2863311530
    buffer_load_dwordx4 v25, s[48:51], s96 offen lds
    s_mov_b64 exec, -1
    s_add_u32 m0, s34, 2048
    s_mov_b32 exec_lo, 1431655765
    s_mov_b32 exec_hi, 1431655765
    buffer_load_dwordx4 v26, s[8:11], s96 offen lds
    s_mov_b32 exec_lo, 2863311530
    s_mov_b32 exec_hi, 2863311530
    buffer_load_dwordx4 v26, s[48:51], s96 offen lds
    s_mov_b64 exec, -1
    s_waitcnt vmcnt(54)
    ds_read_b64_tr_b16 a[4:5], v27 offset:3072
    ds_read_b64_tr_b16 a[6:7], v27 offset:4608
    ds_read_b64_tr_b16 a[84:85], v27 offset:3104
    ds_read_b64_tr_b16 a[86:87], v27 offset:4640
    ds_read_b64_tr_b16 a[164:165], v27 offset:3136
    ds_read_b64_tr_b16 a[166:167], v27 offset:4672
    s_waitcnt lgkmcnt(0)
    s_add_u32 s96, s96, 98304
    s_add_u32 m0, s34, 3072
    s_mov_b32 exec_lo, 1431655765
    s_mov_b32 exec_hi, 1431655765
    buffer_load_dwordx4 v24, s[8:11], s96 offen lds
    s_mov_b32 exec_lo, 2863311530
    s_mov_b32 exec_hi, 2863311530
    buffer_load_dwordx4 v24, s[48:51], s96 offen lds
    s_mov_b64 exec, -1
    s_add_u32 m0, s34, 4096
    s_mov_b32 exec_lo, 1431655765
    s_mov_b32 exec_hi, 1431655765
    buffer_load_dwordx4 v25, s[8:11], s96 offen lds
    s_mov_b32 exec_lo, 2863311530
    s_mov_b32 exec_hi, 2863311530
    buffer_load_dwordx4 v25, s[48:51], s96 offen lds
    s_mov_b64 exec, -1
    s_add_u32 m0, s34, 5120
    s_mov_b32 exec_lo, 1431655765
    s_mov_b32 exec_hi, 1431655765
    buffer_load_dwordx4 v26, s[8:11], s96 offen lds
    s_mov_b32 exec_lo, 2863311530
    s_mov_b32 exec_hi, 2863311530
    buffer_load_dwordx4 v26, s[48:51], s96 offen lds
    s_mov_b64 exec, -1
    s_waitcnt vmcnt(54)
    ds_read_b64_tr_b16 a[8:9], v27 offset:6144
    ds_read_b64_tr_b16 a[10:11], v27 offset:7680
    ds_read_b64_tr_b16 a[88:89], v27 offset:6176
    ds_read_b64_tr_b16 a[90:91], v27 offset:7712
    ds_read_b64_tr_b16 a[168:169], v27 offset:6208
    ds_read_b64_tr_b16 a[170:171], v27 offset:7744
    s_waitcnt lgkmcnt(0)
    s_add_u32 s96, s96, 98304
    s_add_u32 m0, s34, 6144
    s_mov_b32 exec_lo, 1431655765
    s_mov_b32 exec_hi, 1431655765
    buffer_load_dwordx4 v24, s[8:11], s96 offen lds
    s_mov_b32 exec_lo, 2863311530
    s_mov_b32 exec_hi, 2863311530
    buffer_load_dwordx4 v24, s[48:51], s96 offen lds
    s_mov_b64 exec, -1
    s_add_u32 m0, s34, 7168
    s_mov_b32 exec_lo, 1431655765
    s_mov_b32 exec_hi, 1431655765
    buffer_load_dwordx4 v25, s[8:11], s96 offen lds
    s_mov_b32 exec_lo, 2863311530
    s_mov_b32 exec_hi, 2863311530
    buffer_load_dwordx4 v25, s[48:51], s96 offen lds
    s_mov_b64 exec, -1
    s_add_u32 m0, s34, 8192
    s_mov_b32 exec_lo, 1431655765
    s_mov_b32 exec_hi, 1431655765
    buffer_load_dwordx4 v26, s[8:11], s96 offen lds
    s_mov_b32 exec_lo, 2863311530
    s_mov_b32 exec_hi, 2863311530
    buffer_load_dwordx4 v26, s[48:51], s96 offen lds
    s_mov_b64 exec, -1
    s_waitcnt vmcnt(54)
    ds_read_b64_tr_b16 a[12:13], v27 offset:9216
    ds_read_b64_tr_b16 a[14:15], v27 offset:10752
    ds_read_b64_tr_b16 a[92:93], v27 offset:9248
    ds_read_b64_tr_b16 a[94:95], v27 offset:10784
    ds_read_b64_tr_b16 a[172:173], v27 offset:9280
    ds_read_b64_tr_b16 a[174:175], v27 offset:10816
    s_waitcnt lgkmcnt(0)
    s_add_u32 s96, s96, 98304
    s_add_u32 m0, s34, 9216
    s_mov_b32 exec_lo, 1431655765
    s_mov_b32 exec_hi, 1431655765
    buffer_load_dwordx4 v24, s[8:11], s96 offen lds
    s_mov_b32 exec_lo, 2863311530
    s_mov_b32 exec_hi, 2863311530
    buffer_load_dwordx4 v24, s[48:51], s96 offen lds
    s_mov_b64 exec, -1
    s_add_u32 m0, s34, 10240
    s_mov_b32 exec_lo, 1431655765
    s_mov_b32 exec_hi, 1431655765
    buffer_load_dwordx4 v25, s[8:11], s96 offen lds
    s_mov_b32 exec_lo, 2863311530
    s_mov_b32 exec_hi, 2863311530
    buffer_load_dwordx4 v25, s[48:51], s96 offen lds
    s_mov_b64 exec, -1
    s_add_u32 m0, s34, 11264
    s_mov_b32 exec_lo, 1431655765
    s_mov_b32 exec_hi, 1431655765
    buffer_load_dwordx4 v26, s[8:11], s96 offen lds
    s_mov_b32 exec_lo, 2863311530
    s_mov_b32 exec_hi, 2863311530
    buffer_load_dwordx4 v26, s[48:51], s96 offen lds
    s_mov_b64 exec, -1
    s_waitcnt vmcnt(54)
    ds_read_b64_tr_b16 a[16:17], v27 offset:12288
    ds_read_b64_tr_b16 a[18:19], v27 offset:13824
    ds_read_b64_tr_b16 a[96:97], v27 offset:12320
    ds_read_b64_tr_b16 a[98:99], v27 offset:13856
    ds_read_b64_tr_b16 a[176:177], v27 offset:12352
    ds_read_b64_tr_b16 a[178:179], v27 offset:13888
    s_waitcnt lgkmcnt(0)
    s_add_u32 s96, s96, 98304
    s_add_u32 m0, s34, 12288
    s_mov_b32 exec_lo, 1431655765
    s_mov_b32 exec_hi, 1431655765
    buffer_load_dwordx4 v24, s[8:11], s96 offen lds
    s_mov_b32 exec_lo, 2863311530
    s_mov_b32 exec_hi, 2863311530
    buffer_load_dwordx4 v24, s[48:51], s96 offen lds
    s_mov_b64 exec, -1
    s_add_u32 m0, s34, 13312
    s_mov_b32 exec_lo, 1431655765
    s_mov_b32 exec_hi, 1431655765
    buffer_load_dwordx4 v25, s[8:11], s96 offen lds
    s_mov_b32 exec_lo, 2863311530
    s_mov_b32 exec_hi, 2863311530
    buffer_load_dwordx4 v25, s[48:51], s96 offen lds
    s_mov_b64 exec, -1
    s_add_u32 m0, s34, 14336
    s_mov_b32 exec_lo, 1431655765
    s_mov_b32 exec_hi, 1431655765
    buffer_load_dwordx4 v26, s[8:11], s96 offen lds
    s_mov_b32 exec_lo, 2863311530
    s_mov_b32 exec_hi, 2863311530
    buffer_load_dwordx4 v26, s[48:51], s96 offen lds
    s_mov_b64 exec, -1
    s_waitcnt vmcnt(54)
    ds_read_b64_tr_b16 a[20:21], v27 offset:15360
    ds_read_b64_tr_b16 a[22:23], v27 offset:16896
    ds_read_b64_tr_b16 a[100:101], v27 offset:15392
    ds_read_b64_tr_b16 a[102:103], v27 offset:16928
    ds_read_b64_tr_b16 a[180:181], v27 offset:15424
    ds_read_b64_tr_b16 a[182:183], v27 offset:16960
    s_waitcnt lgkmcnt(0)
    s_add_u32 s96, s96, 98304
    s_add_u32 m0, s34, 15360
    s_mov_b32 exec_lo, 1431655765
    s_mov_b32 exec_hi, 1431655765
    buffer_load_dwordx4 v24, s[8:11], s96 offen lds
    s_mov_b32 exec_lo, 2863311530
    s_mov_b32 exec_hi, 2863311530
    buffer_load_dwordx4 v24, s[48:51], s96 offen lds
    s_mov_b64 exec, -1
    s_add_u32 m0, s34, 16384
    s_mov_b32 exec_lo, 1431655765
    s_mov_b32 exec_hi, 1431655765
    buffer_load_dwordx4 v25, s[8:11], s96 offen lds
    s_mov_b32 exec_lo, 2863311530
    s_mov_b32 exec_hi, 2863311530
    buffer_load_dwordx4 v25, s[48:51], s96 offen lds
    s_mov_b64 exec, -1
    s_add_u32 m0, s34, 17408
    s_mov_b32 exec_lo, 1431655765
    s_mov_b32 exec_hi, 1431655765
    buffer_load_dwordx4 v26, s[8:11], s96 offen lds
    s_mov_b32 exec_lo, 2863311530
    s_mov_b32 exec_hi, 2863311530
    buffer_load_dwordx4 v26, s[48:51], s96 offen lds
    s_mov_b64 exec, -1
    s_waitcnt vmcnt(54)
    ds_read_b64_tr_b16 a[24:25], v27 offset:18432
    ds_read_b64_tr_b16 a[26:27], v27 offset:19968
    ds_read_b64_tr_b16 a[104:105], v27 offset:18464
    ds_read_b64_tr_b16 a[106:107], v27 offset:20000
    ds_read_b64_tr_b16 a[184:185], v27 offset:18496
    ds_read_b64_tr_b16 a[186:187], v27 offset:20032
    s_waitcnt lgkmcnt(0)
    s_add_u32 s96, s96, 98304
    s_add_u32 m0, s34, 18432
    s_mov_b32 exec_lo, 1431655765
    s_mov_b32 exec_hi, 1431655765
    buffer_load_dwordx4 v24, s[8:11], s96 offen lds
    s_mov_b32 exec_lo, 2863311530
    s_mov_b32 exec_hi, 2863311530
    buffer_load_dwordx4 v24, s[48:51], s96 offen lds
    s_mov_b64 exec, -1
    s_add_u32 m0, s34, 19456
    s_mov_b32 exec_lo, 1431655765
    s_mov_b32 exec_hi, 1431655765
    buffer_load_dwordx4 v25, s[8:11], s96 offen lds
    s_mov_b32 exec_lo, 2863311530
    s_mov_b32 exec_hi, 2863311530
    buffer_load_dwordx4 v25, s[48:51], s96 offen lds
    s_mov_b64 exec, -1
    s_add_u32 m0, s34, 20480
    s_mov_b32 exec_lo, 1431655765
    s_mov_b32 exec_hi, 1431655765
    buffer_load_dwordx4 v26, s[8:11], s96 offen lds
    s_mov_b32 exec_lo, 2863311530
    s_mov_b32 exec_hi, 2863311530
    buffer_load_dwordx4 v26, s[48:51], s96 offen lds
    s_mov_b64 exec, -1
    s_waitcnt vmcnt(54)
    ds_read_b64_tr_b16 a[28:29], v27 offset:21504
    ds_read_b64_tr_b16 a[30:31], v27 offset:23040
    ds_read_b64_tr_b16 a[108:109], v27 offset:21536
    ds_read_b64_tr_b16 a[110:111], v27 offset:23072
    ds_read_b64_tr_b16 a[188:189], v27 offset:21568
    ds_read_b64_tr_b16 a[190:191], v27 offset:23104
    s_waitcnt lgkmcnt(0)
    s_add_u32 s96, s96, 98304
    s_add_u32 m0, s34, 21504
    s_mov_b32 exec_lo, 1431655765
    s_mov_b32 exec_hi, 1431655765
    buffer_load_dwordx4 v24, s[8:11], s96 offen lds
    s_mov_b32 exec_lo, 2863311530
    s_mov_b32 exec_hi, 2863311530
    buffer_load_dwordx4 v24, s[48:51], s96 offen lds
    s_mov_b64 exec, -1
    s_add_u32 m0, s34, 22528
    s_mov_b32 exec_lo, 1431655765
    s_mov_b32 exec_hi, 1431655765
    buffer_load_dwordx4 v25, s[8:11], s96 offen lds
    s_mov_b32 exec_lo, 2863311530
    s_mov_b32 exec_hi, 2863311530
    buffer_load_dwordx4 v25, s[48:51], s96 offen lds
    s_mov_b64 exec, -1
    s_add_u32 m0, s34, 23552
    s_mov_b32 exec_lo, 1431655765
    s_mov_b32 exec_hi, 1431655765
    buffer_load_dwordx4 v26, s[8:11], s96 offen lds
    s_mov_b32 exec_lo, 2863311530
    s_mov_b32 exec_hi, 2863311530
    buffer_load_dwordx4 v26, s[48:51], s96 offen lds
    s_mov_b64 exec, -1
    s_waitcnt vmcnt(54)
    ds_read_b64_tr_b16 a[32:33], v27 offset:24576
    ds_read_b64_tr_b16 a[34:35], v27 offset:26112
    ds_read_b64_tr_b16 a[112:113], v27 offset:24608
    ds_read_b64_tr_b16 a[114:115], v27 offset:26144
    ds_read_b64_tr_b16 a[192:193], v27 offset:24640
    ds_read_b64_tr_b16 a[194:195], v27 offset:26176
    s_waitcnt lgkmcnt(0)
    s_add_u32 s96, s96, 98304
    s_add_u32 m0, s34, 24576
    s_mov_b32 exec_lo, 1431655765
    s_mov_b32 exec_hi, 1431655765
    buffer_load_dwordx4 v24, s[8:11], s96 offen lds
    s_mov_b32 exec_lo, 2863311530
    s_mov_b32 exec_hi, 2863311530
    buffer_load_dwordx4 v24, s[48:51], s96 offen lds
    s_mov_b64 exec, -1
    s_add_u32 m0, s34, 25600
    s_mov_b32 exec_lo, 1431655765
    s_mov_b32 exec_hi, 1431655765
    buffer_load_dwordx4 v25, s[8:11], s96 offen lds
    s_mov_b32 exec_lo, 2863311530
    s_mov_b32 exec_hi, 2863311530
    buffer_load_dwordx4 v25, s[48:51], s96 offen lds
    s_mov_b64 exec, -1
    s_add_u32 m0, s34, 26624
    s_mov_b32 exec_lo, 1431655765
    s_mov_b32 exec_hi, 1431655765
    buffer_load_dwordx4 v26, s[8:11], s96 offen lds
    s_mov_b32 exec_lo, 2863311530
    s_mov_b32 exec_hi, 2863311530
    buffer_load_dwordx4 v26, s[48:51], s96 offen lds
    s_mov_b64 exec, -1
    s_waitcnt vmcnt(54)
    ds_read_b64_tr_b16 a[36:37], v27 offset:27648
    ds_read_b64_tr_b16 a[38:39], v27 offset:29184
    ds_read_b64_tr_b16 a[116:117], v27 offset:27680
    ds_read_b64_tr_b16 a[118:119], v27 offset:29216
    ds_read_b64_tr_b16 a[196:197], v27 offset:27712
    ds_read_b64_tr_b16 a[198:199], v27 offset:29248
    s_waitcnt lgkmcnt(0)
    s_add_u32 s96, s96, 98304
    s_add_u32 m0, s34, 27648
    s_mov_b32 exec_lo, 1431655765
    s_mov_b32 exec_hi, 1431655765
    buffer_load_dwordx4 v24, s[8:11], s96 offen lds
    s_mov_b32 exec_lo, 2863311530
    s_mov_b32 exec_hi, 2863311530
    buffer_load_dwordx4 v24, s[48:51], s96 offen lds
    s_mov_b64 exec, -1
    s_add_u32 m0, s34, 28672
    s_mov_b32 exec_lo, 1431655765
    s_mov_b32 exec_hi, 1431655765
    buffer_load_dwordx4 v25, s[8:11], s96 offen lds
    s_mov_b32 exec_lo, 2863311530
    s_mov_b32 exec_hi, 2863311530
    buffer_load_dwordx4 v25, s[48:51], s96 offen lds
    s_mov_b64 exec, -1
    s_add_u32 m0, s34, 29696
    s_mov_b32 exec_lo, 1431655765
    s_mov_b32 exec_hi, 1431655765
    buffer_load_dwordx4 v26, s[8:11], s96 offen lds
    s_mov_b32 exec_lo, 2863311530
    s_mov_b32 exec_hi, 2863311530
    buffer_load_dwordx4 v26, s[48:51], s96 offen lds
    s_mov_b64 exec, -1
    s_waitcnt vmcnt(54)
    ds_read_b64_tr_b16 a[40:41], v27 offset:0
    ds_read_b64_tr_b16 a[42:43], v27 offset:1536
    ds_read_b64_tr_b16 a[120:121], v27 offset:32
    ds_read_b64_tr_b16 a[122:123], v27 offset:1568
    ds_read_b64_tr_b16 a[200:201], v27 offset:64
    ds_read_b64_tr_b16 a[202:203], v27 offset:1600
    s_waitcnt lgkmcnt(0)
    s_waitcnt vmcnt(48)
    ds_read_b64_tr_b16 a[44:45], v27 offset:3072
    ds_read_b64_tr_b16 a[46:47], v27 offset:4608
    ds_read_b64_tr_b16 a[124:125], v27 offset:3104
    ds_read_b64_tr_b16 a[126:127], v27 offset:4640
    ds_read_b64_tr_b16 a[204:205], v27 offset:3136
    ds_read_b64_tr_b16 a[206:207], v27 offset:4672
    s_waitcnt lgkmcnt(0)
    s_waitcnt vmcnt(42)
    ds_read_b64_tr_b16 a[48:49], v27 offset:6144
    ds_read_b64_tr_b16 a[50:51], v27 offset:7680
    ds_read_b64_tr_b16 a[128:129], v27 offset:6176
    ds_read_b64_tr_b16 a[130:131], v27 offset:7712
    ds_read_b64_tr_b16 a[208:209], v27 offset:6208
    ds_read_b64_tr_b16 a[210:211], v27 offset:7744
    s_waitcnt lgkmcnt(0)
    s_waitcnt vmcnt(36)
    ds_read_b64_tr_b16 a[52:53], v27 offset:9216
    ds_read_b64_tr_b16 a[54:55], v27 offset:10752
    ds_read_b64_tr_b16 a[132:133], v27 offset:9248
    ds_read_b64_tr_b16 a[134:135], v27 offset:10784
    ds_read_b64_tr_b16 a[212:213], v27 offset:9280
    ds_read_b64_tr_b16 a[214:215], v27 offset:10816
    s_waitcnt lgkmcnt(0)
    s_add_u32 m0, s34, 0
    s_nop 0
    buffer_load_dwordx4 v28, s[92:95], s97 offen lds
    s_add_u32 m0, s34, 1024
    s_nop 0
    buffer_load_dwordx4 v29, s[92:95], s97 offen lds
    s_add_u32 m0, s34, 2048
    s_nop 0
    buffer_load_dwordx4 v30, s[92:95], s97 offen lds
    s_add_u32 m0, s34, 3072
    s_nop 0
    buffer_load_dwordx4 v31, s[92:95], s97 offen lds
    s_add_u32 m0, s34, 4096
    s_nop 0
    buffer_load_dwordx4 v32, s[92:95], s97 offen lds
    s_add_u32 m0, s34, 5120
    s_nop 0
    buffer_load_dwordx4 v33, s[92:95], s97 offen lds
    s_add_u32 m0, s34, 6144
    s_nop 0
    buffer_load_dwordx4 v34, s[92:95], s97 offen lds
    s_add_u32 m0, s34, 7168
    s_nop 0
    buffer_load_dwordx4 v35, s[92:95], s97 offen lds
    s_add_u32 m0, s34, 8192
    s_nop 0
    buffer_load_dwordx4 v36, s[92:95], s97 offen lds
    s_add_u32 m0, s34, 9216
    s_nop 0
    buffer_load_dwordx4 v37, s[92:95], s97 offen lds
    s_waitcnt vmcnt(40)
    ds_read_b64_tr_b16 a[56:57], v27 offset:12288
    ds_read_b64_tr_b16 a[58:59], v27 offset:13824
    ds_read_b64_tr_b16 a[136:137], v27 offset:12320
    ds_read_b64_tr_b16 a[138:139], v27 offset:13856
    ds_read_b64_tr_b16 a[216:217], v27 offset:12352
    ds_read_b64_tr_b16 a[218:219], v27 offset:13888
    s_waitcnt lgkmcnt(0)
    s_waitcnt vmcnt(34)
    ds_read_b64_tr_b16 a[60:61], v27 offset:15360
    ds_read_b64_tr_b16 a[62:63], v27 offset:16896
    ds_read_b64_tr_b16 a[140:141], v27 offset:15392
    ds_read_b64_tr_b16 a[142:143], v27 offset:16928
    ds_read_b64_tr_b16 a[220:221], v27 offset:15424
    ds_read_b64_tr_b16 a[222:223], v27 offset:16960
    s_waitcnt lgkmcnt(0)
    s_waitcnt vmcnt(28)
    ds_read_b64_tr_b16 a[64:65], v27 offset:18432
    ds_read_b64_tr_b16 a[66:67], v27 offset:19968
    ds_read_b64_tr_b16 a[144:145], v27 offset:18464
    ds_read_b64_tr_b16 a[146:147], v27 offset:20000
    ds_read_b64_tr_b16 a[224:225], v27 offset:18496
    ds_read_b64_tr_b16 a[226:227], v27 offset:20032
    s_waitcnt lgkmcnt(0)
    s_add_u32 s97, s97, 40960
    s_add_u32 m0, s34, 10240
    s_nop 0
    buffer_load_dwordx4 v28, s[92:95], s97 offen lds
    s_add_u32 m0, s34, 11264
    s_nop 0
    buffer_load_dwordx4 v29, s[92:95], s97 offen lds
    s_add_u32 m0, s34, 12288
    s_nop 0
    buffer_load_dwordx4 v30, s[92:95], s97 offen lds
    s_add_u32 m0, s34, 13312
    s_nop 0
    buffer_load_dwordx4 v31, s[92:95], s97 offen lds
    s_add_u32 m0, s34, 14336
    s_nop 0
    buffer_load_dwordx4 v32, s[92:95], s97 offen lds
    s_add_u32 m0, s34, 15360
    s_nop 0
    buffer_load_dwordx4 v33, s[92:95], s97 offen lds
    s_add_u32 m0, s34, 16384
    s_nop 0
    buffer_load_dwordx4 v34, s[92:95], s97 offen lds
    s_add_u32 m0, s34, 17408
    s_nop 0
    buffer_load_dwordx4 v35, s[92:95], s97 offen lds
    s_add_u32 m0, s34, 18432
    s_nop 0
    buffer_load_dwordx4 v36, s[92:95], s97 offen lds
    s_add_u32 m0, s34, 19456
    s_nop 0
    buffer_load_dwordx4 v37, s[92:95], s97 offen lds
    s_waitcnt vmcnt(32)
    ds_read_b64_tr_b16 a[68:69], v27 offset:21504
    ds_read_b64_tr_b16 a[70:71], v27 offset:23040
    ds_read_b64_tr_b16 a[148:149], v27 offset:21536
    ds_read_b64_tr_b16 a[150:151], v27 offset:23072
    ds_read_b64_tr_b16 a[228:229], v27 offset:21568
    ds_read_b64_tr_b16 a[230:231], v27 offset:23104
    s_waitcnt lgkmcnt(0)
    s_waitcnt vmcnt(26)
    ds_read_b64_tr_b16 a[72:73], v27 offset:24576
    ds_read_b64_tr_b16 a[74:75], v27 offset:26112
    ds_read_b64_tr_b16 a[152:153], v27 offset:24608
    ds_read_b64_tr_b16 a[154:155], v27 offset:26144
    ds_read_b64_tr_b16 a[232:233], v27 offset:24640
    ds_read_b64_tr_b16 a[234:235], v27 offset:26176
    s_waitcnt lgkmcnt(0)
    s_waitcnt vmcnt(20)
    ds_read_b64_tr_b16 a[76:77], v27 offset:27648
    ds_read_b64_tr_b16 a[78:79], v27 offset:29184
    ds_read_b64_tr_b16 a[156:157], v27 offset:27680
    ds_read_b64_tr_b16 a[158:159], v27 offset:29216
    ds_read_b64_tr_b16 a[236:237], v27 offset:27712
    ds_read_b64_tr_b16 a[238:239], v27 offset:29248
    s_waitcnt lgkmcnt(0)
    s_add_u32 s97, s97, 40960
    s_add_u32 m0, s34, 20480
    s_nop 0
    buffer_load_dwordx4 v28, s[92:95], s97 offen lds
    s_add_u32 m0, s34, 21504
    s_nop 0
    buffer_load_dwordx4 v29, s[92:95], s97 offen lds
    s_add_u32 m0, s34, 22528
    s_nop 0
    buffer_load_dwordx4 v30, s[92:95], s97 offen lds
    s_add_u32 m0, s34, 23552
    s_nop 0
    buffer_load_dwordx4 v31, s[92:95], s97 offen lds
    s_add_u32 m0, s34, 24576
    s_nop 0
    buffer_load_dwordx4 v32, s[92:95], s97 offen lds
    s_add_u32 m0, s34, 25600
    s_nop 0
    buffer_load_dwordx4 v33, s[92:95], s97 offen lds
    s_add_u32 m0, s34, 26624
    s_nop 0
    buffer_load_dwordx4 v34, s[92:95], s97 offen lds
    s_add_u32 m0, s34, 27648
    s_nop 0
    buffer_load_dwordx4 v35, s[92:95], s97 offen lds
    s_add_u32 m0, s34, 28672
    s_nop 0
    buffer_load_dwordx4 v36, s[92:95], s97 offen lds
    s_add_u32 m0, s34, 29696
    s_nop 0
    buffer_load_dwordx4 v37, s[92:95], s97 offen lds
    s_waitcnt vmcnt(20)
    ds_read_b64_tr_b16 v[136:137], v38 offset:0
    ds_read_b64_tr_b16 v[138:139], v38 offset:5120
    ds_read_b64_tr_b16 v[148:149], v38 offset:32
    ds_read_b64_tr_b16 v[150:151], v38 offset:5152
    ds_read_b64_tr_b16 v[160:161], v38 offset:64
    ds_read_b64_tr_b16 v[162:163], v38 offset:5184
    ds_read_b64_tr_b16 v[172:173], v38 offset:96
    ds_read_b64_tr_b16 v[174:175], v38 offset:5216
    ds_read_b64_tr_b16 v[184:185], v38 offset:128
    ds_read_b64_tr_b16 v[186:187], v38 offset:5248
    ds_read_b64_tr_b16 v[196:197], v38 offset:160
    ds_read_b64_tr_b16 v[198:199], v38 offset:5280
    ds_read_b64_tr_b16 v[208:209], v38 offset:192
    ds_read_b64_tr_b16 v[210:211], v38 offset:5312
    ds_read_b64_tr_b16 v[220:221], v38 offset:224
    ds_read_b64_tr_b16 v[222:223], v38 offset:5344
    ds_read_b64_tr_b16 v[232:233], v38 offset:256
    ds_read_b64_tr_b16 v[234:235], v38 offset:5376
    ds_read_b64_tr_b16 v[244:245], v38 offset:288
    ds_read_b64_tr_b16 v[246:247], v38 offset:5408
    s_waitcnt lgkmcnt(0)
    s_waitcnt vmcnt(10)
    ds_read_b64_tr_b16 v[140:141], v38 offset:10240
    ds_read_b64_tr_b16 v[142:143], v38 offset:15360
    ds_read_b64_tr_b16 v[152:153], v38 offset:10272
    ds_read_b64_tr_b16 v[154:155], v38 offset:15392
    ds_read_b64_tr_b16 v[164:165], v38 offset:10304
    ds_read_b64_tr_b16 v[166:167], v38 offset:15424
    ds_read_b64_tr_b16 v[176:177], v38 offset:10336
    ds_read_b64_tr_b16 v[178:179], v38 offset:15456
    ds_read_b64_tr_b16 v[188:189], v38 offset:10368
    ds_read_b64_tr_b16 v[190:191], v38 offset:15488
    ds_read_b64_tr_b16 v[200:201], v38 offset:10400
    ds_read_b64_tr_b16 v[202:203], v38 offset:15520
    ds_read_b64_tr_b16 v[212:213], v38 offset:10432
    ds_read_b64_tr_b16 v[214:215], v38 offset:15552
    ds_read_b64_tr_b16 v[224:225], v38 offset:10464
    ds_read_b64_tr_b16 v[226:227], v38 offset:15584
    ds_read_b64_tr_b16 v[236:237], v38 offset:10496
    ds_read_b64_tr_b16 v[238:239], v38 offset:15616
    ds_read_b64_tr_b16 v[248:249], v38 offset:10528
    ds_read_b64_tr_b16 v[250:251], v38 offset:15648
    s_waitcnt lgkmcnt(0)
    s_waitcnt vmcnt(0)
    ds_read_b64_tr_b16 v[144:145], v38 offset:20480
    ds_read_b64_tr_b16 v[146:147], v38 offset:25600
    ds_read_b64_tr_b16 v[156:157], v38 offset:20512
    ds_read_b64_tr_b16 v[158:159], v38 offset:25632
    ds_read_b64_tr_b16 v[168:169], v38 offset:20544
    ds_read_b64_tr_b16 v[170:171], v38 offset:25664
    ds_read_b64_tr_b16 v[180:181], v38 offset:20576
    ds_read_b64_tr_b16 v[182:183], v38 offset:25696
    ds_read_b64_tr_b16 v[192:193], v38 offset:20608
    ds_read_b64_tr_b16 v[194:195], v38 offset:25728
    ds_read_b64_tr_b16 v[204:205], v38 offset:20640
    ds_read_b64_tr_b16 v[206:207], v38 offset:25760
    ds_read_b64_tr_b16 v[216:217], v38 offset:20672
    ds_read_b64_tr_b16 v[218:219], v38 offset:25792
    ds_read_b64_tr_b16 v[228:229], v38 offset:20704
    ds_read_b64_tr_b16 v[230:231], v38 offset:25824
    ds_read_b64_tr_b16 v[240:241], v38 offset:20736
    ds_read_b64_tr_b16 v[242:243], v38 offset:25856
    ds_read_b64_tr_b16 v[252:253], v38 offset:20768
    ds_read_b64_tr_b16 v[254:255], v38 offset:25888
    s_waitcnt lgkmcnt(0)
    v_and_b32 v24, 1, v0
    v_lshlrev_b32 v24, 4, v24
    v_mov_b32 v25, 0x3f80
    v_lshlrev_b32 v25, v24, v25
    v_bfe_u32 v24, v0, 1, 3
    v_cmp_eq_u32 vcc, 0, v24
    s_nop 1
    v_cndmask_b32 v26, 0, v25, vcc
    v_accvgpr_write_b32 a240, v26
    v_cmp_eq_u32 vcc, 4, v24
    s_nop 1
    v_cndmask_b32 v26, 0, v25, vcc
    v_accvgpr_write_b32 a244, v26
    v_cmp_eq_u32 vcc, 1, v24
    s_nop 1
    v_cndmask_b32 v26, 0, v25, vcc
    v_accvgpr_write_b32 a241, v26
    v_cmp_eq_u32 vcc, 5, v24
    s_nop 1
    v_cndmask_b32 v26, 0, v25, vcc
    v_accvgpr_write_b32 a245, v26
    v_cmp_eq_u32 vcc, 2, v24
    s_nop 1
    v_cndmask_b32 v26, 0, v25, vcc
    v_accvgpr_write_b32 a242, v26
    v_cmp_eq_u32 vcc, 6, v24
    s_nop 1
    v_cndmask_b32 v26, 0, v25, vcc
    v_accvgpr_write_b32 a246, v26
    v_cmp_eq_u32 vcc, 3, v24
    s_nop 1
    v_cndmask_b32 v26, 0, v25, vcc
    v_accvgpr_write_b32 a243, v26
    v_cmp_eq_u32 vcc, 7, v24
    s_nop 1
    v_cndmask_b32 v26, 0, v25, vcc
    v_accvgpr_write_b32 a247, v26
    s_mul_i32 s63, s12, 10240
    s_and_b32 s3, s12, 1
    s_lshl_b32 s3, s3, 2
    v_lshrrev_b32 v24, 3, v0
    v_mul_u32_u24 v1, 1280, v24
    v_lshrrev_b32 v24, 4, v0
    v_add_u32 v24, s3, v24
    v_and_b32 v25, 7, v0
    v_xor_b32 v24, v24, v25
    v_lshl_add_u32 v1, v24, 4, v1
    v_add_u32 v1, s63, v1
    v_bfe_u32 v24, v0, 3, 1
    v_mul_u32_u24 v2, 10240, v24
    v_lshl_add_u32 v2, v25, 7, v2
    v_bfe_u32 v24, v0, 1, 3
    v_lshrrev_b32 v25, 4, v0
    v_xor_b32 v24, v24, v25
    v_lshl_add_u32 v2, v24, 4, v2
    v_xor_b32 v3, 64, v2
    s_lshl_b32 s3, s12, 11
    s_add_u32 s3, s3, 7168
    v_bfe_u32 v24, v0, 1, 2
    v_lshrrev_b32 v25, 4, v0
    v_xor_b32 v24, v24, v25
    v_and_b32 v25, 15, v0
    v_lshl_add_u32 v24, v25, 2, v24
    v_lshl_add_u32 v126, v24, 4, s3
    v_lshl_add_u32 v127, v0, 4, s3
    v_bfe_u32 v24, v0, 3, 2
    v_and_b32 v25, 3, v0
    v_xor_b32 v24, v24, v25
    v_lshrrev_b32 v25, 2, v0
    s_mov_b32 s3, 20480
    v_mul_lo_u32 v4, v25, s3
    v_lshl_add_u32 v4, v24, 4, v4
    s_mul_i32 s3, s12, 320
    v_add_u32 v4, s3, v4
    s_mov_b32 s92, s86
    s_and_b32 s93, s87, 0xffff
    s_mov_b32 s94, 2621440
    s_mov_b32 s95, 0x20000
    v_and_b32 v24, 15, v0
    v_lshrrev_b32 v25, 4, v0
    s_mul_i32 s30, s20, 655360
    s_mul_i32 s3, s21, 1280
    s_add_u32 s30, s30, s3
    s_add_u32 s30, s30, 214564864
    s_add_u32 s31, s30, 327680
    s_mov_b32 s39, 1310720
    v_and_b32 v9, 31, v0
    v_lshlrev_b32 v9, 9, v9
    s_lshl_b32 s24, s20, 14
    s_add_u32 s24, s24, 81920
    v_lshrrev_b32 v26, 5, v0
    v_mul_u32_u24 v26, 3072, v26
    v_lshl_add_u32 v26, v24, 4, v26
    v_and_b32 v27, 1, v25
    v_lshl_add_u32 v26, v27, 8, v26
    v_add_u32 v26, 1024, v26
    s_lshl_b32 s3, s12, 3
    s_add_u32 s3, s3, 0
    v_mov_b32 v14, s3
    s_and_b32 s3, s3, -16
    v_mov_b32 v128, s3
    s_mov_b32 s42, 0
    v_and_b32 v130, 15, v0
    v_lshlrev_b32 v130, 7, v130
    s_and_b32 s15, s14, 0xfffff800
    s_mov_b32 s46, 3216550459
    s_mov_b32 s47, 3216550459
    s_mov_b32 s22, 0
    s_mul_i32 s38, s20, 2621440
    s_lshl_b32 s26, s21, 1
    s_lshr_b32 s27, s12, 1
    s_add_u32 s26, s26, s27
    s_mul_i32 s26, s26, 1280
    s_add_u32 s35, s38, s26
    s_add_u32 s35, s35, 198836224
    s_add_u32 s38, s38, 193593344
    s_add_u32 s37, s26, 190971904
    s_add_u32 s36, s26, 206700544
    s_cmp_eq_u32 s20, 0
    s_cselect_b32 s36, s36, s26
    s_mul_i32 s25, s12, 3
    s_add_u32 s26, s25, 0
    s_lshr_b32 s27, s26, 2
    s_lshl_b32 s27, s27, 10
    s_bfe_u32 s3, s26, 0x10001
    s_lshl_b32 s3, s3, 3
    s_add_u32 s27, s27, s3
    s_and_b32 s3, s26, 1
    s_lshl_b32 s3, s3, 9
    s_add_u32 s27, s27, s3
    v_add_u32 v13, s27, v26
    s_add_u32 s26, s25, 1
    s_lshr_b32 s27, s26, 2
    s_lshl_b32 s27, s27, 10
    s_bfe_u32 s3, s26, 0x10001
    s_lshl_b32 s3, s3, 3
    s_add_u32 s27, s27, s3
    s_and_b32 s3, s26, 1
    s_lshl_b32 s3, s3, 9
    s_add_u32 s27, s27, s3
    v_add_u32 v129, s27, v26
    s_add_u32 s26, s25, 2
    s_lshr_b32 s27, s26, 2
    s_lshl_b32 s27, s27, 10
    s_bfe_u32 s3, s26, 0x10001
    s_lshl_b32 s3, s3, 3
    s_add_u32 s27, s27, s3
    s_and_b32 s3, s26, 1
    s_lshl_b32 s3, s3, 9
    s_add_u32 s27, s27, s3
    v_add_u32 v15, s27, v26
    s_lshl_b32 s3, s18, 2
    s_add_u32 s3, s3, 64
    v_mov_b32 v92, s3
    v_lshlrev_b32 v94, 2, v0
    v_and_b32 v94, 28, v94
    s_mov_b32 s19, 0
L_G_warr_2:
    global_load_dword v93, v92, s[16:17] sc1
    s_add_u32 s19, s19, 1
    s_cmp_ge_u32 s19, 524288
    s_cbranch_scc1 L_fail
    s_waitcnt vmcnt(0)
    v_cmp_gt_u32 vcc, 256, v93
    s_nop 0
    s_cbranch_vccnz L_G_warr_2
    s_cmp_lg_u32 s18, 0
    s_cbranch_scc1 L_G_placed_3
    global_load_dword v93, v94, s[16:17] sc1
    s_waitcnt vmcnt(0)
    v_cmp_ne_u32 vcc, 32, v93
    s_nop 0
    s_cbranch_vccnz L_fallback
L_G_placed_3:
    v_mov_b32 v0, v16
    s_barrier
    buffer_load_dword v10, v9, s[4:7], s24 offen sc1
    s_waitcnt vmcnt(0)
    s_mov_b32 s19, 0
    v_cmp_gt_u32 vcc, 1, v10
    s_nop 0
    s_cbranch_vccnz L_G_flspin_5
L_G_fl_4:
    s_add_u32 s90, s63, 15360
    s_mov_b32 s91, 40960
    s_mov_b32 s43, 0
    v_add_u32 v2, 56320, v2
    v_add_u32 v3, 56320, v3
    s_add_u32 m0, s90, 0
    s_nop 0
    buffer_load_dwordx4 v1, s[4:7], s38 offen offset:0 sc1 lds
    s_add_u32 m0, s90, 896
    s_nop 0
    buffer_load_dwordx4 v1, s[4:7], s38 offen offset:128 sc1 lds
    s_add_u32 m0, s90, 1792
    s_nop 0
    buffer_load_dwordx4 v1, s[4:7], s38 offen offset:256 sc1 lds
    s_add_u32 m0, s90, 2688
    s_nop 0
    buffer_load_dwordx4 v1, s[4:7], s38 offen offset:384 sc1 lds
    s_add_u32 m0, s90, 3584
    s_nop 0
    buffer_load_dwordx4 v1, s[4:7], s38 offen offset:512 sc1 lds
    s_add_u32 m0, s90, 4480
    s_nop 0
    buffer_load_dwordx4 v1, s[4:7], s38 offen offset:640 sc1 lds
    s_add_u32 m0, s90, 5376
    s_nop 0
    buffer_load_dwordx4 v1, s[4:7], s38 offen offset:768 sc1 lds
    s_add_u32 m0, s90, 6272
    s_nop 0
    buffer_load_dwordx4 v1, s[4:7], s38 offen offset:896 sc1 lds
    s_add_u32 m0, s90, 7168
    s_nop 0
    buffer_load_dwordx4 v1, s[4:7], s38 offen offset:1024 sc1 lds
    s_add_u32 m0, s90, 8064
    s_nop 0
    buffer_load_dwordx4 v1, s[4:7], s38 offen offset:1152 sc1 lds
    s_cmp_lg_u32 s18, 0
    s_cbranch_scc1 L_G_slow
    s_branch L_G_fast
L_G_flspin_5:
    buffer_load_dword v10, v9, s[4:7], s24 offen sc1
    s_add_u32 s19, s19, 1
    s_cmp_ge_u32 s19, 524288
    s_cbranch_scc1 L_fail
    s_waitcnt vmcnt(0)
    v_cmp_gt_u32 vcc, 1, v10
    s_nop 0
    s_cbranch_vccnz L_G_flspin_5
    s_branch L_G_fl_4
L_G_fast:
L_Gf_top:
    s_lshr_b32 s25, s22, 1
    s_andn2_b32 s28, 1, s25
    s_sub_u32 s29, 0, s28
    s_add_u32 s40, s22, 2
    s_cmp_eq_u32 s22, 63
    s_cselect_b32 s40, -1, s40
    s_add_u32 s27, s22, 3
    s_cmp_ge_u32 s22, 62
    s_cselect_b32 s27, -1, s27
    s_add_u32 s38, s38, 40960
    s_add_u32 s90, s90, s91
    s_sub_u32 s91, 0, s91
    v_add_u32 v2, s91, v2
    v_add_u32 v3, s91, v3
    s_mov_b32 s89, s43
    s_cmp_eq_u32 s89, 0
    s_cbranch_scc1 L_Gf_plain_1
    s_waitcnt vmcnt(8)
    s_barrier
    ds_read_b128 v[16:19], v2 offset:0
    ds_read_b128 v[20:23], v2 offset:20480
    ds_read_b128 v[24:27], v3 offset:0
    ds_read_b128 v[28:31], v3 offset:20480
    ds_read_b128 v[32:35], v2 offset:1024
    ds_read_b128 v[36:39], v2 offset:21504
    s_waitcnt lgkmcnt(4)
    v_mfma_f32_16x16x32_bf16 v[40:43], a[0:3], v[16:19], 0
    s_add_u32 m0, s90, 0
    s_nop 0
    buffer_load_dwordx4 v1, s[4:7], s38 offen offset:0 sc1 lds
    v_mfma_f32_16x16x32_bf16 v[44:47], a[0:3], v[20:23], 0
    v_mfma_f32_16x16x32_bf16 v[48:51], a[80:83], v[16:19], 0
    v_mfma_f32_16x16x32_bf16 v[52:55], a[80:83], v[20:23], 0
    v_mfma_f32_16x16x32_bf16 v[56:59], a[160:163], v[16:19], 0
    v_mfma_f32_16x16x32_bf16 v[60:63], a[160:163], v[20:23], 0
    ds_read_b128 v[16:19], v3 offset:1024
    ds_read_b128 v[20:23], v3 offset:21504
    s_waitcnt lgkmcnt(4)
    v_mfma_f32_16x16x32_bf16 v[40:43], a[4:7], v[24:27], v[40:43]
    s_add_u32 m0, s90, 896
    s_nop 0
    buffer_load_dwordx4 v1, s[4:7], s38 offen offset:128 sc1 lds
    v_mfma_f32_16x16x32_bf16 v[44:47], a[4:7], v[28:31], v[44:47]
    v_mfma_f32_16x16x32_bf16 v[48:51], a[84:87], v[24:27], v[48:51]
    v_mfma_f32_16x16x32_bf16 v[52:55], a[84:87], v[28:31], v[52:55]
    v_mfma_f32_16x16x32_bf16 v[56:59], a[164:167], v[24:27], v[56:59]
    v_mfma_f32_16x16x32_bf16 v[60:63], a[164:167], v[28:31], v[60:63]
    s_waitcnt vmcnt(8)
    s_barrier
    ds_read_b128 v[24:27], v2 offset:2048
    ds_read_b128 v[28:31], v2 offset:22528
    s_waitcnt lgkmcnt(4)
    v_mfma_f32_16x16x32_bf16 v[40:43], a[8:11], v[32:35], v[40:43]
    s_add_u32 m0, s90, 1792
    s_nop 0
    buffer_load_dwordx4 v1, s[4:7], s38 offen offset:256 sc1 lds
    v_mfma_f32_16x16x32_bf16 v[44:47], a[8:11], v[36:39], v[44:47]
    v_mfma_f32_16x16x32_bf16 v[48:51], a[88:91], v[32:35], v[48:51]
    v_mfma_f32_16x16x32_bf16 v[52:55], a[88:91], v[36:39], v[52:55]
    v_mfma_f32_16x16x32_bf16 v[56:59], a[168:171], v[32:35], v[56:59]
    v_mfma_f32_16x16x32_bf16 v[60:63], a[168:171], v[36:39], v[60:63]
    ds_read_b128 v[32:35], v3 offset:2048
    ds_read_b128 v[36:39], v3 offset:22528
    s_waitcnt lgkmcnt(4)
    v_mfma_f32_16x16x32_bf16 v[40:43], a[12:15], v[16:19], v[40:43]
    s_add_u32 m0, s90, 2688
    s_nop 0
    buffer_load_dwordx4 v1, s[4:7], s38 offen offset:384 sc1 lds
    v_mfma_f32_16x16x32_bf16 v[44:47], a[12:15], v[20:23], v[44:47]
    v_mfma_f32_16x16x32_bf16 v[48:51], a[92:95], v[16:19], v[48:51]
    v_mfma_f32_16x16x32_bf16 v[52:55], a[92:95], v[20:23], v[52:55]
    v_mfma_f32_16x16x32_bf16 v[56:59], a[172:175], v[16:19], v[56:59]
    v_mfma_f32_16x16x32_bf16 v[60:63], a[172:175], v[20:23], v[60:63]
    ds_read_b128 v[16:19], v2 offset:3072
    ds_read_b128 v[20:23], v2 offset:23552
    s_waitcnt lgkmcnt(4)
    v_mfma_f32_16x16x32_bf16 v[40:43], a[16:19], v[24:27], v[40:43]
    s_add_u32 m0, s90, 3584
    s_nop 0
    buffer_load_dwordx4 v1, s[4:7], s38 offen offset:512 sc1 lds
    v_mfma_f32_16x16x32_bf16 v[44:47], a[16:19], v[28:31], v[44:47]
    v_mfma_f32_16x16x32_bf16 v[48:51], a[96:99], v[24:27], v[48:51]
    v_mfma_f32_16x16x32_bf16 v[52:55], a[96:99], v[28:31], v[52:55]
    v_mfma_f32_16x16x32_bf16 v[56:59], a[176:179], v[24:27], v[56:59]
    v_mfma_f32_16x16x32_bf16 v[60:63], a[176:179], v[28:31], v[60:63]
    ds_read_b128 v[24:27], v3 offset:3072
    ds_read_b128 v[28:31], v3 offset:23552
    s_waitcnt lgkmcnt(4)
    v_mfma_f32_16x16x32_bf16 v[40:43], a[20:23], v[32:35], v[40:43]
    s_add_u32 m0, s90, 4480
    s_nop 0
    buffer_load_dwordx4 v1, s[4:7], s38 offen offset:640 sc1 lds
    v_mfma_f32_16x16x32_bf16 v[44:47], a[20:23], v[36:39], v[44:47]
    v_mfma_f32_16x16x32_bf16 v[48:51], a[100:103], v[32:35], v[48:51]
    v_mfma_f32_16x16x32_bf16 v[52:55], a[100:103], v[36:39], v[52:55]
    v_mfma_f32_16x16x32_bf16 v[56:59], a[180:183], v[32:35], v[56:59]
    v_mfma_f32_16x16x32_bf16 v[60:63], a[180:183], v[36:39], v[60:63]
    s_waitcnt vmcnt(9)
    s_barrier
    ds_read_b128 v[32:35], v2 offset:4096
    ds_read_b128 v[36:39], v2 offset:24576
    s_waitcnt lgkmcnt(4)
    v_mfma_f32_16x16x32_bf16 v[40:43], a[24:27], v[16:19], v[40:43]
    s_add_u32 m0, s90, 5376
    s_nop 0
    buffer_load_dwordx4 v1, s[4:7], s38 offen offset:768 sc1 lds
    v_mfma_f32_16x16x32_bf16 v[44:47], a[24:27], v[20:23], v[44:47]
    v_mfma_f32_16x16x32_bf16 v[48:51], a[104:107], v[16:19], v[48:51]
    v_mfma_f32_16x16x32_bf16 v[52:55], a[104:107], v[20:23], v[52:55]
    v_mfma_f32_16x16x32_bf16 v[56:59], a[184:187], v[16:19], v[56:59]
    v_mfma_f32_16x16x32_bf16 v[60:63], a[184:187], v[20:23], v[60:63]
    ds_read_b128 v[16:19], v3 offset:4096
    ds_read_b128 v[20:23], v3 offset:24576
    s_waitcnt lgkmcnt(4)
    v_mfma_f32_16x16x32_bf16 v[40:43], a[28:31], v[24:27], v[40:43]
    s_add_u32 m0, s90, 6272
    s_nop 0
    buffer_load_dwordx4 v1, s[4:7], s38 offen offset:896 sc1 lds
    v_mfma_f32_16x16x32_bf16 v[44:47], a[28:31], v[28:31], v[44:47]
    v_mfma_f32_16x16x32_bf16 v[48:51], a[108:111], v[24:27], v[48:51]
    v_mfma_f32_16x16x32_bf16 v[52:55], a[108:111], v[28:31], v[52:55]
    v_mfma_f32_16x16x32_bf16 v[56:59], a[188:191], v[24:27], v[56:59]
    v_mfma_f32_16x16x32_bf16 v[60:63], a[188:191], v[28:31], v[60:63]
    ds_read_b128 v[24:27], v2 offset:5120
    ds_read_b128 v[28:31], v2 offset:25600
    s_waitcnt lgkmcnt(4)
    v_mfma_f32_16x16x32_bf16 v[40:43], a[32:35], v[32:35], v[40:43]
    s_add_u32 m0, s90, 7168
    s_nop 0
    buffer_load_dwordx4 v1, s[4:7], s38 offen offset:1024 sc1 lds
    v_mfma_f32_16x16x32_bf16 v[44:47], a[32:35], v[36:39], v[44:47]
    v_mfma_f32_16x16x32_bf16 v[48:51], a[112:115], v[32:35], v[48:51]
    v_mfma_f32_16x16x32_bf16 v[52:55], a[112:115], v[36:39], v[52:55]
    v_mfma_f32_16x16x32_bf16 v[56:59], a[192:195], v[32:35], v[56:59]
    v_mfma_f32_16x16x32_bf16 v[60:63], a[192:195], v[36:39], v[60:63]
    ds_read_b128 v[32:35], v3 offset:5120
    ds_read_b128 v[36:39], v3 offset:25600
    s_waitcnt lgkmcnt(4)
    v_mfma_f32_16x16x32_bf16 v[40:43], a[36:39], v[16:19], v[40:43]
    s_add_u32 m0, s90, 8064
    s_nop 0
    buffer_load_dwordx4 v1, s[4:7], s38 offen offset:1152 sc1 lds
    v_mfma_f32_16x16x32_bf16 v[44:47], a[36:39], v[20:23], v[44:47]
    v_mfma_f32_16x16x32_bf16 v[48:51], a[116:119], v[16:19], v[48:51]
    v_mfma_f32_16x16x32_bf16 v[52:55], a[116:119], v[20:23], v[52:55]
    v_mfma_f32_16x16x32_bf16 v[56:59], a[196:199], v[16:19], v[56:59]
    v_mfma_f32_16x16x32_bf16 v[60:63], a[196:199], v[20:23], v[60:63]
    ds_read_b128 v[16:19], v2 offset:6144
    ds_read_b128 v[20:23], v2 offset:26624
    s_waitcnt lgkmcnt(4)
    v_mfma_f32_16x16x32_bf16 v[40:43], a[40:43], v[24:27], v[40:43]
    v_mfma_f32_16x16x32_bf16 v[44:47], a[40:43], v[28:31], v[44:47]
    v_mfma_f32_16x16x32_bf16 v[48:51], a[120:123], v[24:27], v[48:51]
    v_mfma_f32_16x16x32_bf16 v[52:55], a[120:123], v[28:31], v[52:55]
    v_mfma_f32_16x16x32_bf16 v[56:59], a[200:203], v[24:27], v[56:59]
    v_mfma_f32_16x16x32_bf16 v[60:63], a[200:203], v[28:31], v[60:63]
    ds_read_b128 v[24:27], v3 offset:6144
    ds_read_b128 v[28:31], v3 offset:26624
    s_waitcnt lgkmcnt(4)
    v_mfma_f32_16x16x32_bf16 v[40:43], a[44:47], v[32:35], v[40:43]
    v_mfma_f32_16x16x32_bf16 v[44:47], a[44:47], v[36:39], v[44:47]
    v_mfma_f32_16x16x32_bf16 v[48:51], a[124:127], v[32:35], v[48:51]
    v_mfma_f32_16x16x32_bf16 v[52:55], a[124:127], v[36:39], v[52:55]
    v_mfma_f32_16x16x32_bf16 v[56:59], a[204:207], v[32:35], v[56:59]
    v_mfma_f32_16x16x32_bf16 v[60:63], a[204:207], v[36:39], v[60:63]
    s_waitcnt vmcnt(10)
    s_barrier
    s_cmp_eq_u32 s42, 0
    s_cbranch_scc1 L_Gf_nopend_3
    v_mov_b32 v11, s22
    s_mov_b64 exec, 1
    buffer_store_dword v11, v0, s[4:7], s23 offen offset:0 sc1
    s_mov_b64 exec, -1
L_Gf_nopend_3:
    buffer_load_dwordx4 v[112:115], v131, s[4:7], s35 offen offset:0 sc1
    buffer_load_dwordx4 v[116:119], v131, s[4:7], s35 offen offset:256 sc1
    buffer_load_dwordx4 v[120:123], v124, s[4:7], s35 offen offset:0 sc1
    buffer_load_dword v10, v9, s[4:7], s24 offen sc1
    ds_read_b128 v[32:35], v2 offset:7168
    ds_read_b128 v[36:39], v2 offset:27648
    s_waitcnt lgkmcnt(4)
    v_mfma_f32_16x16x32_bf16 v[40:43], a[48:51], v[16:19], v[40:43]
    v_mfma_f32_16x16x32_bf16 v[44:47], a[48:51], v[20:23], v[44:47]
    v_mfma_f32_16x16x32_bf16 v[48:51], a[128:131], v[16:19], v[48:51]
    v_mfma_f32_16x16x32_bf16 v[52:55], a[128:131], v[20:23], v[52:55]
    v_mfma_f32_16x16x32_bf16 v[56:59], a[208:211], v[16:19], v[56:59]
    v_mfma_f32_16x16x32_bf16 v[60:63], a[208:211], v[20:23], v[60:63]
    ds_read_b128 v[16:19], v3 offset:7168
    ds_read_b128 v[20:23], v3 offset:27648
    s_waitcnt lgkmcnt(4)
    v_mfma_f32_16x16x32_bf16 v[40:43], a[52:55], v[24:27], v[40:43]
    v_mfma_f32_16x16x32_bf16 v[44:47], a[52:55], v[28:31], v[44:47]
    v_mfma_f32_16x16x32_bf16 v[48:51], a[132:135], v[24:27], v[48:51]
    v_mfma_f32_16x16x32_bf16 v[52:55], a[132:135], v[28:31], v[52:55]
    v_mfma_f32_16x16x32_bf16 v[56:59], a[212:215], v[24:27], v[56:59]
    v_mfma_f32_16x16x32_bf16 v[60:63], a[212:215], v[28:31], v[60:63]
    ds_read_b128 v[24:27], v2 offset:8192
    ds_read_b128 v[28:31], v2 offset:28672
    s_waitcnt lgkmcnt(4)
    v_mfma_f32_16x16x32_bf16 v[40:43], a[56:59], v[32:35], v[40:43]
    v_mfma_f32_16x16x32_bf16 v[44:47], a[56:59], v[36:39], v[44:47]
    v_mfma_f32_16x16x32_bf16 v[48:51], a[136:139], v[32:35], v[48:51]
    v_mfma_f32_16x16x32_bf16 v[52:55], a[136:139], v[36:39], v[52:55]
    v_mfma_f32_16x16x32_bf16 v[56:59], a[216:219], v[32:35], v[56:59]
    v_mfma_f32_16x16x32_bf16 v[60:63], a[216:219], v[36:39], v[60:63]
    ds_read_b128 v[32:35], v3 offset:8192
    ds_read_b128 v[36:39], v3 offset:28672
    s_waitcnt lgkmcnt(4)
    v_mfma_f32_16x16x32_bf16 v[40:43], a[60:63], v[16:19], v[40:43]
    v_mfma_f32_16x16x32_bf16 v[44:47], a[60:63], v[20:23], v[44:47]
    v_mfma_f32_16x16x32_bf16 v[48:51], a[140:143], v[16:19], v[48:51]
    v_mfma_f32_16x16x32_bf16 v[52:55], a[140:143], v[20:23], v[52:55]
    v_mfma_f32_16x16x32_bf16 v[56:59], a[220:223], v[16:19], v[56:59]
    v_mfma_f32_16x16x32_bf16 v[60:63], a[220:223], v[20:23], v[60:63]
    ds_read_b128 v[16:19], v2 offset:9216
    ds_read_b128 v[20:23], v2 offset:29696
    s_waitcnt lgkmcnt(4)
    v_mfma_f32_16x16x32_bf16 v[40:43], a[64:67], v[24:27], v[40:43]
    v_mfma_f32_16x16x32_bf16 v[44:47], a[64:67], v[28:31], v[44:47]
    v_mfma_f32_16x16x32_bf16 v[48:51], a[144:147], v[24:27], v[48:51]
    v_mfma_f32_16x16x32_bf16 v[52:55], a[144:147], v[28:31], v[52:55]
    v_mfma_f32_16x16x32_bf16 v[56:59], a[224:227], v[24:27], v[56:59]
    v_mfma_f32_16x16x32_bf16 v[60:63], a[224:227], v[28:31], v[60:63]
    ds_read_b128 v[24:27], v3 offset:9216
    ds_read_b128 v[28:31], v3 offset:29696
    s_waitcnt lgkmcnt(4)
    v_mfma_f32_16x16x32_bf16 v[40:43], a[68:71], v[32:35], v[40:43]
    v_mfma_f32_16x16x32_bf16 v[44:47], a[68:71], v[36:39], v[44:47]
    v_mfma_f32_16x16x32_bf16 v[48:51], a[148:151], v[32:35], v[48:51]
    v_mfma_f32_16x16x32_bf16 v[52:55], a[148:151], v[36:39], v[52:55]
    v_mfma_f32_16x16x32_bf16 v[56:59], a[228:231], v[32:35], v[56:59]
    v_mfma_f32_16x16x32_bf16 v[60:63], a[228:231], v[36:39], v[60:63]
    s_waitcnt lgkmcnt(2)
    v_mfma_f32_16x16x32_bf16 v[40:43], a[72:75], v[16:19], v[40:43]
    v_mfma_f32_16x16x32_bf16 v[44:47], a[72:75], v[20:23], v[44:47]
    v_mfma_f32_16x16x32_bf16 v[48:51], a[152:155], v[16:19], v[48:51]
    v_mfma_f32_16x16x32_bf16 v[52:55], a[152:155], v[20:23], v[52:55]
    v_mfma_f32_16x16x32_bf16 v[56:59], a[232:235], v[16:19], v[56:59]
    v_mfma_f32_16x16x32_bf16 v[60:63], a[232:235], v[20:23], v[60:63]
    s_waitcnt lgkmcnt(0)
    v_mfma_f32_16x16x32_bf16 v[40:43], a[76:79], v[24:27], v[40:43]
    v_mfma_f32_16x16x32_bf16 v[44:47], a[76:79], v[28:31], v[44:47]
    v_mfma_f32_16x16x32_bf16 v[48:51], a[156:159], v[24:27], v[48:51]
    v_mfma_f32_16x16x32_bf16 v[52:55], a[156:159], v[28:31], v[52:55]
    v_mfma_f32_16x16x32_bf16 v[56:59], a[236:239], v[24:27], v[56:59]
    v_mfma_f32_16x16x32_bf16 v[60:63], a[236:239], v[28:31], v[60:63]
    s_branch L_Gf_act_2
L_Gf_plain_1:
    s_waitcnt vmcnt(8)
    s_barrier
    ds_read_b128 v[16:19], v2 offset:0
    ds_read_b128 v[20:23], v2 offset:20480
    ds_read_b128 v[24:27], v3 offset:0
    ds_read_b128 v[28:31], v3 offset:20480
    ds_read_b128 v[32:35], v2 offset:1024
    ds_read_b128 v[36:39], v2 offset:21504
    s_waitcnt lgkmcnt(4)
    v_mfma_f32_16x16x32_bf16 v[40:43], a[0:3], v[16:19], 0
    v_mfma_f32_16x16x32_bf16 v[44:47], a[0:3], v[20:23], 0
    v_mfma_f32_16x16x32_bf16 v[48:51], a[80:83], v[16:19], 0
    v_mfma_f32_16x16x32_bf16 v[52:55], a[80:83], v[20:23], 0
    v_mfma_f32_16x16x32_bf16 v[56:59], a[160:163], v[16:19], 0
    v_mfma_f32_16x16x32_bf16 v[60:63], a[160:163], v[20:23], 0
    ds_read_b128 v[16:19], v3 offset:1024
    ds_read_b128 v[20:23], v3 offset:21504
    s_waitcnt lgkmcnt(4)
    v_mfma_f32_16x16x32_bf16 v[40:43], a[4:7], v[24:27], v[40:43]
    v_mfma_f32_16x16x32_bf16 v[44:47], a[4:7], v[28:31], v[44:47]
    v_mfma_f32_16x16x32_bf16 v[48:51], a[84:87], v[24:27], v[48:51]
    v_mfma_f32_16x16x32_bf16 v[52:55], a[84:87], v[28:31], v[52:55]
    v_mfma_f32_16x16x32_bf16 v[56:59], a[164:167], v[24:27], v[56:59]
    v_mfma_f32_16x16x32_bf16 v[60:63], a[164:167], v[28:31], v[60:63]
    s_waitcnt vmcnt(6)
    s_barrier
    ds_read_b128 v[24:27], v2 offset:2048
    ds_read_b128 v[28:31], v2 offset:22528
    s_waitcnt lgkmcnt(4)
    v_mfma_f32_16x16x32_bf16 v[40:43], a[8:11], v[32:35], v[40:43]
    v_mfma_f32_16x16x32_bf16 v[44:47], a[8:11], v[36:39], v[44:47]
    v_mfma_f32_16x16x32_bf16 v[48:51], a[88:91], v[32:35], v[48:51]
    v_mfma_f32_16x16x32_bf16 v[52:55], a[88:91], v[36:39], v[52:55]
    v_mfma_f32_16x16x32_bf16 v[56:59], a[168:171], v[32:35], v[56:59]
    v_mfma_f32_16x16x32_bf16 v[60:63], a[168:171], v[36:39], v[60:63]
    ds_read_b128 v[32:35], v3 offset:2048
    ds_read_b128 v[36:39], v3 offset:22528
    s_waitcnt lgkmcnt(4)
    v_mfma_f32_16x16x32_bf16 v[40:43], a[12:15], v[16:19], v[40:43]
    v_mfma_f32_16x16x32_bf16 v[44:47], a[12:15], v[20:23], v[44:47]
    v_mfma_f32_16x16x32_bf16 v[48:51], a[92:95], v[16:19], v[48:51]
    v_mfma_f32_16x16x32_bf16 v[52:55], a[92:95], v[20:23], v[52:55]
    v_mfma_f32_16x16x32_bf16 v[56:59], a[172:175], v[16:19], v[56:59]
    v_mfma_f32_16x16x32_bf16 v[60:63], a[172:175], v[20:23], v[60:63]
    ds_read_b128 v[16:19], v2 offset:3072
    ds_read_b128 v[20:23], v2 offset:23552
    s_waitcnt lgkmcnt(4)
    v_mfma_f32_16x16x32_bf16 v[40:43], a[16:19], v[24:27], v[40:43]
    v_mfma_f32_16x16x32_bf16 v[44:47], a[16:19], v[28:31], v[44:47]
    v_mfma_f32_16x16x32_bf16 v[48:51], a[96:99], v[24:27], v[48:51]
    v_mfma_f32_16x16x32_bf16 v[52:55], a[96:99], v[28:31], v[52:55]
    v_mfma_f32_16x16x32_bf16 v[56:59], a[176:179], v[24:27], v[56:59]
    v_mfma_f32_16x16x32_bf16 v[60:63], a[176:179], v[28:31], v[60:63]
    ds_read_b128 v[24:27], v3 offset:3072
    ds_read_b128 v[28:31], v3 offset:23552
    s_waitcnt lgkmcnt(4)
    v_mfma_f32_16x16x32_bf16 v[40:43], a[20:23], v[32:35], v[40:43]
    v_mfma_f32_16x16x32_bf16 v[44:47], a[20:23], v[36:39], v[44:47]
    v_mfma_f32_16x16x32_bf16 v[48:51], a[100:103], v[32:35], v[48:51]
    v_mfma_f32_16x16x32_bf16 v[52:55], a[100:103], v[36:39], v[52:55]
    v_mfma_f32_16x16x32_bf16 v[56:59], a[180:183], v[32:35], v[56:59]
    v_mfma_f32_16x16x32_bf16 v[60:63], a[180:183], v[36:39], v[60:63]
    s_waitcnt vmcnt(3)
    s_barrier
    ds_read_b128 v[32:35], v2 offset:4096
    ds_read_b128 v[36:39], v2 offset:24576
    s_waitcnt lgkmcnt(4)
    v_mfma_f32_16x16x32_bf16 v[40:43], a[24:27], v[16:19], v[40:43]
    v_mfma_f32_16x16x32_bf16 v[44:47], a[24:27], v[20:23], v[44:47]
    v_mfma_f32_16x16x32_bf16 v[48:51], a[104:107], v[16:19], v[48:51]
    v_mfma_f32_16x16x32_bf16 v[52:55], a[104:107], v[20:23], v[52:55]
    v_mfma_f32_16x16x32_bf16 v[56:59], a[184:187], v[16:19], v[56:59]
    v_mfma_f32_16x16x32_bf16 v[60:63], a[184:187], v[20:23], v[60:63]
    ds_read_b128 v[16:19], v3 offset:4096
    ds_read_b128 v[20:23], v3 offset:24576
    s_waitcnt lgkmcnt(4)
    v_mfma_f32_16x16x32_bf16 v[40:43], a[28:31], v[24:27], v[40:43]
    v_mfma_f32_16x16x32_bf16 v[44:47], a[28:31], v[28:31], v[44:47]
    v_mfma_f32_16x16x32_bf16 v[48:51], a[108:111], v[24:27], v[48:51]
    v_mfma_f32_16x16x32_bf16 v[52:55], a[108:111], v[28:31], v[52:55]
    v_mfma_f32_16x16x32_bf16 v[56:59], a[188:191], v[24:27], v[56:59]
    v_mfma_f32_16x16x32_bf16 v[60:63], a[188:191], v[28:31], v[60:63]
    ds_read_b128 v[24:27], v2 offset:5120
    ds_read_b128 v[28:31], v2 offset:25600
    s_waitcnt lgkmcnt(4)
    v_mfma_f32_16x16x32_bf16 v[40:43], a[32:35], v[32:35], v[40:43]
    v_mfma_f32_16x16x32_bf16 v[44:47], a[32:35], v[36:39], v[44:47]
    v_mfma_f32_16x16x32_bf16 v[48:51], a[112:115], v[32:35], v[48:51]
    v_mfma_f32_16x16x32_bf16 v[52:55], a[112:115], v[36:39], v[52:55]
    v_mfma_f32_16x16x32_bf16 v[56:59], a[192:195], v[32:35], v[56:59]
    v_mfma_f32_16x16x32_bf16 v[60:63], a[192:195], v[36:39], v[60:63]
    ds_read_b128 v[32:35], v3 offset:5120
    ds_read_b128 v[36:39], v3 offset:25600
    s_waitcnt lgkmcnt(4)
    v_mfma_f32_16x16x32_bf16 v[40:43], a[36:39], v[16:19], v[40:43]
    v_mfma_f32_16x16x32_bf16 v[44:47], a[36:39], v[20:23], v[44:47]
    v_mfma_f32_16x16x32_bf16 v[48:51], a[116:119], v[16:19], v[48:51]
    v_mfma_f32_16x16x32_bf16 v[52:55], a[116:119], v[20:23], v[52:55]
    v_mfma_f32_16x16x32_bf16 v[56:59], a[196:199], v[16:19], v[56:59]
    v_mfma_f32_16x16x32_bf16 v[60:63], a[196:199], v[20:23], v[60:63]
    ds_read_b128 v[16:19], v2 offset:6144
    ds_read_b128 v[20:23], v2 offset:26624
    s_waitcnt lgkmcnt(4)
    v_mfma_f32_16x16x32_bf16 v[40:43], a[40:43], v[24:27], v[40:43]
    v_mfma_f32_16x16x32_bf16 v[44:47], a[40:43], v[28:31], v[44:47]
    v_mfma_f32_16x16x32_bf16 v[48:51], a[120:123], v[24:27], v[48:51]
    v_mfma_f32_16x16x32_bf16 v[52:55], a[120:123], v[28:31], v[52:55]
    v_mfma_f32_16x16x32_bf16 v[56:59], a[200:203], v[24:27], v[56:59]
    v_mfma_f32_16x16x32_bf16 v[60:63], a[200:203], v[28:31], v[60:63]
    ds_read_b128 v[24:27], v3 offset:6144
    ds_read_b128 v[28:31], v3 offset:26624
    s_waitcnt lgkmcnt(4)
    v_mfma_f32_16x16x32_bf16 v[40:43], a[44:47], v[32:35], v[40:43]
    v_mfma_f32_16x16x32_bf16 v[44:47], a[44:47], v[36:39], v[44:47]
    v_mfma_f32_16x16x32_bf16 v[48:51], a[124:127], v[32:35], v[48:51]
    v_mfma_f32_16x16x32_bf16 v[52:55], a[124:127], v[36:39], v[52:55]
    v_mfma_f32_16x16x32_bf16 v[56:59], a[204:207], v[32:35], v[56:59]
    v_mfma_f32_16x16x32_bf16 v[60:63], a[204:207], v[36:39], v[60:63]
    s_waitcnt vmcnt(0)
    s_barrier
    s_cmp_eq_u32 s42, 0
    s_cbranch_scc1 L_Gf_nopend_4
    v_mov_b32 v11, s22
    s_mov_b64 exec, 1
    buffer_store_dword v11, v0, s[4:7], s23 offen offset:0 sc1
    s_mov_b64 exec, -1
L_Gf_nopend_4:
    buffer_load_dwordx4 v[112:115], v131, s[4:7], s35 offen offset:0 sc1
    buffer_load_dwordx4 v[116:119], v131, s[4:7], s35 offen offset:256 sc1
    buffer_load_dwordx4 v[120:123], v124, s[4:7], s35 offen offset:0 sc1
    buffer_load_dword v10, v9, s[4:7], s24 offen sc1
    ds_read_b128 v[32:35], v2 offset:7168
    ds_read_b128 v[36:39], v2 offset:27648
    s_waitcnt lgkmcnt(4)
    v_mfma_f32_16x16x32_bf16 v[40:43], a[48:51], v[16:19], v[40:43]
    v_mfma_f32_16x16x32_bf16 v[44:47], a[48:51], v[20:23], v[44:47]
    v_mfma_f32_16x16x32_bf16 v[48:51], a[128:131], v[16:19], v[48:51]
    v_mfma_f32_16x16x32_bf16 v[52:55], a[128:131], v[20:23], v[52:55]
    v_mfma_f32_16x16x32_bf16 v[56:59], a[208:211], v[16:19], v[56:59]
    v_mfma_f32_16x16x32_bf16 v[60:63], a[208:211], v[20:23], v[60:63]
    ds_read_b128 v[16:19], v3 offset:7168
    ds_read_b128 v[20:23], v3 offset:27648
    s_waitcnt lgkmcnt(4)
    v_mfma_f32_16x16x32_bf16 v[40:43], a[52:55], v[24:27], v[40:43]
    v_mfma_f32_16x16x32_bf16 v[44:47], a[52:55], v[28:31], v[44:47]
    v_mfma_f32_16x16x32_bf16 v[48:51], a[132:135], v[24:27], v[48:51]
    v_mfma_f32_16x16x32_bf16 v[52:55], a[132:135], v[28:31], v[52:55]
    v_mfma_f32_16x16x32_bf16 v[56:59], a[212:215], v[24:27], v[56:59]
    v_mfma_f32_16x16x32_bf16 v[60:63], a[212:215], v[28:31], v[60:63]
    ds_read_b128 v[24:27], v2 offset:8192
    ds_read_b128 v[28:31], v2 offset:28672
    s_waitcnt lgkmcnt(4)
    v_mfma_f32_16x16x32_bf16 v[40:43], a[56:59], v[32:35], v[40:43]
    v_mfma_f32_16x16x32_bf16 v[44:47], a[56:59], v[36:39], v[44:47]
    v_mfma_f32_16x16x32_bf16 v[48:51], a[136:139], v[32:35], v[48:51]
    v_mfma_f32_16x16x32_bf16 v[52:55], a[136:139], v[36:39], v[52:55]
    v_mfma_f32_16x16x32_bf16 v[56:59], a[216:219], v[32:35], v[56:59]
    v_mfma_f32_16x16x32_bf16 v[60:63], a[216:219], v[36:39], v[60:63]
    ds_read_b128 v[32:35], v3 offset:8192
    ds_read_b128 v[36:39], v3 offset:28672
    s_waitcnt lgkmcnt(4)
    v_mfma_f32_16x16x32_bf16 v[40:43], a[60:63], v[16:19], v[40:43]
    v_mfma_f32_16x16x32_bf16 v[44:47], a[60:63], v[20:23], v[44:47]
    v_mfma_f32_16x16x32_bf16 v[48:51], a[140:143], v[16:19], v[48:51]
    v_mfma_f32_16x16x32_bf16 v[52:55], a[140:143], v[20:23], v[52:55]
    v_mfma_f32_16x16x32_bf16 v[56:59], a[220:223], v[16:19], v[56:59]
    v_mfma_f32_16x16x32_bf16 v[60:63], a[220:223], v[20:23], v[60:63]
    ds_read_b128 v[16:19], v2 offset:9216
    ds_read_b128 v[20:23], v2 offset:29696
    s_waitcnt lgkmcnt(4)
    v_mfma_f32_16x16x32_bf16 v[40:43], a[64:67], v[24:27], v[40:43]
    v_mfma_f32_16x16x32_bf16 v[44:47], a[64:67], v[28:31], v[44:47]
    v_mfma_f32_16x16x32_bf16 v[48:51], a[144:147], v[24:27], v[48:51]
    v_mfma_f32_16x16x32_bf16 v[52:55], a[144:147], v[28:31], v[52:55]
    v_mfma_f32_16x16x32_bf16 v[56:59], a[224:227], v[24:27], v[56:59]
    v_mfma_f32_16x16x32_bf16 v[60:63], a[224:227], v[28:31], v[60:63]
    ds_read_b128 v[24:27], v3 offset:9216
    ds_read_b128 v[28:31], v3 offset:29696
    s_waitcnt lgkmcnt(4)
    v_mfma_f32_16x16x32_bf16 v[40:43], a[68:71], v[32:35], v[40:43]
    v_mfma_f32_16x16x32_bf16 v[44:47], a[68:71], v[36:39], v[44:47]
    v_mfma_f32_16x16x32_bf16 v[48:51], a[148:151], v[32:35], v[48:51]
    v_mfma_f32_16x16x32_bf16 v[52:55], a[148:151], v[36:39], v[52:55]
    v_mfma_f32_16x16x32_bf16 v[56:59], a[228:231], v[32:35], v[56:59]
    v_mfma_f32_16x16x32_bf16 v[60:63], a[228:231], v[36:39], v[60:63]
    s_waitcnt lgkmcnt(2)
    v_mfma_f32_16x16x32_bf16 v[40:43], a[72:75], v[16:19], v[40:43]
    v_mfma_f32_16x16x32_bf16 v[44:47], a[72:75], v[20:23], v[44:47]
    v_mfma_f32_16x16x32_bf16 v[48:51], a[152:155], v[16:19], v[48:51]
    v_mfma_f32_16x16x32_bf16 v[52:55], a[152:155], v[20:23], v[52:55]
    v_mfma_f32_16x16x32_bf16 v[56:59], a[232:235], v[16:19], v[56:59]
    v_mfma_f32_16x16x32_bf16 v[60:63], a[232:235], v[20:23], v[60:63]
    s_waitcnt lgkmcnt(0)
    v_mfma_f32_16x16x32_bf16 v[40:43], a[76:79], v[24:27], v[40:43]
    v_mfma_f32_16x16x32_bf16 v[44:47], a[76:79], v[28:31], v[44:47]
    v_mfma_f32_16x16x32_bf16 v[48:51], a[156:159], v[24:27], v[48:51]
    v_mfma_f32_16x16x32_bf16 v[52:55], a[156:159], v[28:31], v[52:55]
    v_mfma_f32_16x16x32_bf16 v[56:59], a[236:239], v[24:27], v[56:59]
    v_mfma_f32_16x16x32_bf16 v[60:63], a[236:239], v[28:31], v[60:63]
L_Gf_act_2:
    s_nop 3
    v_permlane32_swap_b32 v40, v44
    v_permlane32_swap_b32 v41, v45
    v_permlane32_swap_b32 v42, v46
    v_permlane32_swap_b32 v43, v47
    v_permlane32_swap_b32 v48, v52
    v_permlane32_swap_b32 v49, v53
    v_permlane32_swap_b32 v50, v54
    v_permlane32_swap_b32 v51, v55
    v_permlane32_swap_b32 v56, v60
    v_permlane32_swap_b32 v57, v61
    v_permlane32_swap_b32 v58, v62
    v_permlane32_swap_b32 v59, v63
    v_pk_mul_f32 v[40:41], v[40:41], s[46:47]
    v_pk_mul_f32 v[42:43], v[42:43], s[46:47]
    v_pk_mul_f32 v[48:49], v[48:49], s[46:47]
    v_pk_mul_f32 v[50:51], v[50:51], s[46:47]
    v_pk_mul_f32 v[56:57], v[56:57], s[46:47]
    v_pk_mul_f32 v[58:59], v[58:59], s[46:47]
    v_exp_f32 v40, v40
    v_exp_f32 v41, v41
    v_exp_f32 v42, v42
    v_exp_f32 v43, v43
    v_exp_f32 v48, v48
    v_exp_f32 v49, v49
    v_exp_f32 v50, v50
    v_exp_f32 v51, v51
    v_exp_f32 v56, v56
    v_exp_f32 v57, v57
    v_exp_f32 v58, v58
    v_exp_f32 v59, v59
    v_pk_add_f32 v[40:41], v[40:41], 1.0 op_sel_hi:[1,0]
    v_pk_add_f32 v[42:43], v[42:43], 1.0 op_sel_hi:[1,0]
    v_pk_add_f32 v[48:49], v[48:49], 1.0 op_sel_hi:[1,0]
    v_pk_add_f32 v[50:51], v[50:51], 1.0 op_sel_hi:[1,0]
    v_pk_add_f32 v[56:57], v[56:57], 1.0 op_sel_hi:[1,0]
    v_pk_add_f32 v[58:59], v[58:59], 1.0 op_sel_hi:[1,0]
    v_rcp_f32 v40, v40
    v_rcp_f32 v41, v41
    v_rcp_f32 v42, v42
    v_rcp_f32 v43, v43
    v_rcp_f32 v48, v48
    v_rcp_f32 v49, v49
    v_rcp_f32 v50, v50
    v_rcp_f32 v51, v51
    v_rcp_f32 v56, v56
    v_rcp_f32 v57, v57
    v_rcp_f32 v58, v58
    v_rcp_f32 v59, v59
    v_pk_mul_f32 v[40:41], v[40:41], v[44:45]
    v_pk_mul_f32 v[42:43], v[42:43], v[46:47]
    v_cvt_pk_bf16_f32 v64, v40, v41
    v_cvt_pk_bf16_f32 v65, v42, v43
    ds_write_b64 v13, v[64:65]
    v_pk_mul_f32 v[48:49], v[48:49], v[52:53]
    v_pk_mul_f32 v[50:51], v[50:51], v[54:55]
    v_cvt_pk_bf16_f32 v66, v48, v49
    v_cvt_pk_bf16_f32 v67, v50, v51
    ds_write_b64 v129, v[66:67]
    v_pk_mul_f32 v[56:57], v[56:57], v[60:61]
    v_pk_mul_f32 v[58:59], v[58:59], v[62:63]
    v_cvt_pk_bf16_f32 v68, v56, v57
    v_cvt_pk_bf16_f32 v69, v58, v59
    ds_write_b64 v15, v[68:69]
    s_waitcnt vmcnt(0)
    v_cmp_gt_u32 vcc, s27, v10
    s_cmp_eq_u64 vcc, 0
    s_cselect_b32 s3, 1, 0
    v_mov_b32 v11, s3
    s_cmp_eq_u32 s12, 0
    s_cselect_b64 exec, 1, 0
    ds_write_b32 v0, v11 offset:64
    s_mov_b64 exec, -1
    s_waitcnt lgkmcnt(0)
    s_barrier
    v_mov_b32 v10, 0
    ds_read_b32 v10, v10 offset:64
    ds_read_b128 v[16:19], v0 offset:1024
    ds_read_b128 v[20:23], v0 offset:2048
    ds_read_b128 v[24:27], v0 offset:3072
    ds_read_b128 v[28:31], v0 offset:4096
    ds_read_b128 v[32:35], v0 offset:5120
    ds_read_b128 v[36:39], v0 offset:6144
    s_waitcnt lgkmcnt(6)
    v_readfirstlane_b32 s43, v10
    s_waitcnt lgkmcnt(5)
    v_mfma_f32_16x16x32_bf16 v[40:43], v[136:139], v[16:19], 0
    s_waitcnt lgkmcnt(4)
    v_mfma_f32_16x16x32_bf16 v[40:43], v[140:143], v[20:23], v[40:43]
    s_waitcnt lgkmcnt(3)
    v_mfma_f32_16x16x32_bf16 v[40:43], v[144:147], v[24:27], v[40:43]
    v_mfma_f32_16x16x32_bf16 v[44:47], v[148:151], v[16:19], 0
    v_mfma_f32_16x16x32_bf16 v[44:47], v[152:155], v[20:23], v[44:47]
    v_mfma_f32_16x16x32_bf16 v[44:47], v[156:159], v[24:27], v[44:47]
    s_waitcnt lgkmcnt(2)
    v_mfma_f32_16x16x32_bf16 v[48:51], v[136:139], v[28:31], 0
    s_nop 2
    v_cvt_pk_bf16_f32 v56, v40, v41
    s_waitcnt lgkmcnt(1)
    v_mfma_f32_16x16x32_bf16 v[48:51], v[140:143], v[32:35], v[48:51]
    v_cvt_pk_bf16_f32 v57, v42, v43
    v_and_or_b32 v56, v56, -2, s28
    s_waitcnt lgkmcnt(0)
    v_mfma_f32_16x16x32_bf16 v[48:51], v[144:147], v[36:39], v[48:51]
    v_cvt_pk_bf16_f32 v58, v44, v45
    v_mfma_f32_16x16x32_bf16 v[52:55], v[148:151], v[28:31], 0
    v_cvt_pk_bf16_f32 v59, v46, v47
    v_mfma_f32_16x16x32_bf16 v[52:55], v[152:155], v[32:35], v[52:55]
    ds_write_b128 v126, v[56:59] offset:0
    v_mfma_f32_16x16x32_bf16 v[52:55], v[156:159], v[36:39], v[52:55]
    ds_read_b128 v[64:67], v127 offset:0
    v_mfma_f32_16x16x32_bf16 v[40:43], v[160:163], v[16:19], 0
    v_cvt_pk_bf16_f32 v60, v48, v49
    v_mfma_f32_16x16x32_bf16 v[40:43], v[164:167], v[20:23], v[40:43]
    v_cvt_pk_bf16_f32 v61, v50, v51
    v_and_or_b32 v60, v60, -2, s28
    v_mfma_f32_16x16x32_bf16 v[40:43], v[168:171], v[24:27], v[40:43]
    s_nop 0
    v_cvt_pk_bf16_f32 v62, v52, v53
    v_mfma_f32_16x16x32_bf16 v[44:47], v[172:175], v[16:19], 0
    s_waitcnt lgkmcnt(0)
    buffer_store_dwordx4 v[64:67], v4, s[4:7], s30 offen offset:0
    v_cvt_pk_bf16_f32 v63, v54, v55
    v_mfma_f32_16x16x32_bf16 v[44:47], v[176:179], v[20:23], v[44:47]
    ds_write_b128 v126, v[60:63] offset:1024
    v_mfma_f32_16x16x32_bf16 v[44:47], v[180:183], v[24:27], v[44:47]
    ds_read_b128 v[68:71], v127 offset:1024
    v_mfma_f32_16x16x32_bf16 v[48:51], v[160:163], v[28:31], 0
    v_cvt_pk_bf16_f32 v56, v40, v41
    v_mfma_f32_16x16x32_bf16 v[48:51], v[164:167], v[32:35], v[48:51]
    v_cvt_pk_bf16_f32 v57, v42, v43
    v_and_or_b32 v56, v56, -2, s28
    v_mfma_f32_16x16x32_bf16 v[48:51], v[168:171], v[36:39], v[48:51]
    s_nop 0
    v_cvt_pk_bf16_f32 v58, v44, v45
    v_mfma_f32_16x16x32_bf16 v[52:55], v[172:175], v[28:31], 0
    s_waitcnt lgkmcnt(0)
    buffer_store_dwordx4 v[68:71], v4, s[4:7], s31 offen offset:0
    v_cvt_pk_bf16_f32 v59, v46, v47
    v_mfma_f32_16x16x32_bf16 v[52:55], v[176:179], v[32:35], v[52:55]
    ds_write_b128 v126, v[56:59] offset:0
    v_mfma_f32_16x16x32_bf16 v[52:55], v[180:183], v[36:39], v[52:55]
    ds_read_b128 v[64:67], v127 offset:0
    v_mfma_f32_16x16x32_bf16 v[40:43], v[184:187], v[16:19], 0
    v_cvt_pk_bf16_f32 v60, v48, v49
    v_mfma_f32_16x16x32_bf16 v[40:43], v[188:191], v[20:23], v[40:43]
    v_cvt_pk_bf16_f32 v61, v50, v51
    v_and_or_b32 v60, v60, -2, s28
    v_mfma_f32_16x16x32_bf16 v[40:43], v[192:195], v[24:27], v[40:43]
    s_nop 0
    v_cvt_pk_bf16_f32 v62, v52, v53
    v_mfma_f32_16x16x32_bf16 v[44:47], v[196:199], v[16:19], 0
    s_waitcnt lgkmcnt(0)
    buffer_store_dwordx4 v[64:67], v4, s[4:7], s30 offen offset:64
    v_cvt_pk_bf16_f32 v63, v54, v55
    v_mfma_f32_16x16x32_bf16 v[44:47], v[200:203], v[20:23], v[44:47]
    ds_write_b128 v126, v[60:63] offset:1024
    v_mfma_f32_16x16x32_bf16 v[44:47], v[204:207], v[24:27], v[44:47]
    ds_read_b128 v[68:71], v127 offset:1024
    v_mfma_f32_16x16x32_bf16 v[48:51], v[184:187], v[28:31], 0
    v_cvt_pk_bf16_f32 v56, v40, v41
    v_mfma_f32_16x16x32_bf16 v[48:51], v[188:191], v[32:35], v[48:51]
    v_cvt_pk_bf16_f32 v57, v42, v43
    v_and_or_b32 v56, v56, -2, s28
    v_mfma_f32_16x16x32_bf16 v[48:51], v[192:195], v[36:39], v[48:51]
    s_nop 0
    v_cvt_pk_bf16_f32 v58, v44, v45
    v_mfma_f32_16x16x32_bf16 v[52:55], v[196:199], v[28:31], 0
    s_waitcnt lgkmcnt(0)
    buffer_store_dwordx4 v[68:71], v4, s[4:7], s31 offen offset:64
    v_cvt_pk_bf16_f32 v59, v46, v47
    v_mfma_f32_16x16x32_bf16 v[52:55], v[200:203], v[32:35], v[52:55]
    ds_write_b128 v126, v[56:59] offset:0
    v_mfma_f32_16x16x32_bf16 v[52:55], v[204:207], v[36:39], v[52:55]
    ds_read_b128 v[64:67], v127 offset:0
    v_mfma_f32_16x16x32_bf16 v[40:43], v[208:211], v[16:19], 0
    v_cvt_pk_bf16_f32 v60, v48, v49
    v_mfma_f32_16x16x32_bf16 v[40:43], v[212:215], v[20:23], v[40:43]
    v_cvt_pk_bf16_f32 v61, v50, v51
    v_and_or_b32 v60, v60, -2, s28
    v_mfma_f32_16x16x32_bf16 v[40:43], v[216:219], v[24:27], v[40:43]
    s_nop 0
    v_cvt_pk_bf16_f32 v62, v52, v53
    v_mfma_f32_16x16x32_bf16 v[44:47], v[220:223], v[16:19], 0
    s_waitcnt lgkmcnt(0)
    buffer_store_dwordx4 v[64:67], v4, s[4:7], s30 offen offset:128
    v_cvt_pk_bf16_f32 v63, v54, v55
    v_mfma_f32_16x16x32_bf16 v[44:47], v[224:227], v[20:23], v[44:47]
    ds_write_b128 v126, v[60:63] offset:1024
    v_mfma_f32_16x16x32_bf16 v[44:47], v[228:231], v[24:27], v[44:47]
    ds_read_b128 v[68:71], v127 offset:1024
    v_mfma_f32_16x16x32_bf16 v[48:51], v[208:211], v[28:31], 0
    v_cvt_pk_bf16_f32 v56, v40, v41
    v_mfma_f32_16x16x32_bf16 v[48:51], v[212:215], v[32:35], v[48:51]
    v_cvt_pk_bf16_f32 v57, v42, v43
    v_and_or_b32 v56, v56, -2, s28
    v_mfma_f32_16x16x32_bf16 v[48:51], v[216:219], v[36:39], v[48:51]
    s_nop 0
    v_cvt_pk_bf16_f32 v58, v44, v45
    v_mfma_f32_16x16x32_bf16 v[52:55], v[220:223], v[28:31], 0
    s_waitcnt lgkmcnt(0)
    buffer_store_dwordx4 v[68:71], v4, s[4:7], s31 offen offset:128
    v_cvt_pk_bf16_f32 v59, v46, v47
    v_mfma_f32_16x16x32_bf16 v[52:55], v[224:227], v[32:35], v[52:55]
    ds_write_b128 v126, v[56:59] offset:0
    v_mfma_f32_16x16x32_bf16 v[52:55], v[228:231], v[36:39], v[52:55]
    ds_read_b128 v[64:67], v127 offset:0
    v_mfma_f32_16x16x32_bf16 v[40:43], v[232:235], v[16:19], 0
    v_cvt_pk_bf16_f32 v60, v48, v49
    v_mfma_f32_16x16x32_bf16 v[40:43], v[236:239], v[20:23], v[40:43]
    v_cvt_pk_bf16_f32 v61, v50, v51
    v_and_or_b32 v60, v60, -2, s28
    v_mfma_f32_16x16x32_bf16 v[40:43], v[240:243], v[24:27], v[40:43]
    s_nop 0
    v_cvt_pk_bf16_f32 v62, v52, v53
    v_mfma_f32_16x16x32_bf16 v[44:47], v[244:247], v[16:19], 0
    s_waitcnt lgkmcnt(0)
    buffer_store_dwordx4 v[64:67], v4, s[4:7], s30 offen offset:192
    v_cvt_pk_bf16_f32 v63, v54, v55
    v_mfma_f32_16x16x32_bf16 v[44:47], v[248:251], v[20:23], v[44:47]
    ds_write_b128 v126, v[60:63] offset:1024
    v_mfma_f32_16x16x32_bf16 v[44:47], v[252:255], v[24:27], v[44:47]
    ds_read_b128 v[68:71], v127 offset:1024
    v_mfma_f32_16x16x32_bf16 v[48:51], v[232:235], v[28:31], 0
    v_cvt_pk_bf16_f32 v56, v40, v41
    v_mfma_f32_16x16x32_bf16 v[48:51], v[236:239], v[32:35], v[48:51]
    v_cvt_pk_bf16_f32 v57, v42, v43
    v_and_or_b32 v56, v56, -2, s28
    v_mfma_f32_16x16x32_bf16 v[48:51], v[240:243], v[36:39], v[48:51]
    s_nop 0
    v_cvt_pk_bf16_f32 v58, v44, v45
    v_mfma_f32_16x16x32_bf16 v[52:55], v[244:247], v[28:31], 0
    s_waitcnt lgkmcnt(0)
    buffer_store_dwordx4 v[68:71], v4, s[4:7], s31 offen offset:192
    v_cvt_pk_bf16_f32 v59, v46, v47
    v_mfma_f32_16x16x32_bf16 v[52:55], v[248:251], v[32:35], v[52:55]
    ds_write_b128 v126, v[56:59] offset:0
    v_mfma_f32_16x16x32_bf16 v[52:55], v[252:255], v[36:39], v[52:55]
    ds_read_b128 v[64:67], v127 offset:0
    v_cvt_pk_bf16_f32 v60, v48, v49
    v_cvt_pk_bf16_f32 v61, v50, v51
    v_and_or_b32 v60, v60, -2, s28
    s_nop 3
    v_cvt_pk_bf16_f32 v62, v52, v53
    s_waitcnt lgkmcnt(0)
    buffer_store_dwordx4 v[64:67], v4, s[4:7], s30 offen offset:256
    v_cvt_pk_bf16_f32 v63, v54, v55
    ds_write_b128 v126, v[60:63] offset:1024
    ds_read_b128 v[68:71], v127 offset:1024
    s_waitcnt lgkmcnt(0)
    buffer_store_dwordx4 v[68:71], v4, s[4:7], s31 offen offset:256
    s_add_u32 s30, s30, s39
    s_add_u32 s31, s31, s39
    s_cmp_eq_u32 s12, 0
    s_cselect_b32 s42, s89, 0
    s_waitcnt vmcnt(0)
    s_add_u32 s25, s32, 0
    buffer_load_dwordx4 v[72:75], v5, s[4:7], s25 offen sc1
    s_add_u32 s25, s32, 256
    buffer_load_dwordx4 v[76:79], v5, s[4:7], s25 offen sc1
    s_add_u32 s25, s32, 5120
    buffer_load_dwordx4 v[80:83], v5, s[4:7], s25 offen sc1
    s_add_u32 s25, s32, 5376
    buffer_load_dwordx4 v[84:87], v5, s[4:7], s25 offen sc1
    s_add_u32 s25, s32, 10240
    buffer_load_dwordx4 v[88:91], v5, s[4:7], s25 offen sc1
    s_add_u32 s25, s32, 10496
    buffer_load_dwordx4 v[92:95], v5, s[4:7], s25 offen sc1
    s_add_u32 s25, s32, 15360
    buffer_load_dwordx4 v[96:99], v5, s[4:7], s25 offen sc1
    s_add_u32 s25, s32, 15616
    buffer_load_dwordx4 v[100:103], v5, s[4:7], s25 offen sc1
    s_add_u32 s25, s32, 0
    buffer_load_dwordx4 v[104:107], v6, s[4:7], s25 offen sc1
    s_add_u32 s25, s32, 10240
    buffer_load_dwordx4 v[108:111], v6, s[4:7], s25 offen sc1
    s_mov_b32 s19, 0
L_Gf_red_5:
    v_mfma_f32_16x16x32_bf16 v[16:19], a[240:243], v[112:115], 0
    v_mfma_f32_16x16x32_bf16 v[20:23], a[240:243], v[120:123], 0
    v_mfma_f32_16x16x32_bf16 v[16:19], a[244:247], v[116:119], v[16:19]
    s_waitcnt vmcnt(9)
    v_mfma_f32_16x16x32_bf16 v[16:19], a[240:243], v[72:75], v[16:19]
    v_xor_b32 v12, s29, v72
    s_waitcnt vmcnt(8)
    v_mfma_f32_16x16x32_bf16 v[16:19], a[244:247], v[76:79], v[16:19]
    v_bitop3_b32 v12, v12, v76, s29 bitop3:0xf6
    s_waitcnt vmcnt(7)
    v_mfma_f32_16x16x32_bf16 v[16:19], a[240:243], v[80:83], v[16:19]
    v_bitop3_b32 v12, v12, v80, s29 bitop3:0xf6
    s_waitcnt vmcnt(6)
    v_mfma_f32_16x16x32_bf16 v[16:19], a[244:247], v[84:87], v[16:19]
    v_bitop3_b32 v12, v12, v84, s29 bitop3:0xf6
    s_waitcnt vmcnt(5)
    v_mfma_f32_16x16x32_bf16 v[16:19], a[240:243], v[88:91], v[16:19]
    v_bitop3_b32 v12, v12, v88, s29 bitop3:0xf6
    s_waitcnt vmcnt(4)
    v_mfma_f32_16x16x32_bf16 v[16:19], a[244:247], v[92:95], v[16:19]
    v_bitop3_b32 v12, v12, v92, s29 bitop3:0xf6
    s_waitcnt vmcnt(3)
    v_mfma_f32_16x16x32_bf16 v[16:19], a[240:243], v[96:99], v[16:19]
    v_bitop3_b32 v12, v12, v96, s29 bitop3:0xf6
    s_waitcnt vmcnt(2)
    v_mfma_f32_16x16x32_bf16 v[16:19], a[244:247], v[100:103], v[16:19]
    v_bitop3_b32 v12, v12, v100, s29 bitop3:0xf6
    s_waitcnt vmcnt(1)
    v_mfma_f32_16x16x32_bf16 v[20:23], a[240:243], v[104:107], v[20:23]
    v_bitop3_b32 v12, v12, v104, s29 bitop3:0xf6
    s_waitcnt vmcnt(0)
    v_mfma_f32_16x16x32_bf16 v[20:23], a[240:243], v[108:111], v[20:23]
    v_bitop3_b32 v12, v12, v108, s29 bitop3:0xf6
    v_and_b32 v12, 1, v12
    v_cmp_ne_u32 vcc, 0, v12
    s_nop 0
    s_cbranch_vccnz L_Gf_redfix_6
    s_nop 2
    v_add_f32_dpp v20, v20, v20 row_ror:8 row_mask:0xf bank_mask:0xf
    v_add_f32_dpp v21, v21, v21 row_ror:8 row_mask:0xf bank_mask:0xf
    v_add_f32_dpp v22, v22, v22 row_ror:8 row_mask:0xf bank_mask:0xf
    v_add_f32_dpp v23, v23, v23 row_ror:8 row_mask:0xf bank_mask:0xf
    buffer_load_dword v10, v9, s[4:7], s24 offen sc1
    v_cvt_pk_bf16_f32 v64, v16, v17
    v_cvt_pk_bf16_f32 v65, v18, v19
    v_cvt_pk_bf16_f32 v66, v20, v21
    v_cvt_pk_bf16_f32 v67, v22, v23
    v_lshlrev_b32 v16, 16, v64
    v_and_b32 v17, 0xffff0000, v64
    v_lshlrev_b32 v18, 16, v65
    v_and_b32 v19, 0xffff0000, v65
    v_lshlrev_b32 v20, 16, v66
    v_and_b32 v21, 0xffff0000, v66
    v_lshlrev_b32 v22, 16, v67
    v_and_b32 v23, 0xffff0000, v67
    s_cmp_lg_u32 s20, 0
    s_cbranch_scc1 L_Gf_last_7
    v_readfirstlane_b32 s86, v16
    s_nop 1
    v_pk_add_f32 v[32:33], v[16:17], s[86:87] op_sel_hi:[1,0] neg_lo:[0,1] neg_hi:[0,1]
    v_pk_add_f32 v[34:35], v[18:19], s[86:87] op_sel_hi:[1,0] neg_lo:[0,1] neg_hi:[0,1]
    v_pk_add_f32 v[36:37], v[20:21], s[86:87] op_sel_hi:[1,0] neg_lo:[0,1] neg_hi:[0,1]
    v_pk_add_f32 v[38:39], v[22:23], s[86:87] op_sel_hi:[1,0] neg_lo:[0,1] neg_hi:[0,1]
    v_pk_add_f32 v[26:27], v[32:33], v[34:35]
    v_pk_mul_f32 v[28:29], v[32:33], v[32:33]
    v_pk_fma_f32 v[28:29], v[34:35], v[34:35], v[28:29]
    v_add_f32 v30, v26, v27
    v_add_f32 v31, v28, v29
    v_pk_add_f32 v[26:27], v[36:37], v[38:39]
    v_pk_mul_f32 v[28:29], v[36:37], v[36:37]
    v_pk_fma_f32 v[28:29], v[38:39], v[38:39], v[28:29]
    v_add_f32 v24, v26, v27
    v_add_f32 v25, v28, v29
    v_cndmask_b32 v24, 0, v24, s[44:45]
    v_cndmask_b32 v25, 0, v25, s[44:45]
    v_pk_add_f32 v[24:25], v[24:25], v[30:31]
    s_nop 1
    v_add_f32_dpp v24, v24, v24 quad_perm:[1,0,3,2] row_mask:0xf bank_mask:0xf
    v_add_f32_dpp v25, v25, v25 quad_perm:[1,0,3,2] row_mask:0xf bank_mask:0xf
    s_nop 0
    v_add_f32_dpp v24, v24, v24 quad_perm:[2,3,0,1] row_mask:0xf bank_mask:0xf
    v_add_f32_dpp v25, v25, v25 quad_perm:[2,3,0,1] row_mask:0xf bank_mask:0xf
    s_nop 0
    v_add_f32_dpp v24, v24, v24 row_half_mirror row_mask:0xf bank_mask:0xf
    v_add_f32_dpp v25, v25, v25 row_half_mirror row_mask:0xf bank_mask:0xf
    s_nop 0
    v_add_f32_dpp v24, v24, v24 row_mirror row_mask:0xf bank_mask:0xf
    v_add_f32_dpp v25, v25, v25 row_mirror row_mask:0xf bank_mask:0xf
    v_mov_b32 v26, v24
    v_mov_b32 v27, v25
    s_nop 0
    v_permlane16_swap_b32 v24, v26
    v_permlane16_swap_b32 v25, v27
    v_add_f32 v24, v24, v26
    v_add_f32 v25, v25, v27
    v_mov_b32 v26, v24
    v_mov_b32 v27, v25
    s_nop 0
    v_permlane32_swap_b32 v24, v26
    v_permlane32_swap_b32 v25, v27
    v_add_f32 v24, v24, v26
    v_add_f32 v25, v25, v27
    v_mul_f32 v26, 3.1250000000e-03, v24
    v_fma_f32 v25, -v26, v24, v25
    v_add_f32 v24, s86, v26
    s_mov_b64 exec, 1
    ds_write_b64 v14, v[24:25] offset:0
    s_mov_b64 exec, -1
    s_waitcnt lgkmcnt(0)
    s_barrier
    ds_read_b128 v[40:43], v128 offset:0
    s_waitcnt lgkmcnt(0)
    v_pk_add_f32 v[24:25], v[40:41], v[42:43]
    v_sub_f32 v26, v40, v42
    v_mul_f32 v24, 0.5, v24
    v_mul_f32 v26, v26, v26
    v_mul_f32 v25, 1.5625000000e-03, v25
    v_fmac_f32 v25, 0.25, v26
    v_max_f32 v25, 0, v25
    v_cvt_pk_bf16_f32 v26, v25, v24
    v_lshlrev_b32 v25, 16, v26
    v_and_b32 v24, 0xffff0000, v26
    v_add_f32 v25, 0x3727c5ac, v25
    v_pk_add_f32 v[32:33], v[16:17], v[24:25] op_sel_hi:[1,0] neg_lo:[0,1] neg_hi:[0,1]
    v_cvt_pk_bf16_f32 v26, v25, v25
    v_pk_add_f32 v[34:35], v[18:19], v[24:25] op_sel_hi:[1,0] neg_lo:[0,1] neg_hi:[0,1]
    v_lshlrev_b32 v26, 16, v26
    v_sqrt_f32 v26, v26
    v_pk_add_f32 v[36:37], v[20:21], v[24:25] op_sel_hi:[1,0] neg_lo:[0,1] neg_hi:[0,1]
    v_pk_add_f32 v[38:39], v[22:23], v[24:25] op_sel_hi:[1,0] neg_lo:[0,1] neg_hi:[0,1]
    v_cvt_pk_bf16_f32 v68, v32, v33
    v_cvt_pk_bf16_f32 v69, v34, v35
    v_cvt_pk_bf16_f32 v70, v36, v37
    v_cvt_pk_bf16_f32 v71, v38, v39
    v_cvt_pk_bf16_f32 v26, v26, v26
    v_lshlrev_b32 v26, 16, v26
    v_rcp_f32 v26, v26
    v_lshlrev_b32 v32, 16, v68
    v_and_b32 v33, 0xffff0000, v68
    v_lshlrev_b32 v34, 16, v69
    v_and_b32 v35, 0xffff0000, v69
    v_lshlrev_b32 v36, 16, v70
    v_and_b32 v37, 0xffff0000, v70
    v_lshlrev_b32 v38, 16, v71
    v_and_b32 v39, 0xffff0000, v71
    v_pk_mul_f32 v[32:33], v[32:33], v[26:27] op_sel_hi:[1,0]
    v_pk_mul_f32 v[34:35], v[34:35], v[26:27] op_sel_hi:[1,0]
    v_pk_mul_f32 v[36:37], v[36:37], v[26:27] op_sel_hi:[1,0]
    v_pk_mul_f32 v[38:39], v[38:39], v[26:27] op_sel_hi:[1,0]
    v_cvt_pk_bf16_f32 v68, v32, v33
    v_cvt_pk_bf16_f32 v69, v34, v35
    v_cvt_pk_bf16_f32 v70, v36, v37
    v_cvt_pk_bf16_f32 v71, v38, v39
    s_nop 0
    v_permlane16_swap_b32 v68, v70
    v_permlane16_swap_b32 v69, v71
    v_permlane16_swap_b32 v64, v66
    v_permlane16_swap_b32 v65, v67
    s_mov_b32 exec_lo, 16777215
    s_mov_b32 exec_hi, 65535
    buffer_store_dwordx4 v[68:71], v7, s[4:7], s37 offen offset:0 sc1
    buffer_store_dwordx4 v[64:67], v7, s[4:7], s36 offen offset:0 sc1
    s_mov_b64 exec, -1
    s_branch L_Gf_fin_8
L_Gf_last_7:
    buffer_store_dwordx2 v[64:65], v8, s[92:95], s36 offen
    s_mov_b64 exec, s[44:45]
    buffer_store_dwordx2 v[66:67], v125, s[92:95], s36 offen
    s_mov_b64 exec, -1
L_Gf_fin_8:
    s_add_u32 s32, s32, s39
    s_sub_u32 s39, 0, s39
    s_add_u32 s22, s22, 1
    s_add_u32 s35, s35, 40960
    s_add_u32 s36, s36, 40960
    s_add_u32 s37, s37, 40960
    s_cmp_lg_u32 s89, 0
    s_cbranch_scc1 L_Gf_have_11
    s_waitcnt vmcnt(2)
    v_cmp_gt_u32 vcc, s40, v10
    s_nop 0
    s_cbranch_vccnz L_Gf_notyet_9
    s_add_u32 m0, s90, 0
    s_nop 0
    buffer_load_dwordx4 v1, s[4:7], s38 offen offset:0 sc1 lds
    s_add_u32 m0, s90, 896
    s_nop 0
    buffer_load_dwordx4 v1, s[4:7], s38 offen offset:128 sc1 lds
    s_add_u32 m0, s90, 1792
    s_nop 0
    buffer_load_dwordx4 v1, s[4:7], s38 offen offset:256 sc1 lds
    s_add_u32 m0, s90, 2688
    s_nop 0
    buffer_load_dwordx4 v1, s[4:7], s38 offen offset:384 sc1 lds
    s_add_u32 m0, s90, 3584
    s_nop 0
    buffer_load_dwordx4 v1, s[4:7], s38 offen offset:512 sc1 lds
    s_add_u32 m0, s90, 4480
    s_nop 0
    buffer_load_dwordx4 v1, s[4:7], s38 offen offset:640 sc1 lds
    s_add_u32 m0, s90, 5376
    s_nop 0
    buffer_load_dwordx4 v1, s[4:7], s38 offen offset:768 sc1 lds
    s_add_u32 m0, s90, 6272
    s_nop 0
    buffer_load_dwordx4 v1, s[4:7], s38 offen offset:896 sc1 lds
    s_add_u32 m0, s90, 7168
    s_nop 0
    buffer_load_dwordx4 v1, s[4:7], s38 offen offset:1024 sc1 lds
    s_add_u32 m0, s90, 8064
    s_nop 0
    buffer_load_dwordx4 v1, s[4:7], s38 offen offset:1152 sc1 lds
    s_mov_b32 s89, 1
    s_waitcnt vmcnt(10)
    s_branch L_Gf_notyet_9b
L_Gf_notyet_9:
    buffer_load_dword v10, v9, s[4:7], s24 offen sc1
    s_waitcnt vmcnt(0)
L_Gf_notyet_9b:
    s_barrier
    s_cmp_lg_u32 s12, 0
    s_cbranch_scc1 L_Gf_nofl_10
    v_mov_b32 v11, s22
    s_mov_b64 exec, 1
    buffer_store_dword v11, v0, s[4:7], s23 offen offset:0 sc1
    s_mov_b64 exec, -1
L_Gf_nofl_10:
    s_cmp_eq_u32 s22, 64
    s_cbranch_scc1 L_Gf_top_end
    s_cmp_lg_u32 s89, 0
    s_cbranch_scc1 L_Gf_have_11
    s_mov_b32 s19, 0
    v_cmp_gt_u32 vcc, s40, v10
    s_nop 0
    s_cbranch_vccnz L_Gf_flspin_13
L_Gf_fl_12:
    s_add_u32 m0, s90, 0
    s_nop 0
    buffer_load_dwordx4 v1, s[4:7], s38 offen offset:0 sc1 lds
    s_add_u32 m0, s90, 896
    s_nop 0
    buffer_load_dwordx4 v1, s[4:7], s38 offen offset:128 sc1 lds
    s_add_u32 m0, s90, 1792
    s_nop 0
    buffer_load_dwordx4 v1, s[4:7], s38 offen offset:256 sc1 lds
    s_add_u32 m0, s90, 2688
    s_nop 0
    buffer_load_dwordx4 v1, s[4:7], s38 offen offset:384 sc1 lds
    s_add_u32 m0, s90, 3584
    s_nop 0
    buffer_load_dwordx4 v1, s[4:7], s38 offen offset:512 sc1 lds
    s_add_u32 m0, s90, 4480
    s_nop 0
    buffer_load_dwordx4 v1, s[4:7], s38 offen offset:640 sc1 lds
    s_add_u32 m0, s90, 5376
    s_nop 0
    buffer_load_dwordx4 v1, s[4:7], s38 offen offset:768 sc1 lds
    s_add_u32 m0, s90, 6272
    s_nop 0
    buffer_load_dwordx4 v1, s[4:7], s38 offen offset:896 sc1 lds
    s_add_u32 m0, s90, 7168
    s_nop 0
    buffer_load_dwordx4 v1, s[4:7], s38 offen offset:1024 sc1 lds
    s_add_u32 m0, s90, 8064
    s_nop 0
    buffer_load_dwordx4 v1, s[4:7], s38 offen offset:1152 sc1 lds
L_Gf_have_11:
    s_branch L_Gf_top
L_Gf_top_end:
    s_waitcnt vmcnt(0)
    s_endpgm
L_Gf_redfix_6:
    s_add_u32 s25, s32, 0
    buffer_load_dwordx4 v[72:75], v5, s[4:7], s25 offen sc1
    s_add_u32 s25, s32, 256
    buffer_load_dwordx4 v[76:79], v5, s[4:7], s25 offen sc1
    s_add_u32 s25, s32, 5120
    buffer_load_dwordx4 v[80:83], v5, s[4:7], s25 offen sc1
    s_add_u32 s25, s32, 5376
    buffer_load_dwordx4 v[84:87], v5, s[4:7], s25 offen sc1
    s_add_u32 s25, s32, 10240
    buffer_load_dwordx4 v[88:91], v5, s[4:7], s25 offen sc1
    s_add_u32 s25, s32, 10496
    buffer_load_dwordx4 v[92:95], v5, s[4:7], s25 offen sc1
    s_add_u32 s25, s32, 15360
    buffer_load_dwordx4 v[96:99], v5, s[4:7], s25 offen sc1
    s_add_u32 s25, s32, 15616
    buffer_load_dwordx4 v[100:103], v5, s[4:7], s25 offen sc1
    s_add_u32 s25, s32, 0
    buffer_load_dwordx4 v[104:107], v6, s[4:7], s25 offen sc1
    s_add_u32 s25, s32, 10240
    buffer_load_dwordx4 v[108:111], v6, s[4:7], s25 offen sc1
    s_add_u32 s19, s19, 1
    s_cmp_lt_u32 s19, 524288
    s_cbranch_scc1 L_Gf_red_5
    s_branch L_fail
L_Gf_flspin_13:
    buffer_load_dword v10, v9, s[4:7], s24 offen sc1
    s_add_u32 s19, s19, 1
    s_cmp_ge_u32 s19, 524288
    s_cbranch_scc1 L_fail
    s_waitcnt vmcnt(0)
    v_cmp_gt_u32 vcc, s40, v10
    s_nop 0
    s_cbranch_vccnz L_Gf_flspin_13
    s_branch L_Gf_fl_12
L_G_slow:
L_Gs_top:
    s_lshr_b32 s25, s22, 1
    s_andn2_b32 s28, 1, s25
    s_sub_u32 s29, 0, s28
    s_add_u32 s40, s22, 2
    s_cmp_eq_u32 s22, 63
    s_cselect_b32 s40, -1, s40
    s_add_u32 s27, s22, 3
    s_cmp_ge_u32 s22, 62
    s_cselect_b32 s27, -1, s27
    s_add_u32 s38, s38, 40960
    s_add_u32 s90, s90, s91
    s_sub_u32 s91, 0, s91
    v_add_u32 v2, s91, v2
    v_add_u32 v3, s91, v3
    s_mov_b32 s89, s43
    s_cmp_eq_u32 s89, 0
    s_cbranch_scc1 L_Gs_plain_1
    s_waitcnt vmcnt(8)
    s_barrier
    ds_read_b128 v[16:19], v2 offset:0
    ds_read_b128 v[20:23], v2 offset:20480
    ds_read_b128 v[24:27], v3 offset:0
    ds_read_b128 v[28:31], v3 offset:20480
    ds_read_b128 v[32:35], v2 offset:1024
    ds_read_b128 v[36:39], v2 offset:21504
    s_waitcnt lgkmcnt(4)
    v_mfma_f32_16x16x32_bf16 v[40:43], a[0:3], v[16:19], 0
    s_add_u32 m0, s90, 0
    s_nop 0
    buffer_load_dwordx4 v1, s[4:7], s38 offen offset:0 sc1 lds
    v_mfma_f32_16x16x32_bf16 v[44:47], a[0:3], v[20:23], 0
    v_mfma_f32_16x16x32_bf16 v[48:51], a[80:83], v[16:19], 0
    v_mfma_f32_16x16x32_bf16 v[52:55], a[80:83], v[20:23], 0
    v_mfma_f32_16x16x32_bf16 v[56:59], a[160:163], v[16:19], 0
    v_mfma_f32_16x16x32_bf16 v[60:63], a[160:163], v[20:23], 0
    ds_read_b128 v[16:19], v3 offset:1024
    ds_read_b128 v[20:23], v3 offset:21504
    s_waitcnt lgkmcnt(4)
    v_mfma_f32_16x16x32_bf16 v[40:43], a[4:7], v[24:27], v[40:43]
    s_add_u32 m0, s90, 896
    s_nop 0
    buffer_load_dwordx4 v1, s[4:7], s38 offen offset:128 sc1 lds
    v_mfma_f32_16x16x32_bf16 v[44:47], a[4:7], v[28:31], v[44:47]
    v_mfma_f32_16x16x32_bf16 v[48:51], a[84:87], v[24:27], v[48:51]
    v_mfma_f32_16x16x32_bf16 v[52:55], a[84:87], v[28:31], v[52:55]
    v_mfma_f32_16x16x32_bf16 v[56:59], a[164:167], v[24:27], v[56:59]
    v_mfma_f32_16x16x32_bf16 v[60:63], a[164:167], v[28:31], v[60:63]
    s_waitcnt vmcnt(8)
    s_barrier
    ds_read_b128 v[24:27], v2 offset:2048
    ds_read_b128 v[28:31], v2 offset:22528
    s_waitcnt lgkmcnt(4)
    v_mfma_f32_16x16x32_bf16 v[40:43], a[8:11], v[32:35], v[40:43]
    s_add_u32 m0, s90, 1792
    s_nop 0
    buffer_load_dwordx4 v1, s[4:7], s38 offen offset:256 sc1 lds
    v_mfma_f32_16x16x32_bf16 v[44:47], a[8:11], v[36:39], v[44:47]
    v_mfma_f32_16x16x32_bf16 v[48:51], a[88:91], v[32:35], v[48:51]
    v_mfma_f32_16x16x32_bf16 v[52:55], a[88:91], v[36:39], v[52:55]
    v_mfma_f32_16x16x32_bf16 v[56:59], a[168:171], v[32:35], v[56:59]
    v_mfma_f32_16x16x32_bf16 v[60:63], a[168:171], v[36:39], v[60:63]
    ds_read_b128 v[32:35], v3 offset:2048
    ds_read_b128 v[36:39], v3 offset:22528
    s_waitcnt lgkmcnt(4)
    v_mfma_f32_16x16x32_bf16 v[40:43], a[12:15], v[16:19], v[40:43]
    s_add_u32 m0, s90, 2688
    s_nop 0
    buffer_load_dwordx4 v1, s[4:7], s38 offen offset:384 sc1 lds
    v_mfma_f32_16x16x32_bf16 v[44:47], a[12:15], v[20:23], v[44:47]
    v_mfma_f32_16x16x32_bf16 v[48:51], a[92:95], v[16:19], v[48:51]
    v_mfma_f32_16x16x32_bf16 v[52:55], a[92:95], v[20:23], v[52:55]
    v_mfma_f32_16x16x32_bf16 v[56:59], a[172:175], v[16:19], v[56:59]
    v_mfma_f32_16x16x32_bf16 v[60:63], a[172:175], v[20:23], v[60:63]
    ds_read_b128 v[16:19], v2 offset:3072
    ds_read_b128 v[20:23], v2 offset:23552
    s_waitcnt lgkmcnt(4)
    v_mfma_f32_16x16x32_bf16 v[40:43], a[16:19], v[24:27], v[40:43]
    s_add_u32 m0, s90, 3584
    s_nop 0
    buffer_load_dwordx4 v1, s[4:7], s38 offen offset:512 sc1 lds
    v_mfma_f32_16x16x32_bf16 v[44:47], a[16:19], v[28:31], v[44:47]
    v_mfma_f32_16x16x32_bf16 v[48:51], a[96:99], v[24:27], v[48:51]
    v_mfma_f32_16x16x32_bf16 v[52:55], a[96:99], v[28:31], v[52:55]
    v_mfma_f32_16x16x32_bf16 v[56:59], a[176:179], v[24:27], v[56:59]
    v_mfma_f32_16x16x32_bf16 v[60:63], a[176:179], v[28:31], v[60:63]
    ds_read_b128 v[24:27], v3 offset:3072
    ds_read_b128 v[28:31], v3 offset:23552
    s_waitcnt lgkmcnt(4)
    v_mfma_f32_16x16x32_bf16 v[40:43], a[20:23], v[32:35], v[40:43]
    s_add_u32 m0, s90, 4480
    s_nop 0
    buffer_load_dwordx4 v1, s[4:7], s38 offen offset:640 sc1 lds
    v_mfma_f32_16x16x32_bf16 v[44:47], a[20:23], v[36:39], v[44:47]
    v_mfma_f32_16x16x32_bf16 v[48:51], a[100:103], v[32:35], v[48:51]
    v_mfma_f32_16x16x32_bf16 v[52:55], a[100:103], v[36:39], v[52:55]
    v_mfma_f32_16x16x32_bf16 v[56:59], a[180:183], v[32:35], v[56:59]
    v_mfma_f32_16x16x32_bf16 v[60:63], a[180:183], v[36:39], v[60:63]
    s_waitcnt vmcnt(9)
    s_barrier
    ds_read_b128 v[32:35], v2 offset:4096
    ds_read_b128 v[36:39], v2 offset:24576
    s_waitcnt lgkmcnt(4)
    v_mfma_f32_16x16x32_bf16 v[40:43], a[24:27], v[16:19], v[40:43]
    s_add_u32 m0, s90, 5376
    s_nop 0
    buffer_load_dwordx4 v1, s[4:7], s38 offen offset:768 sc1 lds
    v_mfma_f32_16x16x32_bf16 v[44:47], a[24:27], v[20:23], v[44:47]
    v_mfma_f32_16x16x32_bf16 v[48:51], a[104:107], v[16:19], v[48:51]
    v_mfma_f32_16x16x32_bf16 v[52:55], a[104:107], v[20:23], v[52:55]
    v_mfma_f32_16x16x32_bf16 v[56:59], a[184:187], v[16:19], v[56:59]
    v_mfma_f32_16x16x32_bf16 v[60:63], a[184:187], v[20:23], v[60:63]
    ds_read_b128 v[16:19], v3 offset:4096
    ds_read_b128 v[20:23], v3 offset:24576
    s_waitcnt lgkmcnt(4)
    v_mfma_f32_16x16x32_bf16 v[40:43], a[28:31], v[24:27], v[40:43]
    s_add_u32 m0, s90, 6272
    s_nop 0
    buffer_load_dwordx4 v1, s[4:7], s38 offen offset:896 sc1 lds
    v_mfma_f32_16x16x32_bf16 v[44:47], a[28:31], v[28:31], v[44:47]
    v_mfma_f32_16x16x32_bf16 v[48:51], a[108:111], v[24:27], v[48:51]
    v_mfma_f32_16x16x32_bf16 v[52:55], a[108:111], v[28:31], v[52:55]
    v_mfma_f32_16x16x32_bf16 v[56:59], a[188:191], v[24:27], v[56:59]
    v_mfma_f32_16x16x32_bf16 v[60:63], a[188:191], v[28:31], v[60:63]
    ds_read_b128 v[24:27], v2 offset:5120
    ds_read_b128 v[28:31], v2 offset:25600
    s_waitcnt lgkmcnt(4)
    v_mfma_f32_16x16x32_bf16 v[40:43], a[32:35], v[32:35], v[40:43]
    s_add_u32 m0, s90, 7168
    s_nop 0
    buffer_load_dwordx4 v1, s[4:7], s38 offen offset:1024 sc1 lds
    v_mfma_f32_16x16x32_bf16 v[44:47], a[32:35], v[36:39], v[44:47]
    v_mfma_f32_16x16x32_bf16 v[48:51], a[112:115], v[32:35], v[48:51]
    v_mfma_f32_16x16x32_bf16 v[52:55], a[112:115], v[36:39], v[52:55]
    v_mfma_f32_16x16x32_bf16 v[56:59], a[192:195], v[32:35], v[56:59]
    v_mfma_f32_16x16x32_bf16 v[60:63], a[192:195], v[36:39], v[60:63]
    ds_read_b128 v[32:35], v3 offset:5120
    ds_read_b128 v[36:39], v3 offset:25600
    s_waitcnt lgkmcnt(4)
    v_mfma_f32_16x16x32_bf16 v[40:43], a[36:39], v[16:19], v[40:43]
    s_add_u32 m0, s90, 8064
    s_nop 0
    buffer_load_dwordx4 v1, s[4:7], s38 offen offset:1152 sc1 lds
    v_mfma_f32_16x16x32_bf16 v[44:47], a[36:39], v[20:23], v[44:47]
    v_mfma_f32_16x16x32_bf16 v[48:51], a[116:119], v[16:19], v[48:51]
    v_mfma_f32_16x16x32_bf16 v[52:55], a[116:119], v[20:23], v[52:55]
    v_mfma_f32_16x16x32_bf16 v[56:59], a[196:199], v[16:19], v[56:59]
    v_mfma_f32_16x16x32_bf16 v[60:63], a[196:199], v[20:23], v[60:63]
    ds_read_b128 v[16:19], v2 offset:6144
    ds_read_b128 v[20:23], v2 offset:26624
    s_waitcnt lgkmcnt(4)
    v_mfma_f32_16x16x32_bf16 v[40:43], a[40:43], v[24:27], v[40:43]
    v_mfma_f32_16x16x32_bf16 v[44:47], a[40:43], v[28:31], v[44:47]
    v_mfma_f32_16x16x32_bf16 v[48:51], a[120:123], v[24:27], v[48:51]
    v_mfma_f32_16x16x32_bf16 v[52:55], a[120:123], v[28:31], v[52:55]
    v_mfma_f32_16x16x32_bf16 v[56:59], a[200:203], v[24:27], v[56:59]
    v_mfma_f32_16x16x32_bf16 v[60:63], a[200:203], v[28:31], v[60:63]
    ds_read_b128 v[24:27], v3 offset:6144
    ds_read_b128 v[28:31], v3 offset:26624
    s_waitcnt lgkmcnt(4)
    v_mfma_f32_16x16x32_bf16 v[40:43], a[44:47], v[32:35], v[40:43]
    v_mfma_f32_16x16x32_bf16 v[44:47], a[44:47], v[36:39], v[44:47]
    v_mfma_f32_16x16x32_bf16 v[48:51], a[124:127], v[32:35], v[48:51]
    v_mfma_f32_16x16x32_bf16 v[52:55], a[124:127], v[36:39], v[52:55]
    v_mfma_f32_16x16x32_bf16 v[56:59], a[204:207], v[32:35], v[56:59]
    v_mfma_f32_16x16x32_bf16 v[60:63], a[204:207], v[36:39], v[60:63]
    s_waitcnt vmcnt(10)
    s_barrier
    s_cmp_eq_u32 s42, 0
    s_cbranch_scc1 L_Gs_nopend_3
    v_mov_b32 v11, s22
    s_mov_b64 exec, 1
    buffer_store_dword v11, v0, s[4:7], s23 offen offset:0 sc1
    s_mov_b64 exec, -1
L_Gs_nopend_3:
    buffer_load_dwordx4 v[112:115], v131, s[4:7], s35 offen offset:0 sc1
    buffer_load_dwordx4 v[116:119], v131, s[4:7], s35 offen offset:256 sc1
    buffer_load_dwordx4 v[120:123], v124, s[4:7], s35 offen offset:0 sc1
    buffer_load_dword v10, v9, s[4:7], s24 offen sc1
    ds_read_b128 v[32:35], v2 offset:7168
    ds_read_b128 v[36:39], v2 offset:27648
    s_waitcnt lgkmcnt(4)
    v_mfma_f32_16x16x32_bf16 v[40:43], a[48:51], v[16:19], v[40:43]
    v_mfma_f32_16x16x32_bf16 v[44:47], a[48:51], v[20:23], v[44:47]
    v_mfma_f32_16x16x32_bf16 v[48:51], a[128:131], v[16:19], v[48:51]
    v_mfma_f32_16x16x32_bf16 v[52:55], a[128:131], v[20:23], v[52:55]
    v_mfma_f32_16x16x32_bf16 v[56:59], a[208:211], v[16:19], v[56:59]
    v_mfma_f32_16x16x32_bf16 v[60:63], a[208:211], v[20:23], v[60:63]
    ds_read_b128 v[16:19], v3 offset:7168
    ds_read_b128 v[20:23], v3 offset:27648
    s_waitcnt lgkmcnt(4)
    v_mfma_f32_16x16x32_bf16 v[40:43], a[52:55], v[24:27], v[40:43]
    v_mfma_f32_16x16x32_bf16 v[44:47], a[52:55], v[28:31], v[44:47]
    v_mfma_f32_16x16x32_bf16 v[48:51], a[132:135], v[24:27], v[48:51]
    v_mfma_f32_16x16x32_bf16 v[52:55], a[132:135], v[28:31], v[52:55]
    v_mfma_f32_16x16x32_bf16 v[56:59], a[212:215], v[24:27], v[56:59]
    v_mfma_f32_16x16x32_bf16 v[60:63], a[212:215], v[28:31], v[60:63]
    ds_read_b128 v[24:27], v2 offset:8192
    ds_read_b128 v[28:31], v2 offset:28672
    s_waitcnt lgkmcnt(4)
    v_mfma_f32_16x16x32_bf16 v[40:43], a[56:59], v[32:35], v[40:43]
    v_mfma_f32_16x16x32_bf16 v[44:47], a[56:59], v[36:39], v[44:47]
    v_mfma_f32_16x16x32_bf16 v[48:51], a[136:139], v[32:35], v[48:51]
    v_mfma_f32_16x16x32_bf16 v[52:55], a[136:139], v[36:39], v[52:55]
    v_mfma_f32_16x16x32_bf16 v[56:59], a[216:219], v[32:35], v[56:59]
    v_mfma_f32_16x16x32_bf16 v[60:63], a[216:219], v[36:39], v[60:63]
    ds_read_b128 v[32:35], v3 offset:8192
    ds_read_b128 v[36:39], v3 offset:28672
    s_waitcnt lgkmcnt(4)
    v_mfma_f32_16x16x32_bf16 v[40:43], a[60:63], v[16:19], v[40:43]
    v_mfma_f32_16x16x32_bf16 v[44:47], a[60:63], v[20:23], v[44:47]
    v_mfma_f32_16x16x32_bf16 v[48:51], a[140:143], v[16:19], v[48:51]
    v_mfma_f32_16x16x32_bf16 v[52:55], a[140:143], v[20:23], v[52:55]
    v_mfma_f32_16x16x32_bf16 v[56:59], a[220:223], v[16:19], v[56:59]
    v_mfma_f32_16x16x32_bf16 v[60:63], a[220:223], v[20:23], v[60:63]
    ds_read_b128 v[16:19], v2 offset:9216
    ds_read_b128 v[20:23], v2 offset:29696
    s_waitcnt lgkmcnt(4)
    v_mfma_f32_16x16x32_bf16 v[40:43], a[64:67], v[24:27], v[40:43]
    v_mfma_f32_16x16x32_bf16 v[44:47], a[64:67], v[28:31], v[44:47]
    v_mfma_f32_16x16x32_bf16 v[48:51], a[144:147], v[24:27], v[48:51]
    v_mfma_f32_16x16x32_bf16 v[52:55], a[144:147], v[28:31], v[52:55]
    v_mfma_f32_16x16x32_bf16 v[56:59], a[224:227], v[24:27], v[56:59]
    v_mfma_f32_16x16x32_bf16 v[60:63], a[224:227], v[28:31], v[60:63]
    ds_read_b128 v[24:27], v3 offset:9216
    ds_read_b128 v[28:31], v3 offset:29696
    s_waitcnt lgkmcnt(4)
    v_mfma_f32_16x16x32_bf16 v[40:43], a[68:71], v[32:35], v[40:43]
    v_mfma_f32_16x16x32_bf16 v[44:47], a[68:71], v[36:39], v[44:47]
    v_mfma_f32_16x16x32_bf16 v[48:51], a[148:151], v[32:35], v[48:51]
    v_mfma_f32_16x16x32_bf16 v[52:55], a[148:151], v[36:39], v[52:55]
    v_mfma_f32_16x16x32_bf16 v[56:59], a[228:231], v[32:35], v[56:59]
    v_mfma_f32_16x16x32_bf16 v[60:63], a[228:231], v[36:39], v[60:63]
    s_waitcnt lgkmcnt(2)
    v_mfma_f32_16x16x32_bf16 v[40:43], a[72:75], v[16:19], v[40:43]
    v_mfma_f32_16x16x32_bf16 v[44:47], a[72:75], v[20:23], v[44:47]
    v_mfma_f32_16x16x32_bf16 v[48:51], a[152:155], v[16:19], v[48:51]
    v_mfma_f32_16x16x32_bf16 v[52:55], a[152:155], v[20:23], v[52:55]
    v_mfma_f32_16x16x32_bf16 v[56:59], a[232:235], v[16:19], v[56:59]
    v_mfma_f32_16x16x32_bf16 v[60:63], a[232:235], v[20:23], v[60:63]
    s_waitcnt lgkmcnt(0)
    v_mfma_f32_16x16x32_bf16 v[40:43], a[76:79], v[24:27], v[40:43]
    v_mfma_f32_16x16x32_bf16 v[44:47], a[76:79], v[28:31], v[44:47]
    v_mfma_f32_16x16x32_bf16 v[48:51], a[156:159], v[24:27], v[48:51]
    v_mfma_f32_16x16x32_bf16 v[52:55], a[156:159], v[28:31], v[52:55]
    v_mfma_f32_16x16x32_bf16 v[56:59], a[236:239], v[24:27], v[56:59]
    v_mfma_f32_16x16x32_bf16 v[60:63], a[236:239], v[28:31], v[60:63]
    s_branch L_Gs_act_2
L_Gs_plain_1:
    s_waitcnt vmcnt(8)
    s_barrier
    ds_read_b128 v[16:19], v2 offset:0
    ds_read_b128 v[20:23], v2 offset:20480
    ds_read_b128 v[24:27], v3 offset:0
    ds_read_b128 v[28:31], v3 offset:20480
    ds_read_b128 v[32:35], v2 offset:1024
    ds_read_b128 v[36:39], v2 offset:21504
    s_waitcnt lgkmcnt(4)
    v_mfma_f32_16x16x32_bf16 v[40:43], a[0:3], v[16:19], 0
    v_mfma_f32_16x16x32_bf16 v[44:47], a[0:3], v[20:23], 0
    v_mfma_f32_16x16x32_bf16 v[48:51], a[80:83], v[16:19], 0
    v_mfma_f32_16x16x32_bf16 v[52:55], a[80:83], v[20:23], 0
    v_mfma_f32_16x16x32_bf16 v[56:59], a[160:163], v[16:19], 0
    v_mfma_f32_16x16x32_bf16 v[60:63], a[160:163], v[20:23], 0
    ds_read_b128 v[16:19], v3 offset:1024
    ds_read_b128 v[20:23], v3 offset:21504
    s_waitcnt lgkmcnt(4)
    v_mfma_f32_16x16x32_bf16 v[40:43], a[4:7], v[24:27], v[40:43]
    v_mfma_f32_16x16x32_bf16 v[44:47], a[4:7], v[28:31], v[44:47]
    v_mfma_f32_16x16x32_bf16 v[48:51], a[84:87], v[24:27], v[48:51]
    v_mfma_f32_16x16x32_bf16 v[52:55], a[84:87], v[28:31], v[52:55]
    v_mfma_f32_16x16x32_bf16 v[56:59], a[164:167], v[24:27], v[56:59]
    v_mfma_f32_16x16x32_bf16 v[60:63], a[164:167], v[28:31], v[60:63]
    s_waitcnt vmcnt(6)
    s_barrier
    ds_read_b128 v[24:27], v2 offset:2048
    ds_read_b128 v[28:31], v2 offset:22528
    s_waitcnt lgkmcnt(4)
    v_mfma_f32_16x16x32_bf16 v[40:43], a[8:11], v[32:35], v[40:43]
    v_mfma_f32_16x16x32_bf16 v[44:47], a[8:11], v[36:39], v[44:47]
    v_mfma_f32_16x16x32_bf16 v[48:51], a[88:91], v[32:35], v[48:51]
    v_mfma_f32_16x16x32_bf16 v[52:55], a[88:91], v[36:39], v[52:55]
    v_mfma_f32_16x16x32_bf16 v[56:59], a[168:171], v[32:35], v[56:59]
    v_mfma_f32_16x16x32_bf16 v[60:63], a[168:171], v[36:39], v[60:63]
    ds_read_b128 v[32:35], v3 offset:2048
    ds_read_b128 v[36:39], v3 offset:22528
    s_waitcnt lgkmcnt(4)
    v_mfma_f32_16x16x32_bf16 v[40:43], a[12:15], v[16:19], v[40:43]
    v_mfma_f32_16x16x32_bf16 v[44:47], a[12:15], v[20:23], v[44:47]
    v_mfma_f32_16x16x32_bf16 v[48:51], a[92:95], v[16:19], v[48:51]
    v_mfma_f32_16x16x32_bf16 v[52:55], a[92:95], v[20:23], v[52:55]
    v_mfma_f32_16x16x32_bf16 v[56:59], a[172:175], v[16:19], v[56:59]
    v_mfma_f32_16x16x32_bf16 v[60:63], a[172:175], v[20:23], v[60:63]
    ds_read_b128 v[16:19], v2 offset:3072
    ds_read_b128 v[20:23], v2 offset:23552
    s_waitcnt lgkmcnt(4)
    v_mfma_f32_16x16x32_bf16 v[40:43], a[16:19], v[24:27], v[40:43]
    v_mfma_f32_16x16x32_bf16 v[44:47], a[16:19], v[28:31], v[44:47]
    v_mfma_f32_16x16x32_bf16 v[48:51], a[96:99], v[24:27], v[48:51]
    v_mfma_f32_16x16x32_bf16 v[52:55], a[96:99], v[28:31], v[52:55]
    v_mfma_f32_16x16x32_bf16 v[56:59], a[176:179], v[24:27], v[56:59]
    v_mfma_f32_16x16x32_bf16 v[60:63], a[176:179], v[28:31], v[60:63]
    ds_read_b128 v[24:27], v3 offset:3072
    ds_read_b128 v[28:31], v3 offset:23552
    s_waitcnt lgkmcnt(4)
    v_mfma_f32_16x16x32_bf16 v[40:43], a[20:23], v[32:35], v[40:43]
    v_mfma_f32_16x16x32_bf16 v[44:47], a[20:23], v[36:39], v[44:47]
    v_mfma_f32_16x16x32_bf16 v[48:51], a[100:103], v[32:35], v[48:51]
    v_mfma_f32_16x16x32_bf16 v[52:55], a[100:103], v[36:39], v[52:55]
    v_mfma_f32_16x16x32_bf16 v[56:59], a[180:183], v[32:35], v[56:59]
    v_mfma_f32_16x16x32_bf16 v[60:63], a[180:183], v[36:39], v[60:63]
    s_waitcnt vmcnt(3)
    s_barrier
    ds_read_b128 v[32:35], v2 offset:4096
    ds_read_b128 v[36:39], v2 offset:24576
    s_waitcnt lgkmcnt(4)
    v_mfma_f32_16x16x32_bf16 v[40:43], a[24:27], v[16:19], v[40:43]
    v_mfma_f32_16x16x32_bf16 v[44:47], a[24:27], v[20:23], v[44:47]
    v_mfma_f32_16x16x32_bf16 v[48:51], a[104:107], v[16:19], v[48:51]
    v_mfma_f32_16x16x32_bf16 v[52:55], a[104:107], v[20:23], v[52:55]
    v_mfma_f32_16x16x32_bf16 v[56:59], a[184:187], v[16:19], v[56:59]
    v_mfma_f32_16x16x32_bf16 v[60:63], a[184:187], v[20:23], v[60:63]
    ds_read_b128 v[16:19], v3 offset:4096
    ds_read_b128 v[20:23], v3 offset:24576
    s_waitcnt lgkmcnt(4)
    v_mfma_f32_16x16x32_bf16 v[40:43], a[28:31], v[24:27], v[40:43]
    v_mfma_f32_16x16x32_bf16 v[44:47], a[28:31], v[28:31], v[44:47]
    v_mfma_f32_16x16x32_bf16 v[48:51], a[108:111], v[24:27], v[48:51]
    v_mfma_f32_16x16x32_bf16 v[52:55], a[108:111], v[28:31], v[52:55]
    v_mfma_f32_16x16x32_bf16 v[56:59], a[188:191], v[24:27], v[56:59]
    v_mfma_f32_16x16x32_bf16 v[60:63], a[188:191], v[28:31], v[60:63]
    ds_read_b128 v[24:27], v2 offset:5120
    ds_read_b128 v[28:31], v2 offset:25600
    s_waitcnt lgkmcnt(4)
    v_mfma_f32_16x16x32_bf16 v[40:43], a[32:35], v[32:35], v[40:43]
    v_mfma_f32_16x16x32_bf16 v[44:47], a[32:35], v[36:39], v[44:47]
    v_mfma_f32_16x16x32_bf16 v[48:51], a[112:115], v[32:35], v[48:51]
    v_mfma_f32_16x16x32_bf16 v[52:55], a[112:115], v[36:39], v[52:55]
    v_mfma_f32_16x16x32_bf16 v[56:59], a[192:195], v[32:35], v[56:59]
    v_mfma_f32_16x16x32_bf16 v[60:63], a[192:195], v[36:39], v[60:63]
    ds_read_b128 v[32:35], v3 offset:5120
    ds_read_b128 v[36:39], v3 offset:25600
    s_waitcnt lgkmcnt(4)
    v_mfma_f32_16x16x32_bf16 v[40:43], a[36:39], v[16:19], v[40:43]
    v_mfma_f32_16x16x32_bf16 v[44:47], a[36:39], v[20:23], v[44:47]
    v_mfma_f32_16x16x32_bf16 v[48:51], a[116:119], v[16:19], v[48:51]
    v_mfma_f32_16x16x32_bf16 v[52:55], a[116:119], v[20:23], v[52:55]
    v_mfma_f32_16x16x32_bf16 v[56:59], a[196:199], v[16:19], v[56:59]
    v_mfma_f32_16x16x32_bf16 v[60:63], a[196:199], v[20:23], v[60:63]
    ds_read_b128 v[16:19], v2 offset:6144
    ds_read_b128 v[20:23], v2 offset:26624
    s_waitcnt lgkmcnt(4)
    v_mfma_f32_16x16x32_bf16 v[40:43], a[40:43], v[24:27], v[40:43]
    v_mfma_f32_16x16x32_bf16 v[44:47], a[40:43], v[28:31], v[44:47]
    v_mfma_f32_16x16x32_bf16 v[48:51], a[120:123], v[24:27], v[48:51]
    v_mfma_f32_16x16x32_bf16 v[52:55], a[120:123], v[28:31], v[52:55]
    v_mfma_f32_16x16x32_bf16 v[56:59], a[200:203], v[24:27], v[56:59]
    v_mfma_f32_16x16x32_bf16 v[60:63], a[200:203], v[28:31], v[60:63]
    ds_read_b128 v[24:27], v3 offset:6144
    ds_read_b128 v[28:31], v3 offset:26624
    s_waitcnt lgkmcnt(4)
    v_mfma_f32_16x16x32_bf16 v[40:43], a[44:47], v[32:35], v[40:43]
    v_mfma_f32_16x16x32_bf16 v[44:47], a[44:47], v[36:39], v[44:47]
    v_mfma_f32_16x16x32_bf16 v[48:51], a[124:127], v[32:35], v[48:51]
    v_mfma_f32_16x16x32_bf16 v[52:55], a[124:127], v[36:39], v[52:55]
    v_mfma_f32_16x16x32_bf16 v[56:59], a[204:207], v[32:35], v[56:59]
    v_mfma_f32_16x16x32_bf16 v[60:63], a[204:207], v[36:39], v[60:63]
    s_waitcnt vmcnt(0)
    s_barrier
    s_cmp_eq_u32 s42, 0
    s_cbranch_scc1 L_Gs_nopend_4
    v_mov_b32 v11, s22
    s_mov_b64 exec, 1
    buffer_store_dword v11, v0, s[4:7], s23 offen offset:0 sc1
    s_mov_b64 exec, -1
L_Gs_nopend_4:
    buffer_load_dwordx4 v[112:115], v131, s[4:7], s35 offen offset:0 sc1
    buffer_load_dwordx4 v[116:119], v131, s[4:7], s35 offen offset:256 sc1
    buffer_load_dwordx4 v[120:123], v124, s[4:7], s35 offen offset:0 sc1
    buffer_load_dword v10, v9, s[4:7], s24 offen sc1
    ds_read_b128 v[32:35], v2 offset:7168
    ds_read_b128 v[36:39], v2 offset:27648
    s_waitcnt lgkmcnt(4)
    v_mfma_f32_16x16x32_bf16 v[40:43], a[48:51], v[16:19], v[40:43]
    v_mfma_f32_16x16x32_bf16 v[44:47], a[48:51], v[20:23], v[44:47]
    v_mfma_f32_16x16x32_bf16 v[48:51], a[128:131], v[16:19], v[48:51]
    v_mfma_f32_16x16x32_bf16 v[52:55], a[128:131], v[20:23], v[52:55]
    v_mfma_f32_16x16x32_bf16 v[56:59], a[208:211], v[16:19], v[56:59]
    v_mfma_f32_16x16x32_bf16 v[60:63], a[208:211], v[20:23], v[60:63]
    ds_read_b128 v[16:19], v3 offset:7168
    ds_read_b128 v[20:23], v3 offset:27648
    s_waitcnt lgkmcnt(4)
    v_mfma_f32_16x16x32_bf16 v[40:43], a[52:55], v[24:27], v[40:43]
    v_mfma_f32_16x16x32_bf16 v[44:47], a[52:55], v[28:31], v[44:47]
    v_mfma_f32_16x16x32_bf16 v[48:51], a[132:135], v[24:27], v[48:51]
    v_mfma_f32_16x16x32_bf16 v[52:55], a[132:135], v[28:31], v[52:55]
    v_mfma_f32_16x16x32_bf16 v[56:59], a[212:215], v[24:27], v[56:59]
    v_mfma_f32_16x16x32_bf16 v[60:63], a[212:215], v[28:31], v[60:63]
    ds_read_b128 v[24:27], v2 offset:8192
    ds_read_b128 v[28:31], v2 offset:28672
    s_waitcnt lgkmcnt(4)
    v_mfma_f32_16x16x32_bf16 v[40:43], a[56:59], v[32:35], v[40:43]
    v_mfma_f32_16x16x32_bf16 v[44:47], a[56:59], v[36:39], v[44:47]
    v_mfma_f32_16x16x32_bf16 v[48:51], a[136:139], v[32:35], v[48:51]
    v_mfma_f32_16x16x32_bf16 v[52:55], a[136:139], v[36:39], v[52:55]
    v_mfma_f32_16x16x32_bf16 v[56:59], a[216:219], v[32:35], v[56:59]
    v_mfma_f32_16x16x32_bf16 v[60:63], a[216:219], v[36:39], v[60:63]
    ds_read_b128 v[32:35], v3 offset:8192
    ds_read_b128 v[36:39], v3 offset:28672
    s_waitcnt lgkmcnt(4)
    v_mfma_f32_16x16x32_bf16 v[40:43], a[60:63], v[16:19], v[40:43]
    v_mfma_f32_16x16x32_bf16 v[44:47], a[60:63], v[20:23], v[44:47]
    v_mfma_f32_16x16x32_bf16 v[48:51], a[140:143], v[16:19], v[48:51]
    v_mfma_f32_16x16x32_bf16 v[52:55], a[140:143], v[20:23], v[52:55]
    v_mfma_f32_16x16x32_bf16 v[56:59], a[220:223], v[16:19], v[56:59]
    v_mfma_f32_16x16x32_bf16 v[60:63], a[220:223], v[20:23], v[60:63]
    ds_read_b128 v[16:19], v2 offset:9216
    ds_read_b128 v[20:23], v2 offset:29696
    s_waitcnt lgkmcnt(4)
    v_mfma_f32_16x16x32_bf16 v[40:43], a[64:67], v[24:27], v[40:43]
    v_mfma_f32_16x16x32_bf16 v[44:47], a[64:67], v[28:31], v[44:47]
    v_mfma_f32_16x16x32_bf16 v[48:51], a[144:147], v[24:27], v[48:51]
    v_mfma_f32_16x16x32_bf16 v[52:55], a[144:147], v[28:31], v[52:55]
    v_mfma_f32_16x16x32_bf16 v[56:59], a[224:227], v[24:27], v[56:59]
    v_mfma_f32_16x16x32_bf16 v[60:63], a[224:227], v[28:31], v[60:63]
    ds_read_b128 v[24:27], v3 offset:9216
    ds_read_b128 v[28:31], v3 offset:29696
    s_waitcnt lgkmcnt(4)
    v_mfma_f32_16x16x32_bf16 v[40:43], a[68:71], v[32:35], v[40:43]
    v_mfma_f32_16x16x32_bf16 v[44:47], a[68:71], v[36:39], v[44:47]
    v_mfma_f32_16x16x32_bf16 v[48:51], a[148:151], v[32:35], v[48:51]
    v_mfma_f32_16x16x32_bf16 v[52:55], a[148:151], v[36:39], v[52:55]
    v_mfma_f32_16x16x32_bf16 v[56:59], a[228:231], v[32:35], v[56:59]
    v_mfma_f32_16x16x32_bf16 v[60:63], a[228:231], v[36:39], v[60:63]
    s_waitcnt lgkmcnt(2)
    v_mfma_f32_16x16x32_bf16 v[40:43], a[72:75], v[16:19], v[40:43]
    v_mfma_f32_16x16x32_bf16 v[44:47], a[72:75], v[20:23], v[44:47]
    v_mfma_f32_16x16x32_bf16 v[48:51], a[152:155], v[16:19], v[48:51]
    v_mfma_f32_16x16x32_bf16 v[52:55], a[152:155], v[20:23], v[52:55]
    v_mfma_f32_16x16x32_bf16 v[56:59], a[232:235], v[16:19], v[56:59]
    v_mfma_f32_16x16x32_bf16 v[60:63], a[232:235], v[20:23], v[60:63]
    s_waitcnt lgkmcnt(0)
    v_mfma_f32_16x16x32_bf16 v[40:43], a[76:79], v[24:27], v[40:43]
    v_mfma_f32_16x16x32_bf16 v[44:47], a[76:79], v[28:31], v[44:47]
    v_mfma_f32_16x16x32_bf16 v[48:51], a[156:159], v[24:27], v[48:51]
    v_mfma_f32_16x16x32_bf16 v[52:55], a[156:159], v[28:31], v[52:55]
    v_mfma_f32_16x16x32_bf16 v[56:59], a[236:239], v[24:27], v[56:59]
    v_mfma_f32_16x16x32_bf16 v[60:63], a[236:239], v[28:31], v[60:63]
L_Gs_act_2:
    s_nop 3
    v_permlane32_swap_b32 v40, v44
    v_permlane32_swap_b32 v41, v45
    v_permlane32_swap_b32 v42, v46
    v_permlane32_swap_b32 v43, v47
    v_permlane32_swap_b32 v48, v52
    v_permlane32_swap_b32 v49, v53
    v_permlane32_swap_b32 v50, v54
    v_permlane32_swap_b32 v51, v55
    v_permlane32_swap_b32 v56, v60
    v_permlane32_swap_b32 v57, v61
    v_permlane32_swap_b32 v58, v62
    v_permlane32_swap_b32 v59, v63
    v_pk_mul_f32 v[40:41], v[40:41], s[46:47]
    v_pk_mul_f32 v[42:43], v[42:43], s[46:47]
    v_pk_mul_f32 v[48:49], v[48:49], s[46:47]
    v_pk_mul_f32 v[50:51], v[50:51], s[46:47]
    v_pk_mul_f32 v[56:57], v[56:57], s[46:47]
    v_pk_mul_f32 v[58:59], v[58:59], s[46:47]
    v_exp_f32 v40, v40
    v_exp_f32 v41, v41
    v_exp_f32 v42, v42
    v_exp_f32 v43, v43
    v_exp_f32 v48, v48
    v_exp_f32 v49, v49
    v_exp_f32 v50, v50
    v_exp_f32 v51, v51
    v_exp_f32 v56, v56
    v_exp_f32 v57, v57
    v_exp_f32 v58, v58
    v_exp_f32 v59, v59
    v_pk_add_f32 v[40:41], v[40:41], 1.0 op_sel_hi:[1,0]
    v_pk_add_f32 v[42:43], v[42:43], 1.0 op_sel_hi:[1,0]
    v_pk_add_f32 v[48:49], v[48:49], 1.0 op_sel_hi:[1,0]
    v_pk_add_f32 v[50:51], v[50:51], 1.0 op_sel_hi:[1,0]
    v_pk_add_f32 v[56:57], v[56:57], 1.0 op_sel_hi:[1,0]
    v_pk_add_f32 v[58:59], v[58:59], 1.0 op_sel_hi:[1,0]
    v_rcp_f32 v40, v40
    v_rcp_f32 v41, v41
    v_rcp_f32 v42, v42
    v_rcp_f32 v43, v43
    v_rcp_f32 v48, v48
    v_rcp_f32 v49, v49
    v_rcp_f32 v50, v50
    v_rcp_f32 v51, v51
    v_rcp_f32 v56, v56
    v_rcp_f32 v57, v57
    v_rcp_f32 v58, v58
    v_rcp_f32 v59, v59
    v_pk_mul_f32 v[40:41], v[40:41], v[44:45]
    v_pk_mul_f32 v[42:43], v[42:43], v[46:47]
    v_cvt_pk_bf16_f32 v64, v40, v41
    v_cvt_pk_bf16_f32 v65, v42, v43
    ds_write_b64 v13, v[64:65]
    v_pk_mul_f32 v[48:49], v[48:49], v[52:53]
    v_pk_mul_f32 v[50:51], v[50:51], v[54:55]
    v_cvt_pk_bf16_f32 v66, v48, v49
    v_cvt_pk_bf16_f32 v67, v50, v51
    ds_write_b64 v129, v[66:67]
    v_pk_mul_f32 v[56:57], v[56:57], v[60:61]
    v_pk_mul_f32 v[58:59], v[58:59], v[62:63]
    v_cvt_pk_bf16_f32 v68, v56, v57
    v_cvt_pk_bf16_f32 v69, v58, v59
    ds_write_b64 v15, v[68:69]
    s_waitcnt vmcnt(0)
    v_cmp_gt_u32 vcc, s27, v10
    s_cmp_eq_u64 vcc, 0
    s_cselect_b32 s3, 1, 0
    v_mov_b32 v11, s3
    s_cmp_eq_u32 s12, 0
    s_cselect_b64 exec, 1, 0
    ds_write_b32 v0, v11 offset:64
    s_mov_b64 exec, -1
    s_waitcnt lgkmcnt(0)
    s_barrier
    v_mov_b32 v10, 0
    ds_read_b32 v10, v10 offset:64
    ds_read_b128 v[16:19], v0 offset:1024
    ds_read_b128 v[20:23], v0 offset:2048
    ds_read_b128 v[24:27], v0 offset:3072
    ds_read_b128 v[28:31], v0 offset:4096
    ds_read_b128 v[32:35], v0 offset:5120
    ds_read_b128 v[36:39], v0 offset:6144
    s_waitcnt lgkmcnt(6)
    v_readfirstlane_b32 s43, v10
    s_waitcnt lgkmcnt(5)
    v_mfma_f32_16x16x32_bf16 v[40:43], v[136:139], v[16:19], 0
    s_waitcnt lgkmcnt(4)
    v_mfma_f32_16x16x32_bf16 v[40:43], v[140:143], v[20:23], v[40:43]
    s_waitcnt lgkmcnt(3)
    v_mfma_f32_16x16x32_bf16 v[40:43], v[144:147], v[24:27], v[40:43]
    v_mfma_f32_16x16x32_bf16 v[44:47], v[148:151], v[16:19], 0
    v_mfma_f32_16x16x32_bf16 v[44:47], v[152:155], v[20:23], v[44:47]
    v_mfma_f32_16x16x32_bf16 v[44:47], v[156:159], v[24:27], v[44:47]
    s_waitcnt lgkmcnt(2)
    v_mfma_f32_16x16x32_bf16 v[48:51], v[136:139], v[28:31], 0
    s_nop 2
    v_cvt_pk_bf16_f32 v56, v40, v41
    s_waitcnt lgkmcnt(1)
    v_mfma_f32_16x16x32_bf16 v[48:51], v[140:143], v[32:35], v[48:51]
    v_cvt_pk_bf16_f32 v57, v42, v43
    v_and_or_b32 v56, v56, -2, s28
    s_waitcnt lgkmcnt(0)
    v_mfma_f32_16x16x32_bf16 v[48:51], v[144:147], v[36:39], v[48:51]
    v_cvt_pk_bf16_f32 v58, v44, v45
    v_mfma_f32_16x16x32_bf16 v[52:55], v[148:151], v[28:31], 0
    v_cvt_pk_bf16_f32 v59, v46, v47
    v_mfma_f32_16x16x32_bf16 v[52:55], v[152:155], v[32:35], v[52:55]
    ds_write_b128 v126, v[56:59] offset:0
    v_mfma_f32_16x16x32_bf16 v[52:55], v[156:159], v[36:39], v[52:55]
    ds_read_b128 v[64:67], v127 offset:0
    v_mfma_f32_16x16x32_bf16 v[40:43], v[160:163], v[16:19], 0
    v_cvt_pk_bf16_f32 v60, v48, v49
    v_mfma_f32_16x16x32_bf16 v[40:43], v[164:167], v[20:23], v[40:43]
    v_cvt_pk_bf16_f32 v61, v50, v51
    v_and_or_b32 v60, v60, -2, s28
    v_mfma_f32_16x16x32_bf16 v[40:43], v[168:171], v[24:27], v[40:43]
    s_nop 0
    v_cvt_pk_bf16_f32 v62, v52, v53
    v_mfma_f32_16x16x32_bf16 v[44:47], v[172:175], v[16:19], 0
    s_waitcnt lgkmcnt(0)
    buffer_store_dwordx4 v[64:67], v4, s[4:7], s30 offen offset:0 sc1
    v_cvt_pk_bf16_f32 v63, v54, v55
    v_mfma_f32_16x16x32_bf16 v[44:47], v[176:179], v[20:23], v[44:47]
    ds_write_b128 v126, v[60:63] offset:1024
    v_mfma_f32_16x16x32_bf16 v[44:47], v[180:183], v[24:27], v[44:47]
    ds_read_b128 v[68:71], v127 offset:1024
    v_mfma_f32_16x16x32_bf16 v[48:51], v[160:163], v[28:31], 0
    v_cvt_pk_bf16_f32 v56, v40, v41
    v_mfma_f32_16x16x32_bf16 v[48:51], v[164:167], v[32:35], v[48:51]
    v_cvt_pk_bf16_f32 v57, v42, v43
    v_and_or_b32 v56, v56, -2, s28
    v_mfma_f32_16x16x32_bf16 v[48:51], v[168:171], v[36:39], v[48:51]
    s_nop 0
    v_cvt_pk_bf16_f32 v58, v44, v45
    v_mfma_f32_16x16x32_bf16 v[52:55], v[172:175], v[28:31], 0
    s_waitcnt lgkmcnt(0)
    buffer_store_dwordx4 v[68:71], v4, s[4:7], s31 offen offset:0 sc1
    v_cvt_pk_bf16_f32 v59, v46, v47
    v_mfma_f32_16x16x32_bf16 v[52:55], v[176:179], v[32:35], v[52:55]
    ds_write_b128 v126, v[56:59] offset:0
    v_mfma_f32_16x16x32_bf16 v[52:55], v[180:183], v[36:39], v[52:55]
    ds_read_b128 v[64:67], v127 offset:0
    v_mfma_f32_16x16x32_bf16 v[40:43], v[184:187], v[16:19], 0
    v_cvt_pk_bf16_f32 v60, v48, v49
    v_mfma_f32_16x16x32_bf16 v[40:43], v[188:191], v[20:23], v[40:43]
    v_cvt_pk_bf16_f32 v61, v50, v51
    v_and_or_b32 v60, v60, -2, s28
    v_mfma_f32_16x16x32_bf16 v[40:43], v[192:195], v[24:27], v[40:43]
    s_nop 0
    v_cvt_pk_bf16_f32 v62, v52, v53
    v_mfma_f32_16x16x32_bf16 v[44:47], v[196:199], v[16:19], 0
    s_waitcnt lgkmcnt(0)
    buffer_store_dwordx4 v[64:67], v4, s[4:7], s30 offen offset:64 sc1
    v_cvt_pk_bf16_f32 v63, v54, v55
    v_mfma_f32_16x16x32_bf16 v[44:47], v[200:203], v[20:23], v[44:47]
    ds_write_b128 v126, v[60:63] offset:1024
    v_mfma_f32_16x16x32_bf16 v[44:47], v[204:207], v[24:27], v[44:47]
    ds_read_b128 v[68:71], v127 offset:1024
    v_mfma_f32_16x16x32_bf16 v[48:51], v[184:187], v[28:31], 0
    v_cvt_pk_bf16_f32 v56, v40, v41
    v_mfma_f32_16x16x32_bf16 v[48:51], v[188:191], v[32:35], v[48:51]
    v_cvt_pk_bf16_f32 v57, v42, v43
    v_and_or_b32 v56, v56, -2, s28
    v_mfma_f32_16x16x32_bf16 v[48:51], v[192:195], v[36:39], v[48:51]
    s_nop 0
    v_cvt_pk_bf16_f32 v58, v44, v45
    v_mfma_f32_16x16x32_bf16 v[52:55], v[196:199], v[28:31], 0
    s_waitcnt lgkmcnt(0)
    buffer_store_dwordx4 v[68:71], v4, s[4:7], s31 offen offset:64 sc1
    v_cvt_pk_bf16_f32 v59, v46, v47
    v_mfma_f32_16x16x32_bf16 v[52:55], v[200:203], v[32:35], v[52:55]
    ds_write_b128 v126, v[56:59] offset:0
    v_mfma_f32_16x16x32_bf16 v[52:55], v[204:207], v[36:39], v[52:55]
    ds_read_b128 v[64:67], v127 offset:0
    v_mfma_f32_16x16x32_bf16 v[40:43], v[208:211], v[16:19], 0
    v_cvt_pk_bf16_f32 v60, v48, v49
    v_mfma_f32_16x16x32_bf16 v[40:43], v[212:215], v[20:23], v[40:43]
    v_cvt_pk_bf16_f32 v61, v50, v51
    v_and_or_b32 v60, v60, -2, s28
    v_mfma_f32_16x16x32_bf16 v[40:43], v[216:219], v[24:27], v[40:43]
    s_nop 0
    v_cvt_pk_bf16_f32 v62, v52, v53
    v_mfma_f32_16x16x32_bf16 v[44:47], v[220:223], v[16:19], 0
    s_waitcnt lgkmcnt(0)
    buffer_store_dwordx4 v[64:67], v4, s[4:7], s30 offen offset:128 sc1
    v_cvt_pk_bf16_f32 v63, v54, v55
    v_mfma_f32_16x16x32_bf16 v[44:47], v[224:227], v[20:23], v[44:47]
    ds_write_b128 v126, v[60:63] offset:1024
    v_mfma_f32_16x16x32_bf16 v[44:47], v[228:231], v[24:27], v[44:47]
    ds_read_b128 v[68:71], v127 offset:1024
    v_mfma_f32_16x16x32_bf16 v[48:51], v[208:211], v[28:31], 0
    v_cvt_pk_bf16_f32 v56, v40, v41
    v_mfma_f32_16x16x32_bf16 v[48:51], v[212:215], v[32:35], v[48:51]
    v_cvt_pk_bf16_f32 v57, v42, v43
    v_and_or_b32 v56, v56, -2, s28
    v_mfma_f32_16x16x32_bf16 v[48:51], v[216:219], v[36:39], v[48:51]
    s_nop 0
    v_cvt_pk_bf16_f32 v58, v44, v45
    v_mfma_f32_16x16x32_bf16 v[52:55], v[220:223], v[28:31], 0
    s_waitcnt lgkmcnt(0)
    buffer_store_dwordx4 v[68:71], v4, s[4:7], s31 offen offset:128 sc1
    v_cvt_pk_bf16_f32 v59, v46, v47
    v_mfma_f32_16x16x32_bf16 v[52:55], v[224:227], v[32:35], v[52:55]
    ds_write_b128 v126, v[56:59] offset:0
    v_mfma_f32_16x16x32_bf16 v[52:55], v[228:231], v[36:39], v[52:55]
    ds_read_b128 v[64:67], v127 offset:0
    v_mfma_f32_16x16x32_bf16 v[40:43], v[232:235], v[16:19], 0
    v_cvt_pk_bf16_f32 v60, v48, v49
    v_mfma_f32_16x16x32_bf16 v[40:43], v[236:239], v[20:23], v[40:43]
    v_cvt_pk_bf16_f32 v61, v50, v51
    v_and_or_b32 v60, v60, -2, s28
    v_mfma_f32_16x16x32_bf16 v[40:43], v[240:243], v[24:27], v[40:43]
    s_nop 0
    v_cvt_pk_bf16_f32 v62, v52, v53
    v_mfma_f32_16x16x32_bf16 v[44:47], v[244:247], v[16:19], 0
    s_waitcnt lgkmcnt(0)
    buffer_store_dwordx4 v[64:67], v4, s[4:7], s30 offen offset:192 sc1
    v_cvt_pk_bf16_f32 v63, v54, v55
    v_mfma_f32_16x16x32_bf16 v[44:47], v[248:251], v[20:23], v[44:47]
    ds_write_b128 v126, v[60:63] offset:1024
    v_mfma_f32_16x16x32_bf16 v[44:47], v[252:255], v[24:27], v[44:47]
    ds_read_b128 v[68:71], v127 offset:1024
    v_mfma_f32_16x16x32_bf16 v[48:51], v[232:235], v[28:31], 0
    v_cvt_pk_bf16_f32 v56, v40, v41
    v_mfma_f32_16x16x32_bf16 v[48:51], v[236:239], v[32:35], v[48:51]
    v_cvt_pk_bf16_f32 v57, v42, v43
    v_and_or_b32 v56, v56, -2, s28
    v_mfma_f32_16x16x32_bf16 v[48:51], v[240:243], v[36:39], v[48:51]
    s_nop 0
    v_cvt_pk_bf16_f32 v58, v44, v45
    v_mfma_f32_16x16x32_bf16 v[52:55], v[244:247], v[28:31], 0
    s_waitcnt lgkmcnt(0)
    buffer_store_dwordx4 v[68:71], v4, s[4:7], s31 offen offset:192 sc1
    v_cvt_pk_bf16_f32 v59, v46, v47
    v_mfma_f32_16x16x32_bf16 v[52:55], v[248:251], v[32:35], v[52:55]
    ds_write_b128 v126, v[56:59] offset:0
    v_mfma_f32_16x16x32_bf16 v[52:55], v[252:255], v[36:39], v[52:55]
    ds_read_b128 v[64:67], v127 offset:0
    v_cvt_pk_bf16_f32 v60, v48, v49
    v_cvt_pk_bf16_f32 v61, v50, v51
    v_and_or_b32 v60, v60, -2, s28
    s_nop 3
    v_cvt_pk_bf16_f32 v62, v52, v53
    s_waitcnt lgkmcnt(0)
    buffer_store_dwordx4 v[64:67], v4, s[4:7], s30 offen offset:256 sc1
    v_cvt_pk_bf16_f32 v63, v54, v55
    ds_write_b128 v126, v[60:63] offset:1024
    ds_read_b128 v[68:71], v127 offset:1024
    s_waitcnt lgkmcnt(0)
    buffer_store_dwordx4 v[68:71], v4, s[4:7], s31 offen offset:256 sc1
    s_add_u32 s30, s30, s39
    s_add_u32 s31, s31, s39
    s_cmp_eq_u32 s12, 0
    s_cselect_b32 s42, s89, 0
    s_waitcnt vmcnt(0)
    s_add_u32 s25, s32, 0
    buffer_load_dwordx4 v[72:75], v5, s[4:7], s25 offen sc1
    s_add_u32 s25, s32, 256
    buffer_load_dwordx4 v[76:79], v5, s[4:7], s25 offen sc1
    s_add_u32 s25, s32, 5120
    buffer_load_dwordx4 v[80:83], v5, s[4:7], s25 offen sc1
    s_add_u32 s25, s32, 5376
    buffer_load_dwordx4 v[84:87], v5, s[4:7], s25 offen sc1
    s_add_u32 s25, s32, 10240
    buffer_load_dwordx4 v[88:91], v5, s[4:7], s25 offen sc1
    s_add_u32 s25, s32, 10496
    buffer_load_dwordx4 v[92:95], v5, s[4:7], s25 offen sc1
    s_add_u32 s25, s32, 15360
    buffer_load_dwordx4 v[96:99], v5, s[4:7], s25 offen sc1
    s_add_u32 s25, s32, 15616
    buffer_load_dwordx4 v[100:103], v5, s[4:7], s25 offen sc1
    s_add_u32 s25, s32, 0
    buffer_load_dwordx4 v[104:107], v6, s[4:7], s25 offen sc1
    s_add_u32 s25, s32, 10240
    buffer_load_dwordx4 v[108:111], v6, s[4:7], s25 offen sc1
    s_mov_b32 s19, 0
L_Gs_red_5:
    v_mfma_f32_16x16x32_bf16 v[16:19], a[240:243], v[112:115], 0
    v_mfma_f32_16x16x32_bf16 v[20:23], a[240:243], v[120:123], 0
    v_mfma_f32_16x16x32_bf16 v[16:19], a[244:247], v[116:119], v[16:19]
    s_waitcnt vmcnt(9)
    v_mfma_f32_16x16x32_bf16 v[16:19], a[240:243], v[72:75], v[16:19]
    v_xor_b32 v12, s29, v72
    s_waitcnt vmcnt(8)
    v_mfma_f32_16x16x32_bf16 v[16:19], a[244:247], v[76:79], v[16:19]
    v_bitop3_b32 v12, v12, v76, s29 bitop3:0xf6
    s_waitcnt vmcnt(7)
    v_mfma_f32_16x16x32_bf16 v[16:19], a[240:243], v[80:83], v[16:19]
    v_bitop3_b32 v12, v12, v80, s29 bitop3:0xf6
    s_waitcnt vmcnt(6)
    v_mfma_f32_16x16x32_bf16 v[16:19], a[244:247], v[84:87], v[16:19]
    v_bitop3_b32 v12, v12, v84, s29 bitop3:0xf6
    s_waitcnt vmcnt(5)
    v_mfma_f32_16x16x32_bf16 v[16:19], a[240:243], v[88:91], v[16:19]
    v_bitop3_b32 v12, v12, v88, s29 bitop3:0xf6
    s_waitcnt vmcnt(4)
    v_mfma_f32_16x16x32_bf16 v[16:19], a[244:247], v[92:95], v[16:19]
    v_bitop3_b32 v12, v12, v92, s29 bitop3:0xf6
    s_waitcnt vmcnt(3)
    v_mfma_f32_16x16x32_bf16 v[16:19], a[240:243], v[96:99], v[16:19]
    v_bitop3_b32 v12, v12, v96, s29 bitop3:0xf6
    s_waitcnt vmcnt(2)
    v_mfma_f32_16x16x32_bf16 v[16:19], a[244:247], v[100:103], v[16:19]
    v_bitop3_b32 v12, v12, v100, s29 bitop3:0xf6
    s_waitcnt vmcnt(1)
    v_mfma_f32_16x16x32_bf16 v[20:23], a[240:243], v[104:107], v[20:23]
    v_bitop3_b32 v12, v12, v104, s29 bitop3:0xf6
    s_waitcnt vmcnt(0)
    v_mfma_f32_16x16x32_bf16 v[20:23], a[240:243], v[108:111], v[20:23]
    v_bitop3_b32 v12, v12, v108, s29 bitop3:0xf6
    v_and_b32 v12, 1, v12
    v_cmp_ne_u32 vcc, 0, v12
    s_nop 0
    s_cbranch_vccnz L_Gs_redfix_6
    s_nop 2
    v_add_f32_dpp v20, v20, v20 row_ror:8 row_mask:0xf bank_mask:0xf
    v_add_f32_dpp v21, v21, v21 row_ror:8 row_mask:0xf bank_mask:0xf
    v_add_f32_dpp v22, v22, v22 row_ror:8 row_mask:0xf bank_mask:0xf
    v_add_f32_dpp v23, v23, v23 row_ror:8 row_mask:0xf bank_mask:0xf
    buffer_load_dword v10, v9, s[4:7], s24 offen sc1
    v_cvt_pk_bf16_f32 v64, v16, v17
    v_cvt_pk_bf16_f32 v65, v18, v19
    v_cvt_pk_bf16_f32 v66, v20, v21
    v_cvt_pk_bf16_f32 v67, v22, v23
    v_lshlrev_b32 v16, 16, v64
    v_and_b32 v17, 0xffff0000, v64
    v_lshlrev_b32 v18, 16, v65
    v_and_b32 v19, 0xffff0000, v65
    v_lshlrev_b32 v20, 16, v66
    v_and_b32 v21, 0xffff0000, v66
    v_lshlrev_b32 v22, 16, v67
    v_and_b32 v23, 0xffff0000, v67
    s_cmp_lg_u32 s20, 0
    s_cbranch_scc1 L_Gs_last_7
    v_readfirstlane_b32 s86, v16
    s_nop 1
    v_pk_add_f32 v[32:33], v[16:17], s[86:87] op_sel_hi:[1,0] neg_lo:[0,1] neg_hi:[0,1]
    v_pk_add_f32 v[34:35], v[18:19], s[86:87] op_sel_hi:[1,0] neg_lo:[0,1] neg_hi:[0,1]
    v_pk_add_f32 v[36:37], v[20:21], s[86:87] op_sel_hi:[1,0] neg_lo:[0,1] neg_hi:[0,1]
    v_pk_add_f32 v[38:39], v[22:23], s[86:87] op_sel_hi:[1,0] neg_lo:[0,1] neg_hi:[0,1]
    v_pk_add_f32 v[26:27], v[32:33], v[34:35]
    v_pk_mul_f32 v[28:29], v[32:33], v[32:33]
    v_pk_fma_f32 v[28:29], v[34:35], v[34:35], v[28:29]
    v_add_f32 v30, v26, v27
    v_add_f32 v31, v28, v29
    v_pk_add_f32 v[26:27], v[36:37], v[38:39]
    v_pk_mul_f32 v[28:29], v[36:37], v[36:37]
    v_pk_fma_f32 v[28:29], v[38:39], v[38:39], v[28:29]
    v_add_f32 v24, v26, v27
    v_add_f32 v25, v28, v29
    v_cndmask_b32 v24, 0, v24, s[44:45]
    v_cndmask_b32 v25, 0, v25, s[44:45]
    v_pk_add_f32 v[24:25], v[24:25], v[30:31]
    s_nop 1
    v_add_f32_dpp v24, v24, v24 quad_perm:[1,0,3,2] row_mask:0xf bank_mask:0xf
    v_add_f32_dpp v25, v25, v25 quad_perm:[1,0,3,2] row_mask:0xf bank_mask:0xf
    s_nop 0
    v_add_f32_dpp v24, v24, v24 quad_perm:[2,3,0,1] row_mask:0xf bank_mask:0xf
    v_add_f32_dpp v25, v25, v25 quad_perm:[2,3,0,1] row_mask:0xf bank_mask:0xf
    s_nop 0
    v_add_f32_dpp v24, v24, v24 row_half_mirror row_mask:0xf bank_mask:0xf
    v_add_f32_dpp v25, v25, v25 row_half_mirror row_mask:0xf bank_mask:0xf
    s_nop 0
    v_add_f32_dpp v24, v24, v24 row_mirror row_mask:0xf bank_mask:0xf
    v_add_f32_dpp v25, v25, v25 row_mirror row_mask:0xf bank_mask:0xf
    v_mov_b32 v26, v24
    v_mov_b32 v27, v25
    s_nop 0
    v_permlane16_swap_b32 v24, v26
    v_permlane16_swap_b32 v25, v27
    v_add_f32 v24, v24, v26
    v_add_f32 v25, v25, v27
    v_mov_b32 v26, v24
    v_mov_b32 v27, v25
    s_nop 0
    v_permlane32_swap_b32 v24, v26
    v_permlane32_swap_b32 v25, v27
    v_add_f32 v24, v24, v26
    v_add_f32 v25, v25, v27
    v_mul_f32 v26, 3.1250000000e-03, v24
    v_fma_f32 v25, -v26, v24, v25
    v_add_f32 v24, s86, v26
    s_mov_b64 exec, 1
    ds_write_b64 v14, v[24:25] offset:0
    s_mov_b64 exec, -1
    s_waitcnt lgkmcnt(0)
    s_barrier
    ds_read_b128 v[40:43], v128 offset:0
    s_waitcnt lgkmcnt(0)
    v_pk_add_f32 v[24:25], v[40:41], v[42:43]
    v_sub_f32 v26, v40, v42
    v_mul_f32 v24, 0.5, v24
    v_mul_f32 v26, v26, v26
    v_mul_f32 v25, 1.5625000000e-03, v25
    v_fmac_f32 v25, 0.25, v26
    v_max_f32 v25, 0, v25
    v_cvt_pk_bf16_f32 v26, v25, v24
    v_lshlrev_b32 v25, 16, v26
    v_and_b32 v24, 0xffff0000, v26
    v_add_f32 v25, 0x3727c5ac, v25
    v_pk_add_f32 v[32:33], v[16:17], v[24:25] op_sel_hi:[1,0] neg_lo:[0,1] neg_hi:[0,1]
    v_cvt_pk_bf16_f32 v26, v25, v25
    v_pk_add_f32 v[34:35], v[18:19], v[24:25] op_sel_hi:[1,0] neg_lo:[0,1] neg_hi:[0,1]
    v_lshlrev_b32 v26, 16, v26
    v_sqrt_f32 v26, v26
    v_pk_add_f32 v[36:37], v[20:21], v[24:25] op_sel_hi:[1,0] neg_lo:[0,1] neg_hi:[0,1]
    v_pk_add_f32 v[38:39], v[22:23], v[24:25] op_sel_hi:[1,0] neg_lo:[0,1] neg_hi:[0,1]
    v_cvt_pk_bf16_f32 v68, v32, v33
    v_cvt_pk_bf16_f32 v69, v34, v35
    v_cvt_pk_bf16_f32 v70, v36, v37
    v_cvt_pk_bf16_f32 v71, v38, v39
    v_cvt_pk_bf16_f32 v26, v26, v26
    v_lshlrev_b32 v26, 16, v26
    v_rcp_f32 v26, v26
    v_lshlrev_b32 v32, 16, v68
    v_and_b32 v33, 0xffff0000, v68
    v_lshlrev_b32 v34, 16, v69
    v_and_b32 v35, 0xffff0000, v69
    v_lshlrev_b32 v36, 16, v70
    v_and_b32 v37, 0xffff0000, v70
    v_lshlrev_b32 v38, 16, v71
    v_and_b32 v39, 0xffff0000, v71
    v_pk_mul_f32 v[32:33], v[32:33], v[26:27] op_sel_hi:[1,0]
    v_pk_mul_f32 v[34:35], v[34:35], v[26:27] op_sel_hi:[1,0]
    v_pk_mul_f32 v[36:37], v[36:37], v[26:27] op_sel_hi:[1,0]
    v_pk_mul_f32 v[38:39], v[38:39], v[26:27] op_sel_hi:[1,0]
    v_cvt_pk_bf16_f32 v68, v32, v33
    v_cvt_pk_bf16_f32 v69, v34, v35
    v_cvt_pk_bf16_f32 v70, v36, v37
    v_cvt_pk_bf16_f32 v71, v38, v39
    s_nop 0
    v_permlane16_swap_b32 v68, v70
    v_permlane16_swap_b32 v69, v71
    v_permlane16_swap_b32 v64, v66
    v_permlane16_swap_b32 v65, v67
    s_mov_b32 exec_lo, 16777215
    s_mov_b32 exec_hi, 65535
    buffer_store_dwordx4 v[68:71], v7, s[4:7], s37 offen offset:0 sc1
    buffer_store_dwordx4 v[64:67], v7, s[4:7], s36 offen offset:0 sc1
    s_mov_b64 exec, -1
    s_branch L_Gs_fin_8
L_Gs_last_7:
    buffer_store_dwordx2 v[64:65], v8, s[92:95], s36 offen
    s_mov_b64 exec, s[44:45]
    buffer_store_dwordx2 v[66:67], v125, s[92:95], s36 offen
    s_mov_b64 exec, -1
L_Gs_fin_8:
    s_add_u32 s32, s32, s39
    s_sub_u32 s39, 0, s39
    s_add_u32 s22, s22, 1
    s_add_u32 s35, s35, 40960
    s_add_u32 s36, s36, 40960
    s_add_u32 s37, s37, 40960
    s_cmp_lg_u32 s89, 0
    s_cbranch_scc1 L_Gs_have_11
    s_waitcnt vmcnt(2)
    v_cmp_gt_u32 vcc, s40, v10
    s_nop 0
    s_cbranch_vccnz L_Gs_notyet_9
    s_add_u32 m0, s90, 0
    s_nop 0
    buffer_load_dwordx4 v1, s[4:7], s38 offen offset:0 sc1 lds
    s_add_u32 m0, s90, 896
    s_nop 0
    buffer_load_dwordx4 v1, s[4:7], s38 offen offset:128 sc1 lds
    s_add_u32 m0, s90, 1792
    s_nop 0
    buffer_load_dwordx4 v1, s[4:7], s38 offen offset:256 sc1 lds
    s_add_u32 m0, s90, 2688
    s_nop 0
    buffer_load_dwordx4 v1, s[4:7], s38 offen offset:384 sc1 lds
    s_add_u32 m0, s90, 3584
    s_nop 0
    buffer_load_dwordx4 v1, s[4:7], s38 offen offset:512 sc1 lds
    s_add_u32 m0, s90, 4480
    s_nop 0
    buffer_load_dwordx4 v1, s[4:7], s38 offen offset:640 sc1 lds
    s_add_u32 m0, s90, 5376
    s_nop 0
    buffer_load_dwordx4 v1, s[4:7], s38 offen offset:768 sc1 lds
    s_add_u32 m0, s90, 6272
    s_nop 0
    buffer_load_dwordx4 v1, s[4:7], s38 offen offset:896 sc1 lds
    s_add_u32 m0, s90, 7168
    s_nop 0
    buffer_load_dwordx4 v1, s[4:7], s38 offen offset:1024 sc1 lds
    s_add_u32 m0, s90, 8064
    s_nop 0
    buffer_load_dwordx4 v1, s[4:7], s38 offen offset:1152 sc1 lds
    s_mov_b32 s89, 1
    s_waitcnt vmcnt(10)
    s_branch L_Gs_notyet_9b
L_Gs_notyet_9:
    buffer_load_dword v10, v9, s[4:7], s24 offen sc1
    s_waitcnt vmcnt(0)
L_Gs_notyet_9b:
    s_barrier
    s_cmp_lg_u32 s12, 0
    s_cbranch_scc1 L_Gs_nofl_10
    v_mov_b32 v11, s22
    s_mov_b64 exec, 1
    buffer_store_dword v11, v0, s[4:7], s23 offen offset:0 sc1
    s_mov_b64 exec, -1
L_Gs_nofl_10:
    s_cmp_eq_u32 s22, 64
    s_cbranch_scc1 L_Gs_top_end
    s_cmp_lg_u32 s89, 0
    s_cbranch_scc1 L_Gs_have_11
    s_mov_b32 s19, 0
    v_cmp_gt_u32 vcc, s40, v10
    s_nop 0
    s_cbranch_vccnz L_Gs_flspin_13
L_Gs_fl_12:
    s_add_u32 m0, s90, 0
    s_nop 0
    buffer_load_dwordx4 v1, s[4:7], s38 offen offset:0 sc1 lds
    s_add_u32 m0, s90, 896
    s_nop 0
    buffer_load_dwordx4 v1, s[4:7], s38 offen offset:128 sc1 lds
    s_add_u32 m0, s90, 1792
    s_nop 0
    buffer_load_dwordx4 v1, s[4:7], s38 offen offset:256 sc1 lds
    s_add_u32 m0, s90, 2688
    s_nop 0
    buffer_load_dwordx4 v1, s[4:7], s38 offen offset:384 sc1 lds
    s_add_u32 m0, s90, 3584
    s_nop 0
    buffer_load_dwordx4 v1, s[4:7], s38 offen offset:512 sc1 lds
    s_add_u32 m0, s90, 4480
    s_nop 0
    buffer_load_dwordx4 v1, s[4:7], s38 offen offset:640 sc1 lds
    s_add_u32 m0, s90, 5376
    s_nop 0
    buffer_load_dwordx4 v1, s[4:7], s38 offen offset:768 sc1 lds
    s_add_u32 m0, s90, 6272
    s_nop 0
    buffer_load_dwordx4 v1, s[4:7], s38 offen offset:896 sc1 lds
    s_add_u32 m0, s90, 7168
    s_nop 0
    buffer_load_dwordx4 v1, s[4:7], s38 offen offset:1024 sc1 lds
    s_add_u32 m0, s90, 8064
    s_nop 0
    buffer_load_dwordx4 v1, s[4:7], s38 offen offset:1152 sc1 lds
L_Gs_have_11:
    s_branch L_Gs_top
L_Gs_top_end:
    s_waitcnt vmcnt(0)
    s_endpgm
L_Gs_redfix_6:
    s_add_u32 s25, s32, 0
    buffer_load_dwordx4 v[72:75], v5, s[4:7], s25 offen sc1
    s_add_u32 s25, s32, 256
    buffer_load_dwordx4 v[76:79], v5, s[4:7], s25 offen sc1
    s_add_u32 s25, s32, 5120
    buffer_load_dwordx4 v[80:83], v5, s[4:7], s25 offen sc1
    s_add_u32 s25, s32, 5376
    buffer_load_dwordx4 v[84:87], v5, s[4:7], s25 offen sc1
    s_add_u32 s25, s32, 10240
    buffer_load_dwordx4 v[88:91], v5, s[4:7], s25 offen sc1
    s_add_u32 s25, s32, 10496
    buffer_load_dwordx4 v[92:95], v5, s[4:7], s25 offen sc1
    s_add_u32 s25, s32, 15360
    buffer_load_dwordx4 v[96:99], v5, s[4:7], s25 offen sc1
    s_add_u32 s25, s32, 15616
    buffer_load_dwordx4 v[100:103], v5, s[4:7], s25 offen sc1
    s_add_u32 s25, s32, 0
    buffer_load_dwordx4 v[104:107], v6, s[4:7], s25 offen sc1
    s_add_u32 s25, s32, 10240
    buffer_load_dwordx4 v[108:111], v6, s[4:7], s25 offen sc1
    s_add_u32 s19, s19, 1
    s_cmp_lt_u32 s19, 524288
    s_cbranch_scc1 L_Gs_red_5
    s_branch L_fail
L_Gs_flspin_13:
    buffer_load_dword v10, v9, s[4:7], s24 offen sc1
    s_add_u32 s19, s19, 1
    s_cmp_ge_u32 s19, 524288
    s_cbranch_scc1 L_fail
    s_waitcnt vmcnt(0)
    v_cmp_gt_u32 vcc, s40, v10
    s_nop 0
    s_cbranch_vccnz L_Gs_flspin_13
    s_branch L_Gs_fl_12
.section .rodata,"a"
.p2align 6
.amdhsa_kernel interleave_layers__memory_aug_recurrent_mem_tr__glu_gated_glu__prompt_kernel
  .amdhsa_next_free_vgpr 512
  .amdhsa_next_free_sgpr 102
  .amdhsa_accum_offset 256
  .amdhsa_group_segment_fixed_size 0
  .amdhsa_kernarg_size 112
  .amdhsa_user_sgpr_count 2
  .amdhsa_user_sgpr_kernarg_segment_ptr 1
  .amdhsa_system_sgpr_workgroup_id_x 1
  .amdhsa_float_denorm_mode_32 3
.end_amdhsa_kernel
```
